```python
import torch

def _softmax(x, axis=-1):
    return torch.softmax(x, dim=axis)
def _gelu(x):
    return torch.nn.functional.gelu(x, approximate="tanh")
def _silu(x):
    return torch.nn.functional.silu(x)
def _sigmoid(x):
    return torch.sigmoid(x)
def _layernorm(x, axis=-1, eps=1e-5):
    m = x.mean(dim=axis, keepdim=True)
    v = x.var(dim=axis, keepdim=True, unbiased=False)
    return (x - m) / torch.sqrt(v + eps)
def _scatter_add(tgt, idx, src, axis=0):
    return tgt.clone().index_add_(axis, idx, src)
def _segment_sum(src, seg, n):
    out = torch.zeros((n,) + src.shape[1:], dtype=src.dtype)
    return out.index_add_(0, seg, src)
def _pad(x, pw):
    flat = tuple(v for pair in reversed(pw) for v in pair)
    return torch.nn.functional.pad(x, flat)

kernel_name = 'gated_mix__ssm_conv_h3__compressed_kv_cla__prompt'

def setup_inputs():

    _w = (lambda a: (lambda t: t.to(torch.bfloat16) if t.is_floating_point() else t)(torch.as_tensor(a)))
    def _A_setup():
        B, S, D = 1, 2048, 1024
        ks = 4
        return {
            "q": _w((lambda *s: torch.randn(*s, dtype=torch.bfloat16) * 0.05)(B, S, D)),
            "k": _w((lambda *s: torch.randn(*s, dtype=torch.bfloat16) * 0.4)(B, S, D)),
            "v": _w((lambda *s: torch.randn(*s, dtype=torch.bfloat16) * 0.4)(B, S, D)),
            "shift_k": _w((lambda *s: torch.randn(*s, dtype=torch.bfloat16) * 0.4)(D, ks) * 0.5),
            "ssm_k": _w((lambda *s: torch.randn(*s, dtype=torch.bfloat16) * 0.8)(D, S) * (1.0 / S ** 0.5)),
            "ssm_D": _w((lambda *s: torch.randn(*s, dtype=torch.bfloat16) * 0.4)(D)),
        }
    _A_in = _A_setup()

    def _B_setup():
        B, H, Sq, Sk, D, M = 1, 32, 2048, 2048, 128, 1024
        Dc = 4 * D
        return {
            "x": _w((lambda *s: torch.randn(*s, dtype=torch.bfloat16) * 0.05)(B, Sq, M)),
            "c_kv": _w((lambda *s: torch.randn(*s, dtype=torch.bfloat16) * 0.4)(B, Sk, Dc)),
            "w_q": _w((lambda *s: torch.randn(*s, dtype=torch.bfloat16) * 6.4)(M, H, D) * (M ** -0.5)),
            "w_uk": _w((lambda *s: torch.randn(*s, dtype=torch.bfloat16) * 6.4)(Dc, H, D) * (Dc ** -0.5)),
            "w_uv": _w((lambda *s: torch.randn(*s, dtype=torch.bfloat16) * 0.4)(Dc, H, D) * (Dc ** -0.5)),
            "w_o": _w((lambda *s: torch.randn(*s, dtype=torch.bfloat16) * 0.4)(H, D, M) * ((H * D) ** -0.5)),
        }
    _B_in = _B_setup()

    return {
        "A_q": _A_in["q"],
        "A_k": _A_in["k"],
        "A_v": _A_in["v"],
        "A_shift_k": _A_in["shift_k"],
        "A_ssm_k": _A_in["ssm_k"],
        "A_ssm_D": _A_in["ssm_D"],
        "B_x": _B_in["x"],
        "B_c_kv": _B_in["c_kv"],
        "B_w_q": _B_in["w_q"],
        "B_w_uk": _B_in["w_uk"],
        "B_w_uv": _B_in["w_uv"],
        "B_w_o": _B_in["w_o"],
        "gate_w": _w((lambda *s: torch.randn(*s, dtype=torch.bfloat16) * 0.05)(1024) * 16.0),
    }

def reference(A_q, A_k, A_v, A_shift_k, A_ssm_k, A_ssm_D, B_x, B_c_kv, B_w_q, B_w_uk, B_w_uv, B_w_o, gate_w):
    def _A_ref(q, k, v, shift_k, ssm_k, ssm_D):
        B, S, D = q.shape
        ks = shift_k.shape[-1]
        k_pad = _pad(k, ((0, 0), (ks - 1, 0), (0, 0)))
        k_shift = torch.zeros_like(k)
        for t in range(ks):
            k_shift = k_shift + k_pad[:, t:t + S, :] * shift_k[:, ks - 1 - t][None, None, :]
        kv = k_shift * v
        L = 2 * S
        kv_pad = _pad(kv, ((0, 0), (0, S), (0, 0)))
        kf_pad = _pad(ssm_k, ((0, 0), (0, S)))
        kv_f = (lambda x, axes=(-2,-1): torch.fft.rfft2(x.float(), dim=axes))(kv_pad[:, None, :, :], axes=(1, 2))
        kf_f = (lambda x, axes=(-2,-1): torch.fft.rfft2(x.float(), dim=axes))(kf_pad[:, None, :], axes=(1, 2))
        kf_f = (lambda x, *d: x.permute(*d))(kf_f, 1, 2, 0)
        y_f = kv_f * kf_f[None, :, :, :]
        y = (lambda x, s, axes=(-2,-1): torch.fft.irfft2(x, s=s, dim=axes).to(torch.bfloat16))(y_f, (1, L), axes=(1, 2))[:, 0, :S, :]
        y = y + kv * ssm_D[None, None, :]
        return q * y

    def _B_ref(x, c_kv, w_q, w_uk, w_uv, w_o):
        B, Sq, M = x.shape[0], x.shape[1], x.shape[2]
        Sk = c_kv.shape[1]
        H, D = w_q.shape[1], w_q.shape[2]
        q = torch.einsum("bqm,mhd->bhqd", x, w_q)
        k = torch.einsum("bkc,chd->bhkd", c_kv, w_uk)
        v = torch.einsum("bkc,chd->bhkd", c_kv, w_uv)
        scores = torch.einsum("bhqd,bhkd->bhqk", q, k) * (D ** -0.5)
        off = Sk - Sq
        qi = torch.arange(Sq)[:, None]
        kj = torch.arange(Sk)[None, :]
        cmask = kj <= (qi + off)
        scores = torch.where(cmask[None, None], scores, -1e9)
        p = _softmax(scores, axis=-1)
        ctx = torch.einsum("bhqk,bhkd->bhqd", p, v)
        return torch.einsum("bhqd,hdm->bqm", ctx, w_o)

    x = A_q
    g = _sigmoid((x * gate_w).sum(-1, keepdims=True))
    a = _A_ref(x, A_k, A_v, A_shift_k, A_ssm_k, A_ssm_D)
    b = _B_ref(x, B_c_kv, B_w_q, B_w_uk, B_w_uv, B_w_o)
    return g * a + (1 - g) * b
```

```asm
; @launch kernel=kvproj_kernel grid=(256,1,1) block=(256,1,1) lds=163840
; @launch kernel=attn_kernel grid=(256,1,1) block=(256,1,1) lds=163840
; @launch kernel=conv_kernel grid=(256,1,1) block=(256,1,1) lds=108160
; @launch kernel=outproj_kernel grid=(256,1,1) block=(256,1,1) lds=81920
.amdgcn_target "amdgcn-amd-amdhsa--gfx950"
.text
.globl kvproj_kernel
.p2align 8
.type kvproj_kernel,@function
kvproj_kernel:
    s_cmp_ge_u32 s2, 256
    s_cbranch_scc1 kvproj_kernel_end
    s_load_dwordx2 s[20:21], s[0:1], 56
    s_load_dwordx4 s[24:27], s[0:1], 72
    s_load_dwordx2 s[22:23], s[0:1], 120
    v_lshrrev_b32 v16, 6, v0
    v_and_b32 v1, 63, v0
    v_readfirstlane_b32 s40, v16
    s_and_b32 s48, s2, 7
    s_lshl_b32 s48, s48, 2
    s_lshr_b32 s49, s2, 3
    s_and_b32 s41, s49, 3
    s_add_u32 s41, s41, s48
    s_lshr_b32 s42, s2, 5
    v_lshrrev_b32 v16, 3, v1
    v_and_b32 v17, 7, v1
    v_add_u32 v18, 0, v16
    v_bfe_u32 v19, v18, 1, 3
    v_xor_b32 v19, v19, v17
    v_lshlrev_b32 v19, 4, v19
    v_lshl_add_u32 v2, v18, 10, v19
    v_add_u32 v18, 8, v16
    v_bfe_u32 v19, v18, 1, 3
    v_xor_b32 v19, v19, v17
    v_lshlrev_b32 v19, 4, v19
    v_lshl_add_u32 v3, v18, 10, v19
    v_subrev_u32 v3, 1024, v3
    v_add_u32 v18, 16, v16
    v_bfe_u32 v19, v18, 1, 3
    v_xor_b32 v19, v19, v17
    v_lshlrev_b32 v19, 4, v19
    v_lshl_add_u32 v4, v18, 10, v19
    v_subrev_u32 v4, 2048, v4
    v_add_u32 v18, 24, v16
    v_bfe_u32 v19, v18, 1, 3
    v_xor_b32 v19, v19, v17
    v_lshlrev_b32 v19, 4, v19
    v_lshl_add_u32 v5, v18, 10, v19
    v_subrev_u32 v5, 3072, v5
    v_lshrrev_b32 v16, 4, v1
    s_and_b32 s48, s40, 1
    s_lshl_b32 s48, s48, 2
    v_or_b32 v17, s48, v16
    v_lshlrev_b32 v17, 1, v17
    v_and_b32 v18, 15, v1
    v_xor_b32 v17, v17, v18
    v_lshlrev_b32 v17, 4, v17
    v_lshl_add_u32 v6, v16, 13, v17
    v_add_u32 v7, 31744, v6
    v_and_b32 v16, 15, v1
    v_lshrrev_b32 v17, 4, v1
    v_lshrrev_b32 v18, 1, v16
    s_lshr_b32 s48, s40, 1
    s_lshl_b32 s48, s48, 14
    v_lshl_add_u32 v19, v16, 7, s48
    v_xor_b32 v20, v17, v18
    v_lshl_add_u32 v14, v20, 4, v19
    v_xor_b32 v15, 64, v14
    v_mov_b32 v8, v14
    v_mov_b32 v9, v15
    v_lshrrev_b32 v18, 2, v16
    v_and_b32 v19, 1, v17
    v_lshl_or_b32 v19, v19, 2, v18
    v_lshlrev_b32 v20, 12, v17
    v_lshl_add_u32 v20, v18, 8, v20
    v_and_b32 v21, 3, v16
    v_lshl_add_u32 v20, v21, 3, v20
    v_add_u32 v20, 98304, v20
    s_and_b32 s48, s40, 1
    s_lshl_b32 s48, s48, 2
    s_add_u32 s49, s48, 0
    v_xor_b32 v21, s49, v19
    v_lshl_add_u32 v10, v21, 5, v20
    s_add_u32 s49, s48, 1
    v_xor_b32 v21, s49, v19
    v_lshl_add_u32 v11, v21, 5, v20
    s_add_u32 s49, s48, 2
    v_xor_b32 v21, s49, v19
    v_lshl_add_u32 v12, v21, 5, v20
    s_add_u32 s49, s48, 3
    v_xor_b32 v21, s49, v19
    v_lshl_add_u32 v13, v21, 5, v20
    s_waitcnt lgkmcnt(0)
    s_mov_b32 s4, s20
    s_mov_b32 s5, s21
    s_mov_b32 s6, 2097152
    s_mov_b32 s7, 0x00020000
    s_mov_b32 s8, s24
    s_mov_b32 s9, s25
    s_mov_b32 s10, 4194304
    s_mov_b32 s11, 0x00020000
    s_mov_b32 s12, s26
    s_mov_b32 s13, s27
    s_mov_b32 s14, 4194304
    s_mov_b32 s15, 0x00020000
    s_lshl_b32 s44, s42, 18
    s_lshl_b32 s48, s40, 16
    s_add_u32 s44, s44, s48
    s_lshl_b32 s45, s41, 8
    s_add_u32 s45, s45, s48
    s_lshl_b32 s50, s40, 13
    s_lshl_b32 s51, s40, 12
    s_add_u32 s51, s51, 98304
    s_add_u32 m0, s50, 0
    s_add_u32 s48, s44, 0
    buffer_load_dwordx4 v2, s[4:7], s48 offen offset:0 lds
    buffer_load_dwordx4 v3, s[4:7], s48 offen offset:1024 lds
    buffer_load_dwordx4 v4, s[4:7], s48 offen offset:2048 lds
    buffer_load_dwordx4 v5, s[4:7], s48 offen offset:3072 lds
    s_add_u32 m0, s50, 4096
    s_add_u32 s48, s44, 32768
    buffer_load_dwordx4 v2, s[4:7], s48 offen offset:0 lds
    buffer_load_dwordx4 v3, s[4:7], s48 offen offset:1024 lds
    buffer_load_dwordx4 v4, s[4:7], s48 offen offset:2048 lds
    buffer_load_dwordx4 v5, s[4:7], s48 offen offset:3072 lds
    s_add_u32 m0, s51, 0
    s_nop 0
    buffer_load_dwordx4 v6, s[8:11], s45 offen offset:0 lds
    buffer_load_dwordx4 v7, s[8:11], s45 offen offset:1024 lds
    s_add_u32 m0, s51, 2048
    s_nop 0
    buffer_load_dwordx4 v6, s[12:15], s45 offen offset:0 lds
    buffer_load_dwordx4 v7, s[12:15], s45 offen offset:1024 lds
    s_add_u32 s45, s45, 262144
    s_add_u32 m0, s51, 16384
    s_nop 0
    buffer_load_dwordx4 v6, s[8:11], s45 offen offset:0 lds
    buffer_load_dwordx4 v7, s[8:11], s45 offen offset:1024 lds
    s_add_u32 m0, s51, 18432
    s_nop 0
    buffer_load_dwordx4 v6, s[12:15], s45 offen offset:0 lds
    buffer_load_dwordx4 v7, s[12:15], s45 offen offset:1024 lds
    s_add_u32 s45, s45, 262144
    s_add_u32 m0, s50, 32768
    s_add_u32 s48, s44, 128
    buffer_load_dwordx4 v2, s[4:7], s48 offen offset:0 lds
    buffer_load_dwordx4 v3, s[4:7], s48 offen offset:1024 lds
    buffer_load_dwordx4 v4, s[4:7], s48 offen offset:2048 lds
    buffer_load_dwordx4 v5, s[4:7], s48 offen offset:3072 lds
    s_add_u32 m0, s50, 36864
    s_add_u32 s48, s44, 32896
    buffer_load_dwordx4 v2, s[4:7], s48 offen offset:0 lds
    buffer_load_dwordx4 v3, s[4:7], s48 offen offset:1024 lds
    buffer_load_dwordx4 v4, s[4:7], s48 offen offset:2048 lds
    buffer_load_dwordx4 v5, s[4:7], s48 offen offset:3072 lds
    s_add_u32 m0, s51, 32768
    s_nop 0
    buffer_load_dwordx4 v6, s[8:11], s45 offen offset:0 lds
    buffer_load_dwordx4 v7, s[8:11], s45 offen offset:1024 lds
    s_add_u32 m0, s51, 34816
    s_nop 0
    buffer_load_dwordx4 v6, s[12:15], s45 offen offset:0 lds
    buffer_load_dwordx4 v7, s[12:15], s45 offen offset:1024 lds
    s_add_u32 s45, s45, 262144
    s_add_u32 m0, s51, 49152
    s_nop 0
    buffer_load_dwordx4 v6, s[8:11], s45 offen offset:0 lds
    buffer_load_dwordx4 v7, s[8:11], s45 offen offset:1024 lds
    s_add_u32 m0, s51, 51200
    s_nop 0
    buffer_load_dwordx4 v6, s[12:15], s45 offen offset:0 lds
    buffer_load_dwordx4 v7, s[12:15], s45 offen offset:1024 lds
    s_add_u32 s45, s45, 262144
    s_add_u32 m0, s50, 65536
    s_add_u32 s48, s44, 256
    buffer_load_dwordx4 v2, s[4:7], s48 offen offset:0 lds
    buffer_load_dwordx4 v3, s[4:7], s48 offen offset:1024 lds
    buffer_load_dwordx4 v4, s[4:7], s48 offen offset:2048 lds
    buffer_load_dwordx4 v5, s[4:7], s48 offen offset:3072 lds
    s_add_u32 s44, s44, 256
    s_mov_b32 s46, 65536
    s_mov_b32 s47, 0
    s_mov_b32 s43, 0
    s_mov_b32 s16, s22
    s_mov_b32 s17, s23
    s_mov_b32 s18, 33554432
    s_mov_b32 s19, 0x00020000
    v_accvgpr_write_b32 a0, 0
    v_accvgpr_write_b32 a1, 0
    v_accvgpr_write_b32 a2, 0
    v_accvgpr_write_b32 a3, 0
    v_accvgpr_write_b32 a4, 0
    v_accvgpr_write_b32 a5, 0
    v_accvgpr_write_b32 a6, 0
    v_accvgpr_write_b32 a7, 0
    v_accvgpr_write_b32 a8, 0
    v_accvgpr_write_b32 a9, 0
    v_accvgpr_write_b32 a10, 0
    v_accvgpr_write_b32 a11, 0
    v_accvgpr_write_b32 a12, 0
    v_accvgpr_write_b32 a13, 0
    v_accvgpr_write_b32 a14, 0
    v_accvgpr_write_b32 a15, 0
    v_accvgpr_write_b32 a16, 0
    v_accvgpr_write_b32 a17, 0
    v_accvgpr_write_b32 a18, 0
    v_accvgpr_write_b32 a19, 0
    v_accvgpr_write_b32 a20, 0
    v_accvgpr_write_b32 a21, 0
    v_accvgpr_write_b32 a22, 0
    v_accvgpr_write_b32 a23, 0
    v_accvgpr_write_b32 a24, 0
    v_accvgpr_write_b32 a25, 0
    v_accvgpr_write_b32 a26, 0
    v_accvgpr_write_b32 a27, 0
    v_accvgpr_write_b32 a28, 0
    v_accvgpr_write_b32 a29, 0
    v_accvgpr_write_b32 a30, 0
    v_accvgpr_write_b32 a31, 0
    v_accvgpr_write_b32 a32, 0
    v_accvgpr_write_b32 a33, 0
    v_accvgpr_write_b32 a34, 0
    v_accvgpr_write_b32 a35, 0
    v_accvgpr_write_b32 a36, 0
    v_accvgpr_write_b32 a37, 0
    v_accvgpr_write_b32 a38, 0
    v_accvgpr_write_b32 a39, 0
    v_accvgpr_write_b32 a40, 0
    v_accvgpr_write_b32 a41, 0
    v_accvgpr_write_b32 a42, 0
    v_accvgpr_write_b32 a43, 0
    v_accvgpr_write_b32 a44, 0
    v_accvgpr_write_b32 a45, 0
    v_accvgpr_write_b32 a46, 0
    v_accvgpr_write_b32 a47, 0
    v_accvgpr_write_b32 a48, 0
    v_accvgpr_write_b32 a49, 0
    v_accvgpr_write_b32 a50, 0
    v_accvgpr_write_b32 a51, 0
    v_accvgpr_write_b32 a52, 0
    v_accvgpr_write_b32 a53, 0
    v_accvgpr_write_b32 a54, 0
    v_accvgpr_write_b32 a55, 0
    v_accvgpr_write_b32 a56, 0
    v_accvgpr_write_b32 a57, 0
    v_accvgpr_write_b32 a58, 0
    v_accvgpr_write_b32 a59, 0
    v_accvgpr_write_b32 a60, 0
    v_accvgpr_write_b32 a61, 0
    v_accvgpr_write_b32 a62, 0
    v_accvgpr_write_b32 a63, 0
    v_accvgpr_write_b32 a64, 0
    v_accvgpr_write_b32 a65, 0
    v_accvgpr_write_b32 a66, 0
    v_accvgpr_write_b32 a67, 0
    v_accvgpr_write_b32 a68, 0
    v_accvgpr_write_b32 a69, 0
    v_accvgpr_write_b32 a70, 0
    v_accvgpr_write_b32 a71, 0
    v_accvgpr_write_b32 a72, 0
    v_accvgpr_write_b32 a73, 0
    v_accvgpr_write_b32 a74, 0
    v_accvgpr_write_b32 a75, 0
    v_accvgpr_write_b32 a76, 0
    v_accvgpr_write_b32 a77, 0
    v_accvgpr_write_b32 a78, 0
    v_accvgpr_write_b32 a79, 0
    v_accvgpr_write_b32 a80, 0
    v_accvgpr_write_b32 a81, 0
    v_accvgpr_write_b32 a82, 0
    v_accvgpr_write_b32 a83, 0
    v_accvgpr_write_b32 a84, 0
    v_accvgpr_write_b32 a85, 0
    v_accvgpr_write_b32 a86, 0
    v_accvgpr_write_b32 a87, 0
    v_accvgpr_write_b32 a88, 0
    v_accvgpr_write_b32 a89, 0
    v_accvgpr_write_b32 a90, 0
    v_accvgpr_write_b32 a91, 0
    v_accvgpr_write_b32 a92, 0
    v_accvgpr_write_b32 a93, 0
    v_accvgpr_write_b32 a94, 0
    v_accvgpr_write_b32 a95, 0
    v_accvgpr_write_b32 a96, 0
    v_accvgpr_write_b32 a97, 0
    v_accvgpr_write_b32 a98, 0
    v_accvgpr_write_b32 a99, 0
    v_accvgpr_write_b32 a100, 0
    v_accvgpr_write_b32 a101, 0
    v_accvgpr_write_b32 a102, 0
    v_accvgpr_write_b32 a103, 0
    v_accvgpr_write_b32 a104, 0
    v_accvgpr_write_b32 a105, 0
    v_accvgpr_write_b32 a106, 0
    v_accvgpr_write_b32 a107, 0
    v_accvgpr_write_b32 a108, 0
    v_accvgpr_write_b32 a109, 0
    v_accvgpr_write_b32 a110, 0
    v_accvgpr_write_b32 a111, 0
    v_accvgpr_write_b32 a112, 0
    v_accvgpr_write_b32 a113, 0
    v_accvgpr_write_b32 a114, 0
    v_accvgpr_write_b32 a115, 0
    v_accvgpr_write_b32 a116, 0
    v_accvgpr_write_b32 a117, 0
    v_accvgpr_write_b32 a118, 0
    v_accvgpr_write_b32 a119, 0
    v_accvgpr_write_b32 a120, 0
    v_accvgpr_write_b32 a121, 0
    v_accvgpr_write_b32 a122, 0
    v_accvgpr_write_b32 a123, 0
    v_accvgpr_write_b32 a124, 0
    v_accvgpr_write_b32 a125, 0
    v_accvgpr_write_b32 a126, 0
    v_accvgpr_write_b32 a127, 0
    v_accvgpr_write_b32 a128, 0
    v_accvgpr_write_b32 a129, 0
    v_accvgpr_write_b32 a130, 0
    v_accvgpr_write_b32 a131, 0
    v_accvgpr_write_b32 a132, 0
    v_accvgpr_write_b32 a133, 0
    v_accvgpr_write_b32 a134, 0
    v_accvgpr_write_b32 a135, 0
    v_accvgpr_write_b32 a136, 0
    v_accvgpr_write_b32 a137, 0
    v_accvgpr_write_b32 a138, 0
    v_accvgpr_write_b32 a139, 0
    v_accvgpr_write_b32 a140, 0
    v_accvgpr_write_b32 a141, 0
    v_accvgpr_write_b32 a142, 0
    v_accvgpr_write_b32 a143, 0
    v_accvgpr_write_b32 a144, 0
    v_accvgpr_write_b32 a145, 0
    v_accvgpr_write_b32 a146, 0
    v_accvgpr_write_b32 a147, 0
    v_accvgpr_write_b32 a148, 0
    v_accvgpr_write_b32 a149, 0
    v_accvgpr_write_b32 a150, 0
    v_accvgpr_write_b32 a151, 0
    v_accvgpr_write_b32 a152, 0
    v_accvgpr_write_b32 a153, 0
    v_accvgpr_write_b32 a154, 0
    v_accvgpr_write_b32 a155, 0
    v_accvgpr_write_b32 a156, 0
    v_accvgpr_write_b32 a157, 0
    v_accvgpr_write_b32 a158, 0
    v_accvgpr_write_b32 a159, 0
    v_accvgpr_write_b32 a160, 0
    v_accvgpr_write_b32 a161, 0
    v_accvgpr_write_b32 a162, 0
    v_accvgpr_write_b32 a163, 0
    v_accvgpr_write_b32 a164, 0
    v_accvgpr_write_b32 a165, 0
    v_accvgpr_write_b32 a166, 0
    v_accvgpr_write_b32 a167, 0
    v_accvgpr_write_b32 a168, 0
    v_accvgpr_write_b32 a169, 0
    v_accvgpr_write_b32 a170, 0
    v_accvgpr_write_b32 a171, 0
    v_accvgpr_write_b32 a172, 0
    v_accvgpr_write_b32 a173, 0
    v_accvgpr_write_b32 a174, 0
    v_accvgpr_write_b32 a175, 0
    v_accvgpr_write_b32 a176, 0
    v_accvgpr_write_b32 a177, 0
    v_accvgpr_write_b32 a178, 0
    v_accvgpr_write_b32 a179, 0
    v_accvgpr_write_b32 a180, 0
    v_accvgpr_write_b32 a181, 0
    v_accvgpr_write_b32 a182, 0
    v_accvgpr_write_b32 a183, 0
    v_accvgpr_write_b32 a184, 0
    v_accvgpr_write_b32 a185, 0
    v_accvgpr_write_b32 a186, 0
    v_accvgpr_write_b32 a187, 0
    v_accvgpr_write_b32 a188, 0
    v_accvgpr_write_b32 a189, 0
    v_accvgpr_write_b32 a190, 0
    v_accvgpr_write_b32 a191, 0
    v_accvgpr_write_b32 a192, 0
    v_accvgpr_write_b32 a193, 0
    v_accvgpr_write_b32 a194, 0
    v_accvgpr_write_b32 a195, 0
    v_accvgpr_write_b32 a196, 0
    v_accvgpr_write_b32 a197, 0
    v_accvgpr_write_b32 a198, 0
    v_accvgpr_write_b32 a199, 0
    v_accvgpr_write_b32 a200, 0
    v_accvgpr_write_b32 a201, 0
    v_accvgpr_write_b32 a202, 0
    v_accvgpr_write_b32 a203, 0
    v_accvgpr_write_b32 a204, 0
    v_accvgpr_write_b32 a205, 0
    v_accvgpr_write_b32 a206, 0
    v_accvgpr_write_b32 a207, 0
    v_accvgpr_write_b32 a208, 0
    v_accvgpr_write_b32 a209, 0
    v_accvgpr_write_b32 a210, 0
    v_accvgpr_write_b32 a211, 0
    v_accvgpr_write_b32 a212, 0
    v_accvgpr_write_b32 a213, 0
    v_accvgpr_write_b32 a214, 0
    v_accvgpr_write_b32 a215, 0
    v_accvgpr_write_b32 a216, 0
    v_accvgpr_write_b32 a217, 0
    v_accvgpr_write_b32 a218, 0
    v_accvgpr_write_b32 a219, 0
    v_accvgpr_write_b32 a220, 0
    v_accvgpr_write_b32 a221, 0
    v_accvgpr_write_b32 a222, 0
    v_accvgpr_write_b32 a223, 0
    v_accvgpr_write_b32 a224, 0
    v_accvgpr_write_b32 a225, 0
    v_accvgpr_write_b32 a226, 0
    v_accvgpr_write_b32 a227, 0
    v_accvgpr_write_b32 a228, 0
    v_accvgpr_write_b32 a229, 0
    v_accvgpr_write_b32 a230, 0
    v_accvgpr_write_b32 a231, 0
    v_accvgpr_write_b32 a232, 0
    v_accvgpr_write_b32 a233, 0
    v_accvgpr_write_b32 a234, 0
    v_accvgpr_write_b32 a235, 0
    v_accvgpr_write_b32 a236, 0
    v_accvgpr_write_b32 a237, 0
    v_accvgpr_write_b32 a238, 0
    v_accvgpr_write_b32 a239, 0
    v_accvgpr_write_b32 a240, 0
    v_accvgpr_write_b32 a241, 0
    v_accvgpr_write_b32 a242, 0
    v_accvgpr_write_b32 a243, 0
    v_accvgpr_write_b32 a244, 0
    v_accvgpr_write_b32 a245, 0
    v_accvgpr_write_b32 a246, 0
    v_accvgpr_write_b32 a247, 0
    v_accvgpr_write_b32 a248, 0
    v_accvgpr_write_b32 a249, 0
    v_accvgpr_write_b32 a250, 0
    v_accvgpr_write_b32 a251, 0
    v_accvgpr_write_b32 a252, 0
    v_accvgpr_write_b32 a253, 0
    v_accvgpr_write_b32 a254, 0
    v_accvgpr_write_b32 a255, 0
    s_waitcnt vmcnt(24)
    s_barrier
    ds_read_b64_tr_b16 v[64:65], v10 offset:0
    ds_read_b64_tr_b16 v[66:67], v10 offset:1024
    ds_read_b64_tr_b16 v[68:69], v11 offset:0
    ds_read_b64_tr_b16 v[70:71], v11 offset:1024
    ds_read_b128 v[32:35], v8 offset:0
    ds_read_b64_tr_b16 v[72:73], v12 offset:0
    ds_read_b64_tr_b16 v[74:75], v12 offset:1024
    ds_read_b128 v[36:39], v8 offset:2048
    ds_read_b64_tr_b16 v[76:77], v13 offset:0
    ds_read_b64_tr_b16 v[78:79], v13 offset:1024
    ds_read_b128 v[40:43], v8 offset:4096
    ds_read_b64_tr_b16 v[80:81], v10 offset:2048
    ds_read_b64_tr_b16 v[82:83], v10 offset:3072
    ds_read_b128 v[44:47], v8 offset:6144
    ds_read_b64_tr_b16 v[84:85], v11 offset:2048
    ds_read_b64_tr_b16 v[86:87], v11 offset:3072
    ds_read_b128 v[48:51], v8 offset:8192
    ds_read_b64_tr_b16 v[88:89], v12 offset:2048
    ds_read_b64_tr_b16 v[90:91], v12 offset:3072
    ds_read_b128 v[52:55], v8 offset:10240
    ds_read_b64_tr_b16 v[92:93], v13 offset:2048
    ds_read_b64_tr_b16 v[94:95], v13 offset:3072
    ds_read_b128 v[56:59], v8 offset:12288
    ds_read_b128 v[60:63], v8 offset:14336
    s_waitcnt vmcnt(20) lgkmcnt(0)
    s_barrier
.p2align 6
kvproj_kernel_loop:
    v_mfma_f32_16x16x32_bf16 a[0:3], v[64:67], v[32:35], a[0:3]
    ds_read_b64_tr_b16 v[128:129], v10 offset:16384
    v_mfma_f32_16x16x32_bf16 a[4:7], v[64:67], v[36:39], a[4:7]
    v_mfma_f32_16x16x32_bf16 a[8:11], v[64:67], v[40:43], a[8:11]
    ds_read_b64_tr_b16 v[130:131], v10 offset:17408
    v_mfma_f32_16x16x32_bf16 a[12:15], v[64:67], v[44:47], a[12:15]
    v_mfma_f32_16x16x32_bf16 a[16:19], v[64:67], v[48:51], a[16:19]
    ds_read_b64_tr_b16 v[132:133], v11 offset:16384
    v_mfma_f32_16x16x32_bf16 a[20:23], v[64:67], v[52:55], a[20:23]
    v_mfma_f32_16x16x32_bf16 a[24:27], v[64:67], v[56:59], a[24:27]
    ds_read_b64_tr_b16 v[134:135], v11 offset:17408
    v_mfma_f32_16x16x32_bf16 a[28:31], v[64:67], v[60:63], a[28:31]
    s_add_u32 s49, s46, s50
    v_mfma_f32_16x16x32_bf16 a[32:35], v[68:71], v[32:35], a[32:35]
    ds_read_b128 v[96:99], v9 offset:0
    v_mfma_f32_16x16x32_bf16 a[36:39], v[68:71], v[36:39], a[36:39]
    s_add_u32 s48, s44, 32768
    s_add_u32 m0, s49, 4096
    v_mfma_f32_16x16x32_bf16 a[40:43], v[68:71], v[40:43], a[40:43]
    ds_read_b64_tr_b16 v[136:137], v12 offset:16384
    v_mfma_f32_16x16x32_bf16 a[44:47], v[68:71], v[44:47], a[44:47]
    buffer_load_dwordx4 v2, s[4:7], s48 offen offset:0 lds
    v_mfma_f32_16x16x32_bf16 a[48:51], v[68:71], v[48:51], a[48:51]
    ds_read_b64_tr_b16 v[138:139], v12 offset:17408
    v_mfma_f32_16x16x32_bf16 a[52:55], v[68:71], v[52:55], a[52:55]
    v_mfma_f32_16x16x32_bf16 a[56:59], v[68:71], v[56:59], a[56:59]
    ds_read_b128 v[100:103], v9 offset:2048
    v_mfma_f32_16x16x32_bf16 a[60:63], v[68:71], v[60:63], a[60:63]
    v_mfma_f32_16x16x32_bf16 a[64:67], v[72:75], v[32:35], a[64:67]
    ds_read_b64_tr_b16 v[140:141], v13 offset:16384
    v_mfma_f32_16x16x32_bf16 a[68:71], v[72:75], v[36:39], a[68:71]
    buffer_load_dwordx4 v3, s[4:7], s48 offen offset:1024 lds
    v_mfma_f32_16x16x32_bf16 a[72:75], v[72:75], v[40:43], a[72:75]
    ds_read_b64_tr_b16 v[142:143], v13 offset:17408
    v_mfma_f32_16x16x32_bf16 a[76:79], v[72:75], v[44:47], a[76:79]
    v_mfma_f32_16x16x32_bf16 a[80:83], v[72:75], v[48:51], a[80:83]
    ds_read_b128 v[104:107], v9 offset:4096
    v_mfma_f32_16x16x32_bf16 a[84:87], v[72:75], v[52:55], a[84:87]
    v_mfma_f32_16x16x32_bf16 a[88:91], v[72:75], v[56:59], a[88:91]
    ds_read_b64_tr_b16 v[144:145], v10 offset:18432
    v_mfma_f32_16x16x32_bf16 a[92:95], v[72:75], v[60:63], a[92:95]
    buffer_load_dwordx4 v4, s[4:7], s48 offen offset:2048 lds
    v_mfma_f32_16x16x32_bf16 a[96:99], v[76:79], v[32:35], a[96:99]
    ds_read_b64_tr_b16 v[146:147], v10 offset:19456
    v_mfma_f32_16x16x32_bf16 a[100:103], v[76:79], v[36:39], a[100:103]
    v_mfma_f32_16x16x32_bf16 a[104:107], v[76:79], v[40:43], a[104:107]
    ds_read_b128 v[108:111], v9 offset:6144
    v_mfma_f32_16x16x32_bf16 a[108:111], v[76:79], v[44:47], a[108:111]
    v_mfma_f32_16x16x32_bf16 a[112:115], v[76:79], v[48:51], a[112:115]
    ds_read_b64_tr_b16 v[148:149], v11 offset:18432
    v_mfma_f32_16x16x32_bf16 a[116:119], v[76:79], v[52:55], a[116:119]
    buffer_load_dwordx4 v5, s[4:7], s48 offen offset:3072 lds
    v_mfma_f32_16x16x32_bf16 a[120:123], v[76:79], v[56:59], a[120:123]
    ds_read_b64_tr_b16 v[150:151], v11 offset:19456
    v_mfma_f32_16x16x32_bf16 a[124:127], v[76:79], v[60:63], a[124:127]
    v_mfma_f32_16x16x32_bf16 a[128:131], v[32:35], v[80:83], a[128:131]
    ds_read_b128 v[112:115], v9 offset:8192
    v_mfma_f32_16x16x32_bf16 a[132:135], v[36:39], v[80:83], a[132:135]
    s_add_u32 m0, s51, 0
    v_mfma_f32_16x16x32_bf16 a[136:139], v[40:43], v[80:83], a[136:139]
    ds_read_b64_tr_b16 v[152:153], v12 offset:18432
    v_mfma_f32_16x16x32_bf16 a[140:143], v[44:47], v[80:83], a[140:143]
    buffer_load_dwordx4 v6, s[8:11], s45 offen offset:0 lds
    v_mfma_f32_16x16x32_bf16 a[144:147], v[48:51], v[80:83], a[144:147]
    ds_read_b64_tr_b16 v[154:155], v12 offset:19456
    v_mfma_f32_16x16x32_bf16 a[148:151], v[52:55], v[80:83], a[148:151]
    v_mfma_f32_16x16x32_bf16 a[152:155], v[56:59], v[80:83], a[152:155]
    ds_read_b128 v[116:119], v9 offset:10240
    v_mfma_f32_16x16x32_bf16 a[156:159], v[60:63], v[80:83], a[156:159]
    v_mfma_f32_16x16x32_bf16 a[160:163], v[32:35], v[84:87], a[160:163]
    ds_read_b64_tr_b16 v[156:157], v13 offset:18432
    v_mfma_f32_16x16x32_bf16 a[164:167], v[36:39], v[84:87], a[164:167]
    buffer_load_dwordx4 v7, s[8:11], s45 offen offset:1024 lds
    v_mfma_f32_16x16x32_bf16 a[168:171], v[40:43], v[84:87], a[168:171]
    ds_read_b64_tr_b16 v[158:159], v13 offset:19456
    v_mfma_f32_16x16x32_bf16 a[172:175], v[44:47], v[84:87], a[172:175]
    v_mfma_f32_16x16x32_bf16 a[176:179], v[48:51], v[84:87], a[176:179]
    ds_read_b128 v[120:123], v9 offset:12288
    v_mfma_f32_16x16x32_bf16 a[180:183], v[52:55], v[84:87], a[180:183]
    s_add_u32 m0, s51, 2048
    v_mfma_f32_16x16x32_bf16 a[184:187], v[56:59], v[84:87], a[184:187]
    ds_read_b128 v[124:127], v9 offset:14336
    v_mfma_f32_16x16x32_bf16 a[188:191], v[60:63], v[84:87], a[188:191]
    buffer_load_dwordx4 v6, s[12:15], s45 offen offset:0 lds
    v_mfma_f32_16x16x32_bf16 a[192:195], v[32:35], v[88:91], a[192:195]
    v_mfma_f32_16x16x32_bf16 a[196:199], v[36:39], v[88:91], a[196:199]
    v_mfma_f32_16x16x32_bf16 a[200:203], v[40:43], v[88:91], a[200:203]
    v_mfma_f32_16x16x32_bf16 a[204:207], v[44:47], v[88:91], a[204:207]
    v_mfma_f32_16x16x32_bf16 a[208:211], v[48:51], v[88:91], a[208:211]
    v_mfma_f32_16x16x32_bf16 a[212:215], v[52:55], v[88:91], a[212:215]
    buffer_load_dwordx4 v7, s[12:15], s45 offen offset:1024 lds
    v_mfma_f32_16x16x32_bf16 a[216:219], v[56:59], v[88:91], a[216:219]
    v_mfma_f32_16x16x32_bf16 a[220:223], v[60:63], v[88:91], a[220:223]
    s_add_u32 s45, s45, 262144
    v_mfma_f32_16x16x32_bf16 a[224:227], v[32:35], v[92:95], a[224:227]
    v_mfma_f32_16x16x32_bf16 a[228:231], v[36:39], v[92:95], a[228:231]
    v_mfma_f32_16x16x32_bf16 a[232:235], v[40:43], v[92:95], a[232:235]
    v_mfma_f32_16x16x32_bf16 a[236:239], v[44:47], v[92:95], a[236:239]
    v_mfma_f32_16x16x32_bf16 a[240:243], v[48:51], v[92:95], a[240:243]
    v_mfma_f32_16x16x32_bf16 a[244:247], v[52:55], v[92:95], a[244:247]
    v_mfma_f32_16x16x32_bf16 a[248:251], v[56:59], v[92:95], a[248:251]
    v_mfma_f32_16x16x32_bf16 a[252:255], v[60:63], v[92:95], a[252:255]
    s_waitcnt vmcnt(16) lgkmcnt(0)
    s_barrier
    v_mfma_f32_16x16x32_bf16 a[0:3], v[128:131], v[96:99], a[0:3]
    ds_read_b64_tr_b16 v[64:65], v10 offset:32768
    v_mfma_f32_16x16x32_bf16 a[4:7], v[128:131], v[100:103], a[4:7]
    s_mov_b32 s46, s47
    s_add_u32 s47, s47, 32768
    v_mfma_f32_16x16x32_bf16 a[8:11], v[128:131], v[104:107], a[8:11]
    ds_read_b64_tr_b16 v[66:67], v10 offset:33792
    v_mfma_f32_16x16x32_bf16 a[12:15], v[128:131], v[108:111], a[12:15]
    s_cmp_eq_u32 s47, 98304
    s_cselect_b32 s47, 0, s47
    v_mfma_f32_16x16x32_bf16 a[16:19], v[128:131], v[112:115], a[16:19]
    ds_read_b64_tr_b16 v[68:69], v11 offset:32768
    v_mfma_f32_16x16x32_bf16 a[20:23], v[128:131], v[116:119], a[20:23]
    v_add_u32 v8, s47, v14
    v_add_u32 v9, s47, v15
    v_mfma_f32_16x16x32_bf16 a[24:27], v[128:131], v[120:123], a[24:27]
    ds_read_b64_tr_b16 v[70:71], v11 offset:33792
    v_mfma_f32_16x16x32_bf16 a[28:31], v[128:131], v[124:127], a[28:31]
    s_add_u32 s44, s44, 128
    s_add_u32 s49, s46, s50
    v_mfma_f32_16x16x32_bf16 a[32:35], v[132:135], v[96:99], a[32:35]
    ds_read_b128 v[32:35], v8 offset:0
    v_mfma_f32_16x16x32_bf16 a[36:39], v[132:135], v[100:103], a[36:39]
    s_mov_b32 s48, s44
    s_mov_b32 m0, s49
    v_mfma_f32_16x16x32_bf16 a[40:43], v[132:135], v[104:107], a[40:43]
    ds_read_b64_tr_b16 v[72:73], v12 offset:32768
    v_mfma_f32_16x16x32_bf16 a[44:47], v[132:135], v[108:111], a[44:47]
    buffer_load_dwordx4 v2, s[4:7], s48 offen offset:0 lds
    v_mfma_f32_16x16x32_bf16 a[48:51], v[132:135], v[112:115], a[48:51]
    ds_read_b64_tr_b16 v[74:75], v12 offset:33792
    v_mfma_f32_16x16x32_bf16 a[52:55], v[132:135], v[116:119], a[52:55]
    v_mfma_f32_16x16x32_bf16 a[56:59], v[132:135], v[120:123], a[56:59]
    ds_read_b128 v[36:39], v8 offset:2048
    v_mfma_f32_16x16x32_bf16 a[60:63], v[132:135], v[124:127], a[60:63]
    v_mfma_f32_16x16x32_bf16 a[64:67], v[136:139], v[96:99], a[64:67]
    ds_read_b64_tr_b16 v[76:77], v13 offset:32768
    v_mfma_f32_16x16x32_bf16 a[68:71], v[136:139], v[100:103], a[68:71]
    buffer_load_dwordx4 v3, s[4:7], s48 offen offset:1024 lds
    v_mfma_f32_16x16x32_bf16 a[72:75], v[136:139], v[104:107], a[72:75]
    ds_read_b64_tr_b16 v[78:79], v13 offset:33792
    v_mfma_f32_16x16x32_bf16 a[76:79], v[136:139], v[108:111], a[76:79]
    v_mfma_f32_16x16x32_bf16 a[80:83], v[136:139], v[112:115], a[80:83]
    ds_read_b128 v[40:43], v8 offset:4096
    v_mfma_f32_16x16x32_bf16 a[84:87], v[136:139], v[116:119], a[84:87]
    v_mfma_f32_16x16x32_bf16 a[88:91], v[136:139], v[120:123], a[88:91]
    ds_read_b64_tr_b16 v[80:81], v10 offset:34816
    v_mfma_f32_16x16x32_bf16 a[92:95], v[136:139], v[124:127], a[92:95]
    buffer_load_dwordx4 v4, s[4:7], s48 offen offset:2048 lds
    v_mfma_f32_16x16x32_bf16 a[96:99], v[140:143], v[96:99], a[96:99]
    ds_read_b64_tr_b16 v[82:83], v10 offset:35840
    v_mfma_f32_16x16x32_bf16 a[100:103], v[140:143], v[100:103], a[100:103]
    v_mfma_f32_16x16x32_bf16 a[104:107], v[140:143], v[104:107], a[104:107]
    ds_read_b128 v[44:47], v8 offset:6144
    v_mfma_f32_16x16x32_bf16 a[108:111], v[140:143], v[108:111], a[108:111]
    v_mfma_f32_16x16x32_bf16 a[112:115], v[140:143], v[112:115], a[112:115]
    ds_read_b64_tr_b16 v[84:85], v11 offset:34816
    v_mfma_f32_16x16x32_bf16 a[116:119], v[140:143], v[116:119], a[116:119]
    buffer_load_dwordx4 v5, s[4:7], s48 offen offset:3072 lds
    v_mfma_f32_16x16x32_bf16 a[120:123], v[140:143], v[120:123], a[120:123]
    ds_read_b64_tr_b16 v[86:87], v11 offset:35840
    v_mfma_f32_16x16x32_bf16 a[124:127], v[140:143], v[124:127], a[124:127]
    v_mfma_f32_16x16x32_bf16 a[128:131], v[96:99], v[144:147], a[128:131]
    ds_read_b128 v[48:51], v8 offset:8192
    v_mfma_f32_16x16x32_bf16 a[132:135], v[100:103], v[144:147], a[132:135]
    s_add_u32 m0, s51, 16384
    v_mfma_f32_16x16x32_bf16 a[136:139], v[104:107], v[144:147], a[136:139]
    ds_read_b64_tr_b16 v[88:89], v12 offset:34816
    v_mfma_f32_16x16x32_bf16 a[140:143], v[108:111], v[144:147], a[140:143]
    buffer_load_dwordx4 v6, s[8:11], s45 offen offset:0 lds
    v_mfma_f32_16x16x32_bf16 a[144:147], v[112:115], v[144:147], a[144:147]
    ds_read_b64_tr_b16 v[90:91], v12 offset:35840
    v_mfma_f32_16x16x32_bf16 a[148:151], v[116:119], v[144:147], a[148:151]
    v_mfma_f32_16x16x32_bf16 a[152:155], v[120:123], v[144:147], a[152:155]
    ds_read_b128 v[52:55], v8 offset:10240
    v_mfma_f32_16x16x32_bf16 a[156:159], v[124:127], v[144:147], a[156:159]
    v_mfma_f32_16x16x32_bf16 a[160:163], v[96:99], v[148:151], a[160:163]
    ds_read_b64_tr_b16 v[92:93], v13 offset:34816
    v_mfma_f32_16x16x32_bf16 a[164:167], v[100:103], v[148:151], a[164:167]
    buffer_load_dwordx4 v7, s[8:11], s45 offen offset:1024 lds
    v_mfma_f32_16x16x32_bf16 a[168:171], v[104:107], v[148:151], a[168:171]
    ds_read_b64_tr_b16 v[94:95], v13 offset:35840
    v_mfma_f32_16x16x32_bf16 a[172:175], v[108:111], v[148:151], a[172:175]
    v_mfma_f32_16x16x32_bf16 a[176:179], v[112:115], v[148:151], a[176:179]
    ds_read_b128 v[56:59], v8 offset:12288
    v_mfma_f32_16x16x32_bf16 a[180:183], v[116:119], v[148:151], a[180:183]
    s_add_u32 m0, s51, 18432
    v_mfma_f32_16x16x32_bf16 a[184:187], v[120:123], v[148:151], a[184:187]
    ds_read_b128 v[60:63], v8 offset:14336
    v_mfma_f32_16x16x32_bf16 a[188:191], v[124:127], v[148:151], a[188:191]
    buffer_load_dwordx4 v6, s[12:15], s45 offen offset:0 lds
    v_mfma_f32_16x16x32_bf16 a[192:195], v[96:99], v[152:155], a[192:195]
    v_mfma_f32_16x16x32_bf16 a[196:199], v[100:103], v[152:155], a[196:199]
    v_mfma_f32_16x16x32_bf16 a[200:203], v[104:107], v[152:155], a[200:203]
    v_mfma_f32_16x16x32_bf16 a[204:207], v[108:111], v[152:155], a[204:207]
    v_mfma_f32_16x16x32_bf16 a[208:211], v[112:115], v[152:155], a[208:211]
    v_mfma_f32_16x16x32_bf16 a[212:215], v[116:119], v[152:155], a[212:215]
    buffer_load_dwordx4 v7, s[12:15], s45 offen offset:1024 lds
    v_mfma_f32_16x16x32_bf16 a[216:219], v[120:123], v[152:155], a[216:219]
    v_mfma_f32_16x16x32_bf16 a[220:223], v[124:127], v[152:155], a[220:223]
    s_add_u32 s45, s45, 262144
    v_mfma_f32_16x16x32_bf16 a[224:227], v[96:99], v[156:159], a[224:227]
    v_mfma_f32_16x16x32_bf16 a[228:231], v[100:103], v[156:159], a[228:231]
    v_mfma_f32_16x16x32_bf16 a[232:235], v[104:107], v[156:159], a[232:235]
    v_mfma_f32_16x16x32_bf16 a[236:239], v[108:111], v[156:159], a[236:239]
    v_mfma_f32_16x16x32_bf16 a[240:243], v[112:115], v[156:159], a[240:243]
    v_mfma_f32_16x16x32_bf16 a[244:247], v[116:119], v[156:159], a[244:247]
    v_mfma_f32_16x16x32_bf16 a[248:251], v[120:123], v[156:159], a[248:251]
    v_mfma_f32_16x16x32_bf16 a[252:255], v[124:127], v[156:159], a[252:255]
    s_waitcnt vmcnt(16) lgkmcnt(0)
    s_barrier
    v_mfma_f32_16x16x32_bf16 a[0:3], v[64:67], v[32:35], a[0:3]
    ds_read_b64_tr_b16 v[128:129], v10 offset:49152
    v_mfma_f32_16x16x32_bf16 a[4:7], v[64:67], v[36:39], a[4:7]
    v_mfma_f32_16x16x32_bf16 a[8:11], v[64:67], v[40:43], a[8:11]
    ds_read_b64_tr_b16 v[130:131], v10 offset:50176
    v_mfma_f32_16x16x32_bf16 a[12:15], v[64:67], v[44:47], a[12:15]
    v_mfma_f32_16x16x32_bf16 a[16:19], v[64:67], v[48:51], a[16:19]
    ds_read_b64_tr_b16 v[132:133], v11 offset:49152
    v_mfma_f32_16x16x32_bf16 a[20:23], v[64:67], v[52:55], a[20:23]
    v_mfma_f32_16x16x32_bf16 a[24:27], v[64:67], v[56:59], a[24:27]
    ds_read_b64_tr_b16 v[134:135], v11 offset:50176
    v_mfma_f32_16x16x32_bf16 a[28:31], v[64:67], v[60:63], a[28:31]
    s_add_u32 s49, s46, s50
    v_mfma_f32_16x16x32_bf16 a[32:35], v[68:71], v[32:35], a[32:35]
    ds_read_b128 v[96:99], v9 offset:0
    v_mfma_f32_16x16x32_bf16 a[36:39], v[68:71], v[36:39], a[36:39]
    s_add_u32 s48, s44, 32768
    s_add_u32 m0, s49, 4096
    v_mfma_f32_16x16x32_bf16 a[40:43], v[68:71], v[40:43], a[40:43]
    ds_read_b64_tr_b16 v[136:137], v12 offset:49152
    v_mfma_f32_16x16x32_bf16 a[44:47], v[68:71], v[44:47], a[44:47]
    buffer_load_dwordx4 v2, s[4:7], s48 offen offset:0 lds
    v_mfma_f32_16x16x32_bf16 a[48:51], v[68:71], v[48:51], a[48:51]
    ds_read_b64_tr_b16 v[138:139], v12 offset:50176
    v_mfma_f32_16x16x32_bf16 a[52:55], v[68:71], v[52:55], a[52:55]
    v_mfma_f32_16x16x32_bf16 a[56:59], v[68:71], v[56:59], a[56:59]
    ds_read_b128 v[100:103], v9 offset:2048
    v_mfma_f32_16x16x32_bf16 a[60:63], v[68:71], v[60:63], a[60:63]
    v_mfma_f32_16x16x32_bf16 a[64:67], v[72:75], v[32:35], a[64:67]
    ds_read_b64_tr_b16 v[140:141], v13 offset:49152
    v_mfma_f32_16x16x32_bf16 a[68:71], v[72:75], v[36:39], a[68:71]
    buffer_load_dwordx4 v3, s[4:7], s48 offen offset:1024 lds
    v_mfma_f32_16x16x32_bf16 a[72:75], v[72:75], v[40:43], a[72:75]
    ds_read_b64_tr_b16 v[142:143], v13 offset:50176
    v_mfma_f32_16x16x32_bf16 a[76:79], v[72:75], v[44:47], a[76:79]
    v_mfma_f32_16x16x32_bf16 a[80:83], v[72:75], v[48:51], a[80:83]
    ds_read_b128 v[104:107], v9 offset:4096
    v_mfma_f32_16x16x32_bf16 a[84:87], v[72:75], v[52:55], a[84:87]
    v_mfma_f32_16x16x32_bf16 a[88:91], v[72:75], v[56:59], a[88:91]
    ds_read_b64_tr_b16 v[144:145], v10 offset:51200
    v_mfma_f32_16x16x32_bf16 a[92:95], v[72:75], v[60:63], a[92:95]
    buffer_load_dwordx4 v4, s[4:7], s48 offen offset:2048 lds
    v_mfma_f32_16x16x32_bf16 a[96:99], v[76:79], v[32:35], a[96:99]
    ds_read_b64_tr_b16 v[146:147], v10 offset:52224
    v_mfma_f32_16x16x32_bf16 a[100:103], v[76:79], v[36:39], a[100:103]
    v_mfma_f32_16x16x32_bf16 a[104:107], v[76:79], v[40:43], a[104:107]
    ds_read_b128 v[108:111], v9 offset:6144
    v_mfma_f32_16x16x32_bf16 a[108:111], v[76:79], v[44:47], a[108:111]
    v_mfma_f32_16x16x32_bf16 a[112:115], v[76:79], v[48:51], a[112:115]
    ds_read_b64_tr_b16 v[148:149], v11 offset:51200
    v_mfma_f32_16x16x32_bf16 a[116:119], v[76:79], v[52:55], a[116:119]
    buffer_load_dwordx4 v5, s[4:7], s48 offen offset:3072 lds
    v_mfma_f32_16x16x32_bf16 a[120:123], v[76:79], v[56:59], a[120:123]
    ds_read_b64_tr_b16 v[150:151], v11 offset:52224
    v_mfma_f32_16x16x32_bf16 a[124:127], v[76:79], v[60:63], a[124:127]
    v_mfma_f32_16x16x32_bf16 a[128:131], v[32:35], v[80:83], a[128:131]
    ds_read_b128 v[112:115], v9 offset:8192
    v_mfma_f32_16x16x32_bf16 a[132:135], v[36:39], v[80:83], a[132:135]
    s_add_u32 m0, s51, 32768
    v_mfma_f32_16x16x32_bf16 a[136:139], v[40:43], v[80:83], a[136:139]
    ds_read_b64_tr_b16 v[152:153], v12 offset:51200
    v_mfma_f32_16x16x32_bf16 a[140:143], v[44:47], v[80:83], a[140:143]
    buffer_load_dwordx4 v6, s[8:11], s45 offen offset:0 lds
    v_mfma_f32_16x16x32_bf16 a[144:147], v[48:51], v[80:83], a[144:147]
    ds_read_b64_tr_b16 v[154:155], v12 offset:52224
    v_mfma_f32_16x16x32_bf16 a[148:151], v[52:55], v[80:83], a[148:151]
    v_mfma_f32_16x16x32_bf16 a[152:155], v[56:59], v[80:83], a[152:155]
    ds_read_b128 v[116:119], v9 offset:10240
    v_mfma_f32_16x16x32_bf16 a[156:159], v[60:63], v[80:83], a[156:159]
    v_mfma_f32_16x16x32_bf16 a[160:163], v[32:35], v[84:87], a[160:163]
    ds_read_b64_tr_b16 v[156:157], v13 offset:51200
    v_mfma_f32_16x16x32_bf16 a[164:167], v[36:39], v[84:87], a[164:167]
    buffer_load_dwordx4 v7, s[8:11], s45 offen offset:1024 lds
    v_mfma_f32_16x16x32_bf16 a[168:171], v[40:43], v[84:87], a[168:171]
    ds_read_b64_tr_b16 v[158:159], v13 offset:52224
    v_mfma_f32_16x16x32_bf16 a[172:175], v[44:47], v[84:87], a[172:175]
    v_mfma_f32_16x16x32_bf16 a[176:179], v[48:51], v[84:87], a[176:179]
    ds_read_b128 v[120:123], v9 offset:12288
    v_mfma_f32_16x16x32_bf16 a[180:183], v[52:55], v[84:87], a[180:183]
    s_add_u32 m0, s51, 34816
    v_mfma_f32_16x16x32_bf16 a[184:187], v[56:59], v[84:87], a[184:187]
    ds_read_b128 v[124:127], v9 offset:14336
    v_mfma_f32_16x16x32_bf16 a[188:191], v[60:63], v[84:87], a[188:191]
    buffer_load_dwordx4 v6, s[12:15], s45 offen offset:0 lds
    v_mfma_f32_16x16x32_bf16 a[192:195], v[32:35], v[88:91], a[192:195]
    v_mfma_f32_16x16x32_bf16 a[196:199], v[36:39], v[88:91], a[196:199]
    v_mfma_f32_16x16x32_bf16 a[200:203], v[40:43], v[88:91], a[200:203]
    v_mfma_f32_16x16x32_bf16 a[204:207], v[44:47], v[88:91], a[204:207]
    v_mfma_f32_16x16x32_bf16 a[208:211], v[48:51], v[88:91], a[208:211]
    v_mfma_f32_16x16x32_bf16 a[212:215], v[52:55], v[88:91], a[212:215]
    buffer_load_dwordx4 v7, s[12:15], s45 offen offset:1024 lds
    v_mfma_f32_16x16x32_bf16 a[216:219], v[56:59], v[88:91], a[216:219]
    v_mfma_f32_16x16x32_bf16 a[220:223], v[60:63], v[88:91], a[220:223]
    s_add_u32 s45, s45, 262144
    v_mfma_f32_16x16x32_bf16 a[224:227], v[32:35], v[92:95], a[224:227]
    v_mfma_f32_16x16x32_bf16 a[228:231], v[36:39], v[92:95], a[228:231]
    v_mfma_f32_16x16x32_bf16 a[232:235], v[40:43], v[92:95], a[232:235]
    v_mfma_f32_16x16x32_bf16 a[236:239], v[44:47], v[92:95], a[236:239]
    v_mfma_f32_16x16x32_bf16 a[240:243], v[48:51], v[92:95], a[240:243]
    v_mfma_f32_16x16x32_bf16 a[244:247], v[52:55], v[92:95], a[244:247]
    v_mfma_f32_16x16x32_bf16 a[248:251], v[56:59], v[92:95], a[248:251]
    v_mfma_f32_16x16x32_bf16 a[252:255], v[60:63], v[92:95], a[252:255]
    s_waitcnt vmcnt(16) lgkmcnt(0)
    s_barrier
    v_mfma_f32_16x16x32_bf16 a[0:3], v[128:131], v[96:99], a[0:3]
    ds_read_b64_tr_b16 v[64:65], v10 offset:0
    v_mfma_f32_16x16x32_bf16 a[4:7], v[128:131], v[100:103], a[4:7]
    s_mov_b32 s46, s47
    s_add_u32 s47, s47, 32768
    v_mfma_f32_16x16x32_bf16 a[8:11], v[128:131], v[104:107], a[8:11]
    ds_read_b64_tr_b16 v[66:67], v10 offset:1024
    v_mfma_f32_16x16x32_bf16 a[12:15], v[128:131], v[108:111], a[12:15]
    s_cmp_eq_u32 s47, 98304
    s_cselect_b32 s47, 0, s47
    v_mfma_f32_16x16x32_bf16 a[16:19], v[128:131], v[112:115], a[16:19]
    ds_read_b64_tr_b16 v[68:69], v11 offset:0
    v_mfma_f32_16x16x32_bf16 a[20:23], v[128:131], v[116:119], a[20:23]
    v_add_u32 v8, s47, v14
    v_add_u32 v9, s47, v15
    v_mfma_f32_16x16x32_bf16 a[24:27], v[128:131], v[120:123], a[24:27]
    ds_read_b64_tr_b16 v[70:71], v11 offset:1024
    v_mfma_f32_16x16x32_bf16 a[28:31], v[128:131], v[124:127], a[28:31]
    s_add_u32 s44, s44, 128
    s_add_u32 s49, s46, s50
    v_mfma_f32_16x16x32_bf16 a[32:35], v[132:135], v[96:99], a[32:35]
    ds_read_b128 v[32:35], v8 offset:0
    v_mfma_f32_16x16x32_bf16 a[36:39], v[132:135], v[100:103], a[36:39]
    s_mov_b32 s48, s44
    s_mov_b32 m0, s49
    v_mfma_f32_16x16x32_bf16 a[40:43], v[132:135], v[104:107], a[40:43]
    ds_read_b64_tr_b16 v[72:73], v12 offset:0
    v_mfma_f32_16x16x32_bf16 a[44:47], v[132:135], v[108:111], a[44:47]
    buffer_load_dwordx4 v2, s[4:7], s48 offen offset:0 lds
    v_mfma_f32_16x16x32_bf16 a[48:51], v[132:135], v[112:115], a[48:51]
    ds_read_b64_tr_b16 v[74:75], v12 offset:1024
    v_mfma_f32_16x16x32_bf16 a[52:55], v[132:135], v[116:119], a[52:55]
    v_mfma_f32_16x16x32_bf16 a[56:59], v[132:135], v[120:123], a[56:59]
    ds_read_b128 v[36:39], v8 offset:2048
    v_mfma_f32_16x16x32_bf16 a[60:63], v[132:135], v[124:127], a[60:63]
    v_mfma_f32_16x16x32_bf16 a[64:67], v[136:139], v[96:99], a[64:67]
    ds_read_b64_tr_b16 v[76:77], v13 offset:0
    v_mfma_f32_16x16x32_bf16 a[68:71], v[136:139], v[100:103], a[68:71]
    buffer_load_dwordx4 v3, s[4:7], s48 offen offset:1024 lds
    v_mfma_f32_16x16x32_bf16 a[72:75], v[136:139], v[104:107], a[72:75]
    ds_read_b64_tr_b16 v[78:79], v13 offset:1024
    v_mfma_f32_16x16x32_bf16 a[76:79], v[136:139], v[108:111], a[76:79]
    v_mfma_f32_16x16x32_bf16 a[80:83], v[136:139], v[112:115], a[80:83]
    ds_read_b128 v[40:43], v8 offset:4096
    v_mfma_f32_16x16x32_bf16 a[84:87], v[136:139], v[116:119], a[84:87]
    v_mfma_f32_16x16x32_bf16 a[88:91], v[136:139], v[120:123], a[88:91]
    ds_read_b64_tr_b16 v[80:81], v10 offset:2048
    v_mfma_f32_16x16x32_bf16 a[92:95], v[136:139], v[124:127], a[92:95]
    buffer_load_dwordx4 v4, s[4:7], s48 offen offset:2048 lds
    v_mfma_f32_16x16x32_bf16 a[96:99], v[140:143], v[96:99], a[96:99]
    ds_read_b64_tr_b16 v[82:83], v10 offset:3072
    v_mfma_f32_16x16x32_bf16 a[100:103], v[140:143], v[100:103], a[100:103]
    v_mfma_f32_16x16x32_bf16 a[104:107], v[140:143], v[104:107], a[104:107]
    ds_read_b128 v[44:47], v8 offset:6144
    v_mfma_f32_16x16x32_bf16 a[108:111], v[140:143], v[108:111], a[108:111]
    v_mfma_f32_16x16x32_bf16 a[112:115], v[140:143], v[112:115], a[112:115]
    ds_read_b64_tr_b16 v[84:85], v11 offset:2048
    v_mfma_f32_16x16x32_bf16 a[116:119], v[140:143], v[116:119], a[116:119]
    buffer_load_dwordx4 v5, s[4:7], s48 offen offset:3072 lds
    v_mfma_f32_16x16x32_bf16 a[120:123], v[140:143], v[120:123], a[120:123]
    ds_read_b64_tr_b16 v[86:87], v11 offset:3072
    v_mfma_f32_16x16x32_bf16 a[124:127], v[140:143], v[124:127], a[124:127]
    v_mfma_f32_16x16x32_bf16 a[128:131], v[96:99], v[144:147], a[128:131]
    ds_read_b128 v[48:51], v8 offset:8192
    v_mfma_f32_16x16x32_bf16 a[132:135], v[100:103], v[144:147], a[132:135]
    s_add_u32 m0, s51, 49152
    v_mfma_f32_16x16x32_bf16 a[136:139], v[104:107], v[144:147], a[136:139]
    ds_read_b64_tr_b16 v[88:89], v12 offset:2048
    v_mfma_f32_16x16x32_bf16 a[140:143], v[108:111], v[144:147], a[140:143]
    buffer_load_dwordx4 v6, s[8:11], s45 offen offset:0 lds
    v_mfma_f32_16x16x32_bf16 a[144:147], v[112:115], v[144:147], a[144:147]
    ds_read_b64_tr_b16 v[90:91], v12 offset:3072
    v_mfma_f32_16x16x32_bf16 a[148:151], v[116:119], v[144:147], a[148:151]
    v_mfma_f32_16x16x32_bf16 a[152:155], v[120:123], v[144:147], a[152:155]
    ds_read_b128 v[52:55], v8 offset:10240
    v_mfma_f32_16x16x32_bf16 a[156:159], v[124:127], v[144:147], a[156:159]
    v_mfma_f32_16x16x32_bf16 a[160:163], v[96:99], v[148:151], a[160:163]
    ds_read_b64_tr_b16 v[92:93], v13 offset:2048
    v_mfma_f32_16x16x32_bf16 a[164:167], v[100:103], v[148:151], a[164:167]
    buffer_load_dwordx4 v7, s[8:11], s45 offen offset:1024 lds
    v_mfma_f32_16x16x32_bf16 a[168:171], v[104:107], v[148:151], a[168:171]
    ds_read_b64_tr_b16 v[94:95], v13 offset:3072
    v_mfma_f32_16x16x32_bf16 a[172:175], v[108:111], v[148:151], a[172:175]
    v_mfma_f32_16x16x32_bf16 a[176:179], v[112:115], v[148:151], a[176:179]
    ds_read_b128 v[56:59], v8 offset:12288
    v_mfma_f32_16x16x32_bf16 a[180:183], v[116:119], v[148:151], a[180:183]
    s_add_u32 m0, s51, 51200
    v_mfma_f32_16x16x32_bf16 a[184:187], v[120:123], v[148:151], a[184:187]
    ds_read_b128 v[60:63], v8 offset:14336
    v_mfma_f32_16x16x32_bf16 a[188:191], v[124:127], v[148:151], a[188:191]
    buffer_load_dwordx4 v6, s[12:15], s45 offen offset:0 lds
    v_mfma_f32_16x16x32_bf16 a[192:195], v[96:99], v[152:155], a[192:195]
    v_mfma_f32_16x16x32_bf16 a[196:199], v[100:103], v[152:155], a[196:199]
    v_mfma_f32_16x16x32_bf16 a[200:203], v[104:107], v[152:155], a[200:203]
    v_mfma_f32_16x16x32_bf16 a[204:207], v[108:111], v[152:155], a[204:207]
    v_mfma_f32_16x16x32_bf16 a[208:211], v[112:115], v[152:155], a[208:211]
    v_mfma_f32_16x16x32_bf16 a[212:215], v[116:119], v[152:155], a[212:215]
    buffer_load_dwordx4 v7, s[12:15], s45 offen offset:1024 lds
    v_mfma_f32_16x16x32_bf16 a[216:219], v[120:123], v[152:155], a[216:219]
    v_mfma_f32_16x16x32_bf16 a[220:223], v[124:127], v[152:155], a[220:223]
    s_add_u32 s45, s45, 262144
    v_mfma_f32_16x16x32_bf16 a[224:227], v[96:99], v[156:159], a[224:227]
    v_mfma_f32_16x16x32_bf16 a[228:231], v[100:103], v[156:159], a[228:231]
    s_add_u32 s43, s43, 1
    s_cmp_eq_u32 s43, 3
    v_mfma_f32_16x16x32_bf16 a[232:235], v[104:107], v[156:159], a[232:235]
    s_cselect_b32 s6, 0, s6
    s_cselect_b32 s10, 0, s10
    v_mfma_f32_16x16x32_bf16 a[236:239], v[108:111], v[156:159], a[236:239]
    s_cselect_b32 s14, 0, s14
    s_cmp_lg_u32 s43, 4
    v_mfma_f32_16x16x32_bf16 a[240:243], v[112:115], v[156:159], a[240:243]
    v_mfma_f32_16x16x32_bf16 a[244:247], v[116:119], v[156:159], a[244:247]
    v_mfma_f32_16x16x32_bf16 a[248:251], v[120:123], v[156:159], a[248:251]
    v_mfma_f32_16x16x32_bf16 a[252:255], v[124:127], v[156:159], a[252:255]
    s_waitcnt vmcnt(16) lgkmcnt(0)
    s_barrier
    s_cbranch_scc1 kvproj_kernel_loop
    s_load_dwordx4 s[24:27], s[0:1], 8
    s_load_dwordx2 s[28:29], s[0:1], 24
    s_load_dwordx2 s[30:31], s[0:1], 0
    s_load_dwordx2 s[32:33], s[0:1], 96
    s_lshr_b32 s48, s2, 4
    s_and_b32 s49, s2, 15
    v_lshrrev_b32 v16, 4, v0
    v_lshlrev_b32 v16, 3, v16
    s_lshl_b32 s52, s48, 7
    v_add_u32 v16, s52, v16
    v_and_b32 v17, 15, v0
    v_lshlrev_b32 v17, 2, v17
    s_lshl_b32 s53, s49, 6
    v_add_u32 v17, s53, v17
    v_lshlrev_b32 v2, 11, v16
    v_lshl_add_u32 v2, v17, 1, v2
    v_subrev_u32 v3, 6144, v2
    v_lshlrev_b32 v4, 3, v17
    v_mul_u32_u24 v6, 4608, v17
    v_sub_u32 v18, 2040, v16
    v_lshl_add_u32 v6, v18, 1, v6
    v_bfe_u32 v18, v0, 1, 6
    v_add_u32 v18, s53, v18
    v_mul_u32_u24 v7, 4608, v18
    v_and_b32 v18, 1, v0
    v_lshl_add_u32 v7, v18, 4, v7
    s_lshl_b32 s54, s48, 5
    s_add_u32 s54, s54, 4096
    v_add_u32 v7, s54, v7
    v_lshlrev_b32 v5, 5, v1
    s_lshl_b32 s55, s2, 2
    s_add_u32 s55, s55, s40
    s_lshl_b32 s56, s55, 12
    s_movk_i32 s57, 4096
    s_movk_i32 s58, 8192
    s_movk_i32 s59, 12288
    s_waitcnt lgkmcnt(0)
    s_mov_b32 s4, s24
    s_mov_b32 s5, s25
    s_mov_b32 s6, 4194304
    s_mov_b32 s7, 0x00020000
    s_mov_b32 s8, s26
    s_mov_b32 s9, s27
    s_mov_b32 s10, 4194304
    s_mov_b32 s11, 0x00020000
    s_mov_b32 s12, s28
    s_mov_b32 s13, s29
    s_mov_b32 s14, 8192
    s_mov_b32 s15, 0x00020000
    s_mov_b32 s60, s30
    s_mov_b32 s61, s31
    s_mov_b32 s62, 4194304
    s_mov_b32 s63, 0x00020000
    s_mov_b32 s64, s32
    s_mov_b32 s65, s33
    s_mov_b32 s66, 2048
    s_mov_b32 s67, 0x00020000
    buffer_load_dwordx2 v[32:33], v3, s[4:7], 0 offen offset:0
    buffer_load_dwordx2 v[34:35], v3, s[4:7], 0 offen offset:2048
    buffer_load_dwordx2 v[36:37], v3, s[4:7], s57 offen offset:0
    buffer_load_dwordx2 v[38:39], v2, s[4:7], 0 offen offset:0
    buffer_load_dwordx2 v[40:41], v2, s[4:7], 0 offen offset:2048
    buffer_load_dwordx2 v[42:43], v2, s[4:7], s57 offen offset:0
    buffer_load_dwordx2 v[44:45], v2, s[4:7], s57 offen offset:2048
    buffer_load_dwordx2 v[46:47], v2, s[4:7], s58 offen offset:0
    buffer_load_dwordx2 v[48:49], v2, s[4:7], s58 offen offset:2048
    buffer_load_dwordx2 v[50:51], v2, s[4:7], s59 offen offset:0
    buffer_load_dwordx2 v[52:53], v2, s[4:7], s59 offen offset:2048
    buffer_load_dwordx2 v[56:57], v2, s[8:11], 0 offen offset:0
    buffer_load_dwordx2 v[58:59], v2, s[8:11], 0 offen offset:2048
    buffer_load_dwordx2 v[60:61], v2, s[8:11], s57 offen offset:0
    buffer_load_dwordx2 v[62:63], v2, s[8:11], s57 offen offset:2048
    buffer_load_dwordx2 v[64:65], v2, s[8:11], s58 offen offset:0
    buffer_load_dwordx2 v[66:67], v2, s[8:11], s58 offen offset:2048
    buffer_load_dwordx2 v[68:69], v2, s[8:11], s59 offen offset:0
    buffer_load_dwordx2 v[70:71], v2, s[8:11], s59 offen offset:2048
    buffer_load_dwordx4 v[72:75], v4, s[12:15], 0 offen offset:0
    buffer_load_dwordx4 v[76:79], v4, s[12:15], 0 offen offset:16
    buffer_load_dwordx4 v[80:83], v5, s[60:63], s56 offen offset:0
    buffer_load_dwordx4 v[84:87], v5, s[60:63], s56 offen offset:16
    buffer_load_dwordx4 v[88:91], v5, s[60:63], s56 offen offset:2048
    buffer_load_dwordx4 v[92:95], v5, s[60:63], s56 offen offset:2064
    buffer_load_dwordx4 v[96:99], v5, s[64:67], 0 offen offset:0
    buffer_load_dwordx4 v[100:103], v5, s[64:67], 0 offen offset:16
    v_lshlrev_b32 v8, 4, v1
    s_lshl_b32 s48, s41, 6
    s_lshl_b32 s49, s42, 3
    s_add_u32 s48, s48, s49
    s_lshr_b32 s49, s40, 1
    s_lshl_b32 s49, s49, 2
    s_add_u32 s48, s48, s49
    s_lshl_b32 s48, s48, 14
    s_and_b32 s49, s40, 1
    s_lshl_b32 s68, s49, 11
    s_add_u32 s68, s68, s48
    s_lshl_b32 s69, s49, 12
    s_add_u32 s69, s69, s48
    s_add_u32 s69, s69, 8192
    s_mov_b32 s38, 0x3e0293ee
    s_add_u32 s70, s68, 0
    v_accvgpr_read_b32 v112, a0
    v_accvgpr_read_b32 v113, a1
    v_accvgpr_read_b32 v114, a2
    v_accvgpr_read_b32 v115, a3
    v_accvgpr_read_b32 v116, a32
    v_accvgpr_read_b32 v117, a33
    v_accvgpr_read_b32 v118, a34
    v_accvgpr_read_b32 v119, a35
    v_mul_f32 v112, s38, v112
    v_mul_f32 v113, s38, v113
    v_mul_f32 v114, s38, v114
    v_mul_f32 v115, s38, v115
    v_mul_f32 v116, s38, v116
    v_mul_f32 v117, s38, v117
    v_mul_f32 v118, s38, v118
    v_mul_f32 v119, s38, v119
    v_cvt_pk_bf16_f32 v120, v112, v113
    v_cvt_pk_bf16_f32 v121, v114, v115
    v_cvt_pk_bf16_f32 v122, v116, v117
    v_cvt_pk_bf16_f32 v123, v118, v119
    buffer_store_dwordx4 v[120:123], v8, s[16:19], s70 offen offset:0
    v_accvgpr_read_b32 v124, a64
    v_accvgpr_read_b32 v125, a65
    v_accvgpr_read_b32 v126, a66
    v_accvgpr_read_b32 v127, a67
    v_accvgpr_read_b32 v128, a96
    v_accvgpr_read_b32 v129, a97
    v_accvgpr_read_b32 v130, a98
    v_accvgpr_read_b32 v131, a99
    v_mul_f32 v124, s38, v124
    v_mul_f32 v125, s38, v125
    v_mul_f32 v126, s38, v126
    v_mul_f32 v127, s38, v127
    v_mul_f32 v128, s38, v128
    v_mul_f32 v129, s38, v129
    v_mul_f32 v130, s38, v130
    v_mul_f32 v131, s38, v131
    v_cvt_pk_bf16_f32 v132, v124, v125
    v_cvt_pk_bf16_f32 v133, v126, v127
    v_cvt_pk_bf16_f32 v134, v128, v129
    v_cvt_pk_bf16_f32 v135, v130, v131
    buffer_store_dwordx4 v[132:135], v8, s[16:19], s70 offen offset:1024
    s_add_u32 s70, s68, 4096
    v_accvgpr_read_b32 v136, a4
    v_accvgpr_read_b32 v137, a5
    v_accvgpr_read_b32 v138, a6
    v_accvgpr_read_b32 v139, a7
    v_accvgpr_read_b32 v140, a36
    v_accvgpr_read_b32 v141, a37
    v_accvgpr_read_b32 v142, a38
    v_accvgpr_read_b32 v143, a39
    v_mul_f32 v136, s38, v136
    v_mul_f32 v137, s38, v137
    v_mul_f32 v138, s38, v138
    v_mul_f32 v139, s38, v139
    v_mul_f32 v140, s38, v140
    v_mul_f32 v141, s38, v141
    v_mul_f32 v142, s38, v142
    v_mul_f32 v143, s38, v143
    v_cvt_pk_bf16_f32 v144, v136, v137
    v_cvt_pk_bf16_f32 v145, v138, v139
    v_cvt_pk_bf16_f32 v146, v140, v141
    v_cvt_pk_bf16_f32 v147, v142, v143
    buffer_store_dwordx4 v[144:147], v8, s[16:19], s70 offen offset:0
    v_accvgpr_read_b32 v148, a68
    v_accvgpr_read_b32 v149, a69
    v_accvgpr_read_b32 v150, a70
    v_accvgpr_read_b32 v151, a71
    v_accvgpr_read_b32 v152, a100
    v_accvgpr_read_b32 v153, a101
    v_accvgpr_read_b32 v154, a102
    v_accvgpr_read_b32 v155, a103
    v_mul_f32 v148, s38, v148
    v_mul_f32 v149, s38, v149
    v_mul_f32 v150, s38, v150
    v_mul_f32 v151, s38, v151
    v_mul_f32 v152, s38, v152
    v_mul_f32 v153, s38, v153
    v_mul_f32 v154, s38, v154
    v_mul_f32 v155, s38, v155
    v_cvt_pk_bf16_f32 v156, v148, v149
    v_cvt_pk_bf16_f32 v157, v150, v151
    v_cvt_pk_bf16_f32 v158, v152, v153
    v_cvt_pk_bf16_f32 v159, v154, v155
    buffer_store_dwordx4 v[156:159], v8, s[16:19], s70 offen offset:1024
    s_add_u32 s71, s69, 0
    v_accvgpr_read_b32 v112, a128
    v_accvgpr_read_b32 v113, a129
    v_accvgpr_read_b32 v114, a130
    v_accvgpr_read_b32 v115, a131
    v_accvgpr_read_b32 v116, a132
    v_accvgpr_read_b32 v117, a133
    v_accvgpr_read_b32 v118, a134
    v_accvgpr_read_b32 v119, a135
    v_cvt_pk_bf16_f32 v120, v112, v113
    v_cvt_pk_bf16_f32 v121, v114, v115
    v_cvt_pk_bf16_f32 v122, v116, v117
    v_cvt_pk_bf16_f32 v123, v118, v119
    buffer_store_dwordx4 v[120:123], v8, s[16:19], s71 offen offset:0
    v_accvgpr_read_b32 v124, a160
    v_accvgpr_read_b32 v125, a161
    v_accvgpr_read_b32 v126, a162
    v_accvgpr_read_b32 v127, a163
    v_accvgpr_read_b32 v128, a164
    v_accvgpr_read_b32 v129, a165
    v_accvgpr_read_b32 v130, a166
    v_accvgpr_read_b32 v131, a167
    v_cvt_pk_bf16_f32 v132, v124, v125
    v_cvt_pk_bf16_f32 v133, v126, v127
    v_cvt_pk_bf16_f32 v134, v128, v129
    v_cvt_pk_bf16_f32 v135, v130, v131
    buffer_store_dwordx4 v[132:135], v8, s[16:19], s71 offen offset:1024
    v_accvgpr_read_b32 v136, a192
    v_accvgpr_read_b32 v137, a193
    v_accvgpr_read_b32 v138, a194
    v_accvgpr_read_b32 v139, a195
    v_accvgpr_read_b32 v140, a196
    v_accvgpr_read_b32 v141, a197
    v_accvgpr_read_b32 v142, a198
    v_accvgpr_read_b32 v143, a199
    v_cvt_pk_bf16_f32 v144, v136, v137
    v_cvt_pk_bf16_f32 v145, v138, v139
    v_cvt_pk_bf16_f32 v146, v140, v141
    v_cvt_pk_bf16_f32 v147, v142, v143
    buffer_store_dwordx4 v[144:147], v8, s[16:19], s71 offen offset:2048
    v_accvgpr_read_b32 v148, a224
    v_accvgpr_read_b32 v149, a225
    v_accvgpr_read_b32 v150, a226
    v_accvgpr_read_b32 v151, a227
    v_accvgpr_read_b32 v152, a228
    v_accvgpr_read_b32 v153, a229
    v_accvgpr_read_b32 v154, a230
    v_accvgpr_read_b32 v155, a231
    v_cvt_pk_bf16_f32 v156, v148, v149
    v_cvt_pk_bf16_f32 v157, v150, v151
    v_cvt_pk_bf16_f32 v158, v152, v153
    v_cvt_pk_bf16_f32 v159, v154, v155
    buffer_store_dwordx4 v[156:159], v8, s[16:19], s71 offen offset:3072
    s_add_u32 s70, s68, 16384
    v_accvgpr_read_b32 v112, a8
    v_accvgpr_read_b32 v113, a9
    v_accvgpr_read_b32 v114, a10
    v_accvgpr_read_b32 v115, a11
    v_accvgpr_read_b32 v116, a40
    v_accvgpr_read_b32 v117, a41
    v_accvgpr_read_b32 v118, a42
    v_accvgpr_read_b32 v119, a43
    v_mul_f32 v112, s38, v112
    v_mul_f32 v113, s38, v113
    v_mul_f32 v114, s38, v114
    v_mul_f32 v115, s38, v115
    v_mul_f32 v116, s38, v116
    v_mul_f32 v117, s38, v117
    v_mul_f32 v118, s38, v118
    v_mul_f32 v119, s38, v119
    v_cvt_pk_bf16_f32 v120, v112, v113
    v_cvt_pk_bf16_f32 v121, v114, v115
    v_cvt_pk_bf16_f32 v122, v116, v117
    v_cvt_pk_bf16_f32 v123, v118, v119
    buffer_store_dwordx4 v[120:123], v8, s[16:19], s70 offen offset:0
    v_accvgpr_read_b32 v124, a72
    v_accvgpr_read_b32 v125, a73
    v_accvgpr_read_b32 v126, a74
    v_accvgpr_read_b32 v127, a75
    v_accvgpr_read_b32 v128, a104
    v_accvgpr_read_b32 v129, a105
    v_accvgpr_read_b32 v130, a106
    v_accvgpr_read_b32 v131, a107
    v_mul_f32 v124, s38, v124
    v_mul_f32 v125, s38, v125
    v_mul_f32 v126, s38, v126
    v_mul_f32 v127, s38, v127
    v_mul_f32 v128, s38, v128
    v_mul_f32 v129, s38, v129
    v_mul_f32 v130, s38, v130
    v_mul_f32 v131, s38, v131
    v_cvt_pk_bf16_f32 v132, v124, v125
    v_cvt_pk_bf16_f32 v133, v126, v127
    v_cvt_pk_bf16_f32 v134, v128, v129
    v_cvt_pk_bf16_f32 v135, v130, v131
    buffer_store_dwordx4 v[132:135], v8, s[16:19], s70 offen offset:1024
    s_add_u32 s70, s68, 20480
    v_accvgpr_read_b32 v136, a12
    v_accvgpr_read_b32 v137, a13
    v_accvgpr_read_b32 v138, a14
    v_accvgpr_read_b32 v139, a15
    v_accvgpr_read_b32 v140, a44
    v_accvgpr_read_b32 v141, a45
    v_accvgpr_read_b32 v142, a46
    v_accvgpr_read_b32 v143, a47
    v_mul_f32 v136, s38, v136
    v_mul_f32 v137, s38, v137
    v_mul_f32 v138, s38, v138
    v_mul_f32 v139, s38, v139
    v_mul_f32 v140, s38, v140
    v_mul_f32 v141, s38, v141
    v_mul_f32 v142, s38, v142
    v_mul_f32 v143, s38, v143
    v_cvt_pk_bf16_f32 v144, v136, v137
    v_cvt_pk_bf16_f32 v145, v138, v139
    v_cvt_pk_bf16_f32 v146, v140, v141
    v_cvt_pk_bf16_f32 v147, v142, v143
    buffer_store_dwordx4 v[144:147], v8, s[16:19], s70 offen offset:0
    v_accvgpr_read_b32 v148, a76
    v_accvgpr_read_b32 v149, a77
    v_accvgpr_read_b32 v150, a78
    v_accvgpr_read_b32 v151, a79
    v_accvgpr_read_b32 v152, a108
    v_accvgpr_read_b32 v153, a109
    v_accvgpr_read_b32 v154, a110
    v_accvgpr_read_b32 v155, a111
    v_mul_f32 v148, s38, v148
    v_mul_f32 v149, s38, v149
    v_mul_f32 v150, s38, v150
    v_mul_f32 v151, s38, v151
    v_mul_f32 v152, s38, v152
    v_mul_f32 v153, s38, v153
    v_mul_f32 v154, s38, v154
    v_mul_f32 v155, s38, v155
    v_cvt_pk_bf16_f32 v156, v148, v149
    v_cvt_pk_bf16_f32 v157, v150, v151
    v_cvt_pk_bf16_f32 v158, v152, v153
    v_cvt_pk_bf16_f32 v159, v154, v155
    buffer_store_dwordx4 v[156:159], v8, s[16:19], s70 offen offset:1024
    s_add_u32 s71, s69, 16384
    v_accvgpr_read_b32 v112, a136
    v_accvgpr_read_b32 v113, a137
    v_accvgpr_read_b32 v114, a138
    v_accvgpr_read_b32 v115, a139
    v_accvgpr_read_b32 v116, a140
    v_accvgpr_read_b32 v117, a141
    v_accvgpr_read_b32 v118, a142
    v_accvgpr_read_b32 v119, a143
    v_cvt_pk_bf16_f32 v120, v112, v113
    v_cvt_pk_bf16_f32 v121, v114, v115
    v_cvt_pk_bf16_f32 v122, v116, v117
    v_cvt_pk_bf16_f32 v123, v118, v119
    buffer_store_dwordx4 v[120:123], v8, s[16:19], s71 offen offset:0
    v_accvgpr_read_b32 v124, a168
    v_accvgpr_read_b32 v125, a169
    v_accvgpr_read_b32 v126, a170
    v_accvgpr_read_b32 v127, a171
    v_accvgpr_read_b32 v128, a172
    v_accvgpr_read_b32 v129, a173
    v_accvgpr_read_b32 v130, a174
    v_accvgpr_read_b32 v131, a175
    v_cvt_pk_bf16_f32 v132, v124, v125
    v_cvt_pk_bf16_f32 v133, v126, v127
    v_cvt_pk_bf16_f32 v134, v128, v129
    v_cvt_pk_bf16_f32 v135, v130, v131
    buffer_store_dwordx4 v[132:135], v8, s[16:19], s71 offen offset:1024
    v_accvgpr_read_b32 v136, a200
    v_accvgpr_read_b32 v137, a201
    v_accvgpr_read_b32 v138, a202
    v_accvgpr_read_b32 v139, a203
    v_accvgpr_read_b32 v140, a204
    v_accvgpr_read_b32 v141, a205
    v_accvgpr_read_b32 v142, a206
    v_accvgpr_read_b32 v143, a207
    v_cvt_pk_bf16_f32 v144, v136, v137
    v_cvt_pk_bf16_f32 v145, v138, v139
    v_cvt_pk_bf16_f32 v146, v140, v141
    v_cvt_pk_bf16_f32 v147, v142, v143
    buffer_store_dwordx4 v[144:147], v8, s[16:19], s71 offen offset:2048
    v_accvgpr_read_b32 v148, a232
    v_accvgpr_read_b32 v149, a233
    v_accvgpr_read_b32 v150, a234
    v_accvgpr_read_b32 v151, a235
    v_accvgpr_read_b32 v152, a236
    v_accvgpr_read_b32 v153, a237
    v_accvgpr_read_b32 v154, a238
    v_accvgpr_read_b32 v155, a239
    v_cvt_pk_bf16_f32 v156, v148, v149
    v_cvt_pk_bf16_f32 v157, v150, v151
    v_cvt_pk_bf16_f32 v158, v152, v153
    v_cvt_pk_bf16_f32 v159, v154, v155
    buffer_store_dwordx4 v[156:159], v8, s[16:19], s71 offen offset:3072
    s_add_u32 s70, s68, 32768
    v_accvgpr_read_b32 v112, a16
    v_accvgpr_read_b32 v113, a17
    v_accvgpr_read_b32 v114, a18
    v_accvgpr_read_b32 v115, a19
    v_accvgpr_read_b32 v116, a48
    v_accvgpr_read_b32 v117, a49
    v_accvgpr_read_b32 v118, a50
    v_accvgpr_read_b32 v119, a51
    v_mul_f32 v112, s38, v112
    v_mul_f32 v113, s38, v113
    v_mul_f32 v114, s38, v114
    v_mul_f32 v115, s38, v115
    v_mul_f32 v116, s38, v116
    v_mul_f32 v117, s38, v117
    v_mul_f32 v118, s38, v118
    v_mul_f32 v119, s38, v119
    v_cvt_pk_bf16_f32 v120, v112, v113
    v_cvt_pk_bf16_f32 v121, v114, v115
    v_cvt_pk_bf16_f32 v122, v116, v117
    v_cvt_pk_bf16_f32 v123, v118, v119
    buffer_store_dwordx4 v[120:123], v8, s[16:19], s70 offen offset:0
    v_accvgpr_read_b32 v124, a80
    v_accvgpr_read_b32 v125, a81
    v_accvgpr_read_b32 v126, a82
    v_accvgpr_read_b32 v127, a83
    v_accvgpr_read_b32 v128, a112
    v_accvgpr_read_b32 v129, a113
    v_accvgpr_read_b32 v130, a114
    v_accvgpr_read_b32 v131, a115
    v_mul_f32 v124, s38, v124
    v_mul_f32 v125, s38, v125
    v_mul_f32 v126, s38, v126
    v_mul_f32 v127, s38, v127
    v_mul_f32 v128, s38, v128
    v_mul_f32 v129, s38, v129
    v_mul_f32 v130, s38, v130
    v_mul_f32 v131, s38, v131
    v_cvt_pk_bf16_f32 v132, v124, v125
    v_cvt_pk_bf16_f32 v133, v126, v127
    v_cvt_pk_bf16_f32 v134, v128, v129
    v_cvt_pk_bf16_f32 v135, v130, v131
    buffer_store_dwordx4 v[132:135], v8, s[16:19], s70 offen offset:1024
    s_add_u32 s70, s68, 36864
    v_accvgpr_read_b32 v136, a20
    v_accvgpr_read_b32 v137, a21
    v_accvgpr_read_b32 v138, a22
    v_accvgpr_read_b32 v139, a23
    v_accvgpr_read_b32 v140, a52
    v_accvgpr_read_b32 v141, a53
    v_accvgpr_read_b32 v142, a54
    v_accvgpr_read_b32 v143, a55
    v_mul_f32 v136, s38, v136
    v_mul_f32 v137, s38, v137
    v_mul_f32 v138, s38, v138
    v_mul_f32 v139, s38, v139
    v_mul_f32 v140, s38, v140
    v_mul_f32 v141, s38, v141
    v_mul_f32 v142, s38, v142
    v_mul_f32 v143, s38, v143
    v_cvt_pk_bf16_f32 v144, v136, v137
    v_cvt_pk_bf16_f32 v145, v138, v139
    v_cvt_pk_bf16_f32 v146, v140, v141
    v_cvt_pk_bf16_f32 v147, v142, v143
    buffer_store_dwordx4 v[144:147], v8, s[16:19], s70 offen offset:0
    v_accvgpr_read_b32 v148, a84
    v_accvgpr_read_b32 v149, a85
    v_accvgpr_read_b32 v150, a86
    v_accvgpr_read_b32 v151, a87
    v_accvgpr_read_b32 v152, a116
    v_accvgpr_read_b32 v153, a117
    v_accvgpr_read_b32 v154, a118
    v_accvgpr_read_b32 v155, a119
    v_mul_f32 v148, s38, v148
    v_mul_f32 v149, s38, v149
    v_mul_f32 v150, s38, v150
    v_mul_f32 v151, s38, v151
    v_mul_f32 v152, s38, v152
    v_mul_f32 v153, s38, v153
    v_mul_f32 v154, s38, v154
    v_mul_f32 v155, s38, v155
    v_cvt_pk_bf16_f32 v156, v148, v149
    v_cvt_pk_bf16_f32 v157, v150, v151
    v_cvt_pk_bf16_f32 v158, v152, v153
    v_cvt_pk_bf16_f32 v159, v154, v155
    buffer_store_dwordx4 v[156:159], v8, s[16:19], s70 offen offset:1024
    s_add_u32 s71, s69, 32768
    v_accvgpr_read_b32 v112, a144
    v_accvgpr_read_b32 v113, a145
    v_accvgpr_read_b32 v114, a146
    v_accvgpr_read_b32 v115, a147
    v_accvgpr_read_b32 v116, a148
    v_accvgpr_read_b32 v117, a149
    v_accvgpr_read_b32 v118, a150
    v_accvgpr_read_b32 v119, a151
    v_cvt_pk_bf16_f32 v120, v112, v113
    v_cvt_pk_bf16_f32 v121, v114, v115
    v_cvt_pk_bf16_f32 v122, v116, v117
    v_cvt_pk_bf16_f32 v123, v118, v119
    buffer_store_dwordx4 v[120:123], v8, s[16:19], s71 offen offset:0
    v_accvgpr_read_b32 v124, a176
    v_accvgpr_read_b32 v125, a177
    v_accvgpr_read_b32 v126, a178
    v_accvgpr_read_b32 v127, a179
    v_accvgpr_read_b32 v128, a180
    v_accvgpr_read_b32 v129, a181
    v_accvgpr_read_b32 v130, a182
    v_accvgpr_read_b32 v131, a183
    v_cvt_pk_bf16_f32 v132, v124, v125
    v_cvt_pk_bf16_f32 v133, v126, v127
    v_cvt_pk_bf16_f32 v134, v128, v129
    v_cvt_pk_bf16_f32 v135, v130, v131
    buffer_store_dwordx4 v[132:135], v8, s[16:19], s71 offen offset:1024
    v_accvgpr_read_b32 v136, a208
    v_accvgpr_read_b32 v137, a209
    v_accvgpr_read_b32 v138, a210
    v_accvgpr_read_b32 v139, a211
    v_accvgpr_read_b32 v140, a212
    v_accvgpr_read_b32 v141, a213
    v_accvgpr_read_b32 v142, a214
    v_accvgpr_read_b32 v143, a215
    v_cvt_pk_bf16_f32 v144, v136, v137
    v_cvt_pk_bf16_f32 v145, v138, v139
    v_cvt_pk_bf16_f32 v146, v140, v141
    v_cvt_pk_bf16_f32 v147, v142, v143
    buffer_store_dwordx4 v[144:147], v8, s[16:19], s71 offen offset:2048
    v_accvgpr_read_b32 v148, a240
    v_accvgpr_read_b32 v149, a241
    v_accvgpr_read_b32 v150, a242
    v_accvgpr_read_b32 v151, a243
    v_accvgpr_read_b32 v152, a244
    v_accvgpr_read_b32 v153, a245
    v_accvgpr_read_b32 v154, a246
    v_accvgpr_read_b32 v155, a247
    v_cvt_pk_bf16_f32 v156, v148, v149
    v_cvt_pk_bf16_f32 v157, v150, v151
    v_cvt_pk_bf16_f32 v158, v152, v153
    v_cvt_pk_bf16_f32 v159, v154, v155
    buffer_store_dwordx4 v[156:159], v8, s[16:19], s71 offen offset:3072
    s_add_u32 s70, s68, 49152
    v_accvgpr_read_b32 v112, a24
    v_accvgpr_read_b32 v113, a25
    v_accvgpr_read_b32 v114, a26
    v_accvgpr_read_b32 v115, a27
    v_accvgpr_read_b32 v116, a56
    v_accvgpr_read_b32 v117, a57
    v_accvgpr_read_b32 v118, a58
    v_accvgpr_read_b32 v119, a59
    v_mul_f32 v112, s38, v112
    v_mul_f32 v113, s38, v113
    v_mul_f32 v114, s38, v114
    v_mul_f32 v115, s38, v115
    v_mul_f32 v116, s38, v116
    v_mul_f32 v117, s38, v117
    v_mul_f32 v118, s38, v118
    v_mul_f32 v119, s38, v119
    v_cvt_pk_bf16_f32 v120, v112, v113
    v_cvt_pk_bf16_f32 v121, v114, v115
    v_cvt_pk_bf16_f32 v122, v116, v117
    v_cvt_pk_bf16_f32 v123, v118, v119
    buffer_store_dwordx4 v[120:123], v8, s[16:19], s70 offen offset:0
    v_accvgpr_read_b32 v124, a88
    v_accvgpr_read_b32 v125, a89
    v_accvgpr_read_b32 v126, a90
    v_accvgpr_read_b32 v127, a91
    v_accvgpr_read_b32 v128, a120
    v_accvgpr_read_b32 v129, a121
    v_accvgpr_read_b32 v130, a122
    v_accvgpr_read_b32 v131, a123
    v_mul_f32 v124, s38, v124
    v_mul_f32 v125, s38, v125
    v_mul_f32 v126, s38, v126
    v_mul_f32 v127, s38, v127
    v_mul_f32 v128, s38, v128
    v_mul_f32 v129, s38, v129
    v_mul_f32 v130, s38, v130
    v_mul_f32 v131, s38, v131
    v_cvt_pk_bf16_f32 v132, v124, v125
    v_cvt_pk_bf16_f32 v133, v126, v127
    v_cvt_pk_bf16_f32 v134, v128, v129
    v_cvt_pk_bf16_f32 v135, v130, v131
    buffer_store_dwordx4 v[132:135], v8, s[16:19], s70 offen offset:1024
    s_add_u32 s70, s68, 53248
    v_accvgpr_read_b32 v136, a28
    v_accvgpr_read_b32 v137, a29
    v_accvgpr_read_b32 v138, a30
    v_accvgpr_read_b32 v139, a31
    v_accvgpr_read_b32 v140, a60
    v_accvgpr_read_b32 v141, a61
    v_accvgpr_read_b32 v142, a62
    v_accvgpr_read_b32 v143, a63
    v_mul_f32 v136, s38, v136
    v_mul_f32 v137, s38, v137
    v_mul_f32 v138, s38, v138
    v_mul_f32 v139, s38, v139
    v_mul_f32 v140, s38, v140
    v_mul_f32 v141, s38, v141
    v_mul_f32 v142, s38, v142
    v_mul_f32 v143, s38, v143
    v_cvt_pk_bf16_f32 v144, v136, v137
    v_cvt_pk_bf16_f32 v145, v138, v139
    v_cvt_pk_bf16_f32 v146, v140, v141
    v_cvt_pk_bf16_f32 v147, v142, v143
    buffer_store_dwordx4 v[144:147], v8, s[16:19], s70 offen offset:0
    v_accvgpr_read_b32 v148, a92
    v_accvgpr_read_b32 v149, a93
    v_accvgpr_read_b32 v150, a94
    v_accvgpr_read_b32 v151, a95
    v_accvgpr_read_b32 v152, a124
    v_accvgpr_read_b32 v153, a125
    v_accvgpr_read_b32 v154, a126
    v_accvgpr_read_b32 v155, a127
    v_mul_f32 v148, s38, v148
    v_mul_f32 v149, s38, v149
    v_mul_f32 v150, s38, v150
    v_mul_f32 v151, s38, v151
    v_mul_f32 v152, s38, v152
    v_mul_f32 v153, s38, v153
    v_mul_f32 v154, s38, v154
    v_mul_f32 v155, s38, v155
    v_cvt_pk_bf16_f32 v156, v148, v149
    v_cvt_pk_bf16_f32 v157, v150, v151
    v_cvt_pk_bf16_f32 v158, v152, v153
    v_cvt_pk_bf16_f32 v159, v154, v155
    buffer_store_dwordx4 v[156:159], v8, s[16:19], s70 offen offset:1024
    s_add_u32 s71, s69, 49152
    v_accvgpr_read_b32 v112, a152
    v_accvgpr_read_b32 v113, a153
    v_accvgpr_read_b32 v114, a154
    v_accvgpr_read_b32 v115, a155
    v_accvgpr_read_b32 v116, a156
    v_accvgpr_read_b32 v117, a157
    v_accvgpr_read_b32 v118, a158
    v_accvgpr_read_b32 v119, a159
    v_cvt_pk_bf16_f32 v120, v112, v113
    v_cvt_pk_bf16_f32 v121, v114, v115
    v_cvt_pk_bf16_f32 v122, v116, v117
    v_cvt_pk_bf16_f32 v123, v118, v119
    buffer_store_dwordx4 v[120:123], v8, s[16:19], s71 offen offset:0
    v_accvgpr_read_b32 v124, a184
    v_accvgpr_read_b32 v125, a185
    v_accvgpr_read_b32 v126, a186
    v_accvgpr_read_b32 v127, a187
    v_accvgpr_read_b32 v128, a188
    v_accvgpr_read_b32 v129, a189
    v_accvgpr_read_b32 v130, a190
    v_accvgpr_read_b32 v131, a191
    v_cvt_pk_bf16_f32 v132, v124, v125
    v_cvt_pk_bf16_f32 v133, v126, v127
    v_cvt_pk_bf16_f32 v134, v128, v129
    v_cvt_pk_bf16_f32 v135, v130, v131
    buffer_store_dwordx4 v[132:135], v8, s[16:19], s71 offen offset:1024
    v_accvgpr_read_b32 v136, a216
    v_accvgpr_read_b32 v137, a217
    v_accvgpr_read_b32 v138, a218
    v_accvgpr_read_b32 v139, a219
    v_accvgpr_read_b32 v140, a220
    v_accvgpr_read_b32 v141, a221
    v_accvgpr_read_b32 v142, a222
    v_accvgpr_read_b32 v143, a223
    v_cvt_pk_bf16_f32 v144, v136, v137
    v_cvt_pk_bf16_f32 v145, v138, v139
    v_cvt_pk_bf16_f32 v146, v140, v141
    v_cvt_pk_bf16_f32 v147, v142, v143
    buffer_store_dwordx4 v[144:147], v8, s[16:19], s71 offen offset:2048
    v_accvgpr_read_b32 v148, a248
    v_accvgpr_read_b32 v149, a249
    v_accvgpr_read_b32 v150, a250
    v_accvgpr_read_b32 v151, a251
    v_accvgpr_read_b32 v152, a252
    v_accvgpr_read_b32 v153, a253
    v_accvgpr_read_b32 v154, a254
    v_accvgpr_read_b32 v155, a255
    v_cvt_pk_bf16_f32 v156, v148, v149
    v_cvt_pk_bf16_f32 v157, v150, v151
    v_cvt_pk_bf16_f32 v158, v152, v153
    v_cvt_pk_bf16_f32 v159, v154, v155
    buffer_store_dwordx4 v[156:159], v8, s[16:19], s71 offen offset:3072
    s_add_u32 s4, s22, 50331648
    s_addc_u32 s5, s23, 0
    s_mov_b32 s6, 4718592
    s_mov_b32 s7, 0x00020000
    s_add_u32 s8, s22, 59768832
    s_addc_u32 s9, s23, 0
    s_mov_b32 s10, 8192
    s_mov_b32 s11, 0x00020000
    s_waitcnt vmcnt(32)
    s_mov_b32 s34, 0xffff0000
    v_lshlrev_b32 v160, 16, v32
    v_lshlrev_b32 v161, 16, v34
    v_lshlrev_b32 v162, 16, v36
    v_lshlrev_b32 v163, 16, v38
    v_lshlrev_b32 v164, 16, v40
    v_lshlrev_b32 v165, 16, v42
    v_lshlrev_b32 v166, 16, v44
    v_lshlrev_b32 v167, 16, v46
    v_lshlrev_b32 v168, 16, v48
    v_lshlrev_b32 v169, 16, v50
    v_lshlrev_b32 v170, 16, v52
    v_lshlrev_b32 v171, 16, v56
    v_lshlrev_b32 v172, 16, v58
    v_lshlrev_b32 v173, 16, v60
    v_lshlrev_b32 v174, 16, v62
    v_lshlrev_b32 v175, 16, v64
    v_lshlrev_b32 v176, 16, v66
    v_lshlrev_b32 v177, 16, v68
    v_lshlrev_b32 v178, 16, v70
    v_lshlrev_b32 v179, 16, v72
    v_and_b32 v180, s34, v72
    v_lshlrev_b32 v181, 16, v73
    v_and_b32 v182, s34, v73
    v_mul_f32 v184, v163, v179
    v_mul_f32 v185, v164, v179
    v_mul_f32 v186, v165, v179
    v_mul_f32 v187, v166, v179
    v_mul_f32 v188, v167, v179
    v_mul_f32 v189, v168, v179
    v_mul_f32 v190, v169, v179
    v_mul_f32 v191, v170, v179
    v_fmac_f32 v184, v162, v180
    v_fmac_f32 v185, v163, v180
    v_fmac_f32 v186, v164, v180
    v_fmac_f32 v187, v165, v180
    v_fmac_f32 v188, v166, v180
    v_fmac_f32 v189, v167, v180
    v_fmac_f32 v190, v168, v180
    v_fmac_f32 v191, v169, v180
    v_fmac_f32 v184, v161, v181
    v_fmac_f32 v185, v162, v181
    v_fmac_f32 v186, v163, v181
    v_fmac_f32 v187, v164, v181
    v_fmac_f32 v188, v165, v181
    v_fmac_f32 v189, v166, v181
    v_fmac_f32 v190, v167, v181
    v_fmac_f32 v191, v168, v181
    v_fmac_f32 v184, v160, v182
    v_fmac_f32 v185, v161, v182
    v_fmac_f32 v186, v162, v182
    v_fmac_f32 v187, v163, v182
    v_fmac_f32 v188, v164, v182
    v_fmac_f32 v189, v165, v182
    v_fmac_f32 v190, v166, v182
    v_fmac_f32 v191, v167, v182
    v_mul_f32 v184, v184, v171
    v_mul_f32 v185, v185, v172
    v_mul_f32 v186, v186, v173
    v_mul_f32 v187, v187, v174
    v_mul_f32 v188, v188, v175
    v_mul_f32 v189, v189, v176
    v_mul_f32 v190, v190, v177
    v_mul_f32 v191, v191, v178
    v_cvt_pk_bf16_f32 v192, v191, v190
    v_cvt_pk_bf16_f32 v193, v189, v188
    v_cvt_pk_bf16_f32 v194, v187, v186
    v_cvt_pk_bf16_f32 v195, v185, v184
    buffer_store_dwordx4 v[192:195], v6, s[4:7], 0 offen
    v_and_b32 v160, s34, v32
    v_and_b32 v161, s34, v34
    v_and_b32 v162, s34, v36
    v_and_b32 v163, s34, v38
    v_and_b32 v164, s34, v40
    v_and_b32 v165, s34, v42
    v_and_b32 v166, s34, v44
    v_and_b32 v167, s34, v46
    v_and_b32 v168, s34, v48
    v_and_b32 v169, s34, v50
    v_and_b32 v170, s34, v52
    v_and_b32 v171, s34, v56
    v_and_b32 v172, s34, v58
    v_and_b32 v173, s34, v60
    v_and_b32 v174, s34, v62
    v_and_b32 v175, s34, v64
    v_and_b32 v176, s34, v66
    v_and_b32 v177, s34, v68
    v_and_b32 v178, s34, v70
    v_lshlrev_b32 v179, 16, v74
    v_and_b32 v180, s34, v74
    v_lshlrev_b32 v181, 16, v75
    v_and_b32 v182, s34, v75
    v_mul_f32 v184, v163, v179
    v_mul_f32 v185, v164, v179
    v_mul_f32 v186, v165, v179
    v_mul_f32 v187, v166, v179
    v_mul_f32 v188, v167, v179
    v_mul_f32 v189, v168, v179
    v_mul_f32 v190, v169, v179
    v_mul_f32 v191, v170, v179
    v_fmac_f32 v184, v162, v180
    v_fmac_f32 v185, v163, v180
    v_fmac_f32 v186, v164, v180
    v_fmac_f32 v187, v165, v180
    v_fmac_f32 v188, v166, v180
    v_fmac_f32 v189, v167, v180
    v_fmac_f32 v190, v168, v180
    v_fmac_f32 v191, v169, v180
    v_fmac_f32 v184, v161, v181
    v_fmac_f32 v185, v162, v181
    v_fmac_f32 v186, v163, v181
    v_fmac_f32 v187, v164, v181
    v_fmac_f32 v188, v165, v181
    v_fmac_f32 v189, v166, v181
    v_fmac_f32 v190, v167, v181
    v_fmac_f32 v191, v168, v181
    v_fmac_f32 v184, v160, v182
    v_fmac_f32 v185, v161, v182
    v_fmac_f32 v186, v162, v182
    v_fmac_f32 v187, v163, v182
    v_fmac_f32 v188, v164, v182
    v_fmac_f32 v189, v165, v182
    v_fmac_f32 v190, v166, v182
    v_fmac_f32 v191, v167, v182
    v_mul_f32 v184, v184, v171
    v_mul_f32 v185, v185, v172
    v_mul_f32 v186, v186, v173
    v_mul_f32 v187, v187, v174
    v_mul_f32 v188, v188, v175
    v_mul_f32 v189, v189, v176
    v_mul_f32 v190, v190, v177
    v_mul_f32 v191, v191, v178
    v_cvt_pk_bf16_f32 v196, v191, v190
    v_cvt_pk_bf16_f32 v197, v189, v188
    v_cvt_pk_bf16_f32 v198, v187, v186
    v_cvt_pk_bf16_f32 v199, v185, v184
    s_movk_i32 s35, 4608
    buffer_store_dwordx4 v[196:199], v6, s[4:7], s35 offen
    v_lshlrev_b32 v160, 16, v33
    v_lshlrev_b32 v161, 16, v35
    v_lshlrev_b32 v162, 16, v37
    v_lshlrev_b32 v163, 16, v39
    v_lshlrev_b32 v164, 16, v41
    v_lshlrev_b32 v165, 16, v43
    v_lshlrev_b32 v166, 16, v45
    v_lshlrev_b32 v167, 16, v47
    v_lshlrev_b32 v168, 16, v49
    v_lshlrev_b32 v169, 16, v51
    v_lshlrev_b32 v170, 16, v53
    v_lshlrev_b32 v171, 16, v57
    v_lshlrev_b32 v172, 16, v59
    v_lshlrev_b32 v173, 16, v61
    v_lshlrev_b32 v174, 16, v63
    v_lshlrev_b32 v175, 16, v65
    v_lshlrev_b32 v176, 16, v67
    v_lshlrev_b32 v177, 16, v69
    v_lshlrev_b32 v178, 16, v71
    v_lshlrev_b32 v179, 16, v76
    v_and_b32 v180, s34, v76
    v_lshlrev_b32 v181, 16, v77
    v_and_b32 v182, s34, v77
    v_mul_f32 v184, v163, v179
    v_mul_f32 v185, v164, v179
    v_mul_f32 v186, v165, v179
    v_mul_f32 v187, v166, v179
    v_mul_f32 v188, v167, v179
    v_mul_f32 v189, v168, v179
    v_mul_f32 v190, v169, v179
    v_mul_f32 v191, v170, v179
    v_fmac_f32 v184, v162, v180
    v_fmac_f32 v185, v163, v180
    v_fmac_f32 v186, v164, v180
    v_fmac_f32 v187, v165, v180
    v_fmac_f32 v188, v166, v180
    v_fmac_f32 v189, v167, v180
    v_fmac_f32 v190, v168, v180
    v_fmac_f32 v191, v169, v180
    v_fmac_f32 v184, v161, v181
    v_fmac_f32 v185, v162, v181
    v_fmac_f32 v186, v163, v181
    v_fmac_f32 v187, v164, v181
    v_fmac_f32 v188, v165, v181
    v_fmac_f32 v189, v166, v181
    v_fmac_f32 v190, v167, v181
    v_fmac_f32 v191, v168, v181
    v_fmac_f32 v184, v160, v182
    v_fmac_f32 v185, v161, v182
    v_fmac_f32 v186, v162, v182
    v_fmac_f32 v187, v163, v182
    v_fmac_f32 v188, v164, v182
    v_fmac_f32 v189, v165, v182
    v_fmac_f32 v190, v166, v182
    v_fmac_f32 v191, v167, v182
    v_mul_f32 v184, v184, v171
    v_mul_f32 v185, v185, v172
    v_mul_f32 v186, v186, v173
    v_mul_f32 v187, v187, v174
    v_mul_f32 v188, v188, v175
    v_mul_f32 v189, v189, v176
    v_mul_f32 v190, v190, v177
    v_mul_f32 v191, v191, v178
    v_cvt_pk_bf16_f32 v200, v191, v190
    v_cvt_pk_bf16_f32 v201, v189, v188
    v_cvt_pk_bf16_f32 v202, v187, v186
    v_cvt_pk_bf16_f32 v203, v185, v184
    s_movk_i32 s35, 9216
    buffer_store_dwordx4 v[200:203], v6, s[4:7], s35 offen
    v_and_b32 v160, s34, v33
    v_and_b32 v161, s34, v35
    v_and_b32 v162, s34, v37
    v_and_b32 v163, s34, v39
    v_and_b32 v164, s34, v41
    v_and_b32 v165, s34, v43
    v_and_b32 v166, s34, v45
    v_and_b32 v167, s34, v47
    v_and_b32 v168, s34, v49
    v_and_b32 v169, s34, v51
    v_and_b32 v170, s34, v53
    v_and_b32 v171, s34, v57
    v_and_b32 v172, s34, v59
    v_and_b32 v173, s34, v61
    v_and_b32 v174, s34, v63
    v_and_b32 v175, s34, v65
    v_and_b32 v176, s34, v67
    v_and_b32 v177, s34, v69
    v_and_b32 v178, s34, v71
    v_lshlrev_b32 v179, 16, v78
    v_and_b32 v180, s34, v78
    v_lshlrev_b32 v181, 16, v79
    v_and_b32 v182, s34, v79
    v_mul_f32 v184, v163, v179
    v_mul_f32 v185, v164, v179
    v_mul_f32 v186, v165, v179
    v_mul_f32 v187, v166, v179
    v_mul_f32 v188, v167, v179
    v_mul_f32 v189, v168, v179
    v_mul_f32 v190, v169, v179
    v_mul_f32 v191, v170, v179
    v_fmac_f32 v184, v162, v180
    v_fmac_f32 v185, v163, v180
    v_fmac_f32 v186, v164, v180
    v_fmac_f32 v187, v165, v180
    v_fmac_f32 v188, v166, v180
    v_fmac_f32 v189, v167, v180
    v_fmac_f32 v190, v168, v180
    v_fmac_f32 v191, v169, v180
    v_fmac_f32 v184, v161, v181
    v_fmac_f32 v185, v162, v181
    v_fmac_f32 v186, v163, v181
    v_fmac_f32 v187, v164, v181
    v_fmac_f32 v188, v165, v181
    v_fmac_f32 v189, v166, v181
    v_fmac_f32 v190, v167, v181
    v_fmac_f32 v191, v168, v181
    v_fmac_f32 v184, v160, v182
    v_fmac_f32 v185, v161, v182
    v_fmac_f32 v186, v162, v182
    v_fmac_f32 v187, v163, v182
    v_fmac_f32 v188, v164, v182
    v_fmac_f32 v189, v165, v182
    v_fmac_f32 v190, v166, v182
    v_fmac_f32 v191, v167, v182
    v_mul_f32 v184, v184, v171
    v_mul_f32 v185, v185, v172
    v_mul_f32 v186, v186, v173
    v_mul_f32 v187, v187, v174
    v_mul_f32 v188, v188, v175
    v_mul_f32 v189, v189, v176
    v_mul_f32 v190, v190, v177
    v_mul_f32 v191, v191, v178
    v_cvt_pk_bf16_f32 v204, v191, v190
    v_cvt_pk_bf16_f32 v205, v189, v188
    v_cvt_pk_bf16_f32 v206, v187, v186
    v_cvt_pk_bf16_f32 v207, v185, v184
    s_movk_i32 s35, 13824
    buffer_store_dwordx4 v[204:207], v6, s[4:7], s35 offen
    v_mov_b32 v208, 0
    v_mov_b32 v209, 0
    v_mov_b32 v210, 0
    v_mov_b32 v211, 0
    buffer_store_dwordx4 v[208:211], v7, s[4:7], 0 offen
    v_lshlrev_b32 v160, 16, v96
    v_and_b32 v161, s34, v96
    v_lshlrev_b32 v162, 16, v97
    v_and_b32 v163, s34, v97
    v_lshlrev_b32 v164, 16, v98
    v_and_b32 v165, s34, v98
    v_lshlrev_b32 v166, 16, v99
    v_and_b32 v167, s34, v99
    v_lshlrev_b32 v168, 16, v100
    v_and_b32 v169, s34, v100
    v_lshlrev_b32 v170, 16, v101
    v_and_b32 v171, s34, v101
    v_lshlrev_b32 v172, 16, v102
    v_and_b32 v173, s34, v102
    v_lshlrev_b32 v174, 16, v103
    v_and_b32 v175, s34, v103
    v_lshlrev_b32 v176, 16, v80
    v_mul_f32 v212, v176, v160
    v_and_b32 v177, s34, v80
    v_fmac_f32 v212, v177, v161
    v_lshlrev_b32 v178, 16, v81
    v_fmac_f32 v212, v178, v162
    v_and_b32 v179, s34, v81
    v_fmac_f32 v212, v179, v163
    v_lshlrev_b32 v176, 16, v82
    v_fmac_f32 v212, v176, v164
    v_and_b32 v177, s34, v82
    v_fmac_f32 v212, v177, v165
    v_lshlrev_b32 v178, 16, v83
    v_fmac_f32 v212, v178, v166
    v_and_b32 v179, s34, v83
    v_fmac_f32 v212, v179, v167
    v_lshlrev_b32 v176, 16, v84
    v_fmac_f32 v212, v176, v168
    v_and_b32 v177, s34, v84
    v_fmac_f32 v212, v177, v169
    v_lshlrev_b32 v178, 16, v85
    v_fmac_f32 v212, v178, v170
    v_and_b32 v179, s34, v85
    v_fmac_f32 v212, v179, v171
    v_lshlrev_b32 v176, 16, v86
    v_fmac_f32 v212, v176, v172
    v_and_b32 v177, s34, v86
    v_fmac_f32 v212, v177, v173
    v_lshlrev_b32 v178, 16, v87
    v_fmac_f32 v212, v178, v174
    v_and_b32 v179, s34, v87
    v_fmac_f32 v212, v179, v175
    v_lshlrev_b32 v176, 16, v88
    v_mul_f32 v213, v176, v160
    v_and_b32 v177, s34, v88
    v_fmac_f32 v213, v177, v161
    v_lshlrev_b32 v178, 16, v89
    v_fmac_f32 v213, v178, v162
    v_and_b32 v179, s34, v89
    v_fmac_f32 v213, v179, v163
    v_lshlrev_b32 v176, 16, v90
    v_fmac_f32 v213, v176, v164
    v_and_b32 v177, s34, v90
    v_fmac_f32 v213, v177, v165
    v_lshlrev_b32 v178, 16, v91
    v_fmac_f32 v213, v178, v166
    v_and_b32 v179, s34, v91
    v_fmac_f32 v213, v179, v167
    v_lshlrev_b32 v176, 16, v92
    v_fmac_f32 v213, v176, v168
    v_and_b32 v177, s34, v92
    v_fmac_f32 v213, v177, v169
    v_lshlrev_b32 v178, 16, v93
    v_fmac_f32 v213, v178, v170
    v_and_b32 v179, s34, v93
    v_fmac_f32 v213, v179, v171
    v_lshlrev_b32 v176, 16, v94
    v_fmac_f32 v213, v176, v172
    v_and_b32 v177, s34, v94
    v_fmac_f32 v213, v177, v173
    v_lshlrev_b32 v178, 16, v95
    v_fmac_f32 v213, v178, v174
    v_and_b32 v179, s34, v95
    v_fmac_f32 v213, v179, v175
    s_nop 1
    v_add_f32_dpp v212, v212, v212 quad_perm:[1,0,3,2] row_mask:0xf bank_mask:0xf
    v_add_f32_dpp v213, v213, v213 quad_perm:[1,0,3,2] row_mask:0xf bank_mask:0xf
    s_nop 1
    v_add_f32_dpp v212, v212, v212 quad_perm:[2,3,0,1] row_mask:0xf bank_mask:0xf
    v_add_f32_dpp v213, v213, v213 quad_perm:[2,3,0,1] row_mask:0xf bank_mask:0xf
    s_nop 1
    v_add_f32_dpp v212, v212, v212 row_half_mirror row_mask:0xf bank_mask:0xf
    v_add_f32_dpp v213, v213, v213 row_half_mirror row_mask:0xf bank_mask:0xf
    s_nop 1
    v_add_f32_dpp v212, v212, v212 row_mirror row_mask:0xf bank_mask:0xf
    v_add_f32_dpp v213, v213, v213 row_mirror row_mask:0xf bank_mask:0xf
    v_mov_b32 v214, v212
    v_mov_b32 v215, v213
    s_nop 1
    v_permlane16_swap_b32 v212, v214
    v_permlane16_swap_b32 v213, v215
    s_nop 1
    v_add_f32 v212, v212, v214
    v_add_f32 v213, v213, v215
    v_mov_b32 v214, v212
    v_mov_b32 v215, v213
    s_nop 1
    v_permlane32_swap_b32 v212, v214
    v_permlane32_swap_b32 v213, v215
    s_nop 1
    v_add_f32 v212, v212, v214
    v_add_f32 v213, v213, v215
    v_cmp_eq_u32 vcc, 1, v1
    s_nop 1
    v_cndmask_b32 v212, v212, v213, vcc
    v_mul_f32 v212, 0xbfb8aa3b, v212
    v_exp_f32 v212, v212
    s_nop 0
    v_add_f32 v212, 1.0, v212
    v_rcp_f32 v212, v212
    v_lshlrev_b32 v214, 2, v1
    s_lshl_b32 s55, s55, 3
    v_cmp_gt_u32 vcc, 2, v1
    s_and_saveexec_b64 s[36:37], vcc
    buffer_store_dword v212, v214, s[8:11], s55 offen
    s_mov_b64 exec, s[36:37]
kvproj_kernel_end:
    s_endpgm

.globl attn_kernel
.p2align 8
.type attn_kernel,@function
attn_kernel:
    s_cmp_ge_u32 s2, 256
    s_cbranch_scc1 attn_kernel_end
    s_load_dwordx2 s[20:21], s[0:1], 0
    s_load_dwordx2 s[24:25], s[0:1], 64
    s_load_dwordx2 s[22:23], s[0:1], 120
    v_lshrrev_b32 v16, 6, v0
    v_and_b32 v14, 63, v0
    v_readfirstlane_b32 s40, v16
    v_lshlrev_b32 v1, 4, v14
    s_and_b32 s48, s2, 7
    s_lshl_b32 s48, s48, 2
    s_lshr_b32 s49, s2, 3
    s_and_b32 s41, s49, 3
    s_add_u32 s41, s41, s48
    s_lshr_b32 s42, s2, 5
    v_lshrrev_b32 v16, 3, v14
    v_and_b32 v17, 7, v14
    v_add_u32 v18, 0, v16
    v_lshrrev_b32 v19, 1, v18
    v_xor_b32 v19, v19, v17
    v_lshlrev_b32 v19, 4, v19
    v_lshl_add_u32 v2, v18, 13, v19
    v_add_u32 v18, 8, v16
    v_lshrrev_b32 v19, 1, v18
    v_xor_b32 v19, v19, v17
    v_lshlrev_b32 v19, 4, v19
    v_lshl_add_u32 v3, v18, 13, v19
    v_add_u32 v3, -1024, v3
    v_add_u32 v18, 0, v16
    v_lshrrev_b32 v19, 1, v18
    v_xor_b32 v19, v19, v17
    v_lshlrev_b32 v19, 4, v19
    v_lshl_add_u32 v4, v18, 13, v19
    v_add_u32 v4, 129024, v4
    v_add_u32 v18, 8, v16
    v_lshrrev_b32 v19, 1, v18
    v_xor_b32 v19, v19, v17
    v_lshlrev_b32 v19, 4, v19
    v_lshl_add_u32 v5, v18, 13, v19
    v_add_u32 v5, 128000, v5
    v_lshrrev_b32 v16, 4, v14
    v_lshlrev_b32 v17, 1, v16
    v_and_b32 v18, 15, v14
    v_xor_b32 v17, v17, v18
    v_lshlrev_b32 v17, 4, v17
    v_lshl_add_u32 v6, v16, 13, v17
    v_add_u32 v7, 31744, v6
    v_and_b32 v16, 15, v14
    v_lshrrev_b32 v17, 4, v14
    v_lshrrev_b32 v18, 1, v16
    s_lshl_b32 s48, s40, 13
    s_add_u32 s48, s48, 65536
    v_lshl_add_u32 v19, v16, 7, s48
    v_xor_b32 v20, v17, v18
    v_lshl_add_u32 v8, v20, 4, v19
    v_xor_b32 v9, 64, v8
    v_lshrrev_b32 v18, 2, v16
    v_mul_u32_u24 v20, 2176, v17
    v_lshl_add_u32 v20, v18, 8, v20
    v_and_b32 v21, 3, v16
    v_lshl_add_u32 v20, v21, 3, v20
    v_add_u32 v20, 133120, v20
    v_xor_b32 v21, 0, v18
    v_lshl_add_u32 v10, v21, 5, v20
    v_xor_b32 v21, 1, v18
    v_lshl_add_u32 v11, v21, 5, v20
    v_xor_b32 v21, 2, v18
    v_lshl_add_u32 v12, v21, 5, v20
    v_xor_b32 v21, 3, v18
    v_lshl_add_u32 v13, v21, 5, v20
    s_waitcnt lgkmcnt(0)
    s_mov_b32 s4, s20
    s_mov_b32 s5, s21
    s_mov_b32 s6, 4194304
    s_mov_b32 s7, 0x00020000
    s_mov_b32 s8, s24
    s_mov_b32 s9, s25
    s_mov_b32 s10, 8388608
    s_mov_b32 s11, 0x00020000
    s_lshl_b32 s45, s42, 7
    s_add_u32 s45, s45, s40
    s_lshl_b32 s45, s45, 11
    s_sub_u32 s44, 15, s42
    s_lshl_b32 s44, s44, 7
    s_add_u32 s44, s44, s40
    s_lshl_b32 s44, s44, 11
    s_lshl_b32 s47, s40, 16
    s_lshl_b32 s48, s41, 8
    s_add_u32 s47, s47, s48
    s_lshl_b32 s51, s40, 13
    s_add_u32 s50, s51, 4096
    s_mul_i32 s62, s40, 2176
    s_add_u32 s62, s62, 98304
    s_movk_i32 s46, 128
    s_add_u32 m0, s51, 65536
    s_nop 0
    buffer_load_dwordx4 v2, s[4:7], s45 offen offset:0 lds
    buffer_load_dwordx4 v3, s[4:7], s45 offen offset:1024 lds
    buffer_load_dwordx4 v4, s[4:7], s45 offen offset:2048 lds
    buffer_load_dwordx4 v5, s[4:7], s45 offen offset:3072 lds
    s_add_u32 m0, s62, 34816
    s_add_u32 s45, s45, 128
    buffer_load_dwordx4 v6, s[8:11], s47 offen offset:0 lds
    buffer_load_dwordx4 v7, s[8:11], s47 offen offset:1024 lds
    s_add_u32 s47, s47, 262144
    s_add_u32 m0, s50, 65536
    s_nop 0
    buffer_load_dwordx4 v2, s[4:7], s44 offen offset:0 lds
    buffer_load_dwordx4 v3, s[4:7], s44 offen offset:1024 lds
    buffer_load_dwordx4 v4, s[4:7], s44 offen offset:2048 lds
    buffer_load_dwordx4 v5, s[4:7], s44 offen offset:3072 lds
    s_add_u32 m0, s62, 43520
    s_add_u32 s44, s44, 128
    buffer_load_dwordx4 v6, s[8:11], s47 offen offset:0 lds
    buffer_load_dwordx4 v7, s[8:11], s47 offen offset:1024 lds
    s_add_u32 s47, s47, 262144
    s_add_u32 m0, s51, 0
    s_nop 0
    buffer_load_dwordx4 v2, s[4:7], s45 offen offset:0 lds
    buffer_load_dwordx4 v3, s[4:7], s45 offen offset:1024 lds
    buffer_load_dwordx4 v4, s[4:7], s45 offen offset:2048 lds
    buffer_load_dwordx4 v5, s[4:7], s45 offen offset:3072 lds
    s_add_u32 m0, s62, 0
    s_add_u32 s45, s45, 128
    buffer_load_dwordx4 v6, s[8:11], s47 offen offset:0 lds
    buffer_load_dwordx4 v7, s[8:11], s47 offen offset:1024 lds
    s_add_u32 s47, s47, 262144
    s_add_u32 m0, s50, 0
    s_nop 0
    buffer_load_dwordx4 v2, s[4:7], s44 offen offset:0 lds
    buffer_load_dwordx4 v3, s[4:7], s44 offen offset:1024 lds
    buffer_load_dwordx4 v4, s[4:7], s44 offen offset:2048 lds
    buffer_load_dwordx4 v5, s[4:7], s44 offen offset:3072 lds
    s_add_u32 m0, s62, 8704
    s_add_u32 s44, s44, 128
    buffer_load_dwordx4 v6, s[8:11], s47 offen offset:0 lds
    buffer_load_dwordx4 v7, s[8:11], s47 offen offset:1024 lds
    s_add_u32 s47, s47, 262144
    s_add_u32 m0, s51, 32768
    s_nop 0
    buffer_load_dwordx4 v2, s[4:7], s45 offen offset:0 lds
    buffer_load_dwordx4 v3, s[4:7], s45 offen offset:1024 lds
    buffer_load_dwordx4 v4, s[4:7], s45 offen offset:2048 lds
    buffer_load_dwordx4 v5, s[4:7], s45 offen offset:3072 lds
    s_add_u32 m0, s62, 17408
    s_add_u32 s45, s45, 128
    buffer_load_dwordx4 v6, s[8:11], s47 offen offset:0 lds
    buffer_load_dwordx4 v7, s[8:11], s47 offen offset:1024 lds
    s_add_u32 s47, s47, 262144
    s_mov_b32 s63, 32768
    s_mov_b32 s64, 17408
    s_mov_b32 s43, 0
    s_mov_b32 s38, 32768
    s_mov_b32 s39, 17408
    s_lshl_b32 s48, s41, 20
    s_add_u32 s12, s22, s48
    s_addc_u32 s13, s23, 0
    s_lshl_b32 s48, s42, 16
    s_sub_u32 s14, 1048576, s48
    s_mov_b32 s15, 0x00020000
    s_add_u32 s16, s22, 33554432
    s_addc_u32 s17, s23, 0
    s_mov_b32 s18, 16777216
    s_mov_b32 s19, 0x00020000
    s_lshl_b32 s48, s42, 3
    s_add_u32 s48, s48, 0
    s_add_u32 s48, s48, s40
    s_lshl_b32 s48, s48, 5
    s_add_u32 s48, s48, s41
    s_lshl_b32 s68, s48, 12
    s_lshl_b32 s48, s42, 3
    s_add_u32 s48, s48, 4
    s_add_u32 s48, s48, s40
    s_lshl_b32 s48, s48, 5
    s_add_u32 s48, s48, s41
    s_lshl_b32 s69, s48, 12
    s_lshl_b32 s48, s42, 3
    s_sub_u32 s48, 120, s48
    s_add_u32 s48, s48, s40
    s_lshl_b32 s48, s48, 5
    s_add_u32 s48, s48, s41
    s_lshl_b32 s70, s48, 12
    s_lshl_b32 s48, s42, 3
    s_sub_u32 s48, 124, s48
    s_add_u32 s48, s48, s40
    s_lshl_b32 s48, s48, 5
    s_add_u32 s48, s48, s41
    s_lshl_b32 s71, s48, 12
    v_accvgpr_write_b32 a0, 0
    v_accvgpr_write_b32 a1, 0
    v_accvgpr_write_b32 a2, 0
    v_accvgpr_write_b32 a3, 0
    v_accvgpr_write_b32 a4, 0
    v_accvgpr_write_b32 a5, 0
    v_accvgpr_write_b32 a6, 0
    v_accvgpr_write_b32 a7, 0
    v_accvgpr_write_b32 a8, 0
    v_accvgpr_write_b32 a9, 0
    v_accvgpr_write_b32 a10, 0
    v_accvgpr_write_b32 a11, 0
    v_accvgpr_write_b32 a12, 0
    v_accvgpr_write_b32 a13, 0
    v_accvgpr_write_b32 a14, 0
    v_accvgpr_write_b32 a15, 0
    v_accvgpr_write_b32 a16, 0
    v_accvgpr_write_b32 a17, 0
    v_accvgpr_write_b32 a18, 0
    v_accvgpr_write_b32 a19, 0
    v_accvgpr_write_b32 a20, 0
    v_accvgpr_write_b32 a21, 0
    v_accvgpr_write_b32 a22, 0
    v_accvgpr_write_b32 a23, 0
    v_accvgpr_write_b32 a24, 0
    v_accvgpr_write_b32 a25, 0
    v_accvgpr_write_b32 a26, 0
    v_accvgpr_write_b32 a27, 0
    v_accvgpr_write_b32 a28, 0
    v_accvgpr_write_b32 a29, 0
    v_accvgpr_write_b32 a30, 0
    v_accvgpr_write_b32 a31, 0
    v_accvgpr_write_b32 a32, 0
    v_accvgpr_write_b32 a33, 0
    v_accvgpr_write_b32 a34, 0
    v_accvgpr_write_b32 a35, 0
    v_accvgpr_write_b32 a36, 0
    v_accvgpr_write_b32 a37, 0
    v_accvgpr_write_b32 a38, 0
    v_accvgpr_write_b32 a39, 0
    v_accvgpr_write_b32 a40, 0
    v_accvgpr_write_b32 a41, 0
    v_accvgpr_write_b32 a42, 0
    v_accvgpr_write_b32 a43, 0
    v_accvgpr_write_b32 a44, 0
    v_accvgpr_write_b32 a45, 0
    v_accvgpr_write_b32 a46, 0
    v_accvgpr_write_b32 a47, 0
    v_accvgpr_write_b32 a48, 0
    v_accvgpr_write_b32 a49, 0
    v_accvgpr_write_b32 a50, 0
    v_accvgpr_write_b32 a51, 0
    v_accvgpr_write_b32 a52, 0
    v_accvgpr_write_b32 a53, 0
    v_accvgpr_write_b32 a54, 0
    v_accvgpr_write_b32 a55, 0
    v_accvgpr_write_b32 a56, 0
    v_accvgpr_write_b32 a57, 0
    v_accvgpr_write_b32 a58, 0
    v_accvgpr_write_b32 a59, 0
    v_accvgpr_write_b32 a60, 0
    v_accvgpr_write_b32 a61, 0
    v_accvgpr_write_b32 a62, 0
    v_accvgpr_write_b32 a63, 0
    v_accvgpr_write_b32 a64, 0
    v_accvgpr_write_b32 a65, 0
    v_accvgpr_write_b32 a66, 0
    v_accvgpr_write_b32 a67, 0
    v_accvgpr_write_b32 a68, 0
    v_accvgpr_write_b32 a69, 0
    v_accvgpr_write_b32 a70, 0
    v_accvgpr_write_b32 a71, 0
    v_accvgpr_write_b32 a72, 0
    v_accvgpr_write_b32 a73, 0
    v_accvgpr_write_b32 a74, 0
    v_accvgpr_write_b32 a75, 0
    v_accvgpr_write_b32 a76, 0
    v_accvgpr_write_b32 a77, 0
    v_accvgpr_write_b32 a78, 0
    v_accvgpr_write_b32 a79, 0
    v_accvgpr_write_b32 a80, 0
    v_accvgpr_write_b32 a81, 0
    v_accvgpr_write_b32 a82, 0
    v_accvgpr_write_b32 a83, 0
    v_accvgpr_write_b32 a84, 0
    v_accvgpr_write_b32 a85, 0
    v_accvgpr_write_b32 a86, 0
    v_accvgpr_write_b32 a87, 0
    v_accvgpr_write_b32 a88, 0
    v_accvgpr_write_b32 a89, 0
    v_accvgpr_write_b32 a90, 0
    v_accvgpr_write_b32 a91, 0
    v_accvgpr_write_b32 a92, 0
    v_accvgpr_write_b32 a93, 0
    v_accvgpr_write_b32 a94, 0
    v_accvgpr_write_b32 a95, 0
    v_accvgpr_write_b32 a96, 0
    v_accvgpr_write_b32 a97, 0
    v_accvgpr_write_b32 a98, 0
    v_accvgpr_write_b32 a99, 0
    v_accvgpr_write_b32 a100, 0
    v_accvgpr_write_b32 a101, 0
    v_accvgpr_write_b32 a102, 0
    v_accvgpr_write_b32 a103, 0
    v_accvgpr_write_b32 a104, 0
    v_accvgpr_write_b32 a105, 0
    v_accvgpr_write_b32 a106, 0
    v_accvgpr_write_b32 a107, 0
    v_accvgpr_write_b32 a108, 0
    v_accvgpr_write_b32 a109, 0
    v_accvgpr_write_b32 a110, 0
    v_accvgpr_write_b32 a111, 0
    v_accvgpr_write_b32 a112, 0
    v_accvgpr_write_b32 a113, 0
    v_accvgpr_write_b32 a114, 0
    v_accvgpr_write_b32 a115, 0
    v_accvgpr_write_b32 a116, 0
    v_accvgpr_write_b32 a117, 0
    v_accvgpr_write_b32 a118, 0
    v_accvgpr_write_b32 a119, 0
    v_accvgpr_write_b32 a120, 0
    v_accvgpr_write_b32 a121, 0
    v_accvgpr_write_b32 a122, 0
    v_accvgpr_write_b32 a123, 0
    v_accvgpr_write_b32 a124, 0
    v_accvgpr_write_b32 a125, 0
    v_accvgpr_write_b32 a126, 0
    v_accvgpr_write_b32 a127, 0
    v_mov_b32 v128, 0
    v_mov_b32 v129, 0
    v_mov_b32 v130, 0
    v_mov_b32 v131, 0
    v_mov_b32 v132, 0
    v_mov_b32 v133, 0
    v_mov_b32 v134, 0
    v_mov_b32 v135, 0
    v_mov_b32 v136, 0
    v_mov_b32 v137, 0
    v_mov_b32 v138, 0
    v_mov_b32 v139, 0
    v_mov_b32 v140, 0
    v_mov_b32 v141, 0
    v_mov_b32 v142, 0
    v_mov_b32 v143, 0
    v_mov_b32 v144, 0
    v_mov_b32 v145, 0
    v_mov_b32 v146, 0
    v_mov_b32 v147, 0
    v_mov_b32 v148, 0
    v_mov_b32 v149, 0
    v_mov_b32 v150, 0
    v_mov_b32 v151, 0
    v_mov_b32 v152, 0
    v_mov_b32 v153, 0
    v_mov_b32 v154, 0
    v_mov_b32 v155, 0
    v_mov_b32 v156, 0
    v_mov_b32 v157, 0
    v_mov_b32 v158, 0
    v_mov_b32 v159, 0
    v_mov_b32 v160, 0
    v_mov_b32 v161, 0
    v_mov_b32 v162, 0
    v_mov_b32 v163, 0
    v_mov_b32 v164, 0
    v_mov_b32 v165, 0
    v_mov_b32 v166, 0
    v_mov_b32 v167, 0
    v_mov_b32 v168, 0
    v_mov_b32 v169, 0
    v_mov_b32 v170, 0
    v_mov_b32 v171, 0
    v_mov_b32 v172, 0
    v_mov_b32 v173, 0
    v_mov_b32 v174, 0
    v_mov_b32 v175, 0
    v_mov_b32 v176, 0
    v_mov_b32 v177, 0
    v_mov_b32 v178, 0
    v_mov_b32 v179, 0
    v_mov_b32 v180, 0
    v_mov_b32 v181, 0
    v_mov_b32 v182, 0
    v_mov_b32 v183, 0
    v_mov_b32 v184, 0
    v_mov_b32 v185, 0
    v_mov_b32 v186, 0
    v_mov_b32 v187, 0
    v_mov_b32 v188, 0
    v_mov_b32 v189, 0
    v_mov_b32 v190, 0
    v_mov_b32 v191, 0
    v_mov_b32 v192, 0
    v_mov_b32 v193, 0
    v_mov_b32 v194, 0
    v_mov_b32 v195, 0
    v_mov_b32 v196, 0
    v_mov_b32 v197, 0
    v_mov_b32 v198, 0
    v_mov_b32 v199, 0
    v_mov_b32 v200, 0
    v_mov_b32 v201, 0
    v_mov_b32 v202, 0
    v_mov_b32 v203, 0
    v_mov_b32 v204, 0
    v_mov_b32 v205, 0
    v_mov_b32 v206, 0
    v_mov_b32 v207, 0
    v_mov_b32 v208, 0
    v_mov_b32 v209, 0
    v_mov_b32 v210, 0
    v_mov_b32 v211, 0
    v_mov_b32 v212, 0
    v_mov_b32 v213, 0
    v_mov_b32 v214, 0
    v_mov_b32 v215, 0
    v_mov_b32 v216, 0
    v_mov_b32 v217, 0
    v_mov_b32 v218, 0
    v_mov_b32 v219, 0
    v_mov_b32 v220, 0
    v_mov_b32 v221, 0
    v_mov_b32 v222, 0
    v_mov_b32 v223, 0
    v_mov_b32 v224, 0
    v_mov_b32 v225, 0
    v_mov_b32 v226, 0
    v_mov_b32 v227, 0
    v_mov_b32 v228, 0
    v_mov_b32 v229, 0
    v_mov_b32 v230, 0
    v_mov_b32 v231, 0
    v_mov_b32 v232, 0
    v_mov_b32 v233, 0
    v_mov_b32 v234, 0
    v_mov_b32 v235, 0
    v_mov_b32 v236, 0
    v_mov_b32 v237, 0
    v_mov_b32 v238, 0
    v_mov_b32 v239, 0
    v_mov_b32 v240, 0
    v_mov_b32 v241, 0
    v_mov_b32 v242, 0
    v_mov_b32 v243, 0
    v_mov_b32 v244, 0
    v_mov_b32 v245, 0
    v_mov_b32 v246, 0
    v_mov_b32 v247, 0
    v_mov_b32 v248, 0
    v_mov_b32 v249, 0
    v_mov_b32 v250, 0
    v_mov_b32 v251, 0
    v_mov_b32 v252, 0
    v_mov_b32 v253, 0
    v_mov_b32 v254, 0
    v_mov_b32 v255, 0
    s_waitcnt vmcnt(18)
    s_barrier
    ds_read_b64_tr_b16 v[48:49], v10 offset:0
    ds_read_b64_tr_b16 v[50:51], v10 offset:1024
    ds_read_b128 v[32:35], v8 offset:0
    ds_read_b128 v[36:39], v8 offset:2048
    ds_read_b128 v[40:43], v8 offset:4096
    ds_read_b128 v[44:47], v8 offset:6144
    ds_read_b64_tr_b16 v[52:53], v11 offset:0
    ds_read_b64_tr_b16 v[54:55], v11 offset:1024
    ds_read_b64_tr_b16 v[56:57], v12 offset:0
    ds_read_b64_tr_b16 v[58:59], v12 offset:1024
    ds_read_b64_tr_b16 v[60:61], v13 offset:0
    ds_read_b64_tr_b16 v[62:63], v13 offset:1024
    ds_read_b64_tr_b16 v[64:65], v10 offset:128
    ds_read_b64_tr_b16 v[66:67], v10 offset:1152
    ds_read_b64_tr_b16 v[68:69], v11 offset:128
    ds_read_b64_tr_b16 v[70:71], v11 offset:1152
    ds_read_b64_tr_b16 v[72:73], v12 offset:128
    ds_read_b64_tr_b16 v[74:75], v12 offset:1152
    ds_read_b64_tr_b16 v[76:77], v13 offset:128
    ds_read_b64_tr_b16 v[78:79], v13 offset:1152
    s_waitcnt lgkmcnt(0)
.p2align 6
attn_kernel_qloop:
    v_mfma_f32_16x16x32_bf16 v[128:131], v[48:51], v[32:35], v[128:131]
    ds_read_b64_tr_b16 v[96:97], v10 offset:8704
    v_mfma_f32_16x16x32_bf16 v[160:163], v[48:51], v[36:39], v[160:163]
    ds_read_b64_tr_b16 v[98:99], v10 offset:9728
    s_add_u32 m0, s63, s50
    v_mfma_f32_16x16x32_bf16 v[192:195], v[48:51], v[40:43], v[192:195]
    ds_read_b128 v[80:83], v9 offset:0
    v_mfma_f32_16x16x32_bf16 v[224:227], v[48:51], v[44:47], v[224:227]
    buffer_load_dwordx4 v2, s[4:7], s44 offen offset:0 lds
    v_mfma_f32_16x16x32_bf16 v[132:135], v[52:55], v[32:35], v[132:135]
    ds_read_b128 v[84:87], v9 offset:2048
    v_mfma_f32_16x16x32_bf16 v[164:167], v[52:55], v[36:39], v[164:167]
    ds_read_b128 v[88:91], v9 offset:4096
    v_mfma_f32_16x16x32_bf16 v[196:199], v[52:55], v[40:43], v[196:199]
    ds_read_b128 v[92:95], v9 offset:6144
    v_mfma_f32_16x16x32_bf16 v[228:231], v[52:55], v[44:47], v[228:231]
    buffer_load_dwordx4 v3, s[4:7], s44 offen offset:1024 lds
    v_mfma_f32_16x16x32_bf16 v[136:139], v[56:59], v[32:35], v[136:139]
    ds_read_b64_tr_b16 v[100:101], v11 offset:8704
    v_mfma_f32_16x16x32_bf16 v[168:171], v[56:59], v[36:39], v[168:171]
    ds_read_b64_tr_b16 v[102:103], v11 offset:9728
    v_mfma_f32_16x16x32_bf16 v[200:203], v[56:59], v[40:43], v[200:203]
    ds_read_b64_tr_b16 v[104:105], v12 offset:8704
    v_mfma_f32_16x16x32_bf16 v[232:235], v[56:59], v[44:47], v[232:235]
    buffer_load_dwordx4 v4, s[4:7], s44 offen offset:2048 lds
    v_mfma_f32_16x16x32_bf16 v[140:143], v[60:63], v[32:35], v[140:143]
    ds_read_b64_tr_b16 v[106:107], v12 offset:9728
    v_mfma_f32_16x16x32_bf16 v[172:175], v[60:63], v[36:39], v[172:175]
    ds_read_b64_tr_b16 v[108:109], v13 offset:8704
    v_mfma_f32_16x16x32_bf16 v[204:207], v[60:63], v[40:43], v[204:207]
    ds_read_b64_tr_b16 v[110:111], v13 offset:9728
    v_mfma_f32_16x16x32_bf16 v[236:239], v[60:63], v[44:47], v[236:239]
    buffer_load_dwordx4 v5, s[4:7], s44 offen offset:3072 lds
    v_mfma_f32_16x16x32_bf16 v[144:147], v[64:67], v[32:35], v[144:147]
    ds_read_b64_tr_b16 v[112:113], v10 offset:8832
    s_add_u32 s48, s64, s62
    v_mfma_f32_16x16x32_bf16 v[176:179], v[64:67], v[36:39], v[176:179]
    ds_read_b64_tr_b16 v[114:115], v10 offset:9856
    s_add_u32 m0, s48, 8704
    v_mfma_f32_16x16x32_bf16 v[208:211], v[64:67], v[40:43], v[208:211]
    ds_read_b64_tr_b16 v[116:117], v11 offset:8832
    s_add_u32 s44, s44, s46
    v_mfma_f32_16x16x32_bf16 v[240:243], v[64:67], v[44:47], v[240:243]
    buffer_load_dwordx4 v6, s[8:11], s47 offen offset:0 lds
    v_mfma_f32_16x16x32_bf16 v[148:151], v[68:71], v[32:35], v[148:151]
    ds_read_b64_tr_b16 v[118:119], v11 offset:9856
    v_mfma_f32_16x16x32_bf16 v[180:183], v[68:71], v[36:39], v[180:183]
    ds_read_b64_tr_b16 v[120:121], v12 offset:8832
    v_mfma_f32_16x16x32_bf16 v[212:215], v[68:71], v[40:43], v[212:215]
    ds_read_b64_tr_b16 v[122:123], v12 offset:9856
    v_mfma_f32_16x16x32_bf16 v[244:247], v[68:71], v[44:47], v[244:247]
    buffer_load_dwordx4 v7, s[8:11], s47 offen offset:1024 lds
    v_mfma_f32_16x16x32_bf16 v[152:155], v[72:75], v[32:35], v[152:155]
    ds_read_b64_tr_b16 v[124:125], v13 offset:8832
    s_add_u32 s47, s47, 262144
    v_mfma_f32_16x16x32_bf16 v[184:187], v[72:75], v[36:39], v[184:187]
    ds_read_b64_tr_b16 v[126:127], v13 offset:9856
    s_add_u32 s63, s63, 32768
    s_cmp_eq_u32 s63, 98304
    v_mfma_f32_16x16x32_bf16 v[216:219], v[72:75], v[40:43], v[216:219]
    s_cselect_b32 s63, 0, s63
    s_cmp_eq_u32 s63, 65536
    v_mfma_f32_16x16x32_bf16 v[248:251], v[72:75], v[44:47], v[248:251]
    s_cselect_b32 s65, 4294901760, s38
    s_cselect_b32 s66, 4294932480, s39
    v_mfma_f32_16x16x32_bf16 v[156:159], v[76:79], v[32:35], v[156:159]
    s_lshr_b32 s48, s63, 15
    v_add_u32 v8, s65, v8
    v_add_u32 v9, s65, v9
    v_mfma_f32_16x16x32_bf16 v[188:191], v[76:79], v[36:39], v[188:191]
    s_mul_i32 s64, s48, 17408
    v_add_u32 v10, s66, v10
    v_add_u32 v11, s66, v11
    v_mfma_f32_16x16x32_bf16 v[220:223], v[76:79], v[40:43], v[220:223]
    s_cmp_eq_u32 s43, 13
    v_add_u32 v12, s66, v12
    v_add_u32 v13, s66, v13
    v_mfma_f32_16x16x32_bf16 v[252:255], v[76:79], v[44:47], v[252:255]
    s_cbranch_scc1 attn_kernel_switch
attn_kernel_switch_ret:
    s_waitcnt vmcnt(12) lgkmcnt(0)
    s_barrier
    v_mfma_f32_16x16x32_bf16 v[128:131], v[96:99], v[80:83], v[128:131]
    ds_read_b64_tr_b16 v[48:49], v10 offset:0
    v_mfma_f32_16x16x32_bf16 v[160:163], v[96:99], v[84:87], v[160:163]
    ds_read_b64_tr_b16 v[50:51], v10 offset:1024
    s_add_u32 m0, s63, s51
    v_mfma_f32_16x16x32_bf16 v[192:195], v[96:99], v[88:91], v[192:195]
    ds_read_b128 v[32:35], v8 offset:0
    v_mfma_f32_16x16x32_bf16 v[224:227], v[96:99], v[92:95], v[224:227]
    buffer_load_dwordx4 v2, s[4:7], s45 offen offset:0 lds
    v_mfma_f32_16x16x32_bf16 v[132:135], v[100:103], v[80:83], v[132:135]
    ds_read_b128 v[36:39], v8 offset:2048
    v_mfma_f32_16x16x32_bf16 v[164:167], v[100:103], v[84:87], v[164:167]
    ds_read_b128 v[40:43], v8 offset:4096
    v_mfma_f32_16x16x32_bf16 v[196:199], v[100:103], v[88:91], v[196:199]
    ds_read_b128 v[44:47], v8 offset:6144
    v_mfma_f32_16x16x32_bf16 v[228:231], v[100:103], v[92:95], v[228:231]
    buffer_load_dwordx4 v3, s[4:7], s45 offen offset:1024 lds
    v_mfma_f32_16x16x32_bf16 v[136:139], v[104:107], v[80:83], v[136:139]
    ds_read_b64_tr_b16 v[52:53], v11 offset:0
    v_mfma_f32_16x16x32_bf16 v[168:171], v[104:107], v[84:87], v[168:171]
    ds_read_b64_tr_b16 v[54:55], v11 offset:1024
    v_mfma_f32_16x16x32_bf16 v[200:203], v[104:107], v[88:91], v[200:203]
    ds_read_b64_tr_b16 v[56:57], v12 offset:0
    v_mfma_f32_16x16x32_bf16 v[232:235], v[104:107], v[92:95], v[232:235]
    buffer_load_dwordx4 v4, s[4:7], s45 offen offset:2048 lds
    v_mfma_f32_16x16x32_bf16 v[140:143], v[108:111], v[80:83], v[140:143]
    ds_read_b64_tr_b16 v[58:59], v12 offset:1024
    v_mfma_f32_16x16x32_bf16 v[172:175], v[108:111], v[84:87], v[172:175]
    ds_read_b64_tr_b16 v[60:61], v13 offset:0
    v_mfma_f32_16x16x32_bf16 v[204:207], v[108:111], v[88:91], v[204:207]
    ds_read_b64_tr_b16 v[62:63], v13 offset:1024
    v_mfma_f32_16x16x32_bf16 v[236:239], v[108:111], v[92:95], v[236:239]
    buffer_load_dwordx4 v5, s[4:7], s45 offen offset:3072 lds
    v_mfma_f32_16x16x32_bf16 v[144:147], v[112:115], v[80:83], v[144:147]
    ds_read_b64_tr_b16 v[64:65], v10 offset:128
    s_add_u32 s48, s64, s62
    v_mfma_f32_16x16x32_bf16 v[176:179], v[112:115], v[84:87], v[176:179]
    ds_read_b64_tr_b16 v[66:67], v10 offset:1152
    s_mov_b32 m0, s48
    v_mfma_f32_16x16x32_bf16 v[208:211], v[112:115], v[88:91], v[208:211]
    ds_read_b64_tr_b16 v[68:69], v11 offset:128
    s_add_u32 s45, s45, s46
    v_mfma_f32_16x16x32_bf16 v[240:243], v[112:115], v[92:95], v[240:243]
    buffer_load_dwordx4 v6, s[8:11], s47 offen offset:0 lds
    v_mfma_f32_16x16x32_bf16 v[148:151], v[116:119], v[80:83], v[148:151]
    ds_read_b64_tr_b16 v[70:71], v11 offset:1152
    v_mfma_f32_16x16x32_bf16 v[180:183], v[116:119], v[84:87], v[180:183]
    ds_read_b64_tr_b16 v[72:73], v12 offset:128
    v_mfma_f32_16x16x32_bf16 v[212:215], v[116:119], v[88:91], v[212:215]
    ds_read_b64_tr_b16 v[74:75], v12 offset:1152
    v_mfma_f32_16x16x32_bf16 v[244:247], v[116:119], v[92:95], v[244:247]
    buffer_load_dwordx4 v7, s[8:11], s47 offen offset:1024 lds
    v_mfma_f32_16x16x32_bf16 v[152:155], v[120:123], v[80:83], v[152:155]
    ds_read_b64_tr_b16 v[76:77], v13 offset:128
    s_add_u32 s47, s47, 262144
    v_mfma_f32_16x16x32_bf16 v[184:187], v[120:123], v[84:87], v[184:187]
    ds_read_b64_tr_b16 v[78:79], v13 offset:1152
    v_mfma_f32_16x16x32_bf16 v[216:219], v[120:123], v[88:91], v[216:219]
    v_mfma_f32_16x16x32_bf16 v[248:251], v[120:123], v[92:95], v[248:251]
    v_mfma_f32_16x16x32_bf16 v[156:159], v[124:127], v[80:83], v[156:159]
    v_mfma_f32_16x16x32_bf16 v[188:191], v[124:127], v[84:87], v[188:191]
    s_add_u32 s43, s43, 1
    s_cmp_lg_u32 s43, 16
    v_mfma_f32_16x16x32_bf16 v[220:223], v[124:127], v[88:91], v[220:223]
    v_mfma_f32_16x16x32_bf16 v[252:255], v[124:127], v[92:95], v[252:255]
    s_waitcnt lgkmcnt(0)
    s_cbranch_scc1 attn_kernel_qloop
    s_lshl_b32 s58, s40, 12
    s_add_u32 m0, s58, 81920
    s_add_u32 s52, s58, 81920
    buffer_load_dwordx4 v1, s[12:15], s52 offen offset:0 lds
    buffer_load_dwordx4 v1, s[12:15], s52 offen offset:1024 lds
    buffer_load_dwordx4 v1, s[12:15], s52 offen offset:2048 lds
    buffer_load_dwordx4 v1, s[12:15], s52 offen offset:3072 lds
    s_add_u32 m0, s58, 98304
    s_add_u32 s52, s58, 98304
    buffer_load_dwordx4 v1, s[12:15], s52 offen offset:0 lds
    buffer_load_dwordx4 v1, s[12:15], s52 offen offset:1024 lds
    buffer_load_dwordx4 v1, s[12:15], s52 offen offset:2048 lds
    buffer_load_dwordx4 v1, s[12:15], s52 offen offset:3072 lds
    s_add_u32 m0, s58, 114688
    s_add_u32 s52, s58, 114688
    buffer_load_dwordx4 v1, s[12:15], s52 offen offset:0 lds
    buffer_load_dwordx4 v1, s[12:15], s52 offen offset:1024 lds
    buffer_load_dwordx4 v1, s[12:15], s52 offen offset:2048 lds
    buffer_load_dwordx4 v1, s[12:15], s52 offen offset:3072 lds
    s_add_u32 s52, s52, 16384
    s_mov_b32 s56, 0x40004000
    s_mov_b32 s53, 0
    s_mov_b32 s59, 32768
    s_add_u32 s54, s58, 131072
    s_add_u32 s55, s54, 16384
    v_mov_b32 v2, v1
    v_mov_b32 v3, v1
    v_cvt_pk_bf16_f32 v32, v128, v129
    v_cvt_pk_bf16_f32 v33, v130, v131
    v_cvt_pk_bf16_f32 v34, v132, v133
    v_cvt_pk_bf16_f32 v35, v134, v135
    v_cvt_pk_bf16_f32 v36, v136, v137
    v_cvt_pk_bf16_f32 v37, v138, v139
    v_cvt_pk_bf16_f32 v38, v140, v141
    v_cvt_pk_bf16_f32 v39, v142, v143
    v_cvt_pk_bf16_f32 v40, v144, v145
    v_cvt_pk_bf16_f32 v41, v146, v147
    v_cvt_pk_bf16_f32 v42, v148, v149
    v_cvt_pk_bf16_f32 v43, v150, v151
    v_cvt_pk_bf16_f32 v44, v152, v153
    v_cvt_pk_bf16_f32 v45, v154, v155
    v_cvt_pk_bf16_f32 v46, v156, v157
    v_cvt_pk_bf16_f32 v47, v158, v159
    v_cvt_pk_bf16_f32 v48, v160, v161
    v_cvt_pk_bf16_f32 v49, v162, v163
    v_cvt_pk_bf16_f32 v50, v164, v165
    v_cvt_pk_bf16_f32 v51, v166, v167
    v_cvt_pk_bf16_f32 v52, v168, v169
    v_cvt_pk_bf16_f32 v53, v170, v171
    v_cvt_pk_bf16_f32 v54, v172, v173
    v_cvt_pk_bf16_f32 v55, v174, v175
    v_cvt_pk_bf16_f32 v56, v176, v177
    v_cvt_pk_bf16_f32 v57, v178, v179
    v_cvt_pk_bf16_f32 v58, v180, v181
    v_cvt_pk_bf16_f32 v59, v182, v183
    v_cvt_pk_bf16_f32 v60, v184, v185
    v_cvt_pk_bf16_f32 v61, v186, v187
    v_cvt_pk_bf16_f32 v62, v188, v189
    v_cvt_pk_bf16_f32 v63, v190, v191
    v_cvt_pk_bf16_f32 v64, v192, v193
    v_cvt_pk_bf16_f32 v65, v194, v195
    v_cvt_pk_bf16_f32 v66, v196, v197
    v_cvt_pk_bf16_f32 v67, v198, v199
    v_cvt_pk_bf16_f32 v68, v200, v201
    v_cvt_pk_bf16_f32 v69, v202, v203
    v_cvt_pk_bf16_f32 v70, v204, v205
    v_cvt_pk_bf16_f32 v71, v206, v207
    v_cvt_pk_bf16_f32 v72, v208, v209
    v_cvt_pk_bf16_f32 v73, v210, v211
    v_cvt_pk_bf16_f32 v74, v212, v213
    v_cvt_pk_bf16_f32 v75, v214, v215
    v_cvt_pk_bf16_f32 v76, v216, v217
    v_cvt_pk_bf16_f32 v77, v218, v219
    v_cvt_pk_bf16_f32 v78, v220, v221
    v_cvt_pk_bf16_f32 v79, v222, v223
    v_cvt_pk_bf16_f32 v80, v224, v225
    v_cvt_pk_bf16_f32 v81, v226, v227
    v_cvt_pk_bf16_f32 v82, v228, v229
    v_cvt_pk_bf16_f32 v83, v230, v231
    v_cvt_pk_bf16_f32 v84, v232, v233
    v_cvt_pk_bf16_f32 v85, v234, v235
    v_cvt_pk_bf16_f32 v86, v236, v237
    v_cvt_pk_bf16_f32 v87, v238, v239
    v_cvt_pk_bf16_f32 v88, v240, v241
    v_cvt_pk_bf16_f32 v89, v242, v243
    v_cvt_pk_bf16_f32 v90, v244, v245
    v_cvt_pk_bf16_f32 v91, v246, v247
    v_cvt_pk_bf16_f32 v92, v248, v249
    v_cvt_pk_bf16_f32 v93, v250, v251
    v_cvt_pk_bf16_f32 v94, v252, v253
    v_cvt_pk_bf16_f32 v95, v254, v255
    s_waitcnt vmcnt(18)
    s_barrier
    ds_read_b128 a[128:131], v2 offset:0
    ds_read_b128 a[132:135], v2 offset:1024
    ds_read_b128 a[136:139], v2 offset:2048
    ds_read_b128 a[140:143], v2 offset:3072
    ds_read_b128 a[144:147], v2 offset:4096
    ds_read_b128 a[148:151], v2 offset:5120
    ds_read_b128 a[152:155], v2 offset:6144
    ds_read_b128 a[156:159], v2 offset:7168
    v_and_b32 v248, 15, v14
    v_lshrrev_b32 v249, 4, v14
    v_sub_u32 v248, v248, v249
    v_lshl_add_u32 v248, v248, 2, s40
    v_mov_b32 v249, 0xff000000
    v_cmp_gt_i32 s[72:73], 0, v248
    v_cmp_gt_i32 s[74:75], 1, v248
    v_cmp_gt_i32 s[76:77], 2, v248
    v_cmp_gt_i32 s[78:79], 3, v248
    v_cndmask_b32 v96, 0, v249, s[72:73]
    v_cndmask_b32 v97, 0, v249, s[74:75]
    v_cndmask_b32 v98, 0, v249, s[76:77]
    v_cndmask_b32 v99, 0, v249, s[78:79]
    v_cmp_gt_i32 s[72:73], 16, v248
    v_cmp_gt_i32 s[74:75], 17, v248
    v_cmp_gt_i32 s[76:77], 18, v248
    v_cmp_gt_i32 s[78:79], 19, v248
    v_cndmask_b32 v100, 0, v249, s[72:73]
    v_cndmask_b32 v101, 0, v249, s[74:75]
    v_cndmask_b32 v102, 0, v249, s[76:77]
    v_cndmask_b32 v103, 0, v249, s[78:79]
    v_cmp_gt_i32 s[72:73], 32, v248
    v_cmp_gt_i32 s[74:75], 33, v248
    v_cmp_gt_i32 s[76:77], 34, v248
    v_cmp_gt_i32 s[78:79], 35, v248
    v_cndmask_b32 v104, 0, v249, s[72:73]
    v_cndmask_b32 v105, 0, v249, s[74:75]
    v_cndmask_b32 v106, 0, v249, s[76:77]
    v_cndmask_b32 v107, 0, v249, s[78:79]
    v_cmp_gt_i32 s[72:73], 48, v248
    v_cmp_gt_i32 s[74:75], 49, v248
    v_cmp_gt_i32 s[76:77], 50, v248
    v_cmp_gt_i32 s[78:79], 51, v248
    v_cndmask_b32 v108, 0, v249, s[72:73]
    v_cndmask_b32 v109, 0, v249, s[74:75]
    v_cndmask_b32 v110, 0, v249, s[76:77]
    v_cndmask_b32 v111, 0, v249, s[78:79]
    v_mov_b32 v224, 0
    v_mov_b32 v225, 0
    v_mov_b32 v226, 0
    v_mov_b32 v227, 0
    v_mov_b32 v228, 0
    v_mov_b32 v229, 0
    v_mov_b32 v230, 0
    v_mov_b32 v231, 0
    v_mov_b32 v232, 0
    v_mov_b32 v233, 0
    v_mov_b32 v234, 0
    v_mov_b32 v235, 0
    v_mov_b32 v236, 0
    v_mov_b32 v237, 0
    v_mov_b32 v238, 0
    v_mov_b32 v239, 0
    v_mov_b32 v28, 0x3f803f80
    v_mov_b32 v29, 0x3f803f80
    v_mov_b32 v30, 0x3f803f80
    v_mov_b32 v31, 0x3f803f80
    s_waitcnt lgkmcnt(7)
    v_mfma_f32_16x16x32_bf16 v[128:131], a[128:131], v[32:35], 0
    v_mfma_f32_16x16x32_bf16 v[136:139], a[128:131], v[48:51], 0
    v_mfma_f32_16x16x32_bf16 v[144:147], a[128:131], v[64:67], 0
    v_mfma_f32_16x16x32_bf16 v[152:155], a[128:131], v[80:83], 0
    s_waitcnt lgkmcnt(6)
    v_mfma_f32_16x16x32_bf16 v[128:131], a[132:135], v[36:39], v[128:131]
    v_mfma_f32_16x16x32_bf16 v[136:139], a[132:135], v[52:55], v[136:139]
    v_mfma_f32_16x16x32_bf16 v[144:147], a[132:135], v[68:71], v[144:147]
    v_mfma_f32_16x16x32_bf16 v[152:155], a[132:135], v[84:87], v[152:155]
    s_waitcnt lgkmcnt(5)
    v_mfma_f32_16x16x32_bf16 v[128:131], a[136:139], v[40:43], v[128:131]
    v_mfma_f32_16x16x32_bf16 v[136:139], a[136:139], v[56:59], v[136:139]
    v_mfma_f32_16x16x32_bf16 v[144:147], a[136:139], v[72:75], v[144:147]
    v_mfma_f32_16x16x32_bf16 v[152:155], a[136:139], v[88:91], v[152:155]
    s_waitcnt lgkmcnt(4)
    v_mfma_f32_16x16x32_bf16 v[128:131], a[140:143], v[44:47], v[128:131]
    v_mfma_f32_16x16x32_bf16 v[136:139], a[140:143], v[60:63], v[136:139]
    v_mfma_f32_16x16x32_bf16 v[144:147], a[140:143], v[76:79], v[144:147]
    v_mfma_f32_16x16x32_bf16 v[152:155], a[140:143], v[92:95], v[152:155]
    s_waitcnt lgkmcnt(3)
    v_mfma_f32_16x16x32_bf16 v[132:135], a[144:147], v[32:35], 0
    v_mfma_f32_16x16x32_bf16 v[140:143], a[144:147], v[48:51], 0
    v_mfma_f32_16x16x32_bf16 v[148:151], a[144:147], v[64:67], 0
    v_mfma_f32_16x16x32_bf16 v[156:159], a[144:147], v[80:83], 0
    s_waitcnt lgkmcnt(2)
    v_mfma_f32_16x16x32_bf16 v[132:135], a[148:151], v[36:39], v[132:135]
    v_mfma_f32_16x16x32_bf16 v[140:143], a[148:151], v[52:55], v[140:143]
    v_mfma_f32_16x16x32_bf16 v[148:151], a[148:151], v[68:71], v[148:151]
    v_mfma_f32_16x16x32_bf16 v[156:159], a[148:151], v[84:87], v[156:159]
    s_waitcnt lgkmcnt(1)
    v_mfma_f32_16x16x32_bf16 v[132:135], a[152:155], v[40:43], v[132:135]
    v_mfma_f32_16x16x32_bf16 v[140:143], a[152:155], v[56:59], v[140:143]
    v_mfma_f32_16x16x32_bf16 v[148:151], a[152:155], v[72:75], v[148:151]
    v_mfma_f32_16x16x32_bf16 v[156:159], a[152:155], v[88:91], v[156:159]
    s_waitcnt lgkmcnt(0)
    v_mfma_f32_16x16x32_bf16 v[132:135], a[156:159], v[44:47], v[132:135]
    v_mfma_f32_16x16x32_bf16 v[140:143], a[156:159], v[60:63], v[140:143]
    v_mfma_f32_16x16x32_bf16 v[148:151], a[156:159], v[76:79], v[148:151]
    v_mfma_f32_16x16x32_bf16 v[156:159], a[156:159], v[92:95], v[156:159]
    ds_read_b128 a[128:131], v2 offset:16384
    ds_read_b128 a[132:135], v2 offset:17408
    ds_read_b128 a[136:139], v2 offset:18432
    ds_read_b128 a[140:143], v2 offset:19456
    ds_read_b128 a[144:147], v2 offset:20480
    ds_read_b128 a[148:151], v2 offset:21504
    ds_read_b128 a[152:155], v2 offset:22528
    ds_read_b128 a[156:159], v2 offset:23552
    s_cmp_lg_u32 s42, 0
    s_nop 3
    s_cbranch_scc1 attn_kernel_nomask0
    v_add_f32 v128, v96, v128
    v_add_f32 v129, v97, v129
    v_add_f32 v130, v98, v130
    v_add_f32 v131, v99, v131
    v_add_f32 v132, v100, v132
    v_add_f32 v133, v101, v133
    v_add_f32 v134, v102, v134
    v_add_f32 v135, v103, v135
attn_kernel_nomask0:
    v_max3_f32 v240, v128, v129, v130
    v_max3_f32 v240, v131, v132, v240
    v_max3_f32 v240, v133, v134, v240
    v_max_f32 v240, v135, v240
    v_max3_f32 v242, v136, v137, v138
    v_max3_f32 v242, v139, v140, v242
    v_max3_f32 v242, v141, v142, v242
    v_max_f32 v242, v143, v242
    v_max3_f32 v244, v144, v145, v146
    v_max3_f32 v244, v147, v148, v244
    v_max3_f32 v244, v149, v150, v244
    v_max_f32 v244, v151, v244
    v_max3_f32 v246, v152, v153, v154
    v_max3_f32 v246, v155, v156, v246
    v_max3_f32 v246, v157, v158, v246
    v_max_f32 v246, v159, v246
    v_mov_b32 v241, v240
    v_mov_b32 v243, v242
    v_mov_b32 v245, v244
    v_mov_b32 v247, v246
    v_permlane16_swap_b32 v240, v241
    v_permlane16_swap_b32 v242, v243
    v_permlane16_swap_b32 v244, v245
    v_permlane16_swap_b32 v246, v247
    v_max_f32 v240, v240, v241
    v_max_f32 v242, v242, v243
    v_max_f32 v244, v244, v245
    v_max_f32 v246, v246, v247
    v_mov_b32 v241, v240
    v_mov_b32 v243, v242
    v_mov_b32 v245, v244
    v_mov_b32 v247, v246
    v_permlane32_swap_b32 v240, v241
    v_permlane32_swap_b32 v242, v243
    v_permlane32_swap_b32 v244, v245
    v_permlane32_swap_b32 v246, v247
    v_max_f32 v240, v240, v241
    v_max_f32 v242, v242, v243
    v_max_f32 v244, v244, v245
    v_max_f32 v246, v246, v247
    v_add_f32 v240, 0x41c00000, v240
    v_sub_f32 v112, 0, v240
    v_sub_f32 v113, 0, v240
    v_sub_f32 v114, 0, v240
    v_sub_f32 v115, 0, v240
    v_sub_f32 v128, v128, v240
    v_sub_f32 v129, v129, v240
    v_sub_f32 v130, v130, v240
    v_sub_f32 v131, v131, v240
    v_sub_f32 v132, v132, v240
    v_sub_f32 v133, v133, v240
    v_sub_f32 v134, v134, v240
    v_sub_f32 v135, v135, v240
    v_add_f32 v242, 0x41c00000, v242
    v_sub_f32 v116, 0, v242
    v_sub_f32 v117, 0, v242
    v_sub_f32 v118, 0, v242
    v_sub_f32 v119, 0, v242
    v_sub_f32 v136, v136, v242
    v_sub_f32 v137, v137, v242
    v_sub_f32 v138, v138, v242
    v_sub_f32 v139, v139, v242
    v_sub_f32 v140, v140, v242
    v_sub_f32 v141, v141, v242
    v_sub_f32 v142, v142, v242
    v_sub_f32 v143, v143, v242
    v_add_f32 v244, 0x41c00000, v244
    v_sub_f32 v120, 0, v244
    v_sub_f32 v121, 0, v244
    v_sub_f32 v122, 0, v244
    v_sub_f32 v123, 0, v244
    v_sub_f32 v144, v144, v244
    v_sub_f32 v145, v145, v244
    v_sub_f32 v146, v146, v244
    v_sub_f32 v147, v147, v244
    v_sub_f32 v148, v148, v244
    v_sub_f32 v149, v149, v244
    v_sub_f32 v150, v150, v244
    v_sub_f32 v151, v151, v244
    v_add_f32 v246, 0x41c00000, v246
    v_sub_f32 v124, 0, v246
    v_sub_f32 v125, 0, v246
    v_sub_f32 v126, 0, v246
    v_sub_f32 v127, 0, v246
    v_sub_f32 v152, v152, v246
    v_sub_f32 v153, v153, v246
    v_sub_f32 v154, v154, v246
    v_sub_f32 v155, v155, v246
    v_sub_f32 v156, v156, v246
    v_sub_f32 v157, v157, v246
    v_sub_f32 v158, v158, v246
    v_sub_f32 v159, v159, v246
    v_exp_f32 v16, v152
    v_exp_f32 v17, v153
    s_nop 0
    v_cvt_pk_bf16_f32 v204, v16, v17
    v_exp_f32 v18, v154
    v_exp_f32 v19, v155
    s_nop 0
    v_cvt_pk_bf16_f32 v205, v18, v19
    v_or_b32 v24, v204, v205
    v_exp_f32 v20, v156
    v_exp_f32 v21, v157
    s_nop 0
    v_cvt_pk_bf16_f32 v206, v20, v21
    v_exp_f32 v22, v158
    v_exp_f32 v23, v159
    s_nop 0
    v_cvt_pk_bf16_f32 v207, v22, v23
    v_or3_b32 v24, v24, v206, v207
    v_exp_f32 v16, v144
    v_exp_f32 v17, v145
    s_nop 0
    v_cvt_pk_bf16_f32 v200, v16, v17
    v_exp_f32 v18, v146
    v_exp_f32 v19, v147
    s_nop 0
    v_cvt_pk_bf16_f32 v201, v18, v19
    v_or3_b32 v24, v24, v200, v201
    v_exp_f32 v20, v148
    v_exp_f32 v21, v149
    s_nop 0
    v_cvt_pk_bf16_f32 v202, v20, v21
    v_exp_f32 v22, v150
    v_exp_f32 v23, v151
    s_nop 0
    v_cvt_pk_bf16_f32 v203, v22, v23
    v_or3_b32 v24, v24, v202, v203
    v_add_u32 v2, 32768, v1
    s_waitcnt lgkmcnt(0)
    s_lshl_b32 s43, s42, 1
    s_add_u32 s43, s43, 1
.p2align 6
attn_kernel_b4_loop:
    v_mfma_f32_16x16x32_bf16 v[160:163], a[128:131], v[32:35], v[112:115]
    s_cmp_eq_u32 s43, 1
    ds_read_b128 a[160:163], v3 offset:8192
    ds_read_b128 a[164:167], v3 offset:9216
    v_mfma_f32_16x16x32_bf16 v[168:171], a[128:131], v[48:51], v[116:119]
    s_cbranch_scc1 attn_kernel_b4_m0
attn_kernel_b4_m0_ret:
    ds_read_b128 a[168:171], v3 offset:10240
    ds_read_b128 a[172:175], v3 offset:11264
    v_mfma_f32_16x16x32_bf16 v[176:179], a[128:131], v[64:67], v[120:123]
    ds_read_b128 a[176:179], v3 offset:12288
    ds_read_b128 a[180:183], v3 offset:13312
    v_mfma_f32_16x16x32_bf16 v[184:187], a[128:131], v[80:83], v[124:127]
    s_waitcnt vmcnt(16)
    s_barrier
    ds_read_b128 a[184:187], v3 offset:14336
    v_mfma_f32_16x16x32_bf16 v[160:163], a[132:135], v[36:39], v[160:163]
    s_mov_b32 m0, s54
    v_exp_f32 v16, v136
    v_mfma_f32_16x16x32_bf16 v[168:171], a[132:135], v[52:55], v[168:171]
    s_add_u32 s57, s52, 16384
    v_exp_f32 v17, v137
    v_mfma_f32_16x16x32_bf16 v[176:179], a[132:135], v[68:71], v[176:179]
    v_exp_f32 v18, v138
    v_mfma_f32_16x16x32_bf16 v[184:187], a[132:135], v[84:87], v[184:187]
    ds_read_b128 a[188:191], v3 offset:15360
    v_cvt_pk_bf16_f32 v196, v16, v17
    v_mfma_f32_16x16x32_bf16 v[160:163], a[136:139], v[40:43], v[160:163]
    v_exp_f32 v19, v139
    v_mfma_f32_16x16x32_bf16 v[168:171], a[136:139], v[56:59], v[168:171]
    v_exp_f32 v20, v140
    v_mfma_f32_16x16x32_bf16 v[176:179], a[136:139], v[72:75], v[176:179]
    ds_read_b128 a[128:131], v2 offset:0
    v_cvt_pk_bf16_f32 v197, v18, v19
    v_mfma_f32_16x16x32_bf16 v[184:187], a[136:139], v[88:91], v[184:187]
    ds_read_b128 a[132:135], v2 offset:1024
    v_or3_b32 v24, v24, v196, v197
    v_mfma_f32_16x16x32_bf16 v[160:163], a[140:143], v[44:47], v[160:163]
    v_exp_f32 v21, v141
    v_mfma_f32_16x16x32_bf16 v[168:171], a[140:143], v[60:63], v[168:171]
    v_exp_f32 v22, v142
    v_mfma_f32_16x16x32_bf16 v[176:179], a[140:143], v[76:79], v[176:179]
    v_exp_f32 v23, v143
    v_mfma_f32_16x16x32_bf16 v[184:187], a[140:143], v[92:95], v[184:187]
    s_waitcnt lgkmcnt(10)
    ds_read_b128 a[136:139], v2 offset:2048
    v_cvt_pk_bf16_f32 v198, v20, v21
    v_mfma_f32_16x16x32_bf16 v[164:167], a[144:147], v[32:35], v[112:115]
    v_exp_f32 v16, v128
    v_mfma_f32_16x16x32_bf16 v[172:175], a[144:147], v[48:51], v[116:119]
    v_exp_f32 v17, v129
    v_mfma_f32_16x16x32_bf16 v[180:183], a[144:147], v[64:67], v[120:123]
    v_exp_f32 v18, v130
    v_mfma_f32_16x16x32_bf16 v[188:191], a[144:147], v[80:83], v[124:127]
    v_exp_f32 v19, v131
    v_mfma_f32_16x16x32_bf16 v[164:167], a[148:151], v[36:39], v[164:167]
    v_exp_f32 v20, v132
    v_mfma_f32_16x16x32_bf16 v[172:175], a[148:151], v[52:55], v[172:175]
    v_exp_f32 v21, v133
    v_mfma_f32_16x16x32_bf16 v[180:183], a[148:151], v[68:71], v[180:183]
    buffer_load_dwordx4 v1, s[12:15], s52 offen offset:0 lds
    v_mfma_f32_16x16x32_bf16 v[188:191], a[148:151], v[84:87], v[188:191]
    v_cvt_pk_bf16_f32 v199, v22, v23
    v_or3_b32 v24, v24, v198, v199
    v_mfma_f32_16x16x32_bf16 v[164:167], a[152:155], v[40:43], v[164:167]
    v_exp_f32 v22, v134
    v_mfma_f32_16x16x32_bf16 v[172:175], a[152:155], v[56:59], v[172:175]
    v_exp_f32 v23, v135
    v_mfma_f32_16x16x32_bf16 v[180:183], a[152:155], v[72:75], v[180:183]
    v_cvt_pk_bf16_f32 v192, v16, v17
    v_cvt_pk_bf16_f32 v193, v18, v19
    v_mfma_f32_16x16x32_bf16 v[188:191], a[152:155], v[88:91], v[188:191]
    v_or3_b32 v24, v24, v192, v193
    v_cvt_pk_bf16_f32 v194, v20, v21
    v_mfma_f32_16x16x32_bf16 v[164:167], a[156:159], v[44:47], v[164:167]
    v_cvt_pk_bf16_f32 v195, v22, v23
    v_or3_b32 v24, v24, v194, v195
    v_mfma_f32_16x16x32_bf16 v[172:175], a[156:159], v[60:63], v[172:175]
    v_and_b32 v24, s56, v24
    v_cmp_ne_u32 vcc, 0, v24
    v_mfma_f32_16x16x32_bf16 v[180:183], a[156:159], v[76:79], v[180:183]
    s_waitcnt lgkmcnt(7)
    ds_read_b128 a[140:143], v2 offset:3072
    v_mfma_f32_16x16x32_bf16 v[188:191], a[156:159], v[92:95], v[188:191]
    s_cbranch_vccnz attn_kernel_b4_r0
attn_kernel_b4_r0_ret:
    ds_read_b128 a[144:147], v2 offset:4096
    v_mfma_f32_16x16x32_bf16 a[0:3], a[160:163], v[192:195], a[0:3]
    ds_read_b128 a[148:151], v2 offset:5120
    v_mfma_f32_16x16x32_bf16 a[32:35], a[160:163], v[196:199], a[32:35]
    ds_read_b128 a[152:155], v2 offset:6144
    v_mfma_f32_16x16x32_bf16 a[64:67], a[160:163], v[200:203], a[64:67]
    ds_read_b128 a[156:159], v2 offset:7168
    v_mfma_f32_16x16x32_bf16 a[96:99], a[160:163], v[204:207], a[96:99]
    s_cmp_eq_u32 s43, 1
    ds_read_b128 a[160:163], v3 offset:24576
    v_mfma_f32_16x16x32_bf16 a[4:7], a[164:167], v[192:195], a[4:7]
    s_cbranch_scc1 attn_kernel_b4_m1
attn_kernel_b4_m1_ret:
    v_mfma_f32_16x16x32_bf16 a[36:39], a[164:167], v[196:199], a[36:39]
    v_mfma_f32_16x16x32_bf16 a[68:71], a[164:167], v[200:203], a[68:71]
    buffer_load_dwordx4 v1, s[12:15], s52 offen offset:1024 lds
    v_mfma_f32_16x16x32_bf16 a[100:103], a[164:167], v[204:207], a[100:103]
    ds_read_b128 a[164:167], v3 offset:25600
    v_mfma_f32_16x16x32_bf16 a[8:11], a[168:171], v[192:195], a[8:11]
    v_mfma_f32_16x16x32_bf16 a[40:43], a[168:171], v[196:199], a[40:43]
    v_mfma_f32_16x16x32_bf16 a[72:75], a[168:171], v[200:203], a[72:75]
    v_mfma_f32_16x16x32_bf16 a[104:107], a[168:171], v[204:207], a[104:107]
    ds_read_b128 a[168:171], v3 offset:26624
    v_mfma_f32_16x16x32_bf16 a[12:15], a[172:175], v[192:195], a[12:15]
    v_exp_f32 v16, v184
    v_mfma_f32_16x16x32_bf16 a[44:47], a[172:175], v[196:199], a[44:47]
    v_exp_f32 v17, v185
    v_mfma_f32_16x16x32_bf16 a[76:79], a[172:175], v[200:203], a[76:79]
    v_exp_f32 v18, v186
    v_mfma_f32_16x16x32_bf16 a[108:111], a[172:175], v[204:207], a[108:111]
    s_waitcnt lgkmcnt(11)
    ds_read_b128 a[172:175], v3 offset:27648
    v_cvt_pk_bf16_f32 v220, v16, v17
    v_mfma_f32_16x16x32_bf16 a[16:19], a[176:179], v[192:195], a[16:19]
    v_exp_f32 v19, v187
    v_mfma_f32_16x16x32_bf16 a[48:51], a[176:179], v[196:199], a[48:51]
    v_exp_f32 v20, v188
    v_mfma_f32_16x16x32_bf16 a[80:83], a[176:179], v[200:203], a[80:83]
    v_exp_f32 v21, v189
    v_mfma_f32_16x16x32_bf16 a[112:115], a[176:179], v[204:207], a[112:115]
    ds_read_b128 a[176:179], v3 offset:28672
    v_cvt_pk_bf16_f32 v221, v18, v19
    v_mfma_f32_16x16x32_bf16 a[20:23], a[180:183], v[192:195], a[20:23]
    v_exp_f32 v22, v190
    v_mfma_f32_16x16x32_bf16 a[52:55], a[180:183], v[196:199], a[52:55]
    v_exp_f32 v23, v191
    v_mfma_f32_16x16x32_bf16 a[84:87], a[180:183], v[200:203], a[84:87]
    buffer_load_dwordx4 v1, s[12:15], s52 offen offset:2048 lds
    v_mfma_f32_16x16x32_bf16 a[116:119], a[180:183], v[204:207], a[116:119]
    ds_read_b128 a[180:183], v3 offset:29696
    v_or_b32 v24, v220, v221
    v_mfma_f32_16x16x32_bf16 a[24:27], a[184:187], v[192:195], a[24:27]
    v_exp_f32 v16, v176
    v_mfma_f32_16x16x32_bf16 a[56:59], a[184:187], v[196:199], a[56:59]
    v_exp_f32 v17, v177
    v_mfma_f32_16x16x32_bf16 a[88:91], a[184:187], v[200:203], a[88:91]
    v_exp_f32 v18, v178
    v_mfma_f32_16x16x32_bf16 a[120:123], a[184:187], v[204:207], a[120:123]
    ds_read_b128 a[184:187], v3 offset:30720
    v_cvt_pk_bf16_f32 v222, v20, v21
    v_mfma_f32_16x16x32_bf16 a[28:31], a[188:191], v[192:195], a[28:31]
    v_exp_f32 v19, v179
    v_mfma_f32_16x16x32_bf16 a[60:63], a[188:191], v[196:199], a[60:63]
    v_exp_f32 v20, v180
    v_mfma_f32_16x16x32_bf16 a[92:95], a[188:191], v[200:203], a[92:95]
    v_exp_f32 v21, v181
    v_mfma_f32_16x16x32_bf16 a[124:127], a[188:191], v[204:207], a[124:127]
    ds_read_b128 a[188:191], v3 offset:31744
    v_cvt_pk_bf16_f32 v223, v22, v23
    v_mfma_f32_16x16x32_bf16 v[224:227], v[28:31], v[192:195], v[224:227]
    v_exp_f32 v22, v182
    v_mfma_f32_16x16x32_bf16 v[228:231], v[28:31], v[196:199], v[228:231]
    v_exp_f32 v23, v183
    v_mfma_f32_16x16x32_bf16 v[232:235], v[28:31], v[200:203], v[232:235]
    v_or3_b32 v24, v24, v222, v223
    v_cvt_pk_bf16_f32 v216, v16, v17
    v_mfma_f32_16x16x32_bf16 v[236:239], v[28:31], v[204:207], v[236:239]
    s_waitcnt lgkmcnt(12)
    v_exp_f32 v16, v168
    v_mfma_f32_16x16x32_bf16 v[128:131], a[128:131], v[32:35], v[112:115]
    v_exp_f32 v17, v169
    v_mfma_f32_16x16x32_bf16 v[136:139], a[128:131], v[48:51], v[116:119]
    v_cvt_pk_bf16_f32 v217, v18, v19
    v_or3_b32 v24, v24, v216, v217
    v_mfma_f32_16x16x32_bf16 v[144:147], a[128:131], v[64:67], v[120:123]
    buffer_load_dwordx4 v1, s[12:15], s52 offen offset:3072 lds
    v_mfma_f32_16x16x32_bf16 v[152:155], a[128:131], v[80:83], v[124:127]
    s_mov_b32 m0, s55
    ds_read_b128 a[128:131], v2 offset:16384
    v_cvt_pk_bf16_f32 v218, v20, v21
    v_mfma_f32_16x16x32_bf16 v[128:131], a[132:135], v[36:39], v[128:131]
    v_exp_f32 v18, v170
    v_mfma_f32_16x16x32_bf16 v[136:139], a[132:135], v[52:55], v[136:139]
    v_exp_f32 v19, v171
    v_mfma_f32_16x16x32_bf16 v[144:147], a[132:135], v[68:71], v[144:147]
    v_exp_f32 v20, v172
    v_mfma_f32_16x16x32_bf16 v[152:155], a[132:135], v[84:87], v[152:155]
    ds_read_b128 a[132:135], v2 offset:17408
    v_cvt_pk_bf16_f32 v219, v22, v23
    v_mfma_f32_16x16x32_bf16 v[128:131], a[136:139], v[40:43], v[128:131]
    v_exp_f32 v21, v173
    v_mfma_f32_16x16x32_bf16 v[136:139], a[136:139], v[56:59], v[136:139]
    v_exp_f32 v22, v174
    v_mfma_f32_16x16x32_bf16 v[144:147], a[136:139], v[72:75], v[144:147]
    v_exp_f32 v23, v175
    v_mfma_f32_16x16x32_bf16 v[152:155], a[136:139], v[88:91], v[152:155]
    ds_read_b128 a[136:139], v2 offset:18432
    v_or3_b32 v24, v24, v218, v219
    v_mfma_f32_16x16x32_bf16 v[128:131], a[140:143], v[44:47], v[128:131]
    v_cvt_pk_bf16_f32 v212, v16, v17
    v_cvt_pk_bf16_f32 v213, v18, v19
    v_mfma_f32_16x16x32_bf16 v[136:139], a[140:143], v[60:63], v[136:139]
    v_exp_f32 v16, v160
    v_mfma_f32_16x16x32_bf16 v[144:147], a[140:143], v[76:79], v[144:147]
    v_exp_f32 v17, v161
    v_mfma_f32_16x16x32_bf16 v[152:155], a[140:143], v[92:95], v[152:155]
    s_waitcnt lgkmcnt(11)
    ds_read_b128 a[140:143], v2 offset:19456
    v_or3_b32 v24, v24, v212, v213
    v_mfma_f32_16x16x32_bf16 v[132:135], a[144:147], v[32:35], v[112:115]
    v_exp_f32 v18, v162
    v_mfma_f32_16x16x32_bf16 v[140:143], a[144:147], v[48:51], v[116:119]
    v_exp_f32 v19, v163
    v_mfma_f32_16x16x32_bf16 v[148:151], a[144:147], v[64:67], v[120:123]
    buffer_load_dwordx4 v1, s[12:15], s57 offen offset:0 lds
    v_mfma_f32_16x16x32_bf16 v[156:159], a[144:147], v[80:83], v[124:127]
    ds_read_b128 a[144:147], v2 offset:20480
    v_cvt_pk_bf16_f32 v214, v20, v21
    v_mfma_f32_16x16x32_bf16 v[132:135], a[148:151], v[36:39], v[132:135]
    v_exp_f32 v20, v164
    v_mfma_f32_16x16x32_bf16 v[140:143], a[148:151], v[52:55], v[140:143]
    v_exp_f32 v21, v165
    v_mfma_f32_16x16x32_bf16 v[148:151], a[148:151], v[68:71], v[148:151]
    v_cvt_pk_bf16_f32 v215, v22, v23
    v_or3_b32 v24, v24, v214, v215
    v_mfma_f32_16x16x32_bf16 v[156:159], a[148:151], v[84:87], v[156:159]
    ds_read_b128 a[148:151], v2 offset:21504
    v_cvt_pk_bf16_f32 v208, v16, v17
    v_mfma_f32_16x16x32_bf16 v[132:135], a[152:155], v[40:43], v[132:135]
    v_exp_f32 v22, v166
    v_mfma_f32_16x16x32_bf16 v[140:143], a[152:155], v[56:59], v[140:143]
    v_exp_f32 v23, v167
    v_mfma_f32_16x16x32_bf16 v[148:151], a[152:155], v[72:75], v[148:151]
    v_cvt_pk_bf16_f32 v209, v18, v19
    v_or3_b32 v24, v24, v208, v209
    v_mfma_f32_16x16x32_bf16 v[156:159], a[152:155], v[88:91], v[156:159]
    ds_read_b128 a[152:155], v2 offset:22528
    v_cvt_pk_bf16_f32 v210, v20, v21
    v_mfma_f32_16x16x32_bf16 v[132:135], a[156:159], v[44:47], v[132:135]
    v_cvt_pk_bf16_f32 v211, v22, v23
    v_or3_b32 v24, v24, v210, v211
    v_mfma_f32_16x16x32_bf16 v[140:143], a[156:159], v[60:63], v[140:143]
    v_and_b32 v24, s56, v24
    v_cmp_ne_u32 vcc, 0, v24
    v_mfma_f32_16x16x32_bf16 v[148:151], a[156:159], v[76:79], v[148:151]
    s_waitcnt lgkmcnt(11)
    v_mfma_f32_16x16x32_bf16 v[156:159], a[156:159], v[92:95], v[156:159]
    s_cbranch_vccnz attn_kernel_b4_r1
attn_kernel_b4_r1_ret:
    ds_read_b128 a[156:159], v2 offset:23552
    v_mfma_f32_16x16x32_bf16 a[0:3], a[160:163], v[208:211], a[0:3]
    v_mfma_f32_16x16x32_bf16 a[32:35], a[160:163], v[212:215], a[32:35]
    s_add_u32 s52, s52, 32768
    v_mfma_f32_16x16x32_bf16 a[64:67], a[160:163], v[216:219], a[64:67]
    buffer_load_dwordx4 v1, s[12:15], s57 offen offset:1024 lds
    v_mfma_f32_16x16x32_bf16 a[96:99], a[160:163], v[220:223], a[96:99]
    s_add_u32 s54, s53, s58
    v_mfma_f32_16x16x32_bf16 a[4:7], a[164:167], v[208:211], a[4:7]
    s_add_u32 s55, s54, 16384
    v_mfma_f32_16x16x32_bf16 a[36:39], a[164:167], v[212:215], a[36:39]
    s_mov_b32 s53, s59
    v_mfma_f32_16x16x32_bf16 a[68:71], a[164:167], v[216:219], a[68:71]
    s_add_u32 s59, s59, 32768
    v_mfma_f32_16x16x32_bf16 a[100:103], a[164:167], v[220:223], a[100:103]
    s_cmp_eq_u32 s59, 163840
    v_mfma_f32_16x16x32_bf16 a[8:11], a[168:171], v[208:211], a[8:11]
    s_cselect_b32 s59, 0, s59
    v_mfma_f32_16x16x32_bf16 a[40:43], a[168:171], v[212:215], a[40:43]
    s_sub_u32 s43, s43, 1
    v_mfma_f32_16x16x32_bf16 a[72:75], a[168:171], v[216:219], a[72:75]
    s_cmp_lg_u32 s43, 0
    v_mfma_f32_16x16x32_bf16 a[104:107], a[168:171], v[220:223], a[104:107]
    v_exp_f32 v16, v152
    v_mfma_f32_16x16x32_bf16 a[12:15], a[172:175], v[208:211], a[12:15]
    v_exp_f32 v17, v153
    v_mfma_f32_16x16x32_bf16 a[44:47], a[172:175], v[212:215], a[44:47]
    v_exp_f32 v18, v154
    v_mfma_f32_16x16x32_bf16 a[76:79], a[172:175], v[216:219], a[76:79]
    v_exp_f32 v19, v155
    v_mfma_f32_16x16x32_bf16 a[108:111], a[172:175], v[220:223], a[108:111]
    s_waitcnt lgkmcnt(8)
    v_exp_f32 v20, v156
    v_mfma_f32_16x16x32_bf16 a[16:19], a[176:179], v[208:211], a[16:19]
    v_exp_f32 v21, v157
    v_mfma_f32_16x16x32_bf16 a[48:51], a[176:179], v[212:215], a[48:51]
    v_exp_f32 v22, v158
    v_mfma_f32_16x16x32_bf16 a[80:83], a[176:179], v[216:219], a[80:83]
    buffer_load_dwordx4 v1, s[12:15], s57 offen offset:2048 lds
    v_mfma_f32_16x16x32_bf16 a[112:115], a[176:179], v[220:223], a[112:115]
    v_exp_f32 v23, v159
    v_mfma_f32_16x16x32_bf16 a[20:23], a[180:183], v[208:211], a[20:23]
    v_cvt_pk_bf16_f32 v204, v16, v17
    v_cvt_pk_bf16_f32 v205, v18, v19
    v_mfma_f32_16x16x32_bf16 a[52:55], a[180:183], v[212:215], a[52:55]
    v_exp_f32 v16, v144
    v_mfma_f32_16x16x32_bf16 a[84:87], a[180:183], v[216:219], a[84:87]
    v_exp_f32 v17, v145
    v_mfma_f32_16x16x32_bf16 a[116:119], a[180:183], v[220:223], a[116:119]
    v_exp_f32 v18, v146
    v_mfma_f32_16x16x32_bf16 a[24:27], a[184:187], v[208:211], a[24:27]
    v_exp_f32 v19, v147
    v_mfma_f32_16x16x32_bf16 a[56:59], a[184:187], v[212:215], a[56:59]
    v_or_b32 v24, v204, v205
    v_cvt_pk_bf16_f32 v206, v20, v21
    v_mfma_f32_16x16x32_bf16 a[88:91], a[184:187], v[216:219], a[88:91]
    v_exp_f32 v20, v148
    v_mfma_f32_16x16x32_bf16 a[120:123], a[184:187], v[220:223], a[120:123]
    v_exp_f32 v21, v149
    v_mfma_f32_16x16x32_bf16 a[28:31], a[188:191], v[208:211], a[28:31]
    v_cvt_pk_bf16_f32 v207, v22, v23
    v_or3_b32 v24, v24, v206, v207
    v_mfma_f32_16x16x32_bf16 a[60:63], a[188:191], v[212:215], a[60:63]
    v_exp_f32 v22, v150
    v_mfma_f32_16x16x32_bf16 a[92:95], a[188:191], v[216:219], a[92:95]
    v_exp_f32 v23, v151
    v_mfma_f32_16x16x32_bf16 a[124:127], a[188:191], v[220:223], a[124:127]
    v_cvt_pk_bf16_f32 v200, v16, v17
    v_cvt_pk_bf16_f32 v201, v18, v19
    v_mfma_f32_16x16x32_bf16 v[224:227], v[28:31], v[208:211], v[224:227]
    v_or3_b32 v24, v24, v200, v201
    v_cvt_pk_bf16_f32 v202, v20, v21
    v_mfma_f32_16x16x32_bf16 v[228:231], v[28:31], v[212:215], v[228:231]
    v_cvt_pk_bf16_f32 v203, v22, v23
    v_or3_b32 v24, v24, v202, v203
    v_mfma_f32_16x16x32_bf16 v[232:235], v[28:31], v[216:219], v[232:235]
    buffer_load_dwordx4 v1, s[12:15], s57 offen offset:3072 lds
    v_mfma_f32_16x16x32_bf16 v[236:239], v[28:31], v[220:223], v[236:239]
    s_waitcnt lgkmcnt(4)
    v_mov_b32 v3, v2
    v_add_u32 v2, s59, v1
    s_cbranch_scc1 attn_kernel_b4_loop
    s_nop 4
    v_accvgpr_read_b32 v244, a0
    v_accvgpr_read_b32 v245, a1
    v_accvgpr_read_b32 v246, a2
    v_accvgpr_read_b32 v247, a3
    v_accvgpr_read_b32 v248, a4
    v_accvgpr_read_b32 v249, a5
    v_accvgpr_read_b32 v250, a6
    v_accvgpr_read_b32 v251, a7
    v_rcp_f32 v240, v224
    s_nop 0
    v_mul_f32 v244, v244, v240
    v_mul_f32 v245, v245, v240
    v_mul_f32 v246, v246, v240
    v_mul_f32 v247, v247, v240
    v_mul_f32 v248, v248, v240
    v_mul_f32 v249, v249, v240
    v_mul_f32 v250, v250, v240
    v_mul_f32 v251, v251, v240
    v_cvt_pk_bf16_f32 v252, v244, v245
    v_cvt_pk_bf16_f32 v253, v246, v247
    v_cvt_pk_bf16_f32 v254, v248, v249
    v_cvt_pk_bf16_f32 v255, v250, v251
    buffer_store_dwordx4 v[252:255], v1, s[16:19], s68 offen offset:0
    v_accvgpr_read_b32 v244, a8
    v_accvgpr_read_b32 v245, a9
    v_accvgpr_read_b32 v246, a10
    v_accvgpr_read_b32 v247, a11
    v_accvgpr_read_b32 v248, a12
    v_accvgpr_read_b32 v249, a13
    v_accvgpr_read_b32 v250, a14
    v_accvgpr_read_b32 v251, a15
    v_mul_f32 v244, v244, v240
    v_mul_f32 v245, v245, v240
    v_mul_f32 v246, v246, v240
    v_mul_f32 v247, v247, v240
    v_mul_f32 v248, v248, v240
    v_mul_f32 v249, v249, v240
    v_mul_f32 v250, v250, v240
    v_mul_f32 v251, v251, v240
    v_cvt_pk_bf16_f32 v4, v244, v245
    v_cvt_pk_bf16_f32 v5, v246, v247
    v_cvt_pk_bf16_f32 v6, v248, v249
    v_cvt_pk_bf16_f32 v7, v250, v251
    buffer_store_dwordx4 v[4:7], v1, s[16:19], s68 offen offset:1024
    v_accvgpr_read_b32 v244, a16
    v_accvgpr_read_b32 v245, a17
    v_accvgpr_read_b32 v246, a18
    v_accvgpr_read_b32 v247, a19
    v_accvgpr_read_b32 v248, a20
    v_accvgpr_read_b32 v249, a21
    v_accvgpr_read_b32 v250, a22
    v_accvgpr_read_b32 v251, a23
    v_mul_f32 v244, v244, v240
    v_mul_f32 v245, v245, v240
    v_mul_f32 v246, v246, v240
    v_mul_f32 v247, v247, v240
    v_mul_f32 v248, v248, v240
    v_mul_f32 v249, v249, v240
    v_mul_f32 v250, v250, v240
    v_mul_f32 v251, v251, v240
    v_cvt_pk_bf16_f32 v252, v244, v245
    v_cvt_pk_bf16_f32 v253, v246, v247
    v_cvt_pk_bf16_f32 v254, v248, v249
    v_cvt_pk_bf16_f32 v255, v250, v251
    buffer_store_dwordx4 v[252:255], v1, s[16:19], s68 offen offset:2048
    v_accvgpr_read_b32 v244, a24
    v_accvgpr_read_b32 v245, a25
    v_accvgpr_read_b32 v246, a26
    v_accvgpr_read_b32 v247, a27
    v_accvgpr_read_b32 v248, a28
    v_accvgpr_read_b32 v249, a29
    v_accvgpr_read_b32 v250, a30
    v_accvgpr_read_b32 v251, a31
    v_mul_f32 v244, v244, v240
    v_mul_f32 v245, v245, v240
    v_mul_f32 v246, v246, v240
    v_mul_f32 v247, v247, v240
    v_mul_f32 v248, v248, v240
    v_mul_f32 v249, v249, v240
    v_mul_f32 v250, v250, v240
    v_mul_f32 v251, v251, v240
    v_cvt_pk_bf16_f32 v4, v244, v245
    v_cvt_pk_bf16_f32 v5, v246, v247
    v_cvt_pk_bf16_f32 v6, v248, v249
    v_cvt_pk_bf16_f32 v7, v250, v251
    buffer_store_dwordx4 v[4:7], v1, s[16:19], s68 offen offset:3072
    v_mfma_f32_16x16x32_bf16 v[168:171], a[128:131], v[48:51], v[116:119]
    ds_read_b128 a[160:163], v3 offset:8192
    v_add_f32 v136, v96, v136
    v_mfma_f32_16x16x32_bf16 v[176:179], a[128:131], v[64:67], v[120:123]
    ds_read_b128 a[164:167], v3 offset:9216
    v_add_f32 v137, v97, v137
    v_mfma_f32_16x16x32_bf16 v[184:187], a[128:131], v[80:83], v[124:127]
    ds_read_b128 a[168:171], v3 offset:10240
    v_add_f32 v138, v98, v138
    v_mfma_f32_16x16x32_bf16 v[168:171], a[132:135], v[52:55], v[168:171]
    s_waitcnt vmcnt(16)
    s_barrier
    ds_read_b128 a[172:175], v3 offset:11264
    v_mfma_f32_16x16x32_bf16 v[176:179], a[132:135], v[68:71], v[176:179]
    s_mov_b32 m0, s54
    ds_read_b128 a[176:179], v3 offset:12288
    v_add_f32 v139, v99, v139
    v_mfma_f32_16x16x32_bf16 v[184:187], a[132:135], v[84:87], v[184:187]
    s_add_u32 s57, s52, 16384
    ds_read_b128 a[180:183], v3 offset:13312
    v_add_f32 v140, v100, v140
    v_mfma_f32_16x16x32_bf16 v[168:171], a[136:139], v[56:59], v[168:171]
    ds_read_b128 a[184:187], v3 offset:14336
    v_add_f32 v141, v101, v141
    v_mfma_f32_16x16x32_bf16 v[176:179], a[136:139], v[72:75], v[176:179]
    ds_read_b128 a[188:191], v3 offset:15360
    v_add_f32 v142, v102, v142
    v_mfma_f32_16x16x32_bf16 v[184:187], a[136:139], v[88:91], v[184:187]
    ds_read_b128 a[128:131], v2 offset:0
    v_add_f32 v143, v103, v143
    v_mfma_f32_16x16x32_bf16 v[168:171], a[140:143], v[60:63], v[168:171]
    v_exp_f32 v16, v136
    v_mfma_f32_16x16x32_bf16 v[176:179], a[140:143], v[76:79], v[176:179]
    v_exp_f32 v17, v137
    v_mfma_f32_16x16x32_bf16 v[184:187], a[140:143], v[92:95], v[184:187]
    s_waitcnt lgkmcnt(9)
    v_exp_f32 v18, v138
    v_mfma_f32_16x16x32_bf16 v[172:175], a[144:147], v[48:51], v[116:119]
    v_exp_f32 v19, v139
    v_mfma_f32_16x16x32_bf16 v[180:183], a[144:147], v[64:67], v[120:123]
    v_exp_f32 v20, v140
    v_mfma_f32_16x16x32_bf16 v[188:191], a[144:147], v[80:83], v[124:127]
    v_exp_f32 v21, v141
    v_mfma_f32_16x16x32_bf16 v[172:175], a[148:151], v[52:55], v[172:175]
    v_exp_f32 v22, v142
    v_mfma_f32_16x16x32_bf16 v[180:183], a[148:151], v[68:71], v[180:183]
    v_exp_f32 v23, v143
    v_mfma_f32_16x16x32_bf16 v[188:191], a[148:151], v[84:87], v[188:191]
    buffer_load_dwordx4 v1, s[12:15], s52 offen offset:0 lds
    v_mfma_f32_16x16x32_bf16 v[172:175], a[152:155], v[56:59], v[172:175]
    v_cvt_pk_bf16_f32 v196, v16, v17
    v_cvt_pk_bf16_f32 v197, v18, v19
    v_mfma_f32_16x16x32_bf16 v[180:183], a[152:155], v[72:75], v[180:183]
    v_or3_b32 v24, v24, v196, v197
    v_cvt_pk_bf16_f32 v198, v20, v21
    v_mfma_f32_16x16x32_bf16 v[188:191], a[152:155], v[88:91], v[188:191]
    v_cvt_pk_bf16_f32 v199, v22, v23
    v_or3_b32 v24, v24, v198, v199
    v_mfma_f32_16x16x32_bf16 v[172:175], a[156:159], v[60:63], v[172:175]
    v_and_b32 v24, s56, v24
    v_cmp_ne_u32 vcc, 0, v24
    v_mfma_f32_16x16x32_bf16 v[180:183], a[156:159], v[76:79], v[180:183]
    s_waitcnt lgkmcnt(5)
    ds_read_b128 a[132:135], v2 offset:1024
    ds_read_b128 a[136:139], v2 offset:2048
    v_mfma_f32_16x16x32_bf16 v[188:191], a[156:159], v[92:95], v[188:191]
    s_cbranch_vccnz attn_kernel_b3_r0
attn_kernel_b3_r0_ret:
    ds_read_b128 a[140:143], v2 offset:3072
    ds_read_b128 a[144:147], v2 offset:4096
    v_mfma_f32_16x16x32_bf16 a[32:35], a[160:163], v[196:199], a[32:35]
    v_exp_f32 v16, v184
    v_mfma_f32_16x16x32_bf16 a[64:67], a[160:163], v[200:203], a[64:67]
    ds_read_b128 a[148:151], v2 offset:5120
    ds_read_b128 a[152:155], v2 offset:6144
    v_mfma_f32_16x16x32_bf16 a[96:99], a[160:163], v[204:207], a[96:99]
    v_exp_f32 v17, v185
    v_mfma_f32_16x16x32_bf16 a[36:39], a[164:167], v[196:199], a[36:39]
    ds_read_b128 a[156:159], v2 offset:7168
    v_cvt_pk_bf16_f32 v220, v16, v17
    v_mfma_f32_16x16x32_bf16 a[68:71], a[164:167], v[200:203], a[68:71]
    v_exp_f32 v18, v186
    v_mfma_f32_16x16x32_bf16 a[100:103], a[164:167], v[204:207], a[100:103]
    buffer_load_dwordx4 v1, s[12:15], s52 offen offset:1024 lds
    v_mfma_f32_16x16x32_bf16 a[40:43], a[168:171], v[196:199], a[40:43]
    v_exp_f32 v19, v187
    v_mfma_f32_16x16x32_bf16 a[72:75], a[168:171], v[200:203], a[72:75]
    ds_read_b128 a[160:163], v3 offset:24576
    v_cvt_pk_bf16_f32 v221, v18, v19
    v_mfma_f32_16x16x32_bf16 a[104:107], a[168:171], v[204:207], a[104:107]
    v_exp_f32 v20, v188
    v_mfma_f32_16x16x32_bf16 a[44:47], a[172:175], v[196:199], a[44:47]
    v_exp_f32 v21, v189
    v_mfma_f32_16x16x32_bf16 a[76:79], a[172:175], v[200:203], a[76:79]
    ds_read_b128 a[164:167], v3 offset:25600
    v_or_b32 v24, v220, v221
    v_mfma_f32_16x16x32_bf16 a[108:111], a[172:175], v[204:207], a[108:111]
    s_waitcnt lgkmcnt(10)
    ds_read_b128 a[168:171], v3 offset:26624
    v_cvt_pk_bf16_f32 v222, v20, v21
    v_mfma_f32_16x16x32_bf16 a[48:51], a[176:179], v[196:199], a[48:51]
    v_exp_f32 v22, v190
    v_mfma_f32_16x16x32_bf16 a[80:83], a[176:179], v[200:203], a[80:83]
    v_exp_f32 v23, v191
    v_mfma_f32_16x16x32_bf16 a[112:115], a[176:179], v[204:207], a[112:115]
    ds_read_b128 a[172:175], v3 offset:27648
    v_cvt_pk_bf16_f32 v223, v22, v23
    v_mfma_f32_16x16x32_bf16 a[52:55], a[180:183], v[196:199], a[52:55]
    ds_read_b128 a[176:179], v3 offset:28672
    v_or3_b32 v24, v24, v222, v223
    v_mfma_f32_16x16x32_bf16 a[84:87], a[180:183], v[200:203], a[84:87]
    v_exp_f32 v16, v176
    v_mfma_f32_16x16x32_bf16 a[116:119], a[180:183], v[204:207], a[116:119]
    buffer_load_dwordx4 v1, s[12:15], s52 offen offset:2048 lds
    v_mfma_f32_16x16x32_bf16 a[56:59], a[184:187], v[196:199], a[56:59]
    v_exp_f32 v17, v177
    v_mfma_f32_16x16x32_bf16 a[88:91], a[184:187], v[200:203], a[88:91]
    ds_read_b128 a[180:183], v3 offset:29696
    v_cvt_pk_bf16_f32 v216, v16, v17
    v_mfma_f32_16x16x32_bf16 a[120:123], a[184:187], v[204:207], a[120:123]
    v_exp_f32 v18, v178
    v_mfma_f32_16x16x32_bf16 a[60:63], a[188:191], v[196:199], a[60:63]
    v_exp_f32 v19, v179
    v_mfma_f32_16x16x32_bf16 a[92:95], a[188:191], v[200:203], a[92:95]
    ds_read_b128 a[184:187], v3 offset:30720
    v_cvt_pk_bf16_f32 v217, v18, v19
    v_mfma_f32_16x16x32_bf16 a[124:127], a[188:191], v[204:207], a[124:127]
    ds_read_b128 a[188:191], v3 offset:31744
    v_or3_b32 v24, v24, v216, v217
    v_mfma_f32_16x16x32_bf16 v[228:231], v[28:31], v[196:199], v[228:231]
    v_exp_f32 v20, v180
    v_mfma_f32_16x16x32_bf16 v[232:235], v[28:31], v[200:203], v[232:235]
    v_exp_f32 v21, v181
    v_mfma_f32_16x16x32_bf16 v[236:239], v[28:31], v[204:207], v[236:239]
    s_waitcnt lgkmcnt(12)
    v_exp_f32 v22, v182
    v_mfma_f32_16x16x32_bf16 v[136:139], a[128:131], v[48:51], v[116:119]
    v_exp_f32 v23, v183
    v_mfma_f32_16x16x32_bf16 v[144:147], a[128:131], v[64:67], v[120:123]
    v_cvt_pk_bf16_f32 v218, v20, v21
    v_cvt_pk_bf16_f32 v219, v22, v23
    v_mfma_f32_16x16x32_bf16 v[152:155], a[128:131], v[80:83], v[124:127]
    buffer_load_dwordx4 v1, s[12:15], s52 offen offset:3072 lds
    v_mfma_f32_16x16x32_bf16 v[136:139], a[132:135], v[52:55], v[136:139]
    s_mov_b32 m0, s55
    v_or3_b32 v24, v24, v218, v219
    v_add_f32 v168, v104, v168
    v_mfma_f32_16x16x32_bf16 v[144:147], a[132:135], v[68:71], v[144:147]
    ds_read_b128 a[128:131], v2 offset:16384
    v_add_f32 v169, v105, v169
    v_mfma_f32_16x16x32_bf16 v[152:155], a[132:135], v[84:87], v[152:155]
    v_add_f32 v170, v106, v170
    v_add_f32 v171, v107, v171
    v_mfma_f32_16x16x32_bf16 v[136:139], a[136:139], v[56:59], v[136:139]
    v_add_f32 v172, v108, v172
    v_add_f32 v173, v109, v173
    v_mfma_f32_16x16x32_bf16 v[144:147], a[136:139], v[72:75], v[144:147]
    ds_read_b128 a[132:135], v2 offset:17408
    v_add_f32 v174, v110, v174
    v_mfma_f32_16x16x32_bf16 v[152:155], a[136:139], v[88:91], v[152:155]
    ds_read_b128 a[136:139], v2 offset:18432
    v_add_f32 v175, v111, v175
    v_mfma_f32_16x16x32_bf16 v[136:139], a[140:143], v[60:63], v[136:139]
    v_exp_f32 v16, v168
    v_mfma_f32_16x16x32_bf16 v[144:147], a[140:143], v[76:79], v[144:147]
    v_exp_f32 v17, v169
    v_mfma_f32_16x16x32_bf16 v[152:155], a[140:143], v[92:95], v[152:155]
    s_waitcnt lgkmcnt(11)
    v_exp_f32 v18, v170
    v_mfma_f32_16x16x32_bf16 v[140:143], a[144:147], v[48:51], v[116:119]
    v_exp_f32 v19, v171
    v_mfma_f32_16x16x32_bf16 v[148:151], a[144:147], v[64:67], v[120:123]
    buffer_load_dwordx4 v1, s[12:15], s57 offen offset:0 lds
    v_mfma_f32_16x16x32_bf16 v[156:159], a[144:147], v[80:83], v[124:127]
    v_exp_f32 v20, v172
    v_mfma_f32_16x16x32_bf16 v[140:143], a[148:151], v[52:55], v[140:143]
    v_exp_f32 v21, v173
    v_mfma_f32_16x16x32_bf16 v[148:151], a[148:151], v[68:71], v[148:151]
    v_exp_f32 v22, v174
    v_mfma_f32_16x16x32_bf16 v[156:159], a[148:151], v[84:87], v[156:159]
    v_exp_f32 v23, v175
    v_mfma_f32_16x16x32_bf16 v[140:143], a[152:155], v[56:59], v[140:143]
    v_cvt_pk_bf16_f32 v212, v16, v17
    v_cvt_pk_bf16_f32 v213, v18, v19
    v_mfma_f32_16x16x32_bf16 v[148:151], a[152:155], v[72:75], v[148:151]
    v_or3_b32 v24, v24, v212, v213
    v_cvt_pk_bf16_f32 v214, v20, v21
    v_mfma_f32_16x16x32_bf16 v[156:159], a[152:155], v[88:91], v[156:159]
    v_cvt_pk_bf16_f32 v215, v22, v23
    v_or3_b32 v24, v24, v214, v215
    v_mfma_f32_16x16x32_bf16 v[140:143], a[156:159], v[60:63], v[140:143]
    v_and_b32 v24, s56, v24
    v_cmp_ne_u32 vcc, 0, v24
    v_mfma_f32_16x16x32_bf16 v[148:151], a[156:159], v[76:79], v[148:151]
    s_waitcnt lgkmcnt(7)
    ds_read_b128 a[140:143], v2 offset:19456
    v_mfma_f32_16x16x32_bf16 v[156:159], a[156:159], v[92:95], v[156:159]
    s_cbranch_vccnz attn_kernel_b3_r1
attn_kernel_b3_r1_ret:
    ds_read_b128 a[144:147], v2 offset:20480
    v_mfma_f32_16x16x32_bf16 a[32:35], a[160:163], v[212:215], a[32:35]
    ds_read_b128 a[148:151], v2 offset:21504
    v_mfma_f32_16x16x32_bf16 a[64:67], a[160:163], v[216:219], a[64:67]
    buffer_load_dwordx4 v1, s[12:15], s57 offen offset:1024 lds
    v_mfma_f32_16x16x32_bf16 a[96:99], a[160:163], v[220:223], a[96:99]
    s_add_u32 s52, s52, 32768
    v_mfma_f32_16x16x32_bf16 a[36:39], a[164:167], v[212:215], a[36:39]
    s_add_u32 s54, s53, s58
    ds_read_b128 a[152:155], v2 offset:22528
    v_mfma_f32_16x16x32_bf16 a[68:71], a[164:167], v[216:219], a[68:71]
    s_add_u32 s55, s54, 16384
    ds_read_b128 a[156:159], v2 offset:23552
    v_mfma_f32_16x16x32_bf16 a[100:103], a[164:167], v[220:223], a[100:103]
    s_mov_b32 s53, s59
    v_mfma_f32_16x16x32_bf16 a[40:43], a[168:171], v[212:215], a[40:43]
    s_add_u32 s59, s59, 32768
    v_mfma_f32_16x16x32_bf16 a[72:75], a[168:171], v[216:219], a[72:75]
    s_cmp_eq_u32 s59, 163840
    v_mfma_f32_16x16x32_bf16 a[104:107], a[168:171], v[220:223], a[104:107]
    s_cselect_b32 s59, 0, s59
    v_mfma_f32_16x16x32_bf16 a[44:47], a[172:175], v[212:215], a[44:47]
    v_mfma_f32_16x16x32_bf16 a[76:79], a[172:175], v[216:219], a[76:79]
    v_mfma_f32_16x16x32_bf16 a[108:111], a[172:175], v[220:223], a[108:111]
    s_waitcnt lgkmcnt(8)
    v_mfma_f32_16x16x32_bf16 a[48:51], a[176:179], v[212:215], a[48:51]
    v_mfma_f32_16x16x32_bf16 a[80:83], a[176:179], v[216:219], a[80:83]
    buffer_load_dwordx4 v1, s[12:15], s57 offen offset:2048 lds
    v_mfma_f32_16x16x32_bf16 a[112:115], a[176:179], v[220:223], a[112:115]
    v_exp_f32 v16, v152
    v_mfma_f32_16x16x32_bf16 a[52:55], a[180:183], v[212:215], a[52:55]
    v_exp_f32 v17, v153
    v_mfma_f32_16x16x32_bf16 a[84:87], a[180:183], v[216:219], a[84:87]
    v_exp_f32 v18, v154
    v_mfma_f32_16x16x32_bf16 a[116:119], a[180:183], v[220:223], a[116:119]
    v_exp_f32 v19, v155
    v_mfma_f32_16x16x32_bf16 a[56:59], a[184:187], v[212:215], a[56:59]
    v_exp_f32 v20, v156
    v_mfma_f32_16x16x32_bf16 a[88:91], a[184:187], v[216:219], a[88:91]
    v_exp_f32 v21, v157
    v_mfma_f32_16x16x32_bf16 a[120:123], a[184:187], v[220:223], a[120:123]
    v_exp_f32 v22, v158
    v_mfma_f32_16x16x32_bf16 a[60:63], a[188:191], v[212:215], a[60:63]
    v_exp_f32 v23, v159
    v_mfma_f32_16x16x32_bf16 a[92:95], a[188:191], v[216:219], a[92:95]
    v_cvt_pk_bf16_f32 v204, v16, v17
    v_cvt_pk_bf16_f32 v205, v18, v19
    v_mfma_f32_16x16x32_bf16 a[124:127], a[188:191], v[220:223], a[124:127]
    v_or_b32 v24, v204, v205
    v_cvt_pk_bf16_f32 v206, v20, v21
    v_mfma_f32_16x16x32_bf16 v[228:231], v[28:31], v[212:215], v[228:231]
    v_cvt_pk_bf16_f32 v207, v22, v23
    v_or3_b32 v24, v24, v206, v207
    v_mfma_f32_16x16x32_bf16 v[232:235], v[28:31], v[216:219], v[232:235]
    buffer_load_dwordx4 v1, s[12:15], s57 offen offset:3072 lds
    v_mfma_f32_16x16x32_bf16 v[236:239], v[28:31], v[220:223], v[236:239]
    s_waitcnt lgkmcnt(4)
    v_mov_b32 v3, v2
    v_add_u32 v2, s59, v1
    s_nop 4
    v_accvgpr_read_b32 v244, a32
    v_accvgpr_read_b32 v245, a33
    v_accvgpr_read_b32 v246, a34
    v_accvgpr_read_b32 v247, a35
    v_accvgpr_read_b32 v248, a36
    v_accvgpr_read_b32 v249, a37
    v_accvgpr_read_b32 v250, a38
    v_accvgpr_read_b32 v251, a39
    v_rcp_f32 v240, v228
    s_nop 0
    v_mul_f32 v244, v244, v240
    v_mul_f32 v245, v245, v240
    v_mul_f32 v246, v246, v240
    v_mul_f32 v247, v247, v240
    v_mul_f32 v248, v248, v240
    v_mul_f32 v249, v249, v240
    v_mul_f32 v250, v250, v240
    v_mul_f32 v251, v251, v240
    v_cvt_pk_bf16_f32 v252, v244, v245
    v_cvt_pk_bf16_f32 v253, v246, v247
    v_cvt_pk_bf16_f32 v254, v248, v249
    v_cvt_pk_bf16_f32 v255, v250, v251
    buffer_store_dwordx4 v[252:255], v1, s[16:19], s69 offen offset:0
    v_accvgpr_read_b32 v244, a40
    v_accvgpr_read_b32 v245, a41
    v_accvgpr_read_b32 v246, a42
    v_accvgpr_read_b32 v247, a43
    v_accvgpr_read_b32 v248, a44
    v_accvgpr_read_b32 v249, a45
    v_accvgpr_read_b32 v250, a46
    v_accvgpr_read_b32 v251, a47
    v_mul_f32 v244, v244, v240
    v_mul_f32 v245, v245, v240
    v_mul_f32 v246, v246, v240
    v_mul_f32 v247, v247, v240
    v_mul_f32 v248, v248, v240
    v_mul_f32 v249, v249, v240
    v_mul_f32 v250, v250, v240
    v_mul_f32 v251, v251, v240
    v_cvt_pk_bf16_f32 v4, v244, v245
    v_cvt_pk_bf16_f32 v5, v246, v247
    v_cvt_pk_bf16_f32 v6, v248, v249
    v_cvt_pk_bf16_f32 v7, v250, v251
    buffer_store_dwordx4 v[4:7], v1, s[16:19], s69 offen offset:1024
    v_accvgpr_read_b32 v244, a48
    v_accvgpr_read_b32 v245, a49
    v_accvgpr_read_b32 v246, a50
    v_accvgpr_read_b32 v247, a51
    v_accvgpr_read_b32 v248, a52
    v_accvgpr_read_b32 v249, a53
    v_accvgpr_read_b32 v250, a54
    v_accvgpr_read_b32 v251, a55
    v_mul_f32 v244, v244, v240
    v_mul_f32 v245, v245, v240
    v_mul_f32 v246, v246, v240
    v_mul_f32 v247, v247, v240
    v_mul_f32 v248, v248, v240
    v_mul_f32 v249, v249, v240
    v_mul_f32 v250, v250, v240
    v_mul_f32 v251, v251, v240
    v_cvt_pk_bf16_f32 v252, v244, v245
    v_cvt_pk_bf16_f32 v253, v246, v247
    v_cvt_pk_bf16_f32 v254, v248, v249
    v_cvt_pk_bf16_f32 v255, v250, v251
    buffer_store_dwordx4 v[252:255], v1, s[16:19], s69 offen offset:2048
    v_accvgpr_read_b32 v244, a56
    v_accvgpr_read_b32 v245, a57
    v_accvgpr_read_b32 v246, a58
    v_accvgpr_read_b32 v247, a59
    v_accvgpr_read_b32 v248, a60
    v_accvgpr_read_b32 v249, a61
    v_accvgpr_read_b32 v250, a62
    v_accvgpr_read_b32 v251, a63
    v_mul_f32 v244, v244, v240
    v_mul_f32 v245, v245, v240
    v_mul_f32 v246, v246, v240
    v_mul_f32 v247, v247, v240
    v_mul_f32 v248, v248, v240
    v_mul_f32 v249, v249, v240
    v_mul_f32 v250, v250, v240
    v_mul_f32 v251, v251, v240
    v_cvt_pk_bf16_f32 v4, v244, v245
    v_cvt_pk_bf16_f32 v5, v246, v247
    v_cvt_pk_bf16_f32 v6, v248, v249
    v_cvt_pk_bf16_f32 v7, v250, v251
    buffer_store_dwordx4 v[4:7], v1, s[16:19], s69 offen offset:3072
    s_lshl_b32 s43, s42, 2
    s_sub_u32 s43, 29, s43
.p2align 6
attn_kernel_b2_loop:
    v_mfma_f32_16x16x32_bf16 v[176:179], a[128:131], v[64:67], v[120:123]
    s_cmp_eq_u32 s43, 1
    ds_read_b128 a[160:163], v3 offset:8192
    ds_read_b128 a[164:167], v3 offset:9216
    v_mfma_f32_16x16x32_bf16 v[184:187], a[128:131], v[80:83], v[124:127]
    s_cbranch_scc1 attn_kernel_b2_m0
attn_kernel_b2_m0_ret:
    ds_read_b128 a[168:171], v3 offset:10240
    v_exp_f32 v16, v144
    v_mfma_f32_16x16x32_bf16 v[176:179], a[132:135], v[68:71], v[176:179]
    ds_read_b128 a[172:175], v3 offset:11264
    v_exp_f32 v17, v145
    v_mfma_f32_16x16x32_bf16 v[184:187], a[132:135], v[84:87], v[184:187]
    s_waitcnt vmcnt(16)
    s_barrier
    ds_read_b128 a[176:179], v3 offset:12288
    v_mfma_f32_16x16x32_bf16 v[176:179], a[136:139], v[72:75], v[176:179]
    s_mov_b32 m0, s54
    v_exp_f32 v18, v146
    v_mfma_f32_16x16x32_bf16 v[184:187], a[136:139], v[88:91], v[184:187]
    s_add_u32 s57, s52, 16384
    ds_read_b128 a[180:183], v3 offset:13312
    v_exp_f32 v19, v147
    v_mfma_f32_16x16x32_bf16 v[176:179], a[140:143], v[76:79], v[176:179]
    ds_read_b128 a[184:187], v3 offset:14336
    v_exp_f32 v20, v148
    v_mfma_f32_16x16x32_bf16 v[184:187], a[140:143], v[92:95], v[184:187]
    s_waitcnt lgkmcnt(7)
    ds_read_b128 a[188:191], v3 offset:15360
    v_exp_f32 v21, v149
    v_mfma_f32_16x16x32_bf16 v[180:183], a[144:147], v[64:67], v[120:123]
    v_exp_f32 v22, v150
    v_mfma_f32_16x16x32_bf16 v[188:191], a[144:147], v[80:83], v[124:127]
    v_exp_f32 v23, v151
    v_mfma_f32_16x16x32_bf16 v[180:183], a[148:151], v[68:71], v[180:183]
    v_cvt_pk_bf16_f32 v200, v16, v17
    v_cvt_pk_bf16_f32 v201, v18, v19
    v_mfma_f32_16x16x32_bf16 v[188:191], a[148:151], v[84:87], v[188:191]
    v_or3_b32 v24, v24, v200, v201
    v_cvt_pk_bf16_f32 v202, v20, v21
    v_mfma_f32_16x16x32_bf16 v[180:183], a[152:155], v[72:75], v[180:183]
    v_cvt_pk_bf16_f32 v203, v22, v23
    v_or3_b32 v24, v24, v202, v203
    v_mfma_f32_16x16x32_bf16 v[188:191], a[152:155], v[88:91], v[188:191]
    buffer_load_dwordx4 v1, s[12:15], s52 offen offset:0 lds
    v_and_b32 v24, s56, v24
    v_cmp_ne_u32 vcc, 0, v24
    v_mfma_f32_16x16x32_bf16 v[180:183], a[156:159], v[76:79], v[180:183]
    s_waitcnt lgkmcnt(4)
    ds_read_b128 a[128:131], v2 offset:0
    ds_read_b128 a[132:135], v2 offset:1024
    v_mfma_f32_16x16x32_bf16 v[188:191], a[156:159], v[92:95], v[188:191]
    s_cbranch_vccnz attn_kernel_b2_r0
attn_kernel_b2_r0_ret:
    ds_read_b128 a[136:139], v2 offset:2048
    ds_read_b128 a[140:143], v2 offset:3072
    v_mfma_f32_16x16x32_bf16 a[64:67], a[160:163], v[200:203], a[64:67]
    ds_read_b128 a[144:147], v2 offset:4096
    ds_read_b128 a[148:151], v2 offset:5120
    v_mfma_f32_16x16x32_bf16 a[96:99], a[160:163], v[204:207], a[96:99]
    ds_read_b128 a[152:155], v2 offset:6144
    ds_read_b128 a[156:159], v2 offset:7168
    v_mfma_f32_16x16x32_bf16 a[68:71], a[164:167], v[200:203], a[68:71]
    v_exp_f32 v16, v184
    v_mfma_f32_16x16x32_bf16 a[100:103], a[164:167], v[204:207], a[100:103]
    s_cmp_eq_u32 s43, 1
    ds_read_b128 a[160:163], v3 offset:24576
    ds_read_b128 a[164:167], v3 offset:25600
    v_mfma_f32_16x16x32_bf16 a[72:75], a[168:171], v[200:203], a[72:75]
    s_cbranch_scc1 attn_kernel_b2_m1
attn_kernel_b2_m1_ret:
    v_exp_f32 v17, v185
    v_mfma_f32_16x16x32_bf16 a[104:107], a[168:171], v[204:207], a[104:107]
    buffer_load_dwordx4 v1, s[12:15], s52 offen offset:1024 lds
    v_mfma_f32_16x16x32_bf16 a[76:79], a[172:175], v[200:203], a[76:79]
    v_exp_f32 v18, v186
    v_mfma_f32_16x16x32_bf16 a[108:111], a[172:175], v[204:207], a[108:111]
    s_waitcnt lgkmcnt(10)
    ds_read_b128 a[168:171], v3 offset:26624
    v_cvt_pk_bf16_f32 v220, v16, v17
    v_mfma_f32_16x16x32_bf16 a[80:83], a[176:179], v[200:203], a[80:83]
    v_exp_f32 v19, v187
    v_mfma_f32_16x16x32_bf16 a[112:115], a[176:179], v[204:207], a[112:115]
    v_exp_f32 v20, v188
    v_mfma_f32_16x16x32_bf16 a[84:87], a[180:183], v[200:203], a[84:87]
    ds_read_b128 a[172:175], v3 offset:27648
    v_cvt_pk_bf16_f32 v221, v18, v19
    v_mfma_f32_16x16x32_bf16 a[116:119], a[180:183], v[204:207], a[116:119]
    ds_read_b128 a[176:179], v3 offset:28672
    v_or_b32 v24, v220, v221
    v_mfma_f32_16x16x32_bf16 a[88:91], a[184:187], v[200:203], a[88:91]
    buffer_load_dwordx4 v1, s[12:15], s52 offen offset:2048 lds
    v_mfma_f32_16x16x32_bf16 a[120:123], a[184:187], v[204:207], a[120:123]
    v_exp_f32 v21, v189
    v_mfma_f32_16x16x32_bf16 a[92:95], a[188:191], v[200:203], a[92:95]
    v_exp_f32 v22, v190
    v_mfma_f32_16x16x32_bf16 a[124:127], a[188:191], v[204:207], a[124:127]
    ds_read_b128 a[180:183], v3 offset:29696
    v_cvt_pk_bf16_f32 v222, v20, v21
    v_mfma_f32_16x16x32_bf16 v[232:235], v[28:31], v[200:203], v[232:235]
    v_exp_f32 v23, v191
    v_mfma_f32_16x16x32_bf16 v[236:239], v[28:31], v[204:207], v[236:239]
    s_waitcnt lgkmcnt(10)
    v_exp_f32 v16, v176
    v_mfma_f32_16x16x32_bf16 v[144:147], a[128:131], v[64:67], v[120:123]
    v_exp_f32 v17, v177
    v_mfma_f32_16x16x32_bf16 v[152:155], a[128:131], v[80:83], v[124:127]
    v_exp_f32 v18, v178
    v_mfma_f32_16x16x32_bf16 v[144:147], a[132:135], v[68:71], v[144:147]
    buffer_load_dwordx4 v1, s[12:15], s52 offen offset:3072 lds
    v_mfma_f32_16x16x32_bf16 v[152:155], a[132:135], v[84:87], v[152:155]
    s_mov_b32 m0, s55
    v_exp_f32 v19, v179
    v_mfma_f32_16x16x32_bf16 v[144:147], a[136:139], v[72:75], v[144:147]
    v_exp_f32 v20, v180
    v_mfma_f32_16x16x32_bf16 v[152:155], a[136:139], v[88:91], v[152:155]
    v_exp_f32 v21, v181
    v_mfma_f32_16x16x32_bf16 v[144:147], a[140:143], v[76:79], v[144:147]
    v_cvt_pk_bf16_f32 v223, v22, v23
    v_or3_b32 v24, v24, v222, v223
    v_mfma_f32_16x16x32_bf16 v[152:155], a[140:143], v[92:95], v[152:155]
    s_waitcnt lgkmcnt(6)
    v_exp_f32 v22, v182
    v_mfma_f32_16x16x32_bf16 v[148:151], a[144:147], v[64:67], v[120:123]
    v_exp_f32 v23, v183
    v_mfma_f32_16x16x32_bf16 v[156:159], a[144:147], v[80:83], v[124:127]
    buffer_load_dwordx4 v1, s[12:15], s57 offen offset:0 lds
    v_mfma_f32_16x16x32_bf16 v[148:151], a[148:151], v[68:71], v[148:151]
    v_cvt_pk_bf16_f32 v216, v16, v17
    v_cvt_pk_bf16_f32 v217, v18, v19
    v_mfma_f32_16x16x32_bf16 v[156:159], a[148:151], v[84:87], v[156:159]
    v_or3_b32 v24, v24, v216, v217
    v_cvt_pk_bf16_f32 v218, v20, v21
    v_mfma_f32_16x16x32_bf16 v[148:151], a[152:155], v[72:75], v[148:151]
    v_cvt_pk_bf16_f32 v219, v22, v23
    v_or3_b32 v24, v24, v218, v219
    v_mfma_f32_16x16x32_bf16 v[156:159], a[152:155], v[88:91], v[156:159]
    s_cmp_eq_u32 s43, 1
    v_and_b32 v24, s56, v24
    v_cmp_ne_u32 vcc, 0, v24
    v_mfma_f32_16x16x32_bf16 v[148:151], a[156:159], v[76:79], v[148:151]
    s_waitcnt lgkmcnt(2)
    ds_read_b128 a[184:187], v3 offset:30720
    ds_read_b128 a[188:191], v3 offset:31744
    v_mfma_f32_16x16x32_bf16 v[156:159], a[156:159], v[92:95], v[156:159]
    s_cbranch_vccnz attn_kernel_b2_r1
attn_kernel_b2_r1_ret:
    ds_read_b128 a[128:131], v2 offset:16384
    ds_read_b128 a[132:135], v2 offset:17408
    v_mfma_f32_16x16x32_bf16 a[64:67], a[160:163], v[216:219], a[64:67]
    s_cbranch_scc1 attn_kernel_b2_m2
attn_kernel_b2_m2_ret:
    ds_read_b128 a[136:139], v2 offset:18432
    ds_read_b128 a[140:143], v2 offset:19456
    v_mfma_f32_16x16x32_bf16 a[96:99], a[160:163], v[220:223], a[96:99]
    buffer_load_dwordx4 v1, s[12:15], s57 offen offset:1024 lds
    v_mfma_f32_16x16x32_bf16 a[68:71], a[164:167], v[216:219], a[68:71]
    s_add_u32 s52, s52, 32768
    v_exp_f32 v16, v152
    v_mfma_f32_16x16x32_bf16 a[100:103], a[164:167], v[220:223], a[100:103]
    s_add_u32 s54, s53, s58
    v_exp_f32 v17, v153
    v_mfma_f32_16x16x32_bf16 a[72:75], a[168:171], v[216:219], a[72:75]
    s_add_u32 s55, s54, 16384
    v_exp_f32 v18, v154
    v_mfma_f32_16x16x32_bf16 a[104:107], a[168:171], v[220:223], a[104:107]
    s_mov_b32 s53, s59
    ds_read_b128 a[144:147], v2 offset:20480
    v_cvt_pk_bf16_f32 v204, v16, v17
    v_mfma_f32_16x16x32_bf16 a[76:79], a[172:175], v[216:219], a[76:79]
    s_add_u32 s59, s59, 32768
    v_exp_f32 v19, v155
    v_mfma_f32_16x16x32_bf16 a[108:111], a[172:175], v[220:223], a[108:111]
    s_waitcnt lgkmcnt(5)
    ds_read_b128 a[148:151], v2 offset:21504
    v_cvt_pk_bf16_f32 v205, v18, v19
    v_mfma_f32_16x16x32_bf16 a[80:83], a[176:179], v[216:219], a[80:83]
    buffer_load_dwordx4 v1, s[12:15], s57 offen offset:2048 lds
    v_mfma_f32_16x16x32_bf16 a[112:115], a[176:179], v[220:223], a[112:115]
    s_cmp_eq_u32 s59, 163840
    ds_read_b128 a[152:155], v2 offset:22528
    v_or_b32 v24, v204, v205
    v_mfma_f32_16x16x32_bf16 a[84:87], a[180:183], v[216:219], a[84:87]
    s_cselect_b32 s59, 0, s59
    v_exp_f32 v20, v156
    v_mfma_f32_16x16x32_bf16 a[116:119], a[180:183], v[220:223], a[116:119]
    s_sub_u32 s43, s43, 1
    v_exp_f32 v21, v157
    v_mfma_f32_16x16x32_bf16 a[88:91], a[184:187], v[216:219], a[88:91]
    s_cmp_lg_u32 s43, 0
    v_exp_f32 v22, v158
    v_mfma_f32_16x16x32_bf16 a[120:123], a[184:187], v[220:223], a[120:123]
    ds_read_b128 a[156:159], v2 offset:23552
    v_cvt_pk_bf16_f32 v206, v20, v21
    v_mfma_f32_16x16x32_bf16 a[92:95], a[188:191], v[216:219], a[92:95]
    v_exp_f32 v23, v159
    v_mfma_f32_16x16x32_bf16 a[124:127], a[188:191], v[220:223], a[124:127]
    v_cvt_pk_bf16_f32 v207, v22, v23
    v_or3_b32 v24, v24, v206, v207
    v_mfma_f32_16x16x32_bf16 v[232:235], v[28:31], v[216:219], v[232:235]
    buffer_load_dwordx4 v1, s[12:15], s57 offen offset:3072 lds
    v_mfma_f32_16x16x32_bf16 v[236:239], v[28:31], v[220:223], v[236:239]
    s_waitcnt lgkmcnt(4)
    v_mov_b32 v3, v2
    v_add_u32 v2, s59, v1
    s_cbranch_scc1 attn_kernel_b2_loop
    s_nop 4
    v_accvgpr_read_b32 v244, a64
    v_accvgpr_read_b32 v245, a65
    v_accvgpr_read_b32 v246, a66
    v_accvgpr_read_b32 v247, a67
    v_accvgpr_read_b32 v248, a68
    v_accvgpr_read_b32 v249, a69
    v_accvgpr_read_b32 v250, a70
    v_accvgpr_read_b32 v251, a71
    v_rcp_f32 v240, v232
    s_nop 0
    v_mul_f32 v244, v244, v240
    v_mul_f32 v245, v245, v240
    v_mul_f32 v246, v246, v240
    v_mul_f32 v247, v247, v240
    v_mul_f32 v248, v248, v240
    v_mul_f32 v249, v249, v240
    v_mul_f32 v250, v250, v240
    v_mul_f32 v251, v251, v240
    v_cvt_pk_bf16_f32 v252, v244, v245
    v_cvt_pk_bf16_f32 v253, v246, v247
    v_cvt_pk_bf16_f32 v254, v248, v249
    v_cvt_pk_bf16_f32 v255, v250, v251
    buffer_store_dwordx4 v[252:255], v1, s[16:19], s70 offen offset:0
    v_accvgpr_read_b32 v244, a72
    v_accvgpr_read_b32 v245, a73
    v_accvgpr_read_b32 v246, a74
    v_accvgpr_read_b32 v247, a75
    v_accvgpr_read_b32 v248, a76
    v_accvgpr_read_b32 v249, a77
    v_accvgpr_read_b32 v250, a78
    v_accvgpr_read_b32 v251, a79
    v_mul_f32 v244, v244, v240
    v_mul_f32 v245, v245, v240
    v_mul_f32 v246, v246, v240
    v_mul_f32 v247, v247, v240
    v_mul_f32 v248, v248, v240
    v_mul_f32 v249, v249, v240
    v_mul_f32 v250, v250, v240
    v_mul_f32 v251, v251, v240
    v_cvt_pk_bf16_f32 v4, v244, v245
    v_cvt_pk_bf16_f32 v5, v246, v247
    v_cvt_pk_bf16_f32 v6, v248, v249
    v_cvt_pk_bf16_f32 v7, v250, v251
    buffer_store_dwordx4 v[4:7], v1, s[16:19], s70 offen offset:1024
    v_accvgpr_read_b32 v244, a80
    v_accvgpr_read_b32 v245, a81
    v_accvgpr_read_b32 v246, a82
    v_accvgpr_read_b32 v247, a83
    v_accvgpr_read_b32 v248, a84
    v_accvgpr_read_b32 v249, a85
    v_accvgpr_read_b32 v250, a86
    v_accvgpr_read_b32 v251, a87
    v_mul_f32 v244, v244, v240
    v_mul_f32 v245, v245, v240
    v_mul_f32 v246, v246, v240
    v_mul_f32 v247, v247, v240
    v_mul_f32 v248, v248, v240
    v_mul_f32 v249, v249, v240
    v_mul_f32 v250, v250, v240
    v_mul_f32 v251, v251, v240
    v_cvt_pk_bf16_f32 v252, v244, v245
    v_cvt_pk_bf16_f32 v253, v246, v247
    v_cvt_pk_bf16_f32 v254, v248, v249
    v_cvt_pk_bf16_f32 v255, v250, v251
    buffer_store_dwordx4 v[252:255], v1, s[16:19], s70 offen offset:2048
    v_accvgpr_read_b32 v244, a88
    v_accvgpr_read_b32 v245, a89
    v_accvgpr_read_b32 v246, a90
    v_accvgpr_read_b32 v247, a91
    v_accvgpr_read_b32 v248, a92
    v_accvgpr_read_b32 v249, a93
    v_accvgpr_read_b32 v250, a94
    v_accvgpr_read_b32 v251, a95
    v_mul_f32 v244, v244, v240
    v_mul_f32 v245, v245, v240
    v_mul_f32 v246, v246, v240
    v_mul_f32 v247, v247, v240
    v_mul_f32 v248, v248, v240
    v_mul_f32 v249, v249, v240
    v_mul_f32 v250, v250, v240
    v_mul_f32 v251, v251, v240
    v_cvt_pk_bf16_f32 v4, v244, v245
    v_cvt_pk_bf16_f32 v5, v246, v247
    v_cvt_pk_bf16_f32 v6, v248, v249
    v_cvt_pk_bf16_f32 v7, v250, v251
    buffer_store_dwordx4 v[4:7], v1, s[16:19], s70 offen offset:3072
    v_and_b32 v24, s56, v24
    v_cmp_ne_u32 vcc, 0, v24
    v_mfma_f32_16x16x32_bf16 v[184:187], a[128:131], v[80:83], v[124:127]
    ds_read_b128 a[160:163], v3 offset:8192
    v_mfma_f32_16x16x32_bf16 v[184:187], a[132:135], v[84:87], v[184:187]
    ds_read_b128 a[164:167], v3 offset:9216
    v_mfma_f32_16x16x32_bf16 v[184:187], a[136:139], v[88:91], v[184:187]
    ds_read_b128 a[168:171], v3 offset:10240
    v_mfma_f32_16x16x32_bf16 v[184:187], a[140:143], v[92:95], v[184:187]
    s_waitcnt lgkmcnt(3)
    ds_read_b128 a[172:175], v3 offset:11264
    v_mfma_f32_16x16x32_bf16 v[188:191], a[144:147], v[80:83], v[124:127]
    ds_read_b128 a[176:179], v3 offset:12288
    v_mfma_f32_16x16x32_bf16 v[188:191], a[148:151], v[84:87], v[188:191]
    ds_read_b128 a[180:183], v3 offset:13312
    v_mfma_f32_16x16x32_bf16 v[188:191], a[152:155], v[88:91], v[188:191]
    ds_read_b128 a[184:187], v3 offset:14336
    v_mfma_f32_16x16x32_bf16 v[188:191], a[156:159], v[92:95], v[188:191]
    s_waitcnt lgkmcnt(3)
    ds_read_b128 a[188:191], v3 offset:15360
    s_cbranch_vccnz attn_kernel_b1_r0
attn_kernel_b1_r0_ret:
    ds_read_b128 a[128:131], v3 offset:24576
    ds_read_b128 a[132:135], v3 offset:25600
    ds_read_b128 a[136:139], v3 offset:26624
    ds_read_b128 a[140:143], v3 offset:27648
    ds_read_b128 a[144:147], v3 offset:28672
    ds_read_b128 a[148:151], v3 offset:29696
    ds_read_b128 a[152:155], v3 offset:30720
    ds_read_b128 a[156:159], v3 offset:31744
    v_mfma_f32_16x16x32_bf16 a[96:99], a[160:163], v[204:207], a[96:99]
    v_mfma_f32_16x16x32_bf16 a[100:103], a[164:167], v[204:207], a[100:103]
    v_mfma_f32_16x16x32_bf16 a[104:107], a[168:171], v[204:207], a[104:107]
    v_mfma_f32_16x16x32_bf16 a[108:111], a[172:175], v[204:207], a[108:111]
    s_waitcnt lgkmcnt(8)
    v_mfma_f32_16x16x32_bf16 a[112:115], a[176:179], v[204:207], a[112:115]
    v_add_f32 v184, v104, v184
    v_add_f32 v185, v105, v185
    v_add_f32 v186, v106, v186
    v_add_f32 v187, v107, v187
    v_add_f32 v188, v108, v188
    v_add_f32 v189, v109, v189
    v_add_f32 v190, v110, v190
    v_add_f32 v191, v111, v191
    v_mfma_f32_16x16x32_bf16 a[116:119], a[180:183], v[204:207], a[116:119]
    v_exp_f32 v16, v184
    v_exp_f32 v17, v185
    s_nop 0
    v_cvt_pk_bf16_f32 v220, v16, v17
    v_mfma_f32_16x16x32_bf16 a[120:123], a[184:187], v[204:207], a[120:123]
    v_exp_f32 v18, v186
    v_exp_f32 v19, v187
    s_nop 0
    v_cvt_pk_bf16_f32 v221, v18, v19
    v_mfma_f32_16x16x32_bf16 a[124:127], a[188:191], v[204:207], a[124:127]
    v_or_b32 v24, v220, v221
    v_exp_f32 v20, v188
    v_exp_f32 v21, v189
    s_nop 0
    v_mfma_f32_16x16x32_bf16 v[236:239], v[28:31], v[204:207], v[236:239]
    s_waitcnt lgkmcnt(4)
    v_cvt_pk_bf16_f32 v222, v20, v21
    v_exp_f32 v22, v190
    v_exp_f32 v23, v191
    s_nop 0
    v_cvt_pk_bf16_f32 v223, v22, v23
    v_or3_b32 v24, v24, v222, v223
    v_and_b32 v24, s56, v24
    v_cmp_ne_u32 vcc, 0, v24
    s_cbranch_vccnz attn_kernel_b1_r1
attn_kernel_b1_r1_ret:
    v_mfma_f32_16x16x32_bf16 a[96:99], a[128:131], v[220:223], a[96:99]
    v_mfma_f32_16x16x32_bf16 a[100:103], a[132:135], v[220:223], a[100:103]
    v_mfma_f32_16x16x32_bf16 a[104:107], a[136:139], v[220:223], a[104:107]
    v_mfma_f32_16x16x32_bf16 a[108:111], a[140:143], v[220:223], a[108:111]
    s_waitcnt lgkmcnt(0)
    v_mfma_f32_16x16x32_bf16 a[112:115], a[144:147], v[220:223], a[112:115]
    v_mfma_f32_16x16x32_bf16 a[116:119], a[148:151], v[220:223], a[116:119]
    v_mfma_f32_16x16x32_bf16 a[120:123], a[152:155], v[220:223], a[120:123]
    v_mfma_f32_16x16x32_bf16 a[124:127], a[156:159], v[220:223], a[124:127]
    v_mfma_f32_16x16x32_bf16 v[236:239], v[28:31], v[220:223], v[236:239]
    s_nop 4
    v_accvgpr_read_b32 v244, a96
    v_accvgpr_read_b32 v245, a97
    v_accvgpr_read_b32 v246, a98
    v_accvgpr_read_b32 v247, a99
    v_accvgpr_read_b32 v248, a100
    v_accvgpr_read_b32 v249, a101
    v_accvgpr_read_b32 v250, a102
    v_accvgpr_read_b32 v251, a103
    v_rcp_f32 v240, v236
    s_nop 0
    v_mul_f32 v244, v244, v240
    v_mul_f32 v245, v245, v240
    v_mul_f32 v246, v246, v240
    v_mul_f32 v247, v247, v240
    v_mul_f32 v248, v248, v240
    v_mul_f32 v249, v249, v240
    v_mul_f32 v250, v250, v240
    v_mul_f32 v251, v251, v240
    v_cvt_pk_bf16_f32 v252, v244, v245
    v_cvt_pk_bf16_f32 v253, v246, v247
    v_cvt_pk_bf16_f32 v254, v248, v249
    v_cvt_pk_bf16_f32 v255, v250, v251
    buffer_store_dwordx4 v[252:255], v1, s[16:19], s71 offen offset:0
    v_accvgpr_read_b32 v244, a104
    v_accvgpr_read_b32 v245, a105
    v_accvgpr_read_b32 v246, a106
    v_accvgpr_read_b32 v247, a107
    v_accvgpr_read_b32 v248, a108
    v_accvgpr_read_b32 v249, a109
    v_accvgpr_read_b32 v250, a110
    v_accvgpr_read_b32 v251, a111
    v_mul_f32 v244, v244, v240
    v_mul_f32 v245, v245, v240
    v_mul_f32 v246, v246, v240
    v_mul_f32 v247, v247, v240
    v_mul_f32 v248, v248, v240
    v_mul_f32 v249, v249, v240
    v_mul_f32 v250, v250, v240
    v_mul_f32 v251, v251, v240
    v_cvt_pk_bf16_f32 v4, v244, v245
    v_cvt_pk_bf16_f32 v5, v246, v247
    v_cvt_pk_bf16_f32 v6, v248, v249
    v_cvt_pk_bf16_f32 v7, v250, v251
    buffer_store_dwordx4 v[4:7], v1, s[16:19], s71 offen offset:1024
    v_accvgpr_read_b32 v244, a112
    v_accvgpr_read_b32 v245, a113
    v_accvgpr_read_b32 v246, a114
    v_accvgpr_read_b32 v247, a115
    v_accvgpr_read_b32 v248, a116
    v_accvgpr_read_b32 v249, a117
    v_accvgpr_read_b32 v250, a118
    v_accvgpr_read_b32 v251, a119
    v_mul_f32 v244, v244, v240
    v_mul_f32 v245, v245, v240
    v_mul_f32 v246, v246, v240
    v_mul_f32 v247, v247, v240
    v_mul_f32 v248, v248, v240
    v_mul_f32 v249, v249, v240
    v_mul_f32 v250, v250, v240
    v_mul_f32 v251, v251, v240
    v_cvt_pk_bf16_f32 v252, v244, v245
    v_cvt_pk_bf16_f32 v253, v246, v247
    v_cvt_pk_bf16_f32 v254, v248, v249
    v_cvt_pk_bf16_f32 v255, v250, v251
    buffer_store_dwordx4 v[252:255], v1, s[16:19], s71 offen offset:2048
    v_accvgpr_read_b32 v244, a120
    v_accvgpr_read_b32 v245, a121
    v_accvgpr_read_b32 v246, a122
    v_accvgpr_read_b32 v247, a123
    v_accvgpr_read_b32 v248, a124
    v_accvgpr_read_b32 v249, a125
    v_accvgpr_read_b32 v250, a126
    v_accvgpr_read_b32 v251, a127
    v_mul_f32 v244, v244, v240
    v_mul_f32 v245, v245, v240
    v_mul_f32 v246, v246, v240
    v_mul_f32 v247, v247, v240
    v_mul_f32 v248, v248, v240
    v_mul_f32 v249, v249, v240
    v_mul_f32 v250, v250, v240
    v_mul_f32 v251, v251, v240
    v_cvt_pk_bf16_f32 v4, v244, v245
    v_cvt_pk_bf16_f32 v5, v246, v247
    v_cvt_pk_bf16_f32 v6, v248, v249
    v_cvt_pk_bf16_f32 v7, v250, v251
    buffer_store_dwordx4 v[4:7], v1, s[16:19], s71 offen offset:3072
attn_kernel_end:
    s_endpgm
attn_kernel_switch:
    v_mov_b32 v2, v1
    s_mov_b32 s4, s12
    v_mov_b32 v3, v1
    s_mov_b32 s5, s13
    v_mov_b32 v4, v1
    s_mov_b32 s6, s14
    v_mov_b32 v5, v1
    s_mov_b32 s7, s15
    s_mov_b32 s7, 0x00020000
    s_lshl_b32 s45, s40, 12
    s_add_u32 s44, s45, 16384
    s_mov_b32 s46, 32768
    s_mov_b32 s51, s45
    s_mov_b32 s50, s44
    s_mov_b32 s10, 0
    s_mov_b32 s62, 0x30000
    s_branch attn_kernel_switch_ret
attn_kernel_b4_m0:
    s_nop 7
    v_add_f32 v128, v96, v128
    v_add_f32 v129, v97, v129
    v_add_f32 v130, v98, v130
    v_add_f32 v131, v99, v131
    v_add_f32 v132, v100, v132
    v_add_f32 v133, v101, v133
    v_add_f32 v134, v102, v134
    v_add_f32 v135, v103, v135
    s_branch attn_kernel_b4_m0_ret
attn_kernel_b4_m1:
    s_nop 7
    v_add_f32 v160, v104, v160
    v_add_f32 v161, v105, v161
    v_add_f32 v162, v106, v162
    v_add_f32 v163, v107, v163
    v_add_f32 v164, v108, v164
    v_add_f32 v165, v109, v165
    v_add_f32 v166, v110, v166
    v_add_f32 v167, v111, v167
    s_branch attn_kernel_b4_m1_ret
attn_kernel_b2_m0:
    s_nop 7
    v_add_f32 v144, v96, v144
    v_add_f32 v145, v97, v145
    v_add_f32 v146, v98, v146
    v_add_f32 v147, v99, v147
    v_add_f32 v148, v100, v148
    v_add_f32 v149, v101, v149
    v_add_f32 v150, v102, v150
    v_add_f32 v151, v103, v151
    s_branch attn_kernel_b2_m0_ret
attn_kernel_b2_m1:
    s_nop 7
    v_add_f32 v176, v104, v176
    v_add_f32 v177, v105, v177
    v_add_f32 v178, v106, v178
    v_add_f32 v179, v107, v179
    v_add_f32 v180, v108, v180
    v_add_f32 v181, v109, v181
    v_add_f32 v182, v110, v182
    v_add_f32 v183, v111, v183
    s_branch attn_kernel_b2_m1_ret
attn_kernel_b2_m2:
    s_nop 7
    v_add_f32 v152, v96, v152
    v_add_f32 v153, v97, v153
    v_add_f32 v154, v98, v154
    v_add_f32 v155, v99, v155
    v_add_f32 v156, v100, v156
    v_add_f32 v157, v101, v157
    v_add_f32 v158, v102, v158
    v_add_f32 v159, v103, v159
    s_branch attn_kernel_b2_m2_ret
attn_kernel_b4_r0:
    s_nop 7
    v_max3_f32 v240, v128, v129, v130
    v_max3_f32 v240, v131, v132, v240
    v_max3_f32 v240, v133, v134, v240
    v_max_f32 v240, v135, v240
    v_mov_b32 v241, v240
    s_nop 1
    v_permlane16_swap_b32 v240, v241
    s_nop 1
    v_max_f32 v240, v240, v241
    v_mov_b32 v241, v240
    s_nop 1
    v_permlane32_swap_b32 v240, v241
    s_nop 1
    v_max_f32 v240, v240, v241
    v_add_f32 v240, 0x41c00000, v240
    v_max_f32 v240, 0, v240
    v_exp_f32 v242, -v240
    v_sub_f32 v112, v112, v240
    v_sub_f32 v113, v113, v240
    v_sub_f32 v114, v114, v240
    v_sub_f32 v115, v115, v240
    v_sub_f32 v128, v128, v240
    v_sub_f32 v129, v129, v240
    v_sub_f32 v130, v130, v240
    v_sub_f32 v131, v131, v240
    v_sub_f32 v132, v132, v240
    v_sub_f32 v133, v133, v240
    v_sub_f32 v134, v134, v240
    v_sub_f32 v135, v135, v240
    v_sub_f32 v160, v160, v240
    v_sub_f32 v161, v161, v240
    v_sub_f32 v162, v162, v240
    v_sub_f32 v163, v163, v240
    v_sub_f32 v164, v164, v240
    v_sub_f32 v165, v165, v240
    v_sub_f32 v166, v166, v240
    v_sub_f32 v167, v167, v240
    v_mul_f32 v224, v224, v242
    v_mul_f32 v225, v225, v242
    v_mul_f32 v226, v226, v242
    v_mul_f32 v227, v227, v242
    v_accvgpr_read_b32 v241, a0
    v_mul_f32 v241, v241, v242
    v_accvgpr_write_b32 a0, v241
    v_accvgpr_read_b32 v241, a1
    v_mul_f32 v241, v241, v242
    v_accvgpr_write_b32 a1, v241
    v_accvgpr_read_b32 v241, a2
    v_mul_f32 v241, v241, v242
    v_accvgpr_write_b32 a2, v241
    v_accvgpr_read_b32 v241, a3
    v_mul_f32 v241, v241, v242
    v_accvgpr_write_b32 a3, v241
    v_accvgpr_read_b32 v241, a4
    v_mul_f32 v241, v241, v242
    v_accvgpr_write_b32 a4, v241
    v_accvgpr_read_b32 v241, a5
    v_mul_f32 v241, v241, v242
    v_accvgpr_write_b32 a5, v241
    v_accvgpr_read_b32 v241, a6
    v_mul_f32 v241, v241, v242
    v_accvgpr_write_b32 a6, v241
    v_accvgpr_read_b32 v241, a7
    v_mul_f32 v241, v241, v242
    v_accvgpr_write_b32 a7, v241
    v_accvgpr_read_b32 v241, a8
    v_mul_f32 v241, v241, v242
    v_accvgpr_write_b32 a8, v241
    v_accvgpr_read_b32 v241, a9
    v_mul_f32 v241, v241, v242
    v_accvgpr_write_b32 a9, v241
    v_accvgpr_read_b32 v241, a10
    v_mul_f32 v241, v241, v242
    v_accvgpr_write_b32 a10, v241
    v_accvgpr_read_b32 v241, a11
    v_mul_f32 v241, v241, v242
    v_accvgpr_write_b32 a11, v241
    v_accvgpr_read_b32 v241, a12
    v_mul_f32 v241, v241, v242
    v_accvgpr_write_b32 a12, v241
    v_accvgpr_read_b32 v241, a13
    v_mul_f32 v241, v241, v242
    v_accvgpr_write_b32 a13, v241
    v_accvgpr_read_b32 v241, a14
    v_mul_f32 v241, v241, v242
    v_accvgpr_write_b32 a14, v241
    v_accvgpr_read_b32 v241, a15
    v_mul_f32 v241, v241, v242
    v_accvgpr_write_b32 a15, v241
    v_accvgpr_read_b32 v241, a16
    v_mul_f32 v241, v241, v242
    v_accvgpr_write_b32 a16, v241
    v_accvgpr_read_b32 v241, a17
    v_mul_f32 v241, v241, v242
    v_accvgpr_write_b32 a17, v241
    v_accvgpr_read_b32 v241, a18
    v_mul_f32 v241, v241, v242
    v_accvgpr_write_b32 a18, v241
    v_accvgpr_read_b32 v241, a19
    v_mul_f32 v241, v241, v242
    v_accvgpr_write_b32 a19, v241
    v_accvgpr_read_b32 v241, a20
    v_mul_f32 v241, v241, v242
    v_accvgpr_write_b32 a20, v241
    v_accvgpr_read_b32 v241, a21
    v_mul_f32 v241, v241, v242
    v_accvgpr_write_b32 a21, v241
    v_accvgpr_read_b32 v241, a22
    v_mul_f32 v241, v241, v242
    v_accvgpr_write_b32 a22, v241
    v_accvgpr_read_b32 v241, a23
    v_mul_f32 v241, v241, v242
    v_accvgpr_write_b32 a23, v241
    v_accvgpr_read_b32 v241, a24
    v_mul_f32 v241, v241, v242
    v_accvgpr_write_b32 a24, v241
    v_accvgpr_read_b32 v241, a25
    v_mul_f32 v241, v241, v242
    v_accvgpr_write_b32 a25, v241
    v_accvgpr_read_b32 v241, a26
    v_mul_f32 v241, v241, v242
    v_accvgpr_write_b32 a26, v241
    v_accvgpr_read_b32 v241, a27
    v_mul_f32 v241, v241, v242
    v_accvgpr_write_b32 a27, v241
    v_accvgpr_read_b32 v241, a28
    v_mul_f32 v241, v241, v242
    v_accvgpr_write_b32 a28, v241
    v_accvgpr_read_b32 v241, a29
    v_mul_f32 v241, v241, v242
    v_accvgpr_write_b32 a29, v241
    v_accvgpr_read_b32 v241, a30
    v_mul_f32 v241, v241, v242
    v_accvgpr_write_b32 a30, v241
    v_accvgpr_read_b32 v241, a31
    v_mul_f32 v241, v241, v242
    v_accvgpr_write_b32 a31, v241
    v_exp_f32 v244, v128
    v_exp_f32 v245, v129
    s_nop 0
    v_cvt_pk_bf16_f32 v192, v244, v245
    v_exp_f32 v244, v130
    v_exp_f32 v245, v131
    s_nop 0
    v_cvt_pk_bf16_f32 v193, v244, v245
    v_exp_f32 v244, v132
    v_exp_f32 v245, v133
    s_nop 0
    v_cvt_pk_bf16_f32 v194, v244, v245
    v_exp_f32 v244, v134
    v_exp_f32 v245, v135
    s_nop 0
    v_cvt_pk_bf16_f32 v195, v244, v245
    v_max3_f32 v240, v136, v137, v138
    v_max3_f32 v240, v139, v140, v240
    v_max3_f32 v240, v141, v142, v240
    v_max_f32 v240, v143, v240
    v_mov_b32 v241, v240
    s_nop 1
    v_permlane16_swap_b32 v240, v241
    s_nop 1
    v_max_f32 v240, v240, v241
    v_mov_b32 v241, v240
    s_nop 1
    v_permlane32_swap_b32 v240, v241
    s_nop 1
    v_max_f32 v240, v240, v241
    v_add_f32 v240, 0x41c00000, v240
    v_max_f32 v240, 0, v240
    v_exp_f32 v242, -v240
    v_sub_f32 v116, v116, v240
    v_sub_f32 v117, v117, v240
    v_sub_f32 v118, v118, v240
    v_sub_f32 v119, v119, v240
    v_sub_f32 v136, v136, v240
    v_sub_f32 v137, v137, v240
    v_sub_f32 v138, v138, v240
    v_sub_f32 v139, v139, v240
    v_sub_f32 v140, v140, v240
    v_sub_f32 v141, v141, v240
    v_sub_f32 v142, v142, v240
    v_sub_f32 v143, v143, v240
    v_sub_f32 v168, v168, v240
    v_sub_f32 v169, v169, v240
    v_sub_f32 v170, v170, v240
    v_sub_f32 v171, v171, v240
    v_sub_f32 v172, v172, v240
    v_sub_f32 v173, v173, v240
    v_sub_f32 v174, v174, v240
    v_sub_f32 v175, v175, v240
    v_mul_f32 v228, v228, v242
    v_mul_f32 v229, v229, v242
    v_mul_f32 v230, v230, v242
    v_mul_f32 v231, v231, v242
    v_accvgpr_read_b32 v241, a32
    v_mul_f32 v241, v241, v242
    v_accvgpr_write_b32 a32, v241
    v_accvgpr_read_b32 v241, a33
    v_mul_f32 v241, v241, v242
    v_accvgpr_write_b32 a33, v241
    v_accvgpr_read_b32 v241, a34
    v_mul_f32 v241, v241, v242
    v_accvgpr_write_b32 a34, v241
    v_accvgpr_read_b32 v241, a35
    v_mul_f32 v241, v241, v242
    v_accvgpr_write_b32 a35, v241
    v_accvgpr_read_b32 v241, a36
    v_mul_f32 v241, v241, v242
    v_accvgpr_write_b32 a36, v241
    v_accvgpr_read_b32 v241, a37
    v_mul_f32 v241, v241, v242
    v_accvgpr_write_b32 a37, v241
    v_accvgpr_read_b32 v241, a38
    v_mul_f32 v241, v241, v242
    v_accvgpr_write_b32 a38, v241
    v_accvgpr_read_b32 v241, a39
    v_mul_f32 v241, v241, v242
    v_accvgpr_write_b32 a39, v241
    v_accvgpr_read_b32 v241, a40
    v_mul_f32 v241, v241, v242
    v_accvgpr_write_b32 a40, v241
    v_accvgpr_read_b32 v241, a41
    v_mul_f32 v241, v241, v242
    v_accvgpr_write_b32 a41, v241
    v_accvgpr_read_b32 v241, a42
    v_mul_f32 v241, v241, v242
    v_accvgpr_write_b32 a42, v241
    v_accvgpr_read_b32 v241, a43
    v_mul_f32 v241, v241, v242
    v_accvgpr_write_b32 a43, v241
    v_accvgpr_read_b32 v241, a44
    v_mul_f32 v241, v241, v242
    v_accvgpr_write_b32 a44, v241
    v_accvgpr_read_b32 v241, a45
    v_mul_f32 v241, v241, v242
    v_accvgpr_write_b32 a45, v241
    v_accvgpr_read_b32 v241, a46
    v_mul_f32 v241, v241, v242
    v_accvgpr_write_b32 a46, v241
    v_accvgpr_read_b32 v241, a47
    v_mul_f32 v241, v241, v242
    v_accvgpr_write_b32 a47, v241
    v_accvgpr_read_b32 v241, a48
    v_mul_f32 v241, v241, v242
    v_accvgpr_write_b32 a48, v241
    v_accvgpr_read_b32 v241, a49
    v_mul_f32 v241, v241, v242
    v_accvgpr_write_b32 a49, v241
    v_accvgpr_read_b32 v241, a50
    v_mul_f32 v241, v241, v242
    v_accvgpr_write_b32 a50, v241
    v_accvgpr_read_b32 v241, a51
    v_mul_f32 v241, v241, v242
    v_accvgpr_write_b32 a51, v241
    v_accvgpr_read_b32 v241, a52
    v_mul_f32 v241, v241, v242
    v_accvgpr_write_b32 a52, v241
    v_accvgpr_read_b32 v241, a53
    v_mul_f32 v241, v241, v242
    v_accvgpr_write_b32 a53, v241
    v_accvgpr_read_b32 v241, a54
    v_mul_f32 v241, v241, v242
    v_accvgpr_write_b32 a54, v241
    v_accvgpr_read_b32 v241, a55
    v_mul_f32 v241, v241, v242
    v_accvgpr_write_b32 a55, v241
    v_accvgpr_read_b32 v241, a56
    v_mul_f32 v241, v241, v242
    v_accvgpr_write_b32 a56, v241
    v_accvgpr_read_b32 v241, a57
    v_mul_f32 v241, v241, v242
    v_accvgpr_write_b32 a57, v241
    v_accvgpr_read_b32 v241, a58
    v_mul_f32 v241, v241, v242
    v_accvgpr_write_b32 a58, v241
    v_accvgpr_read_b32 v241, a59
    v_mul_f32 v241, v241, v242
    v_accvgpr_write_b32 a59, v241
    v_accvgpr_read_b32 v241, a60
    v_mul_f32 v241, v241, v242
    v_accvgpr_write_b32 a60, v241
    v_accvgpr_read_b32 v241, a61
    v_mul_f32 v241, v241, v242
    v_accvgpr_write_b32 a61, v241
    v_accvgpr_read_b32 v241, a62
    v_mul_f32 v241, v241, v242
    v_accvgpr_write_b32 a62, v241
    v_accvgpr_read_b32 v241, a63
    v_mul_f32 v241, v241, v242
    v_accvgpr_write_b32 a63, v241
    v_exp_f32 v244, v136
    v_exp_f32 v245, v137
    s_nop 0
    v_cvt_pk_bf16_f32 v196, v244, v245
    v_exp_f32 v244, v138
    v_exp_f32 v245, v139
    s_nop 0
    v_cvt_pk_bf16_f32 v197, v244, v245
    v_exp_f32 v244, v140
    v_exp_f32 v245, v141
    s_nop 0
    v_cvt_pk_bf16_f32 v198, v244, v245
    v_exp_f32 v244, v142
    v_exp_f32 v245, v143
    s_nop 0
    v_cvt_pk_bf16_f32 v199, v244, v245
    v_max3_f32 v240, v144, v145, v146
    v_max3_f32 v240, v147, v148, v240
    v_max3_f32 v240, v149, v150, v240
    v_max_f32 v240, v151, v240
    v_mov_b32 v241, v240
    s_nop 1
    v_permlane16_swap_b32 v240, v241
    s_nop 1
    v_max_f32 v240, v240, v241
    v_mov_b32 v241, v240
    s_nop 1
    v_permlane32_swap_b32 v240, v241
    s_nop 1
    v_max_f32 v240, v240, v241
    v_add_f32 v240, 0x41c00000, v240
    v_max_f32 v240, 0, v240
    v_exp_f32 v242, -v240
    v_sub_f32 v120, v120, v240
    v_sub_f32 v121, v121, v240
    v_sub_f32 v122, v122, v240
    v_sub_f32 v123, v123, v240
    v_sub_f32 v144, v144, v240
    v_sub_f32 v145, v145, v240
    v_sub_f32 v146, v146, v240
    v_sub_f32 v147, v147, v240
    v_sub_f32 v148, v148, v240
    v_sub_f32 v149, v149, v240
    v_sub_f32 v150, v150, v240
    v_sub_f32 v151, v151, v240
    v_sub_f32 v176, v176, v240
    v_sub_f32 v177, v177, v240
    v_sub_f32 v178, v178, v240
    v_sub_f32 v179, v179, v240
    v_sub_f32 v180, v180, v240
    v_sub_f32 v181, v181, v240
    v_sub_f32 v182, v182, v240
    v_sub_f32 v183, v183, v240
    v_mul_f32 v232, v232, v242
    v_mul_f32 v233, v233, v242
    v_mul_f32 v234, v234, v242
    v_mul_f32 v235, v235, v242
    v_accvgpr_read_b32 v241, a64
    v_mul_f32 v241, v241, v242
    v_accvgpr_write_b32 a64, v241
    v_accvgpr_read_b32 v241, a65
    v_mul_f32 v241, v241, v242
    v_accvgpr_write_b32 a65, v241
    v_accvgpr_read_b32 v241, a66
    v_mul_f32 v241, v241, v242
    v_accvgpr_write_b32 a66, v241
    v_accvgpr_read_b32 v241, a67
    v_mul_f32 v241, v241, v242
    v_accvgpr_write_b32 a67, v241
    v_accvgpr_read_b32 v241, a68
    v_mul_f32 v241, v241, v242
    v_accvgpr_write_b32 a68, v241
    v_accvgpr_read_b32 v241, a69
    v_mul_f32 v241, v241, v242
    v_accvgpr_write_b32 a69, v241
    v_accvgpr_read_b32 v241, a70
    v_mul_f32 v241, v241, v242
    v_accvgpr_write_b32 a70, v241
    v_accvgpr_read_b32 v241, a71
    v_mul_f32 v241, v241, v242
    v_accvgpr_write_b32 a71, v241
    v_accvgpr_read_b32 v241, a72
    v_mul_f32 v241, v241, v242
    v_accvgpr_write_b32 a72, v241
    v_accvgpr_read_b32 v241, a73
    v_mul_f32 v241, v241, v242
    v_accvgpr_write_b32 a73, v241
    v_accvgpr_read_b32 v241, a74
    v_mul_f32 v241, v241, v242
    v_accvgpr_write_b32 a74, v241
    v_accvgpr_read_b32 v241, a75
    v_mul_f32 v241, v241, v242
    v_accvgpr_write_b32 a75, v241
    v_accvgpr_read_b32 v241, a76
    v_mul_f32 v241, v241, v242
    v_accvgpr_write_b32 a76, v241
    v_accvgpr_read_b32 v241, a77
    v_mul_f32 v241, v241, v242
    v_accvgpr_write_b32 a77, v241
    v_accvgpr_read_b32 v241, a78
    v_mul_f32 v241, v241, v242
    v_accvgpr_write_b32 a78, v241
    v_accvgpr_read_b32 v241, a79
    v_mul_f32 v241, v241, v242
    v_accvgpr_write_b32 a79, v241
    v_accvgpr_read_b32 v241, a80
    v_mul_f32 v241, v241, v242
    v_accvgpr_write_b32 a80, v241
    v_accvgpr_read_b32 v241, a81
    v_mul_f32 v241, v241, v242
    v_accvgpr_write_b32 a81, v241
    v_accvgpr_read_b32 v241, a82
    v_mul_f32 v241, v241, v242
    v_accvgpr_write_b32 a82, v241
    v_accvgpr_read_b32 v241, a83
    v_mul_f32 v241, v241, v242
    v_accvgpr_write_b32 a83, v241
    v_accvgpr_read_b32 v241, a84
    v_mul_f32 v241, v241, v242
    v_accvgpr_write_b32 a84, v241
    v_accvgpr_read_b32 v241, a85
    v_mul_f32 v241, v241, v242
    v_accvgpr_write_b32 a85, v241
    v_accvgpr_read_b32 v241, a86
    v_mul_f32 v241, v241, v242
    v_accvgpr_write_b32 a86, v241
    v_accvgpr_read_b32 v241, a87
    v_mul_f32 v241, v241, v242
    v_accvgpr_write_b32 a87, v241
    v_accvgpr_read_b32 v241, a88
    v_mul_f32 v241, v241, v242
    v_accvgpr_write_b32 a88, v241
    v_accvgpr_read_b32 v241, a89
    v_mul_f32 v241, v241, v242
    v_accvgpr_write_b32 a89, v241
    v_accvgpr_read_b32 v241, a90
    v_mul_f32 v241, v241, v242
    v_accvgpr_write_b32 a90, v241
    v_accvgpr_read_b32 v241, a91
    v_mul_f32 v241, v241, v242
    v_accvgpr_write_b32 a91, v241
    v_accvgpr_read_b32 v241, a92
    v_mul_f32 v241, v241, v242
    v_accvgpr_write_b32 a92, v241
    v_accvgpr_read_b32 v241, a93
    v_mul_f32 v241, v241, v242
    v_accvgpr_write_b32 a93, v241
    v_accvgpr_read_b32 v241, a94
    v_mul_f32 v241, v241, v242
    v_accvgpr_write_b32 a94, v241
    v_accvgpr_read_b32 v241, a95
    v_mul_f32 v241, v241, v242
    v_accvgpr_write_b32 a95, v241
    v_exp_f32 v244, v144
    v_exp_f32 v245, v145
    s_nop 0
    v_cvt_pk_bf16_f32 v200, v244, v245
    v_exp_f32 v244, v146
    v_exp_f32 v245, v147
    s_nop 0
    v_cvt_pk_bf16_f32 v201, v244, v245
    v_exp_f32 v244, v148
    v_exp_f32 v245, v149
    s_nop 0
    v_cvt_pk_bf16_f32 v202, v244, v245
    v_exp_f32 v244, v150
    v_exp_f32 v245, v151
    s_nop 0
    v_cvt_pk_bf16_f32 v203, v244, v245
    v_max3_f32 v240, v152, v153, v154
    v_max3_f32 v240, v155, v156, v240
    v_max3_f32 v240, v157, v158, v240
    v_max_f32 v240, v159, v240
    v_mov_b32 v241, v240
    s_nop 1
    v_permlane16_swap_b32 v240, v241
    s_nop 1
    v_max_f32 v240, v240, v241
    v_mov_b32 v241, v240
    s_nop 1
    v_permlane32_swap_b32 v240, v241
    s_nop 1
    v_max_f32 v240, v240, v241
    v_add_f32 v240, 0x41c00000, v240
    v_max_f32 v240, 0, v240
    v_exp_f32 v242, -v240
    v_sub_f32 v124, v124, v240
    v_sub_f32 v125, v125, v240
    v_sub_f32 v126, v126, v240
    v_sub_f32 v127, v127, v240
    v_sub_f32 v152, v152, v240
    v_sub_f32 v153, v153, v240
    v_sub_f32 v154, v154, v240
    v_sub_f32 v155, v155, v240
    v_sub_f32 v156, v156, v240
    v_sub_f32 v157, v157, v240
    v_sub_f32 v158, v158, v240
    v_sub_f32 v159, v159, v240
    v_sub_f32 v184, v184, v240
    v_sub_f32 v185, v185, v240
    v_sub_f32 v186, v186, v240
    v_sub_f32 v187, v187, v240
    v_sub_f32 v188, v188, v240
    v_sub_f32 v189, v189, v240
    v_sub_f32 v190, v190, v240
    v_sub_f32 v191, v191, v240
    v_mul_f32 v236, v236, v242
    v_mul_f32 v237, v237, v242
    v_mul_f32 v238, v238, v242
    v_mul_f32 v239, v239, v242
    v_accvgpr_read_b32 v241, a96
    v_mul_f32 v241, v241, v242
    v_accvgpr_write_b32 a96, v241
    v_accvgpr_read_b32 v241, a97
    v_mul_f32 v241, v241, v242
    v_accvgpr_write_b32 a97, v241
    v_accvgpr_read_b32 v241, a98
    v_mul_f32 v241, v241, v242
    v_accvgpr_write_b32 a98, v241
    v_accvgpr_read_b32 v241, a99
    v_mul_f32 v241, v241, v242
    v_accvgpr_write_b32 a99, v241
    v_accvgpr_read_b32 v241, a100
    v_mul_f32 v241, v241, v242
    v_accvgpr_write_b32 a100, v241
    v_accvgpr_read_b32 v241, a101
    v_mul_f32 v241, v241, v242
    v_accvgpr_write_b32 a101, v241
    v_accvgpr_read_b32 v241, a102
    v_mul_f32 v241, v241, v242
    v_accvgpr_write_b32 a102, v241
    v_accvgpr_read_b32 v241, a103
    v_mul_f32 v241, v241, v242
    v_accvgpr_write_b32 a103, v241
    v_accvgpr_read_b32 v241, a104
    v_mul_f32 v241, v241, v242
    v_accvgpr_write_b32 a104, v241
    v_accvgpr_read_b32 v241, a105
    v_mul_f32 v241, v241, v242
    v_accvgpr_write_b32 a105, v241
    v_accvgpr_read_b32 v241, a106
    v_mul_f32 v241, v241, v242
    v_accvgpr_write_b32 a106, v241
    v_accvgpr_read_b32 v241, a107
    v_mul_f32 v241, v241, v242
    v_accvgpr_write_b32 a107, v241
    v_accvgpr_read_b32 v241, a108
    v_mul_f32 v241, v241, v242
    v_accvgpr_write_b32 a108, v241
    v_accvgpr_read_b32 v241, a109
    v_mul_f32 v241, v241, v242
    v_accvgpr_write_b32 a109, v241
    v_accvgpr_read_b32 v241, a110
    v_mul_f32 v241, v241, v242
    v_accvgpr_write_b32 a110, v241
    v_accvgpr_read_b32 v241, a111
    v_mul_f32 v241, v241, v242
    v_accvgpr_write_b32 a111, v241
    v_accvgpr_read_b32 v241, a112
    v_mul_f32 v241, v241, v242
    v_accvgpr_write_b32 a112, v241
    v_accvgpr_read_b32 v241, a113
    v_mul_f32 v241, v241, v242
    v_accvgpr_write_b32 a113, v241
    v_accvgpr_read_b32 v241, a114
    v_mul_f32 v241, v241, v242
    v_accvgpr_write_b32 a114, v241
    v_accvgpr_read_b32 v241, a115
    v_mul_f32 v241, v241, v242
    v_accvgpr_write_b32 a115, v241
    v_accvgpr_read_b32 v241, a116
    v_mul_f32 v241, v241, v242
    v_accvgpr_write_b32 a116, v241
    v_accvgpr_read_b32 v241, a117
    v_mul_f32 v241, v241, v242
    v_accvgpr_write_b32 a117, v241
    v_accvgpr_read_b32 v241, a118
    v_mul_f32 v241, v241, v242
    v_accvgpr_write_b32 a118, v241
    v_accvgpr_read_b32 v241, a119
    v_mul_f32 v241, v241, v242
    v_accvgpr_write_b32 a119, v241
    v_accvgpr_read_b32 v241, a120
    v_mul_f32 v241, v241, v242
    v_accvgpr_write_b32 a120, v241
    v_accvgpr_read_b32 v241, a121
    v_mul_f32 v241, v241, v242
    v_accvgpr_write_b32 a121, v241
    v_accvgpr_read_b32 v241, a122
    v_mul_f32 v241, v241, v242
    v_accvgpr_write_b32 a122, v241
    v_accvgpr_read_b32 v241, a123
    v_mul_f32 v241, v241, v242
    v_accvgpr_write_b32 a123, v241
    v_accvgpr_read_b32 v241, a124
    v_mul_f32 v241, v241, v242
    v_accvgpr_write_b32 a124, v241
    v_accvgpr_read_b32 v241, a125
    v_mul_f32 v241, v241, v242
    v_accvgpr_write_b32 a125, v241
    v_accvgpr_read_b32 v241, a126
    v_mul_f32 v241, v241, v242
    v_accvgpr_write_b32 a126, v241
    v_accvgpr_read_b32 v241, a127
    v_mul_f32 v241, v241, v242
    v_accvgpr_write_b32 a127, v241
    v_exp_f32 v244, v152
    v_exp_f32 v245, v153
    s_nop 0
    v_cvt_pk_bf16_f32 v204, v244, v245
    v_exp_f32 v244, v154
    v_exp_f32 v245, v155
    s_nop 0
    v_cvt_pk_bf16_f32 v205, v244, v245
    v_exp_f32 v244, v156
    v_exp_f32 v245, v157
    s_nop 0
    v_cvt_pk_bf16_f32 v206, v244, v245
    v_exp_f32 v244, v158
    v_exp_f32 v245, v159
    s_nop 0
    v_cvt_pk_bf16_f32 v207, v244, v245
    s_nop 1
    s_branch attn_kernel_b4_r0_ret
attn_kernel_b4_r1:
    s_nop 7
    v_max3_f32 v240, v160, v161, v162
    v_max3_f32 v240, v163, v164, v240
    v_max3_f32 v240, v165, v166, v240
    v_max_f32 v240, v167, v240
    v_mov_b32 v241, v240
    s_nop 1
    v_permlane16_swap_b32 v240, v241
    s_nop 1
    v_max_f32 v240, v240, v241
    v_mov_b32 v241, v240
    s_nop 1
    v_permlane32_swap_b32 v240, v241
    s_nop 1
    v_max_f32 v240, v240, v241
    v_add_f32 v240, 0x41c00000, v240
    v_max_f32 v240, 0, v240
    v_exp_f32 v242, -v240
    v_sub_f32 v112, v112, v240
    v_sub_f32 v113, v113, v240
    v_sub_f32 v114, v114, v240
    v_sub_f32 v115, v115, v240
    v_sub_f32 v160, v160, v240
    v_sub_f32 v161, v161, v240
    v_sub_f32 v162, v162, v240
    v_sub_f32 v163, v163, v240
    v_sub_f32 v164, v164, v240
    v_sub_f32 v165, v165, v240
    v_sub_f32 v166, v166, v240
    v_sub_f32 v167, v167, v240
    v_sub_f32 v128, v128, v240
    v_sub_f32 v129, v129, v240
    v_sub_f32 v130, v130, v240
    v_sub_f32 v131, v131, v240
    v_sub_f32 v132, v132, v240
    v_sub_f32 v133, v133, v240
    v_sub_f32 v134, v134, v240
    v_sub_f32 v135, v135, v240
    v_mul_f32 v224, v224, v242
    v_mul_f32 v225, v225, v242
    v_mul_f32 v226, v226, v242
    v_mul_f32 v227, v227, v242
    v_accvgpr_read_b32 v241, a0
    v_mul_f32 v241, v241, v242
    v_accvgpr_write_b32 a0, v241
    v_accvgpr_read_b32 v241, a1
    v_mul_f32 v241, v241, v242
    v_accvgpr_write_b32 a1, v241
    v_accvgpr_read_b32 v241, a2
    v_mul_f32 v241, v241, v242
    v_accvgpr_write_b32 a2, v241
    v_accvgpr_read_b32 v241, a3
    v_mul_f32 v241, v241, v242
    v_accvgpr_write_b32 a3, v241
    v_accvgpr_read_b32 v241, a4
    v_mul_f32 v241, v241, v242
    v_accvgpr_write_b32 a4, v241
    v_accvgpr_read_b32 v241, a5
    v_mul_f32 v241, v241, v242
    v_accvgpr_write_b32 a5, v241
    v_accvgpr_read_b32 v241, a6
    v_mul_f32 v241, v241, v242
    v_accvgpr_write_b32 a6, v241
    v_accvgpr_read_b32 v241, a7
    v_mul_f32 v241, v241, v242
    v_accvgpr_write_b32 a7, v241
    v_accvgpr_read_b32 v241, a8
    v_mul_f32 v241, v241, v242
    v_accvgpr_write_b32 a8, v241
    v_accvgpr_read_b32 v241, a9
    v_mul_f32 v241, v241, v242
    v_accvgpr_write_b32 a9, v241
    v_accvgpr_read_b32 v241, a10
    v_mul_f32 v241, v241, v242
    v_accvgpr_write_b32 a10, v241
    v_accvgpr_read_b32 v241, a11
    v_mul_f32 v241, v241, v242
    v_accvgpr_write_b32 a11, v241
    v_accvgpr_read_b32 v241, a12
    v_mul_f32 v241, v241, v242
    v_accvgpr_write_b32 a12, v241
    v_accvgpr_read_b32 v241, a13
    v_mul_f32 v241, v241, v242
    v_accvgpr_write_b32 a13, v241
    v_accvgpr_read_b32 v241, a14
    v_mul_f32 v241, v241, v242
    v_accvgpr_write_b32 a14, v241
    v_accvgpr_read_b32 v241, a15
    v_mul_f32 v241, v241, v242
    v_accvgpr_write_b32 a15, v241
    v_accvgpr_read_b32 v241, a16
    v_mul_f32 v241, v241, v242
    v_accvgpr_write_b32 a16, v241
    v_accvgpr_read_b32 v241, a17
    v_mul_f32 v241, v241, v242
    v_accvgpr_write_b32 a17, v241
    v_accvgpr_read_b32 v241, a18
    v_mul_f32 v241, v241, v242
    v_accvgpr_write_b32 a18, v241
    v_accvgpr_read_b32 v241, a19
    v_mul_f32 v241, v241, v242
    v_accvgpr_write_b32 a19, v241
    v_accvgpr_read_b32 v241, a20
    v_mul_f32 v241, v241, v242
    v_accvgpr_write_b32 a20, v241
    v_accvgpr_read_b32 v241, a21
    v_mul_f32 v241, v241, v242
    v_accvgpr_write_b32 a21, v241
    v_accvgpr_read_b32 v241, a22
    v_mul_f32 v241, v241, v242
    v_accvgpr_write_b32 a22, v241
    v_accvgpr_read_b32 v241, a23
    v_mul_f32 v241, v241, v242
    v_accvgpr_write_b32 a23, v241
    v_accvgpr_read_b32 v241, a24
    v_mul_f32 v241, v241, v242
    v_accvgpr_write_b32 a24, v241
    v_accvgpr_read_b32 v241, a25
    v_mul_f32 v241, v241, v242
    v_accvgpr_write_b32 a25, v241
    v_accvgpr_read_b32 v241, a26
    v_mul_f32 v241, v241, v242
    v_accvgpr_write_b32 a26, v241
    v_accvgpr_read_b32 v241, a27
    v_mul_f32 v241, v241, v242
    v_accvgpr_write_b32 a27, v241
    v_accvgpr_read_b32 v241, a28
    v_mul_f32 v241, v241, v242
    v_accvgpr_write_b32 a28, v241
    v_accvgpr_read_b32 v241, a29
    v_mul_f32 v241, v241, v242
    v_accvgpr_write_b32 a29, v241
    v_accvgpr_read_b32 v241, a30
    v_mul_f32 v241, v241, v242
    v_accvgpr_write_b32 a30, v241
    v_accvgpr_read_b32 v241, a31
    v_mul_f32 v241, v241, v242
    v_accvgpr_write_b32 a31, v241
    v_exp_f32 v244, v160
    v_exp_f32 v245, v161
    s_nop 0
    v_cvt_pk_bf16_f32 v208, v244, v245
    v_exp_f32 v244, v162
    v_exp_f32 v245, v163
    s_nop 0
    v_cvt_pk_bf16_f32 v209, v244, v245
    v_exp_f32 v244, v164
    v_exp_f32 v245, v165
    s_nop 0
    v_cvt_pk_bf16_f32 v210, v244, v245
    v_exp_f32 v244, v166
    v_exp_f32 v245, v167
    s_nop 0
    v_cvt_pk_bf16_f32 v211, v244, v245
    v_max3_f32 v240, v168, v169, v170
    v_max3_f32 v240, v171, v172, v240
    v_max3_f32 v240, v173, v174, v240
    v_max_f32 v240, v175, v240
    v_mov_b32 v241, v240
    s_nop 1
    v_permlane16_swap_b32 v240, v241
    s_nop 1
    v_max_f32 v240, v240, v241
    v_mov_b32 v241, v240
    s_nop 1
    v_permlane32_swap_b32 v240, v241
    s_nop 1
    v_max_f32 v240, v240, v241
    v_add_f32 v240, 0x41c00000, v240
    v_max_f32 v240, 0, v240
    v_exp_f32 v242, -v240
    v_sub_f32 v116, v116, v240
    v_sub_f32 v117, v117, v240
    v_sub_f32 v118, v118, v240
    v_sub_f32 v119, v119, v240
    v_sub_f32 v168, v168, v240
    v_sub_f32 v169, v169, v240
    v_sub_f32 v170, v170, v240
    v_sub_f32 v171, v171, v240
    v_sub_f32 v172, v172, v240
    v_sub_f32 v173, v173, v240
    v_sub_f32 v174, v174, v240
    v_sub_f32 v175, v175, v240
    v_sub_f32 v136, v136, v240
    v_sub_f32 v137, v137, v240
    v_sub_f32 v138, v138, v240
    v_sub_f32 v139, v139, v240
    v_sub_f32 v140, v140, v240
    v_sub_f32 v141, v141, v240
    v_sub_f32 v142, v142, v240
    v_sub_f32 v143, v143, v240
    v_mul_f32 v228, v228, v242
    v_mul_f32 v229, v229, v242
    v_mul_f32 v230, v230, v242
    v_mul_f32 v231, v231, v242
    v_accvgpr_read_b32 v241, a32
    v_mul_f32 v241, v241, v242
    v_accvgpr_write_b32 a32, v241
    v_accvgpr_read_b32 v241, a33
    v_mul_f32 v241, v241, v242
    v_accvgpr_write_b32 a33, v241
    v_accvgpr_read_b32 v241, a34
    v_mul_f32 v241, v241, v242
    v_accvgpr_write_b32 a34, v241
    v_accvgpr_read_b32 v241, a35
    v_mul_f32 v241, v241, v242
    v_accvgpr_write_b32 a35, v241
    v_accvgpr_read_b32 v241, a36
    v_mul_f32 v241, v241, v242
    v_accvgpr_write_b32 a36, v241
    v_accvgpr_read_b32 v241, a37
    v_mul_f32 v241, v241, v242
    v_accvgpr_write_b32 a37, v241
    v_accvgpr_read_b32 v241, a38
    v_mul_f32 v241, v241, v242
    v_accvgpr_write_b32 a38, v241
    v_accvgpr_read_b32 v241, a39
    v_mul_f32 v241, v241, v242
    v_accvgpr_write_b32 a39, v241
    v_accvgpr_read_b32 v241, a40
    v_mul_f32 v241, v241, v242
    v_accvgpr_write_b32 a40, v241
    v_accvgpr_read_b32 v241, a41
    v_mul_f32 v241, v241, v242
    v_accvgpr_write_b32 a41, v241
    v_accvgpr_read_b32 v241, a42
    v_mul_f32 v241, v241, v242
    v_accvgpr_write_b32 a42, v241
    v_accvgpr_read_b32 v241, a43
    v_mul_f32 v241, v241, v242
    v_accvgpr_write_b32 a43, v241
    v_accvgpr_read_b32 v241, a44
    v_mul_f32 v241, v241, v242
    v_accvgpr_write_b32 a44, v241
    v_accvgpr_read_b32 v241, a45
    v_mul_f32 v241, v241, v242
    v_accvgpr_write_b32 a45, v241
    v_accvgpr_read_b32 v241, a46
    v_mul_f32 v241, v241, v242
    v_accvgpr_write_b32 a46, v241
    v_accvgpr_read_b32 v241, a47
    v_mul_f32 v241, v241, v242
    v_accvgpr_write_b32 a47, v241
    v_accvgpr_read_b32 v241, a48
    v_mul_f32 v241, v241, v242
    v_accvgpr_write_b32 a48, v241
    v_accvgpr_read_b32 v241, a49
    v_mul_f32 v241, v241, v242
    v_accvgpr_write_b32 a49, v241
    v_accvgpr_read_b32 v241, a50
    v_mul_f32 v241, v241, v242
    v_accvgpr_write_b32 a50, v241
    v_accvgpr_read_b32 v241, a51
    v_mul_f32 v241, v241, v242
    v_accvgpr_write_b32 a51, v241
    v_accvgpr_read_b32 v241, a52
    v_mul_f32 v241, v241, v242
    v_accvgpr_write_b32 a52, v241
    v_accvgpr_read_b32 v241, a53
    v_mul_f32 v241, v241, v242
    v_accvgpr_write_b32 a53, v241
    v_accvgpr_read_b32 v241, a54
    v_mul_f32 v241, v241, v242
    v_accvgpr_write_b32 a54, v241
    v_accvgpr_read_b32 v241, a55
    v_mul_f32 v241, v241, v242
    v_accvgpr_write_b32 a55, v241
    v_accvgpr_read_b32 v241, a56
    v_mul_f32 v241, v241, v242
    v_accvgpr_write_b32 a56, v241
    v_accvgpr_read_b32 v241, a57
    v_mul_f32 v241, v241, v242
    v_accvgpr_write_b32 a57, v241
    v_accvgpr_read_b32 v241, a58
    v_mul_f32 v241, v241, v242
    v_accvgpr_write_b32 a58, v241
    v_accvgpr_read_b32 v241, a59
    v_mul_f32 v241, v241, v242
    v_accvgpr_write_b32 a59, v241
    v_accvgpr_read_b32 v241, a60
    v_mul_f32 v241, v241, v242
    v_accvgpr_write_b32 a60, v241
    v_accvgpr_read_b32 v241, a61
    v_mul_f32 v241, v241, v242
    v_accvgpr_write_b32 a61, v241
    v_accvgpr_read_b32 v241, a62
    v_mul_f32 v241, v241, v242
    v_accvgpr_write_b32 a62, v241
    v_accvgpr_read_b32 v241, a63
    v_mul_f32 v241, v241, v242
    v_accvgpr_write_b32 a63, v241
    v_exp_f32 v244, v168
    v_exp_f32 v245, v169
    s_nop 0
    v_cvt_pk_bf16_f32 v212, v244, v245
    v_exp_f32 v244, v170
    v_exp_f32 v245, v171
    s_nop 0
    v_cvt_pk_bf16_f32 v213, v244, v245
    v_exp_f32 v244, v172
    v_exp_f32 v245, v173
    s_nop 0
    v_cvt_pk_bf16_f32 v214, v244, v245
    v_exp_f32 v244, v174
    v_exp_f32 v245, v175
    s_nop 0
    v_cvt_pk_bf16_f32 v215, v244, v245
    v_max3_f32 v240, v176, v177, v178
    v_max3_f32 v240, v179, v180, v240
    v_max3_f32 v240, v181, v182, v240
    v_max_f32 v240, v183, v240
    v_mov_b32 v241, v240
    s_nop 1
    v_permlane16_swap_b32 v240, v241
    s_nop 1
    v_max_f32 v240, v240, v241
    v_mov_b32 v241, v240
    s_nop 1
    v_permlane32_swap_b32 v240, v241
    s_nop 1
    v_max_f32 v240, v240, v241
    v_add_f32 v240, 0x41c00000, v240
    v_max_f32 v240, 0, v240
    v_exp_f32 v242, -v240
    v_sub_f32 v120, v120, v240
    v_sub_f32 v121, v121, v240
    v_sub_f32 v122, v122, v240
    v_sub_f32 v123, v123, v240
    v_sub_f32 v176, v176, v240
    v_sub_f32 v177, v177, v240
    v_sub_f32 v178, v178, v240
    v_sub_f32 v179, v179, v240
    v_sub_f32 v180, v180, v240
    v_sub_f32 v181, v181, v240
    v_sub_f32 v182, v182, v240
    v_sub_f32 v183, v183, v240
    v_sub_f32 v144, v144, v240
    v_sub_f32 v145, v145, v240
    v_sub_f32 v146, v146, v240
    v_sub_f32 v147, v147, v240
    v_sub_f32 v148, v148, v240
    v_sub_f32 v149, v149, v240
    v_sub_f32 v150, v150, v240
    v_sub_f32 v151, v151, v240
    v_mul_f32 v232, v232, v242
    v_mul_f32 v233, v233, v242
    v_mul_f32 v234, v234, v242
    v_mul_f32 v235, v235, v242
    v_accvgpr_read_b32 v241, a64
    v_mul_f32 v241, v241, v242
    v_accvgpr_write_b32 a64, v241
    v_accvgpr_read_b32 v241, a65
    v_mul_f32 v241, v241, v242
    v_accvgpr_write_b32 a65, v241
    v_accvgpr_read_b32 v241, a66
    v_mul_f32 v241, v241, v242
    v_accvgpr_write_b32 a66, v241
    v_accvgpr_read_b32 v241, a67
    v_mul_f32 v241, v241, v242
    v_accvgpr_write_b32 a67, v241
    v_accvgpr_read_b32 v241, a68
    v_mul_f32 v241, v241, v242
    v_accvgpr_write_b32 a68, v241
    v_accvgpr_read_b32 v241, a69
    v_mul_f32 v241, v241, v242
    v_accvgpr_write_b32 a69, v241
    v_accvgpr_read_b32 v241, a70
    v_mul_f32 v241, v241, v242
    v_accvgpr_write_b32 a70, v241
    v_accvgpr_read_b32 v241, a71
    v_mul_f32 v241, v241, v242
    v_accvgpr_write_b32 a71, v241
    v_accvgpr_read_b32 v241, a72
    v_mul_f32 v241, v241, v242
    v_accvgpr_write_b32 a72, v241
    v_accvgpr_read_b32 v241, a73
    v_mul_f32 v241, v241, v242
    v_accvgpr_write_b32 a73, v241
    v_accvgpr_read_b32 v241, a74
    v_mul_f32 v241, v241, v242
    v_accvgpr_write_b32 a74, v241
    v_accvgpr_read_b32 v241, a75
    v_mul_f32 v241, v241, v242
    v_accvgpr_write_b32 a75, v241
    v_accvgpr_read_b32 v241, a76
    v_mul_f32 v241, v241, v242
    v_accvgpr_write_b32 a76, v241
    v_accvgpr_read_b32 v241, a77
    v_mul_f32 v241, v241, v242
    v_accvgpr_write_b32 a77, v241
    v_accvgpr_read_b32 v241, a78
    v_mul_f32 v241, v241, v242
    v_accvgpr_write_b32 a78, v241
    v_accvgpr_read_b32 v241, a79
    v_mul_f32 v241, v241, v242
    v_accvgpr_write_b32 a79, v241
    v_accvgpr_read_b32 v241, a80
    v_mul_f32 v241, v241, v242
    v_accvgpr_write_b32 a80, v241
    v_accvgpr_read_b32 v241, a81
    v_mul_f32 v241, v241, v242
    v_accvgpr_write_b32 a81, v241
    v_accvgpr_read_b32 v241, a82
    v_mul_f32 v241, v241, v242
    v_accvgpr_write_b32 a82, v241
    v_accvgpr_read_b32 v241, a83
    v_mul_f32 v241, v241, v242
    v_accvgpr_write_b32 a83, v241
    v_accvgpr_read_b32 v241, a84
    v_mul_f32 v241, v241, v242
    v_accvgpr_write_b32 a84, v241
    v_accvgpr_read_b32 v241, a85
    v_mul_f32 v241, v241, v242
    v_accvgpr_write_b32 a85, v241
    v_accvgpr_read_b32 v241, a86
    v_mul_f32 v241, v241, v242
    v_accvgpr_write_b32 a86, v241
    v_accvgpr_read_b32 v241, a87
    v_mul_f32 v241, v241, v242
    v_accvgpr_write_b32 a87, v241
    v_accvgpr_read_b32 v241, a88
    v_mul_f32 v241, v241, v242
    v_accvgpr_write_b32 a88, v241
    v_accvgpr_read_b32 v241, a89
    v_mul_f32 v241, v241, v242
    v_accvgpr_write_b32 a89, v241
    v_accvgpr_read_b32 v241, a90
    v_mul_f32 v241, v241, v242
    v_accvgpr_write_b32 a90, v241
    v_accvgpr_read_b32 v241, a91
    v_mul_f32 v241, v241, v242
    v_accvgpr_write_b32 a91, v241
    v_accvgpr_read_b32 v241, a92
    v_mul_f32 v241, v241, v242
    v_accvgpr_write_b32 a92, v241
    v_accvgpr_read_b32 v241, a93
    v_mul_f32 v241, v241, v242
    v_accvgpr_write_b32 a93, v241
    v_accvgpr_read_b32 v241, a94
    v_mul_f32 v241, v241, v242
    v_accvgpr_write_b32 a94, v241
    v_accvgpr_read_b32 v241, a95
    v_mul_f32 v241, v241, v242
    v_accvgpr_write_b32 a95, v241
    v_exp_f32 v244, v176
    v_exp_f32 v245, v177
    s_nop 0
    v_cvt_pk_bf16_f32 v216, v244, v245
    v_exp_f32 v244, v178
    v_exp_f32 v245, v179
    s_nop 0
    v_cvt_pk_bf16_f32 v217, v244, v245
    v_exp_f32 v244, v180
    v_exp_f32 v245, v181
    s_nop 0
    v_cvt_pk_bf16_f32 v218, v244, v245
    v_exp_f32 v244, v182
    v_exp_f32 v245, v183
    s_nop 0
    v_cvt_pk_bf16_f32 v219, v244, v245
    v_max3_f32 v240, v184, v185, v186
    v_max3_f32 v240, v187, v188, v240
    v_max3_f32 v240, v189, v190, v240
    v_max_f32 v240, v191, v240
    v_mov_b32 v241, v240
    s_nop 1
    v_permlane16_swap_b32 v240, v241
    s_nop 1
    v_max_f32 v240, v240, v241
    v_mov_b32 v241, v240
    s_nop 1
    v_permlane32_swap_b32 v240, v241
    s_nop 1
    v_max_f32 v240, v240, v241
    v_add_f32 v240, 0x41c00000, v240
    v_max_f32 v240, 0, v240
    v_exp_f32 v242, -v240
    v_sub_f32 v124, v124, v240
    v_sub_f32 v125, v125, v240
    v_sub_f32 v126, v126, v240
    v_sub_f32 v127, v127, v240
    v_sub_f32 v184, v184, v240
    v_sub_f32 v185, v185, v240
    v_sub_f32 v186, v186, v240
    v_sub_f32 v187, v187, v240
    v_sub_f32 v188, v188, v240
    v_sub_f32 v189, v189, v240
    v_sub_f32 v190, v190, v240
    v_sub_f32 v191, v191, v240
    v_sub_f32 v152, v152, v240
    v_sub_f32 v153, v153, v240
    v_sub_f32 v154, v154, v240
    v_sub_f32 v155, v155, v240
    v_sub_f32 v156, v156, v240
    v_sub_f32 v157, v157, v240
    v_sub_f32 v158, v158, v240
    v_sub_f32 v159, v159, v240
    v_mul_f32 v236, v236, v242
    v_mul_f32 v237, v237, v242
    v_mul_f32 v238, v238, v242
    v_mul_f32 v239, v239, v242
    v_accvgpr_read_b32 v241, a96
    v_mul_f32 v241, v241, v242
    v_accvgpr_write_b32 a96, v241
    v_accvgpr_read_b32 v241, a97
    v_mul_f32 v241, v241, v242
    v_accvgpr_write_b32 a97, v241
    v_accvgpr_read_b32 v241, a98
    v_mul_f32 v241, v241, v242
    v_accvgpr_write_b32 a98, v241
    v_accvgpr_read_b32 v241, a99
    v_mul_f32 v241, v241, v242
    v_accvgpr_write_b32 a99, v241
    v_accvgpr_read_b32 v241, a100
    v_mul_f32 v241, v241, v242
    v_accvgpr_write_b32 a100, v241
    v_accvgpr_read_b32 v241, a101
    v_mul_f32 v241, v241, v242
    v_accvgpr_write_b32 a101, v241
    v_accvgpr_read_b32 v241, a102
    v_mul_f32 v241, v241, v242
    v_accvgpr_write_b32 a102, v241
    v_accvgpr_read_b32 v241, a103
    v_mul_f32 v241, v241, v242
    v_accvgpr_write_b32 a103, v241
    v_accvgpr_read_b32 v241, a104
    v_mul_f32 v241, v241, v242
    v_accvgpr_write_b32 a104, v241
    v_accvgpr_read_b32 v241, a105
    v_mul_f32 v241, v241, v242
    v_accvgpr_write_b32 a105, v241
    v_accvgpr_read_b32 v241, a106
    v_mul_f32 v241, v241, v242
    v_accvgpr_write_b32 a106, v241
    v_accvgpr_read_b32 v241, a107
    v_mul_f32 v241, v241, v242
    v_accvgpr_write_b32 a107, v241
    v_accvgpr_read_b32 v241, a108
    v_mul_f32 v241, v241, v242
    v_accvgpr_write_b32 a108, v241
    v_accvgpr_read_b32 v241, a109
    v_mul_f32 v241, v241, v242
    v_accvgpr_write_b32 a109, v241
    v_accvgpr_read_b32 v241, a110
    v_mul_f32 v241, v241, v242
    v_accvgpr_write_b32 a110, v241
    v_accvgpr_read_b32 v241, a111
    v_mul_f32 v241, v241, v242
    v_accvgpr_write_b32 a111, v241
    v_accvgpr_read_b32 v241, a112
    v_mul_f32 v241, v241, v242
    v_accvgpr_write_b32 a112, v241
    v_accvgpr_read_b32 v241, a113
    v_mul_f32 v241, v241, v242
    v_accvgpr_write_b32 a113, v241
    v_accvgpr_read_b32 v241, a114
    v_mul_f32 v241, v241, v242
    v_accvgpr_write_b32 a114, v241
    v_accvgpr_read_b32 v241, a115
    v_mul_f32 v241, v241, v242
    v_accvgpr_write_b32 a115, v241
    v_accvgpr_read_b32 v241, a116
    v_mul_f32 v241, v241, v242
    v_accvgpr_write_b32 a116, v241
    v_accvgpr_read_b32 v241, a117
    v_mul_f32 v241, v241, v242
    v_accvgpr_write_b32 a117, v241
    v_accvgpr_read_b32 v241, a118
    v_mul_f32 v241, v241, v242
    v_accvgpr_write_b32 a118, v241
    v_accvgpr_read_b32 v241, a119
    v_mul_f32 v241, v241, v242
    v_accvgpr_write_b32 a119, v241
    v_accvgpr_read_b32 v241, a120
    v_mul_f32 v241, v241, v242
    v_accvgpr_write_b32 a120, v241
    v_accvgpr_read_b32 v241, a121
    v_mul_f32 v241, v241, v242
    v_accvgpr_write_b32 a121, v241
    v_accvgpr_read_b32 v241, a122
    v_mul_f32 v241, v241, v242
    v_accvgpr_write_b32 a122, v241
    v_accvgpr_read_b32 v241, a123
    v_mul_f32 v241, v241, v242
    v_accvgpr_write_b32 a123, v241
    v_accvgpr_read_b32 v241, a124
    v_mul_f32 v241, v241, v242
    v_accvgpr_write_b32 a124, v241
    v_accvgpr_read_b32 v241, a125
    v_mul_f32 v241, v241, v242
    v_accvgpr_write_b32 a125, v241
    v_accvgpr_read_b32 v241, a126
    v_mul_f32 v241, v241, v242
    v_accvgpr_write_b32 a126, v241
    v_accvgpr_read_b32 v241, a127
    v_mul_f32 v241, v241, v242
    v_accvgpr_write_b32 a127, v241
    v_exp_f32 v244, v184
    v_exp_f32 v245, v185
    s_nop 0
    v_cvt_pk_bf16_f32 v220, v244, v245
    v_exp_f32 v244, v186
    v_exp_f32 v245, v187
    s_nop 0
    v_cvt_pk_bf16_f32 v221, v244, v245
    v_exp_f32 v244, v188
    v_exp_f32 v245, v189
    s_nop 0
    v_cvt_pk_bf16_f32 v222, v244, v245
    v_exp_f32 v244, v190
    v_exp_f32 v245, v191
    s_nop 0
    v_cvt_pk_bf16_f32 v223, v244, v245
    s_nop 1
    s_branch attn_kernel_b4_r1_ret
attn_kernel_b3_r0:
    s_nop 7
    v_max3_f32 v240, v136, v137, v138
    v_max3_f32 v240, v139, v140, v240
    v_max3_f32 v240, v141, v142, v240
    v_max_f32 v240, v143, v240
    v_mov_b32 v241, v240
    s_nop 1
    v_permlane16_swap_b32 v240, v241
    s_nop 1
    v_max_f32 v240, v240, v241
    v_mov_b32 v241, v240
    s_nop 1
    v_permlane32_swap_b32 v240, v241
    s_nop 1
    v_max_f32 v240, v240, v241
    v_add_f32 v240, 0x41c00000, v240
    v_max_f32 v240, 0, v240
    v_exp_f32 v242, -v240
    v_sub_f32 v116, v116, v240
    v_sub_f32 v117, v117, v240
    v_sub_f32 v118, v118, v240
    v_sub_f32 v119, v119, v240
    v_sub_f32 v136, v136, v240
    v_sub_f32 v137, v137, v240
    v_sub_f32 v138, v138, v240
    v_sub_f32 v139, v139, v240
    v_sub_f32 v140, v140, v240
    v_sub_f32 v141, v141, v240
    v_sub_f32 v142, v142, v240
    v_sub_f32 v143, v143, v240
    v_sub_f32 v168, v168, v240
    v_sub_f32 v169, v169, v240
    v_sub_f32 v170, v170, v240
    v_sub_f32 v171, v171, v240
    v_sub_f32 v172, v172, v240
    v_sub_f32 v173, v173, v240
    v_sub_f32 v174, v174, v240
    v_sub_f32 v175, v175, v240
    v_mul_f32 v228, v228, v242
    v_mul_f32 v229, v229, v242
    v_mul_f32 v230, v230, v242
    v_mul_f32 v231, v231, v242
    v_accvgpr_read_b32 v241, a32
    v_mul_f32 v241, v241, v242
    v_accvgpr_write_b32 a32, v241
    v_accvgpr_read_b32 v241, a33
    v_mul_f32 v241, v241, v242
    v_accvgpr_write_b32 a33, v241
    v_accvgpr_read_b32 v241, a34
    v_mul_f32 v241, v241, v242
    v_accvgpr_write_b32 a34, v241
    v_accvgpr_read_b32 v241, a35
    v_mul_f32 v241, v241, v242
    v_accvgpr_write_b32 a35, v241
    v_accvgpr_read_b32 v241, a36
    v_mul_f32 v241, v241, v242
    v_accvgpr_write_b32 a36, v241
    v_accvgpr_read_b32 v241, a37
    v_mul_f32 v241, v241, v242
    v_accvgpr_write_b32 a37, v241
    v_accvgpr_read_b32 v241, a38
    v_mul_f32 v241, v241, v242
    v_accvgpr_write_b32 a38, v241
    v_accvgpr_read_b32 v241, a39
    v_mul_f32 v241, v241, v242
    v_accvgpr_write_b32 a39, v241
    v_accvgpr_read_b32 v241, a40
    v_mul_f32 v241, v241, v242
    v_accvgpr_write_b32 a40, v241
    v_accvgpr_read_b32 v241, a41
    v_mul_f32 v241, v241, v242
    v_accvgpr_write_b32 a41, v241
    v_accvgpr_read_b32 v241, a42
    v_mul_f32 v241, v241, v242
    v_accvgpr_write_b32 a42, v241
    v_accvgpr_read_b32 v241, a43
    v_mul_f32 v241, v241, v242
    v_accvgpr_write_b32 a43, v241
    v_accvgpr_read_b32 v241, a44
    v_mul_f32 v241, v241, v242
    v_accvgpr_write_b32 a44, v241
    v_accvgpr_read_b32 v241, a45
    v_mul_f32 v241, v241, v242
    v_accvgpr_write_b32 a45, v241
    v_accvgpr_read_b32 v241, a46
    v_mul_f32 v241, v241, v242
    v_accvgpr_write_b32 a46, v241
    v_accvgpr_read_b32 v241, a47
    v_mul_f32 v241, v241, v242
    v_accvgpr_write_b32 a47, v241
    v_accvgpr_read_b32 v241, a48
    v_mul_f32 v241, v241, v242
    v_accvgpr_write_b32 a48, v241
    v_accvgpr_read_b32 v241, a49
    v_mul_f32 v241, v241, v242
    v_accvgpr_write_b32 a49, v241
    v_accvgpr_read_b32 v241, a50
    v_mul_f32 v241, v241, v242
    v_accvgpr_write_b32 a50, v241
    v_accvgpr_read_b32 v241, a51
    v_mul_f32 v241, v241, v242
    v_accvgpr_write_b32 a51, v241
    v_accvgpr_read_b32 v241, a52
    v_mul_f32 v241, v241, v242
    v_accvgpr_write_b32 a52, v241
    v_accvgpr_read_b32 v241, a53
    v_mul_f32 v241, v241, v242
    v_accvgpr_write_b32 a53, v241
    v_accvgpr_read_b32 v241, a54
    v_mul_f32 v241, v241, v242
    v_accvgpr_write_b32 a54, v241
    v_accvgpr_read_b32 v241, a55
    v_mul_f32 v241, v241, v242
    v_accvgpr_write_b32 a55, v241
    v_accvgpr_read_b32 v241, a56
    v_mul_f32 v241, v241, v242
    v_accvgpr_write_b32 a56, v241
    v_accvgpr_read_b32 v241, a57
    v_mul_f32 v241, v241, v242
    v_accvgpr_write_b32 a57, v241
    v_accvgpr_read_b32 v241, a58
    v_mul_f32 v241, v241, v242
    v_accvgpr_write_b32 a58, v241
    v_accvgpr_read_b32 v241, a59
    v_mul_f32 v241, v241, v242
    v_accvgpr_write_b32 a59, v241
    v_accvgpr_read_b32 v241, a60
    v_mul_f32 v241, v241, v242
    v_accvgpr_write_b32 a60, v241
    v_accvgpr_read_b32 v241, a61
    v_mul_f32 v241, v241, v242
    v_accvgpr_write_b32 a61, v241
    v_accvgpr_read_b32 v241, a62
    v_mul_f32 v241, v241, v242
    v_accvgpr_write_b32 a62, v241
    v_accvgpr_read_b32 v241, a63
    v_mul_f32 v241, v241, v242
    v_accvgpr_write_b32 a63, v241
    v_exp_f32 v244, v136
    v_exp_f32 v245, v137
    s_nop 0
    v_cvt_pk_bf16_f32 v196, v244, v245
    v_exp_f32 v244, v138
    v_exp_f32 v245, v139
    s_nop 0
    v_cvt_pk_bf16_f32 v197, v244, v245
    v_exp_f32 v244, v140
    v_exp_f32 v245, v141
    s_nop 0
    v_cvt_pk_bf16_f32 v198, v244, v245
    v_exp_f32 v244, v142
    v_exp_f32 v245, v143
    s_nop 0
    v_cvt_pk_bf16_f32 v199, v244, v245
    v_max3_f32 v240, v144, v145, v146
    v_max3_f32 v240, v147, v148, v240
    v_max3_f32 v240, v149, v150, v240
    v_max_f32 v240, v151, v240
    v_mov_b32 v241, v240
    s_nop 1
    v_permlane16_swap_b32 v240, v241
    s_nop 1
    v_max_f32 v240, v240, v241
    v_mov_b32 v241, v240
    s_nop 1
    v_permlane32_swap_b32 v240, v241
    s_nop 1
    v_max_f32 v240, v240, v241
    v_add_f32 v240, 0x41c00000, v240
    v_max_f32 v240, 0, v240
    v_exp_f32 v242, -v240
    v_sub_f32 v120, v120, v240
    v_sub_f32 v121, v121, v240
    v_sub_f32 v122, v122, v240
    v_sub_f32 v123, v123, v240
    v_sub_f32 v144, v144, v240
    v_sub_f32 v145, v145, v240
    v_sub_f32 v146, v146, v240
    v_sub_f32 v147, v147, v240
    v_sub_f32 v148, v148, v240
    v_sub_f32 v149, v149, v240
    v_sub_f32 v150, v150, v240
    v_sub_f32 v151, v151, v240
    v_sub_f32 v176, v176, v240
    v_sub_f32 v177, v177, v240
    v_sub_f32 v178, v178, v240
    v_sub_f32 v179, v179, v240
    v_sub_f32 v180, v180, v240
    v_sub_f32 v181, v181, v240
    v_sub_f32 v182, v182, v240
    v_sub_f32 v183, v183, v240
    v_mul_f32 v232, v232, v242
    v_mul_f32 v233, v233, v242
    v_mul_f32 v234, v234, v242
    v_mul_f32 v235, v235, v242
    v_accvgpr_read_b32 v241, a64
    v_mul_f32 v241, v241, v242
    v_accvgpr_write_b32 a64, v241
    v_accvgpr_read_b32 v241, a65
    v_mul_f32 v241, v241, v242
    v_accvgpr_write_b32 a65, v241
    v_accvgpr_read_b32 v241, a66
    v_mul_f32 v241, v241, v242
    v_accvgpr_write_b32 a66, v241
    v_accvgpr_read_b32 v241, a67
    v_mul_f32 v241, v241, v242
    v_accvgpr_write_b32 a67, v241
    v_accvgpr_read_b32 v241, a68
    v_mul_f32 v241, v241, v242
    v_accvgpr_write_b32 a68, v241
    v_accvgpr_read_b32 v241, a69
    v_mul_f32 v241, v241, v242
    v_accvgpr_write_b32 a69, v241
    v_accvgpr_read_b32 v241, a70
    v_mul_f32 v241, v241, v242
    v_accvgpr_write_b32 a70, v241
    v_accvgpr_read_b32 v241, a71
    v_mul_f32 v241, v241, v242
    v_accvgpr_write_b32 a71, v241
    v_accvgpr_read_b32 v241, a72
    v_mul_f32 v241, v241, v242
    v_accvgpr_write_b32 a72, v241
    v_accvgpr_read_b32 v241, a73
    v_mul_f32 v241, v241, v242
    v_accvgpr_write_b32 a73, v241
    v_accvgpr_read_b32 v241, a74
    v_mul_f32 v241, v241, v242
    v_accvgpr_write_b32 a74, v241
    v_accvgpr_read_b32 v241, a75
    v_mul_f32 v241, v241, v242
    v_accvgpr_write_b32 a75, v241
    v_accvgpr_read_b32 v241, a76
    v_mul_f32 v241, v241, v242
    v_accvgpr_write_b32 a76, v241
    v_accvgpr_read_b32 v241, a77
    v_mul_f32 v241, v241, v242
    v_accvgpr_write_b32 a77, v241
    v_accvgpr_read_b32 v241, a78
    v_mul_f32 v241, v241, v242
    v_accvgpr_write_b32 a78, v241
    v_accvgpr_read_b32 v241, a79
    v_mul_f32 v241, v241, v242
    v_accvgpr_write_b32 a79, v241
    v_accvgpr_read_b32 v241, a80
    v_mul_f32 v241, v241, v242
    v_accvgpr_write_b32 a80, v241
    v_accvgpr_read_b32 v241, a81
    v_mul_f32 v241, v241, v242
    v_accvgpr_write_b32 a81, v241
    v_accvgpr_read_b32 v241, a82
    v_mul_f32 v241, v241, v242
    v_accvgpr_write_b32 a82, v241
    v_accvgpr_read_b32 v241, a83
    v_mul_f32 v241, v241, v242
    v_accvgpr_write_b32 a83, v241
    v_accvgpr_read_b32 v241, a84
    v_mul_f32 v241, v241, v242
    v_accvgpr_write_b32 a84, v241
    v_accvgpr_read_b32 v241, a85
    v_mul_f32 v241, v241, v242
    v_accvgpr_write_b32 a85, v241
    v_accvgpr_read_b32 v241, a86
    v_mul_f32 v241, v241, v242
    v_accvgpr_write_b32 a86, v241
    v_accvgpr_read_b32 v241, a87
    v_mul_f32 v241, v241, v242
    v_accvgpr_write_b32 a87, v241
    v_accvgpr_read_b32 v241, a88
    v_mul_f32 v241, v241, v242
    v_accvgpr_write_b32 a88, v241
    v_accvgpr_read_b32 v241, a89
    v_mul_f32 v241, v241, v242
    v_accvgpr_write_b32 a89, v241
    v_accvgpr_read_b32 v241, a90
    v_mul_f32 v241, v241, v242
    v_accvgpr_write_b32 a90, v241
    v_accvgpr_read_b32 v241, a91
    v_mul_f32 v241, v241, v242
    v_accvgpr_write_b32 a91, v241
    v_accvgpr_read_b32 v241, a92
    v_mul_f32 v241, v241, v242
    v_accvgpr_write_b32 a92, v241
    v_accvgpr_read_b32 v241, a93
    v_mul_f32 v241, v241, v242
    v_accvgpr_write_b32 a93, v241
    v_accvgpr_read_b32 v241, a94
    v_mul_f32 v241, v241, v242
    v_accvgpr_write_b32 a94, v241
    v_accvgpr_read_b32 v241, a95
    v_mul_f32 v241, v241, v242
    v_accvgpr_write_b32 a95, v241
    v_exp_f32 v244, v144
    v_exp_f32 v245, v145
    s_nop 0
    v_cvt_pk_bf16_f32 v200, v244, v245
    v_exp_f32 v244, v146
    v_exp_f32 v245, v147
    s_nop 0
    v_cvt_pk_bf16_f32 v201, v244, v245
    v_exp_f32 v244, v148
    v_exp_f32 v245, v149
    s_nop 0
    v_cvt_pk_bf16_f32 v202, v244, v245
    v_exp_f32 v244, v150
    v_exp_f32 v245, v151
    s_nop 0
    v_cvt_pk_bf16_f32 v203, v244, v245
    v_max3_f32 v240, v152, v153, v154
    v_max3_f32 v240, v155, v156, v240
    v_max3_f32 v240, v157, v158, v240
    v_max_f32 v240, v159, v240
    v_mov_b32 v241, v240
    s_nop 1
    v_permlane16_swap_b32 v240, v241
    s_nop 1
    v_max_f32 v240, v240, v241
    v_mov_b32 v241, v240
    s_nop 1
    v_permlane32_swap_b32 v240, v241
    s_nop 1
    v_max_f32 v240, v240, v241
    v_add_f32 v240, 0x41c00000, v240
    v_max_f32 v240, 0, v240
    v_exp_f32 v242, -v240
    v_sub_f32 v124, v124, v240
    v_sub_f32 v125, v125, v240
    v_sub_f32 v126, v126, v240
    v_sub_f32 v127, v127, v240
    v_sub_f32 v152, v152, v240
    v_sub_f32 v153, v153, v240
    v_sub_f32 v154, v154, v240
    v_sub_f32 v155, v155, v240
    v_sub_f32 v156, v156, v240
    v_sub_f32 v157, v157, v240
    v_sub_f32 v158, v158, v240
    v_sub_f32 v159, v159, v240
    v_sub_f32 v184, v184, v240
    v_sub_f32 v185, v185, v240
    v_sub_f32 v186, v186, v240
    v_sub_f32 v187, v187, v240
    v_sub_f32 v188, v188, v240
    v_sub_f32 v189, v189, v240
    v_sub_f32 v190, v190, v240
    v_sub_f32 v191, v191, v240
    v_mul_f32 v236, v236, v242
    v_mul_f32 v237, v237, v242
    v_mul_f32 v238, v238, v242
    v_mul_f32 v239, v239, v242
    v_accvgpr_read_b32 v241, a96
    v_mul_f32 v241, v241, v242
    v_accvgpr_write_b32 a96, v241
    v_accvgpr_read_b32 v241, a97
    v_mul_f32 v241, v241, v242
    v_accvgpr_write_b32 a97, v241
    v_accvgpr_read_b32 v241, a98
    v_mul_f32 v241, v241, v242
    v_accvgpr_write_b32 a98, v241
    v_accvgpr_read_b32 v241, a99
    v_mul_f32 v241, v241, v242
    v_accvgpr_write_b32 a99, v241
    v_accvgpr_read_b32 v241, a100
    v_mul_f32 v241, v241, v242
    v_accvgpr_write_b32 a100, v241
    v_accvgpr_read_b32 v241, a101
    v_mul_f32 v241, v241, v242
    v_accvgpr_write_b32 a101, v241
    v_accvgpr_read_b32 v241, a102
    v_mul_f32 v241, v241, v242
    v_accvgpr_write_b32 a102, v241
    v_accvgpr_read_b32 v241, a103
    v_mul_f32 v241, v241, v242
    v_accvgpr_write_b32 a103, v241
    v_accvgpr_read_b32 v241, a104
    v_mul_f32 v241, v241, v242
    v_accvgpr_write_b32 a104, v241
    v_accvgpr_read_b32 v241, a105
    v_mul_f32 v241, v241, v242
    v_accvgpr_write_b32 a105, v241
    v_accvgpr_read_b32 v241, a106
    v_mul_f32 v241, v241, v242
    v_accvgpr_write_b32 a106, v241
    v_accvgpr_read_b32 v241, a107
    v_mul_f32 v241, v241, v242
    v_accvgpr_write_b32 a107, v241
    v_accvgpr_read_b32 v241, a108
    v_mul_f32 v241, v241, v242
    v_accvgpr_write_b32 a108, v241
    v_accvgpr_read_b32 v241, a109
    v_mul_f32 v241, v241, v242
    v_accvgpr_write_b32 a109, v241
    v_accvgpr_read_b32 v241, a110
    v_mul_f32 v241, v241, v242
    v_accvgpr_write_b32 a110, v241
    v_accvgpr_read_b32 v241, a111
    v_mul_f32 v241, v241, v242
    v_accvgpr_write_b32 a111, v241
    v_accvgpr_read_b32 v241, a112
    v_mul_f32 v241, v241, v242
    v_accvgpr_write_b32 a112, v241
    v_accvgpr_read_b32 v241, a113
    v_mul_f32 v241, v241, v242
    v_accvgpr_write_b32 a113, v241
    v_accvgpr_read_b32 v241, a114
    v_mul_f32 v241, v241, v242
    v_accvgpr_write_b32 a114, v241
    v_accvgpr_read_b32 v241, a115
    v_mul_f32 v241, v241, v242
    v_accvgpr_write_b32 a115, v241
    v_accvgpr_read_b32 v241, a116
    v_mul_f32 v241, v241, v242
    v_accvgpr_write_b32 a116, v241
    v_accvgpr_read_b32 v241, a117
    v_mul_f32 v241, v241, v242
    v_accvgpr_write_b32 a117, v241
    v_accvgpr_read_b32 v241, a118
    v_mul_f32 v241, v241, v242
    v_accvgpr_write_b32 a118, v241
    v_accvgpr_read_b32 v241, a119
    v_mul_f32 v241, v241, v242
    v_accvgpr_write_b32 a119, v241
    v_accvgpr_read_b32 v241, a120
    v_mul_f32 v241, v241, v242
    v_accvgpr_write_b32 a120, v241
    v_accvgpr_read_b32 v241, a121
    v_mul_f32 v241, v241, v242
    v_accvgpr_write_b32 a121, v241
    v_accvgpr_read_b32 v241, a122
    v_mul_f32 v241, v241, v242
    v_accvgpr_write_b32 a122, v241
    v_accvgpr_read_b32 v241, a123
    v_mul_f32 v241, v241, v242
    v_accvgpr_write_b32 a123, v241
    v_accvgpr_read_b32 v241, a124
    v_mul_f32 v241, v241, v242
    v_accvgpr_write_b32 a124, v241
    v_accvgpr_read_b32 v241, a125
    v_mul_f32 v241, v241, v242
    v_accvgpr_write_b32 a125, v241
    v_accvgpr_read_b32 v241, a126
    v_mul_f32 v241, v241, v242
    v_accvgpr_write_b32 a126, v241
    v_accvgpr_read_b32 v241, a127
    v_mul_f32 v241, v241, v242
    v_accvgpr_write_b32 a127, v241
    v_exp_f32 v244, v152
    v_exp_f32 v245, v153
    s_nop 0
    v_cvt_pk_bf16_f32 v204, v244, v245
    v_exp_f32 v244, v154
    v_exp_f32 v245, v155
    s_nop 0
    v_cvt_pk_bf16_f32 v205, v244, v245
    v_exp_f32 v244, v156
    v_exp_f32 v245, v157
    s_nop 0
    v_cvt_pk_bf16_f32 v206, v244, v245
    v_exp_f32 v244, v158
    v_exp_f32 v245, v159
    s_nop 0
    v_cvt_pk_bf16_f32 v207, v244, v245
    s_nop 1
    s_branch attn_kernel_b3_r0_ret
attn_kernel_b3_r1:
    s_nop 7
    v_max3_f32 v240, v168, v169, v170
    v_max3_f32 v240, v171, v172, v240
    v_max3_f32 v240, v173, v174, v240
    v_max_f32 v240, v175, v240
    v_mov_b32 v241, v240
    s_nop 1
    v_permlane16_swap_b32 v240, v241
    s_nop 1
    v_max_f32 v240, v240, v241
    v_mov_b32 v241, v240
    s_nop 1
    v_permlane32_swap_b32 v240, v241
    s_nop 1
    v_max_f32 v240, v240, v241
    v_add_f32 v240, 0x41c00000, v240
    v_max_f32 v240, 0, v240
    v_exp_f32 v242, -v240
    v_sub_f32 v116, v116, v240
    v_sub_f32 v117, v117, v240
    v_sub_f32 v118, v118, v240
    v_sub_f32 v119, v119, v240
    v_sub_f32 v168, v168, v240
    v_sub_f32 v169, v169, v240
    v_sub_f32 v170, v170, v240
    v_sub_f32 v171, v171, v240
    v_sub_f32 v172, v172, v240
    v_sub_f32 v173, v173, v240
    v_sub_f32 v174, v174, v240
    v_sub_f32 v175, v175, v240
    v_sub_f32 v136, v136, v240
    v_sub_f32 v137, v137, v240
    v_sub_f32 v138, v138, v240
    v_sub_f32 v139, v139, v240
    v_sub_f32 v140, v140, v240
    v_sub_f32 v141, v141, v240
    v_sub_f32 v142, v142, v240
    v_sub_f32 v143, v143, v240
    v_mul_f32 v228, v228, v242
    v_mul_f32 v229, v229, v242
    v_mul_f32 v230, v230, v242
    v_mul_f32 v231, v231, v242
    v_accvgpr_read_b32 v241, a32
    v_mul_f32 v241, v241, v242
    v_accvgpr_write_b32 a32, v241
    v_accvgpr_read_b32 v241, a33
    v_mul_f32 v241, v241, v242
    v_accvgpr_write_b32 a33, v241
    v_accvgpr_read_b32 v241, a34
    v_mul_f32 v241, v241, v242
    v_accvgpr_write_b32 a34, v241
    v_accvgpr_read_b32 v241, a35
    v_mul_f32 v241, v241, v242
    v_accvgpr_write_b32 a35, v241
    v_accvgpr_read_b32 v241, a36
    v_mul_f32 v241, v241, v242
    v_accvgpr_write_b32 a36, v241
    v_accvgpr_read_b32 v241, a37
    v_mul_f32 v241, v241, v242
    v_accvgpr_write_b32 a37, v241
    v_accvgpr_read_b32 v241, a38
    v_mul_f32 v241, v241, v242
    v_accvgpr_write_b32 a38, v241
    v_accvgpr_read_b32 v241, a39
    v_mul_f32 v241, v241, v242
    v_accvgpr_write_b32 a39, v241
    v_accvgpr_read_b32 v241, a40
    v_mul_f32 v241, v241, v242
    v_accvgpr_write_b32 a40, v241
    v_accvgpr_read_b32 v241, a41
    v_mul_f32 v241, v241, v242
    v_accvgpr_write_b32 a41, v241
    v_accvgpr_read_b32 v241, a42
    v_mul_f32 v241, v241, v242
    v_accvgpr_write_b32 a42, v241
    v_accvgpr_read_b32 v241, a43
    v_mul_f32 v241, v241, v242
    v_accvgpr_write_b32 a43, v241
    v_accvgpr_read_b32 v241, a44
    v_mul_f32 v241, v241, v242
    v_accvgpr_write_b32 a44, v241
    v_accvgpr_read_b32 v241, a45
    v_mul_f32 v241, v241, v242
    v_accvgpr_write_b32 a45, v241
    v_accvgpr_read_b32 v241, a46
    v_mul_f32 v241, v241, v242
    v_accvgpr_write_b32 a46, v241
    v_accvgpr_read_b32 v241, a47
    v_mul_f32 v241, v241, v242
    v_accvgpr_write_b32 a47, v241
    v_accvgpr_read_b32 v241, a48
    v_mul_f32 v241, v241, v242
    v_accvgpr_write_b32 a48, v241
    v_accvgpr_read_b32 v241, a49
    v_mul_f32 v241, v241, v242
    v_accvgpr_write_b32 a49, v241
    v_accvgpr_read_b32 v241, a50
    v_mul_f32 v241, v241, v242
    v_accvgpr_write_b32 a50, v241
    v_accvgpr_read_b32 v241, a51
    v_mul_f32 v241, v241, v242
    v_accvgpr_write_b32 a51, v241
    v_accvgpr_read_b32 v241, a52
    v_mul_f32 v241, v241, v242
    v_accvgpr_write_b32 a52, v241
    v_accvgpr_read_b32 v241, a53
    v_mul_f32 v241, v241, v242
    v_accvgpr_write_b32 a53, v241
    v_accvgpr_read_b32 v241, a54
    v_mul_f32 v241, v241, v242
    v_accvgpr_write_b32 a54, v241
    v_accvgpr_read_b32 v241, a55
    v_mul_f32 v241, v241, v242
    v_accvgpr_write_b32 a55, v241
    v_accvgpr_read_b32 v241, a56
    v_mul_f32 v241, v241, v242
    v_accvgpr_write_b32 a56, v241
    v_accvgpr_read_b32 v241, a57
    v_mul_f32 v241, v241, v242
    v_accvgpr_write_b32 a57, v241
    v_accvgpr_read_b32 v241, a58
    v_mul_f32 v241, v241, v242
    v_accvgpr_write_b32 a58, v241
    v_accvgpr_read_b32 v241, a59
    v_mul_f32 v241, v241, v242
    v_accvgpr_write_b32 a59, v241
    v_accvgpr_read_b32 v241, a60
    v_mul_f32 v241, v241, v242
    v_accvgpr_write_b32 a60, v241
    v_accvgpr_read_b32 v241, a61
    v_mul_f32 v241, v241, v242
    v_accvgpr_write_b32 a61, v241
    v_accvgpr_read_b32 v241, a62
    v_mul_f32 v241, v241, v242
    v_accvgpr_write_b32 a62, v241
    v_accvgpr_read_b32 v241, a63
    v_mul_f32 v241, v241, v242
    v_accvgpr_write_b32 a63, v241
    v_exp_f32 v244, v168
    v_exp_f32 v245, v169
    s_nop 0
    v_cvt_pk_bf16_f32 v212, v244, v245
    v_exp_f32 v244, v170
    v_exp_f32 v245, v171
    s_nop 0
    v_cvt_pk_bf16_f32 v213, v244, v245
    v_exp_f32 v244, v172
    v_exp_f32 v245, v173
    s_nop 0
    v_cvt_pk_bf16_f32 v214, v244, v245
    v_exp_f32 v244, v174
    v_exp_f32 v245, v175
    s_nop 0
    v_cvt_pk_bf16_f32 v215, v244, v245
    v_max3_f32 v240, v176, v177, v178
    v_max3_f32 v240, v179, v180, v240
    v_max3_f32 v240, v181, v182, v240
    v_max_f32 v240, v183, v240
    v_mov_b32 v241, v240
    s_nop 1
    v_permlane16_swap_b32 v240, v241
    s_nop 1
    v_max_f32 v240, v240, v241
    v_mov_b32 v241, v240
    s_nop 1
    v_permlane32_swap_b32 v240, v241
    s_nop 1
    v_max_f32 v240, v240, v241
    v_add_f32 v240, 0x41c00000, v240
    v_max_f32 v240, 0, v240
    v_exp_f32 v242, -v240
    v_sub_f32 v120, v120, v240
    v_sub_f32 v121, v121, v240
    v_sub_f32 v122, v122, v240
    v_sub_f32 v123, v123, v240
    v_sub_f32 v176, v176, v240
    v_sub_f32 v177, v177, v240
    v_sub_f32 v178, v178, v240
    v_sub_f32 v179, v179, v240
    v_sub_f32 v180, v180, v240
    v_sub_f32 v181, v181, v240
    v_sub_f32 v182, v182, v240
    v_sub_f32 v183, v183, v240
    v_sub_f32 v144, v144, v240
    v_sub_f32 v145, v145, v240
    v_sub_f32 v146, v146, v240
    v_sub_f32 v147, v147, v240
    v_sub_f32 v148, v148, v240
    v_sub_f32 v149, v149, v240
    v_sub_f32 v150, v150, v240
    v_sub_f32 v151, v151, v240
    v_mul_f32 v232, v232, v242
    v_mul_f32 v233, v233, v242
    v_mul_f32 v234, v234, v242
    v_mul_f32 v235, v235, v242
    v_accvgpr_read_b32 v241, a64
    v_mul_f32 v241, v241, v242
    v_accvgpr_write_b32 a64, v241
    v_accvgpr_read_b32 v241, a65
    v_mul_f32 v241, v241, v242
    v_accvgpr_write_b32 a65, v241
    v_accvgpr_read_b32 v241, a66
    v_mul_f32 v241, v241, v242
    v_accvgpr_write_b32 a66, v241
    v_accvgpr_read_b32 v241, a67
    v_mul_f32 v241, v241, v242
    v_accvgpr_write_b32 a67, v241
    v_accvgpr_read_b32 v241, a68
    v_mul_f32 v241, v241, v242
    v_accvgpr_write_b32 a68, v241
    v_accvgpr_read_b32 v241, a69
    v_mul_f32 v241, v241, v242
    v_accvgpr_write_b32 a69, v241
    v_accvgpr_read_b32 v241, a70
    v_mul_f32 v241, v241, v242
    v_accvgpr_write_b32 a70, v241
    v_accvgpr_read_b32 v241, a71
    v_mul_f32 v241, v241, v242
    v_accvgpr_write_b32 a71, v241
    v_accvgpr_read_b32 v241, a72
    v_mul_f32 v241, v241, v242
    v_accvgpr_write_b32 a72, v241
    v_accvgpr_read_b32 v241, a73
    v_mul_f32 v241, v241, v242
    v_accvgpr_write_b32 a73, v241
    v_accvgpr_read_b32 v241, a74
    v_mul_f32 v241, v241, v242
    v_accvgpr_write_b32 a74, v241
    v_accvgpr_read_b32 v241, a75
    v_mul_f32 v241, v241, v242
    v_accvgpr_write_b32 a75, v241
    v_accvgpr_read_b32 v241, a76
    v_mul_f32 v241, v241, v242
    v_accvgpr_write_b32 a76, v241
    v_accvgpr_read_b32 v241, a77
    v_mul_f32 v241, v241, v242
    v_accvgpr_write_b32 a77, v241
    v_accvgpr_read_b32 v241, a78
    v_mul_f32 v241, v241, v242
    v_accvgpr_write_b32 a78, v241
    v_accvgpr_read_b32 v241, a79
    v_mul_f32 v241, v241, v242
    v_accvgpr_write_b32 a79, v241
    v_accvgpr_read_b32 v241, a80
    v_mul_f32 v241, v241, v242
    v_accvgpr_write_b32 a80, v241
    v_accvgpr_read_b32 v241, a81
    v_mul_f32 v241, v241, v242
    v_accvgpr_write_b32 a81, v241
    v_accvgpr_read_b32 v241, a82
    v_mul_f32 v241, v241, v242
    v_accvgpr_write_b32 a82, v241
    v_accvgpr_read_b32 v241, a83
    v_mul_f32 v241, v241, v242
    v_accvgpr_write_b32 a83, v241
    v_accvgpr_read_b32 v241, a84
    v_mul_f32 v241, v241, v242
    v_accvgpr_write_b32 a84, v241
    v_accvgpr_read_b32 v241, a85
    v_mul_f32 v241, v241, v242
    v_accvgpr_write_b32 a85, v241
    v_accvgpr_read_b32 v241, a86
    v_mul_f32 v241, v241, v242
    v_accvgpr_write_b32 a86, v241
    v_accvgpr_read_b32 v241, a87
    v_mul_f32 v241, v241, v242
    v_accvgpr_write_b32 a87, v241
    v_accvgpr_read_b32 v241, a88
    v_mul_f32 v241, v241, v242
    v_accvgpr_write_b32 a88, v241
    v_accvgpr_read_b32 v241, a89
    v_mul_f32 v241, v241, v242
    v_accvgpr_write_b32 a89, v241
    v_accvgpr_read_b32 v241, a90
    v_mul_f32 v241, v241, v242
    v_accvgpr_write_b32 a90, v241
    v_accvgpr_read_b32 v241, a91
    v_mul_f32 v241, v241, v242
    v_accvgpr_write_b32 a91, v241
    v_accvgpr_read_b32 v241, a92
    v_mul_f32 v241, v241, v242
    v_accvgpr_write_b32 a92, v241
    v_accvgpr_read_b32 v241, a93
    v_mul_f32 v241, v241, v242
    v_accvgpr_write_b32 a93, v241
    v_accvgpr_read_b32 v241, a94
    v_mul_f32 v241, v241, v242
    v_accvgpr_write_b32 a94, v241
    v_accvgpr_read_b32 v241, a95
    v_mul_f32 v241, v241, v242
    v_accvgpr_write_b32 a95, v241
    v_exp_f32 v244, v176
    v_exp_f32 v245, v177
    s_nop 0
    v_cvt_pk_bf16_f32 v216, v244, v245
    v_exp_f32 v244, v178
    v_exp_f32 v245, v179
    s_nop 0
    v_cvt_pk_bf16_f32 v217, v244, v245
    v_exp_f32 v244, v180
    v_exp_f32 v245, v181
    s_nop 0
    v_cvt_pk_bf16_f32 v218, v244, v245
    v_exp_f32 v244, v182
    v_exp_f32 v245, v183
    s_nop 0
    v_cvt_pk_bf16_f32 v219, v244, v245
    v_max3_f32 v240, v184, v185, v186
    v_max3_f32 v240, v187, v188, v240
    v_max3_f32 v240, v189, v190, v240
    v_max_f32 v240, v191, v240
    v_mov_b32 v241, v240
    s_nop 1
    v_permlane16_swap_b32 v240, v241
    s_nop 1
    v_max_f32 v240, v240, v241
    v_mov_b32 v241, v240
    s_nop 1
    v_permlane32_swap_b32 v240, v241
    s_nop 1
    v_max_f32 v240, v240, v241
    v_add_f32 v240, 0x41c00000, v240
    v_max_f32 v240, 0, v240
    v_exp_f32 v242, -v240
    v_sub_f32 v124, v124, v240
    v_sub_f32 v125, v125, v240
    v_sub_f32 v126, v126, v240
    v_sub_f32 v127, v127, v240
    v_sub_f32 v184, v184, v240
    v_sub_f32 v185, v185, v240
    v_sub_f32 v186, v186, v240
    v_sub_f32 v187, v187, v240
    v_sub_f32 v188, v188, v240
    v_sub_f32 v189, v189, v240
    v_sub_f32 v190, v190, v240
    v_sub_f32 v191, v191, v240
    v_sub_f32 v152, v152, v240
    v_sub_f32 v153, v153, v240
    v_sub_f32 v154, v154, v240
    v_sub_f32 v155, v155, v240
    v_sub_f32 v156, v156, v240
    v_sub_f32 v157, v157, v240
    v_sub_f32 v158, v158, v240
    v_sub_f32 v159, v159, v240
    v_mul_f32 v236, v236, v242
    v_mul_f32 v237, v237, v242
    v_mul_f32 v238, v238, v242
    v_mul_f32 v239, v239, v242
    v_accvgpr_read_b32 v241, a96
    v_mul_f32 v241, v241, v242
    v_accvgpr_write_b32 a96, v241
    v_accvgpr_read_b32 v241, a97
    v_mul_f32 v241, v241, v242
    v_accvgpr_write_b32 a97, v241
    v_accvgpr_read_b32 v241, a98
    v_mul_f32 v241, v241, v242
    v_accvgpr_write_b32 a98, v241
    v_accvgpr_read_b32 v241, a99
    v_mul_f32 v241, v241, v242
    v_accvgpr_write_b32 a99, v241
    v_accvgpr_read_b32 v241, a100
    v_mul_f32 v241, v241, v242
    v_accvgpr_write_b32 a100, v241
    v_accvgpr_read_b32 v241, a101
    v_mul_f32 v241, v241, v242
    v_accvgpr_write_b32 a101, v241
    v_accvgpr_read_b32 v241, a102
    v_mul_f32 v241, v241, v242
    v_accvgpr_write_b32 a102, v241
    v_accvgpr_read_b32 v241, a103
    v_mul_f32 v241, v241, v242
    v_accvgpr_write_b32 a103, v241
    v_accvgpr_read_b32 v241, a104
    v_mul_f32 v241, v241, v242
    v_accvgpr_write_b32 a104, v241
    v_accvgpr_read_b32 v241, a105
    v_mul_f32 v241, v241, v242
    v_accvgpr_write_b32 a105, v241
    v_accvgpr_read_b32 v241, a106
    v_mul_f32 v241, v241, v242
    v_accvgpr_write_b32 a106, v241
    v_accvgpr_read_b32 v241, a107
    v_mul_f32 v241, v241, v242
    v_accvgpr_write_b32 a107, v241
    v_accvgpr_read_b32 v241, a108
    v_mul_f32 v241, v241, v242
    v_accvgpr_write_b32 a108, v241
    v_accvgpr_read_b32 v241, a109
    v_mul_f32 v241, v241, v242
    v_accvgpr_write_b32 a109, v241
    v_accvgpr_read_b32 v241, a110
    v_mul_f32 v241, v241, v242
    v_accvgpr_write_b32 a110, v241
    v_accvgpr_read_b32 v241, a111
    v_mul_f32 v241, v241, v242
    v_accvgpr_write_b32 a111, v241
    v_accvgpr_read_b32 v241, a112
    v_mul_f32 v241, v241, v242
    v_accvgpr_write_b32 a112, v241
    v_accvgpr_read_b32 v241, a113
    v_mul_f32 v241, v241, v242
    v_accvgpr_write_b32 a113, v241
    v_accvgpr_read_b32 v241, a114
    v_mul_f32 v241, v241, v242
    v_accvgpr_write_b32 a114, v241
    v_accvgpr_read_b32 v241, a115
    v_mul_f32 v241, v241, v242
    v_accvgpr_write_b32 a115, v241
    v_accvgpr_read_b32 v241, a116
    v_mul_f32 v241, v241, v242
    v_accvgpr_write_b32 a116, v241
    v_accvgpr_read_b32 v241, a117
    v_mul_f32 v241, v241, v242
    v_accvgpr_write_b32 a117, v241
    v_accvgpr_read_b32 v241, a118
    v_mul_f32 v241, v241, v242
    v_accvgpr_write_b32 a118, v241
    v_accvgpr_read_b32 v241, a119
    v_mul_f32 v241, v241, v242
    v_accvgpr_write_b32 a119, v241
    v_accvgpr_read_b32 v241, a120
    v_mul_f32 v241, v241, v242
    v_accvgpr_write_b32 a120, v241
    v_accvgpr_read_b32 v241, a121
    v_mul_f32 v241, v241, v242
    v_accvgpr_write_b32 a121, v241
    v_accvgpr_read_b32 v241, a122
    v_mul_f32 v241, v241, v242
    v_accvgpr_write_b32 a122, v241
    v_accvgpr_read_b32 v241, a123
    v_mul_f32 v241, v241, v242
    v_accvgpr_write_b32 a123, v241
    v_accvgpr_read_b32 v241, a124
    v_mul_f32 v241, v241, v242
    v_accvgpr_write_b32 a124, v241
    v_accvgpr_read_b32 v241, a125
    v_mul_f32 v241, v241, v242
    v_accvgpr_write_b32 a125, v241
    v_accvgpr_read_b32 v241, a126
    v_mul_f32 v241, v241, v242
    v_accvgpr_write_b32 a126, v241
    v_accvgpr_read_b32 v241, a127
    v_mul_f32 v241, v241, v242
    v_accvgpr_write_b32 a127, v241
    v_exp_f32 v244, v184
    v_exp_f32 v245, v185
    s_nop 0
    v_cvt_pk_bf16_f32 v220, v244, v245
    v_exp_f32 v244, v186
    v_exp_f32 v245, v187
    s_nop 0
    v_cvt_pk_bf16_f32 v221, v244, v245
    v_exp_f32 v244, v188
    v_exp_f32 v245, v189
    s_nop 0
    v_cvt_pk_bf16_f32 v222, v244, v245
    v_exp_f32 v244, v190
    v_exp_f32 v245, v191
    s_nop 0
    v_cvt_pk_bf16_f32 v223, v244, v245
    s_nop 1
    s_branch attn_kernel_b3_r1_ret
attn_kernel_b2_r0:
    s_nop 7
    v_max3_f32 v240, v144, v145, v146
    v_max3_f32 v240, v147, v148, v240
    v_max3_f32 v240, v149, v150, v240
    v_max_f32 v240, v151, v240
    v_mov_b32 v241, v240
    s_nop 1
    v_permlane16_swap_b32 v240, v241
    s_nop 1
    v_max_f32 v240, v240, v241
    v_mov_b32 v241, v240
    s_nop 1
    v_permlane32_swap_b32 v240, v241
    s_nop 1
    v_max_f32 v240, v240, v241
    v_add_f32 v240, 0x41c00000, v240
    v_max_f32 v240, 0, v240
    v_exp_f32 v242, -v240
    v_sub_f32 v120, v120, v240
    v_sub_f32 v121, v121, v240
    v_sub_f32 v122, v122, v240
    v_sub_f32 v123, v123, v240
    v_sub_f32 v144, v144, v240
    v_sub_f32 v145, v145, v240
    v_sub_f32 v146, v146, v240
    v_sub_f32 v147, v147, v240
    v_sub_f32 v148, v148, v240
    v_sub_f32 v149, v149, v240
    v_sub_f32 v150, v150, v240
    v_sub_f32 v151, v151, v240
    v_sub_f32 v176, v176, v240
    v_sub_f32 v177, v177, v240
    v_sub_f32 v178, v178, v240
    v_sub_f32 v179, v179, v240
    v_sub_f32 v180, v180, v240
    v_sub_f32 v181, v181, v240
    v_sub_f32 v182, v182, v240
    v_sub_f32 v183, v183, v240
    v_mul_f32 v232, v232, v242
    v_mul_f32 v233, v233, v242
    v_mul_f32 v234, v234, v242
    v_mul_f32 v235, v235, v242
    v_accvgpr_read_b32 v241, a64
    v_mul_f32 v241, v241, v242
    v_accvgpr_write_b32 a64, v241
    v_accvgpr_read_b32 v241, a65
    v_mul_f32 v241, v241, v242
    v_accvgpr_write_b32 a65, v241
    v_accvgpr_read_b32 v241, a66
    v_mul_f32 v241, v241, v242
    v_accvgpr_write_b32 a66, v241
    v_accvgpr_read_b32 v241, a67
    v_mul_f32 v241, v241, v242
    v_accvgpr_write_b32 a67, v241
    v_accvgpr_read_b32 v241, a68
    v_mul_f32 v241, v241, v242
    v_accvgpr_write_b32 a68, v241
    v_accvgpr_read_b32 v241, a69
    v_mul_f32 v241, v241, v242
    v_accvgpr_write_b32 a69, v241
    v_accvgpr_read_b32 v241, a70
    v_mul_f32 v241, v241, v242
    v_accvgpr_write_b32 a70, v241
    v_accvgpr_read_b32 v241, a71
    v_mul_f32 v241, v241, v242
    v_accvgpr_write_b32 a71, v241
    v_accvgpr_read_b32 v241, a72
    v_mul_f32 v241, v241, v242
    v_accvgpr_write_b32 a72, v241
    v_accvgpr_read_b32 v241, a73
    v_mul_f32 v241, v241, v242
    v_accvgpr_write_b32 a73, v241
    v_accvgpr_read_b32 v241, a74
    v_mul_f32 v241, v241, v242
    v_accvgpr_write_b32 a74, v241
    v_accvgpr_read_b32 v241, a75
    v_mul_f32 v241, v241, v242
    v_accvgpr_write_b32 a75, v241
    v_accvgpr_read_b32 v241, a76
    v_mul_f32 v241, v241, v242
    v_accvgpr_write_b32 a76, v241
    v_accvgpr_read_b32 v241, a77
    v_mul_f32 v241, v241, v242
    v_accvgpr_write_b32 a77, v241
    v_accvgpr_read_b32 v241, a78
    v_mul_f32 v241, v241, v242
    v_accvgpr_write_b32 a78, v241
    v_accvgpr_read_b32 v241, a79
    v_mul_f32 v241, v241, v242
    v_accvgpr_write_b32 a79, v241
    v_accvgpr_read_b32 v241, a80
    v_mul_f32 v241, v241, v242
    v_accvgpr_write_b32 a80, v241
    v_accvgpr_read_b32 v241, a81
    v_mul_f32 v241, v241, v242
    v_accvgpr_write_b32 a81, v241
    v_accvgpr_read_b32 v241, a82
    v_mul_f32 v241, v241, v242
    v_accvgpr_write_b32 a82, v241
    v_accvgpr_read_b32 v241, a83
    v_mul_f32 v241, v241, v242
    v_accvgpr_write_b32 a83, v241
    v_accvgpr_read_b32 v241, a84
    v_mul_f32 v241, v241, v242
    v_accvgpr_write_b32 a84, v241
    v_accvgpr_read_b32 v241, a85
    v_mul_f32 v241, v241, v242
    v_accvgpr_write_b32 a85, v241
    v_accvgpr_read_b32 v241, a86
    v_mul_f32 v241, v241, v242
    v_accvgpr_write_b32 a86, v241
    v_accvgpr_read_b32 v241, a87
    v_mul_f32 v241, v241, v242
    v_accvgpr_write_b32 a87, v241
    v_accvgpr_read_b32 v241, a88
    v_mul_f32 v241, v241, v242
    v_accvgpr_write_b32 a88, v241
    v_accvgpr_read_b32 v241, a89
    v_mul_f32 v241, v241, v242
    v_accvgpr_write_b32 a89, v241
    v_accvgpr_read_b32 v241, a90
    v_mul_f32 v241, v241, v242
    v_accvgpr_write_b32 a90, v241
    v_accvgpr_read_b32 v241, a91
    v_mul_f32 v241, v241, v242
    v_accvgpr_write_b32 a91, v241
    v_accvgpr_read_b32 v241, a92
    v_mul_f32 v241, v241, v242
    v_accvgpr_write_b32 a92, v241
    v_accvgpr_read_b32 v241, a93
    v_mul_f32 v241, v241, v242
    v_accvgpr_write_b32 a93, v241
    v_accvgpr_read_b32 v241, a94
    v_mul_f32 v241, v241, v242
    v_accvgpr_write_b32 a94, v241
    v_accvgpr_read_b32 v241, a95
    v_mul_f32 v241, v241, v242
    v_accvgpr_write_b32 a95, v241
    v_exp_f32 v244, v144
    v_exp_f32 v245, v145
    s_nop 0
    v_cvt_pk_bf16_f32 v200, v244, v245
    v_exp_f32 v244, v146
    v_exp_f32 v245, v147
    s_nop 0
    v_cvt_pk_bf16_f32 v201, v244, v245
    v_exp_f32 v244, v148
    v_exp_f32 v245, v149
    s_nop 0
    v_cvt_pk_bf16_f32 v202, v244, v245
    v_exp_f32 v244, v150
    v_exp_f32 v245, v151
    s_nop 0
    v_cvt_pk_bf16_f32 v203, v244, v245
    v_max3_f32 v240, v152, v153, v154
    v_max3_f32 v240, v155, v156, v240
    v_max3_f32 v240, v157, v158, v240
    v_max_f32 v240, v159, v240
    v_mov_b32 v241, v240
    s_nop 1
    v_permlane16_swap_b32 v240, v241
    s_nop 1
    v_max_f32 v240, v240, v241
    v_mov_b32 v241, v240
    s_nop 1
    v_permlane32_swap_b32 v240, v241
    s_nop 1
    v_max_f32 v240, v240, v241
    v_add_f32 v240, 0x41c00000, v240
    v_max_f32 v240, 0, v240
    v_exp_f32 v242, -v240
    v_sub_f32 v124, v124, v240
    v_sub_f32 v125, v125, v240
    v_sub_f32 v126, v126, v240
    v_sub_f32 v127, v127, v240
    v_sub_f32 v152, v152, v240
    v_sub_f32 v153, v153, v240
    v_sub_f32 v154, v154, v240
    v_sub_f32 v155, v155, v240
    v_sub_f32 v156, v156, v240
    v_sub_f32 v157, v157, v240
    v_sub_f32 v158, v158, v240
    v_sub_f32 v159, v159, v240
    v_sub_f32 v184, v184, v240
    v_sub_f32 v185, v185, v240
    v_sub_f32 v186, v186, v240
    v_sub_f32 v187, v187, v240
    v_sub_f32 v188, v188, v240
    v_sub_f32 v189, v189, v240
    v_sub_f32 v190, v190, v240
    v_sub_f32 v191, v191, v240
    v_mul_f32 v236, v236, v242
    v_mul_f32 v237, v237, v242
    v_mul_f32 v238, v238, v242
    v_mul_f32 v239, v239, v242
    v_accvgpr_read_b32 v241, a96
    v_mul_f32 v241, v241, v242
    v_accvgpr_write_b32 a96, v241
    v_accvgpr_read_b32 v241, a97
    v_mul_f32 v241, v241, v242
    v_accvgpr_write_b32 a97, v241
    v_accvgpr_read_b32 v241, a98
    v_mul_f32 v241, v241, v242
    v_accvgpr_write_b32 a98, v241
    v_accvgpr_read_b32 v241, a99
    v_mul_f32 v241, v241, v242
    v_accvgpr_write_b32 a99, v241
    v_accvgpr_read_b32 v241, a100
    v_mul_f32 v241, v241, v242
    v_accvgpr_write_b32 a100, v241
    v_accvgpr_read_b32 v241, a101
    v_mul_f32 v241, v241, v242
    v_accvgpr_write_b32 a101, v241
    v_accvgpr_read_b32 v241, a102
    v_mul_f32 v241, v241, v242
    v_accvgpr_write_b32 a102, v241
    v_accvgpr_read_b32 v241, a103
    v_mul_f32 v241, v241, v242
    v_accvgpr_write_b32 a103, v241
    v_accvgpr_read_b32 v241, a104
    v_mul_f32 v241, v241, v242
    v_accvgpr_write_b32 a104, v241
    v_accvgpr_read_b32 v241, a105
    v_mul_f32 v241, v241, v242
    v_accvgpr_write_b32 a105, v241
    v_accvgpr_read_b32 v241, a106
    v_mul_f32 v241, v241, v242
    v_accvgpr_write_b32 a106, v241
    v_accvgpr_read_b32 v241, a107
    v_mul_f32 v241, v241, v242
    v_accvgpr_write_b32 a107, v241
    v_accvgpr_read_b32 v241, a108
    v_mul_f32 v241, v241, v242
    v_accvgpr_write_b32 a108, v241
    v_accvgpr_read_b32 v241, a109
    v_mul_f32 v241, v241, v242
    v_accvgpr_write_b32 a109, v241
    v_accvgpr_read_b32 v241, a110
    v_mul_f32 v241, v241, v242
    v_accvgpr_write_b32 a110, v241
    v_accvgpr_read_b32 v241, a111
    v_mul_f32 v241, v241, v242
    v_accvgpr_write_b32 a111, v241
    v_accvgpr_read_b32 v241, a112
    v_mul_f32 v241, v241, v242
    v_accvgpr_write_b32 a112, v241
    v_accvgpr_read_b32 v241, a113
    v_mul_f32 v241, v241, v242
    v_accvgpr_write_b32 a113, v241
    v_accvgpr_read_b32 v241, a114
    v_mul_f32 v241, v241, v242
    v_accvgpr_write_b32 a114, v241
    v_accvgpr_read_b32 v241, a115
    v_mul_f32 v241, v241, v242
    v_accvgpr_write_b32 a115, v241
    v_accvgpr_read_b32 v241, a116
    v_mul_f32 v241, v241, v242
    v_accvgpr_write_b32 a116, v241
    v_accvgpr_read_b32 v241, a117
    v_mul_f32 v241, v241, v242
    v_accvgpr_write_b32 a117, v241
    v_accvgpr_read_b32 v241, a118
    v_mul_f32 v241, v241, v242
    v_accvgpr_write_b32 a118, v241
    v_accvgpr_read_b32 v241, a119
    v_mul_f32 v241, v241, v242
    v_accvgpr_write_b32 a119, v241
    v_accvgpr_read_b32 v241, a120
    v_mul_f32 v241, v241, v242
    v_accvgpr_write_b32 a120, v241
    v_accvgpr_read_b32 v241, a121
    v_mul_f32 v241, v241, v242
    v_accvgpr_write_b32 a121, v241
    v_accvgpr_read_b32 v241, a122
    v_mul_f32 v241, v241, v242
    v_accvgpr_write_b32 a122, v241
    v_accvgpr_read_b32 v241, a123
    v_mul_f32 v241, v241, v242
    v_accvgpr_write_b32 a123, v241
    v_accvgpr_read_b32 v241, a124
    v_mul_f32 v241, v241, v242
    v_accvgpr_write_b32 a124, v241
    v_accvgpr_read_b32 v241, a125
    v_mul_f32 v241, v241, v242
    v_accvgpr_write_b32 a125, v241
    v_accvgpr_read_b32 v241, a126
    v_mul_f32 v241, v241, v242
    v_accvgpr_write_b32 a126, v241
    v_accvgpr_read_b32 v241, a127
    v_mul_f32 v241, v241, v242
    v_accvgpr_write_b32 a127, v241
    v_exp_f32 v244, v152
    v_exp_f32 v245, v153
    s_nop 0
    v_cvt_pk_bf16_f32 v204, v244, v245
    v_exp_f32 v244, v154
    v_exp_f32 v245, v155
    s_nop 0
    v_cvt_pk_bf16_f32 v205, v244, v245
    v_exp_f32 v244, v156
    v_exp_f32 v245, v157
    s_nop 0
    v_cvt_pk_bf16_f32 v206, v244, v245
    v_exp_f32 v244, v158
    v_exp_f32 v245, v159
    s_nop 0
    v_cvt_pk_bf16_f32 v207, v244, v245
    s_nop 1
    s_branch attn_kernel_b2_r0_ret
attn_kernel_b2_r1:
    s_nop 7
    v_max3_f32 v240, v176, v177, v178
    v_max3_f32 v240, v179, v180, v240
    v_max3_f32 v240, v181, v182, v240
    v_max_f32 v240, v183, v240
    v_mov_b32 v241, v240
    s_nop 1
    v_permlane16_swap_b32 v240, v241
    s_nop 1
    v_max_f32 v240, v240, v241
    v_mov_b32 v241, v240
    s_nop 1
    v_permlane32_swap_b32 v240, v241
    s_nop 1
    v_max_f32 v240, v240, v241
    v_add_f32 v240, 0x41c00000, v240
    v_max_f32 v240, 0, v240
    v_exp_f32 v242, -v240
    v_sub_f32 v120, v120, v240
    v_sub_f32 v121, v121, v240
    v_sub_f32 v122, v122, v240
    v_sub_f32 v123, v123, v240
    v_sub_f32 v176, v176, v240
    v_sub_f32 v177, v177, v240
    v_sub_f32 v178, v178, v240
    v_sub_f32 v179, v179, v240
    v_sub_f32 v180, v180, v240
    v_sub_f32 v181, v181, v240
    v_sub_f32 v182, v182, v240
    v_sub_f32 v183, v183, v240
    v_sub_f32 v144, v144, v240
    v_sub_f32 v145, v145, v240
    v_sub_f32 v146, v146, v240
    v_sub_f32 v147, v147, v240
    v_sub_f32 v148, v148, v240
    v_sub_f32 v149, v149, v240
    v_sub_f32 v150, v150, v240
    v_sub_f32 v151, v151, v240
    v_mul_f32 v232, v232, v242
    v_mul_f32 v233, v233, v242
    v_mul_f32 v234, v234, v242
    v_mul_f32 v235, v235, v242
    v_accvgpr_read_b32 v241, a64
    v_mul_f32 v241, v241, v242
    v_accvgpr_write_b32 a64, v241
    v_accvgpr_read_b32 v241, a65
    v_mul_f32 v241, v241, v242
    v_accvgpr_write_b32 a65, v241
    v_accvgpr_read_b32 v241, a66
    v_mul_f32 v241, v241, v242
    v_accvgpr_write_b32 a66, v241
    v_accvgpr_read_b32 v241, a67
    v_mul_f32 v241, v241, v242
    v_accvgpr_write_b32 a67, v241
    v_accvgpr_read_b32 v241, a68
    v_mul_f32 v241, v241, v242
    v_accvgpr_write_b32 a68, v241
    v_accvgpr_read_b32 v241, a69
    v_mul_f32 v241, v241, v242
    v_accvgpr_write_b32 a69, v241
    v_accvgpr_read_b32 v241, a70
    v_mul_f32 v241, v241, v242
    v_accvgpr_write_b32 a70, v241
    v_accvgpr_read_b32 v241, a71
    v_mul_f32 v241, v241, v242
    v_accvgpr_write_b32 a71, v241
    v_accvgpr_read_b32 v241, a72
    v_mul_f32 v241, v241, v242
    v_accvgpr_write_b32 a72, v241
    v_accvgpr_read_b32 v241, a73
    v_mul_f32 v241, v241, v242
    v_accvgpr_write_b32 a73, v241
    v_accvgpr_read_b32 v241, a74
    v_mul_f32 v241, v241, v242
    v_accvgpr_write_b32 a74, v241
    v_accvgpr_read_b32 v241, a75
    v_mul_f32 v241, v241, v242
    v_accvgpr_write_b32 a75, v241
    v_accvgpr_read_b32 v241, a76
    v_mul_f32 v241, v241, v242
    v_accvgpr_write_b32 a76, v241
    v_accvgpr_read_b32 v241, a77
    v_mul_f32 v241, v241, v242
    v_accvgpr_write_b32 a77, v241
    v_accvgpr_read_b32 v241, a78
    v_mul_f32 v241, v241, v242
    v_accvgpr_write_b32 a78, v241
    v_accvgpr_read_b32 v241, a79
    v_mul_f32 v241, v241, v242
    v_accvgpr_write_b32 a79, v241
    v_accvgpr_read_b32 v241, a80
    v_mul_f32 v241, v241, v242
    v_accvgpr_write_b32 a80, v241
    v_accvgpr_read_b32 v241, a81
    v_mul_f32 v241, v241, v242
    v_accvgpr_write_b32 a81, v241
    v_accvgpr_read_b32 v241, a82
    v_mul_f32 v241, v241, v242
    v_accvgpr_write_b32 a82, v241
    v_accvgpr_read_b32 v241, a83
    v_mul_f32 v241, v241, v242
    v_accvgpr_write_b32 a83, v241
    v_accvgpr_read_b32 v241, a84
    v_mul_f32 v241, v241, v242
    v_accvgpr_write_b32 a84, v241
    v_accvgpr_read_b32 v241, a85
    v_mul_f32 v241, v241, v242
    v_accvgpr_write_b32 a85, v241
    v_accvgpr_read_b32 v241, a86
    v_mul_f32 v241, v241, v242
    v_accvgpr_write_b32 a86, v241
    v_accvgpr_read_b32 v241, a87
    v_mul_f32 v241, v241, v242
    v_accvgpr_write_b32 a87, v241
    v_accvgpr_read_b32 v241, a88
    v_mul_f32 v241, v241, v242
    v_accvgpr_write_b32 a88, v241
    v_accvgpr_read_b32 v241, a89
    v_mul_f32 v241, v241, v242
    v_accvgpr_write_b32 a89, v241
    v_accvgpr_read_b32 v241, a90
    v_mul_f32 v241, v241, v242
    v_accvgpr_write_b32 a90, v241
    v_accvgpr_read_b32 v241, a91
    v_mul_f32 v241, v241, v242
    v_accvgpr_write_b32 a91, v241
    v_accvgpr_read_b32 v241, a92
    v_mul_f32 v241, v241, v242
    v_accvgpr_write_b32 a92, v241
    v_accvgpr_read_b32 v241, a93
    v_mul_f32 v241, v241, v242
    v_accvgpr_write_b32 a93, v241
    v_accvgpr_read_b32 v241, a94
    v_mul_f32 v241, v241, v242
    v_accvgpr_write_b32 a94, v241
    v_accvgpr_read_b32 v241, a95
    v_mul_f32 v241, v241, v242
    v_accvgpr_write_b32 a95, v241
    v_exp_f32 v244, v176
    v_exp_f32 v245, v177
    s_nop 0
    v_cvt_pk_bf16_f32 v216, v244, v245
    v_exp_f32 v244, v178
    v_exp_f32 v245, v179
    s_nop 0
    v_cvt_pk_bf16_f32 v217, v244, v245
    v_exp_f32 v244, v180
    v_exp_f32 v245, v181
    s_nop 0
    v_cvt_pk_bf16_f32 v218, v244, v245
    v_exp_f32 v244, v182
    v_exp_f32 v245, v183
    s_nop 0
    v_cvt_pk_bf16_f32 v219, v244, v245
    v_max3_f32 v240, v184, v185, v186
    v_max3_f32 v240, v187, v188, v240
    v_max3_f32 v240, v189, v190, v240
    v_max_f32 v240, v191, v240
    v_mov_b32 v241, v240
    s_nop 1
    v_permlane16_swap_b32 v240, v241
    s_nop 1
    v_max_f32 v240, v240, v241
    v_mov_b32 v241, v240
    s_nop 1
    v_permlane32_swap_b32 v240, v241
    s_nop 1
    v_max_f32 v240, v240, v241
    v_add_f32 v240, 0x41c00000, v240
    v_max_f32 v240, 0, v240
    v_exp_f32 v242, -v240
    v_sub_f32 v124, v124, v240
    v_sub_f32 v125, v125, v240
    v_sub_f32 v126, v126, v240
    v_sub_f32 v127, v127, v240
    v_sub_f32 v184, v184, v240
    v_sub_f32 v185, v185, v240
    v_sub_f32 v186, v186, v240
    v_sub_f32 v187, v187, v240
    v_sub_f32 v188, v188, v240
    v_sub_f32 v189, v189, v240
    v_sub_f32 v190, v190, v240
    v_sub_f32 v191, v191, v240
    v_sub_f32 v152, v152, v240
    v_sub_f32 v153, v153, v240
    v_sub_f32 v154, v154, v240
    v_sub_f32 v155, v155, v240
    v_sub_f32 v156, v156, v240
    v_sub_f32 v157, v157, v240
    v_sub_f32 v158, v158, v240
    v_sub_f32 v159, v159, v240
    v_mul_f32 v236, v236, v242
    v_mul_f32 v237, v237, v242
    v_mul_f32 v238, v238, v242
    v_mul_f32 v239, v239, v242
    v_accvgpr_read_b32 v241, a96
    v_mul_f32 v241, v241, v242
    v_accvgpr_write_b32 a96, v241
    v_accvgpr_read_b32 v241, a97
    v_mul_f32 v241, v241, v242
    v_accvgpr_write_b32 a97, v241
    v_accvgpr_read_b32 v241, a98
    v_mul_f32 v241, v241, v242
    v_accvgpr_write_b32 a98, v241
    v_accvgpr_read_b32 v241, a99
    v_mul_f32 v241, v241, v242
    v_accvgpr_write_b32 a99, v241
    v_accvgpr_read_b32 v241, a100
    v_mul_f32 v241, v241, v242
    v_accvgpr_write_b32 a100, v241
    v_accvgpr_read_b32 v241, a101
    v_mul_f32 v241, v241, v242
    v_accvgpr_write_b32 a101, v241
    v_accvgpr_read_b32 v241, a102
    v_mul_f32 v241, v241, v242
    v_accvgpr_write_b32 a102, v241
    v_accvgpr_read_b32 v241, a103
    v_mul_f32 v241, v241, v242
    v_accvgpr_write_b32 a103, v241
    v_accvgpr_read_b32 v241, a104
    v_mul_f32 v241, v241, v242
    v_accvgpr_write_b32 a104, v241
    v_accvgpr_read_b32 v241, a105
    v_mul_f32 v241, v241, v242
    v_accvgpr_write_b32 a105, v241
    v_accvgpr_read_b32 v241, a106
    v_mul_f32 v241, v241, v242
    v_accvgpr_write_b32 a106, v241
    v_accvgpr_read_b32 v241, a107
    v_mul_f32 v241, v241, v242
    v_accvgpr_write_b32 a107, v241
    v_accvgpr_read_b32 v241, a108
    v_mul_f32 v241, v241, v242
    v_accvgpr_write_b32 a108, v241
    v_accvgpr_read_b32 v241, a109
    v_mul_f32 v241, v241, v242
    v_accvgpr_write_b32 a109, v241
    v_accvgpr_read_b32 v241, a110
    v_mul_f32 v241, v241, v242
    v_accvgpr_write_b32 a110, v241
    v_accvgpr_read_b32 v241, a111
    v_mul_f32 v241, v241, v242
    v_accvgpr_write_b32 a111, v241
    v_accvgpr_read_b32 v241, a112
    v_mul_f32 v241, v241, v242
    v_accvgpr_write_b32 a112, v241
    v_accvgpr_read_b32 v241, a113
    v_mul_f32 v241, v241, v242
    v_accvgpr_write_b32 a113, v241
    v_accvgpr_read_b32 v241, a114
    v_mul_f32 v241, v241, v242
    v_accvgpr_write_b32 a114, v241
    v_accvgpr_read_b32 v241, a115
    v_mul_f32 v241, v241, v242
    v_accvgpr_write_b32 a115, v241
    v_accvgpr_read_b32 v241, a116
    v_mul_f32 v241, v241, v242
    v_accvgpr_write_b32 a116, v241
    v_accvgpr_read_b32 v241, a117
    v_mul_f32 v241, v241, v242
    v_accvgpr_write_b32 a117, v241
    v_accvgpr_read_b32 v241, a118
    v_mul_f32 v241, v241, v242
    v_accvgpr_write_b32 a118, v241
    v_accvgpr_read_b32 v241, a119
    v_mul_f32 v241, v241, v242
    v_accvgpr_write_b32 a119, v241
    v_accvgpr_read_b32 v241, a120
    v_mul_f32 v241, v241, v242
    v_accvgpr_write_b32 a120, v241
    v_accvgpr_read_b32 v241, a121
    v_mul_f32 v241, v241, v242
    v_accvgpr_write_b32 a121, v241
    v_accvgpr_read_b32 v241, a122
    v_mul_f32 v241, v241, v242
    v_accvgpr_write_b32 a122, v241
    v_accvgpr_read_b32 v241, a123
    v_mul_f32 v241, v241, v242
    v_accvgpr_write_b32 a123, v241
    v_accvgpr_read_b32 v241, a124
    v_mul_f32 v241, v241, v242
    v_accvgpr_write_b32 a124, v241
    v_accvgpr_read_b32 v241, a125
    v_mul_f32 v241, v241, v242
    v_accvgpr_write_b32 a125, v241
    v_accvgpr_read_b32 v241, a126
    v_mul_f32 v241, v241, v242
    v_accvgpr_write_b32 a126, v241
    v_accvgpr_read_b32 v241, a127
    v_mul_f32 v241, v241, v242
    v_accvgpr_write_b32 a127, v241
    v_exp_f32 v244, v184
    v_exp_f32 v245, v185
    s_nop 0
    v_cvt_pk_bf16_f32 v220, v244, v245
    v_exp_f32 v244, v186
    v_exp_f32 v245, v187
    s_nop 0
    v_cvt_pk_bf16_f32 v221, v244, v245
    v_exp_f32 v244, v188
    v_exp_f32 v245, v189
    s_nop 0
    v_cvt_pk_bf16_f32 v222, v244, v245
    v_exp_f32 v244, v190
    v_exp_f32 v245, v191
    s_nop 0
    v_cvt_pk_bf16_f32 v223, v244, v245
    s_nop 1
    s_branch attn_kernel_b2_r1_ret
attn_kernel_b1_r0:
    s_nop 7
    v_max3_f32 v240, v152, v153, v154
    v_max3_f32 v240, v155, v156, v240
    v_max3_f32 v240, v157, v158, v240
    v_max_f32 v240, v159, v240
    v_mov_b32 v241, v240
    s_nop 1
    v_permlane16_swap_b32 v240, v241
    s_nop 1
    v_max_f32 v240, v240, v241
    v_mov_b32 v241, v240
    s_nop 1
    v_permlane32_swap_b32 v240, v241
    s_nop 1
    v_max_f32 v240, v240, v241
    v_add_f32 v240, 0x41c00000, v240
    v_max_f32 v240, 0, v240
    v_exp_f32 v242, -v240
    v_sub_f32 v124, v124, v240
    v_sub_f32 v125, v125, v240
    v_sub_f32 v126, v126, v240
    v_sub_f32 v127, v127, v240
    v_sub_f32 v152, v152, v240
    v_sub_f32 v153, v153, v240
    v_sub_f32 v154, v154, v240
    v_sub_f32 v155, v155, v240
    v_sub_f32 v156, v156, v240
    v_sub_f32 v157, v157, v240
    v_sub_f32 v158, v158, v240
    v_sub_f32 v159, v159, v240
    v_sub_f32 v184, v184, v240
    v_sub_f32 v185, v185, v240
    v_sub_f32 v186, v186, v240
    v_sub_f32 v187, v187, v240
    v_sub_f32 v188, v188, v240
    v_sub_f32 v189, v189, v240
    v_sub_f32 v190, v190, v240
    v_sub_f32 v191, v191, v240
    v_mul_f32 v236, v236, v242
    v_mul_f32 v237, v237, v242
    v_mul_f32 v238, v238, v242
    v_mul_f32 v239, v239, v242
    v_accvgpr_read_b32 v241, a96
    v_mul_f32 v241, v241, v242
    v_accvgpr_write_b32 a96, v241
    v_accvgpr_read_b32 v241, a97
    v_mul_f32 v241, v241, v242
    v_accvgpr_write_b32 a97, v241
    v_accvgpr_read_b32 v241, a98
    v_mul_f32 v241, v241, v242
    v_accvgpr_write_b32 a98, v241
    v_accvgpr_read_b32 v241, a99
    v_mul_f32 v241, v241, v242
    v_accvgpr_write_b32 a99, v241
    v_accvgpr_read_b32 v241, a100
    v_mul_f32 v241, v241, v242
    v_accvgpr_write_b32 a100, v241
    v_accvgpr_read_b32 v241, a101
    v_mul_f32 v241, v241, v242
    v_accvgpr_write_b32 a101, v241
    v_accvgpr_read_b32 v241, a102
    v_mul_f32 v241, v241, v242
    v_accvgpr_write_b32 a102, v241
    v_accvgpr_read_b32 v241, a103
    v_mul_f32 v241, v241, v242
    v_accvgpr_write_b32 a103, v241
    v_accvgpr_read_b32 v241, a104
    v_mul_f32 v241, v241, v242
    v_accvgpr_write_b32 a104, v241
    v_accvgpr_read_b32 v241, a105
    v_mul_f32 v241, v241, v242
    v_accvgpr_write_b32 a105, v241
    v_accvgpr_read_b32 v241, a106
    v_mul_f32 v241, v241, v242
    v_accvgpr_write_b32 a106, v241
    v_accvgpr_read_b32 v241, a107
    v_mul_f32 v241, v241, v242
    v_accvgpr_write_b32 a107, v241
    v_accvgpr_read_b32 v241, a108
    v_mul_f32 v241, v241, v242
    v_accvgpr_write_b32 a108, v241
    v_accvgpr_read_b32 v241, a109
    v_mul_f32 v241, v241, v242
    v_accvgpr_write_b32 a109, v241
    v_accvgpr_read_b32 v241, a110
    v_mul_f32 v241, v241, v242
    v_accvgpr_write_b32 a110, v241
    v_accvgpr_read_b32 v241, a111
    v_mul_f32 v241, v241, v242
    v_accvgpr_write_b32 a111, v241
    v_accvgpr_read_b32 v241, a112
    v_mul_f32 v241, v241, v242
    v_accvgpr_write_b32 a112, v241
    v_accvgpr_read_b32 v241, a113
    v_mul_f32 v241, v241, v242
    v_accvgpr_write_b32 a113, v241
    v_accvgpr_read_b32 v241, a114
    v_mul_f32 v241, v241, v242
    v_accvgpr_write_b32 a114, v241
    v_accvgpr_read_b32 v241, a115
    v_mul_f32 v241, v241, v242
    v_accvgpr_write_b32 a115, v241
    v_accvgpr_read_b32 v241, a116
    v_mul_f32 v241, v241, v242
    v_accvgpr_write_b32 a116, v241
    v_accvgpr_read_b32 v241, a117
    v_mul_f32 v241, v241, v242
    v_accvgpr_write_b32 a117, v241
    v_accvgpr_read_b32 v241, a118
    v_mul_f32 v241, v241, v242
    v_accvgpr_write_b32 a118, v241
    v_accvgpr_read_b32 v241, a119
    v_mul_f32 v241, v241, v242
    v_accvgpr_write_b32 a119, v241
    v_accvgpr_read_b32 v241, a120
    v_mul_f32 v241, v241, v242
    v_accvgpr_write_b32 a120, v241
    v_accvgpr_read_b32 v241, a121
    v_mul_f32 v241, v241, v242
    v_accvgpr_write_b32 a121, v241
    v_accvgpr_read_b32 v241, a122
    v_mul_f32 v241, v241, v242
    v_accvgpr_write_b32 a122, v241
    v_accvgpr_read_b32 v241, a123
    v_mul_f32 v241, v241, v242
    v_accvgpr_write_b32 a123, v241
    v_accvgpr_read_b32 v241, a124
    v_mul_f32 v241, v241, v242
    v_accvgpr_write_b32 a124, v241
    v_accvgpr_read_b32 v241, a125
    v_mul_f32 v241, v241, v242
    v_accvgpr_write_b32 a125, v241
    v_accvgpr_read_b32 v241, a126
    v_mul_f32 v241, v241, v242
    v_accvgpr_write_b32 a126, v241
    v_accvgpr_read_b32 v241, a127
    v_mul_f32 v241, v241, v242
    v_accvgpr_write_b32 a127, v241
    v_exp_f32 v244, v152
    v_exp_f32 v245, v153
    s_nop 0
    v_cvt_pk_bf16_f32 v204, v244, v245
    v_exp_f32 v244, v154
    v_exp_f32 v245, v155
    s_nop 0
    v_cvt_pk_bf16_f32 v205, v244, v245
    v_exp_f32 v244, v156
    v_exp_f32 v245, v157
    s_nop 0
    v_cvt_pk_bf16_f32 v206, v244, v245
    v_exp_f32 v244, v158
    v_exp_f32 v245, v159
    s_nop 0
    v_cvt_pk_bf16_f32 v207, v244, v245
    s_nop 1
    s_branch attn_kernel_b1_r0_ret
attn_kernel_b1_r1:
    s_nop 7
    v_max3_f32 v240, v184, v185, v186
    v_max3_f32 v240, v187, v188, v240
    v_max3_f32 v240, v189, v190, v240
    v_max_f32 v240, v191, v240
    v_mov_b32 v241, v240
    s_nop 1
    v_permlane16_swap_b32 v240, v241
    s_nop 1
    v_max_f32 v240, v240, v241
    v_mov_b32 v241, v240
    s_nop 1
    v_permlane32_swap_b32 v240, v241
    s_nop 1
    v_max_f32 v240, v240, v241
    v_add_f32 v240, 0x41c00000, v240
    v_max_f32 v240, 0, v240
    v_exp_f32 v242, -v240
    v_sub_f32 v124, v124, v240
    v_sub_f32 v125, v125, v240
    v_sub_f32 v126, v126, v240
    v_sub_f32 v127, v127, v240
    v_sub_f32 v184, v184, v240
    v_sub_f32 v185, v185, v240
    v_sub_f32 v186, v186, v240
    v_sub_f32 v187, v187, v240
    v_sub_f32 v188, v188, v240
    v_sub_f32 v189, v189, v240
    v_sub_f32 v190, v190, v240
    v_sub_f32 v191, v191, v240
    v_mul_f32 v236, v236, v242
    v_mul_f32 v237, v237, v242
    v_mul_f32 v238, v238, v242
    v_mul_f32 v239, v239, v242
    v_accvgpr_read_b32 v241, a96
    v_mul_f32 v241, v241, v242
    v_accvgpr_write_b32 a96, v241
    v_accvgpr_read_b32 v241, a97
    v_mul_f32 v241, v241, v242
    v_accvgpr_write_b32 a97, v241
    v_accvgpr_read_b32 v241, a98
    v_mul_f32 v241, v241, v242
    v_accvgpr_write_b32 a98, v241
    v_accvgpr_read_b32 v241, a99
    v_mul_f32 v241, v241, v242
    v_accvgpr_write_b32 a99, v241
    v_accvgpr_read_b32 v241, a100
    v_mul_f32 v241, v241, v242
    v_accvgpr_write_b32 a100, v241
    v_accvgpr_read_b32 v241, a101
    v_mul_f32 v241, v241, v242
    v_accvgpr_write_b32 a101, v241
    v_accvgpr_read_b32 v241, a102
    v_mul_f32 v241, v241, v242
    v_accvgpr_write_b32 a102, v241
    v_accvgpr_read_b32 v241, a103
    v_mul_f32 v241, v241, v242
    v_accvgpr_write_b32 a103, v241
    v_accvgpr_read_b32 v241, a104
    v_mul_f32 v241, v241, v242
    v_accvgpr_write_b32 a104, v241
    v_accvgpr_read_b32 v241, a105
    v_mul_f32 v241, v241, v242
    v_accvgpr_write_b32 a105, v241
    v_accvgpr_read_b32 v241, a106
    v_mul_f32 v241, v241, v242
    v_accvgpr_write_b32 a106, v241
    v_accvgpr_read_b32 v241, a107
    v_mul_f32 v241, v241, v242
    v_accvgpr_write_b32 a107, v241
    v_accvgpr_read_b32 v241, a108
    v_mul_f32 v241, v241, v242
    v_accvgpr_write_b32 a108, v241
    v_accvgpr_read_b32 v241, a109
    v_mul_f32 v241, v241, v242
    v_accvgpr_write_b32 a109, v241
    v_accvgpr_read_b32 v241, a110
    v_mul_f32 v241, v241, v242
    v_accvgpr_write_b32 a110, v241
    v_accvgpr_read_b32 v241, a111
    v_mul_f32 v241, v241, v242
    v_accvgpr_write_b32 a111, v241
    v_accvgpr_read_b32 v241, a112
    v_mul_f32 v241, v241, v242
    v_accvgpr_write_b32 a112, v241
    v_accvgpr_read_b32 v241, a113
    v_mul_f32 v241, v241, v242
    v_accvgpr_write_b32 a113, v241
    v_accvgpr_read_b32 v241, a114
    v_mul_f32 v241, v241, v242
    v_accvgpr_write_b32 a114, v241
    v_accvgpr_read_b32 v241, a115
    v_mul_f32 v241, v241, v242
    v_accvgpr_write_b32 a115, v241
    v_accvgpr_read_b32 v241, a116
    v_mul_f32 v241, v241, v242
    v_accvgpr_write_b32 a116, v241
    v_accvgpr_read_b32 v241, a117
    v_mul_f32 v241, v241, v242
    v_accvgpr_write_b32 a117, v241
    v_accvgpr_read_b32 v241, a118
    v_mul_f32 v241, v241, v242
    v_accvgpr_write_b32 a118, v241
    v_accvgpr_read_b32 v241, a119
    v_mul_f32 v241, v241, v242
    v_accvgpr_write_b32 a119, v241
    v_accvgpr_read_b32 v241, a120
    v_mul_f32 v241, v241, v242
    v_accvgpr_write_b32 a120, v241
    v_accvgpr_read_b32 v241, a121
    v_mul_f32 v241, v241, v242
    v_accvgpr_write_b32 a121, v241
    v_accvgpr_read_b32 v241, a122
    v_mul_f32 v241, v241, v242
    v_accvgpr_write_b32 a122, v241
    v_accvgpr_read_b32 v241, a123
    v_mul_f32 v241, v241, v242
    v_accvgpr_write_b32 a123, v241
    v_accvgpr_read_b32 v241, a124
    v_mul_f32 v241, v241, v242
    v_accvgpr_write_b32 a124, v241
    v_accvgpr_read_b32 v241, a125
    v_mul_f32 v241, v241, v242
    v_accvgpr_write_b32 a125, v241
    v_accvgpr_read_b32 v241, a126
    v_mul_f32 v241, v241, v242
    v_accvgpr_write_b32 a126, v241
    v_accvgpr_read_b32 v241, a127
    v_mul_f32 v241, v241, v242
    v_accvgpr_write_b32 a127, v241
    v_exp_f32 v244, v184
    v_exp_f32 v245, v185
    s_nop 0
    v_cvt_pk_bf16_f32 v220, v244, v245
    v_exp_f32 v244, v186
    v_exp_f32 v245, v187
    s_nop 0
    v_cvt_pk_bf16_f32 v221, v244, v245
    v_exp_f32 v244, v188
    v_exp_f32 v245, v189
    s_nop 0
    v_cvt_pk_bf16_f32 v222, v244, v245
    v_exp_f32 v244, v190
    v_exp_f32 v245, v191
    s_nop 0
    v_cvt_pk_bf16_f32 v223, v244, v245
    s_nop 1
    s_branch attn_kernel_b1_r1_ret

.globl conv_kernel
.p2align 8
.type conv_kernel,@function
conv_kernel:
    s_cmp_ge_u32 s2, 256
    s_cbranch_scc1 conv_kernel_end
    v_lshrrev_b32 v6, 6, v0
    s_nop 0
    v_readfirstlane_b32 s40, v6
    s_load_dwordx4 s[20:23], s[0:1], 32
    s_load_dwordx2 s[24:25], s[0:1], 120
    v_and_b32 v1, 63, v0
    v_lshlrev_b32 v2, 4, v1
    s_lshl_b32 s33, s2, 2
    s_add_u32 s33, s33, s40
    s_mul_i32 s34, s40, 27040
    s_waitcnt lgkmcnt(0)
    s_mov_b32 s4, s20
    s_mov_b32 s5, s21
    s_mov_b32 s6, 4194304
    s_mov_b32 s7, 0x00020000
    s_mov_b32 s8, s22
    s_mov_b32 s9, s23
    s_mov_b32 s10, 2048
    s_mov_b32 s11, 0x00020000
    s_add_u32 s12, s24, 50331648
    s_addc_u32 s13, s25, 0
    s_mov_b32 s14, 4718592
    s_mov_b32 s15, 0x00020000
    s_add_u32 s16, s24, 55574528
    s_addc_u32 s17, s25, 0
    s_mov_b32 s18, 4194304
    s_mov_b32 s19, 0x00020000
    s_lshl_b32 s26, s33, 12
    s_add_u32 s27, s26, 8
    s_mul_i32 s28, s33, 4608
    s_lshl_b32 s29, s33, 1
    s_add_u32 m0, s34, 8480
    s_add_u32 s30, s28, 6
    buffer_load_dwordx4 v2, s[12:15], s30 offen offset:0 lds
    buffer_load_dwordx4 v2, s[12:15], s30 offen offset:1024 lds
    buffer_load_dwordx4 v2, s[12:15], s30 offen offset:2048 lds
    buffer_load_dwordx4 v2, s[12:15], s30 offen offset:3072 lds
    s_add_u32 m0, s34, 13120
    s_add_u32 s30, s28, 4
    buffer_load_dwordx4 v2, s[12:15], s30 offen offset:0 lds
    buffer_load_dwordx4 v2, s[12:15], s30 offen offset:1024 lds
    buffer_load_dwordx4 v2, s[12:15], s30 offen offset:2048 lds
    buffer_load_dwordx4 v2, s[12:15], s30 offen offset:3072 lds
    s_add_u32 m0, s34, 17760
    s_add_u32 s30, s28, 2
    buffer_load_dwordx4 v2, s[12:15], s30 offen offset:0 lds
    buffer_load_dwordx4 v2, s[12:15], s30 offen offset:1024 lds
    buffer_load_dwordx4 v2, s[12:15], s30 offen offset:2048 lds
    buffer_load_dwordx4 v2, s[12:15], s30 offen offset:3072 lds
    s_add_u32 m0, s34, 22400
    s_add_u32 s30, s28, 0
    buffer_load_dwordx4 v2, s[12:15], s30 offen offset:0 lds
    buffer_load_dwordx4 v2, s[12:15], s30 offen offset:1024 lds
    buffer_load_dwordx4 v2, s[12:15], s30 offen offset:2048 lds
    buffer_load_dwordx4 v2, s[12:15], s30 offen offset:3072 lds
    s_add_u32 m0, s34, 128
    s_nop 0
    buffer_load_dwordx4 v2, s[4:7], s26 offen offset:0 lds
    buffer_load_dwordx4 v2, s[4:7], s26 offen offset:1024 lds
    buffer_load_dwordx4 v2, s[4:7], s26 offen offset:2048 lds
    buffer_load_dwordx4 v2, s[4:7], s26 offen offset:3072 lds
    s_add_u32 m0, s34, 4368
    s_nop 0
    buffer_load_dwordx4 v2, s[4:7], s27 offen offset:0 lds
    buffer_load_dwordx4 v2, s[4:7], s27 offen offset:1024 lds
    buffer_load_dwordx4 v2, s[4:7], s27 offen offset:2048 lds
    buffer_load_dwordx4 v2, s[4:7], s27 offen offset:3072 lds
    v_mov_b32 v6, 0
    buffer_load_dwordx2 v[8:9], v6, s[4:7], s26 offen
    buffer_load_ushort v10, v6, s[8:11], s29 offen
    s_mov_b64 exec, 0xffffff
    s_add_u32 m0, s34, 12576
    s_add_u32 s30, s28, 4102
    buffer_load_dwordx4 v2, s[12:15], s30 offen offset:0 lds
    s_add_u32 m0, s34, 17216
    s_add_u32 s30, s28, 4100
    buffer_load_dwordx4 v2, s[12:15], s30 offen offset:0 lds
    s_add_u32 m0, s34, 21856
    s_add_u32 s30, s28, 4098
    buffer_load_dwordx4 v2, s[12:15], s30 offen offset:0 lds
    s_add_u32 m0, s34, 26496
    s_add_u32 s30, s28, 4096
    buffer_load_dwordx4 v2, s[12:15], s30 offen offset:0 lds
    s_mov_b64 exec, -1
    v_and_b32 v6, 15, v1
    v_lshrrev_b32 v7, 4, v1
    v_and_b32 v11, 1, v6
    v_cmp_eq_u32 vcc, 1, v11
    v_mov_b32 v12, 4240
    v_lshlrev_b32 v13, 4, v7
    v_cndmask_b32 v12, v12, 8, vcc
    v_lshl_add_u32 v12, v6, 3, v12
    v_add3_u32 v3, v12, v13, s34
    v_and_b32 v11, 3, v6
    v_mul_u32_u24 v11, 4640, v11
    v_lshrrev_b32 v12, 2, v6
    v_lshlrev_b32 v12, 7, v12
    v_sub_u32 v11, v11, v12
    v_add3_u32 v4, v11, v13, s34
    v_add_u32 v4, 8864, v4
    v_lshlrev_b32 v11, 3, v7
    v_lshl_add_u32 v5, v6, 5, v11
    v_mov_b32 v24, 0
    v_mov_b32 v25, 0
    v_mov_b32 v26, 0
    v_mov_b32 v27, 0
    v_and_b32 v11, 7, v1
    v_lshlrev_b32 v11, 4, v11
    v_bfe_u32 v12, v1, 3, 1
    v_mul_u32_u24 v12, 4240, v12
    v_add3_u32 v11, v11, v12, s34
    ds_write_b128 v11, v[24:27]
    v_lshlrev_b32 v12, 2, v6
    v_sub_u32 v12, 60, v12
    v_lshrrev_b32 v12, 3, v12
    v_sub_u32 v12, v12, v7
    v_and_b32 v13, 1, v6
    v_lshl_add_u32 v12, v13, 4, v12
    s_waitcnt vmcnt(4) lgkmcnt(0)
    v_mov_b32 v11, s34
    ds_write_b64 v11, v[8:9] offset:4360
    v_cmp_eq_u32 vcc, 16, v12
    v_mov_b32 v17, 0
    s_nop 0
    v_cndmask_b32 v16, 0, v10, vcc
    v_cmp_eq_u32 vcc, 0, v12
    v_mov_b32 v19, 0
    s_nop 0
    v_cndmask_b32 v18, 0, v10, vcc
    v_cmp_eq_u32 vcc, 20, v12
    v_mov_b32 v21, 0
    s_nop 0
    v_cndmask_b32 v20, 0, v10, vcc
    v_cmp_eq_u32 vcc, 4, v12
    v_mov_b32 v23, 0
    s_nop 0
    v_cndmask_b32 v22, 0, v10, vcc
    s_waitcnt vmcnt(0) lgkmcnt(0)
    ds_read_b128 v[96:99], v4 offset:3584
    ds_read_b128 v[64:67], v3 offset:0
    ds_read_b128 v[100:103], v4 offset:3072
    ds_read_b128 v[68:71], v3 offset:512
    ds_read_b128 v[104:107], v4 offset:2560
    ds_read_b128 v[72:75], v3 offset:1024
    ds_read_b128 v[108:111], v4 offset:2048
    ds_read_b128 v[76:79], v3 offset:1536
    ds_read_b128 v[112:115], v4 offset:1536
    ds_read_b128 v[80:83], v3 offset:2048
    ds_read_b128 v[116:119], v4 offset:1024
    ds_read_b128 v[84:87], v3 offset:2560
    ds_read_b128 v[120:123], v4 offset:512
    ds_read_b128 v[88:91], v3 offset:3072
    ds_read_b128 v[124:127], v4 offset:0
    ds_read_b128 v[92:95], v3 offset:3584
    s_waitcnt lgkmcnt(0)
    v_mfma_f32_16x16x32_bf16 v[32:35], v[16:19], v[96:99], 0
    v_mfma_f32_16x16x32_bf16 v[36:39], v[16:19], v[100:103], 0
    v_mfma_f32_16x16x32_bf16 v[40:43], v[16:19], v[104:107], 0
    ds_read_b128 v[160:163], v4 offset:3648
    v_mfma_f32_16x16x32_bf16 v[44:47], v[16:19], v[108:111], 0
    v_mfma_f32_16x16x32_bf16 v[48:51], v[16:19], v[112:115], 0
    ds_read_b128 v[128:131], v3 offset:64
    v_mfma_f32_16x16x32_bf16 v[52:55], v[16:19], v[116:119], 0
    v_mfma_f32_16x16x32_bf16 v[56:59], v[16:19], v[120:123], 0
    ds_read_b128 v[164:167], v4 offset:3136
    v_mfma_f32_16x16x32_bf16 v[60:63], v[16:19], v[124:127], 0
    v_mfma_f32_16x16x32_bf16 v[32:35], v[64:67], v[96:99], v[32:35]
    ds_read_b128 v[132:135], v3 offset:576
    v_mfma_f32_16x16x32_bf16 v[36:39], v[64:67], v[100:103], v[36:39]
    v_mfma_f32_16x16x32_bf16 v[40:43], v[64:67], v[104:107], v[40:43]
    ds_read_b128 v[168:171], v4 offset:2624
    v_mfma_f32_16x16x32_bf16 v[44:47], v[64:67], v[108:111], v[44:47]
    v_mfma_f32_16x16x32_bf16 v[48:51], v[64:67], v[112:115], v[48:51]
    ds_read_b128 v[136:139], v3 offset:1088
    v_mfma_f32_16x16x32_bf16 v[52:55], v[64:67], v[116:119], v[52:55]
    v_mfma_f32_16x16x32_bf16 v[56:59], v[64:67], v[120:123], v[56:59]
    ds_read_b128 v[172:175], v4 offset:2112
    v_mfma_f32_16x16x32_bf16 v[60:63], v[64:67], v[124:127], v[60:63]
    v_mfma_f32_16x16x32_bf16 v[36:39], v[68:71], v[96:99], v[36:39]
    ds_read_b128 v[140:143], v3 offset:1600
    v_mfma_f32_16x16x32_bf16 v[40:43], v[68:71], v[100:103], v[40:43]
    v_mfma_f32_16x16x32_bf16 v[44:47], v[68:71], v[104:107], v[44:47]
    ds_read_b128 v[176:179], v4 offset:1600
    v_mfma_f32_16x16x32_bf16 v[48:51], v[68:71], v[108:111], v[48:51]
    v_mfma_f32_16x16x32_bf16 v[52:55], v[68:71], v[112:115], v[52:55]
    ds_read_b128 v[144:147], v3 offset:2112
    v_mfma_f32_16x16x32_bf16 v[56:59], v[68:71], v[116:119], v[56:59]
    v_mfma_f32_16x16x32_bf16 v[60:63], v[68:71], v[120:123], v[60:63]
    ds_read_b128 v[180:183], v4 offset:1088
    v_mfma_f32_16x16x32_bf16 v[40:43], v[72:75], v[96:99], v[40:43]
    v_mfma_f32_16x16x32_bf16 v[44:47], v[72:75], v[100:103], v[44:47]
    ds_read_b128 v[148:151], v3 offset:2624
    v_mfma_f32_16x16x32_bf16 v[48:51], v[72:75], v[104:107], v[48:51]
    v_mfma_f32_16x16x32_bf16 v[52:55], v[72:75], v[108:111], v[52:55]
    ds_read_b128 v[184:187], v4 offset:576
    v_mfma_f32_16x16x32_bf16 v[56:59], v[72:75], v[112:115], v[56:59]
    v_mfma_f32_16x16x32_bf16 v[60:63], v[72:75], v[116:119], v[60:63]
    ds_read_b128 v[152:155], v3 offset:3136
    v_mfma_f32_16x16x32_bf16 v[44:47], v[76:79], v[96:99], v[44:47]
    v_mfma_f32_16x16x32_bf16 v[48:51], v[76:79], v[100:103], v[48:51]
    ds_read_b128 v[188:191], v4 offset:64
    v_mfma_f32_16x16x32_bf16 v[52:55], v[76:79], v[104:107], v[52:55]
    v_mfma_f32_16x16x32_bf16 v[56:59], v[76:79], v[108:111], v[56:59]
    ds_read_b128 v[156:159], v3 offset:3648
    v_mfma_f32_16x16x32_bf16 v[60:63], v[76:79], v[112:115], v[60:63]
    v_mfma_f32_16x16x32_bf16 v[48:51], v[80:83], v[96:99], v[48:51]
    v_mfma_f32_16x16x32_bf16 v[52:55], v[80:83], v[100:103], v[52:55]
    v_mfma_f32_16x16x32_bf16 v[56:59], v[80:83], v[104:107], v[56:59]
    v_mfma_f32_16x16x32_bf16 v[60:63], v[80:83], v[108:111], v[60:63]
    v_mfma_f32_16x16x32_bf16 v[52:55], v[84:87], v[96:99], v[52:55]
    v_mfma_f32_16x16x32_bf16 v[56:59], v[84:87], v[100:103], v[56:59]
    v_mfma_f32_16x16x32_bf16 v[60:63], v[84:87], v[104:107], v[60:63]
    v_mfma_f32_16x16x32_bf16 v[56:59], v[88:91], v[96:99], v[56:59]
    v_mfma_f32_16x16x32_bf16 v[60:63], v[88:91], v[100:103], v[60:63]
    v_mfma_f32_16x16x32_bf16 v[60:63], v[92:95], v[96:99], v[60:63]
    s_waitcnt lgkmcnt(0)
    v_mfma_f32_16x16x32_bf16 v[32:35], v[20:23], v[160:163], v[32:35]
    v_mfma_f32_16x16x32_bf16 v[36:39], v[20:23], v[164:167], v[36:39]
    v_mfma_f32_16x16x32_bf16 v[40:43], v[20:23], v[168:171], v[40:43]
    ds_read_b128 v[96:99], v4 offset:3712
    v_mfma_f32_16x16x32_bf16 v[44:47], v[20:23], v[172:175], v[44:47]
    v_mfma_f32_16x16x32_bf16 v[48:51], v[20:23], v[176:179], v[48:51]
    ds_read_b128 v[64:67], v3 offset:128
    v_mfma_f32_16x16x32_bf16 v[52:55], v[20:23], v[180:183], v[52:55]
    v_mfma_f32_16x16x32_bf16 v[56:59], v[20:23], v[184:187], v[56:59]
    ds_read_b128 v[100:103], v4 offset:3200
    v_mfma_f32_16x16x32_bf16 v[60:63], v[20:23], v[188:191], v[60:63]
    v_mfma_f32_16x16x32_bf16 v[32:35], v[128:131], v[160:163], v[32:35]
    ds_read_b128 v[68:71], v3 offset:640
    v_mfma_f32_16x16x32_bf16 v[36:39], v[128:131], v[164:167], v[36:39]
    v_mfma_f32_16x16x32_bf16 v[40:43], v[128:131], v[168:171], v[40:43]
    ds_read_b128 v[104:107], v4 offset:2688
    v_mfma_f32_16x16x32_bf16 v[44:47], v[128:131], v[172:175], v[44:47]
    v_mfma_f32_16x16x32_bf16 v[48:51], v[128:131], v[176:179], v[48:51]
    ds_read_b128 v[72:75], v3 offset:1152
    v_mfma_f32_16x16x32_bf16 v[52:55], v[128:131], v[180:183], v[52:55]
    v_mfma_f32_16x16x32_bf16 v[56:59], v[128:131], v[184:187], v[56:59]
    ds_read_b128 v[108:111], v4 offset:2176
    v_mfma_f32_16x16x32_bf16 v[60:63], v[128:131], v[188:191], v[60:63]
    v_mfma_f32_16x16x32_bf16 v[36:39], v[132:135], v[160:163], v[36:39]
    ds_read_b128 v[76:79], v3 offset:1664
    v_mfma_f32_16x16x32_bf16 v[40:43], v[132:135], v[164:167], v[40:43]
    v_mfma_f32_16x16x32_bf16 v[44:47], v[132:135], v[168:171], v[44:47]
    ds_read_b128 v[112:115], v4 offset:1664
    v_mfma_f32_16x16x32_bf16 v[48:51], v[132:135], v[172:175], v[48:51]
    v_mfma_f32_16x16x32_bf16 v[52:55], v[132:135], v[176:179], v[52:55]
    ds_read_b128 v[80:83], v3 offset:2176
    v_mfma_f32_16x16x32_bf16 v[56:59], v[132:135], v[180:183], v[56:59]
    v_mfma_f32_16x16x32_bf16 v[60:63], v[132:135], v[184:187], v[60:63]
    ds_read_b128 v[116:119], v4 offset:1152
    v_mfma_f32_16x16x32_bf16 v[40:43], v[136:139], v[160:163], v[40:43]
    v_mfma_f32_16x16x32_bf16 v[44:47], v[136:139], v[164:167], v[44:47]
    ds_read_b128 v[84:87], v3 offset:2688
    v_mfma_f32_16x16x32_bf16 v[48:51], v[136:139], v[168:171], v[48:51]
    v_mfma_f32_16x16x32_bf16 v[52:55], v[136:139], v[172:175], v[52:55]
    ds_read_b128 v[120:123], v4 offset:640
    v_mfma_f32_16x16x32_bf16 v[56:59], v[136:139], v[176:179], v[56:59]
    v_mfma_f32_16x16x32_bf16 v[60:63], v[136:139], v[180:183], v[60:63]
    ds_read_b128 v[88:91], v3 offset:3200
    v_mfma_f32_16x16x32_bf16 v[44:47], v[140:143], v[160:163], v[44:47]
    v_mfma_f32_16x16x32_bf16 v[48:51], v[140:143], v[164:167], v[48:51]
    ds_read_b128 v[124:127], v4 offset:128
    v_mfma_f32_16x16x32_bf16 v[52:55], v[140:143], v[168:171], v[52:55]
    v_mfma_f32_16x16x32_bf16 v[56:59], v[140:143], v[172:175], v[56:59]
    ds_read_b128 v[92:95], v3 offset:3712
    v_mfma_f32_16x16x32_bf16 v[60:63], v[140:143], v[176:179], v[60:63]
    v_mfma_f32_16x16x32_bf16 v[48:51], v[144:147], v[160:163], v[48:51]
    v_mfma_f32_16x16x32_bf16 v[52:55], v[144:147], v[164:167], v[52:55]
    v_mfma_f32_16x16x32_bf16 v[56:59], v[144:147], v[168:171], v[56:59]
    v_mfma_f32_16x16x32_bf16 v[60:63], v[144:147], v[172:175], v[60:63]
    v_mfma_f32_16x16x32_bf16 v[52:55], v[148:151], v[160:163], v[52:55]
    v_mfma_f32_16x16x32_bf16 v[56:59], v[148:151], v[164:167], v[56:59]
    v_mfma_f32_16x16x32_bf16 v[60:63], v[148:151], v[168:171], v[60:63]
    v_mfma_f32_16x16x32_bf16 v[56:59], v[152:155], v[160:163], v[56:59]
    v_mfma_f32_16x16x32_bf16 v[60:63], v[152:155], v[164:167], v[60:63]
    v_mfma_f32_16x16x32_bf16 v[60:63], v[156:159], v[160:163], v[60:63]
    s_waitcnt lgkmcnt(0)
    v_mfma_f32_16x16x32_bf16 v[32:35], v[64:67], v[96:99], v[32:35]
    v_mfma_f32_16x16x32_bf16 v[36:39], v[64:67], v[100:103], v[36:39]
    v_mfma_f32_16x16x32_bf16 v[40:43], v[64:67], v[104:107], v[40:43]
    ds_read_b128 v[160:163], v4 offset:3776
    v_mfma_f32_16x16x32_bf16 v[44:47], v[64:67], v[108:111], v[44:47]
    v_mfma_f32_16x16x32_bf16 v[48:51], v[64:67], v[112:115], v[48:51]
    ds_read_b128 v[128:131], v3 offset:192
    v_mfma_f32_16x16x32_bf16 v[52:55], v[64:67], v[116:119], v[52:55]
    v_mfma_f32_16x16x32_bf16 v[56:59], v[64:67], v[120:123], v[56:59]
    ds_read_b128 v[164:167], v4 offset:3264
    v_mfma_f32_16x16x32_bf16 v[60:63], v[64:67], v[124:127], v[60:63]
    v_mfma_f32_16x16x32_bf16 v[36:39], v[68:71], v[96:99], v[36:39]
    ds_read_b128 v[132:135], v3 offset:704
    v_mfma_f32_16x16x32_bf16 v[40:43], v[68:71], v[100:103], v[40:43]
    v_mfma_f32_16x16x32_bf16 v[44:47], v[68:71], v[104:107], v[44:47]
    ds_read_b128 v[168:171], v4 offset:2752
    v_mfma_f32_16x16x32_bf16 v[48:51], v[68:71], v[108:111], v[48:51]
    v_mfma_f32_16x16x32_bf16 v[52:55], v[68:71], v[112:115], v[52:55]
    ds_read_b128 v[136:139], v3 offset:1216
    v_mfma_f32_16x16x32_bf16 v[56:59], v[68:71], v[116:119], v[56:59]
    v_mfma_f32_16x16x32_bf16 v[60:63], v[68:71], v[120:123], v[60:63]
    ds_read_b128 v[172:175], v4 offset:2240
    v_mfma_f32_16x16x32_bf16 v[40:43], v[72:75], v[96:99], v[40:43]
    v_mfma_f32_16x16x32_bf16 v[44:47], v[72:75], v[100:103], v[44:47]
    ds_read_b128 v[140:143], v3 offset:1728
    v_mfma_f32_16x16x32_bf16 v[48:51], v[72:75], v[104:107], v[48:51]
    v_mfma_f32_16x16x32_bf16 v[52:55], v[72:75], v[108:111], v[52:55]
    ds_read_b128 v[176:179], v4 offset:1728
    v_mfma_f32_16x16x32_bf16 v[56:59], v[72:75], v[112:115], v[56:59]
    v_mfma_f32_16x16x32_bf16 v[60:63], v[72:75], v[116:119], v[60:63]
    ds_read_b128 v[144:147], v3 offset:2240
    v_mfma_f32_16x16x32_bf16 v[44:47], v[76:79], v[96:99], v[44:47]
    v_mfma_f32_16x16x32_bf16 v[48:51], v[76:79], v[100:103], v[48:51]
    ds_read_b128 v[180:183], v4 offset:1216
    v_mfma_f32_16x16x32_bf16 v[52:55], v[76:79], v[104:107], v[52:55]
    v_mfma_f32_16x16x32_bf16 v[56:59], v[76:79], v[108:111], v[56:59]
    ds_read_b128 v[148:151], v3 offset:2752
    v_mfma_f32_16x16x32_bf16 v[60:63], v[76:79], v[112:115], v[60:63]
    v_mfma_f32_16x16x32_bf16 v[48:51], v[80:83], v[96:99], v[48:51]
    ds_read_b128 v[184:187], v4 offset:704
    v_mfma_f32_16x16x32_bf16 v[52:55], v[80:83], v[100:103], v[52:55]
    v_mfma_f32_16x16x32_bf16 v[56:59], v[80:83], v[104:107], v[56:59]
    ds_read_b128 v[152:155], v3 offset:3264
    v_mfma_f32_16x16x32_bf16 v[60:63], v[80:83], v[108:111], v[60:63]
    v_mfma_f32_16x16x32_bf16 v[52:55], v[84:87], v[96:99], v[52:55]
    ds_read_b128 v[188:191], v4 offset:192
    v_mfma_f32_16x16x32_bf16 v[56:59], v[84:87], v[100:103], v[56:59]
    v_mfma_f32_16x16x32_bf16 v[60:63], v[84:87], v[104:107], v[60:63]
    ds_read_b128 v[156:159], v3 offset:3776
    v_mfma_f32_16x16x32_bf16 v[56:59], v[88:91], v[96:99], v[56:59]
    v_mfma_f32_16x16x32_bf16 v[60:63], v[88:91], v[100:103], v[60:63]
    v_mfma_f32_16x16x32_bf16 v[60:63], v[92:95], v[96:99], v[60:63]
    s_waitcnt lgkmcnt(0)
    v_mfma_f32_16x16x32_bf16 v[32:35], v[128:131], v[160:163], v[32:35]
    v_mfma_f32_16x16x32_bf16 v[36:39], v[128:131], v[164:167], v[36:39]
    v_mfma_f32_16x16x32_bf16 v[40:43], v[128:131], v[168:171], v[40:43]
    ds_read_b128 v[96:99], v4 offset:3840
    v_mfma_f32_16x16x32_bf16 v[44:47], v[128:131], v[172:175], v[44:47]
    v_mfma_f32_16x16x32_bf16 v[48:51], v[128:131], v[176:179], v[48:51]
    ds_read_b128 v[64:67], v3 offset:256
    v_mfma_f32_16x16x32_bf16 v[52:55], v[128:131], v[180:183], v[52:55]
    v_mfma_f32_16x16x32_bf16 v[56:59], v[128:131], v[184:187], v[56:59]
    ds_read_b128 v[100:103], v4 offset:3328
    v_mfma_f32_16x16x32_bf16 v[60:63], v[128:131], v[188:191], v[60:63]
    v_mfma_f32_16x16x32_bf16 v[36:39], v[132:135], v[160:163], v[36:39]
    ds_read_b128 v[68:71], v3 offset:768
    v_mfma_f32_16x16x32_bf16 v[40:43], v[132:135], v[164:167], v[40:43]
    v_mfma_f32_16x16x32_bf16 v[44:47], v[132:135], v[168:171], v[44:47]
    ds_read_b128 v[104:107], v4 offset:2816
    v_mfma_f32_16x16x32_bf16 v[48:51], v[132:135], v[172:175], v[48:51]
    v_mfma_f32_16x16x32_bf16 v[52:55], v[132:135], v[176:179], v[52:55]
    ds_read_b128 v[72:75], v3 offset:1280
    v_mfma_f32_16x16x32_bf16 v[56:59], v[132:135], v[180:183], v[56:59]
    v_mfma_f32_16x16x32_bf16 v[60:63], v[132:135], v[184:187], v[60:63]
    ds_read_b128 v[108:111], v4 offset:2304
    v_mfma_f32_16x16x32_bf16 v[40:43], v[136:139], v[160:163], v[40:43]
    v_mfma_f32_16x16x32_bf16 v[44:47], v[136:139], v[164:167], v[44:47]
    ds_read_b128 v[76:79], v3 offset:1792
    v_mfma_f32_16x16x32_bf16 v[48:51], v[136:139], v[168:171], v[48:51]
    v_mfma_f32_16x16x32_bf16 v[52:55], v[136:139], v[172:175], v[52:55]
    ds_read_b128 v[112:115], v4 offset:1792
    v_mfma_f32_16x16x32_bf16 v[56:59], v[136:139], v[176:179], v[56:59]
    v_mfma_f32_16x16x32_bf16 v[60:63], v[136:139], v[180:183], v[60:63]
    ds_read_b128 v[80:83], v3 offset:2304
    v_mfma_f32_16x16x32_bf16 v[44:47], v[140:143], v[160:163], v[44:47]
    v_mfma_f32_16x16x32_bf16 v[48:51], v[140:143], v[164:167], v[48:51]
    ds_read_b128 v[116:119], v4 offset:1280
    v_mfma_f32_16x16x32_bf16 v[52:55], v[140:143], v[168:171], v[52:55]
    v_mfma_f32_16x16x32_bf16 v[56:59], v[140:143], v[172:175], v[56:59]
    ds_read_b128 v[84:87], v3 offset:2816
    v_mfma_f32_16x16x32_bf16 v[60:63], v[140:143], v[176:179], v[60:63]
    v_mfma_f32_16x16x32_bf16 v[48:51], v[144:147], v[160:163], v[48:51]
    ds_read_b128 v[120:123], v4 offset:768
    v_mfma_f32_16x16x32_bf16 v[52:55], v[144:147], v[164:167], v[52:55]
    v_mfma_f32_16x16x32_bf16 v[56:59], v[144:147], v[168:171], v[56:59]
    ds_read_b128 v[88:91], v3 offset:3328
    v_mfma_f32_16x16x32_bf16 v[60:63], v[144:147], v[172:175], v[60:63]
    v_mfma_f32_16x16x32_bf16 v[52:55], v[148:151], v[160:163], v[52:55]
    ds_read_b128 v[124:127], v4 offset:256
    v_mfma_f32_16x16x32_bf16 v[56:59], v[148:151], v[164:167], v[56:59]
    v_mfma_f32_16x16x32_bf16 v[60:63], v[148:151], v[168:171], v[60:63]
    ds_read_b128 v[92:95], v3 offset:3840
    v_mfma_f32_16x16x32_bf16 v[56:59], v[152:155], v[160:163], v[56:59]
    v_mfma_f32_16x16x32_bf16 v[60:63], v[152:155], v[164:167], v[60:63]
    v_mfma_f32_16x16x32_bf16 v[60:63], v[156:159], v[160:163], v[60:63]
    s_waitcnt lgkmcnt(0)
    v_mfma_f32_16x16x32_bf16 v[32:35], v[64:67], v[96:99], v[32:35]
    v_mfma_f32_16x16x32_bf16 v[36:39], v[64:67], v[100:103], v[36:39]
    v_mfma_f32_16x16x32_bf16 v[40:43], v[64:67], v[104:107], v[40:43]
    ds_read_b128 v[160:163], v4 offset:3904
    v_mfma_f32_16x16x32_bf16 v[44:47], v[64:67], v[108:111], v[44:47]
    v_mfma_f32_16x16x32_bf16 v[48:51], v[64:67], v[112:115], v[48:51]
    ds_read_b128 v[128:131], v3 offset:320
    v_mfma_f32_16x16x32_bf16 v[52:55], v[64:67], v[116:119], v[52:55]
    v_mfma_f32_16x16x32_bf16 v[56:59], v[64:67], v[120:123], v[56:59]
    ds_read_b128 v[164:167], v4 offset:3392
    v_mfma_f32_16x16x32_bf16 v[60:63], v[64:67], v[124:127], v[60:63]
    v_mfma_f32_16x16x32_bf16 v[36:39], v[68:71], v[96:99], v[36:39]
    ds_read_b128 v[132:135], v3 offset:832
    v_mfma_f32_16x16x32_bf16 v[40:43], v[68:71], v[100:103], v[40:43]
    v_mfma_f32_16x16x32_bf16 v[44:47], v[68:71], v[104:107], v[44:47]
    ds_read_b128 v[168:171], v4 offset:2880
    v_mfma_f32_16x16x32_bf16 v[48:51], v[68:71], v[108:111], v[48:51]
    v_mfma_f32_16x16x32_bf16 v[52:55], v[68:71], v[112:115], v[52:55]
    ds_read_b128 v[136:139], v3 offset:1344
    v_mfma_f32_16x16x32_bf16 v[56:59], v[68:71], v[116:119], v[56:59]
    v_mfma_f32_16x16x32_bf16 v[60:63], v[68:71], v[120:123], v[60:63]
    ds_read_b128 v[172:175], v4 offset:2368
    v_mfma_f32_16x16x32_bf16 v[40:43], v[72:75], v[96:99], v[40:43]
    v_mfma_f32_16x16x32_bf16 v[44:47], v[72:75], v[100:103], v[44:47]
    ds_read_b128 v[140:143], v3 offset:1856
    v_mfma_f32_16x16x32_bf16 v[48:51], v[72:75], v[104:107], v[48:51]
    v_mfma_f32_16x16x32_bf16 v[52:55], v[72:75], v[108:111], v[52:55]
    ds_read_b128 v[176:179], v4 offset:1856
    v_mfma_f32_16x16x32_bf16 v[56:59], v[72:75], v[112:115], v[56:59]
    v_mfma_f32_16x16x32_bf16 v[60:63], v[72:75], v[116:119], v[60:63]
    ds_read_b128 v[144:147], v3 offset:2368
    v_mfma_f32_16x16x32_bf16 v[44:47], v[76:79], v[96:99], v[44:47]
    v_mfma_f32_16x16x32_bf16 v[48:51], v[76:79], v[100:103], v[48:51]
    ds_read_b128 v[180:183], v4 offset:1344
    v_mfma_f32_16x16x32_bf16 v[52:55], v[76:79], v[104:107], v[52:55]
    v_mfma_f32_16x16x32_bf16 v[56:59], v[76:79], v[108:111], v[56:59]
    ds_read_b128 v[148:151], v3 offset:2880
    v_mfma_f32_16x16x32_bf16 v[60:63], v[76:79], v[112:115], v[60:63]
    v_mfma_f32_16x16x32_bf16 v[48:51], v[80:83], v[96:99], v[48:51]
    ds_read_b128 v[184:187], v4 offset:832
    v_mfma_f32_16x16x32_bf16 v[52:55], v[80:83], v[100:103], v[52:55]
    v_mfma_f32_16x16x32_bf16 v[56:59], v[80:83], v[104:107], v[56:59]
    ds_read_b128 v[152:155], v3 offset:3392
    v_mfma_f32_16x16x32_bf16 v[60:63], v[80:83], v[108:111], v[60:63]
    v_mfma_f32_16x16x32_bf16 v[52:55], v[84:87], v[96:99], v[52:55]
    ds_read_b128 v[188:191], v4 offset:320
    v_mfma_f32_16x16x32_bf16 v[56:59], v[84:87], v[100:103], v[56:59]
    v_mfma_f32_16x16x32_bf16 v[60:63], v[84:87], v[104:107], v[60:63]
    ds_read_b128 v[156:159], v3 offset:3904
    v_mfma_f32_16x16x32_bf16 v[56:59], v[88:91], v[96:99], v[56:59]
    v_mfma_f32_16x16x32_bf16 v[60:63], v[88:91], v[100:103], v[60:63]
    v_mfma_f32_16x16x32_bf16 v[60:63], v[92:95], v[96:99], v[60:63]
    s_waitcnt lgkmcnt(0)
    v_mfma_f32_16x16x32_bf16 v[32:35], v[128:131], v[160:163], v[32:35]
    v_mfma_f32_16x16x32_bf16 v[36:39], v[128:131], v[164:167], v[36:39]
    v_mfma_f32_16x16x32_bf16 v[40:43], v[128:131], v[168:171], v[40:43]
    ds_read_b128 v[96:99], v4 offset:3968
    v_mfma_f32_16x16x32_bf16 v[44:47], v[128:131], v[172:175], v[44:47]
    v_mfma_f32_16x16x32_bf16 v[48:51], v[128:131], v[176:179], v[48:51]
    ds_read_b128 v[64:67], v3 offset:384
    v_mfma_f32_16x16x32_bf16 v[52:55], v[128:131], v[180:183], v[52:55]
    v_mfma_f32_16x16x32_bf16 v[56:59], v[128:131], v[184:187], v[56:59]
    ds_read_b128 v[100:103], v4 offset:3456
    v_mfma_f32_16x16x32_bf16 v[60:63], v[128:131], v[188:191], v[60:63]
    v_mfma_f32_16x16x32_bf16 v[36:39], v[132:135], v[160:163], v[36:39]
    ds_read_b128 v[68:71], v3 offset:896
    v_mfma_f32_16x16x32_bf16 v[40:43], v[132:135], v[164:167], v[40:43]
    v_mfma_f32_16x16x32_bf16 v[44:47], v[132:135], v[168:171], v[44:47]
    ds_read_b128 v[104:107], v4 offset:2944
    v_mfma_f32_16x16x32_bf16 v[48:51], v[132:135], v[172:175], v[48:51]
    v_mfma_f32_16x16x32_bf16 v[52:55], v[132:135], v[176:179], v[52:55]
    ds_read_b128 v[72:75], v3 offset:1408
    v_mfma_f32_16x16x32_bf16 v[56:59], v[132:135], v[180:183], v[56:59]
    v_mfma_f32_16x16x32_bf16 v[60:63], v[132:135], v[184:187], v[60:63]
    ds_read_b128 v[108:111], v4 offset:2432
    v_mfma_f32_16x16x32_bf16 v[40:43], v[136:139], v[160:163], v[40:43]
    v_mfma_f32_16x16x32_bf16 v[44:47], v[136:139], v[164:167], v[44:47]
    ds_read_b128 v[76:79], v3 offset:1920
    v_mfma_f32_16x16x32_bf16 v[48:51], v[136:139], v[168:171], v[48:51]
    v_mfma_f32_16x16x32_bf16 v[52:55], v[136:139], v[172:175], v[52:55]
    ds_read_b128 v[112:115], v4 offset:1920
    v_mfma_f32_16x16x32_bf16 v[56:59], v[136:139], v[176:179], v[56:59]
    v_mfma_f32_16x16x32_bf16 v[60:63], v[136:139], v[180:183], v[60:63]
    ds_read_b128 v[80:83], v3 offset:2432
    v_mfma_f32_16x16x32_bf16 v[44:47], v[140:143], v[160:163], v[44:47]
    v_mfma_f32_16x16x32_bf16 v[48:51], v[140:143], v[164:167], v[48:51]
    ds_read_b128 v[116:119], v4 offset:1408
    v_mfma_f32_16x16x32_bf16 v[52:55], v[140:143], v[168:171], v[52:55]
    v_mfma_f32_16x16x32_bf16 v[56:59], v[140:143], v[172:175], v[56:59]
    ds_read_b128 v[84:87], v3 offset:2944
    v_mfma_f32_16x16x32_bf16 v[60:63], v[140:143], v[176:179], v[60:63]
    v_mfma_f32_16x16x32_bf16 v[48:51], v[144:147], v[160:163], v[48:51]
    ds_read_b128 v[120:123], v4 offset:896
    v_mfma_f32_16x16x32_bf16 v[52:55], v[144:147], v[164:167], v[52:55]
    v_mfma_f32_16x16x32_bf16 v[56:59], v[144:147], v[168:171], v[56:59]
    ds_read_b128 v[88:91], v3 offset:3456
    v_mfma_f32_16x16x32_bf16 v[60:63], v[144:147], v[172:175], v[60:63]
    v_mfma_f32_16x16x32_bf16 v[52:55], v[148:151], v[160:163], v[52:55]
    ds_read_b128 v[124:127], v4 offset:384
    v_mfma_f32_16x16x32_bf16 v[56:59], v[148:151], v[164:167], v[56:59]
    v_mfma_f32_16x16x32_bf16 v[60:63], v[148:151], v[168:171], v[60:63]
    ds_read_b128 v[92:95], v3 offset:3968
    v_mfma_f32_16x16x32_bf16 v[56:59], v[152:155], v[160:163], v[56:59]
    v_mfma_f32_16x16x32_bf16 v[60:63], v[152:155], v[164:167], v[60:63]
    v_mfma_f32_16x16x32_bf16 v[60:63], v[156:159], v[160:163], v[60:63]
    s_waitcnt lgkmcnt(0)
    v_mfma_f32_16x16x32_bf16 v[32:35], v[64:67], v[96:99], v[32:35]
    v_mfma_f32_16x16x32_bf16 v[36:39], v[64:67], v[100:103], v[36:39]
    v_mfma_f32_16x16x32_bf16 v[40:43], v[64:67], v[104:107], v[40:43]
    ds_read_b128 v[160:163], v4 offset:4032
    v_mfma_f32_16x16x32_bf16 v[44:47], v[64:67], v[108:111], v[44:47]
    v_mfma_f32_16x16x32_bf16 v[48:51], v[64:67], v[112:115], v[48:51]
    ds_read_b128 v[128:131], v3 offset:448
    v_mfma_f32_16x16x32_bf16 v[52:55], v[64:67], v[116:119], v[52:55]
    v_mfma_f32_16x16x32_bf16 v[56:59], v[64:67], v[120:123], v[56:59]
    ds_read_b128 v[164:167], v4 offset:3520
    v_mfma_f32_16x16x32_bf16 v[60:63], v[64:67], v[124:127], v[60:63]
    v_mfma_f32_16x16x32_bf16 v[36:39], v[68:71], v[96:99], v[36:39]
    ds_read_b128 v[132:135], v3 offset:960
    v_mfma_f32_16x16x32_bf16 v[40:43], v[68:71], v[100:103], v[40:43]
    v_mfma_f32_16x16x32_bf16 v[44:47], v[68:71], v[104:107], v[44:47]
    ds_read_b128 v[168:171], v4 offset:3008
    v_mfma_f32_16x16x32_bf16 v[48:51], v[68:71], v[108:111], v[48:51]
    v_mfma_f32_16x16x32_bf16 v[52:55], v[68:71], v[112:115], v[52:55]
    ds_read_b128 v[136:139], v3 offset:1472
    v_mfma_f32_16x16x32_bf16 v[56:59], v[68:71], v[116:119], v[56:59]
    v_mfma_f32_16x16x32_bf16 v[60:63], v[68:71], v[120:123], v[60:63]
    ds_read_b128 v[172:175], v4 offset:2496
    v_mfma_f32_16x16x32_bf16 v[40:43], v[72:75], v[96:99], v[40:43]
    v_mfma_f32_16x16x32_bf16 v[44:47], v[72:75], v[100:103], v[44:47]
    ds_read_b128 v[140:143], v3 offset:1984
    v_mfma_f32_16x16x32_bf16 v[48:51], v[72:75], v[104:107], v[48:51]
    v_mfma_f32_16x16x32_bf16 v[52:55], v[72:75], v[108:111], v[52:55]
    ds_read_b128 v[176:179], v4 offset:1984
    v_mfma_f32_16x16x32_bf16 v[56:59], v[72:75], v[112:115], v[56:59]
    v_mfma_f32_16x16x32_bf16 v[60:63], v[72:75], v[116:119], v[60:63]
    ds_read_b128 v[144:147], v3 offset:2496
    v_mfma_f32_16x16x32_bf16 v[44:47], v[76:79], v[96:99], v[44:47]
    v_mfma_f32_16x16x32_bf16 v[48:51], v[76:79], v[100:103], v[48:51]
    ds_read_b128 v[180:183], v4 offset:1472
    v_mfma_f32_16x16x32_bf16 v[52:55], v[76:79], v[104:107], v[52:55]
    v_mfma_f32_16x16x32_bf16 v[56:59], v[76:79], v[108:111], v[56:59]
    ds_read_b128 v[148:151], v3 offset:3008
    v_mfma_f32_16x16x32_bf16 v[60:63], v[76:79], v[112:115], v[60:63]
    v_mfma_f32_16x16x32_bf16 v[48:51], v[80:83], v[96:99], v[48:51]
    ds_read_b128 v[184:187], v4 offset:960
    v_mfma_f32_16x16x32_bf16 v[52:55], v[80:83], v[100:103], v[52:55]
    v_mfma_f32_16x16x32_bf16 v[56:59], v[80:83], v[104:107], v[56:59]
    ds_read_b128 v[152:155], v3 offset:3520
    v_mfma_f32_16x16x32_bf16 v[60:63], v[80:83], v[108:111], v[60:63]
    v_mfma_f32_16x16x32_bf16 v[52:55], v[84:87], v[96:99], v[52:55]
    ds_read_b128 v[188:191], v4 offset:448
    v_mfma_f32_16x16x32_bf16 v[56:59], v[84:87], v[100:103], v[56:59]
    v_mfma_f32_16x16x32_bf16 v[60:63], v[84:87], v[104:107], v[60:63]
    ds_read_b128 v[156:159], v3 offset:4032
    v_mfma_f32_16x16x32_bf16 v[56:59], v[88:91], v[96:99], v[56:59]
    v_mfma_f32_16x16x32_bf16 v[60:63], v[88:91], v[100:103], v[60:63]
    v_mfma_f32_16x16x32_bf16 v[60:63], v[92:95], v[96:99], v[60:63]
    s_waitcnt lgkmcnt(0)
    v_mfma_f32_16x16x32_bf16 v[32:35], v[128:131], v[160:163], v[32:35]
    v_mfma_f32_16x16x32_bf16 v[36:39], v[128:131], v[164:167], v[36:39]
    v_mfma_f32_16x16x32_bf16 v[40:43], v[128:131], v[168:171], v[40:43]
    v_mfma_f32_16x16x32_bf16 v[44:47], v[128:131], v[172:175], v[44:47]
    v_mfma_f32_16x16x32_bf16 v[48:51], v[128:131], v[176:179], v[48:51]
    v_mfma_f32_16x16x32_bf16 v[52:55], v[128:131], v[180:183], v[52:55]
    v_mfma_f32_16x16x32_bf16 v[56:59], v[128:131], v[184:187], v[56:59]
    v_mfma_f32_16x16x32_bf16 v[60:63], v[128:131], v[188:191], v[60:63]
    v_mfma_f32_16x16x32_bf16 v[36:39], v[132:135], v[160:163], v[36:39]
    v_mfma_f32_16x16x32_bf16 v[40:43], v[132:135], v[164:167], v[40:43]
    v_mfma_f32_16x16x32_bf16 v[44:47], v[132:135], v[168:171], v[44:47]
    v_mfma_f32_16x16x32_bf16 v[48:51], v[132:135], v[172:175], v[48:51]
    v_mfma_f32_16x16x32_bf16 v[52:55], v[132:135], v[176:179], v[52:55]
    v_mfma_f32_16x16x32_bf16 v[56:59], v[132:135], v[180:183], v[56:59]
    v_mfma_f32_16x16x32_bf16 v[60:63], v[132:135], v[184:187], v[60:63]
    v_mfma_f32_16x16x32_bf16 v[40:43], v[136:139], v[160:163], v[40:43]
    v_mfma_f32_16x16x32_bf16 v[44:47], v[136:139], v[164:167], v[44:47]
    v_mfma_f32_16x16x32_bf16 v[48:51], v[136:139], v[168:171], v[48:51]
    v_mfma_f32_16x16x32_bf16 v[52:55], v[136:139], v[172:175], v[52:55]
    v_mfma_f32_16x16x32_bf16 v[56:59], v[136:139], v[176:179], v[56:59]
    v_mfma_f32_16x16x32_bf16 v[60:63], v[136:139], v[180:183], v[60:63]
    v_mfma_f32_16x16x32_bf16 v[44:47], v[140:143], v[160:163], v[44:47]
    v_mfma_f32_16x16x32_bf16 v[48:51], v[140:143], v[164:167], v[48:51]
    v_mfma_f32_16x16x32_bf16 v[52:55], v[140:143], v[168:171], v[52:55]
    v_mfma_f32_16x16x32_bf16 v[56:59], v[140:143], v[172:175], v[56:59]
    v_mfma_f32_16x16x32_bf16 v[60:63], v[140:143], v[176:179], v[60:63]
    v_mfma_f32_16x16x32_bf16 v[48:51], v[144:147], v[160:163], v[48:51]
    v_mfma_f32_16x16x32_bf16 v[52:55], v[144:147], v[164:167], v[52:55]
    v_mfma_f32_16x16x32_bf16 v[56:59], v[144:147], v[168:171], v[56:59]
    v_mfma_f32_16x16x32_bf16 v[60:63], v[144:147], v[172:175], v[60:63]
    v_mfma_f32_16x16x32_bf16 v[52:55], v[148:151], v[160:163], v[52:55]
    v_mfma_f32_16x16x32_bf16 v[56:59], v[148:151], v[164:167], v[56:59]
    v_mfma_f32_16x16x32_bf16 v[60:63], v[148:151], v[168:171], v[60:63]
    v_mfma_f32_16x16x32_bf16 v[56:59], v[152:155], v[160:163], v[56:59]
    v_mfma_f32_16x16x32_bf16 v[60:63], v[152:155], v[164:167], v[60:63]
    v_mfma_f32_16x16x32_bf16 v[60:63], v[156:159], v[160:163], v[60:63]
    s_nop 7
    v_cvt_pk_bf16_f32 v32, v32, v33
    v_cvt_pk_bf16_f32 v33, v34, v35
    buffer_store_dwordx2 v[32:33], v5, s[16:19], s26 offen offset:0
    v_cvt_pk_bf16_f32 v36, v36, v37
    v_cvt_pk_bf16_f32 v37, v38, v39
    buffer_store_dwordx2 v[36:37], v5, s[16:19], s26 offen offset:512
    v_cvt_pk_bf16_f32 v40, v40, v41
    v_cvt_pk_bf16_f32 v41, v42, v43
    buffer_store_dwordx2 v[40:41], v5, s[16:19], s26 offen offset:1024
    v_cvt_pk_bf16_f32 v44, v44, v45
    v_cvt_pk_bf16_f32 v45, v46, v47
    buffer_store_dwordx2 v[44:45], v5, s[16:19], s26 offen offset:1536
    v_cvt_pk_bf16_f32 v48, v48, v49
    v_cvt_pk_bf16_f32 v49, v50, v51
    buffer_store_dwordx2 v[48:49], v5, s[16:19], s26 offen offset:2048
    v_cvt_pk_bf16_f32 v52, v52, v53
    v_cvt_pk_bf16_f32 v53, v54, v55
    buffer_store_dwordx2 v[52:53], v5, s[16:19], s26 offen offset:2560
    v_cvt_pk_bf16_f32 v56, v56, v57
    v_cvt_pk_bf16_f32 v57, v58, v59
    buffer_store_dwordx2 v[56:57], v5, s[16:19], s26 offen offset:3072
    v_cvt_pk_bf16_f32 v60, v60, v61
    v_cvt_pk_bf16_f32 v61, v62, v63
    buffer_store_dwordx2 v[60:61], v5, s[16:19], s26 offen offset:3584
conv_kernel_end:
    s_endpgm

.globl outproj_kernel
.p2align 8
.type outproj_kernel,@function
outproj_kernel:
    s_cmp_ge_u32 s2, 256
    s_cbranch_scc1 outproj_kernel_end
    s_load_dwordx2 s[20:21], s[0:1], 88
    s_load_dwordx2 s[22:23], s[0:1], 120
    s_load_dwordx2 s[24:25], s[0:1], 0
    s_load_dwordx2 s[26:27], s[0:1], 104
    v_lshrrev_b32 v16, 6, v0
    v_and_b32 v1, 63, v0
    v_readfirstlane_b32 s40, v16
    v_lshlrev_b32 v2, 4, v1
    s_bfe_u32 s44, s2, 0x20001
    s_lshl_b32 s41, s44, 2
    s_bfe_u32 s44, s2, 0x20003
    s_add_u32 s41, s41, s44
    s_and_b32 s42, s2, 1
    s_lshl_b32 s42, s42, 3
    s_lshr_b32 s44, s2, 5
    s_add_u32 s42, s42, s44
    v_lshrrev_b32 v16, 3, v1
    v_and_b32 v17, 6, v16
    v_and_b32 v18, 7, v1
    v_xor_b32 v17, v17, v18
    v_lshlrev_b32 v17, 4, v17
    v_lshl_add_u32 v4, v16, 11, v17
    v_add_u32 v5, 64512, v4
    v_add_u32 v6, 129024, v4
    v_add_u32 v7, 193536, v4
    v_and_b32 v16, 15, v1
    v_lshrrev_b32 v17, 4, v1
    v_lshrrev_b32 v18, 5, v1
    v_lshlrev_b32 v18, 12, v18
    v_bfe_u32 v19, v1, 2, 3
    v_lshl_add_u32 v18, v19, 7, v18
    v_and_b32 v20, 3, v1
    v_lshl_add_u32 v18, v20, 3, v18
    v_lshrrev_b32 v19, 1, v19
    v_xor_b32 v21, 0, v19
    v_lshl_add_u32 v8, v21, 5, v18
    v_xor_b32 v21, 1, v19
    v_lshl_add_u32 v9, v21, 5, v18
    v_xor_b32 v21, 2, v19
    v_lshl_add_u32 v10, v21, 5, v18
    v_xor_b32 v21, 3, v19
    v_lshl_add_u32 v11, v21, 5, v18
    v_lshlrev_b32 v21, 3, v17
    v_lshl_add_u32 v12, v16, 13, v21
    v_lshrrev_b32 v21, 2, v1
    v_lshlrev_b32 v21, 8, v21
    v_lshl_add_u32 v21, v20, 3, v21
    s_lshl_b32 s44, s40, 5
    s_add_u32 s44, s44, 65536
    v_add_u32 v13, s44, v21
    s_waitcnt lgkmcnt(0)
    s_mov_b32 s4, s20
    s_mov_b32 s5, s21
    s_mov_b32 s6, 8388608
    s_mov_b32 s7, 0x00020000
    s_add_u32 s8, s22, 33554432
    s_addc_u32 s9, s23, 0
    s_mov_b32 s10, 16777216
    s_mov_b32 s11, 0x00020000
    s_lshl_b32 s46, s40, 14
    s_lshl_b32 s44, s42, 7
    s_add_u32 s46, s46, s44
    s_lshl_b32 s49, s40, 12
    s_lshl_b32 s47, s41, 3
    s_add_u32 s47, s47, s40
    s_lshl_b32 s47, s47, 17
    s_add_u32 s48, s47, 524288
    s_add_u32 m0, s49, 0
    s_nop 0
    buffer_load_dwordx4 v4, s[4:7], s46 offen offset:0 lds
    buffer_load_dwordx4 v5, s[4:7], s46 offen offset:1024 lds
    buffer_load_dwordx4 v6, s[4:7], s46 offen offset:2048 lds
    buffer_load_dwordx4 v7, s[4:7], s46 offen offset:3072 lds
    buffer_load_dwordx4 a[0:3], v2, s[8:11], s47 offen offset:0
    buffer_load_dwordx4 a[4:7], v2, s[8:11], s48 offen offset:0
    buffer_load_dwordx4 a[8:11], v2, s[8:11], s47 offen offset:1024
    buffer_load_dwordx4 a[12:15], v2, s[8:11], s48 offen offset:1024
    buffer_load_dwordx4 a[16:19], v2, s[8:11], s47 offen offset:2048
    buffer_load_dwordx4 a[20:23], v2, s[8:11], s48 offen offset:2048
    buffer_load_dwordx4 a[24:27], v2, s[8:11], s47 offen offset:3072
    buffer_load_dwordx4 a[28:31], v2, s[8:11], s48 offen offset:3072
    s_add_u32 s46, s46, 262144
    s_add_u32 s47, s47, 4096
    s_add_u32 s48, s48, 4096
    s_add_u32 m0, s49, 16384
    s_nop 0
    buffer_load_dwordx4 v4, s[4:7], s46 offen offset:0 lds
    buffer_load_dwordx4 v5, s[4:7], s46 offen offset:1024 lds
    buffer_load_dwordx4 v6, s[4:7], s46 offen offset:2048 lds
    buffer_load_dwordx4 v7, s[4:7], s46 offen offset:3072 lds
    buffer_load_dwordx4 a[32:35], v2, s[8:11], s47 offen offset:0
    buffer_load_dwordx4 a[36:39], v2, s[8:11], s48 offen offset:0
    buffer_load_dwordx4 a[40:43], v2, s[8:11], s47 offen offset:1024
    buffer_load_dwordx4 a[44:47], v2, s[8:11], s48 offen offset:1024
    buffer_load_dwordx4 a[48:51], v2, s[8:11], s47 offen offset:2048
    buffer_load_dwordx4 a[52:55], v2, s[8:11], s48 offen offset:2048
    buffer_load_dwordx4 a[56:59], v2, s[8:11], s47 offen offset:3072
    buffer_load_dwordx4 a[60:63], v2, s[8:11], s48 offen offset:3072
    s_add_u32 s46, s46, 262144
    s_add_u32 s47, s47, 4096
    s_add_u32 s48, s48, 4096
    s_add_u32 m0, s49, 32768
    s_nop 0
    buffer_load_dwordx4 v4, s[4:7], s46 offen offset:0 lds
    buffer_load_dwordx4 v5, s[4:7], s46 offen offset:1024 lds
    buffer_load_dwordx4 v6, s[4:7], s46 offen offset:2048 lds
    buffer_load_dwordx4 v7, s[4:7], s46 offen offset:3072 lds
    buffer_load_dwordx4 a[64:67], v2, s[8:11], s47 offen offset:0
    buffer_load_dwordx4 a[68:71], v2, s[8:11], s48 offen offset:0
    buffer_load_dwordx4 a[72:75], v2, s[8:11], s47 offen offset:1024
    buffer_load_dwordx4 a[76:79], v2, s[8:11], s48 offen offset:1024
    buffer_load_dwordx4 a[80:83], v2, s[8:11], s47 offen offset:2048
    buffer_load_dwordx4 a[84:87], v2, s[8:11], s48 offen offset:2048
    buffer_load_dwordx4 a[88:91], v2, s[8:11], s47 offen offset:3072
    buffer_load_dwordx4 a[92:95], v2, s[8:11], s48 offen offset:3072
    s_add_u32 s46, s46, 262144
    s_add_u32 s47, s47, 4096
    s_add_u32 s48, s48, 4096
    s_add_u32 m0, s49, 49152
    s_nop 0
    buffer_load_dwordx4 v4, s[4:7], s46 offen offset:0 lds
    buffer_load_dwordx4 a[96:99], v2, s[8:11], s47 offen offset:0
    buffer_load_dwordx4 a[100:103], v2, s[8:11], s48 offen offset:0
    buffer_load_dwordx4 a[104:107], v2, s[8:11], s47 offen offset:1024
    buffer_load_dwordx4 a[108:111], v2, s[8:11], s48 offen offset:1024
    buffer_load_dwordx4 a[112:115], v2, s[8:11], s47 offen offset:2048
    buffer_load_dwordx4 a[116:119], v2, s[8:11], s48 offen offset:2048
    s_mov_b32 s12, s24
    s_mov_b32 s13, s25
    s_mov_b32 s14, 4194304
    s_mov_b32 s15, 0x00020000
    s_mov_b32 s16, s26
    s_mov_b32 s17, s27
    s_mov_b32 s18, 4194304
    s_mov_b32 s19, 0x00020000
    s_add_u32 s28, s22, 55574528
    s_addc_u32 s29, s23, 0
    s_mov_b32 s30, 4194304
    s_mov_b32 s31, 0x00020000
    s_add_u32 s52, s22, 59768832
    s_addc_u32 s53, s23, 0
    s_mov_b32 s54, 8192
    s_mov_b32 s55, 0x00020000
    s_lshl_b32 s56, s41, 7
    s_add_u32 s56, s56, s40
    s_lshl_b32 s58, s56, 2
    s_lshl_b32 s56, s56, 11
    s_lshl_b32 s44, s42, 7
    s_add_u32 s56, s56, s44
    s_add_u32 s57, s56, 131072
    v_lshlrev_b32 v22, 4, v16
    v_lshlrev_b32 v23, 12, v17
    v_lshl_add_u32 v23, v16, 4, v23
    s_lshl_b32 s59, s42, 2
    s_add_u32 s59, s59, s40
    s_lshl_b32 s59, s59, 16
    s_lshl_b32 s44, s41, 8
    s_add_u32 s59, s59, s44
    s_mov_b32 s43, 0
    v_mov_b32 v80, 0
    v_mov_b32 v81, 0
    v_mov_b32 v82, 0
    v_mov_b32 v83, 0
    v_mov_b32 v84, 0
    v_mov_b32 v85, 0
    v_mov_b32 v86, 0
    v_mov_b32 v87, 0
    v_mov_b32 v88, 0
    v_mov_b32 v89, 0
    v_mov_b32 v90, 0
    v_mov_b32 v91, 0
    v_mov_b32 v92, 0
    v_mov_b32 v93, 0
    v_mov_b32 v94, 0
    v_mov_b32 v95, 0
    v_mov_b32 v96, 0
    v_mov_b32 v97, 0
    v_mov_b32 v98, 0
    v_mov_b32 v99, 0
    v_mov_b32 v100, 0
    v_mov_b32 v101, 0
    v_mov_b32 v102, 0
    v_mov_b32 v103, 0
    v_mov_b32 v104, 0
    v_mov_b32 v105, 0
    v_mov_b32 v106, 0
    v_mov_b32 v107, 0
    v_mov_b32 v108, 0
    v_mov_b32 v109, 0
    v_mov_b32 v110, 0
    v_mov_b32 v111, 0
    s_waitcnt vmcnt(31)
    s_barrier
    ds_read_b64_tr_b16 v[48:49], v8 offset:0
    ds_read_b64_tr_b16 v[50:51], v8 offset:8192
    ds_read_b64_tr_b16 v[52:53], v9 offset:0
    ds_read_b64_tr_b16 v[54:55], v9 offset:8192
    ds_read_b64_tr_b16 v[56:57], v10 offset:0
    ds_read_b64_tr_b16 v[58:59], v10 offset:8192
    ds_read_b64_tr_b16 v[60:61], v11 offset:0
    ds_read_b64_tr_b16 v[62:63], v11 offset:8192
.p2align 6
outproj_kernel_loop:
    s_waitcnt lgkmcnt(0)
    v_mfma_f32_16x16x32_bf16 v[80:83], v[48:51], a[0:3], v[80:83]
    ds_read_b64_tr_b16 v[64:65], v8 offset:1024
    ds_read_b64_tr_b16 v[66:67], v8 offset:9216
    v_mfma_f32_16x16x32_bf16 v[84:87], v[48:51], a[4:7], v[84:87]
    ds_read_b64_tr_b16 v[68:69], v9 offset:1024
    ds_read_b64_tr_b16 v[70:71], v9 offset:9216
    v_mfma_f32_16x16x32_bf16 v[88:91], v[52:55], a[0:3], v[88:91]
    ds_read_b64_tr_b16 v[72:73], v10 offset:1024
    ds_read_b64_tr_b16 v[74:75], v10 offset:9216
    v_mfma_f32_16x16x32_bf16 v[92:95], v[52:55], a[4:7], v[92:95]
    ds_read_b64_tr_b16 v[76:77], v11 offset:1024
    ds_read_b64_tr_b16 v[78:79], v11 offset:9216
    v_mfma_f32_16x16x32_bf16 v[96:99], v[56:59], a[0:3], v[96:99]
    buffer_load_dwordx4 a[120:123], v2, s[8:11], s47 offen offset:3072
    v_mfma_f32_16x16x32_bf16 v[100:103], v[56:59], a[4:7], v[100:103]
    buffer_load_dwordx4 a[124:127], v2, s[8:11], s48 offen offset:3072
    v_mfma_f32_16x16x32_bf16 v[104:107], v[60:63], a[0:3], v[104:107]
    buffer_load_dwordx4 v5, s[4:7], s46 offen offset:1024 lds
    v_mfma_f32_16x16x32_bf16 v[108:111], v[60:63], a[4:7], v[108:111]
    s_add_u32 s47, s47, 4096
    s_add_u32 s48, s48, 4096
    s_cmp_eq_u32 s43, 7
    s_cbranch_scc1 outproj_kernel_extras
outproj_kernel_extras_ret:
    s_waitcnt lgkmcnt(0)
    v_mfma_f32_16x16x32_bf16 v[80:83], v[64:67], a[8:11], v[80:83]
    ds_read_b64_tr_b16 v[48:49], v8 offset:2048
    ds_read_b64_tr_b16 v[50:51], v8 offset:10240
    v_mfma_f32_16x16x32_bf16 v[84:87], v[64:67], a[12:15], v[84:87]
    ds_read_b64_tr_b16 v[52:53], v9 offset:2048
    ds_read_b64_tr_b16 v[54:55], v9 offset:10240
    v_mfma_f32_16x16x32_bf16 v[88:91], v[68:71], a[8:11], v[88:91]
    ds_read_b64_tr_b16 v[56:57], v10 offset:2048
    ds_read_b64_tr_b16 v[58:59], v10 offset:10240
    v_mfma_f32_16x16x32_bf16 v[92:95], v[68:71], a[12:15], v[92:95]
    ds_read_b64_tr_b16 v[60:61], v11 offset:2048
    ds_read_b64_tr_b16 v[62:63], v11 offset:10240
    v_mfma_f32_16x16x32_bf16 v[96:99], v[72:75], a[8:11], v[96:99]
    buffer_load_dwordx4 a[0:3], v2, s[8:11], s47 offen offset:0
    v_mfma_f32_16x16x32_bf16 v[100:103], v[72:75], a[12:15], v[100:103]
    buffer_load_dwordx4 a[4:7], v2, s[8:11], s48 offen offset:0
    v_mfma_f32_16x16x32_bf16 v[104:107], v[76:79], a[8:11], v[104:107]
    buffer_load_dwordx4 v6, s[4:7], s46 offen offset:2048 lds
    v_mfma_f32_16x16x32_bf16 v[108:111], v[76:79], a[12:15], v[108:111]
    s_waitcnt lgkmcnt(0)
    v_mfma_f32_16x16x32_bf16 v[80:83], v[48:51], a[16:19], v[80:83]
    ds_read_b64_tr_b16 v[64:65], v8 offset:3072
    ds_read_b64_tr_b16 v[66:67], v8 offset:11264
    v_mfma_f32_16x16x32_bf16 v[84:87], v[48:51], a[20:23], v[84:87]
    ds_read_b64_tr_b16 v[68:69], v9 offset:3072
    ds_read_b64_tr_b16 v[70:71], v9 offset:11264
    v_mfma_f32_16x16x32_bf16 v[88:91], v[52:55], a[16:19], v[88:91]
    ds_read_b64_tr_b16 v[72:73], v10 offset:3072
    ds_read_b64_tr_b16 v[74:75], v10 offset:11264
    v_mfma_f32_16x16x32_bf16 v[92:95], v[52:55], a[20:23], v[92:95]
    ds_read_b64_tr_b16 v[76:77], v11 offset:3072
    ds_read_b64_tr_b16 v[78:79], v11 offset:11264
    v_mfma_f32_16x16x32_bf16 v[96:99], v[56:59], a[16:19], v[96:99]
    buffer_load_dwordx4 a[8:11], v2, s[8:11], s47 offen offset:1024
    v_mfma_f32_16x16x32_bf16 v[100:103], v[56:59], a[20:23], v[100:103]
    buffer_load_dwordx4 a[12:15], v2, s[8:11], s48 offen offset:1024
    v_mfma_f32_16x16x32_bf16 v[104:107], v[60:63], a[16:19], v[104:107]
    buffer_load_dwordx4 v7, s[4:7], s46 offen offset:3072 lds
    v_mfma_f32_16x16x32_bf16 v[108:111], v[60:63], a[20:23], v[108:111]
    s_add_u32 s46, s46, 262144
    s_waitcnt vmcnt(24) lgkmcnt(0)
    s_barrier
    v_mfma_f32_16x16x32_bf16 v[80:83], v[64:67], a[24:27], v[80:83]
    s_add_u32 m0, s49, 0
    ds_read_b64_tr_b16 v[48:49], v8 offset:16384
    ds_read_b64_tr_b16 v[50:51], v8 offset:24576
    v_mfma_f32_16x16x32_bf16 v[84:87], v[64:67], a[28:31], v[84:87]
    ds_read_b64_tr_b16 v[52:53], v9 offset:16384
    ds_read_b64_tr_b16 v[54:55], v9 offset:24576
    v_mfma_f32_16x16x32_bf16 v[88:91], v[68:71], a[24:27], v[88:91]
    ds_read_b64_tr_b16 v[56:57], v10 offset:16384
    ds_read_b64_tr_b16 v[58:59], v10 offset:24576
    v_mfma_f32_16x16x32_bf16 v[92:95], v[68:71], a[28:31], v[92:95]
    ds_read_b64_tr_b16 v[60:61], v11 offset:16384
    ds_read_b64_tr_b16 v[62:63], v11 offset:24576
    v_mfma_f32_16x16x32_bf16 v[96:99], v[72:75], a[24:27], v[96:99]
    buffer_load_dwordx4 a[16:19], v2, s[8:11], s47 offen offset:2048
    v_mfma_f32_16x16x32_bf16 v[100:103], v[72:75], a[28:31], v[100:103]
    buffer_load_dwordx4 a[20:23], v2, s[8:11], s48 offen offset:2048
    v_mfma_f32_16x16x32_bf16 v[104:107], v[76:79], a[24:27], v[104:107]
    buffer_load_dwordx4 v4, s[4:7], s46 offen offset:0 lds
    v_mfma_f32_16x16x32_bf16 v[108:111], v[76:79], a[28:31], v[108:111]
    s_waitcnt lgkmcnt(0)
    v_mfma_f32_16x16x32_bf16 v[80:83], v[48:51], a[32:35], v[80:83]
    ds_read_b64_tr_b16 v[64:65], v8 offset:17408
    ds_read_b64_tr_b16 v[66:67], v8 offset:25600
    v_mfma_f32_16x16x32_bf16 v[84:87], v[48:51], a[36:39], v[84:87]
    ds_read_b64_tr_b16 v[68:69], v9 offset:17408
    ds_read_b64_tr_b16 v[70:71], v9 offset:25600
    v_mfma_f32_16x16x32_bf16 v[88:91], v[52:55], a[32:35], v[88:91]
    ds_read_b64_tr_b16 v[72:73], v10 offset:17408
    ds_read_b64_tr_b16 v[74:75], v10 offset:25600
    v_mfma_f32_16x16x32_bf16 v[92:95], v[52:55], a[36:39], v[92:95]
    ds_read_b64_tr_b16 v[76:77], v11 offset:17408
    ds_read_b64_tr_b16 v[78:79], v11 offset:25600
    v_mfma_f32_16x16x32_bf16 v[96:99], v[56:59], a[32:35], v[96:99]
    buffer_load_dwordx4 a[24:27], v2, s[8:11], s47 offen offset:3072
    v_mfma_f32_16x16x32_bf16 v[100:103], v[56:59], a[36:39], v[100:103]
    buffer_load_dwordx4 a[28:31], v2, s[8:11], s48 offen offset:3072
    v_mfma_f32_16x16x32_bf16 v[104:107], v[60:63], a[32:35], v[104:107]
    buffer_load_dwordx4 v5, s[4:7], s46 offen offset:1024 lds
    v_mfma_f32_16x16x32_bf16 v[108:111], v[60:63], a[36:39], v[108:111]
    s_add_u32 s47, s47, 4096
    s_add_u32 s48, s48, 4096
    s_waitcnt lgkmcnt(0)
    v_mfma_f32_16x16x32_bf16 v[80:83], v[64:67], a[40:43], v[80:83]
    ds_read_b64_tr_b16 v[48:49], v8 offset:18432
    ds_read_b64_tr_b16 v[50:51], v8 offset:26624
    v_mfma_f32_16x16x32_bf16 v[84:87], v[64:67], a[44:47], v[84:87]
    ds_read_b64_tr_b16 v[52:53], v9 offset:18432
    ds_read_b64_tr_b16 v[54:55], v9 offset:26624
    v_mfma_f32_16x16x32_bf16 v[88:91], v[68:71], a[40:43], v[88:91]
    ds_read_b64_tr_b16 v[56:57], v10 offset:18432
    ds_read_b64_tr_b16 v[58:59], v10 offset:26624
    v_mfma_f32_16x16x32_bf16 v[92:95], v[68:71], a[44:47], v[92:95]
    ds_read_b64_tr_b16 v[60:61], v11 offset:18432
    ds_read_b64_tr_b16 v[62:63], v11 offset:26624
    v_mfma_f32_16x16x32_bf16 v[96:99], v[72:75], a[40:43], v[96:99]
    buffer_load_dwordx4 a[32:35], v2, s[8:11], s47 offen offset:0
    v_mfma_f32_16x16x32_bf16 v[100:103], v[72:75], a[44:47], v[100:103]
    buffer_load_dwordx4 a[36:39], v2, s[8:11], s48 offen offset:0
    v_mfma_f32_16x16x32_bf16 v[104:107], v[76:79], a[40:43], v[104:107]
    buffer_load_dwordx4 v6, s[4:7], s46 offen offset:2048 lds
    v_mfma_f32_16x16x32_bf16 v[108:111], v[76:79], a[44:47], v[108:111]
    s_waitcnt lgkmcnt(0)
    v_mfma_f32_16x16x32_bf16 v[80:83], v[48:51], a[48:51], v[80:83]
    ds_read_b64_tr_b16 v[64:65], v8 offset:19456
    ds_read_b64_tr_b16 v[66:67], v8 offset:27648
    v_mfma_f32_16x16x32_bf16 v[84:87], v[48:51], a[52:55], v[84:87]
    ds_read_b64_tr_b16 v[68:69], v9 offset:19456
    ds_read_b64_tr_b16 v[70:71], v9 offset:27648
    v_mfma_f32_16x16x32_bf16 v[88:91], v[52:55], a[48:51], v[88:91]
    ds_read_b64_tr_b16 v[72:73], v10 offset:19456
    ds_read_b64_tr_b16 v[74:75], v10 offset:27648
    v_mfma_f32_16x16x32_bf16 v[92:95], v[52:55], a[52:55], v[92:95]
    ds_read_b64_tr_b16 v[76:77], v11 offset:19456
    ds_read_b64_tr_b16 v[78:79], v11 offset:27648
    v_mfma_f32_16x16x32_bf16 v[96:99], v[56:59], a[48:51], v[96:99]
    buffer_load_dwordx4 a[40:43], v2, s[8:11], s47 offen offset:1024
    v_mfma_f32_16x16x32_bf16 v[100:103], v[56:59], a[52:55], v[100:103]
    buffer_load_dwordx4 a[44:47], v2, s[8:11], s48 offen offset:1024
    v_mfma_f32_16x16x32_bf16 v[104:107], v[60:63], a[48:51], v[104:107]
    buffer_load_dwordx4 v7, s[4:7], s46 offen offset:3072 lds
    v_mfma_f32_16x16x32_bf16 v[108:111], v[60:63], a[52:55], v[108:111]
    s_add_u32 s46, s46, 262144
    s_waitcnt vmcnt(24) lgkmcnt(0)
    s_barrier
    v_mfma_f32_16x16x32_bf16 v[80:83], v[64:67], a[56:59], v[80:83]
    s_add_u32 m0, s49, 16384
    ds_read_b64_tr_b16 v[48:49], v8 offset:32768
    ds_read_b64_tr_b16 v[50:51], v8 offset:40960
    v_mfma_f32_16x16x32_bf16 v[84:87], v[64:67], a[60:63], v[84:87]
    ds_read_b64_tr_b16 v[52:53], v9 offset:32768
    ds_read_b64_tr_b16 v[54:55], v9 offset:40960
    v_mfma_f32_16x16x32_bf16 v[88:91], v[68:71], a[56:59], v[88:91]
    ds_read_b64_tr_b16 v[56:57], v10 offset:32768
    ds_read_b64_tr_b16 v[58:59], v10 offset:40960
    v_mfma_f32_16x16x32_bf16 v[92:95], v[68:71], a[60:63], v[92:95]
    ds_read_b64_tr_b16 v[60:61], v11 offset:32768
    ds_read_b64_tr_b16 v[62:63], v11 offset:40960
    v_mfma_f32_16x16x32_bf16 v[96:99], v[72:75], a[56:59], v[96:99]
    buffer_load_dwordx4 a[48:51], v2, s[8:11], s47 offen offset:2048
    v_mfma_f32_16x16x32_bf16 v[100:103], v[72:75], a[60:63], v[100:103]
    buffer_load_dwordx4 a[52:55], v2, s[8:11], s48 offen offset:2048
    v_mfma_f32_16x16x32_bf16 v[104:107], v[76:79], a[56:59], v[104:107]
    buffer_load_dwordx4 v4, s[4:7], s46 offen offset:0 lds
    v_mfma_f32_16x16x32_bf16 v[108:111], v[76:79], a[60:63], v[108:111]
    s_waitcnt lgkmcnt(0)
    v_mfma_f32_16x16x32_bf16 v[80:83], v[48:51], a[64:67], v[80:83]
    ds_read_b64_tr_b16 v[64:65], v8 offset:33792
    ds_read_b64_tr_b16 v[66:67], v8 offset:41984
    v_mfma_f32_16x16x32_bf16 v[84:87], v[48:51], a[68:71], v[84:87]
    ds_read_b64_tr_b16 v[68:69], v9 offset:33792
    ds_read_b64_tr_b16 v[70:71], v9 offset:41984
    v_mfma_f32_16x16x32_bf16 v[88:91], v[52:55], a[64:67], v[88:91]
    ds_read_b64_tr_b16 v[72:73], v10 offset:33792
    ds_read_b64_tr_b16 v[74:75], v10 offset:41984
    v_mfma_f32_16x16x32_bf16 v[92:95], v[52:55], a[68:71], v[92:95]
    ds_read_b64_tr_b16 v[76:77], v11 offset:33792
    ds_read_b64_tr_b16 v[78:79], v11 offset:41984
    v_mfma_f32_16x16x32_bf16 v[96:99], v[56:59], a[64:67], v[96:99]
    buffer_load_dwordx4 a[56:59], v2, s[8:11], s47 offen offset:3072
    v_mfma_f32_16x16x32_bf16 v[100:103], v[56:59], a[68:71], v[100:103]
    buffer_load_dwordx4 a[60:63], v2, s[8:11], s48 offen offset:3072
    v_mfma_f32_16x16x32_bf16 v[104:107], v[60:63], a[64:67], v[104:107]
    buffer_load_dwordx4 v5, s[4:7], s46 offen offset:1024 lds
    v_mfma_f32_16x16x32_bf16 v[108:111], v[60:63], a[68:71], v[108:111]
    s_add_u32 s47, s47, 4096
    s_add_u32 s48, s48, 4096
    s_waitcnt lgkmcnt(0)
    v_mfma_f32_16x16x32_bf16 v[80:83], v[64:67], a[72:75], v[80:83]
    ds_read_b64_tr_b16 v[48:49], v8 offset:34816
    ds_read_b64_tr_b16 v[50:51], v8 offset:43008
    v_mfma_f32_16x16x32_bf16 v[84:87], v[64:67], a[76:79], v[84:87]
    ds_read_b64_tr_b16 v[52:53], v9 offset:34816
    ds_read_b64_tr_b16 v[54:55], v9 offset:43008
    v_mfma_f32_16x16x32_bf16 v[88:91], v[68:71], a[72:75], v[88:91]
    ds_read_b64_tr_b16 v[56:57], v10 offset:34816
    ds_read_b64_tr_b16 v[58:59], v10 offset:43008
    v_mfma_f32_16x16x32_bf16 v[92:95], v[68:71], a[76:79], v[92:95]
    ds_read_b64_tr_b16 v[60:61], v11 offset:34816
    ds_read_b64_tr_b16 v[62:63], v11 offset:43008
    v_mfma_f32_16x16x32_bf16 v[96:99], v[72:75], a[72:75], v[96:99]
    buffer_load_dwordx4 a[64:67], v2, s[8:11], s47 offen offset:0
    v_mfma_f32_16x16x32_bf16 v[100:103], v[72:75], a[76:79], v[100:103]
    buffer_load_dwordx4 a[68:71], v2, s[8:11], s48 offen offset:0
    v_mfma_f32_16x16x32_bf16 v[104:107], v[76:79], a[72:75], v[104:107]
    buffer_load_dwordx4 v6, s[4:7], s46 offen offset:2048 lds
    v_mfma_f32_16x16x32_bf16 v[108:111], v[76:79], a[76:79], v[108:111]
    s_waitcnt lgkmcnt(0)
    v_mfma_f32_16x16x32_bf16 v[80:83], v[48:51], a[80:83], v[80:83]
    ds_read_b64_tr_b16 v[64:65], v8 offset:35840
    ds_read_b64_tr_b16 v[66:67], v8 offset:44032
    v_mfma_f32_16x16x32_bf16 v[84:87], v[48:51], a[84:87], v[84:87]
    ds_read_b64_tr_b16 v[68:69], v9 offset:35840
    ds_read_b64_tr_b16 v[70:71], v9 offset:44032
    v_mfma_f32_16x16x32_bf16 v[88:91], v[52:55], a[80:83], v[88:91]
    ds_read_b64_tr_b16 v[72:73], v10 offset:35840
    ds_read_b64_tr_b16 v[74:75], v10 offset:44032
    v_mfma_f32_16x16x32_bf16 v[92:95], v[52:55], a[84:87], v[92:95]
    ds_read_b64_tr_b16 v[76:77], v11 offset:35840
    ds_read_b64_tr_b16 v[78:79], v11 offset:44032
    v_mfma_f32_16x16x32_bf16 v[96:99], v[56:59], a[80:83], v[96:99]
    buffer_load_dwordx4 a[72:75], v2, s[8:11], s47 offen offset:1024
    v_mfma_f32_16x16x32_bf16 v[100:103], v[56:59], a[84:87], v[100:103]
    buffer_load_dwordx4 a[76:79], v2, s[8:11], s48 offen offset:1024
    v_mfma_f32_16x16x32_bf16 v[104:107], v[60:63], a[80:83], v[104:107]
    buffer_load_dwordx4 v7, s[4:7], s46 offen offset:3072 lds
    v_mfma_f32_16x16x32_bf16 v[108:111], v[60:63], a[84:87], v[108:111]
    s_add_u32 s46, s46, 262144
    s_waitcnt vmcnt(24) lgkmcnt(0)
    s_barrier
    v_mfma_f32_16x16x32_bf16 v[80:83], v[64:67], a[88:91], v[80:83]
    s_add_u32 m0, s49, 32768
    ds_read_b64_tr_b16 v[48:49], v8 offset:49152
    ds_read_b64_tr_b16 v[50:51], v8 offset:57344
    v_mfma_f32_16x16x32_bf16 v[84:87], v[64:67], a[92:95], v[84:87]
    ds_read_b64_tr_b16 v[52:53], v9 offset:49152
    ds_read_b64_tr_b16 v[54:55], v9 offset:57344
    v_mfma_f32_16x16x32_bf16 v[88:91], v[68:71], a[88:91], v[88:91]
    ds_read_b64_tr_b16 v[56:57], v10 offset:49152
    ds_read_b64_tr_b16 v[58:59], v10 offset:57344
    v_mfma_f32_16x16x32_bf16 v[92:95], v[68:71], a[92:95], v[92:95]
    ds_read_b64_tr_b16 v[60:61], v11 offset:49152
    ds_read_b64_tr_b16 v[62:63], v11 offset:57344
    v_mfma_f32_16x16x32_bf16 v[96:99], v[72:75], a[88:91], v[96:99]
    buffer_load_dwordx4 a[80:83], v2, s[8:11], s47 offen offset:2048
    v_mfma_f32_16x16x32_bf16 v[100:103], v[72:75], a[92:95], v[100:103]
    buffer_load_dwordx4 a[84:87], v2, s[8:11], s48 offen offset:2048
    v_mfma_f32_16x16x32_bf16 v[104:107], v[76:79], a[88:91], v[104:107]
    buffer_load_dwordx4 v4, s[4:7], s46 offen offset:0 lds
    v_mfma_f32_16x16x32_bf16 v[108:111], v[76:79], a[92:95], v[108:111]
    s_waitcnt lgkmcnt(0)
    v_mfma_f32_16x16x32_bf16 v[80:83], v[48:51], a[96:99], v[80:83]
    ds_read_b64_tr_b16 v[64:65], v8 offset:50176
    ds_read_b64_tr_b16 v[66:67], v8 offset:58368
    v_mfma_f32_16x16x32_bf16 v[84:87], v[48:51], a[100:103], v[84:87]
    ds_read_b64_tr_b16 v[68:69], v9 offset:50176
    ds_read_b64_tr_b16 v[70:71], v9 offset:58368
    v_mfma_f32_16x16x32_bf16 v[88:91], v[52:55], a[96:99], v[88:91]
    ds_read_b64_tr_b16 v[72:73], v10 offset:50176
    ds_read_b64_tr_b16 v[74:75], v10 offset:58368
    v_mfma_f32_16x16x32_bf16 v[92:95], v[52:55], a[100:103], v[92:95]
    ds_read_b64_tr_b16 v[76:77], v11 offset:50176
    ds_read_b64_tr_b16 v[78:79], v11 offset:58368
    v_mfma_f32_16x16x32_bf16 v[96:99], v[56:59], a[96:99], v[96:99]
    buffer_load_dwordx4 a[88:91], v2, s[8:11], s47 offen offset:3072
    v_mfma_f32_16x16x32_bf16 v[100:103], v[56:59], a[100:103], v[100:103]
    buffer_load_dwordx4 a[92:95], v2, s[8:11], s48 offen offset:3072
    v_mfma_f32_16x16x32_bf16 v[104:107], v[60:63], a[96:99], v[104:107]
    buffer_load_dwordx4 v5, s[4:7], s46 offen offset:1024 lds
    v_mfma_f32_16x16x32_bf16 v[108:111], v[60:63], a[100:103], v[108:111]
    s_add_u32 s47, s47, 4096
    s_add_u32 s48, s48, 4096
    s_waitcnt lgkmcnt(0)
    v_mfma_f32_16x16x32_bf16 v[80:83], v[64:67], a[104:107], v[80:83]
    ds_read_b64_tr_b16 v[48:49], v8 offset:51200
    ds_read_b64_tr_b16 v[50:51], v8 offset:59392
    v_mfma_f32_16x16x32_bf16 v[84:87], v[64:67], a[108:111], v[84:87]
    ds_read_b64_tr_b16 v[52:53], v9 offset:51200
    ds_read_b64_tr_b16 v[54:55], v9 offset:59392
    v_mfma_f32_16x16x32_bf16 v[88:91], v[68:71], a[104:107], v[88:91]
    ds_read_b64_tr_b16 v[56:57], v10 offset:51200
    ds_read_b64_tr_b16 v[58:59], v10 offset:59392
    v_mfma_f32_16x16x32_bf16 v[92:95], v[68:71], a[108:111], v[92:95]
    ds_read_b64_tr_b16 v[60:61], v11 offset:51200
    ds_read_b64_tr_b16 v[62:63], v11 offset:59392
    v_mfma_f32_16x16x32_bf16 v[96:99], v[72:75], a[104:107], v[96:99]
    buffer_load_dwordx4 a[96:99], v2, s[8:11], s47 offen offset:0
    v_mfma_f32_16x16x32_bf16 v[100:103], v[72:75], a[108:111], v[100:103]
    buffer_load_dwordx4 a[100:103], v2, s[8:11], s48 offen offset:0
    v_mfma_f32_16x16x32_bf16 v[104:107], v[76:79], a[104:107], v[104:107]
    buffer_load_dwordx4 v6, s[4:7], s46 offen offset:2048 lds
    v_mfma_f32_16x16x32_bf16 v[108:111], v[76:79], a[108:111], v[108:111]
    s_waitcnt lgkmcnt(0)
    v_mfma_f32_16x16x32_bf16 v[80:83], v[48:51], a[112:115], v[80:83]
    ds_read_b64_tr_b16 v[64:65], v8 offset:52224
    ds_read_b64_tr_b16 v[66:67], v8 offset:60416
    v_mfma_f32_16x16x32_bf16 v[84:87], v[48:51], a[116:119], v[84:87]
    ds_read_b64_tr_b16 v[68:69], v9 offset:52224
    ds_read_b64_tr_b16 v[70:71], v9 offset:60416
    v_mfma_f32_16x16x32_bf16 v[88:91], v[52:55], a[112:115], v[88:91]
    ds_read_b64_tr_b16 v[72:73], v10 offset:52224
    ds_read_b64_tr_b16 v[74:75], v10 offset:60416
    v_mfma_f32_16x16x32_bf16 v[92:95], v[52:55], a[116:119], v[92:95]
    ds_read_b64_tr_b16 v[76:77], v11 offset:52224
    ds_read_b64_tr_b16 v[78:79], v11 offset:60416
    v_mfma_f32_16x16x32_bf16 v[96:99], v[56:59], a[112:115], v[96:99]
    buffer_load_dwordx4 a[104:107], v2, s[8:11], s47 offen offset:1024
    v_mfma_f32_16x16x32_bf16 v[100:103], v[56:59], a[116:119], v[100:103]
    buffer_load_dwordx4 a[108:111], v2, s[8:11], s48 offen offset:1024
    v_mfma_f32_16x16x32_bf16 v[104:107], v[60:63], a[112:115], v[104:107]
    buffer_load_dwordx4 v7, s[4:7], s46 offen offset:3072 lds
    v_mfma_f32_16x16x32_bf16 v[108:111], v[60:63], a[116:119], v[108:111]
    s_add_u32 s46, s46, 262144
    s_waitcnt vmcnt(24) lgkmcnt(0)
    s_barrier
    v_mfma_f32_16x16x32_bf16 v[80:83], v[64:67], a[120:123], v[80:83]
    s_add_u32 m0, s49, 49152
    ds_read_b64_tr_b16 v[48:49], v8 offset:0
    ds_read_b64_tr_b16 v[50:51], v8 offset:8192
    v_mfma_f32_16x16x32_bf16 v[84:87], v[64:67], a[124:127], v[84:87]
    ds_read_b64_tr_b16 v[52:53], v9 offset:0
    ds_read_b64_tr_b16 v[54:55], v9 offset:8192
    v_mfma_f32_16x16x32_bf16 v[88:91], v[68:71], a[120:123], v[88:91]
    ds_read_b64_tr_b16 v[56:57], v10 offset:0
    ds_read_b64_tr_b16 v[58:59], v10 offset:8192
    v_mfma_f32_16x16x32_bf16 v[92:95], v[68:71], a[124:127], v[92:95]
    ds_read_b64_tr_b16 v[60:61], v11 offset:0
    ds_read_b64_tr_b16 v[62:63], v11 offset:8192
    v_mfma_f32_16x16x32_bf16 v[96:99], v[72:75], a[120:123], v[96:99]
    buffer_load_dwordx4 a[112:115], v2, s[8:11], s47 offen offset:2048
    v_mfma_f32_16x16x32_bf16 v[100:103], v[72:75], a[124:127], v[100:103]
    buffer_load_dwordx4 a[116:119], v2, s[8:11], s48 offen offset:2048
    v_mfma_f32_16x16x32_bf16 v[104:107], v[76:79], a[120:123], v[104:107]
    buffer_load_dwordx4 v4, s[4:7], s46 offen offset:0 lds
    v_mfma_f32_16x16x32_bf16 v[108:111], v[76:79], a[124:127], v[108:111]
    s_add_u32 s43, s43, 1
    s_cmp_lg_u32 s43, 8
    s_cbranch_scc1 outproj_kernel_loop
    s_waitcnt vmcnt(0) lgkmcnt(0)
    s_barrier
    ds_read_b64_tr_b16 v[48:49], v13 offset:0
    ds_read_b64_tr_b16 v[52:53], v13 offset:4096
    ds_read_b64_tr_b16 v[56:57], v13 offset:8192
    ds_read_b64_tr_b16 v[60:61], v13 offset:12288
    ds_read_b64_tr_b16 v[50:51], v13 offset:128
    ds_read_b64_tr_b16 v[54:55], v13 offset:4224
    ds_read_b64_tr_b16 v[58:59], v13 offset:8320
    ds_read_b64_tr_b16 v[62:63], v13 offset:12416
    s_mov_b32 s60, 0xffff0000
    s_waitcnt lgkmcnt(0)
    v_lshlrev_b32 v64, 16, v32
    v_lshlrev_b32 v68, 16, v48
    v_and_b32 v65, s60, v32
    v_and_b32 v69, s60, v48
    v_lshlrev_b32 v66, 16, v33
    v_lshlrev_b32 v70, 16, v49
    v_and_b32 v67, s60, v33
    v_and_b32 v71, s60, v49
    v_fma_f32 v64, v64, v68, -v80
    v_fma_f32 v65, v65, v69, -v81
    v_fma_f32 v66, v66, v70, -v82
    v_fma_f32 v67, v67, v71, -v83
    v_fmac_f32 v80, v14, v64
    v_fmac_f32 v81, v14, v65
    v_fmac_f32 v82, v14, v66
    v_fmac_f32 v83, v14, v67
    v_cvt_pk_bf16_f32 v80, v80, v81
    v_cvt_pk_bf16_f32 v81, v82, v83
    buffer_store_dwordx2 v[80:81], v12, s[16:19], s56 offen offset:0
    v_lshlrev_b32 v64, 16, v36
    v_lshlrev_b32 v68, 16, v52
    v_and_b32 v65, s60, v36
    v_and_b32 v69, s60, v52
    v_lshlrev_b32 v66, 16, v37
    v_lshlrev_b32 v70, 16, v53
    v_and_b32 v67, s60, v37
    v_and_b32 v71, s60, v53
    v_fma_f32 v64, v64, v68, -v88
    v_fma_f32 v65, v65, v69, -v89
    v_fma_f32 v66, v66, v70, -v90
    v_fma_f32 v67, v67, v71, -v91
    v_fmac_f32 v88, v14, v64
    v_fmac_f32 v89, v14, v65
    v_fmac_f32 v90, v14, v66
    v_fmac_f32 v91, v14, v67
    v_cvt_pk_bf16_f32 v88, v88, v89
    v_cvt_pk_bf16_f32 v89, v90, v91
    buffer_store_dwordx2 v[88:89], v12, s[16:19], s56 offen offset:32
    v_lshlrev_b32 v64, 16, v40
    v_lshlrev_b32 v68, 16, v56
    v_and_b32 v65, s60, v40
    v_and_b32 v69, s60, v56
    v_lshlrev_b32 v66, 16, v41
    v_lshlrev_b32 v70, 16, v57
    v_and_b32 v67, s60, v41
    v_and_b32 v71, s60, v57
    v_fma_f32 v64, v64, v68, -v96
    v_fma_f32 v65, v65, v69, -v97
    v_fma_f32 v66, v66, v70, -v98
    v_fma_f32 v67, v67, v71, -v99
    v_fmac_f32 v96, v14, v64
    v_fmac_f32 v97, v14, v65
    v_fmac_f32 v98, v14, v66
    v_fmac_f32 v99, v14, v67
    v_cvt_pk_bf16_f32 v96, v96, v97
    v_cvt_pk_bf16_f32 v97, v98, v99
    buffer_store_dwordx2 v[96:97], v12, s[16:19], s56 offen offset:64
    v_lshlrev_b32 v64, 16, v44
    v_lshlrev_b32 v68, 16, v60
    v_and_b32 v65, s60, v44
    v_and_b32 v69, s60, v60
    v_lshlrev_b32 v66, 16, v45
    v_lshlrev_b32 v70, 16, v61
    v_and_b32 v67, s60, v45
    v_and_b32 v71, s60, v61
    v_fma_f32 v64, v64, v68, -v104
    v_fma_f32 v65, v65, v69, -v105
    v_fma_f32 v66, v66, v70, -v106
    v_fma_f32 v67, v67, v71, -v107
    v_fmac_f32 v104, v14, v64
    v_fmac_f32 v105, v14, v65
    v_fmac_f32 v106, v14, v66
    v_fmac_f32 v107, v14, v67
    v_cvt_pk_bf16_f32 v104, v104, v105
    v_cvt_pk_bf16_f32 v105, v106, v107
    buffer_store_dwordx2 v[104:105], v12, s[16:19], s56 offen offset:96
    v_lshlrev_b32 v72, 16, v34
    v_lshlrev_b32 v76, 16, v50
    v_and_b32 v73, s60, v34
    v_and_b32 v77, s60, v50
    v_lshlrev_b32 v74, 16, v35
    v_lshlrev_b32 v78, 16, v51
    v_and_b32 v75, s60, v35
    v_and_b32 v79, s60, v51
    v_fma_f32 v72, v72, v76, -v84
    v_fma_f32 v73, v73, v77, -v85
    v_fma_f32 v74, v74, v78, -v86
    v_fma_f32 v75, v75, v79, -v87
    v_fmac_f32 v84, v15, v72
    v_fmac_f32 v85, v15, v73
    v_fmac_f32 v86, v15, v74
    v_fmac_f32 v87, v15, v75
    v_cvt_pk_bf16_f32 v84, v84, v85
    v_cvt_pk_bf16_f32 v85, v86, v87
    buffer_store_dwordx2 v[84:85], v12, s[16:19], s57 offen offset:0
    v_lshlrev_b32 v72, 16, v38
    v_lshlrev_b32 v76, 16, v54
    v_and_b32 v73, s60, v38
    v_and_b32 v77, s60, v54
    v_lshlrev_b32 v74, 16, v39
    v_lshlrev_b32 v78, 16, v55
    v_and_b32 v75, s60, v39
    v_and_b32 v79, s60, v55
    v_fma_f32 v72, v72, v76, -v92
    v_fma_f32 v73, v73, v77, -v93
    v_fma_f32 v74, v74, v78, -v94
    v_fma_f32 v75, v75, v79, -v95
    v_fmac_f32 v92, v15, v72
    v_fmac_f32 v93, v15, v73
    v_fmac_f32 v94, v15, v74
    v_fmac_f32 v95, v15, v75
    v_cvt_pk_bf16_f32 v92, v92, v93
    v_cvt_pk_bf16_f32 v93, v94, v95
    buffer_store_dwordx2 v[92:93], v12, s[16:19], s57 offen offset:32
    v_lshlrev_b32 v72, 16, v42
    v_lshlrev_b32 v76, 16, v58
    v_and_b32 v73, s60, v42
    v_and_b32 v77, s60, v58
    v_lshlrev_b32 v74, 16, v43
    v_lshlrev_b32 v78, 16, v59
    v_and_b32 v75, s60, v43
    v_and_b32 v79, s60, v59
    v_fma_f32 v72, v72, v76, -v100
    v_fma_f32 v73, v73, v77, -v101
    v_fma_f32 v74, v74, v78, -v102
    v_fma_f32 v75, v75, v79, -v103
    v_fmac_f32 v100, v15, v72
    v_fmac_f32 v101, v15, v73
    v_fmac_f32 v102, v15, v74
    v_fmac_f32 v103, v15, v75
    v_cvt_pk_bf16_f32 v100, v100, v101
    v_cvt_pk_bf16_f32 v101, v102, v103
    buffer_store_dwordx2 v[100:101], v12, s[16:19], s57 offen offset:64
    v_lshlrev_b32 v72, 16, v46
    v_lshlrev_b32 v76, 16, v62
    v_and_b32 v73, s60, v46
    v_and_b32 v77, s60, v62
    v_lshlrev_b32 v74, 16, v47
    v_lshlrev_b32 v78, 16, v63
    v_and_b32 v75, s60, v47
    v_and_b32 v79, s60, v63
    v_fma_f32 v72, v72, v76, -v108
    v_fma_f32 v73, v73, v77, -v109
    v_fma_f32 v74, v74, v78, -v110
    v_fma_f32 v75, v75, v79, -v111
    v_fmac_f32 v108, v15, v72
    v_fmac_f32 v109, v15, v73
    v_fmac_f32 v110, v15, v74
    v_fmac_f32 v111, v15, v75
    v_cvt_pk_bf16_f32 v108, v108, v109
    v_cvt_pk_bf16_f32 v109, v110, v111
    buffer_store_dwordx2 v[108:109], v12, s[16:19], s57 offen offset:96
outproj_kernel_end:
    s_endpgm
outproj_kernel_extras:
    s_mov_b32 s10, 0
    s_add_u32 m0, s49, 65536
    s_add_u32 s44, s59, 0
    buffer_load_dwordx4 v23, s[28:31], s44 offen lds
    s_add_u32 m0, s49, 66560
    s_add_u32 s44, s59, 16384
    buffer_load_dwordx4 v23, s[28:31], s44 offen lds
    s_add_u32 m0, s49, 67584
    s_add_u32 s44, s59, 32768
    buffer_load_dwordx4 v23, s[28:31], s44 offen lds
    s_add_u32 m0, s49, 68608
    s_add_u32 s44, s59, 49152
    buffer_load_dwordx4 v23, s[28:31], s44 offen lds
    buffer_load_dwordx2 v[32:33], v12, s[12:15], s56 offen offset:0
    buffer_load_dwordx2 v[36:37], v12, s[12:15], s56 offen offset:32
    buffer_load_dwordx2 v[40:41], v12, s[12:15], s56 offen offset:64
    buffer_load_dwordx2 v[44:45], v12, s[12:15], s56 offen offset:96
    buffer_load_dword v14, v22, s[52:55], s58 offen offset:0
    buffer_load_dwordx2 v[34:35], v12, s[12:15], s57 offen offset:0
    buffer_load_dwordx2 v[38:39], v12, s[12:15], s57 offen offset:32
    buffer_load_dwordx2 v[42:43], v12, s[12:15], s57 offen offset:64
    buffer_load_dwordx2 v[46:47], v12, s[12:15], s57 offen offset:96
    buffer_load_dword v15, v22, s[52:55], s58 offen offset:256
    s_add_u32 m0, s49, 49152
    s_branch outproj_kernel_extras_ret

.section .rodata,"a"
.p2align 6
.amdhsa_kernel kvproj_kernel
  .amdhsa_next_free_vgpr 512
  .amdhsa_next_free_sgpr 102
  .amdhsa_accum_offset 256
  .amdhsa_group_segment_fixed_size 0
  .amdhsa_kernarg_size 128
  .amdhsa_user_sgpr_count 2
  .amdhsa_user_sgpr_kernarg_segment_ptr 1
  .amdhsa_system_sgpr_workgroup_id_x 1
  .amdhsa_float_denorm_mode_32 3
.end_amdhsa_kernel

.p2align 6
.amdhsa_kernel attn_kernel
  .amdhsa_next_free_vgpr 512
  .amdhsa_next_free_sgpr 102
  .amdhsa_accum_offset 256
  .amdhsa_group_segment_fixed_size 0
  .amdhsa_kernarg_size 128
  .amdhsa_user_sgpr_count 2
  .amdhsa_user_sgpr_kernarg_segment_ptr 1
  .amdhsa_system_sgpr_workgroup_id_x 1
  .amdhsa_float_denorm_mode_32 3
.end_amdhsa_kernel

.p2align 6
.amdhsa_kernel conv_kernel
  .amdhsa_next_free_vgpr 256
  .amdhsa_next_free_sgpr 102
  .amdhsa_accum_offset 256
  .amdhsa_group_segment_fixed_size 0
  .amdhsa_kernarg_size 128
  .amdhsa_user_sgpr_count 2
  .amdhsa_user_sgpr_kernarg_segment_ptr 1
  .amdhsa_system_sgpr_workgroup_id_x 1
  .amdhsa_float_denorm_mode_32 3
.end_amdhsa_kernel

.p2align 6
.amdhsa_kernel outproj_kernel
  .amdhsa_next_free_vgpr 256
  .amdhsa_next_free_sgpr 102
  .amdhsa_accum_offset 128
  .amdhsa_group_segment_fixed_size 0
  .amdhsa_kernarg_size 128
  .amdhsa_user_sgpr_count 2
  .amdhsa_user_sgpr_kernarg_segment_ptr 1
  .amdhsa_system_sgpr_workgroup_id_x 1
  .amdhsa_float_denorm_mode_32 3
.end_amdhsa_kernel
```

```asm
; @launch grid=(256,1,1) block=(256,1,1) lds=163840
.amdgcn_target "amdgcn-amd-amdhsa--gfx950"
.text
.globl gated_mix__ssm_conv_h3__compressed_kv_cla__prompt_kernel
.p2align 8
.type gated_mix__ssm_conv_h3__compressed_kv_cla__prompt_kernel,@function
gated_mix__ssm_conv_h3__compressed_kv_cla__prompt_kernel:
    s_cmp_ge_u32 s2, 256
    s_cbranch_scc1 gated_mix__ssm_conv_h3__compressed_kv_cla__prompt_kernel_end
    s_load_dwordx16 s[64:79], s[0:1], 0
    s_load_dwordx16 s[80:95], s[0:1], 64
    s_getpc_b64 s[4:5]
gated_mix__ssm_conv_h3__compressed_kv_cla__prompt_kernel_pc:
    v_lshlrev_b32 v242, 7, v0
    v_add_u32 v243, 0x8000, v242
    v_min_u32 v243, gated_mix__ssm_conv_h3__compressed_kv_cla__prompt_kernel_hotend-gated_mix__ssm_conv_h3__compressed_kv_cla__prompt_kernel_pc, v243
    global_load_dword v255, v242, s[4:5]
    global_load_dword v255, v243, s[4:5]
    v_add_u32 v244, 0x10000, v242
    v_min_u32 v244, gated_mix__ssm_conv_h3__compressed_kv_cla__prompt_kernel_hotend-gated_mix__ssm_conv_h3__compressed_kv_cla__prompt_kernel_pc, v244
    global_load_dword v255, v244, s[4:5]
    v_lshrrev_b32 v242, 6, v0
    v_and_b32 v240, 63, v0
    v_readfirstlane_b32 s32, v242
    v_lshlrev_b32 v16, 4, v240
    s_and_b32 s36, s2, 7
    s_lshl_b32 s36, s36, 2
    s_bfe_u32 s33, s2, 0x20003
    s_add_u32 s33, s33, s36
    s_lshr_b32 s34, s2, 5
    v_lshrrev_b32 v242, 3, v240
    v_and_b32 v247, 7, v240
    v_lshrrev_b32 v245, 4, v240
    v_xor_b32 v243, v245, v247
    v_lshlrev_b32 v243, 4, v243
    v_xor_b32 v244, 64, v243
    v_lshl_add_u32 v2, v242, 10, v243
    v_lshl_add_u32 v3, v242, 10, v244
    v_add_u32 v3, 7168, v3
    v_add_u32 v4, 14336, v2
    v_add_u32 v5, 14336, v3
    v_and_b32 v246, 15, v240
    v_lshlrev_b32 v247, 1, v245
    v_xor_b32 v247, v247, v246
    v_lshlrev_b32 v247, 4, v247
    v_lshl_add_u32 v21, v245, 13, v247
    s_and_b32 s36, s32, 1
    s_lshl_b32 s36, s36, 7
    v_xor_b32 v6, s36, v21
    v_add_u32 v7, 31744, v6
    s_lshl_b32 s38, s34, 18
    s_lshl_b32 s36, s32, 16
    s_add_u32 s38, s38, s36
    s_lshl_b32 s39, s33, 8
    s_add_u32 s39, s39, s36
    s_lshl_b32 s42, s32, 13
    s_lshl_b32 s43, s32, 12
    s_add_u32 s43, s43, 98304
    s_waitcnt lgkmcnt(0)
    s_mov_b32 s4, s78
    s_mov_b32 s5, s79
    s_mov_b32 s6, 2097152
    s_mov_b32 s7, 0x00020000
    s_mov_b32 s8, s82
    s_mov_b32 s9, s83
    s_mov_b32 s10, 4194304
    s_mov_b32 s11, 0x00020000
    s_mov_b32 s12, s84
    s_mov_b32 s13, s85
    s_mov_b32 s14, 4194304
    s_mov_b32 s15, 0x00020000
    s_and_b32 s35, s2, 7
    s_lshl_b32 s58, s35, 19
    s_lshl_b32 s35, s35, 7
    s_add_u32 s59, s38, 32768
    s_add_u32 s36, s35, 0
    s_and_b32 s36, s36, 1023
    s_add_u32 s36, s36, s38
    s_add_u32 m0, s42, 0
    s_nop 0
    buffer_load_dwordx4 v2, s[4:7], s36 offen offset:0 lds
    buffer_load_dwordx4 v3, s[4:7], s36 offen offset:1024 lds
    buffer_load_dwordx4 v4, s[4:7], s36 offen offset:2048 lds
    buffer_load_dwordx4 v5, s[4:7], s36 offen offset:3072 lds
    s_add_u32 s36, s35, 0
    s_and_b32 s36, s36, 1023
    s_add_u32 s36, s36, s59
    s_add_u32 m0, s42, 4096
    s_nop 0
    buffer_load_dwordx4 v2, s[4:7], s36 offen offset:0 lds
    buffer_load_dwordx4 v3, s[4:7], s36 offen offset:1024 lds
    buffer_load_dwordx4 v4, s[4:7], s36 offen offset:2048 lds
    buffer_load_dwordx4 v5, s[4:7], s36 offen offset:3072 lds
    s_add_u32 s37, s58, 0
    s_and_b32 s37, s37, 4194303
    s_add_u32 s37, s37, s39
    s_add_u32 m0, s43, 0
    s_nop 0
    buffer_load_dwordx4 v6, s[8:11], s37 offen offset:0 nt lds
    buffer_load_dwordx4 v7, s[8:11], s37 offen offset:1024 nt lds
    s_add_u32 m0, s43, 2048
    s_nop 0
    buffer_load_dwordx4 v6, s[12:15], s37 offen offset:0 nt lds
    buffer_load_dwordx4 v7, s[12:15], s37 offen offset:1024 nt lds
    s_add_u32 s37, s58, 262144
    s_and_b32 s37, s37, 4194303
    s_add_u32 s37, s37, s39
    s_add_u32 m0, s43, 16384
    s_nop 0
    buffer_load_dwordx4 v6, s[8:11], s37 offen offset:0 nt lds
    buffer_load_dwordx4 v7, s[8:11], s37 offen offset:1024 nt lds
    s_add_u32 m0, s43, 18432
    s_nop 0
    buffer_load_dwordx4 v6, s[12:15], s37 offen offset:0 nt lds
    buffer_load_dwordx4 v7, s[12:15], s37 offen offset:1024 nt lds
    s_add_u32 s36, s35, 128
    s_and_b32 s36, s36, 1023
    s_add_u32 s36, s36, s38
    s_add_u32 m0, s42, 32768
    s_nop 0
    buffer_load_dwordx4 v2, s[4:7], s36 offen offset:0 lds
    buffer_load_dwordx4 v3, s[4:7], s36 offen offset:1024 lds
    buffer_load_dwordx4 v4, s[4:7], s36 offen offset:2048 lds
    buffer_load_dwordx4 v5, s[4:7], s36 offen offset:3072 lds
    s_add_u32 s36, s35, 128
    s_and_b32 s36, s36, 1023
    s_add_u32 s36, s36, s59
    s_add_u32 m0, s42, 36864
    s_nop 0
    buffer_load_dwordx4 v2, s[4:7], s36 offen offset:0 lds
    buffer_load_dwordx4 v3, s[4:7], s36 offen offset:1024 lds
    buffer_load_dwordx4 v4, s[4:7], s36 offen offset:2048 lds
    buffer_load_dwordx4 v5, s[4:7], s36 offen offset:3072 lds
    s_add_u32 s37, s58, 524288
    s_and_b32 s37, s37, 4194303
    s_add_u32 s37, s37, s39
    s_add_u32 m0, s43, 32768
    s_nop 0
    buffer_load_dwordx4 v6, s[8:11], s37 offen offset:0 nt lds
    buffer_load_dwordx4 v7, s[8:11], s37 offen offset:1024 nt lds
    s_add_u32 m0, s43, 34816
    s_nop 0
    buffer_load_dwordx4 v6, s[12:15], s37 offen offset:0 nt lds
    buffer_load_dwordx4 v7, s[12:15], s37 offen offset:1024 nt lds
    s_add_u32 s37, s58, 786432
    s_and_b32 s37, s37, 4194303
    s_add_u32 s37, s37, s39
    s_add_u32 m0, s43, 49152
    s_nop 0
    buffer_load_dwordx4 v6, s[8:11], s37 offen offset:0 nt lds
    buffer_load_dwordx4 v7, s[8:11], s37 offen offset:1024 nt lds
    s_add_u32 m0, s43, 51200
    s_nop 0
    buffer_load_dwordx4 v6, s[12:15], s37 offen offset:0 nt lds
    buffer_load_dwordx4 v7, s[12:15], s37 offen offset:1024 nt lds
    s_add_u32 s36, s35, 256
    s_and_b32 s36, s36, 1023
    s_add_u32 s36, s36, s38
    s_add_u32 m0, s42, 65536
    s_nop 0
    buffer_load_dwordx4 v2, s[4:7], s36 offen offset:0 lds
    buffer_load_dwordx4 v3, s[4:7], s36 offen offset:1024 lds
    buffer_load_dwordx4 v4, s[4:7], s36 offen offset:2048 lds
    buffer_load_dwordx4 v5, s[4:7], s36 offen offset:3072 lds
    v_lshrrev_b32 v247, 1, v246
    v_xor_b32 v247, v245, v247
    v_lshlrev_b32 v247, 4, v247
    v_lshl_add_u32 v247, v246, 7, v247
    s_lshr_b32 s36, s32, 1
    s_lshl_b32 s36, s36, 14
    v_add_u32 v8, s36, v247
    v_xor_b32 v9, 64, v8
    v_add_u32 v14, 65536, v8
    v_add_u32 v15, 65536, v9
    v_add_u32 v23, s42, v247
    v_xor_b32 v24, 64, v23
    v_add_u32 v25, 65536, v23
    v_add_u32 v26, 65536, v24
    v_lshrrev_b32 v247, 2, v246
    v_and_b32 v248, 3, v246
    v_lshlrev_b32 v248, 3, v248
    v_lshl_add_u32 v248, v247, 8, v248
    v_add_u32 v248, 98304, v248
    v_lshl_add_u32 v249, v245, 12, v248
    v_mul_u32_u24 v250, 2176, v245
    v_add_u32 v250, v250, v248
    v_xor_b32 v248, s32, v245
    v_and_b32 v248, 1, v248
    v_lshl_add_u32 v249, v248, 7, v249
    v_xor_b32 v248, 0, v247
    v_lshl_add_u32 v10, v248, 5, v249
    v_lshl_add_u32 v27, v248, 5, v250
    v_xor_b32 v248, 1, v247
    v_lshl_add_u32 v11, v248, 5, v249
    v_lshl_add_u32 v28, v248, 5, v250
    v_xor_b32 v248, 2, v247
    v_lshl_add_u32 v12, v248, 5, v249
    v_lshl_add_u32 v29, v248, 5, v250
    v_xor_b32 v248, 3, v247
    v_lshl_add_u32 v13, v248, 5, v249
    v_lshl_add_u32 v30, v248, 5, v250
    v_lshl_add_u32 v17, v242, 13, v243
    v_lshl_add_u32 v18, v242, 13, v244
    v_add_u32 v18, 64512, v18
    v_add_u32 v19, 129024, v17
    v_add_u32 v20, 129024, v18
    v_add_u32 v22, 31744, v21
    s_lshl_b32 s54, s2, 2
    s_add_u32 s54, s54, s32
    v_lshlrev_b32 v254, 7, v240
    v_mov_b32 v247, 0x80000000
    v_cmp_gt_u32 vcc, 8, v240
    s_lshl_b32 s46, s54, 10
    s_nop 0
    v_cndmask_b32 v254, v247, v254, vcc
    s_mov_b32 s20, s80
    s_mov_b32 s21, s81
    s_mov_b32 s22, 8388608
    s_mov_b32 s23, 0x00020000
    s_mov_b32 s24, s64
    s_mov_b32 s25, s65
    s_mov_b32 s26, 4194304
    s_mov_b32 s27, 0x00020000
    s_add_u32 s28, s94, 60817408
    s_addc_u32 s29, s95, 0
    s_mov_b32 s30, 16384
    s_mov_b32 s31, 0x00020000
    s_mov_b32 s49, s39
    s_mul_i32 s50, s32, 2176
    s_add_u32 s50, s50, 98304
    s_lshl_b32 s44, s34, 7
    s_add_u32 s44, s44, s32
    s_lshl_b32 s44, s44, 11
    s_lshl_b32 s37, s34, 1
    s_sub_u32 s45, 15, s37
    s_lshl_b32 s45, s45, 18
    s_add_u32 s45, s45, s44
    s_lshl_b32 s57, s54, 2
    s_add_u32 s57, s57, 8192
    s_lshl_b32 s36, s32, 5
    s_add_u32 s36, s36, s33
    s_lshl_b32 s36, s36, 2
    s_lshl_b32 s37, s34, 9
    s_add_u32 s55, s36, s37
    s_sub_u32 s56, 7680, s37
    s_add_u32 s56, s56, s36
    s_lshl_b32 s36, s34, 3
    s_add_u32 s36, s36, 0
    s_add_u32 s36, s36, s32
    s_lshl_b32 s36, s36, 5
    s_add_u32 s36, s36, s33
    s_lshl_b32 s60, s36, 12
    s_lshl_b32 s36, s34, 3
    s_add_u32 s36, s36, 4
    s_add_u32 s36, s36, s32
    s_lshl_b32 s36, s36, 5
    s_add_u32 s36, s36, s33
    s_lshl_b32 s61, s36, 12
    s_lshl_b32 s36, s34, 3
    s_sub_u32 s36, 120, s36
    s_add_u32 s36, s36, s32
    s_lshl_b32 s36, s36, 5
    s_add_u32 s36, s36, s33
    s_lshl_b32 s62, s36, 12
    s_lshl_b32 s36, s34, 3
    s_sub_u32 s36, 124, s36
    s_add_u32 s36, s36, s32
    s_lshl_b32 s36, s36, 5
    s_add_u32 s36, s36, s33
    s_lshl_b32 s63, s36, 12
    s_lshr_b32 s36, s2, 4
    s_lshl_b32 s36, s36, 4
    s_lshl_b32 s37, s32, 2
    s_add_u32 s36, s36, s37
    s_and_b32 s37, s2, 15
    s_lshl_b32 s37, s37, 6
    v_add_u32 v247, s36, v245
    v_lshl_add_u32 v248, v246, 2, s37
    v_lshlrev_b32 v0, 14, v247
    v_lshl_add_u32 v0, v248, 1, v0
    v_subrev_u32 v1, 6144, v0
    v_lshlrev_b32 v232, 3, v248
    v_lshlrev_b32 v233, 4, v240
    v_mul_u32_u24 v234, 4608, v248
    v_lshlrev_b32 v247, 4, v247
    v_sub_u32 v247, 4080, v247
    v_add_u32 v234, v234, v247
    v_add_u32 v235, s37, v240
    v_mul_u32_u24 v235, 4608, v235
    s_movk_i32 s47, 4096
    s_movk_i32 s48, 8192
    s_movk_i32 s51, 12288
    s_mov_b32 s52, 0xffff0000
    s_lshr_b32 s37, s2, 4
    s_or_b32 s37, s37, s32
    s_cmp_eq_u32 s37, 0
    s_cselect_b32 s53, s47, 0x80000000
    s_lshl_b32 s36, s33, 13
    s_add_u32 s40, s44, s36
    s_add_u32 s41, s45, s36
    s_waitcnt vmcnt(24)
    s_barrier
    ds_read_b64_tr_b16 v[64:65], v10 offset:0
    ds_read_b64_tr_b16 v[66:67], v10 offset:1024
    ds_read_b64_tr_b16 v[68:69], v11 offset:0
    ds_read_b64_tr_b16 v[70:71], v11 offset:1024
    ds_read_b128 v[32:35], v8 offset:0
    ds_read_b64_tr_b16 v[72:73], v12 offset:0
    ds_read_b64_tr_b16 v[74:75], v12 offset:1024
    ds_read_b128 v[36:39], v8 offset:2048
    ds_read_b64_tr_b16 v[76:77], v13 offset:0
    ds_read_b64_tr_b16 v[78:79], v13 offset:1024
    ds_read_b128 v[40:43], v8 offset:4096
    ds_read_b64_tr_b16 v[80:81], v10 offset:2048
    ds_read_b64_tr_b16 v[82:83], v10 offset:3072
    ds_read_b128 v[44:47], v8 offset:6144
    ds_read_b64_tr_b16 v[84:85], v11 offset:2048
    ds_read_b64_tr_b16 v[86:87], v11 offset:3072
    ds_read_b128 v[48:51], v8 offset:8192
    ds_read_b64_tr_b16 v[88:89], v12 offset:2048
    ds_read_b64_tr_b16 v[90:91], v12 offset:3072
    ds_read_b128 v[52:55], v8 offset:10240
    ds_read_b64_tr_b16 v[92:93], v13 offset:2048
    ds_read_b64_tr_b16 v[94:95], v13 offset:3072
    ds_read_b128 v[56:59], v8 offset:12288
    ds_read_b128 v[60:63], v8 offset:14336
    s_waitcnt vmcnt(20) lgkmcnt(0)
    s_barrier
    v_mfma_f32_16x16x32_bf16 a[0:3], v[64:67], v[32:35], 0
    ds_read_b64_tr_b16 v[128:129], v10 offset:16384
    v_mfma_f32_16x16x32_bf16 a[4:7], v[64:67], v[36:39], 0
    s_add_u32 s36, s35, 256
    s_and_b32 s36, s36, 1023
    s_add_u32 s36, s36, s59
    v_mfma_f32_16x16x32_bf16 a[8:11], v[64:67], v[40:43], 0
    s_add_u32 m0, s42, 69632
    ds_read_b64_tr_b16 v[130:131], v10 offset:17408
    v_mfma_f32_16x16x32_bf16 a[12:15], v[64:67], v[44:47], 0
    buffer_load_dwordx4 v2, s[4:7], s36 offen offset:0 lds
    v_mfma_f32_16x16x32_bf16 a[16:19], v[64:67], v[48:51], 0
    ds_read_b64_tr_b16 v[132:133], v11 offset:16384
    v_mfma_f32_16x16x32_bf16 a[20:23], v[64:67], v[52:55], 0
    v_mfma_f32_16x16x32_bf16 a[24:27], v[64:67], v[56:59], 0
    ds_read_b64_tr_b16 v[134:135], v11 offset:17408
    v_mfma_f32_16x16x32_bf16 a[28:31], v[64:67], v[60:63], 0
    buffer_load_dwordx4 v3, s[4:7], s36 offen offset:1024 lds
    v_mfma_f32_16x16x32_bf16 a[32:35], v[68:71], v[32:35], 0
    ds_read_b128 v[96:99], v9 offset:0
    v_mfma_f32_16x16x32_bf16 a[36:39], v[68:71], v[36:39], 0
    v_mfma_f32_16x16x32_bf16 a[40:43], v[68:71], v[40:43], 0
    ds_read_b64_tr_b16 v[136:137], v12 offset:16384
    v_mfma_f32_16x16x32_bf16 a[44:47], v[68:71], v[44:47], 0
    buffer_load_dwordx4 v4, s[4:7], s36 offen offset:2048 lds
    v_mfma_f32_16x16x32_bf16 a[48:51], v[68:71], v[48:51], 0
    ds_read_b64_tr_b16 v[138:139], v12 offset:17408
    v_mfma_f32_16x16x32_bf16 a[52:55], v[68:71], v[52:55], 0
    v_mfma_f32_16x16x32_bf16 a[56:59], v[68:71], v[56:59], 0
    ds_read_b128 v[100:103], v9 offset:2048
    v_mfma_f32_16x16x32_bf16 a[60:63], v[68:71], v[60:63], 0
    buffer_load_dwordx4 v5, s[4:7], s36 offen offset:3072 lds
    v_mfma_f32_16x16x32_bf16 a[64:67], v[72:75], v[32:35], 0
    ds_read_b64_tr_b16 v[140:141], v13 offset:16384
    v_mfma_f32_16x16x32_bf16 a[68:71], v[72:75], v[36:39], 0
    s_add_u32 s37, s58, 1048576
    s_and_b32 s37, s37, 4194303
    s_add_u32 s37, s37, s39
    v_mfma_f32_16x16x32_bf16 a[72:75], v[72:75], v[40:43], 0
    s_add_u32 m0, s43, 0
    ds_read_b64_tr_b16 v[142:143], v13 offset:17408
    v_mfma_f32_16x16x32_bf16 a[76:79], v[72:75], v[44:47], 0
    buffer_load_dwordx4 v6, s[8:11], s37 offen offset:0 nt lds
    v_mfma_f32_16x16x32_bf16 a[80:83], v[72:75], v[48:51], 0
    ds_read_b128 v[104:107], v9 offset:4096
    v_mfma_f32_16x16x32_bf16 a[84:87], v[72:75], v[52:55], 0
    v_mfma_f32_16x16x32_bf16 a[88:91], v[72:75], v[56:59], 0
    ds_read_b64_tr_b16 v[144:145], v10 offset:18432
    v_mfma_f32_16x16x32_bf16 a[92:95], v[72:75], v[60:63], 0
    buffer_load_dwordx4 v7, s[8:11], s37 offen offset:1024 nt lds
    v_mfma_f32_16x16x32_bf16 a[96:99], v[76:79], v[32:35], 0
    ds_read_b64_tr_b16 v[146:147], v10 offset:19456
    v_mfma_f32_16x16x32_bf16 a[100:103], v[76:79], v[36:39], 0
    v_mfma_f32_16x16x32_bf16 a[104:107], v[76:79], v[40:43], 0
    s_add_u32 m0, s43, 2048
    ds_read_b128 v[108:111], v9 offset:6144
    v_mfma_f32_16x16x32_bf16 a[108:111], v[76:79], v[44:47], 0
    buffer_load_dwordx4 v6, s[12:15], s37 offen offset:0 nt lds
    v_mfma_f32_16x16x32_bf16 a[112:115], v[76:79], v[48:51], 0
    s_mov_b32 s16, s92
    ds_read_b64_tr_b16 v[148:149], v11 offset:18432
    v_mfma_f32_16x16x32_bf16 a[116:119], v[76:79], v[52:55], 0
    s_mov_b32 s17, s93
    v_mfma_f32_16x16x32_bf16 a[120:123], v[76:79], v[56:59], 0
    s_mov_b32 s18, 256
    ds_read_b64_tr_b16 v[150:151], v11 offset:19456
    v_mfma_f32_16x16x32_bf16 a[124:127], v[76:79], v[60:63], 0
    buffer_load_dwordx4 v7, s[12:15], s37 offen offset:1024 nt lds
    v_mfma_f32_16x16x32_bf16 a[128:131], v[32:35], v[80:83], 0
    s_mov_b32 s19, 0x00020000
    ds_read_b128 v[112:115], v9 offset:8192
    v_mfma_f32_16x16x32_bf16 a[132:135], v[36:39], v[80:83], 0
    s_getreg_b32 s54, hwreg(HW_REG_XCC_ID, 0, 3)
    v_mfma_f32_16x16x32_bf16 a[136:139], v[40:43], v[80:83], 0
    s_lshl_b32 s54, s54, 2
    ds_read_b64_tr_b16 v[152:153], v12 offset:18432
    v_mfma_f32_16x16x32_bf16 a[140:143], v[44:47], v[80:83], 0
    v_mfma_f32_16x16x32_bf16 a[144:147], v[48:51], v[80:83], 0
    s_lshl_b32 s54, 1, s54
    ds_read_b64_tr_b16 v[154:155], v12 offset:19456
    v_mfma_f32_16x16x32_bf16 a[148:151], v[52:55], v[80:83], 0
    v_or_b32 v236, s32, v16
    v_mov_b32 v237, 0x80000000
    v_mfma_f32_16x16x32_bf16 a[152:155], v[56:59], v[80:83], 0
    ds_read_b128 v[116:119], v9 offset:10240
    v_cmp_eq_u32 vcc, 0, v236
    v_mfma_f32_16x16x32_bf16 a[156:159], v[60:63], v[80:83], 0
    v_mfma_f32_16x16x32_bf16 a[160:163], v[32:35], v[84:87], 0
    ds_read_b64_tr_b16 v[156:157], v13 offset:18432
    v_mov_b32 v238, s54
    v_mfma_f32_16x16x32_bf16 a[164:167], v[36:39], v[84:87], 0
    s_lshl_b32 s54, s33, 3
    v_mfma_f32_16x16x32_bf16 a[168:171], v[40:43], v[84:87], 0
    ds_read_b64_tr_b16 v[158:159], v13 offset:19456
    v_mfma_f32_16x16x32_bf16 a[172:175], v[44:47], v[84:87], 0
    v_mfma_f32_16x16x32_bf16 a[176:179], v[48:51], v[84:87], 0
    ds_read_b128 v[120:123], v9 offset:12288
    v_cndmask_b32 v236, v237, v236, vcc
    v_mfma_f32_16x16x32_bf16 a[180:183], v[52:55], v[84:87], 0
    v_mfma_f32_16x16x32_bf16 a[184:187], v[56:59], v[84:87], 0
    ds_read_b128 v[124:127], v9 offset:14336
    v_mfma_f32_16x16x32_bf16 a[188:191], v[60:63], v[84:87], 0
    buffer_atomic_add v238, v236, s[16:19], s54 offen offset:4 sc1
    v_mfma_f32_16x16x32_bf16 a[192:195], v[32:35], v[88:91], 0
    v_mov_b32 v236, 0
    v_mfma_f32_16x16x32_bf16 a[196:199], v[36:39], v[88:91], 0
    s_mov_b32 s16, s88
    v_mfma_f32_16x16x32_bf16 a[200:203], v[40:43], v[88:91], 0
    s_mov_b32 s17, s89
    v_mfma_f32_16x16x32_bf16 a[204:207], v[44:47], v[88:91], 0
    v_mfma_f32_16x16x32_bf16 a[208:211], v[48:51], v[88:91], 0
    s_mov_b32 s18, 2048
    v_mfma_f32_16x16x32_bf16 a[212:215], v[52:55], v[88:91], 0
    v_mfma_f32_16x16x32_bf16 a[216:219], v[56:59], v[88:91], 0
    v_mfma_f32_16x16x32_bf16 a[220:223], v[60:63], v[88:91], 0
    buffer_load_dwordx4 v[222:225], v233, s[16:19], 0 offen offset:0
    v_mfma_f32_16x16x32_bf16 a[224:227], v[32:35], v[92:95], 0
    v_mfma_f32_16x16x32_bf16 a[228:231], v[36:39], v[92:95], 0
    v_mfma_f32_16x16x32_bf16 a[232:235], v[40:43], v[92:95], 0
    v_mfma_f32_16x16x32_bf16 a[236:239], v[44:47], v[92:95], 0
    buffer_load_dwordx4 v[226:229], v233, s[16:19], 0 offen offset:1024
    v_mfma_f32_16x16x32_bf16 a[240:243], v[48:51], v[92:95], 0
    v_mfma_f32_16x16x32_bf16 a[244:247], v[52:55], v[92:95], 0
    v_mfma_f32_16x16x32_bf16 a[248:251], v[56:59], v[92:95], 0
    v_mfma_f32_16x16x32_bf16 a[252:255], v[60:63], v[92:95], 0
    s_waitcnt vmcnt(19) lgkmcnt(0)
    s_barrier
    v_mfma_f32_16x16x32_bf16 a[0:3], v[128:131], v[96:99], a[0:3]
    ds_read_b64_tr_b16 v[64:65], v10 offset:32768
    v_mfma_f32_16x16x32_bf16 a[4:7], v[128:131], v[100:103], a[4:7]
    s_add_u32 s36, s35, 384
    s_and_b32 s36, s36, 1023
    s_add_u32 s36, s36, s38
    v_mfma_f32_16x16x32_bf16 a[8:11], v[128:131], v[104:107], a[8:11]
    s_add_u32 m0, s42, 0
    ds_read_b64_tr_b16 v[66:67], v10 offset:33792
    v_mfma_f32_16x16x32_bf16 a[12:15], v[128:131], v[108:111], a[12:15]
    buffer_load_dwordx4 v2, s[4:7], s36 offen offset:0 lds
    v_mfma_f32_16x16x32_bf16 a[16:19], v[128:131], v[112:115], a[16:19]
    ds_read_b64_tr_b16 v[68:69], v11 offset:32768
    v_mfma_f32_16x16x32_bf16 a[20:23], v[128:131], v[116:119], a[20:23]
    v_mfma_f32_16x16x32_bf16 a[24:27], v[128:131], v[120:123], a[24:27]
    ds_read_b64_tr_b16 v[70:71], v11 offset:33792
    v_mfma_f32_16x16x32_bf16 a[28:31], v[128:131], v[124:127], a[28:31]
    buffer_load_dwordx4 v3, s[4:7], s36 offen offset:1024 lds
    v_mfma_f32_16x16x32_bf16 a[32:35], v[132:135], v[96:99], a[32:35]
    ds_read_b128 v[32:35], v8 offset:32768
    v_mfma_f32_16x16x32_bf16 a[36:39], v[132:135], v[100:103], a[36:39]
    v_mfma_f32_16x16x32_bf16 a[40:43], v[132:135], v[104:107], a[40:43]
    ds_read_b64_tr_b16 v[72:73], v12 offset:32768
    v_mfma_f32_16x16x32_bf16 a[44:47], v[132:135], v[108:111], a[44:47]
    buffer_load_dwordx4 v4, s[4:7], s36 offen offset:2048 lds
    v_mfma_f32_16x16x32_bf16 a[48:51], v[132:135], v[112:115], a[48:51]
    ds_read_b64_tr_b16 v[74:75], v12 offset:33792
    v_mfma_f32_16x16x32_bf16 a[52:55], v[132:135], v[116:119], a[52:55]
    v_mfma_f32_16x16x32_bf16 a[56:59], v[132:135], v[120:123], a[56:59]
    ds_read_b128 v[36:39], v8 offset:34816
    v_mfma_f32_16x16x32_bf16 a[60:63], v[132:135], v[124:127], a[60:63]
    buffer_load_dwordx4 v5, s[4:7], s36 offen offset:3072 lds
    v_mfma_f32_16x16x32_bf16 a[64:67], v[136:139], v[96:99], a[64:67]
    ds_read_b64_tr_b16 v[76:77], v13 offset:32768
    v_mfma_f32_16x16x32_bf16 a[68:71], v[136:139], v[100:103], a[68:71]
    s_add_u32 s37, s58, 1310720
    s_and_b32 s37, s37, 4194303
    s_add_u32 s37, s37, s39
    v_mfma_f32_16x16x32_bf16 a[72:75], v[136:139], v[104:107], a[72:75]
    s_add_u32 m0, s43, 16384
    ds_read_b64_tr_b16 v[78:79], v13 offset:33792
    v_mfma_f32_16x16x32_bf16 a[76:79], v[136:139], v[108:111], a[76:79]
    buffer_load_dwordx4 v6, s[8:11], s37 offen offset:0 nt lds
    v_mfma_f32_16x16x32_bf16 a[80:83], v[136:139], v[112:115], a[80:83]
    ds_read_b128 v[40:43], v8 offset:36864
    v_mfma_f32_16x16x32_bf16 a[84:87], v[136:139], v[116:119], a[84:87]
    v_mfma_f32_16x16x32_bf16 a[88:91], v[136:139], v[120:123], a[88:91]
    ds_read_b64_tr_b16 v[80:81], v10 offset:34816
    v_mfma_f32_16x16x32_bf16 a[92:95], v[136:139], v[124:127], a[92:95]
    buffer_load_dwordx4 v7, s[8:11], s37 offen offset:1024 nt lds
    v_mfma_f32_16x16x32_bf16 a[96:99], v[140:143], v[96:99], a[96:99]
    ds_read_b64_tr_b16 v[82:83], v10 offset:35840
    v_mfma_f32_16x16x32_bf16 a[100:103], v[140:143], v[100:103], a[100:103]
    v_mfma_f32_16x16x32_bf16 a[104:107], v[140:143], v[104:107], a[104:107]
    s_add_u32 m0, s43, 18432
    ds_read_b128 v[44:47], v8 offset:38912
    v_mfma_f32_16x16x32_bf16 a[108:111], v[140:143], v[108:111], a[108:111]
    buffer_load_dwordx4 v6, s[12:15], s37 offen offset:0 nt lds
    v_mfma_f32_16x16x32_bf16 a[112:115], v[140:143], v[112:115], a[112:115]
    ds_read_b64_tr_b16 v[84:85], v11 offset:34816
    v_mfma_f32_16x16x32_bf16 a[116:119], v[140:143], v[116:119], a[116:119]
    v_mfma_f32_16x16x32_bf16 a[120:123], v[140:143], v[120:123], a[120:123]
    ds_read_b64_tr_b16 v[86:87], v11 offset:35840
    v_mfma_f32_16x16x32_bf16 a[124:127], v[140:143], v[124:127], a[124:127]
    buffer_load_dwordx4 v7, s[12:15], s37 offen offset:1024 nt lds
    v_mfma_f32_16x16x32_bf16 a[128:131], v[96:99], v[144:147], a[128:131]
    ds_read_b128 v[48:51], v8 offset:40960
    v_mfma_f32_16x16x32_bf16 a[132:135], v[100:103], v[144:147], a[132:135]
    v_mfma_f32_16x16x32_bf16 a[136:139], v[104:107], v[144:147], a[136:139]
    ds_read_b64_tr_b16 v[88:89], v12 offset:34816
    v_mfma_f32_16x16x32_bf16 a[140:143], v[108:111], v[144:147], a[140:143]
    v_mfma_f32_16x16x32_bf16 a[144:147], v[112:115], v[144:147], a[144:147]
    ds_read_b64_tr_b16 v[90:91], v12 offset:35840
    v_mfma_f32_16x16x32_bf16 a[148:151], v[116:119], v[144:147], a[148:151]
    v_mfma_f32_16x16x32_bf16 a[152:155], v[120:123], v[144:147], a[152:155]
    ds_read_b128 v[52:55], v8 offset:43008
    v_mfma_f32_16x16x32_bf16 a[156:159], v[124:127], v[144:147], a[156:159]
    v_mfma_f32_16x16x32_bf16 a[160:163], v[96:99], v[148:151], a[160:163]
    s_mov_b32 s16, s70
    ds_read_b64_tr_b16 v[92:93], v13 offset:34816
    v_mfma_f32_16x16x32_bf16 a[164:167], v[100:103], v[148:151], a[164:167]
    s_mov_b32 s17, s71
    v_mfma_f32_16x16x32_bf16 a[168:171], v[104:107], v[148:151], a[168:171]
    s_mov_b32 s18, 8192
    ds_read_b64_tr_b16 v[94:95], v13 offset:35840
    v_mfma_f32_16x16x32_bf16 a[172:175], v[108:111], v[148:151], a[172:175]
    buffer_load_dwordx4 v[198:201], v232, s[16:19], 0 offen offset:0
    v_mfma_f32_16x16x32_bf16 a[176:179], v[112:115], v[148:151], a[176:179]
    ds_read_b128 v[56:59], v8 offset:45056
    v_mfma_f32_16x16x32_bf16 a[180:183], v[116:119], v[148:151], a[180:183]
    v_mfma_f32_16x16x32_bf16 a[184:187], v[120:123], v[148:151], a[184:187]
    ds_read_b128 v[60:63], v8 offset:47104
    v_mfma_f32_16x16x32_bf16 a[188:191], v[124:127], v[148:151], a[188:191]
    buffer_load_dwordx4 v[202:205], v232, s[16:19], 0 offen offset:16
    v_mfma_f32_16x16x32_bf16 a[192:195], v[96:99], v[152:155], a[192:195]
    v_mfma_f32_16x16x32_bf16 a[196:199], v[100:103], v[152:155], a[196:199]
    v_mfma_f32_16x16x32_bf16 a[200:203], v[104:107], v[152:155], a[200:203]
    v_mfma_f32_16x16x32_bf16 a[204:207], v[108:111], v[152:155], a[204:207]
    v_mfma_f32_16x16x32_bf16 a[208:211], v[112:115], v[152:155], a[208:211]
    v_mfma_f32_16x16x32_bf16 a[212:215], v[116:119], v[152:155], a[212:215]
    v_mfma_f32_16x16x32_bf16 a[216:219], v[120:123], v[152:155], a[216:219]
    v_mfma_f32_16x16x32_bf16 a[220:223], v[124:127], v[152:155], a[220:223]
    v_mfma_f32_16x16x32_bf16 a[224:227], v[96:99], v[156:159], a[224:227]
    v_mfma_f32_16x16x32_bf16 a[228:231], v[100:103], v[156:159], a[228:231]
    v_mfma_f32_16x16x32_bf16 a[232:235], v[104:107], v[156:159], a[232:235]
    v_mfma_f32_16x16x32_bf16 a[236:239], v[108:111], v[156:159], a[236:239]
    v_mfma_f32_16x16x32_bf16 a[240:243], v[112:115], v[156:159], a[240:243]
    v_mfma_f32_16x16x32_bf16 a[244:247], v[116:119], v[156:159], a[244:247]
    v_mfma_f32_16x16x32_bf16 a[248:251], v[120:123], v[156:159], a[248:251]
    v_mfma_f32_16x16x32_bf16 a[252:255], v[124:127], v[156:159], a[252:255]
    s_waitcnt vmcnt(25) lgkmcnt(0)
    s_barrier
    v_mfma_f32_16x16x32_bf16 a[0:3], v[64:67], v[32:35], a[0:3]
    ds_read_b64_tr_b16 v[128:129], v10 offset:49152
    v_mfma_f32_16x16x32_bf16 a[4:7], v[64:67], v[36:39], a[4:7]
    s_add_u32 s36, s35, 384
    s_and_b32 s36, s36, 1023
    s_add_u32 s36, s36, s59
    v_mfma_f32_16x16x32_bf16 a[8:11], v[64:67], v[40:43], a[8:11]
    s_add_u32 m0, s42, 4096
    ds_read_b64_tr_b16 v[130:131], v10 offset:50176
    v_mfma_f32_16x16x32_bf16 a[12:15], v[64:67], v[44:47], a[12:15]
    buffer_load_dwordx4 v2, s[4:7], s36 offen offset:0 lds
    v_mfma_f32_16x16x32_bf16 a[16:19], v[64:67], v[48:51], a[16:19]
    ds_read_b64_tr_b16 v[132:133], v11 offset:49152
    v_mfma_f32_16x16x32_bf16 a[20:23], v[64:67], v[52:55], a[20:23]
    v_mfma_f32_16x16x32_bf16 a[24:27], v[64:67], v[56:59], a[24:27]
    ds_read_b64_tr_b16 v[134:135], v11 offset:50176
    v_mfma_f32_16x16x32_bf16 a[28:31], v[64:67], v[60:63], a[28:31]
    buffer_load_dwordx4 v3, s[4:7], s36 offen offset:1024 lds
    v_mfma_f32_16x16x32_bf16 a[32:35], v[68:71], v[32:35], a[32:35]
    ds_read_b128 v[96:99], v9 offset:32768
    v_mfma_f32_16x16x32_bf16 a[36:39], v[68:71], v[36:39], a[36:39]
    v_mfma_f32_16x16x32_bf16 a[40:43], v[68:71], v[40:43], a[40:43]
    ds_read_b64_tr_b16 v[136:137], v12 offset:49152
    v_mfma_f32_16x16x32_bf16 a[44:47], v[68:71], v[44:47], a[44:47]
    buffer_load_dwordx4 v4, s[4:7], s36 offen offset:2048 lds
    v_mfma_f32_16x16x32_bf16 a[48:51], v[68:71], v[48:51], a[48:51]
    ds_read_b64_tr_b16 v[138:139], v12 offset:50176
    v_mfma_f32_16x16x32_bf16 a[52:55], v[68:71], v[52:55], a[52:55]
    v_mfma_f32_16x16x32_bf16 a[56:59], v[68:71], v[56:59], a[56:59]
    ds_read_b128 v[100:103], v9 offset:34816
    v_mfma_f32_16x16x32_bf16 a[60:63], v[68:71], v[60:63], a[60:63]
    buffer_load_dwordx4 v5, s[4:7], s36 offen offset:3072 lds
    v_mfma_f32_16x16x32_bf16 a[64:67], v[72:75], v[32:35], a[64:67]
    ds_read_b64_tr_b16 v[140:141], v13 offset:49152
    v_mfma_f32_16x16x32_bf16 a[68:71], v[72:75], v[36:39], a[68:71]
    s_add_u32 s37, s58, 1572864
    s_and_b32 s37, s37, 4194303
    s_add_u32 s37, s37, s39
    v_mfma_f32_16x16x32_bf16 a[72:75], v[72:75], v[40:43], a[72:75]
    s_add_u32 m0, s43, 32768
    ds_read_b64_tr_b16 v[142:143], v13 offset:50176
    v_mfma_f32_16x16x32_bf16 a[76:79], v[72:75], v[44:47], a[76:79]
    buffer_load_dwordx4 v6, s[8:11], s37 offen offset:0 nt lds
    v_mfma_f32_16x16x32_bf16 a[80:83], v[72:75], v[48:51], a[80:83]
    ds_read_b128 v[104:107], v9 offset:36864
    v_mfma_f32_16x16x32_bf16 a[84:87], v[72:75], v[52:55], a[84:87]
    v_mfma_f32_16x16x32_bf16 a[88:91], v[72:75], v[56:59], a[88:91]
    ds_read_b64_tr_b16 v[144:145], v10 offset:51200
    v_mfma_f32_16x16x32_bf16 a[92:95], v[72:75], v[60:63], a[92:95]
    buffer_load_dwordx4 v7, s[8:11], s37 offen offset:1024 nt lds
    v_mfma_f32_16x16x32_bf16 a[96:99], v[76:79], v[32:35], a[96:99]
    ds_read_b64_tr_b16 v[146:147], v10 offset:52224
    v_mfma_f32_16x16x32_bf16 a[100:103], v[76:79], v[36:39], a[100:103]
    v_mfma_f32_16x16x32_bf16 a[104:107], v[76:79], v[40:43], a[104:107]
    s_add_u32 m0, s43, 34816
    ds_read_b128 v[108:111], v9 offset:38912
    v_mfma_f32_16x16x32_bf16 a[108:111], v[76:79], v[44:47], a[108:111]
    buffer_load_dwordx4 v6, s[12:15], s37 offen offset:0 nt lds
    v_mfma_f32_16x16x32_bf16 a[112:115], v[76:79], v[48:51], a[112:115]
    ds_read_b64_tr_b16 v[148:149], v11 offset:51200
    v_mfma_f32_16x16x32_bf16 a[116:119], v[76:79], v[52:55], a[116:119]
    v_mfma_f32_16x16x32_bf16 a[120:123], v[76:79], v[56:59], a[120:123]
    ds_read_b64_tr_b16 v[150:151], v11 offset:52224
    v_mfma_f32_16x16x32_bf16 a[124:127], v[76:79], v[60:63], a[124:127]
    buffer_load_dwordx4 v7, s[12:15], s37 offen offset:1024 nt lds
    v_mfma_f32_16x16x32_bf16 a[128:131], v[32:35], v[80:83], a[128:131]
    ds_read_b128 v[112:115], v9 offset:40960
    v_mfma_f32_16x16x32_bf16 a[132:135], v[36:39], v[80:83], a[132:135]
    v_mfma_f32_16x16x32_bf16 a[136:139], v[40:43], v[80:83], a[136:139]
    ds_read_b64_tr_b16 v[152:153], v12 offset:51200
    v_mfma_f32_16x16x32_bf16 a[140:143], v[44:47], v[80:83], a[140:143]
    v_mfma_f32_16x16x32_bf16 a[144:147], v[48:51], v[80:83], a[144:147]
    ds_read_b64_tr_b16 v[154:155], v12 offset:52224
    v_mfma_f32_16x16x32_bf16 a[148:151], v[52:55], v[80:83], a[148:151]
    v_mfma_f32_16x16x32_bf16 a[152:155], v[56:59], v[80:83], a[152:155]
    ds_read_b128 v[116:119], v9 offset:43008
    v_mfma_f32_16x16x32_bf16 a[156:159], v[60:63], v[80:83], a[156:159]
    v_mfma_f32_16x16x32_bf16 a[160:163], v[32:35], v[84:87], a[160:163]
    s_mov_b32 s16, s66
    ds_read_b64_tr_b16 v[156:157], v13 offset:51200
    v_mfma_f32_16x16x32_bf16 a[164:167], v[36:39], v[84:87], a[164:167]
    s_mov_b32 s17, s67
    v_mfma_f32_16x16x32_bf16 a[168:171], v[40:43], v[84:87], a[168:171]
    s_mov_b32 s18, 4194304
    ds_read_b64_tr_b16 v[158:159], v13 offset:52224
    v_mfma_f32_16x16x32_bf16 a[172:175], v[44:47], v[84:87], a[172:175]
    buffer_load_dwordx4 v[206:209], v233, s[24:27], s40 offen offset:0
    v_mfma_f32_16x16x32_bf16 a[176:179], v[48:51], v[84:87], a[176:179]
    ds_read_b128 v[120:123], v9 offset:45056
    v_mfma_f32_16x16x32_bf16 a[180:183], v[52:55], v[84:87], a[180:183]
    v_mfma_f32_16x16x32_bf16 a[184:187], v[56:59], v[84:87], a[184:187]
    ds_read_b128 v[124:127], v9 offset:47104
    v_mfma_f32_16x16x32_bf16 a[188:191], v[60:63], v[84:87], a[188:191]
    buffer_load_dwordx4 v[210:213], v233, s[24:27], s40 offen offset:1024
    v_mfma_f32_16x16x32_bf16 a[192:195], v[32:35], v[88:91], a[192:195]
    v_mfma_f32_16x16x32_bf16 a[196:199], v[36:39], v[88:91], a[196:199]
    v_mfma_f32_16x16x32_bf16 a[200:203], v[40:43], v[88:91], a[200:203]
    v_mfma_f32_16x16x32_bf16 a[204:207], v[44:47], v[88:91], a[204:207]
    v_mfma_f32_16x16x32_bf16 a[208:211], v[48:51], v[88:91], a[208:211]
    v_mfma_f32_16x16x32_bf16 a[212:215], v[52:55], v[88:91], a[212:215]
    v_mfma_f32_16x16x32_bf16 a[216:219], v[56:59], v[88:91], a[216:219]
    v_mfma_f32_16x16x32_bf16 a[220:223], v[60:63], v[88:91], a[220:223]
    v_mfma_f32_16x16x32_bf16 a[224:227], v[32:35], v[92:95], a[224:227]
    v_mfma_f32_16x16x32_bf16 a[228:231], v[36:39], v[92:95], a[228:231]
    v_mfma_f32_16x16x32_bf16 a[232:235], v[40:43], v[92:95], a[232:235]
    v_mfma_f32_16x16x32_bf16 a[236:239], v[44:47], v[92:95], a[236:239]
    v_mfma_f32_16x16x32_bf16 a[240:243], v[48:51], v[92:95], a[240:243]
    v_mfma_f32_16x16x32_bf16 a[244:247], v[52:55], v[92:95], a[244:247]
    v_mfma_f32_16x16x32_bf16 a[248:251], v[56:59], v[92:95], a[248:251]
    v_mfma_f32_16x16x32_bf16 a[252:255], v[60:63], v[92:95], a[252:255]
    s_waitcnt vmcnt(23) lgkmcnt(0)
    s_barrier
    v_mfma_f32_16x16x32_bf16 a[0:3], v[128:131], v[96:99], a[0:3]
    ds_read_b64_tr_b16 v[64:65], v10 offset:0
    v_mfma_f32_16x16x32_bf16 a[4:7], v[128:131], v[100:103], a[4:7]
    s_add_u32 s36, s35, 512
    s_and_b32 s36, s36, 1023
    s_add_u32 s36, s36, s38
    v_mfma_f32_16x16x32_bf16 a[8:11], v[128:131], v[104:107], a[8:11]
    s_add_u32 m0, s42, 32768
    ds_read_b64_tr_b16 v[66:67], v10 offset:1024
    v_mfma_f32_16x16x32_bf16 a[12:15], v[128:131], v[108:111], a[12:15]
    buffer_load_dwordx4 v2, s[4:7], s36 offen offset:0 lds
    v_mfma_f32_16x16x32_bf16 a[16:19], v[128:131], v[112:115], a[16:19]
    ds_read_b64_tr_b16 v[68:69], v11 offset:0
    v_mfma_f32_16x16x32_bf16 a[20:23], v[128:131], v[116:119], a[20:23]
    v_mfma_f32_16x16x32_bf16 a[24:27], v[128:131], v[120:123], a[24:27]
    ds_read_b64_tr_b16 v[70:71], v11 offset:1024
    v_mfma_f32_16x16x32_bf16 a[28:31], v[128:131], v[124:127], a[28:31]
    buffer_load_dwordx4 v3, s[4:7], s36 offen offset:1024 lds
    v_mfma_f32_16x16x32_bf16 a[32:35], v[132:135], v[96:99], a[32:35]
    ds_read_b128 v[32:35], v14 offset:0
    v_mfma_f32_16x16x32_bf16 a[36:39], v[132:135], v[100:103], a[36:39]
    v_mfma_f32_16x16x32_bf16 a[40:43], v[132:135], v[104:107], a[40:43]
    ds_read_b64_tr_b16 v[72:73], v12 offset:0
    v_mfma_f32_16x16x32_bf16 a[44:47], v[132:135], v[108:111], a[44:47]
    buffer_load_dwordx4 v4, s[4:7], s36 offen offset:2048 lds
    v_mfma_f32_16x16x32_bf16 a[48:51], v[132:135], v[112:115], a[48:51]
    ds_read_b64_tr_b16 v[74:75], v12 offset:1024
    v_mfma_f32_16x16x32_bf16 a[52:55], v[132:135], v[116:119], a[52:55]
    v_mfma_f32_16x16x32_bf16 a[56:59], v[132:135], v[120:123], a[56:59]
    ds_read_b128 v[36:39], v14 offset:2048
    v_mfma_f32_16x16x32_bf16 a[60:63], v[132:135], v[124:127], a[60:63]
    buffer_load_dwordx4 v5, s[4:7], s36 offen offset:3072 lds
    v_mfma_f32_16x16x32_bf16 a[64:67], v[136:139], v[96:99], a[64:67]
    ds_read_b64_tr_b16 v[76:77], v13 offset:0
    v_mfma_f32_16x16x32_bf16 a[68:71], v[136:139], v[100:103], a[68:71]
    s_add_u32 s37, s58, 1835008
    s_and_b32 s37, s37, 4194303
    s_add_u32 s37, s37, s39
    v_mfma_f32_16x16x32_bf16 a[72:75], v[136:139], v[104:107], a[72:75]
    s_add_u32 m0, s43, 49152
    ds_read_b64_tr_b16 v[78:79], v13 offset:1024
    v_mfma_f32_16x16x32_bf16 a[76:79], v[136:139], v[108:111], a[76:79]
    buffer_load_dwordx4 v6, s[8:11], s37 offen offset:0 nt lds
    v_mfma_f32_16x16x32_bf16 a[80:83], v[136:139], v[112:115], a[80:83]
    ds_read_b128 v[40:43], v14 offset:4096
    v_mfma_f32_16x16x32_bf16 a[84:87], v[136:139], v[116:119], a[84:87]
    v_mfma_f32_16x16x32_bf16 a[88:91], v[136:139], v[120:123], a[88:91]
    ds_read_b64_tr_b16 v[80:81], v10 offset:2048
    v_mfma_f32_16x16x32_bf16 a[92:95], v[136:139], v[124:127], a[92:95]
    buffer_load_dwordx4 v7, s[8:11], s37 offen offset:1024 nt lds
    v_mfma_f32_16x16x32_bf16 a[96:99], v[140:143], v[96:99], a[96:99]
    ds_read_b64_tr_b16 v[82:83], v10 offset:3072
    v_mfma_f32_16x16x32_bf16 a[100:103], v[140:143], v[100:103], a[100:103]
    v_mfma_f32_16x16x32_bf16 a[104:107], v[140:143], v[104:107], a[104:107]
    s_add_u32 m0, s43, 51200
    ds_read_b128 v[44:47], v14 offset:6144
    v_mfma_f32_16x16x32_bf16 a[108:111], v[140:143], v[108:111], a[108:111]
    buffer_load_dwordx4 v6, s[12:15], s37 offen offset:0 nt lds
    v_mfma_f32_16x16x32_bf16 a[112:115], v[140:143], v[112:115], a[112:115]
    ds_read_b64_tr_b16 v[84:85], v11 offset:2048
    v_mfma_f32_16x16x32_bf16 a[116:119], v[140:143], v[116:119], a[116:119]
    v_mfma_f32_16x16x32_bf16 a[120:123], v[140:143], v[120:123], a[120:123]
    ds_read_b64_tr_b16 v[86:87], v11 offset:3072
    v_mfma_f32_16x16x32_bf16 a[124:127], v[140:143], v[124:127], a[124:127]
    buffer_load_dwordx4 v7, s[12:15], s37 offen offset:1024 nt lds
    v_mfma_f32_16x16x32_bf16 a[128:131], v[96:99], v[144:147], a[128:131]
    ds_read_b128 v[48:51], v14 offset:8192
    v_mfma_f32_16x16x32_bf16 a[132:135], v[100:103], v[144:147], a[132:135]
    v_mfma_f32_16x16x32_bf16 a[136:139], v[104:107], v[144:147], a[136:139]
    ds_read_b64_tr_b16 v[88:89], v12 offset:2048
    v_mfma_f32_16x16x32_bf16 a[140:143], v[108:111], v[144:147], a[140:143]
    v_mfma_f32_16x16x32_bf16 a[144:147], v[112:115], v[144:147], a[144:147]
    ds_read_b64_tr_b16 v[90:91], v12 offset:3072
    v_mfma_f32_16x16x32_bf16 a[148:151], v[116:119], v[144:147], a[148:151]
    v_mfma_f32_16x16x32_bf16 a[152:155], v[120:123], v[144:147], a[152:155]
    ds_read_b128 v[52:55], v14 offset:10240
    v_mfma_f32_16x16x32_bf16 a[156:159], v[124:127], v[144:147], a[156:159]
    v_mfma_f32_16x16x32_bf16 a[160:163], v[96:99], v[148:151], a[160:163]
    ds_read_b64_tr_b16 v[92:93], v13 offset:2048
    v_mfma_f32_16x16x32_bf16 a[164:167], v[100:103], v[148:151], a[164:167]
    v_mfma_f32_16x16x32_bf16 a[168:171], v[104:107], v[148:151], a[168:171]
    ds_read_b64_tr_b16 v[94:95], v13 offset:3072
    v_mfma_f32_16x16x32_bf16 a[172:175], v[108:111], v[148:151], a[172:175]
    v_mfma_f32_16x16x32_bf16 a[176:179], v[112:115], v[148:151], a[176:179]
    ds_read_b128 v[56:59], v14 offset:12288
    v_mfma_f32_16x16x32_bf16 a[180:183], v[116:119], v[148:151], a[180:183]
    v_mfma_f32_16x16x32_bf16 a[184:187], v[120:123], v[148:151], a[184:187]
    ds_read_b128 v[60:63], v14 offset:14336
    v_mfma_f32_16x16x32_bf16 a[188:191], v[124:127], v[148:151], a[188:191]
    v_mfma_f32_16x16x32_bf16 a[192:195], v[96:99], v[152:155], a[192:195]
    v_mfma_f32_16x16x32_bf16 a[196:199], v[100:103], v[152:155], a[196:199]
    v_mfma_f32_16x16x32_bf16 a[200:203], v[104:107], v[152:155], a[200:203]
    v_mfma_f32_16x16x32_bf16 a[204:207], v[108:111], v[152:155], a[204:207]
    v_mfma_f32_16x16x32_bf16 a[208:211], v[112:115], v[152:155], a[208:211]
    v_mfma_f32_16x16x32_bf16 a[212:215], v[116:119], v[152:155], a[212:215]
    v_mfma_f32_16x16x32_bf16 a[216:219], v[120:123], v[152:155], a[216:219]
    v_mfma_f32_16x16x32_bf16 a[220:223], v[124:127], v[152:155], a[220:223]
    v_mfma_f32_16x16x32_bf16 a[224:227], v[96:99], v[156:159], a[224:227]
    v_mfma_f32_16x16x32_bf16 a[228:231], v[100:103], v[156:159], a[228:231]
    v_mfma_f32_16x16x32_bf16 a[232:235], v[104:107], v[156:159], a[232:235]
    v_mfma_f32_16x16x32_bf16 a[236:239], v[108:111], v[156:159], a[236:239]
    v_mfma_f32_16x16x32_bf16 a[240:243], v[112:115], v[156:159], a[240:243]
    v_mfma_f32_16x16x32_bf16 a[244:247], v[116:119], v[156:159], a[244:247]
    v_mfma_f32_16x16x32_bf16 a[248:251], v[120:123], v[156:159], a[248:251]
    v_mfma_f32_16x16x32_bf16 a[252:255], v[124:127], v[156:159], a[252:255]
    s_waitcnt vmcnt(20) lgkmcnt(0)
    s_barrier
    v_mfma_f32_16x16x32_bf16 a[0:3], v[64:67], v[32:35], a[0:3]
    ds_read_b64_tr_b16 v[128:129], v10 offset:16384
    v_mfma_f32_16x16x32_bf16 a[4:7], v[64:67], v[36:39], a[4:7]
    s_add_u32 s36, s35, 512
    s_and_b32 s36, s36, 1023
    s_add_u32 s36, s36, s59
    v_mfma_f32_16x16x32_bf16 a[8:11], v[64:67], v[40:43], a[8:11]
    s_add_u32 m0, s42, 36864
    ds_read_b64_tr_b16 v[130:131], v10 offset:17408
    v_mfma_f32_16x16x32_bf16 a[12:15], v[64:67], v[44:47], a[12:15]
    buffer_load_dwordx4 v2, s[4:7], s36 offen offset:0 lds
    v_mfma_f32_16x16x32_bf16 a[16:19], v[64:67], v[48:51], a[16:19]
    ds_read_b64_tr_b16 v[132:133], v11 offset:16384
    v_mfma_f32_16x16x32_bf16 a[20:23], v[64:67], v[52:55], a[20:23]
    v_mfma_f32_16x16x32_bf16 a[24:27], v[64:67], v[56:59], a[24:27]
    ds_read_b64_tr_b16 v[134:135], v11 offset:17408
    v_mfma_f32_16x16x32_bf16 a[28:31], v[64:67], v[60:63], a[28:31]
    buffer_load_dwordx4 v3, s[4:7], s36 offen offset:1024 lds
    v_mfma_f32_16x16x32_bf16 a[32:35], v[68:71], v[32:35], a[32:35]
    ds_read_b128 v[96:99], v15 offset:0
    v_mfma_f32_16x16x32_bf16 a[36:39], v[68:71], v[36:39], a[36:39]
    v_mfma_f32_16x16x32_bf16 a[40:43], v[68:71], v[40:43], a[40:43]
    ds_read_b64_tr_b16 v[136:137], v12 offset:16384
    v_mfma_f32_16x16x32_bf16 a[44:47], v[68:71], v[44:47], a[44:47]
    buffer_load_dwordx4 v4, s[4:7], s36 offen offset:2048 lds
    v_mfma_f32_16x16x32_bf16 a[48:51], v[68:71], v[48:51], a[48:51]
    ds_read_b64_tr_b16 v[138:139], v12 offset:17408
    v_mfma_f32_16x16x32_bf16 a[52:55], v[68:71], v[52:55], a[52:55]
    v_mfma_f32_16x16x32_bf16 a[56:59], v[68:71], v[56:59], a[56:59]
    ds_read_b128 v[100:103], v15 offset:2048
    v_mfma_f32_16x16x32_bf16 a[60:63], v[68:71], v[60:63], a[60:63]
    buffer_load_dwordx4 v5, s[4:7], s36 offen offset:3072 lds
    v_mfma_f32_16x16x32_bf16 a[64:67], v[72:75], v[32:35], a[64:67]
    ds_read_b64_tr_b16 v[140:141], v13 offset:16384
    v_mfma_f32_16x16x32_bf16 a[68:71], v[72:75], v[36:39], a[68:71]
    s_add_u32 s37, s58, 2097152
    s_and_b32 s37, s37, 4194303
    s_add_u32 s37, s37, s39
    v_mfma_f32_16x16x32_bf16 a[72:75], v[72:75], v[40:43], a[72:75]
    s_add_u32 m0, s43, 0
    ds_read_b64_tr_b16 v[142:143], v13 offset:17408
    v_mfma_f32_16x16x32_bf16 a[76:79], v[72:75], v[44:47], a[76:79]
    buffer_load_dwordx4 v6, s[8:11], s37 offen offset:0 nt lds
    v_mfma_f32_16x16x32_bf16 a[80:83], v[72:75], v[48:51], a[80:83]
    ds_read_b128 v[104:107], v15 offset:4096
    v_mfma_f32_16x16x32_bf16 a[84:87], v[72:75], v[52:55], a[84:87]
    v_mfma_f32_16x16x32_bf16 a[88:91], v[72:75], v[56:59], a[88:91]
    ds_read_b64_tr_b16 v[144:145], v10 offset:18432
    v_mfma_f32_16x16x32_bf16 a[92:95], v[72:75], v[60:63], a[92:95]
    buffer_load_dwordx4 v7, s[8:11], s37 offen offset:1024 nt lds
    v_mfma_f32_16x16x32_bf16 a[96:99], v[76:79], v[32:35], a[96:99]
    ds_read_b64_tr_b16 v[146:147], v10 offset:19456
    v_mfma_f32_16x16x32_bf16 a[100:103], v[76:79], v[36:39], a[100:103]
    v_mfma_f32_16x16x32_bf16 a[104:107], v[76:79], v[40:43], a[104:107]
    s_add_u32 m0, s43, 2048
    ds_read_b128 v[108:111], v15 offset:6144
    v_mfma_f32_16x16x32_bf16 a[108:111], v[76:79], v[44:47], a[108:111]
    buffer_load_dwordx4 v6, s[12:15], s37 offen offset:0 nt lds
    v_mfma_f32_16x16x32_bf16 a[112:115], v[76:79], v[48:51], a[112:115]
    ds_read_b64_tr_b16 v[148:149], v11 offset:18432
    v_mfma_f32_16x16x32_bf16 a[116:119], v[76:79], v[52:55], a[116:119]
    v_mfma_f32_16x16x32_bf16 a[120:123], v[76:79], v[56:59], a[120:123]
    ds_read_b64_tr_b16 v[150:151], v11 offset:19456
    v_mfma_f32_16x16x32_bf16 a[124:127], v[76:79], v[60:63], a[124:127]
    buffer_load_dwordx4 v7, s[12:15], s37 offen offset:1024 nt lds
    v_mfma_f32_16x16x32_bf16 a[128:131], v[32:35], v[80:83], a[128:131]
    ds_read_b128 v[112:115], v15 offset:8192
    v_mfma_f32_16x16x32_bf16 a[132:135], v[36:39], v[80:83], a[132:135]
    v_mfma_f32_16x16x32_bf16 a[136:139], v[40:43], v[80:83], a[136:139]
    ds_read_b64_tr_b16 v[152:153], v12 offset:18432
    v_mfma_f32_16x16x32_bf16 a[140:143], v[44:47], v[80:83], a[140:143]
    buffer_load_dwordx4 v[214:217], v233, s[24:27], s41 offen offset:0
    v_mfma_f32_16x16x32_bf16 a[144:147], v[48:51], v[80:83], a[144:147]
    ds_read_b64_tr_b16 v[154:155], v12 offset:19456
    v_mfma_f32_16x16x32_bf16 a[148:151], v[52:55], v[80:83], a[148:151]
    v_mfma_f32_16x16x32_bf16 a[152:155], v[56:59], v[80:83], a[152:155]
    ds_read_b128 v[116:119], v15 offset:10240
    v_mfma_f32_16x16x32_bf16 a[156:159], v[60:63], v[80:83], a[156:159]
    buffer_load_dwordx4 v[218:221], v233, s[24:27], s41 offen offset:1024
    v_mfma_f32_16x16x32_bf16 a[160:163], v[32:35], v[84:87], a[160:163]
    ds_read_b64_tr_b16 v[156:157], v13 offset:18432
    v_mfma_f32_16x16x32_bf16 a[164:167], v[36:39], v[84:87], a[164:167]
    v_mfma_f32_16x16x32_bf16 a[168:171], v[40:43], v[84:87], a[168:171]
    ds_read_b64_tr_b16 v[158:159], v13 offset:19456
    v_mfma_f32_16x16x32_bf16 a[172:175], v[44:47], v[84:87], a[172:175]
    buffer_load_dwordx2 v[160:161], v1, s[16:19], 0 offen offset:0 nt
    v_mfma_f32_16x16x32_bf16 a[176:179], v[48:51], v[84:87], a[176:179]
    ds_read_b128 v[120:123], v15 offset:12288
    v_mfma_f32_16x16x32_bf16 a[180:183], v[52:55], v[84:87], a[180:183]
    v_mfma_f32_16x16x32_bf16 a[184:187], v[56:59], v[84:87], a[184:187]
    ds_read_b128 v[124:127], v15 offset:14336
    v_mfma_f32_16x16x32_bf16 a[188:191], v[60:63], v[84:87], a[188:191]
    buffer_load_dwordx2 v[162:163], v1, s[16:19], 0 offen offset:2048 nt
    v_mfma_f32_16x16x32_bf16 a[192:195], v[32:35], v[88:91], a[192:195]
    v_mfma_f32_16x16x32_bf16 a[196:199], v[36:39], v[88:91], a[196:199]
    v_mfma_f32_16x16x32_bf16 a[200:203], v[40:43], v[88:91], a[200:203]
    v_mfma_f32_16x16x32_bf16 a[204:207], v[44:47], v[88:91], a[204:207]
    v_mfma_f32_16x16x32_bf16 a[208:211], v[48:51], v[88:91], a[208:211]
    v_mfma_f32_16x16x32_bf16 a[212:215], v[52:55], v[88:91], a[212:215]
    v_mfma_f32_16x16x32_bf16 a[216:219], v[56:59], v[88:91], a[216:219]
    v_mfma_f32_16x16x32_bf16 a[220:223], v[60:63], v[88:91], a[220:223]
    v_mfma_f32_16x16x32_bf16 a[224:227], v[32:35], v[92:95], a[224:227]
    v_mfma_f32_16x16x32_bf16 a[228:231], v[36:39], v[92:95], a[228:231]
    v_mfma_f32_16x16x32_bf16 a[232:235], v[40:43], v[92:95], a[232:235]
    v_mfma_f32_16x16x32_bf16 a[236:239], v[44:47], v[92:95], a[236:239]
    v_mfma_f32_16x16x32_bf16 a[240:243], v[48:51], v[92:95], a[240:243]
    v_mfma_f32_16x16x32_bf16 a[244:247], v[52:55], v[92:95], a[244:247]
    v_mfma_f32_16x16x32_bf16 a[248:251], v[56:59], v[92:95], a[248:251]
    v_mfma_f32_16x16x32_bf16 a[252:255], v[60:63], v[92:95], a[252:255]
    s_waitcnt vmcnt(22) lgkmcnt(0)
    s_barrier
    v_mfma_f32_16x16x32_bf16 a[0:3], v[128:131], v[96:99], a[0:3]
    ds_read_b64_tr_b16 v[64:65], v10 offset:32768
    v_mfma_f32_16x16x32_bf16 a[4:7], v[128:131], v[100:103], a[4:7]
    s_add_u32 s36, s35, 640
    s_and_b32 s36, s36, 1023
    s_add_u32 s36, s36, s38
    v_mfma_f32_16x16x32_bf16 a[8:11], v[128:131], v[104:107], a[8:11]
    s_add_u32 m0, s42, 65536
    ds_read_b64_tr_b16 v[66:67], v10 offset:33792
    v_mfma_f32_16x16x32_bf16 a[12:15], v[128:131], v[108:111], a[12:15]
    buffer_load_dwordx4 v2, s[4:7], s36 offen offset:0 lds
    v_mfma_f32_16x16x32_bf16 a[16:19], v[128:131], v[112:115], a[16:19]
    ds_read_b64_tr_b16 v[68:69], v11 offset:32768
    v_mfma_f32_16x16x32_bf16 a[20:23], v[128:131], v[116:119], a[20:23]
    v_mfma_f32_16x16x32_bf16 a[24:27], v[128:131], v[120:123], a[24:27]
    ds_read_b64_tr_b16 v[70:71], v11 offset:33792
    v_mfma_f32_16x16x32_bf16 a[28:31], v[128:131], v[124:127], a[28:31]
    buffer_load_dwordx4 v3, s[4:7], s36 offen offset:1024 lds
    v_mfma_f32_16x16x32_bf16 a[32:35], v[132:135], v[96:99], a[32:35]
    ds_read_b128 v[32:35], v8 offset:0
    v_mfma_f32_16x16x32_bf16 a[36:39], v[132:135], v[100:103], a[36:39]
    v_mfma_f32_16x16x32_bf16 a[40:43], v[132:135], v[104:107], a[40:43]
    ds_read_b64_tr_b16 v[72:73], v12 offset:32768
    v_mfma_f32_16x16x32_bf16 a[44:47], v[132:135], v[108:111], a[44:47]
    buffer_load_dwordx4 v4, s[4:7], s36 offen offset:2048 lds
    v_mfma_f32_16x16x32_bf16 a[48:51], v[132:135], v[112:115], a[48:51]
    ds_read_b64_tr_b16 v[74:75], v12 offset:33792
    v_mfma_f32_16x16x32_bf16 a[52:55], v[132:135], v[116:119], a[52:55]
    v_mfma_f32_16x16x32_bf16 a[56:59], v[132:135], v[120:123], a[56:59]
    ds_read_b128 v[36:39], v8 offset:2048
    v_mfma_f32_16x16x32_bf16 a[60:63], v[132:135], v[124:127], a[60:63]
    buffer_load_dwordx4 v5, s[4:7], s36 offen offset:3072 lds
    v_mfma_f32_16x16x32_bf16 a[64:67], v[136:139], v[96:99], a[64:67]
    ds_read_b64_tr_b16 v[76:77], v13 offset:32768
    v_mfma_f32_16x16x32_bf16 a[68:71], v[136:139], v[100:103], a[68:71]
    s_add_u32 s37, s58, 2359296
    s_and_b32 s37, s37, 4194303
    s_add_u32 s37, s37, s39
    v_mfma_f32_16x16x32_bf16 a[72:75], v[136:139], v[104:107], a[72:75]
    s_add_u32 m0, s43, 16384
    ds_read_b64_tr_b16 v[78:79], v13 offset:33792
    v_mfma_f32_16x16x32_bf16 a[76:79], v[136:139], v[108:111], a[76:79]
    buffer_load_dwordx4 v6, s[8:11], s37 offen offset:0 nt lds
    v_mfma_f32_16x16x32_bf16 a[80:83], v[136:139], v[112:115], a[80:83]
    ds_read_b128 v[40:43], v8 offset:4096
    v_mfma_f32_16x16x32_bf16 a[84:87], v[136:139], v[116:119], a[84:87]
    v_mfma_f32_16x16x32_bf16 a[88:91], v[136:139], v[120:123], a[88:91]
    ds_read_b64_tr_b16 v[80:81], v10 offset:34816
    v_mfma_f32_16x16x32_bf16 a[92:95], v[136:139], v[124:127], a[92:95]
    buffer_load_dwordx4 v7, s[8:11], s37 offen offset:1024 nt lds
    v_mfma_f32_16x16x32_bf16 a[96:99], v[140:143], v[96:99], a[96:99]
    ds_read_b64_tr_b16 v[82:83], v10 offset:35840
    v_mfma_f32_16x16x32_bf16 a[100:103], v[140:143], v[100:103], a[100:103]
    v_mfma_f32_16x16x32_bf16 a[104:107], v[140:143], v[104:107], a[104:107]
    s_add_u32 m0, s43, 18432
    ds_read_b128 v[44:47], v8 offset:6144
    v_mfma_f32_16x16x32_bf16 a[108:111], v[140:143], v[108:111], a[108:111]
    buffer_load_dwordx4 v6, s[12:15], s37 offen offset:0 nt lds
    v_mfma_f32_16x16x32_bf16 a[112:115], v[140:143], v[112:115], a[112:115]
    ds_read_b64_tr_b16 v[84:85], v11 offset:34816
    v_mfma_f32_16x16x32_bf16 a[116:119], v[140:143], v[116:119], a[116:119]
    v_mfma_f32_16x16x32_bf16 a[120:123], v[140:143], v[120:123], a[120:123]
    ds_read_b64_tr_b16 v[86:87], v11 offset:35840
    v_mfma_f32_16x16x32_bf16 a[124:127], v[140:143], v[124:127], a[124:127]
    buffer_load_dwordx4 v7, s[12:15], s37 offen offset:1024 nt lds
    v_mfma_f32_16x16x32_bf16 a[128:131], v[96:99], v[144:147], a[128:131]
    ds_read_b128 v[48:51], v8 offset:8192
    v_mfma_f32_16x16x32_bf16 a[132:135], v[100:103], v[144:147], a[132:135]
    v_mfma_f32_16x16x32_bf16 a[136:139], v[104:107], v[144:147], a[136:139]
    ds_read_b64_tr_b16 v[88:89], v12 offset:34816
    v_mfma_f32_16x16x32_bf16 a[140:143], v[108:111], v[144:147], a[140:143]
    buffer_load_dwordx2 v[164:165], v1, s[16:19], s47 offen offset:0 nt
    v_mfma_f32_16x16x32_bf16 a[144:147], v[112:115], v[144:147], a[144:147]
    ds_read_b64_tr_b16 v[90:91], v12 offset:35840
    v_mfma_f32_16x16x32_bf16 a[148:151], v[116:119], v[144:147], a[148:151]
    v_mfma_f32_16x16x32_bf16 a[152:155], v[120:123], v[144:147], a[152:155]
    ds_read_b128 v[52:55], v8 offset:10240
    v_mfma_f32_16x16x32_bf16 a[156:159], v[124:127], v[144:147], a[156:159]
    buffer_load_dwordx2 v[166:167], v0, s[16:19], 0 offen offset:0 nt
    v_mfma_f32_16x16x32_bf16 a[160:163], v[96:99], v[148:151], a[160:163]
    ds_read_b64_tr_b16 v[92:93], v13 offset:34816
    v_mfma_f32_16x16x32_bf16 a[164:167], v[100:103], v[148:151], a[164:167]
    v_mfma_f32_16x16x32_bf16 a[168:171], v[104:107], v[148:151], a[168:171]
    ds_read_b64_tr_b16 v[94:95], v13 offset:35840
    v_mfma_f32_16x16x32_bf16 a[172:175], v[108:111], v[148:151], a[172:175]
    buffer_load_dwordx2 v[168:169], v0, s[16:19], 0 offen offset:2048 nt
    v_mfma_f32_16x16x32_bf16 a[176:179], v[112:115], v[148:151], a[176:179]
    ds_read_b128 v[56:59], v8 offset:12288
    v_mfma_f32_16x16x32_bf16 a[180:183], v[116:119], v[148:151], a[180:183]
    v_mfma_f32_16x16x32_bf16 a[184:187], v[120:123], v[148:151], a[184:187]
    ds_read_b128 v[60:63], v8 offset:14336
    v_mfma_f32_16x16x32_bf16 a[188:191], v[124:127], v[148:151], a[188:191]
    v_mfma_f32_16x16x32_bf16 a[192:195], v[96:99], v[152:155], a[192:195]
    v_mfma_f32_16x16x32_bf16 a[196:199], v[100:103], v[152:155], a[196:199]
    v_mfma_f32_16x16x32_bf16 a[200:203], v[104:107], v[152:155], a[200:203]
    v_mfma_f32_16x16x32_bf16 a[204:207], v[108:111], v[152:155], a[204:207]
    v_mfma_f32_16x16x32_bf16 a[208:211], v[112:115], v[152:155], a[208:211]
    v_mfma_f32_16x16x32_bf16 a[212:215], v[116:119], v[152:155], a[212:215]
    v_mfma_f32_16x16x32_bf16 a[216:219], v[120:123], v[152:155], a[216:219]
    v_mfma_f32_16x16x32_bf16 a[220:223], v[124:127], v[152:155], a[220:223]
    v_mfma_f32_16x16x32_bf16 a[224:227], v[96:99], v[156:159], a[224:227]
    v_mfma_f32_16x16x32_bf16 a[228:231], v[100:103], v[156:159], a[228:231]
    v_mfma_f32_16x16x32_bf16 a[232:235], v[104:107], v[156:159], a[232:235]
    v_mfma_f32_16x16x32_bf16 a[236:239], v[108:111], v[156:159], a[236:239]
    buffer_load_dword v31, v254, s[20:23], s46 offen offset:0
    v_mfma_f32_16x16x32_bf16 a[240:243], v[112:115], v[156:159], a[240:243]
    s_add_u32 s46, s46, 1048576
    v_mfma_f32_16x16x32_bf16 a[244:247], v[116:119], v[156:159], a[244:247]
    v_mfma_f32_16x16x32_bf16 a[248:251], v[120:123], v[156:159], a[248:251]
    v_mfma_f32_16x16x32_bf16 a[252:255], v[124:127], v[156:159], a[252:255]
    s_waitcnt vmcnt(24) lgkmcnt(0)
    s_barrier
    v_mfma_f32_16x16x32_bf16 a[0:3], v[64:67], v[32:35], a[0:3]
    ds_read_b64_tr_b16 v[128:129], v10 offset:49152
    v_mfma_f32_16x16x32_bf16 a[4:7], v[64:67], v[36:39], a[4:7]
    s_add_u32 s36, s35, 640
    s_and_b32 s36, s36, 1023
    s_add_u32 s36, s36, s59
    v_mfma_f32_16x16x32_bf16 a[8:11], v[64:67], v[40:43], a[8:11]
    s_add_u32 m0, s42, 69632
    ds_read_b64_tr_b16 v[130:131], v10 offset:50176
    v_mfma_f32_16x16x32_bf16 a[12:15], v[64:67], v[44:47], a[12:15]
    buffer_load_dwordx4 v2, s[4:7], s36 offen offset:0 lds
    v_mfma_f32_16x16x32_bf16 a[16:19], v[64:67], v[48:51], a[16:19]
    ds_read_b64_tr_b16 v[132:133], v11 offset:49152
    v_mfma_f32_16x16x32_bf16 a[20:23], v[64:67], v[52:55], a[20:23]
    v_mfma_f32_16x16x32_bf16 a[24:27], v[64:67], v[56:59], a[24:27]
    ds_read_b64_tr_b16 v[134:135], v11 offset:50176
    v_mfma_f32_16x16x32_bf16 a[28:31], v[64:67], v[60:63], a[28:31]
    buffer_load_dwordx4 v3, s[4:7], s36 offen offset:1024 lds
    v_mfma_f32_16x16x32_bf16 a[32:35], v[68:71], v[32:35], a[32:35]
    ds_read_b128 v[96:99], v9 offset:0
    v_mfma_f32_16x16x32_bf16 a[36:39], v[68:71], v[36:39], a[36:39]
    v_mfma_f32_16x16x32_bf16 a[40:43], v[68:71], v[40:43], a[40:43]
    ds_read_b64_tr_b16 v[136:137], v12 offset:49152
    v_mfma_f32_16x16x32_bf16 a[44:47], v[68:71], v[44:47], a[44:47]
    buffer_load_dwordx4 v4, s[4:7], s36 offen offset:2048 lds
    v_mfma_f32_16x16x32_bf16 a[48:51], v[68:71], v[48:51], a[48:51]
    ds_read_b64_tr_b16 v[138:139], v12 offset:50176
    v_mfma_f32_16x16x32_bf16 a[52:55], v[68:71], v[52:55], a[52:55]
    v_mfma_f32_16x16x32_bf16 a[56:59], v[68:71], v[56:59], a[56:59]
    ds_read_b128 v[100:103], v9 offset:2048
    v_mfma_f32_16x16x32_bf16 a[60:63], v[68:71], v[60:63], a[60:63]
    buffer_load_dwordx4 v5, s[4:7], s36 offen offset:3072 lds
    v_mfma_f32_16x16x32_bf16 a[64:67], v[72:75], v[32:35], a[64:67]
    ds_read_b64_tr_b16 v[140:141], v13 offset:49152
    v_mfma_f32_16x16x32_bf16 a[68:71], v[72:75], v[36:39], a[68:71]
    s_add_u32 s37, s58, 2621440
    s_and_b32 s37, s37, 4194303
    s_add_u32 s37, s37, s39
    v_mfma_f32_16x16x32_bf16 a[72:75], v[72:75], v[40:43], a[72:75]
    s_add_u32 m0, s43, 32768
    ds_read_b64_tr_b16 v[142:143], v13 offset:50176
    v_mfma_f32_16x16x32_bf16 a[76:79], v[72:75], v[44:47], a[76:79]
    buffer_load_dwordx4 v6, s[8:11], s37 offen offset:0 nt lds
    v_mfma_f32_16x16x32_bf16 a[80:83], v[72:75], v[48:51], a[80:83]
    ds_read_b128 v[104:107], v9 offset:4096
    v_mfma_f32_16x16x32_bf16 a[84:87], v[72:75], v[52:55], a[84:87]
    v_mfma_f32_16x16x32_bf16 a[88:91], v[72:75], v[56:59], a[88:91]
    ds_read_b64_tr_b16 v[144:145], v10 offset:51200
    v_mfma_f32_16x16x32_bf16 a[92:95], v[72:75], v[60:63], a[92:95]
    buffer_load_dwordx4 v7, s[8:11], s37 offen offset:1024 nt lds
    v_mfma_f32_16x16x32_bf16 a[96:99], v[76:79], v[32:35], a[96:99]
    ds_read_b64_tr_b16 v[146:147], v10 offset:52224
    v_mfma_f32_16x16x32_bf16 a[100:103], v[76:79], v[36:39], a[100:103]
    v_mfma_f32_16x16x32_bf16 a[104:107], v[76:79], v[40:43], a[104:107]
    s_add_u32 m0, s43, 34816
    ds_read_b128 v[108:111], v9 offset:6144
    v_mfma_f32_16x16x32_bf16 a[108:111], v[76:79], v[44:47], a[108:111]
    buffer_load_dwordx4 v6, s[12:15], s37 offen offset:0 nt lds
    v_mfma_f32_16x16x32_bf16 a[112:115], v[76:79], v[48:51], a[112:115]
    ds_read_b64_tr_b16 v[148:149], v11 offset:51200
    v_mfma_f32_16x16x32_bf16 a[116:119], v[76:79], v[52:55], a[116:119]
    v_mfma_f32_16x16x32_bf16 a[120:123], v[76:79], v[56:59], a[120:123]
    ds_read_b64_tr_b16 v[150:151], v11 offset:52224
    v_mfma_f32_16x16x32_bf16 a[124:127], v[76:79], v[60:63], a[124:127]
    buffer_load_dwordx4 v7, s[12:15], s37 offen offset:1024 nt lds
    v_mfma_f32_16x16x32_bf16 a[128:131], v[32:35], v[80:83], a[128:131]
    ds_read_b128 v[112:115], v9 offset:8192
    v_mfma_f32_16x16x32_bf16 a[132:135], v[36:39], v[80:83], a[132:135]
    v_mfma_f32_16x16x32_bf16 a[136:139], v[40:43], v[80:83], a[136:139]
    ds_read_b64_tr_b16 v[152:153], v12 offset:51200
    v_mfma_f32_16x16x32_bf16 a[140:143], v[44:47], v[80:83], a[140:143]
    buffer_load_dwordx2 v[170:171], v0, s[16:19], s47 offen offset:0 nt
    v_mfma_f32_16x16x32_bf16 a[144:147], v[48:51], v[80:83], a[144:147]
    ds_read_b64_tr_b16 v[154:155], v12 offset:52224
    v_mfma_f32_16x16x32_bf16 a[148:151], v[52:55], v[80:83], a[148:151]
    v_mfma_f32_16x16x32_bf16 a[152:155], v[56:59], v[80:83], a[152:155]
    ds_read_b128 v[116:119], v9 offset:10240
    v_mfma_f32_16x16x32_bf16 a[156:159], v[60:63], v[80:83], a[156:159]
    buffer_load_dwordx2 v[172:173], v0, s[16:19], s47 offen offset:2048 nt
    v_mfma_f32_16x16x32_bf16 a[160:163], v[32:35], v[84:87], a[160:163]
    ds_read_b64_tr_b16 v[156:157], v13 offset:51200
    v_mfma_f32_16x16x32_bf16 a[164:167], v[36:39], v[84:87], a[164:167]
    v_mfma_f32_16x16x32_bf16 a[168:171], v[40:43], v[84:87], a[168:171]
    ds_read_b64_tr_b16 v[158:159], v13 offset:52224
    v_mfma_f32_16x16x32_bf16 a[172:175], v[44:47], v[84:87], a[172:175]
    buffer_load_dwordx2 v[174:175], v0, s[16:19], s48 offen offset:0 nt
    v_mfma_f32_16x16x32_bf16 a[176:179], v[48:51], v[84:87], a[176:179]
    ds_read_b128 v[120:123], v9 offset:12288
    v_mfma_f32_16x16x32_bf16 a[180:183], v[52:55], v[84:87], a[180:183]
    v_mfma_f32_16x16x32_bf16 a[184:187], v[56:59], v[84:87], a[184:187]
    ds_read_b128 v[124:127], v9 offset:14336
    v_mfma_f32_16x16x32_bf16 a[188:191], v[60:63], v[84:87], a[188:191]
    v_mfma_f32_16x16x32_bf16 a[192:195], v[32:35], v[88:91], a[192:195]
    v_mfma_f32_16x16x32_bf16 a[196:199], v[36:39], v[88:91], a[196:199]
    v_mfma_f32_16x16x32_bf16 a[200:203], v[40:43], v[88:91], a[200:203]
    v_mfma_f32_16x16x32_bf16 a[204:207], v[44:47], v[88:91], a[204:207]
    v_mfma_f32_16x16x32_bf16 a[208:211], v[48:51], v[88:91], a[208:211]
    v_mfma_f32_16x16x32_bf16 a[212:215], v[52:55], v[88:91], a[212:215]
    v_mfma_f32_16x16x32_bf16 a[216:219], v[56:59], v[88:91], a[216:219]
    v_mfma_f32_16x16x32_bf16 a[220:223], v[60:63], v[88:91], a[220:223]
    v_mfma_f32_16x16x32_bf16 a[224:227], v[32:35], v[92:95], a[224:227]
    v_mfma_f32_16x16x32_bf16 a[228:231], v[36:39], v[92:95], a[228:231]
    v_mfma_f32_16x16x32_bf16 a[232:235], v[40:43], v[92:95], a[232:235]
    v_mfma_f32_16x16x32_bf16 a[236:239], v[44:47], v[92:95], a[236:239]
    buffer_load_dword v31, v254, s[20:23], s46 offen offset:0
    v_mfma_f32_16x16x32_bf16 a[240:243], v[48:51], v[92:95], a[240:243]
    s_add_u32 s46, s46, 1048576
    v_mfma_f32_16x16x32_bf16 a[244:247], v[52:55], v[92:95], a[244:247]
    v_mfma_f32_16x16x32_bf16 a[248:251], v[56:59], v[92:95], a[248:251]
    v_mfma_f32_16x16x32_bf16 a[252:255], v[60:63], v[92:95], a[252:255]
    s_waitcnt vmcnt(26) lgkmcnt(0)
    s_barrier
    v_mfma_f32_16x16x32_bf16 a[0:3], v[128:131], v[96:99], a[0:3]
    ds_read_b64_tr_b16 v[64:65], v10 offset:0
    v_lshlrev_b32 v240, 16, v222
    v_mfma_f32_16x16x32_bf16 a[4:7], v[128:131], v[100:103], a[4:7]
    s_add_u32 s36, s35, 768
    s_and_b32 s36, s36, 1023
    s_add_u32 s36, s36, s38
    v_lshlrev_b32 v238, 16, v206
    v_lshlrev_b32 v239, 16, v214
    v_mfma_f32_16x16x32_bf16 a[8:11], v[128:131], v[104:107], a[8:11]
    s_add_u32 m0, s42, 0
    ds_read_b64_tr_b16 v[66:67], v10 offset:1024
    v_mul_f32 v236, v238, v240
    v_mfma_f32_16x16x32_bf16 a[12:15], v[128:131], v[108:111], a[12:15]
    buffer_load_dwordx4 v2, s[4:7], s36 offen offset:0 lds
    v_mfma_f32_16x16x32_bf16 a[16:19], v[128:131], v[112:115], a[16:19]
    ds_read_b64_tr_b16 v[68:69], v11 offset:0
    v_mul_f32 v237, v239, v240
    v_mfma_f32_16x16x32_bf16 a[20:23], v[128:131], v[116:119], a[20:23]
    v_and_b32 v240, s52, v222
    v_and_b32 v238, s52, v206
    v_mfma_f32_16x16x32_bf16 a[24:27], v[128:131], v[120:123], a[24:27]
    ds_read_b64_tr_b16 v[70:71], v11 offset:1024
    v_and_b32 v239, s52, v214
    v_mfma_f32_16x16x32_bf16 a[28:31], v[128:131], v[124:127], a[28:31]
    buffer_load_dwordx4 v3, s[4:7], s36 offen offset:1024 lds
    v_mfma_f32_16x16x32_bf16 a[32:35], v[132:135], v[96:99], a[32:35]
    ds_read_b128 v[32:35], v8 offset:32768
    v_fmac_f32 v236, v238, v240
    v_mfma_f32_16x16x32_bf16 a[36:39], v[132:135], v[100:103], a[36:39]
    v_fmac_f32 v237, v239, v240
    v_lshlrev_b32 v240, 16, v223
    v_mfma_f32_16x16x32_bf16 a[40:43], v[132:135], v[104:107], a[40:43]
    ds_read_b64_tr_b16 v[72:73], v12 offset:0
    v_lshlrev_b32 v238, 16, v207
    v_mfma_f32_16x16x32_bf16 a[44:47], v[132:135], v[108:111], a[44:47]
    buffer_load_dwordx4 v4, s[4:7], s36 offen offset:2048 lds
    v_mfma_f32_16x16x32_bf16 a[48:51], v[132:135], v[112:115], a[48:51]
    ds_read_b64_tr_b16 v[74:75], v12 offset:1024
    v_lshlrev_b32 v239, 16, v215
    v_mfma_f32_16x16x32_bf16 a[52:55], v[132:135], v[116:119], a[52:55]
    v_fmac_f32 v236, v238, v240
    v_fmac_f32 v237, v239, v240
    v_mfma_f32_16x16x32_bf16 a[56:59], v[132:135], v[120:123], a[56:59]
    ds_read_b128 v[36:39], v8 offset:34816
    v_and_b32 v240, s52, v223
    v_mfma_f32_16x16x32_bf16 a[60:63], v[132:135], v[124:127], a[60:63]
    buffer_load_dwordx4 v5, s[4:7], s36 offen offset:3072 lds
    v_mfma_f32_16x16x32_bf16 a[64:67], v[136:139], v[96:99], a[64:67]
    ds_read_b64_tr_b16 v[76:77], v13 offset:0
    v_and_b32 v238, s52, v207
    v_mfma_f32_16x16x32_bf16 a[68:71], v[136:139], v[100:103], a[68:71]
    s_add_u32 s37, s58, 2883584
    s_and_b32 s37, s37, 4194303
    s_add_u32 s37, s37, s39
    v_and_b32 v239, s52, v215
    v_fmac_f32 v236, v238, v240
    v_mfma_f32_16x16x32_bf16 a[72:75], v[136:139], v[104:107], a[72:75]
    s_add_u32 m0, s43, 49152
    ds_read_b64_tr_b16 v[78:79], v13 offset:1024
    v_fmac_f32 v237, v239, v240
    v_mfma_f32_16x16x32_bf16 a[76:79], v[136:139], v[108:111], a[76:79]
    buffer_load_dwordx4 v6, s[8:11], s37 offen offset:0 nt lds
    v_mfma_f32_16x16x32_bf16 a[80:83], v[136:139], v[112:115], a[80:83]
    ds_read_b128 v[40:43], v8 offset:36864
    v_lshlrev_b32 v240, 16, v224
    v_mfma_f32_16x16x32_bf16 a[84:87], v[136:139], v[116:119], a[84:87]
    v_lshlrev_b32 v238, 16, v208
    v_lshlrev_b32 v239, 16, v216
    v_mfma_f32_16x16x32_bf16 a[88:91], v[136:139], v[120:123], a[88:91]
    ds_read_b64_tr_b16 v[80:81], v10 offset:2048
    v_fmac_f32 v236, v238, v240
    v_mfma_f32_16x16x32_bf16 a[92:95], v[136:139], v[124:127], a[92:95]
    buffer_load_dwordx4 v7, s[8:11], s37 offen offset:1024 nt lds
    v_mfma_f32_16x16x32_bf16 a[96:99], v[140:143], v[96:99], a[96:99]
    ds_read_b64_tr_b16 v[82:83], v10 offset:3072
    v_fmac_f32 v237, v239, v240
    v_mfma_f32_16x16x32_bf16 a[100:103], v[140:143], v[100:103], a[100:103]
    v_and_b32 v240, s52, v224
    v_and_b32 v238, s52, v208
    v_mfma_f32_16x16x32_bf16 a[104:107], v[140:143], v[104:107], a[104:107]
    s_add_u32 m0, s43, 51200
    ds_read_b128 v[44:47], v8 offset:38912
    v_and_b32 v239, s52, v216
    v_mfma_f32_16x16x32_bf16 a[108:111], v[140:143], v[108:111], a[108:111]
    buffer_load_dwordx4 v6, s[12:15], s37 offen offset:0 nt lds
    v_mfma_f32_16x16x32_bf16 a[112:115], v[140:143], v[112:115], a[112:115]
    ds_read_b64_tr_b16 v[84:85], v11 offset:2048
    v_fmac_f32 v236, v238, v240
    v_mfma_f32_16x16x32_bf16 a[116:119], v[140:143], v[116:119], a[116:119]
    v_fmac_f32 v237, v239, v240
    v_lshlrev_b32 v240, 16, v225
    v_mfma_f32_16x16x32_bf16 a[120:123], v[140:143], v[120:123], a[120:123]
    ds_read_b64_tr_b16 v[86:87], v11 offset:3072
    v_lshlrev_b32 v238, 16, v209
    v_mfma_f32_16x16x32_bf16 a[124:127], v[140:143], v[124:127], a[124:127]
    buffer_load_dwordx4 v7, s[12:15], s37 offen offset:1024 nt lds
    v_mfma_f32_16x16x32_bf16 a[128:131], v[96:99], v[144:147], a[128:131]
    ds_read_b128 v[48:51], v8 offset:40960
    v_lshlrev_b32 v239, 16, v217
    v_mfma_f32_16x16x32_bf16 a[132:135], v[100:103], v[144:147], a[132:135]
    v_fmac_f32 v236, v238, v240
    v_fmac_f32 v237, v239, v240
    v_mfma_f32_16x16x32_bf16 a[136:139], v[104:107], v[144:147], a[136:139]
    ds_read_b64_tr_b16 v[88:89], v12 offset:2048
    v_and_b32 v240, s52, v225
    v_mfma_f32_16x16x32_bf16 a[140:143], v[108:111], v[144:147], a[140:143]
    buffer_load_dwordx2 v[176:177], v0, s[16:19], s48 offen offset:2048 nt
    v_mfma_f32_16x16x32_bf16 a[144:147], v[112:115], v[144:147], a[144:147]
    ds_read_b64_tr_b16 v[90:91], v12 offset:3072
    v_and_b32 v238, s52, v209
    v_mfma_f32_16x16x32_bf16 a[148:151], v[116:119], v[144:147], a[148:151]
    v_and_b32 v239, s52, v217
    v_fmac_f32 v236, v238, v240
    v_mfma_f32_16x16x32_bf16 a[152:155], v[120:123], v[144:147], a[152:155]
    ds_read_b128 v[52:55], v8 offset:43008
    v_fmac_f32 v237, v239, v240
    v_mfma_f32_16x16x32_bf16 a[156:159], v[124:127], v[144:147], a[156:159]
    buffer_load_dwordx2 v[178:179], v0, s[16:19], s51 offen offset:0 nt
    v_mfma_f32_16x16x32_bf16 a[160:163], v[96:99], v[148:151], a[160:163]
    ds_read_b64_tr_b16 v[92:93], v13 offset:2048
    v_lshlrev_b32 v240, 16, v226
    v_mfma_f32_16x16x32_bf16 a[164:167], v[100:103], v[148:151], a[164:167]
    v_lshlrev_b32 v238, 16, v210
    v_lshlrev_b32 v239, 16, v218
    v_mfma_f32_16x16x32_bf16 a[168:171], v[104:107], v[148:151], a[168:171]
    ds_read_b64_tr_b16 v[94:95], v13 offset:3072
    v_fmac_f32 v236, v238, v240
    v_mfma_f32_16x16x32_bf16 a[172:175], v[108:111], v[148:151], a[172:175]
    buffer_load_dwordx2 v[180:181], v0, s[16:19], s51 offen offset:2048 nt
    v_mfma_f32_16x16x32_bf16 a[176:179], v[112:115], v[148:151], a[176:179]
    s_mov_b32 s16, s68
    ds_read_b128 v[56:59], v8 offset:45056
    v_fmac_f32 v237, v239, v240
    v_mfma_f32_16x16x32_bf16 a[180:183], v[116:119], v[148:151], a[180:183]
    s_mov_b32 s17, s69
    v_and_b32 v240, s52, v226
    v_and_b32 v238, s52, v210
    v_mfma_f32_16x16x32_bf16 a[184:187], v[120:123], v[148:151], a[184:187]
    ds_read_b128 v[60:63], v8 offset:47104
    v_and_b32 v239, s52, v218
    v_mfma_f32_16x16x32_bf16 a[188:191], v[124:127], v[148:151], a[188:191]
    v_mfma_f32_16x16x32_bf16 a[192:195], v[96:99], v[152:155], a[192:195]
    v_fmac_f32 v236, v238, v240
    v_fmac_f32 v237, v239, v240
    v_mfma_f32_16x16x32_bf16 a[196:199], v[100:103], v[152:155], a[196:199]
    v_lshlrev_b32 v240, 16, v227
    v_lshlrev_b32 v238, 16, v211
    v_mfma_f32_16x16x32_bf16 a[200:203], v[104:107], v[152:155], a[200:203]
    v_lshlrev_b32 v239, 16, v219
    v_fmac_f32 v236, v238, v240
    v_mfma_f32_16x16x32_bf16 a[204:207], v[108:111], v[152:155], a[204:207]
    v_mfma_f32_16x16x32_bf16 a[208:211], v[112:115], v[152:155], a[208:211]
    v_fmac_f32 v237, v239, v240
    v_and_b32 v240, s52, v227
    v_mfma_f32_16x16x32_bf16 a[212:215], v[116:119], v[152:155], a[212:215]
    v_and_b32 v238, s52, v211
    v_and_b32 v239, s52, v219
    v_mfma_f32_16x16x32_bf16 a[216:219], v[120:123], v[152:155], a[216:219]
    v_fmac_f32 v236, v238, v240
    v_fmac_f32 v237, v239, v240
    v_mfma_f32_16x16x32_bf16 a[220:223], v[124:127], v[152:155], a[220:223]
    v_mfma_f32_16x16x32_bf16 a[224:227], v[96:99], v[156:159], a[224:227]
    v_lshlrev_b32 v240, 16, v228
    v_lshlrev_b32 v238, 16, v212
    v_mfma_f32_16x16x32_bf16 a[228:231], v[100:103], v[156:159], a[228:231]
    v_lshlrev_b32 v239, 16, v220
    v_fmac_f32 v236, v238, v240
    v_mfma_f32_16x16x32_bf16 a[232:235], v[104:107], v[156:159], a[232:235]
    v_fmac_f32 v237, v239, v240
    v_and_b32 v240, s52, v228
    v_mfma_f32_16x16x32_bf16 a[236:239], v[108:111], v[156:159], a[236:239]
    buffer_load_dword v31, v254, s[20:23], s46 offen offset:0
    v_mfma_f32_16x16x32_bf16 a[240:243], v[112:115], v[156:159], a[240:243]
    s_add_u32 s46, s46, 1048576
    v_and_b32 v238, s52, v212
    v_and_b32 v239, s52, v220
    v_mfma_f32_16x16x32_bf16 a[244:247], v[116:119], v[156:159], a[244:247]
    v_fmac_f32 v236, v238, v240
    v_fmac_f32 v237, v239, v240
    v_mfma_f32_16x16x32_bf16 a[248:251], v[120:123], v[156:159], a[248:251]
    v_lshlrev_b32 v240, 16, v229
    v_lshlrev_b32 v238, 16, v213
    v_mfma_f32_16x16x32_bf16 a[252:255], v[124:127], v[156:159], a[252:255]
    s_waitcnt vmcnt(28) lgkmcnt(0)
    s_barrier
    v_lshlrev_b32 v239, 16, v221
    v_fmac_f32 v236, v238, v240
    v_mfma_f32_16x16x32_bf16 a[0:3], v[64:67], v[32:35], a[0:3]
    ds_read_b64_tr_b16 v[128:129], v10 offset:16384
    v_fmac_f32 v237, v239, v240
    v_mfma_f32_16x16x32_bf16 a[4:7], v[64:67], v[36:39], a[4:7]
    s_add_u32 s36, s35, 768
    s_and_b32 s36, s36, 1023
    s_add_u32 s36, s36, s59
    v_and_b32 v240, s52, v229
    v_and_b32 v238, s52, v213
    v_mfma_f32_16x16x32_bf16 a[8:11], v[64:67], v[40:43], a[8:11]
    s_add_u32 m0, s42, 4096
    ds_read_b64_tr_b16 v[130:131], v10 offset:17408
    v_and_b32 v239, s52, v221
    v_mfma_f32_16x16x32_bf16 a[12:15], v[64:67], v[44:47], a[12:15]
    buffer_load_dwordx4 v2, s[4:7], s36 offen offset:0 lds
    v_mfma_f32_16x16x32_bf16 a[16:19], v[64:67], v[48:51], a[16:19]
    ds_read_b64_tr_b16 v[132:133], v11 offset:16384
    v_fmac_f32 v236, v238, v240
    v_mfma_f32_16x16x32_bf16 a[20:23], v[64:67], v[52:55], a[20:23]
    v_fmac_f32 v237, v239, v240
    v_mfma_f32_16x16x32_bf16 a[24:27], v[64:67], v[56:59], a[24:27]
    ds_read_b64_tr_b16 v[134:135], v11 offset:17408
    v_mfma_f32_16x16x32_bf16 a[28:31], v[64:67], v[60:63], a[28:31]
    buffer_load_dwordx4 v3, s[4:7], s36 offen offset:1024 lds
    v_mfma_f32_16x16x32_bf16 a[32:35], v[68:71], v[32:35], a[32:35]
    ds_read_b128 v[96:99], v9 offset:32768
    v_add_f32_dpp v236, v236, v236 quad_perm:[1,0,3,2] row_mask:0xf bank_mask:0xf
    v_mfma_f32_16x16x32_bf16 a[36:39], v[68:71], v[36:39], a[36:39]
    v_add_f32_dpp v237, v237, v237 quad_perm:[1,0,3,2] row_mask:0xf bank_mask:0xf
    v_mfma_f32_16x16x32_bf16 a[40:43], v[68:71], v[40:43], a[40:43]
    ds_read_b64_tr_b16 v[136:137], v12 offset:16384
    v_mfma_f32_16x16x32_bf16 a[44:47], v[68:71], v[44:47], a[44:47]
    buffer_load_dwordx4 v4, s[4:7], s36 offen offset:2048 lds
    v_mfma_f32_16x16x32_bf16 a[48:51], v[68:71], v[48:51], a[48:51]
    ds_read_b64_tr_b16 v[138:139], v12 offset:17408
    v_add_f32_dpp v236, v236, v236 quad_perm:[2,3,0,1] row_mask:0xf bank_mask:0xf
    v_mfma_f32_16x16x32_bf16 a[52:55], v[68:71], v[52:55], a[52:55]
    v_add_f32_dpp v237, v237, v237 quad_perm:[2,3,0,1] row_mask:0xf bank_mask:0xf
    v_mfma_f32_16x16x32_bf16 a[56:59], v[68:71], v[56:59], a[56:59]
    ds_read_b128 v[100:103], v9 offset:34816
    v_mfma_f32_16x16x32_bf16 a[60:63], v[68:71], v[60:63], a[60:63]
    buffer_load_dwordx4 v5, s[4:7], s36 offen offset:3072 lds
    v_mfma_f32_16x16x32_bf16 a[64:67], v[72:75], v[32:35], a[64:67]
    ds_read_b64_tr_b16 v[140:141], v13 offset:16384
    v_add_f32_dpp v236, v236, v236 row_half_mirror row_mask:0xf bank_mask:0xf
    v_mfma_f32_16x16x32_bf16 a[68:71], v[72:75], v[36:39], a[68:71]
    s_add_u32 s37, s58, 3145728
    s_and_b32 s37, s37, 4194303
    s_add_u32 s37, s37, s39
    v_add_f32_dpp v237, v237, v237 row_half_mirror row_mask:0xf bank_mask:0xf
    v_mfma_f32_16x16x32_bf16 a[72:75], v[72:75], v[40:43], a[72:75]
    s_add_u32 m0, s43, 0
    ds_read_b64_tr_b16 v[142:143], v13 offset:17408
    v_mfma_f32_16x16x32_bf16 a[76:79], v[72:75], v[44:47], a[76:79]
    buffer_load_dwordx4 v6, s[8:11], s37 offen offset:0 nt lds
    v_mfma_f32_16x16x32_bf16 a[80:83], v[72:75], v[48:51], a[80:83]
    ds_read_b128 v[104:107], v9 offset:36864
    v_add_f32_dpp v236, v236, v236 row_mirror row_mask:0xf bank_mask:0xf
    v_mfma_f32_16x16x32_bf16 a[84:87], v[72:75], v[52:55], a[84:87]
    v_add_f32_dpp v237, v237, v237 row_mirror row_mask:0xf bank_mask:0xf
    v_mov_b32 v238, v236
    v_mfma_f32_16x16x32_bf16 a[88:91], v[72:75], v[56:59], a[88:91]
    ds_read_b64_tr_b16 v[144:145], v10 offset:18432
    v_mov_b32 v239, v237
    v_mfma_f32_16x16x32_bf16 a[92:95], v[72:75], v[60:63], a[92:95]
    buffer_load_dwordx4 v7, s[8:11], s37 offen offset:1024 nt lds
    v_mfma_f32_16x16x32_bf16 a[96:99], v[76:79], v[32:35], a[96:99]
    ds_read_b64_tr_b16 v[146:147], v10 offset:19456
    v_permlane16_swap_b32 v236, v238
    v_mfma_f32_16x16x32_bf16 a[100:103], v[76:79], v[36:39], a[100:103]
    v_permlane16_swap_b32 v237, v239
    v_mfma_f32_16x16x32_bf16 a[104:107], v[76:79], v[40:43], a[104:107]
    s_add_u32 m0, s43, 2048
    ds_read_b128 v[108:111], v9 offset:38912
    v_add_f32 v236, v236, v238
    v_mfma_f32_16x16x32_bf16 a[108:111], v[76:79], v[44:47], a[108:111]
    buffer_load_dwordx4 v6, s[12:15], s37 offen offset:0 nt lds
    v_mfma_f32_16x16x32_bf16 a[112:115], v[76:79], v[48:51], a[112:115]
    ds_read_b64_tr_b16 v[148:149], v11 offset:18432
    v_add_f32 v237, v237, v239
    v_mfma_f32_16x16x32_bf16 a[116:119], v[76:79], v[52:55], a[116:119]
    v_mov_b32 v238, v236
    v_mov_b32 v239, v237
    v_mfma_f32_16x16x32_bf16 a[120:123], v[76:79], v[56:59], a[120:123]
    ds_read_b64_tr_b16 v[150:151], v11 offset:19456
    v_mfma_f32_16x16x32_bf16 a[124:127], v[76:79], v[60:63], a[124:127]
    buffer_load_dwordx4 v7, s[12:15], s37 offen offset:1024 nt lds
    v_mfma_f32_16x16x32_bf16 a[128:131], v[32:35], v[80:83], a[128:131]
    ds_read_b128 v[112:115], v9 offset:40960
    v_permlane32_swap_b32 v236, v238
    v_mfma_f32_16x16x32_bf16 a[132:135], v[36:39], v[80:83], a[132:135]
    v_permlane32_swap_b32 v237, v239
    v_mfma_f32_16x16x32_bf16 a[136:139], v[40:43], v[80:83], a[136:139]
    ds_read_b64_tr_b16 v[152:153], v12 offset:18432
    v_add_f32 v236, v236, v238
    v_mfma_f32_16x16x32_bf16 a[140:143], v[44:47], v[80:83], a[140:143]
    buffer_load_dwordx2 v[182:183], v0, s[16:19], 0 offen offset:0 nt
    v_mfma_f32_16x16x32_bf16 a[144:147], v[48:51], v[80:83], a[144:147]
    ds_read_b64_tr_b16 v[154:155], v12 offset:19456
    v_add_f32 v237, v237, v239
    v_mfma_f32_16x16x32_bf16 a[148:151], v[52:55], v[80:83], a[148:151]
    v_mul_f32 v236, 0xbfb8aa3b, v236
    v_mul_f32 v237, 0xbfb8aa3b, v237
    v_mfma_f32_16x16x32_bf16 a[152:155], v[56:59], v[80:83], a[152:155]
    ds_read_b128 v[116:119], v9 offset:43008
    v_exp_f32 v236, v236
    v_mfma_f32_16x16x32_bf16 a[156:159], v[60:63], v[80:83], a[156:159]
    buffer_load_dwordx2 v[184:185], v0, s[16:19], 0 offen offset:2048 nt
    v_mfma_f32_16x16x32_bf16 a[160:163], v[32:35], v[84:87], a[160:163]
    ds_read_b64_tr_b16 v[156:157], v13 offset:18432
    v_exp_f32 v237, v237
    v_mfma_f32_16x16x32_bf16 a[164:167], v[36:39], v[84:87], a[164:167]
    v_mov_b32 v238, 0
    v_add_f32 v236, 1.0, v236
    v_mfma_f32_16x16x32_bf16 a[168:171], v[40:43], v[84:87], a[168:171]
    ds_read_b64_tr_b16 v[158:159], v13 offset:19456
    v_add_f32 v237, 1.0, v237
    v_mfma_f32_16x16x32_bf16 a[172:175], v[44:47], v[84:87], a[172:175]
    buffer_load_dwordx2 v[186:187], v0, s[16:19], s47 offen offset:0 nt
    v_mfma_f32_16x16x32_bf16 a[176:179], v[48:51], v[84:87], a[176:179]
    ds_read_b128 v[120:123], v9 offset:45056
    v_rcp_f32 v236, v236
    v_mfma_f32_16x16x32_bf16 a[180:183], v[52:55], v[84:87], a[180:183]
    v_rcp_f32 v237, v237
    v_mfma_f32_16x16x32_bf16 a[184:187], v[56:59], v[84:87], a[184:187]
    ds_read_b128 v[124:127], v9 offset:47104
    v_mfma_f32_16x16x32_bf16 a[188:191], v[60:63], v[84:87], a[188:191]
    v_mfma_f32_16x16x32_bf16 a[192:195], v[32:35], v[88:91], a[192:195]
    v_mfma_f32_16x16x32_bf16 a[196:199], v[36:39], v[88:91], a[196:199]
    v_mfma_f32_16x16x32_bf16 a[200:203], v[40:43], v[88:91], a[200:203]
    v_mfma_f32_16x16x32_bf16 a[204:207], v[44:47], v[88:91], a[204:207]
    v_mfma_f32_16x16x32_bf16 a[208:211], v[48:51], v[88:91], a[208:211]
    v_mfma_f32_16x16x32_bf16 a[212:215], v[52:55], v[88:91], a[212:215]
    v_mfma_f32_16x16x32_bf16 a[216:219], v[56:59], v[88:91], a[216:219]
    v_mfma_f32_16x16x32_bf16 a[220:223], v[60:63], v[88:91], a[220:223]
    v_mfma_f32_16x16x32_bf16 a[224:227], v[32:35], v[92:95], a[224:227]
    v_mfma_f32_16x16x32_bf16 a[228:231], v[36:39], v[92:95], a[228:231]
    v_mfma_f32_16x16x32_bf16 a[232:235], v[40:43], v[92:95], a[232:235]
    v_mfma_f32_16x16x32_bf16 a[236:239], v[44:47], v[92:95], a[236:239]
    buffer_load_dword v31, v254, s[20:23], s46 offen offset:0
    v_mfma_f32_16x16x32_bf16 a[240:243], v[48:51], v[92:95], a[240:243]
    s_add_u32 s46, s46, 1048576
    v_mfma_f32_16x16x32_bf16 a[244:247], v[52:55], v[92:95], a[244:247]
    v_mfma_f32_16x16x32_bf16 a[248:251], v[56:59], v[92:95], a[248:251]
    v_mfma_f32_16x16x32_bf16 a[252:255], v[60:63], v[92:95], a[252:255]
    s_waitcnt vmcnt(28) lgkmcnt(0)
    s_barrier
    v_mfma_f32_16x16x32_bf16 a[0:3], v[128:131], v[96:99], a[0:3]
    ds_read_b64_tr_b16 v[64:65], v10 offset:32768
    v_mfma_f32_16x16x32_bf16 a[4:7], v[128:131], v[100:103], a[4:7]
    s_add_u32 s36, s35, 896
    s_and_b32 s36, s36, 1023
    s_add_u32 s36, s36, s38
    v_mfma_f32_16x16x32_bf16 a[8:11], v[128:131], v[104:107], a[8:11]
    s_add_u32 m0, s42, 32768
    ds_read_b64_tr_b16 v[66:67], v10 offset:33792
    v_mfma_f32_16x16x32_bf16 a[12:15], v[128:131], v[108:111], a[12:15]
    buffer_load_dwordx4 v2, s[4:7], s36 offen offset:0 lds
    v_mfma_f32_16x16x32_bf16 a[16:19], v[128:131], v[112:115], a[16:19]
    ds_read_b64_tr_b16 v[68:69], v11 offset:32768
    v_mfma_f32_16x16x32_bf16 a[20:23], v[128:131], v[116:119], a[20:23]
    v_mfma_f32_16x16x32_bf16 a[24:27], v[128:131], v[120:123], a[24:27]
    ds_read_b64_tr_b16 v[70:71], v11 offset:33792
    v_mfma_f32_16x16x32_bf16 a[28:31], v[128:131], v[124:127], a[28:31]
    buffer_load_dwordx4 v3, s[4:7], s36 offen offset:1024 lds
    v_mfma_f32_16x16x32_bf16 a[32:35], v[132:135], v[96:99], a[32:35]
    ds_read_b128 v[32:35], v14 offset:0
    v_mfma_f32_16x16x32_bf16 a[36:39], v[132:135], v[100:103], a[36:39]
    v_mfma_f32_16x16x32_bf16 a[40:43], v[132:135], v[104:107], a[40:43]
    ds_read_b64_tr_b16 v[72:73], v12 offset:32768
    v_mfma_f32_16x16x32_bf16 a[44:47], v[132:135], v[108:111], a[44:47]
    buffer_load_dwordx4 v4, s[4:7], s36 offen offset:2048 lds
    v_mfma_f32_16x16x32_bf16 a[48:51], v[132:135], v[112:115], a[48:51]
    ds_read_b64_tr_b16 v[74:75], v12 offset:33792
    v_mfma_f32_16x16x32_bf16 a[52:55], v[132:135], v[116:119], a[52:55]
    v_mfma_f32_16x16x32_bf16 a[56:59], v[132:135], v[120:123], a[56:59]
    ds_read_b128 v[36:39], v14 offset:2048
    v_mfma_f32_16x16x32_bf16 a[60:63], v[132:135], v[124:127], a[60:63]
    buffer_load_dwordx4 v5, s[4:7], s36 offen offset:3072 lds
    v_mfma_f32_16x16x32_bf16 a[64:67], v[136:139], v[96:99], a[64:67]
    ds_read_b64_tr_b16 v[76:77], v13 offset:32768
    v_mfma_f32_16x16x32_bf16 a[68:71], v[136:139], v[100:103], a[68:71]
    s_add_u32 s37, s58, 3407872
    s_and_b32 s37, s37, 4194303
    s_add_u32 s37, s37, s39
    v_mfma_f32_16x16x32_bf16 a[72:75], v[136:139], v[104:107], a[72:75]
    s_add_u32 m0, s43, 16384
    ds_read_b64_tr_b16 v[78:79], v13 offset:33792
    v_mfma_f32_16x16x32_bf16 a[76:79], v[136:139], v[108:111], a[76:79]
    buffer_load_dwordx4 v6, s[8:11], s37 offen offset:0 nt lds
    v_mfma_f32_16x16x32_bf16 a[80:83], v[136:139], v[112:115], a[80:83]
    ds_read_b128 v[40:43], v14 offset:4096
    v_mfma_f32_16x16x32_bf16 a[84:87], v[136:139], v[116:119], a[84:87]
    v_mfma_f32_16x16x32_bf16 a[88:91], v[136:139], v[120:123], a[88:91]
    ds_read_b64_tr_b16 v[80:81], v10 offset:34816
    v_mfma_f32_16x16x32_bf16 a[92:95], v[136:139], v[124:127], a[92:95]
    buffer_load_dwordx4 v7, s[8:11], s37 offen offset:1024 nt lds
    v_mfma_f32_16x16x32_bf16 a[96:99], v[140:143], v[96:99], a[96:99]
    ds_read_b64_tr_b16 v[82:83], v10 offset:35840
    v_mfma_f32_16x16x32_bf16 a[100:103], v[140:143], v[100:103], a[100:103]
    v_mfma_f32_16x16x32_bf16 a[104:107], v[140:143], v[104:107], a[104:107]
    s_add_u32 m0, s43, 18432
    ds_read_b128 v[44:47], v14 offset:6144
    v_mfma_f32_16x16x32_bf16 a[108:111], v[140:143], v[108:111], a[108:111]
    buffer_load_dwordx4 v6, s[12:15], s37 offen offset:0 nt lds
    v_mfma_f32_16x16x32_bf16 a[112:115], v[140:143], v[112:115], a[112:115]
    ds_read_b64_tr_b16 v[84:85], v11 offset:34816
    v_mfma_f32_16x16x32_bf16 a[116:119], v[140:143], v[116:119], a[116:119]
    v_mfma_f32_16x16x32_bf16 a[120:123], v[140:143], v[120:123], a[120:123]
    ds_read_b64_tr_b16 v[86:87], v11 offset:35840
    v_mfma_f32_16x16x32_bf16 a[124:127], v[140:143], v[124:127], a[124:127]
    buffer_load_dwordx4 v7, s[12:15], s37 offen offset:1024 nt lds
    v_mfma_f32_16x16x32_bf16 a[128:131], v[96:99], v[144:147], a[128:131]
    ds_read_b128 v[48:51], v14 offset:8192
    v_mfma_f32_16x16x32_bf16 a[132:135], v[100:103], v[144:147], a[132:135]
    v_mfma_f32_16x16x32_bf16 a[136:139], v[104:107], v[144:147], a[136:139]
    ds_read_b64_tr_b16 v[88:89], v12 offset:34816
    v_mfma_f32_16x16x32_bf16 a[140:143], v[108:111], v[144:147], a[140:143]
    buffer_load_dwordx2 v[188:189], v0, s[16:19], s47 offen offset:2048 nt
    v_mfma_f32_16x16x32_bf16 a[144:147], v[112:115], v[144:147], a[144:147]
    ds_read_b64_tr_b16 v[90:91], v12 offset:35840
    v_mfma_f32_16x16x32_bf16 a[148:151], v[116:119], v[144:147], a[148:151]
    v_mfma_f32_16x16x32_bf16 a[152:155], v[120:123], v[144:147], a[152:155]
    ds_read_b128 v[52:55], v14 offset:10240
    v_mfma_f32_16x16x32_bf16 a[156:159], v[124:127], v[144:147], a[156:159]
    buffer_load_dwordx2 v[190:191], v0, s[16:19], s48 offen offset:0 nt
    v_mfma_f32_16x16x32_bf16 a[160:163], v[96:99], v[148:151], a[160:163]
    ds_read_b64_tr_b16 v[92:93], v13 offset:34816
    v_mfma_f32_16x16x32_bf16 a[164:167], v[100:103], v[148:151], a[164:167]
    v_mfma_f32_16x16x32_bf16 a[168:171], v[104:107], v[148:151], a[168:171]
    ds_read_b64_tr_b16 v[94:95], v13 offset:35840
    v_mfma_f32_16x16x32_bf16 a[172:175], v[108:111], v[148:151], a[172:175]
    buffer_load_dwordx2 v[192:193], v0, s[16:19], s48 offen offset:2048 nt
    v_mfma_f32_16x16x32_bf16 a[176:179], v[112:115], v[148:151], a[176:179]
    ds_read_b128 v[56:59], v14 offset:12288
    v_mfma_f32_16x16x32_bf16 a[180:183], v[116:119], v[148:151], a[180:183]
    v_mfma_f32_16x16x32_bf16 a[184:187], v[120:123], v[148:151], a[184:187]
    ds_read_b128 v[60:63], v14 offset:14336
    v_mfma_f32_16x16x32_bf16 a[188:191], v[124:127], v[148:151], a[188:191]
    v_mfma_f32_16x16x32_bf16 a[192:195], v[96:99], v[152:155], a[192:195]
    v_mfma_f32_16x16x32_bf16 a[196:199], v[100:103], v[152:155], a[196:199]
    v_mfma_f32_16x16x32_bf16 a[200:203], v[104:107], v[152:155], a[200:203]
    v_mfma_f32_16x16x32_bf16 a[204:207], v[108:111], v[152:155], a[204:207]
    v_mfma_f32_16x16x32_bf16 a[208:211], v[112:115], v[152:155], a[208:211]
    v_mfma_f32_16x16x32_bf16 a[212:215], v[116:119], v[152:155], a[212:215]
    v_mfma_f32_16x16x32_bf16 a[216:219], v[120:123], v[152:155], a[216:219]
    v_mfma_f32_16x16x32_bf16 a[220:223], v[124:127], v[152:155], a[220:223]
    v_mfma_f32_16x16x32_bf16 a[224:227], v[96:99], v[156:159], a[224:227]
    v_mfma_f32_16x16x32_bf16 a[228:231], v[100:103], v[156:159], a[228:231]
    v_mfma_f32_16x16x32_bf16 a[232:235], v[104:107], v[156:159], a[232:235]
    v_mfma_f32_16x16x32_bf16 a[236:239], v[108:111], v[156:159], a[236:239]
    v_mfma_f32_16x16x32_bf16 a[240:243], v[112:115], v[156:159], a[240:243]
    v_mfma_f32_16x16x32_bf16 a[244:247], v[116:119], v[156:159], a[244:247]
    v_mfma_f32_16x16x32_bf16 a[248:251], v[120:123], v[156:159], a[248:251]
    v_mfma_f32_16x16x32_bf16 a[252:255], v[124:127], v[156:159], a[252:255]
    s_waitcnt vmcnt(27) lgkmcnt(0)
    s_barrier
    v_mfma_f32_16x16x32_bf16 a[0:3], v[64:67], v[32:35], a[0:3]
    ds_read_b64_tr_b16 v[128:129], v10 offset:49152
    v_mfma_f32_16x16x32_bf16 a[4:7], v[64:67], v[36:39], a[4:7]
    s_add_u32 s36, s35, 896
    s_and_b32 s36, s36, 1023
    s_add_u32 s36, s36, s59
    v_mfma_f32_16x16x32_bf16 a[8:11], v[64:67], v[40:43], a[8:11]
    s_add_u32 m0, s42, 36864
    ds_read_b64_tr_b16 v[130:131], v10 offset:50176
    v_mfma_f32_16x16x32_bf16 a[12:15], v[64:67], v[44:47], a[12:15]
    buffer_load_dwordx4 v2, s[4:7], s36 offen offset:0 lds
    v_mfma_f32_16x16x32_bf16 a[16:19], v[64:67], v[48:51], a[16:19]
    ds_read_b64_tr_b16 v[132:133], v11 offset:49152
    v_mfma_f32_16x16x32_bf16 a[20:23], v[64:67], v[52:55], a[20:23]
    v_mfma_f32_16x16x32_bf16 a[24:27], v[64:67], v[56:59], a[24:27]
    ds_read_b64_tr_b16 v[134:135], v11 offset:50176
    v_mfma_f32_16x16x32_bf16 a[28:31], v[64:67], v[60:63], a[28:31]
    buffer_load_dwordx4 v3, s[4:7], s36 offen offset:1024 lds
    v_mfma_f32_16x16x32_bf16 a[32:35], v[68:71], v[32:35], a[32:35]
    ds_read_b128 v[96:99], v15 offset:0
    v_mfma_f32_16x16x32_bf16 a[36:39], v[68:71], v[36:39], a[36:39]
    v_mfma_f32_16x16x32_bf16 a[40:43], v[68:71], v[40:43], a[40:43]
    ds_read_b64_tr_b16 v[136:137], v12 offset:49152
    v_mfma_f32_16x16x32_bf16 a[44:47], v[68:71], v[44:47], a[44:47]
    buffer_load_dwordx4 v4, s[4:7], s36 offen offset:2048 lds
    v_mfma_f32_16x16x32_bf16 a[48:51], v[68:71], v[48:51], a[48:51]
    ds_read_b64_tr_b16 v[138:139], v12 offset:50176
    v_mfma_f32_16x16x32_bf16 a[52:55], v[68:71], v[52:55], a[52:55]
    v_mfma_f32_16x16x32_bf16 a[56:59], v[68:71], v[56:59], a[56:59]
    ds_read_b128 v[100:103], v15 offset:2048
    v_mfma_f32_16x16x32_bf16 a[60:63], v[68:71], v[60:63], a[60:63]
    buffer_load_dwordx4 v5, s[4:7], s36 offen offset:3072 lds
    v_mfma_f32_16x16x32_bf16 a[64:67], v[72:75], v[32:35], a[64:67]
    ds_read_b64_tr_b16 v[140:141], v13 offset:49152
    v_mfma_f32_16x16x32_bf16 a[68:71], v[72:75], v[36:39], a[68:71]
    s_add_u32 s37, s58, 3670016
    s_and_b32 s37, s37, 4194303
    s_add_u32 s37, s37, s39
    v_mfma_f32_16x16x32_bf16 a[72:75], v[72:75], v[40:43], a[72:75]
    s_add_u32 m0, s43, 32768
    ds_read_b64_tr_b16 v[142:143], v13 offset:50176
    v_mfma_f32_16x16x32_bf16 a[76:79], v[72:75], v[44:47], a[76:79]
    buffer_load_dwordx4 v6, s[8:11], s37 offen offset:0 nt lds
    v_mfma_f32_16x16x32_bf16 a[80:83], v[72:75], v[48:51], a[80:83]
    ds_read_b128 v[104:107], v15 offset:4096
    v_mfma_f32_16x16x32_bf16 a[84:87], v[72:75], v[52:55], a[84:87]
    v_mfma_f32_16x16x32_bf16 a[88:91], v[72:75], v[56:59], a[88:91]
    ds_read_b64_tr_b16 v[144:145], v10 offset:51200
    v_mfma_f32_16x16x32_bf16 a[92:95], v[72:75], v[60:63], a[92:95]
    buffer_load_dwordx4 v7, s[8:11], s37 offen offset:1024 nt lds
    v_mfma_f32_16x16x32_bf16 a[96:99], v[76:79], v[32:35], a[96:99]
    ds_read_b64_tr_b16 v[146:147], v10 offset:52224
    v_mfma_f32_16x16x32_bf16 a[100:103], v[76:79], v[36:39], a[100:103]
    v_mfma_f32_16x16x32_bf16 a[104:107], v[76:79], v[40:43], a[104:107]
    s_add_u32 m0, s43, 34816
    ds_read_b128 v[108:111], v15 offset:6144
    v_mfma_f32_16x16x32_bf16 a[108:111], v[76:79], v[44:47], a[108:111]
    buffer_load_dwordx4 v6, s[12:15], s37 offen offset:0 nt lds
    v_mfma_f32_16x16x32_bf16 a[112:115], v[76:79], v[48:51], a[112:115]
    ds_read_b64_tr_b16 v[148:149], v11 offset:51200
    v_mfma_f32_16x16x32_bf16 a[116:119], v[76:79], v[52:55], a[116:119]
    v_mfma_f32_16x16x32_bf16 a[120:123], v[76:79], v[56:59], a[120:123]
    ds_read_b64_tr_b16 v[150:151], v11 offset:52224
    v_mfma_f32_16x16x32_bf16 a[124:127], v[76:79], v[60:63], a[124:127]
    buffer_load_dwordx4 v7, s[12:15], s37 offen offset:1024 nt lds
    v_mfma_f32_16x16x32_bf16 a[128:131], v[32:35], v[80:83], a[128:131]
    ds_read_b128 v[112:115], v15 offset:8192
    v_mfma_f32_16x16x32_bf16 a[132:135], v[36:39], v[80:83], a[132:135]
    v_mfma_f32_16x16x32_bf16 a[136:139], v[40:43], v[80:83], a[136:139]
    ds_read_b64_tr_b16 v[152:153], v12 offset:51200
    v_mfma_f32_16x16x32_bf16 a[140:143], v[44:47], v[80:83], a[140:143]
    buffer_load_dwordx2 v[194:195], v0, s[16:19], s51 offen offset:0 nt
    v_mfma_f32_16x16x32_bf16 a[144:147], v[48:51], v[80:83], a[144:147]
    ds_read_b64_tr_b16 v[154:155], v12 offset:52224
    v_mfma_f32_16x16x32_bf16 a[148:151], v[52:55], v[80:83], a[148:151]
    v_mfma_f32_16x16x32_bf16 a[152:155], v[56:59], v[80:83], a[152:155]
    ds_read_b128 v[116:119], v15 offset:10240
    v_mfma_f32_16x16x32_bf16 a[156:159], v[60:63], v[80:83], a[156:159]
    buffer_load_dwordx2 v[196:197], v0, s[16:19], s51 offen offset:2048 nt
    v_mfma_f32_16x16x32_bf16 a[160:163], v[32:35], v[84:87], a[160:163]
    s_add_u32 s16, s94, 59768832
    s_addc_u32 s17, s95, 0
    ds_read_b64_tr_b16 v[156:157], v13 offset:51200
    v_mfma_f32_16x16x32_bf16 a[164:167], v[36:39], v[84:87], a[164:167]
    s_mov_b32 s18, 8192
    v_mfma_f32_16x16x32_bf16 a[168:171], v[40:43], v[84:87], a[168:171]
    s_lshr_b32 s40, s40, 9
    ds_read_b64_tr_b16 v[158:159], v13 offset:52224
    v_mfma_f32_16x16x32_bf16 a[172:175], v[44:47], v[84:87], a[172:175]
    v_mfma_f32_16x16x32_bf16 a[176:179], v[48:51], v[84:87], a[176:179]
    s_lshr_b32 s41, s41, 9
    ds_read_b128 v[120:123], v15 offset:12288
    v_mfma_f32_16x16x32_bf16 a[180:183], v[52:55], v[84:87], a[180:183]
    v_mfma_f32_16x16x32_bf16 a[184:187], v[56:59], v[84:87], a[184:187]
    ds_read_b128 v[124:127], v15 offset:14336
    v_mfma_f32_16x16x32_bf16 a[188:191], v[60:63], v[84:87], a[188:191]
    buffer_store_dword v236, v238, s[16:19], s40 offen sc1
    v_mfma_f32_16x16x32_bf16 a[192:195], v[32:35], v[88:91], a[192:195]
    v_mfma_f32_16x16x32_bf16 a[196:199], v[36:39], v[88:91], a[196:199]
    v_mfma_f32_16x16x32_bf16 a[200:203], v[40:43], v[88:91], a[200:203]
    v_mfma_f32_16x16x32_bf16 a[204:207], v[44:47], v[88:91], a[204:207]
    buffer_store_dword v237, v238, s[16:19], s41 offen sc1
    v_mfma_f32_16x16x32_bf16 a[208:211], v[48:51], v[88:91], a[208:211]
    s_add_u32 s16, s94, 50331648
    s_addc_u32 s17, s95, 0
    v_mfma_f32_16x16x32_bf16 a[212:215], v[52:55], v[88:91], a[212:215]
    s_mov_b32 s18, 4718592
    v_mfma_f32_16x16x32_bf16 a[216:219], v[56:59], v[88:91], a[216:219]
    v_mfma_f32_16x16x32_bf16 a[220:223], v[60:63], v[88:91], a[220:223]
    v_mfma_f32_16x16x32_bf16 a[224:227], v[32:35], v[92:95], a[224:227]
    v_mfma_f32_16x16x32_bf16 a[228:231], v[36:39], v[92:95], a[228:231]
    v_mfma_f32_16x16x32_bf16 a[232:235], v[40:43], v[92:95], a[232:235]
    v_mfma_f32_16x16x32_bf16 a[236:239], v[44:47], v[92:95], a[236:239]
    buffer_load_dword v31, v254, s[20:23], s46 offen offset:0
    v_mfma_f32_16x16x32_bf16 a[240:243], v[48:51], v[92:95], a[240:243]
    s_add_u32 s46, s46, 1048576
    v_mfma_f32_16x16x32_bf16 a[244:247], v[52:55], v[92:95], a[244:247]
    v_mfma_f32_16x16x32_bf16 a[248:251], v[56:59], v[92:95], a[248:251]
    v_mfma_f32_16x16x32_bf16 a[252:255], v[60:63], v[92:95], a[252:255]
    s_waitcnt vmcnt(28) lgkmcnt(0)
    s_barrier
    v_mfma_f32_16x16x32_bf16 a[0:3], v[128:131], v[96:99], a[0:3]
    ds_read_b64_tr_b16 v[64:65], v10 offset:0
    v_mfma_f32_16x16x32_bf16 a[4:7], v[128:131], v[100:103], a[4:7]
    s_add_u32 s36, s44, 0
    v_mfma_f32_16x16x32_bf16 a[8:11], v[128:131], v[104:107], a[8:11]
    s_add_u32 m0, s42, 65536
    ds_read_b64_tr_b16 v[66:67], v10 offset:1024
    v_mfma_f32_16x16x32_bf16 a[12:15], v[128:131], v[108:111], a[12:15]
    buffer_load_dwordx4 v17, s[24:27], s36 offen offset:0 lds
    v_mfma_f32_16x16x32_bf16 a[16:19], v[128:131], v[112:115], a[16:19]
    ds_read_b64_tr_b16 v[68:69], v11 offset:0
    v_mfma_f32_16x16x32_bf16 a[20:23], v[128:131], v[116:119], a[20:23]
    v_mfma_f32_16x16x32_bf16 a[24:27], v[128:131], v[120:123], a[24:27]
    ds_read_b64_tr_b16 v[70:71], v11 offset:1024
    v_mfma_f32_16x16x32_bf16 a[28:31], v[128:131], v[124:127], a[28:31]
    buffer_load_dwordx4 v18, s[24:27], s36 offen offset:1024 lds
    v_mfma_f32_16x16x32_bf16 a[32:35], v[132:135], v[96:99], a[32:35]
    ds_read_b128 v[32:35], v8 offset:0
    v_mfma_f32_16x16x32_bf16 a[36:39], v[132:135], v[100:103], a[36:39]
    v_mfma_f32_16x16x32_bf16 a[40:43], v[132:135], v[104:107], a[40:43]
    ds_read_b64_tr_b16 v[72:73], v12 offset:0
    v_mfma_f32_16x16x32_bf16 a[44:47], v[132:135], v[108:111], a[44:47]
    buffer_load_dwordx4 v19, s[24:27], s36 offen offset:2048 lds
    v_mfma_f32_16x16x32_bf16 a[48:51], v[132:135], v[112:115], a[48:51]
    ds_read_b64_tr_b16 v[74:75], v12 offset:1024
    v_mfma_f32_16x16x32_bf16 a[52:55], v[132:135], v[116:119], a[52:55]
    v_mfma_f32_16x16x32_bf16 a[56:59], v[132:135], v[120:123], a[56:59]
    ds_read_b128 v[36:39], v8 offset:2048
    v_mfma_f32_16x16x32_bf16 a[60:63], v[132:135], v[124:127], a[60:63]
    buffer_load_dwordx4 v20, s[24:27], s36 offen offset:3072 lds
    v_mfma_f32_16x16x32_bf16 a[64:67], v[136:139], v[96:99], a[64:67]
    ds_read_b64_tr_b16 v[76:77], v13 offset:0
    v_mfma_f32_16x16x32_bf16 a[68:71], v[136:139], v[100:103], a[68:71]
    s_add_u32 s37, s58, 3932160
    s_and_b32 s37, s37, 4194303
    s_add_u32 s37, s37, s39
    v_mfma_f32_16x16x32_bf16 a[72:75], v[136:139], v[104:107], a[72:75]
    s_add_u32 m0, s43, 49152
    ds_read_b64_tr_b16 v[78:79], v13 offset:1024
    v_mfma_f32_16x16x32_bf16 a[76:79], v[136:139], v[108:111], a[76:79]
    buffer_load_dwordx4 v6, s[8:11], s37 offen offset:0 nt lds
    v_mfma_f32_16x16x32_bf16 a[80:83], v[136:139], v[112:115], a[80:83]
    ds_read_b128 v[40:43], v8 offset:4096
    v_mfma_f32_16x16x32_bf16 a[84:87], v[136:139], v[116:119], a[84:87]
    v_mfma_f32_16x16x32_bf16 a[88:91], v[136:139], v[120:123], a[88:91]
    ds_read_b64_tr_b16 v[80:81], v10 offset:2048
    v_mfma_f32_16x16x32_bf16 a[92:95], v[136:139], v[124:127], a[92:95]
    buffer_load_dwordx4 v7, s[8:11], s37 offen offset:1024 nt lds
    v_mfma_f32_16x16x32_bf16 a[96:99], v[140:143], v[96:99], a[96:99]
    ds_read_b64_tr_b16 v[82:83], v10 offset:3072
    v_mfma_f32_16x16x32_bf16 a[100:103], v[140:143], v[100:103], a[100:103]
    v_mfma_f32_16x16x32_bf16 a[104:107], v[140:143], v[104:107], a[104:107]
    s_add_u32 m0, s43, 51200
    ds_read_b128 v[44:47], v8 offset:6144
    v_mfma_f32_16x16x32_bf16 a[108:111], v[140:143], v[108:111], a[108:111]
    buffer_load_dwordx4 v6, s[12:15], s37 offen offset:0 nt lds
    v_mfma_f32_16x16x32_bf16 a[112:115], v[140:143], v[112:115], a[112:115]
    ds_read_b64_tr_b16 v[84:85], v11 offset:2048
    v_mfma_f32_16x16x32_bf16 a[116:119], v[140:143], v[116:119], a[116:119]
    v_mfma_f32_16x16x32_bf16 a[120:123], v[140:143], v[120:123], a[120:123]
    ds_read_b64_tr_b16 v[86:87], v11 offset:3072
    v_mov_b32 v241, 0
    v_mfma_f32_16x16x32_bf16 a[124:127], v[140:143], v[124:127], a[124:127]
    buffer_load_dwordx4 v7, s[12:15], s37 offen offset:1024 nt lds
    v_mfma_f32_16x16x32_bf16 a[128:131], v[96:99], v[144:147], a[128:131]
    ds_read_b128 v[48:51], v8 offset:8192
    v_mfma_f32_16x16x32_bf16 a[132:135], v[100:103], v[144:147], a[132:135]
    v_mfma_f32_16x16x32_bf16 a[136:139], v[104:107], v[144:147], a[136:139]
    ds_read_b64_tr_b16 v[88:89], v12 offset:2048
    v_mfma_f32_16x16x32_bf16 a[140:143], v[108:111], v[144:147], a[140:143]
    buffer_store_dword v241, v241, s[28:31], s55 offen sc1
    v_mfma_f32_16x16x32_bf16 a[144:147], v[112:115], v[144:147], a[144:147]
    ds_read_b64_tr_b16 v[90:91], v12 offset:3072
    v_mfma_f32_16x16x32_bf16 a[148:151], v[116:119], v[144:147], a[148:151]
    v_mfma_f32_16x16x32_bf16 a[152:155], v[120:123], v[144:147], a[152:155]
    ds_read_b128 v[52:55], v8 offset:10240
    v_mfma_f32_16x16x32_bf16 a[156:159], v[124:127], v[144:147], a[156:159]
    buffer_store_dword v241, v241, s[28:31], s56 offen sc1
    v_mfma_f32_16x16x32_bf16 a[160:163], v[96:99], v[148:151], a[160:163]
    ds_read_b64_tr_b16 v[92:93], v13 offset:2048
    v_mfma_f32_16x16x32_bf16 a[164:167], v[100:103], v[148:151], a[164:167]
    v_mfma_f32_16x16x32_bf16 a[168:171], v[104:107], v[148:151], a[168:171]
    ds_read_b64_tr_b16 v[94:95], v13 offset:3072
    v_mfma_f32_16x16x32_bf16 a[172:175], v[108:111], v[148:151], a[172:175]
    buffer_store_dword v241, v241, s[28:31], s57 offen sc1
    v_mfma_f32_16x16x32_bf16 a[176:179], v[112:115], v[148:151], a[176:179]
    ds_read_b128 v[56:59], v8 offset:12288
    v_mfma_f32_16x16x32_bf16 a[180:183], v[116:119], v[148:151], a[180:183]
    v_mfma_f32_16x16x32_bf16 a[184:187], v[120:123], v[148:151], a[184:187]
    ds_read_b128 v[60:63], v8 offset:14336
    v_mfma_f32_16x16x32_bf16 a[188:191], v[124:127], v[148:151], a[188:191]
    v_mfma_f32_16x16x32_bf16 a[192:195], v[96:99], v[152:155], a[192:195]
    v_mfma_f32_16x16x32_bf16 a[196:199], v[100:103], v[152:155], a[196:199]
    v_mfma_f32_16x16x32_bf16 a[200:203], v[104:107], v[152:155], a[200:203]
    v_mfma_f32_16x16x32_bf16 a[204:207], v[108:111], v[152:155], a[204:207]
    v_mfma_f32_16x16x32_bf16 a[208:211], v[112:115], v[152:155], a[208:211]
    v_mfma_f32_16x16x32_bf16 a[212:215], v[116:119], v[152:155], a[212:215]
    v_mfma_f32_16x16x32_bf16 a[216:219], v[120:123], v[152:155], a[216:219]
    v_mfma_f32_16x16x32_bf16 a[220:223], v[124:127], v[152:155], a[220:223]
    v_mfma_f32_16x16x32_bf16 a[224:227], v[96:99], v[156:159], a[224:227]
    v_mfma_f32_16x16x32_bf16 a[228:231], v[100:103], v[156:159], a[228:231]
    v_mfma_f32_16x16x32_bf16 a[232:235], v[104:107], v[156:159], a[232:235]
    v_mfma_f32_16x16x32_bf16 a[236:239], v[108:111], v[156:159], a[236:239]
    buffer_load_dword v31, v254, s[20:23], s46 offen offset:0
    v_mfma_f32_16x16x32_bf16 a[240:243], v[112:115], v[156:159], a[240:243]
    s_add_u32 s46, s46, 1048576
    v_mfma_f32_16x16x32_bf16 a[244:247], v[116:119], v[156:159], a[244:247]
    v_mfma_f32_16x16x32_bf16 a[248:251], v[120:123], v[156:159], a[248:251]
    v_mfma_f32_16x16x32_bf16 a[252:255], v[124:127], v[156:159], a[252:255]
    s_waitcnt vmcnt(15) lgkmcnt(0)
    s_barrier
    v_mfma_f32_16x16x32_bf16 a[0:3], v[64:67], v[32:35], a[0:3]
    ds_read_b64_tr_b16 v[128:129], v10 offset:16384
    v_lshlrev_b32 v206, 16, v160
    v_mfma_f32_16x16x32_bf16 a[4:7], v[64:67], v[36:39], a[4:7]
    s_add_u32 s36, s45, 0
    v_lshlrev_b32 v207, 16, v162
    v_lshlrev_b32 v208, 16, v164
    v_mfma_f32_16x16x32_bf16 a[8:11], v[64:67], v[40:43], a[8:11]
    s_add_u32 m0, s42, 69632
    ds_read_b64_tr_b16 v[130:131], v10 offset:17408
    v_lshlrev_b32 v209, 16, v166
    v_mfma_f32_16x16x32_bf16 a[12:15], v[64:67], v[44:47], a[12:15]
    buffer_load_dwordx4 v17, s[24:27], s36 offen offset:0 lds
    v_mfma_f32_16x16x32_bf16 a[16:19], v[64:67], v[48:51], a[16:19]
    ds_read_b64_tr_b16 v[132:133], v11 offset:16384
    v_lshlrev_b32 v210, 16, v168
    v_mfma_f32_16x16x32_bf16 a[20:23], v[64:67], v[52:55], a[20:23]
    v_lshlrev_b32 v211, 16, v170
    v_lshlrev_b32 v212, 16, v172
    v_mfma_f32_16x16x32_bf16 a[24:27], v[64:67], v[56:59], a[24:27]
    ds_read_b64_tr_b16 v[134:135], v11 offset:17408
    v_lshlrev_b32 v213, 16, v174
    v_mfma_f32_16x16x32_bf16 a[28:31], v[64:67], v[60:63], a[28:31]
    buffer_load_dwordx4 v18, s[24:27], s36 offen offset:1024 lds
    v_mfma_f32_16x16x32_bf16 a[32:35], v[68:71], v[32:35], a[32:35]
    ds_read_b128 v[96:99], v9 offset:0
    v_lshlrev_b32 v214, 16, v176
    v_mfma_f32_16x16x32_bf16 a[36:39], v[68:71], v[36:39], a[36:39]
    v_lshlrev_b32 v215, 16, v178
    v_lshlrev_b32 v216, 16, v180
    v_mfma_f32_16x16x32_bf16 a[40:43], v[68:71], v[40:43], a[40:43]
    ds_read_b64_tr_b16 v[136:137], v12 offset:16384
    v_lshlrev_b32 v217, 16, v198
    v_mfma_f32_16x16x32_bf16 a[44:47], v[68:71], v[44:47], a[44:47]
    buffer_load_dwordx4 v19, s[24:27], s36 offen offset:2048 lds
    v_mfma_f32_16x16x32_bf16 a[48:51], v[68:71], v[48:51], a[48:51]
    ds_read_b64_tr_b16 v[138:139], v12 offset:17408
    v_and_b32 v218, s52, v198
    v_mfma_f32_16x16x32_bf16 a[52:55], v[68:71], v[52:55], a[52:55]
    v_lshlrev_b32 v219, 16, v199
    v_and_b32 v220, s52, v199
    v_mfma_f32_16x16x32_bf16 a[56:59], v[68:71], v[56:59], a[56:59]
    ds_read_b128 v[100:103], v9 offset:2048
    v_mul_f32 v221, v209, v217
    v_mfma_f32_16x16x32_bf16 a[60:63], v[68:71], v[60:63], a[60:63]
    buffer_load_dwordx4 v20, s[24:27], s36 offen offset:3072 lds
    v_mfma_f32_16x16x32_bf16 a[64:67], v[72:75], v[32:35], a[64:67]
    ds_read_b64_tr_b16 v[140:141], v13 offset:16384
    v_mul_f32 v222, v210, v217
    v_mfma_f32_16x16x32_bf16 a[68:71], v[72:75], v[36:39], a[68:71]
    s_add_u32 s37, s49, 0
    v_mul_f32 v223, v211, v217
    v_mul_f32 v224, v212, v217
    v_mfma_f32_16x16x32_bf16 a[72:75], v[72:75], v[40:43], a[72:75]
    s_add_u32 m0, s50, 0
    ds_read_b64_tr_b16 v[142:143], v13 offset:17408
    v_mul_f32 v225, v213, v217
    v_mfma_f32_16x16x32_bf16 a[76:79], v[72:75], v[44:47], a[76:79]
    buffer_load_dwordx4 v21, s[20:23], s37 offen offset:0 lds
    v_mfma_f32_16x16x32_bf16 a[80:83], v[72:75], v[48:51], a[80:83]
    ds_read_b128 v[104:107], v9 offset:4096
    v_mul_f32 v226, v214, v217
    v_mfma_f32_16x16x32_bf16 a[84:87], v[72:75], v[52:55], a[84:87]
    v_mul_f32 v227, v215, v217
    v_mul_f32 v228, v216, v217
    v_mfma_f32_16x16x32_bf16 a[88:91], v[72:75], v[56:59], a[88:91]
    ds_read_b64_tr_b16 v[144:145], v10 offset:18432
    v_fmac_f32 v221, v208, v218
    v_mfma_f32_16x16x32_bf16 a[92:95], v[72:75], v[60:63], a[92:95]
    buffer_load_dwordx4 v22, s[20:23], s37 offen offset:1024 lds
    v_mfma_f32_16x16x32_bf16 a[96:99], v[76:79], v[32:35], a[96:99]
    ds_read_b64_tr_b16 v[146:147], v10 offset:19456
    v_fmac_f32 v222, v209, v218
    v_mfma_f32_16x16x32_bf16 a[100:103], v[76:79], v[36:39], a[100:103]
    v_fmac_f32 v223, v210, v218
    v_fmac_f32 v224, v211, v218
    v_mfma_f32_16x16x32_bf16 a[104:107], v[76:79], v[40:43], a[104:107]
    ds_read_b128 v[108:111], v9 offset:6144
    v_fmac_f32 v225, v212, v218
    v_mfma_f32_16x16x32_bf16 a[108:111], v[76:79], v[44:47], a[108:111]
    v_mfma_f32_16x16x32_bf16 a[112:115], v[76:79], v[48:51], a[112:115]
    ds_read_b64_tr_b16 v[148:149], v11 offset:18432
    v_fmac_f32 v226, v213, v218
    v_mfma_f32_16x16x32_bf16 a[116:119], v[76:79], v[52:55], a[116:119]
    v_fmac_f32 v227, v214, v218
    v_fmac_f32 v228, v215, v218
    v_mfma_f32_16x16x32_bf16 a[120:123], v[76:79], v[56:59], a[120:123]
    ds_read_b64_tr_b16 v[150:151], v11 offset:19456
    v_fmac_f32 v221, v207, v219
    v_mfma_f32_16x16x32_bf16 a[124:127], v[76:79], v[60:63], a[124:127]
    v_mfma_f32_16x16x32_bf16 a[128:131], v[32:35], v[80:83], a[128:131]
    ds_read_b128 v[112:115], v9 offset:8192
    v_fmac_f32 v222, v208, v219
    v_mfma_f32_16x16x32_bf16 a[132:135], v[36:39], v[80:83], a[132:135]
    v_fmac_f32 v223, v209, v219
    v_fmac_f32 v224, v210, v219
    v_mfma_f32_16x16x32_bf16 a[136:139], v[40:43], v[80:83], a[136:139]
    ds_read_b64_tr_b16 v[152:153], v12 offset:18432
    v_fmac_f32 v225, v211, v219
    v_mfma_f32_16x16x32_bf16 a[140:143], v[44:47], v[80:83], a[140:143]
    v_mfma_f32_16x16x32_bf16 a[144:147], v[48:51], v[80:83], a[144:147]
    ds_read_b64_tr_b16 v[154:155], v12 offset:19456
    v_fmac_f32 v226, v212, v219
    v_mfma_f32_16x16x32_bf16 a[148:151], v[52:55], v[80:83], a[148:151]
    v_fmac_f32 v227, v213, v219
    v_fmac_f32 v228, v214, v219
    v_mfma_f32_16x16x32_bf16 a[152:155], v[56:59], v[80:83], a[152:155]
    ds_read_b128 v[116:119], v9 offset:10240
    v_fmac_f32 v221, v206, v220
    v_mfma_f32_16x16x32_bf16 a[156:159], v[60:63], v[80:83], a[156:159]
    v_mfma_f32_16x16x32_bf16 a[160:163], v[32:35], v[84:87], a[160:163]
    ds_read_b64_tr_b16 v[156:157], v13 offset:18432
    v_fmac_f32 v222, v207, v220
    v_mfma_f32_16x16x32_bf16 a[164:167], v[36:39], v[84:87], a[164:167]
    v_fmac_f32 v223, v208, v220
    v_fmac_f32 v224, v209, v220
    v_mfma_f32_16x16x32_bf16 a[168:171], v[40:43], v[84:87], a[168:171]
    ds_read_b64_tr_b16 v[158:159], v13 offset:19456
    v_fmac_f32 v225, v210, v220
    v_mfma_f32_16x16x32_bf16 a[172:175], v[44:47], v[84:87], a[172:175]
    v_mfma_f32_16x16x32_bf16 a[176:179], v[48:51], v[84:87], a[176:179]
    ds_read_b128 v[120:123], v9 offset:12288
    v_fmac_f32 v226, v211, v220
    v_mfma_f32_16x16x32_bf16 a[180:183], v[52:55], v[84:87], a[180:183]
    v_fmac_f32 v227, v212, v220
    v_fmac_f32 v228, v213, v220
    v_mfma_f32_16x16x32_bf16 a[184:187], v[56:59], v[84:87], a[184:187]
    ds_read_b128 v[124:127], v9 offset:14336
    v_lshlrev_b32 v206, 16, v182
    v_mfma_f32_16x16x32_bf16 a[188:191], v[60:63], v[84:87], a[188:191]
    v_mfma_f32_16x16x32_bf16 a[192:195], v[32:35], v[88:91], a[192:195]
    v_lshlrev_b32 v207, 16, v184
    v_lshlrev_b32 v208, 16, v186
    v_mfma_f32_16x16x32_bf16 a[196:199], v[36:39], v[88:91], a[196:199]
    v_lshlrev_b32 v209, 16, v188
    v_lshlrev_b32 v210, 16, v190
    v_mfma_f32_16x16x32_bf16 a[200:203], v[40:43], v[88:91], a[200:203]
    v_lshlrev_b32 v211, 16, v192
    v_lshlrev_b32 v212, 16, v194
    v_mfma_f32_16x16x32_bf16 a[204:207], v[44:47], v[88:91], a[204:207]
    v_mfma_f32_16x16x32_bf16 a[208:211], v[48:51], v[88:91], a[208:211]
    v_lshlrev_b32 v213, 16, v196
    v_mul_f32 v221, v221, v206
    v_mfma_f32_16x16x32_bf16 a[212:215], v[52:55], v[88:91], a[212:215]
    v_mul_f32 v222, v222, v207
    v_mul_f32 v223, v223, v208
    v_mfma_f32_16x16x32_bf16 a[216:219], v[56:59], v[88:91], a[216:219]
    v_mul_f32 v224, v224, v209
    v_mul_f32 v225, v225, v210
    v_mfma_f32_16x16x32_bf16 a[220:223], v[60:63], v[88:91], a[220:223]
    v_mfma_f32_16x16x32_bf16 a[224:227], v[32:35], v[92:95], a[224:227]
    v_mul_f32 v226, v226, v211
    v_mul_f32 v227, v227, v212
    v_mfma_f32_16x16x32_bf16 a[228:231], v[36:39], v[92:95], a[228:231]
    v_mul_f32 v228, v228, v213
    v_cvt_pk_bf16_f32 v244, v228, v227
    v_mfma_f32_16x16x32_bf16 a[232:235], v[40:43], v[92:95], a[232:235]
    v_cvt_pk_bf16_f32 v245, v226, v225
    v_cvt_pk_bf16_f32 v246, v224, v223
    v_mfma_f32_16x16x32_bf16 a[236:239], v[44:47], v[92:95], a[236:239]
    buffer_load_dword v31, v254, s[20:23], s46 offen offset:0
    v_mfma_f32_16x16x32_bf16 a[240:243], v[48:51], v[92:95], a[240:243]
    s_add_u32 s46, s46, 1048576
    v_cvt_pk_bf16_f32 v247, v222, v221
    v_and_b32 v206, s52, v160
    v_mfma_f32_16x16x32_bf16 a[244:247], v[52:55], v[92:95], a[244:247]
    v_and_b32 v207, s52, v162
    v_and_b32 v208, s52, v164
    v_mfma_f32_16x16x32_bf16 a[248:251], v[56:59], v[92:95], a[248:251]
    v_and_b32 v209, s52, v166
    v_and_b32 v210, s52, v168
    v_mfma_f32_16x16x32_bf16 a[252:255], v[60:63], v[92:95], a[252:255]
    s_waitcnt vmcnt(24) lgkmcnt(0)
    s_barrier
    v_and_b32 v211, s52, v170
    v_and_b32 v212, s52, v172
    v_mfma_f32_16x16x32_bf16 a[0:3], v[128:131], v[96:99], a[0:3]
    ds_read_b64_tr_b16 v[64:65], v10 offset:32768
    v_and_b32 v213, s52, v174
    v_mfma_f32_16x16x32_bf16 a[4:7], v[128:131], v[100:103], a[4:7]
    s_add_u32 s36, s44, 128
    v_and_b32 v214, s52, v176
    v_and_b32 v215, s52, v178
    v_mfma_f32_16x16x32_bf16 a[8:11], v[128:131], v[104:107], a[8:11]
    s_add_u32 m0, s42, 0
    ds_read_b64_tr_b16 v[66:67], v10 offset:33792
    v_and_b32 v216, s52, v180
    v_mfma_f32_16x16x32_bf16 a[12:15], v[128:131], v[108:111], a[12:15]
    buffer_load_dwordx4 v17, s[24:27], s36 offen offset:0 lds
    v_mfma_f32_16x16x32_bf16 a[16:19], v[128:131], v[112:115], a[16:19]
    ds_read_b64_tr_b16 v[68:69], v11 offset:32768
    v_lshlrev_b32 v217, 16, v200
    v_mfma_f32_16x16x32_bf16 a[20:23], v[128:131], v[116:119], a[20:23]
    v_and_b32 v218, s52, v200
    v_lshlrev_b32 v219, 16, v201
    v_mfma_f32_16x16x32_bf16 a[24:27], v[128:131], v[120:123], a[24:27]
    ds_read_b64_tr_b16 v[70:71], v11 offset:33792
    v_and_b32 v220, s52, v201
    v_mfma_f32_16x16x32_bf16 a[28:31], v[128:131], v[124:127], a[28:31]
    buffer_load_dwordx4 v18, s[24:27], s36 offen offset:1024 lds
    v_mfma_f32_16x16x32_bf16 a[32:35], v[132:135], v[96:99], a[32:35]
    ds_read_b128 v[32:35], v8 offset:32768
    v_mul_f32 v221, v209, v217
    v_mfma_f32_16x16x32_bf16 a[36:39], v[132:135], v[100:103], a[36:39]
    v_mul_f32 v222, v210, v217
    v_mul_f32 v223, v211, v217
    v_mfma_f32_16x16x32_bf16 a[40:43], v[132:135], v[104:107], a[40:43]
    ds_read_b64_tr_b16 v[72:73], v12 offset:32768
    v_mul_f32 v224, v212, v217
    v_mfma_f32_16x16x32_bf16 a[44:47], v[132:135], v[108:111], a[44:47]
    buffer_load_dwordx4 v19, s[24:27], s36 offen offset:2048 lds
    v_mfma_f32_16x16x32_bf16 a[48:51], v[132:135], v[112:115], a[48:51]
    ds_read_b64_tr_b16 v[74:75], v12 offset:33792
    v_mul_f32 v225, v213, v217
    v_mfma_f32_16x16x32_bf16 a[52:55], v[132:135], v[116:119], a[52:55]
    v_mul_f32 v226, v214, v217
    v_mul_f32 v227, v215, v217
    v_mfma_f32_16x16x32_bf16 a[56:59], v[132:135], v[120:123], a[56:59]
    ds_read_b128 v[36:39], v8 offset:34816
    v_mul_f32 v228, v216, v217
    v_mfma_f32_16x16x32_bf16 a[60:63], v[132:135], v[124:127], a[60:63]
    buffer_load_dwordx4 v20, s[24:27], s36 offen offset:3072 lds
    v_mfma_f32_16x16x32_bf16 a[64:67], v[136:139], v[96:99], a[64:67]
    ds_read_b64_tr_b16 v[76:77], v13 offset:32768
    v_fmac_f32 v221, v208, v218
    v_mfma_f32_16x16x32_bf16 a[68:71], v[136:139], v[100:103], a[68:71]
    s_add_u32 s37, s49, 262144
    v_fmac_f32 v222, v209, v218
    v_fmac_f32 v223, v210, v218
    v_mfma_f32_16x16x32_bf16 a[72:75], v[136:139], v[104:107], a[72:75]
    s_add_u32 m0, s50, 8704
    ds_read_b64_tr_b16 v[78:79], v13 offset:33792
    v_fmac_f32 v224, v211, v218
    v_mfma_f32_16x16x32_bf16 a[76:79], v[136:139], v[108:111], a[76:79]
    buffer_load_dwordx4 v21, s[20:23], s37 offen offset:0 lds
    v_mfma_f32_16x16x32_bf16 a[80:83], v[136:139], v[112:115], a[80:83]
    ds_read_b128 v[40:43], v8 offset:36864
    v_fmac_f32 v225, v212, v218
    v_mfma_f32_16x16x32_bf16 a[84:87], v[136:139], v[116:119], a[84:87]
    v_fmac_f32 v226, v213, v218
    v_fmac_f32 v227, v214, v218
    v_mfma_f32_16x16x32_bf16 a[88:91], v[136:139], v[120:123], a[88:91]
    ds_read_b64_tr_b16 v[80:81], v10 offset:34816
    v_fmac_f32 v228, v215, v218
    v_mfma_f32_16x16x32_bf16 a[92:95], v[136:139], v[124:127], a[92:95]
    buffer_load_dwordx4 v22, s[20:23], s37 offen offset:1024 lds
    v_mfma_f32_16x16x32_bf16 a[96:99], v[140:143], v[96:99], a[96:99]
    ds_read_b64_tr_b16 v[82:83], v10 offset:35840
    v_fmac_f32 v221, v207, v219
    v_mfma_f32_16x16x32_bf16 a[100:103], v[140:143], v[100:103], a[100:103]
    s_add_u32 s37, s49, 524288
    v_fmac_f32 v222, v208, v219
    v_fmac_f32 v223, v209, v219
    v_mfma_f32_16x16x32_bf16 a[104:107], v[140:143], v[104:107], a[104:107]
    s_add_u32 m0, s50, 17408
    ds_read_b128 v[44:47], v8 offset:38912
    v_fmac_f32 v224, v210, v219
    v_mfma_f32_16x16x32_bf16 a[108:111], v[140:143], v[108:111], a[108:111]
    buffer_load_dwordx4 v21, s[20:23], s37 offen offset:0 lds
    v_mfma_f32_16x16x32_bf16 a[112:115], v[140:143], v[112:115], a[112:115]
    ds_read_b64_tr_b16 v[84:85], v11 offset:34816
    v_fmac_f32 v225, v211, v219
    v_mfma_f32_16x16x32_bf16 a[116:119], v[140:143], v[116:119], a[116:119]
    v_fmac_f32 v226, v212, v219
    v_fmac_f32 v227, v213, v219
    v_mfma_f32_16x16x32_bf16 a[120:123], v[140:143], v[120:123], a[120:123]
    ds_read_b64_tr_b16 v[86:87], v11 offset:35840
    v_fmac_f32 v228, v214, v219
    v_mfma_f32_16x16x32_bf16 a[124:127], v[140:143], v[124:127], a[124:127]
    buffer_load_dwordx4 v22, s[20:23], s37 offen offset:1024 lds
    v_mfma_f32_16x16x32_bf16 a[128:131], v[96:99], v[144:147], a[128:131]
    ds_read_b128 v[48:51], v8 offset:40960
    v_fmac_f32 v221, v206, v220
    v_mfma_f32_16x16x32_bf16 a[132:135], v[100:103], v[144:147], a[132:135]
    v_fmac_f32 v222, v207, v220
    v_fmac_f32 v223, v208, v220
    v_mfma_f32_16x16x32_bf16 a[136:139], v[104:107], v[144:147], a[136:139]
    ds_read_b64_tr_b16 v[88:89], v12 offset:34816
    v_fmac_f32 v224, v209, v220
    v_mfma_f32_16x16x32_bf16 a[140:143], v[108:111], v[144:147], a[140:143]
    buffer_store_dwordx4 v[244:247], v234, s[16:19], 0 offen sc1
    v_mfma_f32_16x16x32_bf16 a[144:147], v[112:115], v[144:147], a[144:147]
    s_movk_i32 s54, 4608
    ds_read_b64_tr_b16 v[90:91], v12 offset:35840
    v_fmac_f32 v225, v210, v220
    v_mfma_f32_16x16x32_bf16 a[148:151], v[116:119], v[144:147], a[148:151]
    v_fmac_f32 v226, v211, v220
    v_fmac_f32 v227, v212, v220
    v_mfma_f32_16x16x32_bf16 a[152:155], v[120:123], v[144:147], a[152:155]
    ds_read_b128 v[52:55], v8 offset:43008
    v_fmac_f32 v228, v213, v220
    v_mfma_f32_16x16x32_bf16 a[156:159], v[124:127], v[144:147], a[156:159]
    v_mfma_f32_16x16x32_bf16 a[160:163], v[96:99], v[148:151], a[160:163]
    ds_read_b64_tr_b16 v[92:93], v13 offset:34816
    v_and_b32 v206, s52, v182
    v_mfma_f32_16x16x32_bf16 a[164:167], v[100:103], v[148:151], a[164:167]
    v_and_b32 v207, s52, v184
    v_and_b32 v208, s52, v186
    v_mfma_f32_16x16x32_bf16 a[168:171], v[104:107], v[148:151], a[168:171]
    ds_read_b64_tr_b16 v[94:95], v13 offset:35840
    v_and_b32 v209, s52, v188
    v_mfma_f32_16x16x32_bf16 a[172:175], v[108:111], v[148:151], a[172:175]
    v_mfma_f32_16x16x32_bf16 a[176:179], v[112:115], v[148:151], a[176:179]
    ds_read_b128 v[56:59], v8 offset:45056
    v_and_b32 v210, s52, v190
    v_mfma_f32_16x16x32_bf16 a[180:183], v[116:119], v[148:151], a[180:183]
    v_and_b32 v211, s52, v192
    v_and_b32 v212, s52, v194
    v_mfma_f32_16x16x32_bf16 a[184:187], v[120:123], v[148:151], a[184:187]
    ds_read_b128 v[60:63], v8 offset:47104
    v_and_b32 v213, s52, v196
    v_mfma_f32_16x16x32_bf16 a[188:191], v[124:127], v[148:151], a[188:191]
    v_mfma_f32_16x16x32_bf16 a[192:195], v[96:99], v[152:155], a[192:195]
    v_mul_f32 v221, v221, v206
    v_mul_f32 v222, v222, v207
    v_mfma_f32_16x16x32_bf16 a[196:199], v[100:103], v[152:155], a[196:199]
    v_mul_f32 v223, v223, v208
    v_mul_f32 v224, v224, v209
    v_mfma_f32_16x16x32_bf16 a[200:203], v[104:107], v[152:155], a[200:203]
    v_mul_f32 v225, v225, v210
    v_mul_f32 v226, v226, v211
    v_mfma_f32_16x16x32_bf16 a[204:207], v[108:111], v[152:155], a[204:207]
    v_mfma_f32_16x16x32_bf16 a[208:211], v[112:115], v[152:155], a[208:211]
    v_mul_f32 v227, v227, v212
    v_mul_f32 v228, v228, v213
    v_mfma_f32_16x16x32_bf16 a[212:215], v[116:119], v[152:155], a[212:215]
    v_cvt_pk_bf16_f32 v248, v228, v227
    v_cvt_pk_bf16_f32 v249, v226, v225
    v_mfma_f32_16x16x32_bf16 a[216:219], v[120:123], v[152:155], a[216:219]
    v_cvt_pk_bf16_f32 v250, v224, v223
    v_cvt_pk_bf16_f32 v251, v222, v221
    v_mfma_f32_16x16x32_bf16 a[220:223], v[124:127], v[152:155], a[220:223]
    buffer_store_dwordx4 v[248:251], v234, s[16:19], s54 offen sc1
    v_mfma_f32_16x16x32_bf16 a[224:227], v[96:99], v[156:159], a[224:227]
    s_movk_i32 s54, 9216
    v_lshlrev_b32 v206, 16, v161
    v_lshlrev_b32 v207, 16, v163
    v_mfma_f32_16x16x32_bf16 a[228:231], v[100:103], v[156:159], a[228:231]
    v_lshlrev_b32 v208, 16, v165
    v_lshlrev_b32 v209, 16, v167
    v_mfma_f32_16x16x32_bf16 a[232:235], v[104:107], v[156:159], a[232:235]
    v_lshlrev_b32 v210, 16, v169
    v_lshlrev_b32 v211, 16, v171
    v_mfma_f32_16x16x32_bf16 a[236:239], v[108:111], v[156:159], a[236:239]
    buffer_load_dword v31, v254, s[20:23], s46 offen offset:0
    v_mfma_f32_16x16x32_bf16 a[240:243], v[112:115], v[156:159], a[240:243]
    s_add_u32 s46, s46, 1048576
    v_lshlrev_b32 v212, 16, v173
    v_lshlrev_b32 v213, 16, v175
    v_mfma_f32_16x16x32_bf16 a[244:247], v[116:119], v[156:159], a[244:247]
    v_lshlrev_b32 v214, 16, v177
    v_lshlrev_b32 v215, 16, v179
    v_mfma_f32_16x16x32_bf16 a[248:251], v[120:123], v[156:159], a[248:251]
    v_lshlrev_b32 v216, 16, v181
    v_lshlrev_b32 v217, 16, v202
    v_mfma_f32_16x16x32_bf16 a[252:255], v[124:127], v[156:159], a[252:255]
    s_waitcnt vmcnt(22) lgkmcnt(0)
    s_barrier
    v_and_b32 v218, s52, v202
    v_lshlrev_b32 v219, 16, v203
    v_mfma_f32_16x16x32_bf16 a[0:3], v[64:67], v[32:35], a[0:3]
    ds_read_b64_tr_b16 v[128:129], v10 offset:49152
    v_and_b32 v220, s52, v203
    v_mfma_f32_16x16x32_bf16 a[4:7], v[64:67], v[36:39], a[4:7]
    s_add_u32 s36, s45, 128
    v_mul_f32 v221, v209, v217
    v_mul_f32 v222, v210, v217
    v_mfma_f32_16x16x32_bf16 a[8:11], v[64:67], v[40:43], a[8:11]
    s_add_u32 m0, s42, 4096
    ds_read_b64_tr_b16 v[130:131], v10 offset:50176
    v_mul_f32 v223, v211, v217
    v_mfma_f32_16x16x32_bf16 a[12:15], v[64:67], v[44:47], a[12:15]
    buffer_load_dwordx4 v17, s[24:27], s36 offen offset:0 lds
    v_mfma_f32_16x16x32_bf16 a[16:19], v[64:67], v[48:51], a[16:19]
    ds_read_b64_tr_b16 v[132:133], v11 offset:49152
    v_mul_f32 v224, v212, v217
    v_mfma_f32_16x16x32_bf16 a[20:23], v[64:67], v[52:55], a[20:23]
    v_mul_f32 v225, v213, v217
    v_mul_f32 v226, v214, v217
    v_mfma_f32_16x16x32_bf16 a[24:27], v[64:67], v[56:59], a[24:27]
    ds_read_b64_tr_b16 v[134:135], v11 offset:50176
    v_mul_f32 v227, v215, v217
    v_mfma_f32_16x16x32_bf16 a[28:31], v[64:67], v[60:63], a[28:31]
    buffer_load_dwordx4 v18, s[24:27], s36 offen offset:1024 lds
    v_mfma_f32_16x16x32_bf16 a[32:35], v[68:71], v[32:35], a[32:35]
    ds_read_b128 v[96:99], v9 offset:32768
    v_mul_f32 v228, v216, v217
    v_mfma_f32_16x16x32_bf16 a[36:39], v[68:71], v[36:39], a[36:39]
    v_fmac_f32 v221, v208, v218
    v_fmac_f32 v222, v209, v218
    v_mfma_f32_16x16x32_bf16 a[40:43], v[68:71], v[40:43], a[40:43]
    ds_read_b64_tr_b16 v[136:137], v12 offset:49152
    v_fmac_f32 v223, v210, v218
    v_mfma_f32_16x16x32_bf16 a[44:47], v[68:71], v[44:47], a[44:47]
    buffer_load_dwordx4 v19, s[24:27], s36 offen offset:2048 lds
    v_mfma_f32_16x16x32_bf16 a[48:51], v[68:71], v[48:51], a[48:51]
    ds_read_b64_tr_b16 v[138:139], v12 offset:50176
    v_fmac_f32 v224, v211, v218
    v_mfma_f32_16x16x32_bf16 a[52:55], v[68:71], v[52:55], a[52:55]
    v_fmac_f32 v225, v212, v218
    v_fmac_f32 v226, v213, v218
    v_mfma_f32_16x16x32_bf16 a[56:59], v[68:71], v[56:59], a[56:59]
    ds_read_b128 v[100:103], v9 offset:34816
    v_fmac_f32 v227, v214, v218
    v_mfma_f32_16x16x32_bf16 a[60:63], v[68:71], v[60:63], a[60:63]
    buffer_load_dwordx4 v20, s[24:27], s36 offen offset:3072 lds
    v_mfma_f32_16x16x32_bf16 a[64:67], v[72:75], v[32:35], a[64:67]
    ds_read_b64_tr_b16 v[140:141], v13 offset:49152
    v_fmac_f32 v228, v215, v218
    v_mfma_f32_16x16x32_bf16 a[68:71], v[72:75], v[36:39], a[68:71]
    s_add_u32 s37, s49, 786432
    v_fmac_f32 v221, v207, v219
    v_fmac_f32 v222, v208, v219
    v_mfma_f32_16x16x32_bf16 a[72:75], v[72:75], v[40:43], a[72:75]
    s_add_u32 m0, s50, 26112
    ds_read_b64_tr_b16 v[142:143], v13 offset:50176
    v_fmac_f32 v223, v209, v219
    v_mfma_f32_16x16x32_bf16 a[76:79], v[72:75], v[44:47], a[76:79]
    buffer_load_dwordx4 v21, s[20:23], s37 offen offset:0 lds
    v_mfma_f32_16x16x32_bf16 a[80:83], v[72:75], v[48:51], a[80:83]
    ds_read_b128 v[104:107], v9 offset:36864
    v_fmac_f32 v224, v210, v219
    v_mfma_f32_16x16x32_bf16 a[84:87], v[72:75], v[52:55], a[84:87]
    v_fmac_f32 v225, v211, v219
    v_fmac_f32 v226, v212, v219
    v_mfma_f32_16x16x32_bf16 a[88:91], v[72:75], v[56:59], a[88:91]
    ds_read_b64_tr_b16 v[144:145], v10 offset:51200
    v_fmac_f32 v227, v213, v219
    v_mfma_f32_16x16x32_bf16 a[92:95], v[72:75], v[60:63], a[92:95]
    buffer_load_dwordx4 v22, s[20:23], s37 offen offset:1024 lds
    v_mfma_f32_16x16x32_bf16 a[96:99], v[76:79], v[32:35], a[96:99]
    ds_read_b64_tr_b16 v[146:147], v10 offset:52224
    v_fmac_f32 v228, v214, v219
    v_mfma_f32_16x16x32_bf16 a[100:103], v[76:79], v[36:39], a[100:103]
    s_add_u32 s37, s49, 1048576
    v_fmac_f32 v221, v206, v220
    v_fmac_f32 v222, v207, v220
    v_mfma_f32_16x16x32_bf16 a[104:107], v[76:79], v[40:43], a[104:107]
    s_add_u32 m0, s50, 34816
    ds_read_b128 v[108:111], v9 offset:38912
    v_fmac_f32 v223, v208, v220
    v_mfma_f32_16x16x32_bf16 a[108:111], v[76:79], v[44:47], a[108:111]
    buffer_load_dwordx4 v21, s[20:23], s37 offen offset:0 lds
    v_mfma_f32_16x16x32_bf16 a[112:115], v[76:79], v[48:51], a[112:115]
    ds_read_b64_tr_b16 v[148:149], v11 offset:51200
    v_fmac_f32 v224, v209, v220
    v_mfma_f32_16x16x32_bf16 a[116:119], v[76:79], v[52:55], a[116:119]
    v_fmac_f32 v225, v210, v220
    v_fmac_f32 v226, v211, v220
    v_mfma_f32_16x16x32_bf16 a[120:123], v[76:79], v[56:59], a[120:123]
    ds_read_b64_tr_b16 v[150:151], v11 offset:52224
    v_fmac_f32 v227, v212, v220
    v_mfma_f32_16x16x32_bf16 a[124:127], v[76:79], v[60:63], a[124:127]
    buffer_load_dwordx4 v22, s[20:23], s37 offen offset:1024 lds
    v_mfma_f32_16x16x32_bf16 a[128:131], v[32:35], v[80:83], a[128:131]
    ds_read_b128 v[112:115], v9 offset:40960
    v_fmac_f32 v228, v213, v220
    v_mfma_f32_16x16x32_bf16 a[132:135], v[36:39], v[80:83], a[132:135]
    v_lshlrev_b32 v206, 16, v183
    v_lshlrev_b32 v207, 16, v185
    v_mfma_f32_16x16x32_bf16 a[136:139], v[40:43], v[80:83], a[136:139]
    ds_read_b64_tr_b16 v[152:153], v12 offset:51200
    v_lshlrev_b32 v208, 16, v187
    v_mfma_f32_16x16x32_bf16 a[140:143], v[44:47], v[80:83], a[140:143]
    v_mfma_f32_16x16x32_bf16 a[144:147], v[48:51], v[80:83], a[144:147]
    ds_read_b64_tr_b16 v[154:155], v12 offset:52224
    v_lshlrev_b32 v209, 16, v189
    v_mfma_f32_16x16x32_bf16 a[148:151], v[52:55], v[80:83], a[148:151]
    v_lshlrev_b32 v210, 16, v191
    v_lshlrev_b32 v211, 16, v193
    v_mfma_f32_16x16x32_bf16 a[152:155], v[56:59], v[80:83], a[152:155]
    ds_read_b128 v[116:119], v9 offset:43008
    v_lshlrev_b32 v212, 16, v195
    v_mfma_f32_16x16x32_bf16 a[156:159], v[60:63], v[80:83], a[156:159]
    v_mfma_f32_16x16x32_bf16 a[160:163], v[32:35], v[84:87], a[160:163]
    ds_read_b64_tr_b16 v[156:157], v13 offset:51200
    v_lshlrev_b32 v213, 16, v197
    v_mfma_f32_16x16x32_bf16 a[164:167], v[36:39], v[84:87], a[164:167]
    v_mul_f32 v221, v221, v206
    v_mul_f32 v222, v222, v207
    v_mfma_f32_16x16x32_bf16 a[168:171], v[40:43], v[84:87], a[168:171]
    ds_read_b64_tr_b16 v[158:159], v13 offset:52224
    v_mul_f32 v223, v223, v208
    v_mfma_f32_16x16x32_bf16 a[172:175], v[44:47], v[84:87], a[172:175]
    v_mfma_f32_16x16x32_bf16 a[176:179], v[48:51], v[84:87], a[176:179]
    ds_read_b128 v[120:123], v9 offset:45056
    v_mul_f32 v224, v224, v209
    v_mfma_f32_16x16x32_bf16 a[180:183], v[52:55], v[84:87], a[180:183]
    v_mul_f32 v225, v225, v210
    v_mul_f32 v226, v226, v211
    v_mfma_f32_16x16x32_bf16 a[184:187], v[56:59], v[84:87], a[184:187]
    ds_read_b128 v[124:127], v9 offset:47104
    v_mul_f32 v227, v227, v212
    v_mfma_f32_16x16x32_bf16 a[188:191], v[60:63], v[84:87], a[188:191]
    v_mfma_f32_16x16x32_bf16 a[192:195], v[32:35], v[88:91], a[192:195]
    v_mul_f32 v228, v228, v213
    v_cvt_pk_bf16_f32 v244, v228, v227
    v_mfma_f32_16x16x32_bf16 a[196:199], v[36:39], v[88:91], a[196:199]
    v_cvt_pk_bf16_f32 v245, v226, v225
    v_cvt_pk_bf16_f32 v246, v224, v223
    v_mfma_f32_16x16x32_bf16 a[200:203], v[40:43], v[88:91], a[200:203]
    v_cvt_pk_bf16_f32 v247, v222, v221
    v_and_b32 v206, s52, v161
    v_mfma_f32_16x16x32_bf16 a[204:207], v[44:47], v[88:91], a[204:207]
    buffer_store_dwordx4 v[244:247], v234, s[16:19], s54 offen sc1
    v_mfma_f32_16x16x32_bf16 a[208:211], v[48:51], v[88:91], a[208:211]
    s_movk_i32 s54, 13824
    v_and_b32 v207, s52, v163
    v_and_b32 v208, s52, v165
    v_mfma_f32_16x16x32_bf16 a[212:215], v[52:55], v[88:91], a[212:215]
    v_and_b32 v209, s52, v167
    v_and_b32 v210, s52, v169
    v_mfma_f32_16x16x32_bf16 a[216:219], v[56:59], v[88:91], a[216:219]
    v_and_b32 v211, s52, v171
    v_and_b32 v212, s52, v173
    v_mfma_f32_16x16x32_bf16 a[220:223], v[60:63], v[88:91], a[220:223]
    v_mfma_f32_16x16x32_bf16 a[224:227], v[32:35], v[92:95], a[224:227]
    v_and_b32 v213, s52, v175
    v_and_b32 v214, s52, v177
    v_mfma_f32_16x16x32_bf16 a[228:231], v[36:39], v[92:95], a[228:231]
    v_and_b32 v215, s52, v179
    v_and_b32 v216, s52, v181
    v_mfma_f32_16x16x32_bf16 a[232:235], v[40:43], v[92:95], a[232:235]
    v_lshlrev_b32 v217, 16, v204
    v_and_b32 v218, s52, v204
    v_mfma_f32_16x16x32_bf16 a[236:239], v[44:47], v[92:95], a[236:239]
    v_mfma_f32_16x16x32_bf16 a[240:243], v[48:51], v[92:95], a[240:243]
    v_lshlrev_b32 v219, 16, v205
    v_and_b32 v220, s52, v205
    v_mfma_f32_16x16x32_bf16 a[244:247], v[52:55], v[92:95], a[244:247]
    v_mul_f32 v221, v209, v217
    v_mul_f32 v222, v210, v217
    v_mfma_f32_16x16x32_bf16 a[248:251], v[56:59], v[92:95], a[248:251]
    v_mul_f32 v223, v211, v217
    v_mul_f32 v224, v212, v217
    v_mfma_f32_16x16x32_bf16 a[252:255], v[60:63], v[92:95], a[252:255]
    s_waitcnt vmcnt(21) lgkmcnt(0)
    s_barrier
    v_mul_f32 v225, v213, v217
    v_mul_f32 v226, v214, v217
    v_mfma_f32_16x16x32_bf16 a[0:3], v[128:131], v[96:99], a[0:3]
    ds_read_b64_tr_b16 v[48:49], v27 offset:0
    v_mul_f32 v227, v215, v217
    v_mfma_f32_16x16x32_bf16 a[4:7], v[128:131], v[100:103], a[4:7]
    s_add_u32 s36, s44, 256
    v_mul_f32 v228, v216, v217
    v_fmac_f32 v221, v208, v218
    v_mfma_f32_16x16x32_bf16 a[8:11], v[128:131], v[104:107], a[8:11]
    s_add_u32 m0, s42, 32768
    ds_read_b64_tr_b16 v[50:51], v27 offset:1024
    v_fmac_f32 v222, v209, v218
    v_mfma_f32_16x16x32_bf16 a[12:15], v[128:131], v[108:111], a[12:15]
    buffer_load_dwordx4 v17, s[24:27], s36 offen offset:0 lds
    v_mfma_f32_16x16x32_bf16 a[16:19], v[128:131], v[112:115], a[16:19]
    ds_read_b128 v[32:35], v25 offset:0
    v_fmac_f32 v223, v210, v218
    v_mfma_f32_16x16x32_bf16 a[20:23], v[128:131], v[116:119], a[20:23]
    v_fmac_f32 v224, v211, v218
    v_fmac_f32 v225, v212, v218
    v_mfma_f32_16x16x32_bf16 a[24:27], v[128:131], v[120:123], a[24:27]
    ds_read_b128 v[36:39], v25 offset:2048
    v_fmac_f32 v226, v213, v218
    v_mfma_f32_16x16x32_bf16 a[28:31], v[128:131], v[124:127], a[28:31]
    buffer_load_dwordx4 v18, s[24:27], s36 offen offset:1024 lds
    v_mfma_f32_16x16x32_bf16 a[32:35], v[132:135], v[96:99], a[32:35]
    ds_read_b128 v[40:43], v25 offset:4096
    v_fmac_f32 v227, v214, v218
    v_mfma_f32_16x16x32_bf16 a[36:39], v[132:135], v[100:103], a[36:39]
    v_fmac_f32 v228, v215, v218
    v_fmac_f32 v221, v207, v219
    v_mfma_f32_16x16x32_bf16 a[40:43], v[132:135], v[104:107], a[40:43]
    ds_read_b128 v[44:47], v25 offset:6144
    v_fmac_f32 v222, v208, v219
    v_mfma_f32_16x16x32_bf16 a[44:47], v[132:135], v[108:111], a[44:47]
    buffer_load_dwordx4 v19, s[24:27], s36 offen offset:2048 lds
    v_mfma_f32_16x16x32_bf16 a[48:51], v[132:135], v[112:115], a[48:51]
    ds_read_b64_tr_b16 v[52:53], v28 offset:0
    v_fmac_f32 v223, v209, v219
    v_mfma_f32_16x16x32_bf16 a[52:55], v[132:135], v[116:119], a[52:55]
    v_fmac_f32 v224, v210, v219
    v_fmac_f32 v225, v211, v219
    v_mfma_f32_16x16x32_bf16 a[56:59], v[132:135], v[120:123], a[56:59]
    ds_read_b64_tr_b16 v[54:55], v28 offset:1024
    v_fmac_f32 v226, v212, v219
    v_mfma_f32_16x16x32_bf16 a[60:63], v[132:135], v[124:127], a[60:63]
    buffer_load_dwordx4 v20, s[24:27], s36 offen offset:3072 lds
    v_mfma_f32_16x16x32_bf16 a[64:67], v[136:139], v[96:99], a[64:67]
    ds_read_b64_tr_b16 v[56:57], v29 offset:0
    v_fmac_f32 v227, v213, v219
    v_mfma_f32_16x16x32_bf16 a[68:71], v[136:139], v[100:103], a[68:71]
    v_fmac_f32 v228, v214, v219
    v_fmac_f32 v221, v206, v220
    v_mfma_f32_16x16x32_bf16 a[72:75], v[136:139], v[104:107], a[72:75]
    ds_read_b64_tr_b16 v[58:59], v29 offset:1024
    v_fmac_f32 v222, v207, v220
    v_mfma_f32_16x16x32_bf16 a[76:79], v[136:139], v[108:111], a[76:79]
    v_mfma_f32_16x16x32_bf16 a[80:83], v[136:139], v[112:115], a[80:83]
    ds_read_b64_tr_b16 v[60:61], v30 offset:0
    v_fmac_f32 v223, v208, v220
    v_mfma_f32_16x16x32_bf16 a[84:87], v[136:139], v[116:119], a[84:87]
    v_fmac_f32 v224, v209, v220
    v_fmac_f32 v225, v210, v220
    v_mfma_f32_16x16x32_bf16 a[88:91], v[136:139], v[120:123], a[88:91]
    ds_read_b64_tr_b16 v[62:63], v30 offset:1024
    v_fmac_f32 v226, v211, v220
    v_mfma_f32_16x16x32_bf16 a[92:95], v[136:139], v[124:127], a[92:95]
    v_mfma_f32_16x16x32_bf16 a[96:99], v[140:143], v[96:99], a[96:99]
    ds_read_b64_tr_b16 v[64:65], v27 offset:128
    v_fmac_f32 v227, v212, v220
    v_mfma_f32_16x16x32_bf16 a[100:103], v[140:143], v[100:103], a[100:103]
    v_fmac_f32 v228, v213, v220
    v_and_b32 v206, s52, v183
    v_mfma_f32_16x16x32_bf16 a[104:107], v[140:143], v[104:107], a[104:107]
    ds_read_b64_tr_b16 v[66:67], v27 offset:1152
    v_and_b32 v207, s52, v185
    v_mfma_f32_16x16x32_bf16 a[108:111], v[140:143], v[108:111], a[108:111]
    v_mfma_f32_16x16x32_bf16 a[112:115], v[140:143], v[112:115], a[112:115]
    ds_read_b64_tr_b16 v[68:69], v28 offset:128
    v_and_b32 v208, s52, v187
    v_mfma_f32_16x16x32_bf16 a[116:119], v[140:143], v[116:119], a[116:119]
    v_and_b32 v209, s52, v189
    v_and_b32 v210, s52, v191
    v_mfma_f32_16x16x32_bf16 a[120:123], v[140:143], v[120:123], a[120:123]
    ds_read_b64_tr_b16 v[70:71], v28 offset:1152
    v_and_b32 v211, s52, v193
    v_mfma_f32_16x16x32_bf16 a[124:127], v[140:143], v[124:127], a[124:127]
    v_mfma_f32_16x16x32_bf16 a[128:131], v[96:99], v[144:147], a[128:131]
    ds_read_b64_tr_b16 v[72:73], v29 offset:128
    v_and_b32 v212, s52, v195
    v_mfma_f32_16x16x32_bf16 a[132:135], v[100:103], v[144:147], a[132:135]
    v_and_b32 v213, s52, v197
    v_mul_f32 v221, v221, v206
    v_mfma_f32_16x16x32_bf16 a[136:139], v[104:107], v[144:147], a[136:139]
    ds_read_b64_tr_b16 v[74:75], v29 offset:1152
    v_mul_f32 v222, v222, v207
    v_mfma_f32_16x16x32_bf16 a[140:143], v[108:111], v[144:147], a[140:143]
    v_mfma_f32_16x16x32_bf16 a[144:147], v[112:115], v[144:147], a[144:147]
    ds_read_b64_tr_b16 v[76:77], v30 offset:128
    v_mul_f32 v223, v223, v208
    v_mfma_f32_16x16x32_bf16 a[148:151], v[116:119], v[144:147], a[148:151]
    v_mul_f32 v224, v224, v209
    v_mul_f32 v225, v225, v210
    v_mfma_f32_16x16x32_bf16 a[152:155], v[120:123], v[144:147], a[152:155]
    ds_read_b64_tr_b16 v[78:79], v30 offset:1152
    v_mul_f32 v226, v226, v211
    v_mfma_f32_16x16x32_bf16 a[156:159], v[124:127], v[144:147], a[156:159]
    v_mfma_f32_16x16x32_bf16 a[160:163], v[96:99], v[148:151], a[160:163]
    v_mul_f32 v227, v227, v212
    v_mul_f32 v228, v228, v213
    v_mfma_f32_16x16x32_bf16 a[164:167], v[100:103], v[148:151], a[164:167]
    v_cvt_pk_bf16_f32 v248, v228, v227
    v_cvt_pk_bf16_f32 v249, v226, v225
    v_mfma_f32_16x16x32_bf16 a[168:171], v[104:107], v[148:151], a[168:171]
    v_cvt_pk_bf16_f32 v250, v224, v223
    v_cvt_pk_bf16_f32 v251, v222, v221
    v_mfma_f32_16x16x32_bf16 a[172:175], v[108:111], v[148:151], a[172:175]
    buffer_store_dwordx4 v[248:251], v234, s[16:19], s54 offen sc1
    v_mfma_f32_16x16x32_bf16 a[176:179], v[112:115], v[148:151], a[176:179]
    v_mov_b32 v160, 0
    v_mov_b32 v161, 0
    v_mfma_f32_16x16x32_bf16 a[180:183], v[116:119], v[148:151], a[180:183]
    v_mov_b32 v162, 0
    v_mov_b32 v163, 0
    v_mfma_f32_16x16x32_bf16 a[184:187], v[120:123], v[148:151], a[184:187]
    v_mfma_f32_16x16x32_bf16 a[188:191], v[124:127], v[148:151], a[188:191]
    buffer_store_dwordx4 v[160:163], v235, s[16:19], s53 offen sc1
    v_mfma_f32_16x16x32_bf16 a[192:195], v[96:99], v[152:155], a[192:195]
    v_mfma_f32_16x16x32_bf16 a[196:199], v[100:103], v[152:155], a[196:199]
    v_mfma_f32_16x16x32_bf16 a[200:203], v[104:107], v[152:155], a[200:203]
    v_mfma_f32_16x16x32_bf16 a[204:207], v[108:111], v[152:155], a[204:207]
    v_mfma_f32_16x16x32_bf16 a[208:211], v[112:115], v[152:155], a[208:211]
    v_mfma_f32_16x16x32_bf16 a[212:215], v[116:119], v[152:155], a[212:215]
    v_mfma_f32_16x16x32_bf16 a[216:219], v[120:123], v[152:155], a[216:219]
    v_mfma_f32_16x16x32_bf16 a[220:223], v[124:127], v[152:155], a[220:223]
    v_mfma_f32_16x16x32_bf16 a[224:227], v[96:99], v[156:159], a[224:227]
    v_mfma_f32_16x16x32_bf16 a[228:231], v[100:103], v[156:159], a[228:231]
    v_mfma_f32_16x16x32_bf16 a[232:235], v[104:107], v[156:159], a[232:235]
    v_mfma_f32_16x16x32_bf16 a[236:239], v[108:111], v[156:159], a[236:239]
    v_mfma_f32_16x16x32_bf16 a[240:243], v[112:115], v[156:159], a[240:243]
    v_mfma_f32_16x16x32_bf16 a[244:247], v[116:119], v[156:159], a[244:247]
    v_mfma_f32_16x16x32_bf16 a[248:251], v[120:123], v[156:159], a[248:251]
    v_mfma_f32_16x16x32_bf16 a[252:255], v[124:127], v[156:159], a[252:255]
    s_waitcnt vmcnt(20) lgkmcnt(0)
    s_barrier
    v_mfma_f32_16x16x32_bf16 v[128:131], v[48:51], v[32:35], 0
    s_lshl_b32 s38, s33, 6
    ds_read_b64_tr_b16 v[96:97], v27 offset:8704
    ds_read_b64_tr_b16 v[98:99], v27 offset:9728
    v_mfma_f32_16x16x32_bf16 v[160:163], v[48:51], v[36:39], 0
    s_add_u32 s36, s45, 256
    v_mfma_f32_16x16x32_bf16 v[192:195], v[48:51], v[40:43], 0
    s_add_u32 m0, s42, 36864
    ds_read_b128 v[80:83], v26 offset:0
    ds_read_b128 v[84:87], v26 offset:2048
    v_mfma_f32_16x16x32_bf16 v[224:227], v[48:51], v[44:47], 0
    buffer_load_dwordx4 v17, s[24:27], s36 offen offset:0 lds
    v_mfma_f32_16x16x32_bf16 v[132:135], v[52:55], v[32:35], 0
    s_lshl_b32 s54, s34, 3
    ds_read_b128 v[88:91], v26 offset:4096
    ds_read_b128 v[92:95], v26 offset:6144
    v_mfma_f32_16x16x32_bf16 v[164:167], v[52:55], v[36:39], 0
    s_add_u32 s38, s38, s54
    v_accvgpr_read_b32 v4, a132
    v_accvgpr_read_b32 v5, a133
    v_mfma_f32_16x16x32_bf16 v[196:199], v[52:55], v[40:43], 0
    s_lshr_b32 s54, s32, 1
    ds_read_b64_tr_b16 v[100:101], v28 offset:8704
    ds_read_b64_tr_b16 v[102:103], v28 offset:9728
    v_mfma_f32_16x16x32_bf16 v[228:231], v[52:55], v[44:47], 0
    buffer_load_dwordx4 v18, s[24:27], s36 offen offset:1024 lds
    v_mfma_f32_16x16x32_bf16 v[136:139], v[56:59], v[32:35], 0
    s_lshl_b32 s54, s54, 2
    ds_read_b64_tr_b16 v[104:105], v29 offset:8704
    ds_read_b64_tr_b16 v[106:107], v29 offset:9728
    v_mfma_f32_16x16x32_bf16 v[168:171], v[56:59], v[36:39], 0
    s_add_u32 s38, s38, s54
    v_accvgpr_read_b32 v6, a134
    v_accvgpr_read_b32 v7, a135
    v_mfma_f32_16x16x32_bf16 v[200:203], v[56:59], v[40:43], 0
    s_lshl_b32 s38, s38, 14
    ds_read_b64_tr_b16 v[108:109], v30 offset:8704
    ds_read_b64_tr_b16 v[110:111], v30 offset:9728
    v_mfma_f32_16x16x32_bf16 v[232:235], v[56:59], v[44:47], 0
    v_mfma_f32_16x16x32_bf16 v[140:143], v[60:63], v[32:35], 0
    s_and_b32 s54, s32, 1
    ds_read_b64_tr_b16 v[112:113], v27 offset:8832
    ds_read_b64_tr_b16 v[114:115], v27 offset:9856
    v_mfma_f32_16x16x32_bf16 v[172:175], v[60:63], v[36:39], 0
    s_lshl_b32 s54, s54, 11
    v_accvgpr_read_b32 v0, a128
    v_accvgpr_read_b32 v1, a129
    v_mfma_f32_16x16x32_bf16 v[204:207], v[60:63], v[40:43], 0
    s_add_u32 s41, s38, s54
    ds_read_b64_tr_b16 v[116:117], v28 offset:8832
    ds_read_b64_tr_b16 v[118:119], v28 offset:9856
    v_mfma_f32_16x16x32_bf16 v[236:239], v[60:63], v[44:47], 0
    buffer_load_dwordx4 v19, s[24:27], s36 offen offset:2048 lds
    v_mfma_f32_16x16x32_bf16 v[144:147], v[64:67], v[32:35], 0
    s_add_u32 s38, s41, s54
    ds_read_b64_tr_b16 v[120:121], v29 offset:8832
    ds_read_b64_tr_b16 v[122:123], v29 offset:9856
    v_mfma_f32_16x16x32_bf16 v[176:179], v[64:67], v[36:39], 0
    s_add_u32 s38, s38, 8192
    v_accvgpr_read_b32 v2, a130
    v_accvgpr_read_b32 v3, a131
    v_mfma_f32_16x16x32_bf16 v[208:211], v[64:67], v[40:43], 0
    s_mov_b32 s40, 0x3e0293ee
    ds_read_b64_tr_b16 v[124:125], v30 offset:8832
    ds_read_b64_tr_b16 v[126:127], v30 offset:9856
    v_mfma_f32_16x16x32_bf16 v[240:243], v[64:67], v[44:47], 0
    s_mov_b32 s16, s94
    v_cvt_pk_bf16_f32 v0, v0, v1
    v_cvt_pk_bf16_f32 v1, v2, v3
    v_mfma_f32_16x16x32_bf16 v[148:151], v[68:71], v[32:35], 0
    s_mov_b32 s17, s95
    v_cvt_pk_bf16_f32 v2, v4, v5
    v_cvt_pk_bf16_f32 v3, v6, v7
    v_mfma_f32_16x16x32_bf16 v[180:183], v[68:71], v[36:39], 0
    buffer_load_dwordx4 v20, s[24:27], s36 offen offset:3072 lds
    v_mfma_f32_16x16x32_bf16 v[212:215], v[68:71], v[40:43], 0
    s_add_u32 s37, s49, 1310720
    v_accvgpr_read_b32 v12, a32
    v_accvgpr_read_b32 v13, a33
    v_mfma_f32_16x16x32_bf16 v[244:247], v[68:71], v[44:47], 0
    s_add_u32 m0, s50, 43520
    v_accvgpr_read_b32 v14, a34
    v_accvgpr_read_b32 v15, a35
    v_mfma_f32_16x16x32_bf16 v[152:155], v[72:75], v[32:35], 0
    buffer_load_dwordx4 v21, s[20:23], s37 offen offset:0 lds
    v_mfma_f32_16x16x32_bf16 v[184:187], v[72:75], v[36:39], 0
    s_mov_b32 s18, 33554432
    v_accvgpr_read_b32 v8, a0
    v_accvgpr_read_b32 v9, a1
    v_mfma_f32_16x16x32_bf16 v[216:219], v[72:75], v[40:43], 0
    v_accvgpr_read_b32 v10, a2
    v_accvgpr_read_b32 v11, a3
    v_mfma_f32_16x16x32_bf16 v[248:251], v[72:75], v[44:47], 0
    buffer_store_dwordx4 v[0:3], v16, s[16:19], s38 offen offset:0
    v_mfma_f32_16x16x32_bf16 v[156:159], v[76:79], v[32:35], 0
    v_mul_f32 v8, s40, v8
    v_mul_f32 v9, s40, v9
    v_mfma_f32_16x16x32_bf16 v[188:191], v[76:79], v[36:39], 0
    v_mul_f32 v10, s40, v10
    v_mul_f32 v11, s40, v11
    v_mfma_f32_16x16x32_bf16 v[220:223], v[76:79], v[40:43], 0
    buffer_load_dwordx4 v22, s[20:23], s37 offen offset:1024 lds
    v_mfma_f32_16x16x32_bf16 v[252:255], v[76:79], v[44:47], 0
    s_waitcnt vmcnt(16) lgkmcnt(0)
    s_barrier
    v_mul_f32 v12, s40, v12
    v_mul_f32 v13, s40, v13
    v_mfma_f32_16x16x32_bf16 v[128:131], v[96:99], v[80:83], v[128:131]
    ds_read_b64_tr_b16 v[48:49], v27 offset:17408
    ds_read_b64_tr_b16 v[50:51], v27 offset:18432
    v_mfma_f32_16x16x32_bf16 v[160:163], v[96:99], v[84:87], v[160:163]
    s_add_u32 s36, s44, 384
    v_mul_f32 v14, s40, v14
    v_mul_f32 v15, s40, v15
    v_mfma_f32_16x16x32_bf16 v[192:195], v[96:99], v[88:91], v[192:195]
    s_add_u32 m0, s42, 65536
    ds_read_b128 v[32:35], v23 offset:0
    ds_read_b128 v[36:39], v23 offset:2048
    v_mfma_f32_16x16x32_bf16 v[224:227], v[96:99], v[92:95], v[224:227]
    buffer_load_dwordx4 v17, s[24:27], s36 offen offset:0 lds
    v_mfma_f32_16x16x32_bf16 v[132:135], v[100:103], v[80:83], v[132:135]
    ds_read_b128 v[40:43], v23 offset:4096
    ds_read_b128 v[44:47], v23 offset:6144
    v_mfma_f32_16x16x32_bf16 v[164:167], v[100:103], v[84:87], v[164:167]
    v_cvt_pk_bf16_f32 v8, v8, v9
    v_cvt_pk_bf16_f32 v9, v10, v11
    v_mfma_f32_16x16x32_bf16 v[196:199], v[100:103], v[88:91], v[196:199]
    ds_read_b64_tr_b16 v[52:53], v28 offset:17408
    ds_read_b64_tr_b16 v[54:55], v28 offset:18432
    v_mfma_f32_16x16x32_bf16 v[228:231], v[100:103], v[92:95], v[228:231]
    buffer_load_dwordx4 v18, s[24:27], s36 offen offset:1024 lds
    v_mfma_f32_16x16x32_bf16 v[136:139], v[104:107], v[80:83], v[136:139]
    ds_read_b64_tr_b16 v[56:57], v29 offset:17408
    ds_read_b64_tr_b16 v[58:59], v29 offset:18432
    v_mfma_f32_16x16x32_bf16 v[168:171], v[104:107], v[84:87], v[168:171]
    v_cvt_pk_bf16_f32 v10, v12, v13
    v_cvt_pk_bf16_f32 v11, v14, v15
    v_mfma_f32_16x16x32_bf16 v[200:203], v[104:107], v[88:91], v[200:203]
    ds_read_b64_tr_b16 v[60:61], v30 offset:17408
    ds_read_b64_tr_b16 v[62:63], v30 offset:18432
    v_mfma_f32_16x16x32_bf16 v[232:235], v[104:107], v[92:95], v[232:235]
    buffer_store_dwordx4 v[8:11], v16, s[16:19], s41 offen offset:0
    v_mfma_f32_16x16x32_bf16 v[140:143], v[108:111], v[80:83], v[140:143]
    ds_read_b64_tr_b16 v[64:65], v27 offset:17536
    ds_read_b64_tr_b16 v[66:67], v27 offset:18560
    v_mfma_f32_16x16x32_bf16 v[172:175], v[108:111], v[84:87], v[172:175]
    v_accvgpr_read_b32 v4, a164
    v_accvgpr_read_b32 v5, a165
    v_mfma_f32_16x16x32_bf16 v[204:207], v[108:111], v[88:91], v[204:207]
    ds_read_b64_tr_b16 v[68:69], v28 offset:17536
    ds_read_b64_tr_b16 v[70:71], v28 offset:18560
    v_mfma_f32_16x16x32_bf16 v[236:239], v[108:111], v[92:95], v[236:239]
    buffer_load_dwordx4 v19, s[24:27], s36 offen offset:2048 lds
    v_mfma_f32_16x16x32_bf16 v[144:147], v[112:115], v[80:83], v[144:147]
    ds_read_b64_tr_b16 v[72:73], v29 offset:17536
    ds_read_b64_tr_b16 v[74:75], v29 offset:18560
    v_mfma_f32_16x16x32_bf16 v[176:179], v[112:115], v[84:87], v[176:179]
    v_accvgpr_read_b32 v6, a166
    v_accvgpr_read_b32 v7, a167
    v_mfma_f32_16x16x32_bf16 v[208:211], v[112:115], v[88:91], v[208:211]
    ds_read_b64_tr_b16 v[76:77], v30 offset:17536
    ds_read_b64_tr_b16 v[78:79], v30 offset:18560
    v_mfma_f32_16x16x32_bf16 v[240:243], v[112:115], v[92:95], v[240:243]
    v_accvgpr_read_b32 v0, a160
    v_accvgpr_read_b32 v1, a161
    v_mfma_f32_16x16x32_bf16 v[148:151], v[116:119], v[80:83], v[148:151]
    v_accvgpr_read_b32 v2, a162
    v_accvgpr_read_b32 v3, a163
    v_mfma_f32_16x16x32_bf16 v[180:183], v[116:119], v[84:87], v[180:183]
    buffer_load_dwordx4 v20, s[24:27], s36 offen offset:3072 lds
    v_mfma_f32_16x16x32_bf16 v[212:215], v[116:119], v[88:91], v[212:215]
    s_add_u32 s37, s49, 1572864
    v_cvt_pk_bf16_f32 v0, v0, v1
    v_cvt_pk_bf16_f32 v1, v2, v3
    v_mfma_f32_16x16x32_bf16 v[244:247], v[116:119], v[92:95], v[244:247]
    s_add_u32 m0, s50, 0
    v_cvt_pk_bf16_f32 v2, v4, v5
    v_cvt_pk_bf16_f32 v3, v6, v7
    v_mfma_f32_16x16x32_bf16 v[152:155], v[120:123], v[80:83], v[152:155]
    buffer_load_dwordx4 v21, s[20:23], s37 offen offset:0 lds
    v_mfma_f32_16x16x32_bf16 v[184:187], v[120:123], v[84:87], v[184:187]
    v_accvgpr_read_b32 v12, a96
    v_accvgpr_read_b32 v13, a97
    v_mfma_f32_16x16x32_bf16 v[216:219], v[120:123], v[88:91], v[216:219]
    v_accvgpr_read_b32 v14, a98
    v_accvgpr_read_b32 v15, a99
    v_mfma_f32_16x16x32_bf16 v[248:251], v[120:123], v[92:95], v[248:251]
    buffer_store_dwordx4 v[0:3], v16, s[16:19], s38 offen offset:1024
    v_mfma_f32_16x16x32_bf16 v[156:159], v[124:127], v[80:83], v[156:159]
    v_accvgpr_read_b32 v8, a64
    v_accvgpr_read_b32 v9, a65
    v_mfma_f32_16x16x32_bf16 v[188:191], v[124:127], v[84:87], v[188:191]
    v_accvgpr_read_b32 v10, a66
    v_accvgpr_read_b32 v11, a67
    v_mfma_f32_16x16x32_bf16 v[220:223], v[124:127], v[88:91], v[220:223]
    buffer_load_dwordx4 v22, s[20:23], s37 offen offset:1024 lds
    v_mfma_f32_16x16x32_bf16 v[252:255], v[124:127], v[92:95], v[252:255]
    s_waitcnt lgkmcnt(0)
    v_mul_f32 v8, s40, v8
    v_mul_f32 v9, s40, v9
    v_mfma_f32_16x16x32_bf16 v[128:131], v[48:51], v[32:35], v[128:131]
    ds_read_b64_tr_b16 v[96:97], v27 offset:26112
    ds_read_b64_tr_b16 v[98:99], v27 offset:27136
    v_mfma_f32_16x16x32_bf16 v[160:163], v[48:51], v[36:39], v[160:163]
    s_add_u32 s36, s45, 384
    v_mul_f32 v10, s40, v10
    v_mul_f32 v11, s40, v11
    v_mfma_f32_16x16x32_bf16 v[192:195], v[48:51], v[40:43], v[192:195]
    s_add_u32 m0, s42, 69632
    ds_read_b128 v[80:83], v24 offset:0
    ds_read_b128 v[84:87], v24 offset:2048
    v_mfma_f32_16x16x32_bf16 v[224:227], v[48:51], v[44:47], v[224:227]
    buffer_load_dwordx4 v17, s[24:27], s36 offen offset:0 lds
    v_mfma_f32_16x16x32_bf16 v[132:135], v[52:55], v[32:35], v[132:135]
    ds_read_b128 v[88:91], v24 offset:4096
    ds_read_b128 v[92:95], v24 offset:6144
    v_mfma_f32_16x16x32_bf16 v[164:167], v[52:55], v[36:39], v[164:167]
    v_mul_f32 v12, s40, v12
    v_mul_f32 v13, s40, v13
    v_mfma_f32_16x16x32_bf16 v[196:199], v[52:55], v[40:43], v[196:199]
    ds_read_b64_tr_b16 v[100:101], v28 offset:26112
    ds_read_b64_tr_b16 v[102:103], v28 offset:27136
    v_mfma_f32_16x16x32_bf16 v[228:231], v[52:55], v[44:47], v[228:231]
    buffer_load_dwordx4 v18, s[24:27], s36 offen offset:1024 lds
    v_mfma_f32_16x16x32_bf16 v[136:139], v[56:59], v[32:35], v[136:139]
    ds_read_b64_tr_b16 v[104:105], v29 offset:26112
    ds_read_b64_tr_b16 v[106:107], v29 offset:27136
    v_mfma_f32_16x16x32_bf16 v[168:171], v[56:59], v[36:39], v[168:171]
    v_mul_f32 v14, s40, v14
    v_mul_f32 v15, s40, v15
    v_mfma_f32_16x16x32_bf16 v[200:203], v[56:59], v[40:43], v[200:203]
    ds_read_b64_tr_b16 v[108:109], v30 offset:26112
    ds_read_b64_tr_b16 v[110:111], v30 offset:27136
    v_mfma_f32_16x16x32_bf16 v[232:235], v[56:59], v[44:47], v[232:235]
    v_mfma_f32_16x16x32_bf16 v[140:143], v[60:63], v[32:35], v[140:143]
    ds_read_b64_tr_b16 v[112:113], v27 offset:26240
    ds_read_b64_tr_b16 v[114:115], v27 offset:27264
    v_mfma_f32_16x16x32_bf16 v[172:175], v[60:63], v[36:39], v[172:175]
    v_cvt_pk_bf16_f32 v8, v8, v9
    v_cvt_pk_bf16_f32 v9, v10, v11
    v_mfma_f32_16x16x32_bf16 v[204:207], v[60:63], v[40:43], v[204:207]
    ds_read_b64_tr_b16 v[116:117], v28 offset:26240
    ds_read_b64_tr_b16 v[118:119], v28 offset:27264
    v_mfma_f32_16x16x32_bf16 v[236:239], v[60:63], v[44:47], v[236:239]
    buffer_load_dwordx4 v19, s[24:27], s36 offen offset:2048 lds
    v_mfma_f32_16x16x32_bf16 v[144:147], v[64:67], v[32:35], v[144:147]
    ds_read_b64_tr_b16 v[120:121], v29 offset:26240
    ds_read_b64_tr_b16 v[122:123], v29 offset:27264
    v_mfma_f32_16x16x32_bf16 v[176:179], v[64:67], v[36:39], v[176:179]
    v_cvt_pk_bf16_f32 v10, v12, v13
    v_cvt_pk_bf16_f32 v11, v14, v15
    v_mfma_f32_16x16x32_bf16 v[208:211], v[64:67], v[40:43], v[208:211]
    ds_read_b64_tr_b16 v[124:125], v30 offset:26240
    ds_read_b64_tr_b16 v[126:127], v30 offset:27264
    v_mfma_f32_16x16x32_bf16 v[240:243], v[64:67], v[44:47], v[240:243]
    v_accvgpr_read_b32 v4, a196
    v_accvgpr_read_b32 v5, a197
    v_mfma_f32_16x16x32_bf16 v[148:151], v[68:71], v[32:35], v[148:151]
    v_accvgpr_read_b32 v6, a198
    v_accvgpr_read_b32 v7, a199
    v_mfma_f32_16x16x32_bf16 v[180:183], v[68:71], v[36:39], v[180:183]
    buffer_load_dwordx4 v20, s[24:27], s36 offen offset:3072 lds
    v_mfma_f32_16x16x32_bf16 v[212:215], v[68:71], v[40:43], v[212:215]
    s_add_u32 s37, s49, 1835008
    v_accvgpr_read_b32 v0, a192
    v_accvgpr_read_b32 v1, a193
    v_mfma_f32_16x16x32_bf16 v[244:247], v[68:71], v[44:47], v[244:247]
    s_add_u32 m0, s50, 8704
    v_accvgpr_read_b32 v2, a194
    v_accvgpr_read_b32 v3, a195
    v_mfma_f32_16x16x32_bf16 v[152:155], v[72:75], v[32:35], v[152:155]
    buffer_load_dwordx4 v21, s[20:23], s37 offen offset:0 lds
    v_mfma_f32_16x16x32_bf16 v[184:187], v[72:75], v[36:39], v[184:187]
    v_cvt_pk_bf16_f32 v0, v0, v1
    v_cvt_pk_bf16_f32 v1, v2, v3
    v_mfma_f32_16x16x32_bf16 v[216:219], v[72:75], v[40:43], v[216:219]
    v_cvt_pk_bf16_f32 v2, v4, v5
    v_cvt_pk_bf16_f32 v3, v6, v7
    v_mfma_f32_16x16x32_bf16 v[248:251], v[72:75], v[44:47], v[248:251]
    buffer_store_dwordx4 v[8:11], v16, s[16:19], s41 offen offset:1024
    v_mfma_f32_16x16x32_bf16 v[156:159], v[76:79], v[32:35], v[156:159]
    s_add_u32 s41, s41, 4096
    v_accvgpr_read_b32 v12, a36
    v_accvgpr_read_b32 v13, a37
    v_mfma_f32_16x16x32_bf16 v[188:191], v[76:79], v[36:39], v[188:191]
    v_accvgpr_read_b32 v14, a38
    v_accvgpr_read_b32 v15, a39
    v_mfma_f32_16x16x32_bf16 v[220:223], v[76:79], v[40:43], v[220:223]
    buffer_load_dwordx4 v22, s[20:23], s37 offen offset:1024 lds
    v_mfma_f32_16x16x32_bf16 v[252:255], v[76:79], v[44:47], v[252:255]
    s_waitcnt vmcnt(15) lgkmcnt(0)
    s_barrier
    v_accvgpr_read_b32 v8, a4
    v_accvgpr_read_b32 v9, a5
    v_mfma_f32_16x16x32_bf16 v[128:131], v[96:99], v[80:83], v[128:131]
    ds_read_b64_tr_b16 v[48:49], v27 offset:34816
    ds_read_b64_tr_b16 v[50:51], v27 offset:35840
    v_mfma_f32_16x16x32_bf16 v[160:163], v[96:99], v[84:87], v[160:163]
    s_add_u32 s36, s44, 512
    v_accvgpr_read_b32 v10, a6
    v_accvgpr_read_b32 v11, a7
    v_mfma_f32_16x16x32_bf16 v[192:195], v[96:99], v[88:91], v[192:195]
    s_add_u32 m0, s42, 0
    ds_read_b128 v[32:35], v23 offset:32768
    ds_read_b128 v[36:39], v23 offset:34816
    v_mfma_f32_16x16x32_bf16 v[224:227], v[96:99], v[92:95], v[224:227]
    buffer_load_dwordx4 v17, s[24:27], s36 offen offset:0 lds
    v_mfma_f32_16x16x32_bf16 v[132:135], v[100:103], v[80:83], v[132:135]
    ds_read_b128 v[40:43], v23 offset:36864
    ds_read_b128 v[44:47], v23 offset:38912
    v_mfma_f32_16x16x32_bf16 v[164:167], v[100:103], v[84:87], v[164:167]
    v_mul_f32 v8, s40, v8
    v_mul_f32 v9, s40, v9
    v_mfma_f32_16x16x32_bf16 v[196:199], v[100:103], v[88:91], v[196:199]
    ds_read_b64_tr_b16 v[52:53], v28 offset:34816
    ds_read_b64_tr_b16 v[54:55], v28 offset:35840
    v_mfma_f32_16x16x32_bf16 v[228:231], v[100:103], v[92:95], v[228:231]
    buffer_load_dwordx4 v18, s[24:27], s36 offen offset:1024 lds
    v_mfma_f32_16x16x32_bf16 v[136:139], v[104:107], v[80:83], v[136:139]
    ds_read_b64_tr_b16 v[56:57], v29 offset:34816
    ds_read_b64_tr_b16 v[58:59], v29 offset:35840
    v_mfma_f32_16x16x32_bf16 v[168:171], v[104:107], v[84:87], v[168:171]
    v_mul_f32 v10, s40, v10
    v_mul_f32 v11, s40, v11
    v_mfma_f32_16x16x32_bf16 v[200:203], v[104:107], v[88:91], v[200:203]
    ds_read_b64_tr_b16 v[60:61], v30 offset:34816
    ds_read_b64_tr_b16 v[62:63], v30 offset:35840
    v_mfma_f32_16x16x32_bf16 v[232:235], v[104:107], v[92:95], v[232:235]
    buffer_store_dwordx4 v[0:3], v16, s[16:19], s38 offen offset:2048
    v_mfma_f32_16x16x32_bf16 v[140:143], v[108:111], v[80:83], v[140:143]
    ds_read_b64_tr_b16 v[64:65], v27 offset:34944
    ds_read_b64_tr_b16 v[66:67], v27 offset:35968
    v_mfma_f32_16x16x32_bf16 v[172:175], v[108:111], v[84:87], v[172:175]
    v_mul_f32 v12, s40, v12
    v_mul_f32 v13, s40, v13
    v_mfma_f32_16x16x32_bf16 v[204:207], v[108:111], v[88:91], v[204:207]
    ds_read_b64_tr_b16 v[68:69], v28 offset:34944
    ds_read_b64_tr_b16 v[70:71], v28 offset:35968
    v_mfma_f32_16x16x32_bf16 v[236:239], v[108:111], v[92:95], v[236:239]
    buffer_load_dwordx4 v19, s[24:27], s36 offen offset:2048 lds
    v_mfma_f32_16x16x32_bf16 v[144:147], v[112:115], v[80:83], v[144:147]
    ds_read_b64_tr_b16 v[72:73], v29 offset:34944
    ds_read_b64_tr_b16 v[74:75], v29 offset:35968
    v_mfma_f32_16x16x32_bf16 v[176:179], v[112:115], v[84:87], v[176:179]
    v_mul_f32 v14, s40, v14
    v_mul_f32 v15, s40, v15
    v_mfma_f32_16x16x32_bf16 v[208:211], v[112:115], v[88:91], v[208:211]
    ds_read_b64_tr_b16 v[76:77], v30 offset:34944
    ds_read_b64_tr_b16 v[78:79], v30 offset:35968
    v_mfma_f32_16x16x32_bf16 v[240:243], v[112:115], v[92:95], v[240:243]
    v_cvt_pk_bf16_f32 v8, v8, v9
    v_cvt_pk_bf16_f32 v9, v10, v11
    v_mfma_f32_16x16x32_bf16 v[148:151], v[116:119], v[80:83], v[148:151]
    v_cvt_pk_bf16_f32 v10, v12, v13
    v_cvt_pk_bf16_f32 v11, v14, v15
    v_mfma_f32_16x16x32_bf16 v[180:183], v[116:119], v[84:87], v[180:183]
    buffer_load_dwordx4 v20, s[24:27], s36 offen offset:3072 lds
    v_mfma_f32_16x16x32_bf16 v[212:215], v[116:119], v[88:91], v[212:215]
    s_add_u32 s37, s49, 2097152
    v_accvgpr_read_b32 v4, a228
    v_accvgpr_read_b32 v5, a229
    v_mfma_f32_16x16x32_bf16 v[244:247], v[116:119], v[92:95], v[244:247]
    s_add_u32 m0, s50, 17408
    v_accvgpr_read_b32 v6, a230
    v_accvgpr_read_b32 v7, a231
    v_mfma_f32_16x16x32_bf16 v[152:155], v[120:123], v[80:83], v[152:155]
    buffer_load_dwordx4 v21, s[20:23], s37 offen offset:0 lds
    v_mfma_f32_16x16x32_bf16 v[184:187], v[120:123], v[84:87], v[184:187]
    v_accvgpr_read_b32 v0, a224
    v_accvgpr_read_b32 v1, a225
    v_mfma_f32_16x16x32_bf16 v[216:219], v[120:123], v[88:91], v[216:219]
    v_accvgpr_read_b32 v2, a226
    v_accvgpr_read_b32 v3, a227
    v_mfma_f32_16x16x32_bf16 v[248:251], v[120:123], v[92:95], v[248:251]
    buffer_store_dwordx4 v[8:11], v16, s[16:19], s41 offen offset:0
    v_mfma_f32_16x16x32_bf16 v[156:159], v[124:127], v[80:83], v[156:159]
    v_cvt_pk_bf16_f32 v0, v0, v1
    v_cvt_pk_bf16_f32 v1, v2, v3
    v_mfma_f32_16x16x32_bf16 v[188:191], v[124:127], v[84:87], v[188:191]
    v_cvt_pk_bf16_f32 v2, v4, v5
    v_cvt_pk_bf16_f32 v3, v6, v7
    v_mfma_f32_16x16x32_bf16 v[220:223], v[124:127], v[88:91], v[220:223]
    buffer_load_dwordx4 v22, s[20:23], s37 offen offset:1024 lds
    v_mfma_f32_16x16x32_bf16 v[252:255], v[124:127], v[92:95], v[252:255]
    s_waitcnt lgkmcnt(0)
    v_accvgpr_read_b32 v12, a100
    v_accvgpr_read_b32 v13, a101
    v_mfma_f32_16x16x32_bf16 v[128:131], v[48:51], v[32:35], v[128:131]
    ds_read_b64_tr_b16 v[96:97], v27 offset:43520
    ds_read_b64_tr_b16 v[98:99], v27 offset:44544
    v_mfma_f32_16x16x32_bf16 v[160:163], v[48:51], v[36:39], v[160:163]
    s_add_u32 s36, s45, 512
    v_accvgpr_read_b32 v14, a102
    v_accvgpr_read_b32 v15, a103
    v_mfma_f32_16x16x32_bf16 v[192:195], v[48:51], v[40:43], v[192:195]
    s_add_u32 m0, s42, 4096
    ds_read_b128 v[80:83], v24 offset:32768
    ds_read_b128 v[84:87], v24 offset:34816
    v_mfma_f32_16x16x32_bf16 v[224:227], v[48:51], v[44:47], v[224:227]
    buffer_load_dwordx4 v17, s[24:27], s36 offen offset:0 lds
    v_mfma_f32_16x16x32_bf16 v[132:135], v[52:55], v[32:35], v[132:135]
    ds_read_b128 v[88:91], v24 offset:36864
    ds_read_b128 v[92:95], v24 offset:38912
    v_mfma_f32_16x16x32_bf16 v[164:167], v[52:55], v[36:39], v[164:167]
    v_accvgpr_read_b32 v8, a68
    v_accvgpr_read_b32 v9, a69
    v_mfma_f32_16x16x32_bf16 v[196:199], v[52:55], v[40:43], v[196:199]
    ds_read_b64_tr_b16 v[100:101], v28 offset:43520
    ds_read_b64_tr_b16 v[102:103], v28 offset:44544
    v_mfma_f32_16x16x32_bf16 v[228:231], v[52:55], v[44:47], v[228:231]
    buffer_load_dwordx4 v18, s[24:27], s36 offen offset:1024 lds
    v_mfma_f32_16x16x32_bf16 v[136:139], v[56:59], v[32:35], v[136:139]
    ds_read_b64_tr_b16 v[104:105], v29 offset:43520
    ds_read_b64_tr_b16 v[106:107], v29 offset:44544
    v_mfma_f32_16x16x32_bf16 v[168:171], v[56:59], v[36:39], v[168:171]
    v_accvgpr_read_b32 v10, a70
    v_accvgpr_read_b32 v11, a71
    v_mfma_f32_16x16x32_bf16 v[200:203], v[56:59], v[40:43], v[200:203]
    ds_read_b64_tr_b16 v[108:109], v30 offset:43520
    ds_read_b64_tr_b16 v[110:111], v30 offset:44544
    v_mfma_f32_16x16x32_bf16 v[232:235], v[56:59], v[44:47], v[232:235]
    buffer_store_dwordx4 v[0:3], v16, s[16:19], s38 offen offset:3072
    v_mfma_f32_16x16x32_bf16 v[140:143], v[60:63], v[32:35], v[140:143]
    s_add_u32 s38, s38, 16384
    ds_read_b64_tr_b16 v[112:113], v27 offset:43648
    ds_read_b64_tr_b16 v[114:115], v27 offset:44672
    v_mfma_f32_16x16x32_bf16 v[172:175], v[60:63], v[36:39], v[172:175]
    v_mul_f32 v8, s40, v8
    v_mul_f32 v9, s40, v9
    v_mfma_f32_16x16x32_bf16 v[204:207], v[60:63], v[40:43], v[204:207]
    ds_read_b64_tr_b16 v[116:117], v28 offset:43648
    ds_read_b64_tr_b16 v[118:119], v28 offset:44672
    v_mfma_f32_16x16x32_bf16 v[236:239], v[60:63], v[44:47], v[236:239]
    buffer_load_dwordx4 v19, s[24:27], s36 offen offset:2048 lds
    v_mfma_f32_16x16x32_bf16 v[144:147], v[64:67], v[32:35], v[144:147]
    ds_read_b64_tr_b16 v[120:121], v29 offset:43648
    ds_read_b64_tr_b16 v[122:123], v29 offset:44672
    v_mfma_f32_16x16x32_bf16 v[176:179], v[64:67], v[36:39], v[176:179]
    v_mul_f32 v10, s40, v10
    v_mul_f32 v11, s40, v11
    v_mfma_f32_16x16x32_bf16 v[208:211], v[64:67], v[40:43], v[208:211]
    ds_read_b64_tr_b16 v[124:125], v30 offset:43648
    ds_read_b64_tr_b16 v[126:127], v30 offset:44672
    v_mfma_f32_16x16x32_bf16 v[240:243], v[64:67], v[44:47], v[240:243]
    v_mul_f32 v12, s40, v12
    v_mul_f32 v13, s40, v13
    v_mfma_f32_16x16x32_bf16 v[148:151], v[68:71], v[32:35], v[148:151]
    v_mul_f32 v14, s40, v14
    v_mul_f32 v15, s40, v15
    v_mfma_f32_16x16x32_bf16 v[180:183], v[68:71], v[36:39], v[180:183]
    buffer_load_dwordx4 v20, s[24:27], s36 offen offset:3072 lds
    v_mfma_f32_16x16x32_bf16 v[212:215], v[68:71], v[40:43], v[212:215]
    s_add_u32 s37, s49, 2359296
    v_cvt_pk_bf16_f32 v8, v8, v9
    v_cvt_pk_bf16_f32 v9, v10, v11
    v_mfma_f32_16x16x32_bf16 v[244:247], v[68:71], v[44:47], v[244:247]
    s_add_u32 m0, s50, 26112
    v_cvt_pk_bf16_f32 v10, v12, v13
    v_cvt_pk_bf16_f32 v11, v14, v15
    v_mfma_f32_16x16x32_bf16 v[152:155], v[72:75], v[32:35], v[152:155]
    buffer_load_dwordx4 v21, s[20:23], s37 offen offset:0 lds
    v_mfma_f32_16x16x32_bf16 v[184:187], v[72:75], v[36:39], v[184:187]
    v_accvgpr_read_b32 v4, a140
    v_accvgpr_read_b32 v5, a141
    v_mfma_f32_16x16x32_bf16 v[216:219], v[72:75], v[40:43], v[216:219]
    v_accvgpr_read_b32 v6, a142
    v_accvgpr_read_b32 v7, a143
    v_mfma_f32_16x16x32_bf16 v[248:251], v[72:75], v[44:47], v[248:251]
    buffer_store_dwordx4 v[8:11], v16, s[16:19], s41 offen offset:1024
    v_mfma_f32_16x16x32_bf16 v[156:159], v[76:79], v[32:35], v[156:159]
    s_add_u32 s41, s41, 12288
    v_accvgpr_read_b32 v0, a136
    v_accvgpr_read_b32 v1, a137
    v_mfma_f32_16x16x32_bf16 v[188:191], v[76:79], v[36:39], v[188:191]
    v_accvgpr_read_b32 v2, a138
    v_accvgpr_read_b32 v3, a139
    v_mfma_f32_16x16x32_bf16 v[220:223], v[76:79], v[40:43], v[220:223]
    buffer_load_dwordx4 v22, s[20:23], s37 offen offset:1024 lds
    v_mfma_f32_16x16x32_bf16 v[252:255], v[76:79], v[44:47], v[252:255]
    s_waitcnt vmcnt(16) lgkmcnt(0)
    s_barrier
    v_cvt_pk_bf16_f32 v0, v0, v1
    v_cvt_pk_bf16_f32 v1, v2, v3
    v_mfma_f32_16x16x32_bf16 v[128:131], v[96:99], v[80:83], v[128:131]
    ds_read_b64_tr_b16 v[48:49], v27 offset:0
    ds_read_b64_tr_b16 v[50:51], v27 offset:1024
    v_mfma_f32_16x16x32_bf16 v[160:163], v[96:99], v[84:87], v[160:163]
    s_add_u32 s36, s44, 640
    v_cvt_pk_bf16_f32 v2, v4, v5
    v_cvt_pk_bf16_f32 v3, v6, v7
    v_mfma_f32_16x16x32_bf16 v[192:195], v[96:99], v[88:91], v[192:195]
    s_add_u32 m0, s42, 32768
    ds_read_b128 v[32:35], v25 offset:0
    ds_read_b128 v[36:39], v25 offset:2048
    v_mfma_f32_16x16x32_bf16 v[224:227], v[96:99], v[92:95], v[224:227]
    buffer_load_dwordx4 v17, s[24:27], s36 offen offset:0 lds
    v_mfma_f32_16x16x32_bf16 v[132:135], v[100:103], v[80:83], v[132:135]
    ds_read_b128 v[40:43], v25 offset:4096
    ds_read_b128 v[44:47], v25 offset:6144
    v_mfma_f32_16x16x32_bf16 v[164:167], v[100:103], v[84:87], v[164:167]
    v_accvgpr_read_b32 v12, a40
    v_accvgpr_read_b32 v13, a41
    v_mfma_f32_16x16x32_bf16 v[196:199], v[100:103], v[88:91], v[196:199]
    ds_read_b64_tr_b16 v[52:53], v28 offset:0
    ds_read_b64_tr_b16 v[54:55], v28 offset:1024
    v_mfma_f32_16x16x32_bf16 v[228:231], v[100:103], v[92:95], v[228:231]
    buffer_load_dwordx4 v18, s[24:27], s36 offen offset:1024 lds
    v_mfma_f32_16x16x32_bf16 v[136:139], v[104:107], v[80:83], v[136:139]
    ds_read_b64_tr_b16 v[56:57], v29 offset:0
    ds_read_b64_tr_b16 v[58:59], v29 offset:1024
    v_mfma_f32_16x16x32_bf16 v[168:171], v[104:107], v[84:87], v[168:171]
    v_accvgpr_read_b32 v14, a42
    v_accvgpr_read_b32 v15, a43
    v_mfma_f32_16x16x32_bf16 v[200:203], v[104:107], v[88:91], v[200:203]
    ds_read_b64_tr_b16 v[60:61], v30 offset:0
    ds_read_b64_tr_b16 v[62:63], v30 offset:1024
    v_mfma_f32_16x16x32_bf16 v[232:235], v[104:107], v[92:95], v[232:235]
    buffer_store_dwordx4 v[0:3], v16, s[16:19], s38 offen offset:0
    v_mfma_f32_16x16x32_bf16 v[140:143], v[108:111], v[80:83], v[140:143]
    ds_read_b64_tr_b16 v[64:65], v27 offset:128
    ds_read_b64_tr_b16 v[66:67], v27 offset:1152
    v_mfma_f32_16x16x32_bf16 v[172:175], v[108:111], v[84:87], v[172:175]
    v_accvgpr_read_b32 v8, a8
    v_accvgpr_read_b32 v9, a9
    v_mfma_f32_16x16x32_bf16 v[204:207], v[108:111], v[88:91], v[204:207]
    ds_read_b64_tr_b16 v[68:69], v28 offset:128
    ds_read_b64_tr_b16 v[70:71], v28 offset:1152
    v_mfma_f32_16x16x32_bf16 v[236:239], v[108:111], v[92:95], v[236:239]
    buffer_load_dwordx4 v19, s[24:27], s36 offen offset:2048 lds
    v_mfma_f32_16x16x32_bf16 v[144:147], v[112:115], v[80:83], v[144:147]
    ds_read_b64_tr_b16 v[72:73], v29 offset:128
    ds_read_b64_tr_b16 v[74:75], v29 offset:1152
    v_mfma_f32_16x16x32_bf16 v[176:179], v[112:115], v[84:87], v[176:179]
    v_accvgpr_read_b32 v10, a10
    v_accvgpr_read_b32 v11, a11
    v_mfma_f32_16x16x32_bf16 v[208:211], v[112:115], v[88:91], v[208:211]
    ds_read_b64_tr_b16 v[76:77], v30 offset:128
    ds_read_b64_tr_b16 v[78:79], v30 offset:1152
    v_mfma_f32_16x16x32_bf16 v[240:243], v[112:115], v[92:95], v[240:243]
    v_mul_f32 v8, s40, v8
    v_mul_f32 v9, s40, v9
    v_mfma_f32_16x16x32_bf16 v[148:151], v[116:119], v[80:83], v[148:151]
    v_mul_f32 v10, s40, v10
    v_mul_f32 v11, s40, v11
    v_mfma_f32_16x16x32_bf16 v[180:183], v[116:119], v[84:87], v[180:183]
    buffer_load_dwordx4 v20, s[24:27], s36 offen offset:3072 lds
    v_mfma_f32_16x16x32_bf16 v[212:215], v[116:119], v[88:91], v[212:215]
    s_add_u32 s37, s49, 2621440
    v_mul_f32 v12, s40, v12
    v_mul_f32 v13, s40, v13
    v_mfma_f32_16x16x32_bf16 v[244:247], v[116:119], v[92:95], v[244:247]
    s_add_u32 m0, s50, 34816
    v_mul_f32 v14, s40, v14
    v_mul_f32 v15, s40, v15
    v_mfma_f32_16x16x32_bf16 v[152:155], v[120:123], v[80:83], v[152:155]
    buffer_load_dwordx4 v21, s[20:23], s37 offen offset:0 lds
    v_mfma_f32_16x16x32_bf16 v[184:187], v[120:123], v[84:87], v[184:187]
    v_cvt_pk_bf16_f32 v8, v8, v9
    v_cvt_pk_bf16_f32 v9, v10, v11
    v_mfma_f32_16x16x32_bf16 v[216:219], v[120:123], v[88:91], v[216:219]
    v_cvt_pk_bf16_f32 v10, v12, v13
    v_cvt_pk_bf16_f32 v11, v14, v15
    v_mfma_f32_16x16x32_bf16 v[248:251], v[120:123], v[92:95], v[248:251]
    buffer_store_dwordx4 v[8:11], v16, s[16:19], s41 offen offset:0
    v_mfma_f32_16x16x32_bf16 v[156:159], v[124:127], v[80:83], v[156:159]
    v_accvgpr_read_b32 v4, a172
    v_accvgpr_read_b32 v5, a173
    v_mfma_f32_16x16x32_bf16 v[188:191], v[124:127], v[84:87], v[188:191]
    v_accvgpr_read_b32 v6, a174
    v_accvgpr_read_b32 v7, a175
    v_mfma_f32_16x16x32_bf16 v[220:223], v[124:127], v[88:91], v[220:223]
    buffer_load_dwordx4 v22, s[20:23], s37 offen offset:1024 lds
    v_mfma_f32_16x16x32_bf16 v[252:255], v[124:127], v[92:95], v[252:255]
    s_waitcnt lgkmcnt(0)
    v_accvgpr_read_b32 v0, a168
    v_accvgpr_read_b32 v1, a169
    v_mfma_f32_16x16x32_bf16 v[128:131], v[48:51], v[32:35], v[128:131]
    ds_read_b64_tr_b16 v[96:97], v27 offset:8704
    ds_read_b64_tr_b16 v[98:99], v27 offset:9728
    v_mfma_f32_16x16x32_bf16 v[160:163], v[48:51], v[36:39], v[160:163]
    s_add_u32 s36, s45, 640
    v_accvgpr_read_b32 v2, a170
    v_accvgpr_read_b32 v3, a171
    v_mfma_f32_16x16x32_bf16 v[192:195], v[48:51], v[40:43], v[192:195]
    s_add_u32 m0, s42, 36864
    ds_read_b128 v[80:83], v26 offset:0
    ds_read_b128 v[84:87], v26 offset:2048
    v_mfma_f32_16x16x32_bf16 v[224:227], v[48:51], v[44:47], v[224:227]
    buffer_load_dwordx4 v17, s[24:27], s36 offen offset:0 lds
    v_mfma_f32_16x16x32_bf16 v[132:135], v[52:55], v[32:35], v[132:135]
    ds_read_b128 v[88:91], v26 offset:4096
    ds_read_b128 v[92:95], v26 offset:6144
    v_mfma_f32_16x16x32_bf16 v[164:167], v[52:55], v[36:39], v[164:167]
    v_cvt_pk_bf16_f32 v0, v0, v1
    v_cvt_pk_bf16_f32 v1, v2, v3
    v_mfma_f32_16x16x32_bf16 v[196:199], v[52:55], v[40:43], v[196:199]
    ds_read_b64_tr_b16 v[100:101], v28 offset:8704
    ds_read_b64_tr_b16 v[102:103], v28 offset:9728
    v_mfma_f32_16x16x32_bf16 v[228:231], v[52:55], v[44:47], v[228:231]
    buffer_load_dwordx4 v18, s[24:27], s36 offen offset:1024 lds
    v_mfma_f32_16x16x32_bf16 v[136:139], v[56:59], v[32:35], v[136:139]
    ds_read_b64_tr_b16 v[104:105], v29 offset:8704
    ds_read_b64_tr_b16 v[106:107], v29 offset:9728
    v_mfma_f32_16x16x32_bf16 v[168:171], v[56:59], v[36:39], v[168:171]
    v_cvt_pk_bf16_f32 v2, v4, v5
    v_cvt_pk_bf16_f32 v3, v6, v7
    v_mfma_f32_16x16x32_bf16 v[200:203], v[56:59], v[40:43], v[200:203]
    ds_read_b64_tr_b16 v[108:109], v30 offset:8704
    ds_read_b64_tr_b16 v[110:111], v30 offset:9728
    v_mfma_f32_16x16x32_bf16 v[232:235], v[56:59], v[44:47], v[232:235]
    buffer_store_dwordx4 v[0:3], v16, s[16:19], s38 offen offset:1024
    v_mfma_f32_16x16x32_bf16 v[140:143], v[60:63], v[32:35], v[140:143]
    ds_read_b64_tr_b16 v[112:113], v27 offset:8832
    ds_read_b64_tr_b16 v[114:115], v27 offset:9856
    v_mfma_f32_16x16x32_bf16 v[172:175], v[60:63], v[36:39], v[172:175]
    v_accvgpr_read_b32 v12, a104
    v_accvgpr_read_b32 v13, a105
    v_mfma_f32_16x16x32_bf16 v[204:207], v[60:63], v[40:43], v[204:207]
    ds_read_b64_tr_b16 v[116:117], v28 offset:8832
    ds_read_b64_tr_b16 v[118:119], v28 offset:9856
    v_mfma_f32_16x16x32_bf16 v[236:239], v[60:63], v[44:47], v[236:239]
    buffer_load_dwordx4 v19, s[24:27], s36 offen offset:2048 lds
    v_mfma_f32_16x16x32_bf16 v[144:147], v[64:67], v[32:35], v[144:147]
    ds_read_b64_tr_b16 v[120:121], v29 offset:8832
    ds_read_b64_tr_b16 v[122:123], v29 offset:9856
    v_mfma_f32_16x16x32_bf16 v[176:179], v[64:67], v[36:39], v[176:179]
    v_accvgpr_read_b32 v14, a106
    v_accvgpr_read_b32 v15, a107
    v_mfma_f32_16x16x32_bf16 v[208:211], v[64:67], v[40:43], v[208:211]
    ds_read_b64_tr_b16 v[124:125], v30 offset:8832
    ds_read_b64_tr_b16 v[126:127], v30 offset:9856
    v_mfma_f32_16x16x32_bf16 v[240:243], v[64:67], v[44:47], v[240:243]
    v_accvgpr_read_b32 v8, a72
    v_accvgpr_read_b32 v9, a73
    v_mfma_f32_16x16x32_bf16 v[148:151], v[68:71], v[32:35], v[148:151]
    v_accvgpr_read_b32 v10, a74
    v_accvgpr_read_b32 v11, a75
    v_mfma_f32_16x16x32_bf16 v[180:183], v[68:71], v[36:39], v[180:183]
    buffer_load_dwordx4 v20, s[24:27], s36 offen offset:3072 lds
    v_mfma_f32_16x16x32_bf16 v[212:215], v[68:71], v[40:43], v[212:215]
    s_add_u32 s37, s49, 2883584
    v_mul_f32 v8, s40, v8
    v_mul_f32 v9, s40, v9
    v_mfma_f32_16x16x32_bf16 v[244:247], v[68:71], v[44:47], v[244:247]
    s_add_u32 m0, s50, 43520
    v_mul_f32 v10, s40, v10
    v_mul_f32 v11, s40, v11
    v_mfma_f32_16x16x32_bf16 v[152:155], v[72:75], v[32:35], v[152:155]
    buffer_load_dwordx4 v21, s[20:23], s37 offen offset:0 lds
    v_mfma_f32_16x16x32_bf16 v[184:187], v[72:75], v[36:39], v[184:187]
    v_mul_f32 v12, s40, v12
    v_mul_f32 v13, s40, v13
    v_mfma_f32_16x16x32_bf16 v[216:219], v[72:75], v[40:43], v[216:219]
    v_mul_f32 v14, s40, v14
    v_mul_f32 v15, s40, v15
    v_mfma_f32_16x16x32_bf16 v[248:251], v[72:75], v[44:47], v[248:251]
    v_mfma_f32_16x16x32_bf16 v[156:159], v[76:79], v[32:35], v[156:159]
    v_cvt_pk_bf16_f32 v8, v8, v9
    v_cvt_pk_bf16_f32 v9, v10, v11
    v_mfma_f32_16x16x32_bf16 v[188:191], v[76:79], v[36:39], v[188:191]
    v_cvt_pk_bf16_f32 v10, v12, v13
    v_cvt_pk_bf16_f32 v11, v14, v15
    v_mfma_f32_16x16x32_bf16 v[220:223], v[76:79], v[40:43], v[220:223]
    buffer_load_dwordx4 v22, s[20:23], s37 offen offset:1024 lds
    v_mfma_f32_16x16x32_bf16 v[252:255], v[76:79], v[44:47], v[252:255]
    s_waitcnt vmcnt(15) lgkmcnt(0)
    s_barrier
    v_accvgpr_read_b32 v4, a204
    v_accvgpr_read_b32 v5, a205
    v_mfma_f32_16x16x32_bf16 v[128:131], v[96:99], v[80:83], v[128:131]
    ds_read_b64_tr_b16 v[48:49], v27 offset:17408
    ds_read_b64_tr_b16 v[50:51], v27 offset:18432
    v_mfma_f32_16x16x32_bf16 v[160:163], v[96:99], v[84:87], v[160:163]
    s_add_u32 s36, s44, 768
    v_accvgpr_read_b32 v6, a206
    v_accvgpr_read_b32 v7, a207
    v_mfma_f32_16x16x32_bf16 v[192:195], v[96:99], v[88:91], v[192:195]
    s_add_u32 m0, s42, 65536
    ds_read_b128 v[32:35], v23 offset:0
    ds_read_b128 v[36:39], v23 offset:2048
    v_mfma_f32_16x16x32_bf16 v[224:227], v[96:99], v[92:95], v[224:227]
    buffer_load_dwordx4 v17, s[24:27], s36 offen offset:0 lds
    v_mfma_f32_16x16x32_bf16 v[132:135], v[100:103], v[80:83], v[132:135]
    ds_read_b128 v[40:43], v23 offset:4096
    ds_read_b128 v[44:47], v23 offset:6144
    v_mfma_f32_16x16x32_bf16 v[164:167], v[100:103], v[84:87], v[164:167]
    v_accvgpr_read_b32 v0, a200
    v_accvgpr_read_b32 v1, a201
    v_mfma_f32_16x16x32_bf16 v[196:199], v[100:103], v[88:91], v[196:199]
    ds_read_b64_tr_b16 v[52:53], v28 offset:17408
    ds_read_b64_tr_b16 v[54:55], v28 offset:18432
    v_mfma_f32_16x16x32_bf16 v[228:231], v[100:103], v[92:95], v[228:231]
    buffer_load_dwordx4 v18, s[24:27], s36 offen offset:1024 lds
    v_mfma_f32_16x16x32_bf16 v[136:139], v[104:107], v[80:83], v[136:139]
    ds_read_b64_tr_b16 v[56:57], v29 offset:17408
    ds_read_b64_tr_b16 v[58:59], v29 offset:18432
    v_mfma_f32_16x16x32_bf16 v[168:171], v[104:107], v[84:87], v[168:171]
    v_accvgpr_read_b32 v2, a202
    v_accvgpr_read_b32 v3, a203
    v_mfma_f32_16x16x32_bf16 v[200:203], v[104:107], v[88:91], v[200:203]
    ds_read_b64_tr_b16 v[60:61], v30 offset:17408
    ds_read_b64_tr_b16 v[62:63], v30 offset:18432
    v_mfma_f32_16x16x32_bf16 v[232:235], v[104:107], v[92:95], v[232:235]
    buffer_store_dwordx4 v[8:11], v16, s[16:19], s41 offen offset:1024
    v_mfma_f32_16x16x32_bf16 v[140:143], v[108:111], v[80:83], v[140:143]
    s_add_u32 s41, s41, 4096
    ds_read_b64_tr_b16 v[64:65], v27 offset:17536
    ds_read_b64_tr_b16 v[66:67], v27 offset:18560
    v_mfma_f32_16x16x32_bf16 v[172:175], v[108:111], v[84:87], v[172:175]
    v_cvt_pk_bf16_f32 v0, v0, v1
    v_cvt_pk_bf16_f32 v1, v2, v3
    v_mfma_f32_16x16x32_bf16 v[204:207], v[108:111], v[88:91], v[204:207]
    ds_read_b64_tr_b16 v[68:69], v28 offset:17536
    ds_read_b64_tr_b16 v[70:71], v28 offset:18560
    v_mfma_f32_16x16x32_bf16 v[236:239], v[108:111], v[92:95], v[236:239]
    buffer_load_dwordx4 v19, s[24:27], s36 offen offset:2048 lds
    v_mfma_f32_16x16x32_bf16 v[144:147], v[112:115], v[80:83], v[144:147]
    ds_read_b64_tr_b16 v[72:73], v29 offset:17536
    ds_read_b64_tr_b16 v[74:75], v29 offset:18560
    v_mfma_f32_16x16x32_bf16 v[176:179], v[112:115], v[84:87], v[176:179]
    v_cvt_pk_bf16_f32 v2, v4, v5
    v_cvt_pk_bf16_f32 v3, v6, v7
    v_mfma_f32_16x16x32_bf16 v[208:211], v[112:115], v[88:91], v[208:211]
    ds_read_b64_tr_b16 v[76:77], v30 offset:17536
    ds_read_b64_tr_b16 v[78:79], v30 offset:18560
    v_mfma_f32_16x16x32_bf16 v[240:243], v[112:115], v[92:95], v[240:243]
    v_accvgpr_read_b32 v12, a44
    v_accvgpr_read_b32 v13, a45
    v_mfma_f32_16x16x32_bf16 v[148:151], v[116:119], v[80:83], v[148:151]
    v_accvgpr_read_b32 v14, a46
    v_accvgpr_read_b32 v15, a47
    v_mfma_f32_16x16x32_bf16 v[180:183], v[116:119], v[84:87], v[180:183]
    buffer_load_dwordx4 v20, s[24:27], s36 offen offset:3072 lds
    v_mfma_f32_16x16x32_bf16 v[212:215], v[116:119], v[88:91], v[212:215]
    s_add_u32 s37, s49, 3145728
    v_accvgpr_read_b32 v8, a12
    v_accvgpr_read_b32 v9, a13
    v_mfma_f32_16x16x32_bf16 v[244:247], v[116:119], v[92:95], v[244:247]
    s_add_u32 m0, s50, 0
    v_accvgpr_read_b32 v10, a14
    v_accvgpr_read_b32 v11, a15
    v_mfma_f32_16x16x32_bf16 v[152:155], v[120:123], v[80:83], v[152:155]
    buffer_load_dwordx4 v21, s[20:23], s37 offen offset:0 lds
    v_mfma_f32_16x16x32_bf16 v[184:187], v[120:123], v[84:87], v[184:187]
    v_mul_f32 v8, s40, v8
    v_mul_f32 v9, s40, v9
    v_mfma_f32_16x16x32_bf16 v[216:219], v[120:123], v[88:91], v[216:219]
    v_mul_f32 v10, s40, v10
    v_mul_f32 v11, s40, v11
    v_mfma_f32_16x16x32_bf16 v[248:251], v[120:123], v[92:95], v[248:251]
    buffer_store_dwordx4 v[0:3], v16, s[16:19], s38 offen offset:2048
    v_mfma_f32_16x16x32_bf16 v[156:159], v[124:127], v[80:83], v[156:159]
    v_mul_f32 v12, s40, v12
    v_mul_f32 v13, s40, v13
    v_mfma_f32_16x16x32_bf16 v[188:191], v[124:127], v[84:87], v[188:191]
    v_mul_f32 v14, s40, v14
    v_mul_f32 v15, s40, v15
    v_mfma_f32_16x16x32_bf16 v[220:223], v[124:127], v[88:91], v[220:223]
    buffer_load_dwordx4 v22, s[20:23], s37 offen offset:1024 lds
    v_mfma_f32_16x16x32_bf16 v[252:255], v[124:127], v[92:95], v[252:255]
    s_waitcnt lgkmcnt(0)
    v_cvt_pk_bf16_f32 v8, v8, v9
    v_cvt_pk_bf16_f32 v9, v10, v11
    v_mfma_f32_16x16x32_bf16 v[128:131], v[48:51], v[32:35], v[128:131]
    ds_read_b64_tr_b16 v[96:97], v27 offset:26112
    ds_read_b64_tr_b16 v[98:99], v27 offset:27136
    v_mfma_f32_16x16x32_bf16 v[160:163], v[48:51], v[36:39], v[160:163]
    s_add_u32 s36, s45, 768
    v_cvt_pk_bf16_f32 v10, v12, v13
    v_cvt_pk_bf16_f32 v11, v14, v15
    v_mfma_f32_16x16x32_bf16 v[192:195], v[48:51], v[40:43], v[192:195]
    s_add_u32 m0, s42, 69632
    ds_read_b128 v[80:83], v24 offset:0
    ds_read_b128 v[84:87], v24 offset:2048
    v_mfma_f32_16x16x32_bf16 v[224:227], v[48:51], v[44:47], v[224:227]
    buffer_load_dwordx4 v17, s[24:27], s36 offen offset:0 lds
    v_mfma_f32_16x16x32_bf16 v[132:135], v[52:55], v[32:35], v[132:135]
    ds_read_b128 v[88:91], v24 offset:4096
    ds_read_b128 v[92:95], v24 offset:6144
    v_mfma_f32_16x16x32_bf16 v[164:167], v[52:55], v[36:39], v[164:167]
    v_accvgpr_read_b32 v4, a236
    v_accvgpr_read_b32 v5, a237
    v_mfma_f32_16x16x32_bf16 v[196:199], v[52:55], v[40:43], v[196:199]
    ds_read_b64_tr_b16 v[100:101], v28 offset:26112
    ds_read_b64_tr_b16 v[102:103], v28 offset:27136
    v_mfma_f32_16x16x32_bf16 v[228:231], v[52:55], v[44:47], v[228:231]
    buffer_load_dwordx4 v18, s[24:27], s36 offen offset:1024 lds
    v_mfma_f32_16x16x32_bf16 v[136:139], v[56:59], v[32:35], v[136:139]
    ds_read_b64_tr_b16 v[104:105], v29 offset:26112
    ds_read_b64_tr_b16 v[106:107], v29 offset:27136
    v_mfma_f32_16x16x32_bf16 v[168:171], v[56:59], v[36:39], v[168:171]
    v_accvgpr_read_b32 v6, a238
    v_accvgpr_read_b32 v7, a239
    v_mfma_f32_16x16x32_bf16 v[200:203], v[56:59], v[40:43], v[200:203]
    ds_read_b64_tr_b16 v[108:109], v30 offset:26112
    ds_read_b64_tr_b16 v[110:111], v30 offset:27136
    v_mfma_f32_16x16x32_bf16 v[232:235], v[56:59], v[44:47], v[232:235]
    buffer_store_dwordx4 v[8:11], v16, s[16:19], s41 offen offset:0
    v_mfma_f32_16x16x32_bf16 v[140:143], v[60:63], v[32:35], v[140:143]
    ds_read_b64_tr_b16 v[112:113], v27 offset:26240
    ds_read_b64_tr_b16 v[114:115], v27 offset:27264
    v_mfma_f32_16x16x32_bf16 v[172:175], v[60:63], v[36:39], v[172:175]
    v_accvgpr_read_b32 v0, a232
    v_accvgpr_read_b32 v1, a233
    v_mfma_f32_16x16x32_bf16 v[204:207], v[60:63], v[40:43], v[204:207]
    ds_read_b64_tr_b16 v[116:117], v28 offset:26240
    ds_read_b64_tr_b16 v[118:119], v28 offset:27264
    v_mfma_f32_16x16x32_bf16 v[236:239], v[60:63], v[44:47], v[236:239]
    buffer_load_dwordx4 v19, s[24:27], s36 offen offset:2048 lds
    v_mfma_f32_16x16x32_bf16 v[144:147], v[64:67], v[32:35], v[144:147]
    ds_read_b64_tr_b16 v[120:121], v29 offset:26240
    ds_read_b64_tr_b16 v[122:123], v29 offset:27264
    v_mfma_f32_16x16x32_bf16 v[176:179], v[64:67], v[36:39], v[176:179]
    v_accvgpr_read_b32 v2, a234
    v_accvgpr_read_b32 v3, a235
    v_mfma_f32_16x16x32_bf16 v[208:211], v[64:67], v[40:43], v[208:211]
    ds_read_b64_tr_b16 v[124:125], v30 offset:26240
    ds_read_b64_tr_b16 v[126:127], v30 offset:27264
    v_mfma_f32_16x16x32_bf16 v[240:243], v[64:67], v[44:47], v[240:243]
    v_cvt_pk_bf16_f32 v0, v0, v1
    v_cvt_pk_bf16_f32 v1, v2, v3
    v_mfma_f32_16x16x32_bf16 v[148:151], v[68:71], v[32:35], v[148:151]
    v_cvt_pk_bf16_f32 v2, v4, v5
    v_cvt_pk_bf16_f32 v3, v6, v7
    v_mfma_f32_16x16x32_bf16 v[180:183], v[68:71], v[36:39], v[180:183]
    buffer_load_dwordx4 v20, s[24:27], s36 offen offset:3072 lds
    v_mfma_f32_16x16x32_bf16 v[212:215], v[68:71], v[40:43], v[212:215]
    s_add_u32 s37, s49, 3407872
    v_accvgpr_read_b32 v12, a108
    v_accvgpr_read_b32 v13, a109
    v_mfma_f32_16x16x32_bf16 v[244:247], v[68:71], v[44:47], v[244:247]
    s_add_u32 m0, s50, 8704
    v_accvgpr_read_b32 v14, a110
    v_accvgpr_read_b32 v15, a111
    v_mfma_f32_16x16x32_bf16 v[152:155], v[72:75], v[32:35], v[152:155]
    buffer_load_dwordx4 v21, s[20:23], s37 offen offset:0 lds
    v_mfma_f32_16x16x32_bf16 v[184:187], v[72:75], v[36:39], v[184:187]
    v_accvgpr_read_b32 v8, a76
    v_accvgpr_read_b32 v9, a77
    v_mfma_f32_16x16x32_bf16 v[216:219], v[72:75], v[40:43], v[216:219]
    v_accvgpr_read_b32 v10, a78
    v_accvgpr_read_b32 v11, a79
    v_mfma_f32_16x16x32_bf16 v[248:251], v[72:75], v[44:47], v[248:251]
    buffer_store_dwordx4 v[0:3], v16, s[16:19], s38 offen offset:3072
    v_mfma_f32_16x16x32_bf16 v[156:159], v[76:79], v[32:35], v[156:159]
    s_add_u32 s38, s38, 16384
    v_mul_f32 v8, s40, v8
    v_mul_f32 v9, s40, v9
    v_mfma_f32_16x16x32_bf16 v[188:191], v[76:79], v[36:39], v[188:191]
    v_mul_f32 v10, s40, v10
    v_mul_f32 v11, s40, v11
    v_mfma_f32_16x16x32_bf16 v[220:223], v[76:79], v[40:43], v[220:223]
    buffer_load_dwordx4 v22, s[20:23], s37 offen offset:1024 lds
    v_mfma_f32_16x16x32_bf16 v[252:255], v[76:79], v[44:47], v[252:255]
    s_waitcnt vmcnt(16) lgkmcnt(0)
    s_barrier
    v_mul_f32 v12, s40, v12
    v_mul_f32 v13, s40, v13
    v_mfma_f32_16x16x32_bf16 v[128:131], v[96:99], v[80:83], v[128:131]
    ds_read_b64_tr_b16 v[48:49], v27 offset:34816
    ds_read_b64_tr_b16 v[50:51], v27 offset:35840
    v_mfma_f32_16x16x32_bf16 v[160:163], v[96:99], v[84:87], v[160:163]
    s_add_u32 s36, s44, 896
    v_mul_f32 v14, s40, v14
    v_mul_f32 v15, s40, v15
    v_mfma_f32_16x16x32_bf16 v[192:195], v[96:99], v[88:91], v[192:195]
    s_add_u32 m0, s42, 0
    ds_read_b128 v[32:35], v23 offset:32768
    ds_read_b128 v[36:39], v23 offset:34816
    v_mfma_f32_16x16x32_bf16 v[224:227], v[96:99], v[92:95], v[224:227]
    buffer_load_dwordx4 v17, s[24:27], s36 offen offset:0 lds
    v_mfma_f32_16x16x32_bf16 v[132:135], v[100:103], v[80:83], v[132:135]
    ds_read_b128 v[40:43], v23 offset:36864
    ds_read_b128 v[44:47], v23 offset:38912
    v_mfma_f32_16x16x32_bf16 v[164:167], v[100:103], v[84:87], v[164:167]
    v_cvt_pk_bf16_f32 v8, v8, v9
    v_cvt_pk_bf16_f32 v9, v10, v11
    v_mfma_f32_16x16x32_bf16 v[196:199], v[100:103], v[88:91], v[196:199]
    ds_read_b64_tr_b16 v[52:53], v28 offset:34816
    ds_read_b64_tr_b16 v[54:55], v28 offset:35840
    v_mfma_f32_16x16x32_bf16 v[228:231], v[100:103], v[92:95], v[228:231]
    buffer_load_dwordx4 v18, s[24:27], s36 offen offset:1024 lds
    v_mfma_f32_16x16x32_bf16 v[136:139], v[104:107], v[80:83], v[136:139]
    ds_read_b64_tr_b16 v[56:57], v29 offset:34816
    ds_read_b64_tr_b16 v[58:59], v29 offset:35840
    v_mfma_f32_16x16x32_bf16 v[168:171], v[104:107], v[84:87], v[168:171]
    v_cvt_pk_bf16_f32 v10, v12, v13
    v_cvt_pk_bf16_f32 v11, v14, v15
    v_mfma_f32_16x16x32_bf16 v[200:203], v[104:107], v[88:91], v[200:203]
    ds_read_b64_tr_b16 v[60:61], v30 offset:34816
    ds_read_b64_tr_b16 v[62:63], v30 offset:35840
    v_mfma_f32_16x16x32_bf16 v[232:235], v[104:107], v[92:95], v[232:235]
    buffer_store_dwordx4 v[8:11], v16, s[16:19], s41 offen offset:1024
    v_mfma_f32_16x16x32_bf16 v[140:143], v[108:111], v[80:83], v[140:143]
    s_add_u32 s41, s41, 12288
    ds_read_b64_tr_b16 v[64:65], v27 offset:34944
    ds_read_b64_tr_b16 v[66:67], v27 offset:35968
    v_mfma_f32_16x16x32_bf16 v[172:175], v[108:111], v[84:87], v[172:175]
    v_accvgpr_read_b32 v4, a148
    v_accvgpr_read_b32 v5, a149
    v_mfma_f32_16x16x32_bf16 v[204:207], v[108:111], v[88:91], v[204:207]
    ds_read_b64_tr_b16 v[68:69], v28 offset:34944
    ds_read_b64_tr_b16 v[70:71], v28 offset:35968
    v_mfma_f32_16x16x32_bf16 v[236:239], v[108:111], v[92:95], v[236:239]
    buffer_load_dwordx4 v19, s[24:27], s36 offen offset:2048 lds
    v_mfma_f32_16x16x32_bf16 v[144:147], v[112:115], v[80:83], v[144:147]
    ds_read_b64_tr_b16 v[72:73], v29 offset:34944
    ds_read_b64_tr_b16 v[74:75], v29 offset:35968
    v_mfma_f32_16x16x32_bf16 v[176:179], v[112:115], v[84:87], v[176:179]
    v_accvgpr_read_b32 v6, a150
    v_accvgpr_read_b32 v7, a151
    v_mfma_f32_16x16x32_bf16 v[208:211], v[112:115], v[88:91], v[208:211]
    ds_read_b64_tr_b16 v[76:77], v30 offset:34944
    ds_read_b64_tr_b16 v[78:79], v30 offset:35968
    v_mfma_f32_16x16x32_bf16 v[240:243], v[112:115], v[92:95], v[240:243]
    v_accvgpr_read_b32 v0, a144
    v_accvgpr_read_b32 v1, a145
    v_mfma_f32_16x16x32_bf16 v[148:151], v[116:119], v[80:83], v[148:151]
    v_accvgpr_read_b32 v2, a146
    v_accvgpr_read_b32 v3, a147
    v_mfma_f32_16x16x32_bf16 v[180:183], v[116:119], v[84:87], v[180:183]
    buffer_load_dwordx4 v20, s[24:27], s36 offen offset:3072 lds
    v_mfma_f32_16x16x32_bf16 v[212:215], v[116:119], v[88:91], v[212:215]
    s_add_u32 s37, s49, 3670016
    v_cvt_pk_bf16_f32 v0, v0, v1
    v_cvt_pk_bf16_f32 v1, v2, v3
    v_mfma_f32_16x16x32_bf16 v[244:247], v[116:119], v[92:95], v[244:247]
    s_add_u32 m0, s50, 17408
    v_cvt_pk_bf16_f32 v2, v4, v5
    v_cvt_pk_bf16_f32 v3, v6, v7
    v_mfma_f32_16x16x32_bf16 v[152:155], v[120:123], v[80:83], v[152:155]
    buffer_load_dwordx4 v21, s[20:23], s37 offen offset:0 lds
    v_mfma_f32_16x16x32_bf16 v[184:187], v[120:123], v[84:87], v[184:187]
    v_accvgpr_read_b32 v12, a48
    v_accvgpr_read_b32 v13, a49
    v_mfma_f32_16x16x32_bf16 v[216:219], v[120:123], v[88:91], v[216:219]
    v_accvgpr_read_b32 v14, a50
    v_accvgpr_read_b32 v15, a51
    v_mfma_f32_16x16x32_bf16 v[248:251], v[120:123], v[92:95], v[248:251]
    buffer_store_dwordx4 v[0:3], v16, s[16:19], s38 offen offset:0
    v_mfma_f32_16x16x32_bf16 v[156:159], v[124:127], v[80:83], v[156:159]
    v_accvgpr_read_b32 v8, a16
    v_accvgpr_read_b32 v9, a17
    v_mfma_f32_16x16x32_bf16 v[188:191], v[124:127], v[84:87], v[188:191]
    v_accvgpr_read_b32 v10, a18
    v_accvgpr_read_b32 v11, a19
    v_mfma_f32_16x16x32_bf16 v[220:223], v[124:127], v[88:91], v[220:223]
    buffer_load_dwordx4 v22, s[20:23], s37 offen offset:1024 lds
    v_mfma_f32_16x16x32_bf16 v[252:255], v[124:127], v[92:95], v[252:255]
    s_waitcnt lgkmcnt(0)
    v_mul_f32 v8, s40, v8
    v_mul_f32 v9, s40, v9
    v_mfma_f32_16x16x32_bf16 v[128:131], v[48:51], v[32:35], v[128:131]
    ds_read_b64_tr_b16 v[96:97], v27 offset:43520
    ds_read_b64_tr_b16 v[98:99], v27 offset:44544
    v_mfma_f32_16x16x32_bf16 v[160:163], v[48:51], v[36:39], v[160:163]
    s_add_u32 s36, s45, 896
    v_mul_f32 v10, s40, v10
    v_mul_f32 v11, s40, v11
    v_mfma_f32_16x16x32_bf16 v[192:195], v[48:51], v[40:43], v[192:195]
    s_add_u32 m0, s42, 4096
    ds_read_b128 v[80:83], v24 offset:32768
    ds_read_b128 v[84:87], v24 offset:34816
    v_mfma_f32_16x16x32_bf16 v[224:227], v[48:51], v[44:47], v[224:227]
    buffer_load_dwordx4 v17, s[24:27], s36 offen offset:0 lds
    v_mfma_f32_16x16x32_bf16 v[132:135], v[52:55], v[32:35], v[132:135]
    ds_read_b128 v[88:91], v24 offset:36864
    ds_read_b128 v[92:95], v24 offset:38912
    v_mfma_f32_16x16x32_bf16 v[164:167], v[52:55], v[36:39], v[164:167]
    v_mul_f32 v12, s40, v12
    v_mul_f32 v13, s40, v13
    v_mfma_f32_16x16x32_bf16 v[196:199], v[52:55], v[40:43], v[196:199]
    ds_read_b64_tr_b16 v[100:101], v28 offset:43520
    ds_read_b64_tr_b16 v[102:103], v28 offset:44544
    v_mfma_f32_16x16x32_bf16 v[228:231], v[52:55], v[44:47], v[228:231]
    buffer_load_dwordx4 v18, s[24:27], s36 offen offset:1024 lds
    v_mfma_f32_16x16x32_bf16 v[136:139], v[56:59], v[32:35], v[136:139]
    ds_read_b64_tr_b16 v[104:105], v29 offset:43520
    ds_read_b64_tr_b16 v[106:107], v29 offset:44544
    v_mfma_f32_16x16x32_bf16 v[168:171], v[56:59], v[36:39], v[168:171]
    v_mul_f32 v14, s40, v14
    v_mul_f32 v15, s40, v15
    v_mfma_f32_16x16x32_bf16 v[200:203], v[56:59], v[40:43], v[200:203]
    ds_read_b64_tr_b16 v[108:109], v30 offset:43520
    ds_read_b64_tr_b16 v[110:111], v30 offset:44544
    v_mfma_f32_16x16x32_bf16 v[232:235], v[56:59], v[44:47], v[232:235]
    v_mfma_f32_16x16x32_bf16 v[140:143], v[60:63], v[32:35], v[140:143]
    ds_read_b64_tr_b16 v[112:113], v27 offset:43648
    ds_read_b64_tr_b16 v[114:115], v27 offset:44672
    v_mfma_f32_16x16x32_bf16 v[172:175], v[60:63], v[36:39], v[172:175]
    v_cvt_pk_bf16_f32 v8, v8, v9
    v_cvt_pk_bf16_f32 v9, v10, v11
    v_mfma_f32_16x16x32_bf16 v[204:207], v[60:63], v[40:43], v[204:207]
    ds_read_b64_tr_b16 v[116:117], v28 offset:43648
    ds_read_b64_tr_b16 v[118:119], v28 offset:44672
    v_mfma_f32_16x16x32_bf16 v[236:239], v[60:63], v[44:47], v[236:239]
    buffer_load_dwordx4 v19, s[24:27], s36 offen offset:2048 lds
    v_mfma_f32_16x16x32_bf16 v[144:147], v[64:67], v[32:35], v[144:147]
    ds_read_b64_tr_b16 v[120:121], v29 offset:43648
    ds_read_b64_tr_b16 v[122:123], v29 offset:44672
    v_mfma_f32_16x16x32_bf16 v[176:179], v[64:67], v[36:39], v[176:179]
    v_cvt_pk_bf16_f32 v10, v12, v13
    v_cvt_pk_bf16_f32 v11, v14, v15
    v_mfma_f32_16x16x32_bf16 v[208:211], v[64:67], v[40:43], v[208:211]
    ds_read_b64_tr_b16 v[124:125], v30 offset:43648
    ds_read_b64_tr_b16 v[126:127], v30 offset:44672
    v_mfma_f32_16x16x32_bf16 v[240:243], v[64:67], v[44:47], v[240:243]
    v_accvgpr_read_b32 v4, a180
    v_accvgpr_read_b32 v5, a181
    v_mfma_f32_16x16x32_bf16 v[148:151], v[68:71], v[32:35], v[148:151]
    v_accvgpr_read_b32 v6, a182
    v_accvgpr_read_b32 v7, a183
    v_mfma_f32_16x16x32_bf16 v[180:183], v[68:71], v[36:39], v[180:183]
    buffer_load_dwordx4 v20, s[24:27], s36 offen offset:3072 lds
    v_mfma_f32_16x16x32_bf16 v[212:215], v[68:71], v[40:43], v[212:215]
    s_add_u32 s37, s49, 3932160
    v_accvgpr_read_b32 v0, a176
    v_accvgpr_read_b32 v1, a177
    v_mfma_f32_16x16x32_bf16 v[244:247], v[68:71], v[44:47], v[244:247]
    s_add_u32 m0, s50, 26112
    v_accvgpr_read_b32 v2, a178
    v_accvgpr_read_b32 v3, a179
    v_mfma_f32_16x16x32_bf16 v[152:155], v[72:75], v[32:35], v[152:155]
    buffer_load_dwordx4 v21, s[20:23], s37 offen offset:0 lds
    v_mfma_f32_16x16x32_bf16 v[184:187], v[72:75], v[36:39], v[184:187]
    v_cvt_pk_bf16_f32 v0, v0, v1
    v_cvt_pk_bf16_f32 v1, v2, v3
    v_mfma_f32_16x16x32_bf16 v[216:219], v[72:75], v[40:43], v[216:219]
    v_cvt_pk_bf16_f32 v2, v4, v5
    v_cvt_pk_bf16_f32 v3, v6, v7
    v_mfma_f32_16x16x32_bf16 v[248:251], v[72:75], v[44:47], v[248:251]
    buffer_store_dwordx4 v[8:11], v16, s[16:19], s41 offen offset:0
    v_mfma_f32_16x16x32_bf16 v[156:159], v[76:79], v[32:35], v[156:159]
    v_accvgpr_read_b32 v12, a112
    v_accvgpr_read_b32 v13, a113
    v_mfma_f32_16x16x32_bf16 v[188:191], v[76:79], v[36:39], v[188:191]
    v_accvgpr_read_b32 v14, a114
    v_accvgpr_read_b32 v15, a115
    v_mfma_f32_16x16x32_bf16 v[220:223], v[76:79], v[40:43], v[220:223]
    buffer_load_dwordx4 v22, s[20:23], s37 offen offset:1024 lds
    v_mfma_f32_16x16x32_bf16 v[252:255], v[76:79], v[44:47], v[252:255]
    s_waitcnt vmcnt(15) lgkmcnt(0)
    s_barrier
    v_accvgpr_read_b32 v8, a80
    v_accvgpr_read_b32 v9, a81
    v_mfma_f32_16x16x32_bf16 v[128:131], v[96:99], v[80:83], v[128:131]
    ds_read_b64_tr_b16 v[48:49], v27 offset:0
    ds_read_b64_tr_b16 v[50:51], v27 offset:1024
    v_mfma_f32_16x16x32_bf16 v[160:163], v[96:99], v[84:87], v[160:163]
    s_add_u32 s36, s44, 1024
    v_accvgpr_read_b32 v10, a82
    v_accvgpr_read_b32 v11, a83
    v_mfma_f32_16x16x32_bf16 v[192:195], v[96:99], v[88:91], v[192:195]
    s_add_u32 m0, s42, 32768
    ds_read_b128 v[32:35], v25 offset:0
    ds_read_b128 v[36:39], v25 offset:2048
    v_mfma_f32_16x16x32_bf16 v[224:227], v[96:99], v[92:95], v[224:227]
    buffer_load_dwordx4 v17, s[24:27], s36 offen offset:0 lds
    v_mfma_f32_16x16x32_bf16 v[132:135], v[100:103], v[80:83], v[132:135]
    ds_read_b128 v[40:43], v25 offset:4096
    ds_read_b128 v[44:47], v25 offset:6144
    v_mfma_f32_16x16x32_bf16 v[164:167], v[100:103], v[84:87], v[164:167]
    v_mul_f32 v8, s40, v8
    v_mul_f32 v9, s40, v9
    v_mfma_f32_16x16x32_bf16 v[196:199], v[100:103], v[88:91], v[196:199]
    ds_read_b64_tr_b16 v[52:53], v28 offset:0
    ds_read_b64_tr_b16 v[54:55], v28 offset:1024
    v_mfma_f32_16x16x32_bf16 v[228:231], v[100:103], v[92:95], v[228:231]
    buffer_load_dwordx4 v18, s[24:27], s36 offen offset:1024 lds
    v_mfma_f32_16x16x32_bf16 v[136:139], v[104:107], v[80:83], v[136:139]
    ds_read_b64_tr_b16 v[56:57], v29 offset:0
    ds_read_b64_tr_b16 v[58:59], v29 offset:1024
    v_mfma_f32_16x16x32_bf16 v[168:171], v[104:107], v[84:87], v[168:171]
    v_mul_f32 v10, s40, v10
    v_mul_f32 v11, s40, v11
    v_mfma_f32_16x16x32_bf16 v[200:203], v[104:107], v[88:91], v[200:203]
    ds_read_b64_tr_b16 v[60:61], v30 offset:0
    ds_read_b64_tr_b16 v[62:63], v30 offset:1024
    v_mfma_f32_16x16x32_bf16 v[232:235], v[104:107], v[92:95], v[232:235]
    buffer_store_dwordx4 v[0:3], v16, s[16:19], s38 offen offset:1024
    v_mfma_f32_16x16x32_bf16 v[140:143], v[108:111], v[80:83], v[140:143]
    ds_read_b64_tr_b16 v[64:65], v27 offset:128
    ds_read_b64_tr_b16 v[66:67], v27 offset:1152
    v_mfma_f32_16x16x32_bf16 v[172:175], v[108:111], v[84:87], v[172:175]
    v_mul_f32 v12, s40, v12
    v_mul_f32 v13, s40, v13
    v_mfma_f32_16x16x32_bf16 v[204:207], v[108:111], v[88:91], v[204:207]
    ds_read_b64_tr_b16 v[68:69], v28 offset:128
    ds_read_b64_tr_b16 v[70:71], v28 offset:1152
    v_mfma_f32_16x16x32_bf16 v[236:239], v[108:111], v[92:95], v[236:239]
    buffer_load_dwordx4 v19, s[24:27], s36 offen offset:2048 lds
    v_mfma_f32_16x16x32_bf16 v[144:147], v[112:115], v[80:83], v[144:147]
    ds_read_b64_tr_b16 v[72:73], v29 offset:128
    ds_read_b64_tr_b16 v[74:75], v29 offset:1152
    v_mfma_f32_16x16x32_bf16 v[176:179], v[112:115], v[84:87], v[176:179]
    v_mul_f32 v14, s40, v14
    v_mul_f32 v15, s40, v15
    v_mfma_f32_16x16x32_bf16 v[208:211], v[112:115], v[88:91], v[208:211]
    ds_read_b64_tr_b16 v[76:77], v30 offset:128
    ds_read_b64_tr_b16 v[78:79], v30 offset:1152
    v_mfma_f32_16x16x32_bf16 v[240:243], v[112:115], v[92:95], v[240:243]
    v_cvt_pk_bf16_f32 v8, v8, v9
    v_cvt_pk_bf16_f32 v9, v10, v11
    v_mfma_f32_16x16x32_bf16 v[148:151], v[116:119], v[80:83], v[148:151]
    v_cvt_pk_bf16_f32 v10, v12, v13
    v_cvt_pk_bf16_f32 v11, v14, v15
    v_mfma_f32_16x16x32_bf16 v[180:183], v[116:119], v[84:87], v[180:183]
    buffer_load_dwordx4 v20, s[24:27], s36 offen offset:3072 lds
    v_mfma_f32_16x16x32_bf16 v[212:215], v[116:119], v[88:91], v[212:215]
    s_add_u32 s37, s49, 4194304
    v_accvgpr_read_b32 v4, a212
    v_accvgpr_read_b32 v5, a213
    v_mfma_f32_16x16x32_bf16 v[244:247], v[116:119], v[92:95], v[244:247]
    s_add_u32 m0, s50, 34816
    v_accvgpr_read_b32 v6, a214
    v_accvgpr_read_b32 v7, a215
    v_mfma_f32_16x16x32_bf16 v[152:155], v[120:123], v[80:83], v[152:155]
    buffer_load_dwordx4 v21, s[20:23], s37 offen offset:0 lds
    v_mfma_f32_16x16x32_bf16 v[184:187], v[120:123], v[84:87], v[184:187]
    v_accvgpr_read_b32 v0, a208
    v_accvgpr_read_b32 v1, a209
    v_mfma_f32_16x16x32_bf16 v[216:219], v[120:123], v[88:91], v[216:219]
    v_accvgpr_read_b32 v2, a210
    v_accvgpr_read_b32 v3, a211
    v_mfma_f32_16x16x32_bf16 v[248:251], v[120:123], v[92:95], v[248:251]
    buffer_store_dwordx4 v[8:11], v16, s[16:19], s41 offen offset:1024
    v_mfma_f32_16x16x32_bf16 v[156:159], v[124:127], v[80:83], v[156:159]
    s_add_u32 s41, s41, 4096
    v_cvt_pk_bf16_f32 v0, v0, v1
    v_cvt_pk_bf16_f32 v1, v2, v3
    v_mfma_f32_16x16x32_bf16 v[188:191], v[124:127], v[84:87], v[188:191]
    v_cvt_pk_bf16_f32 v2, v4, v5
    v_cvt_pk_bf16_f32 v3, v6, v7
    v_mfma_f32_16x16x32_bf16 v[220:223], v[124:127], v[88:91], v[220:223]
    buffer_load_dwordx4 v22, s[20:23], s37 offen offset:1024 lds
    v_mfma_f32_16x16x32_bf16 v[252:255], v[124:127], v[92:95], v[252:255]
    s_waitcnt lgkmcnt(0)
    v_accvgpr_read_b32 v12, a52
    v_accvgpr_read_b32 v13, a53
    v_mfma_f32_16x16x32_bf16 v[128:131], v[48:51], v[32:35], v[128:131]
    ds_read_b64_tr_b16 v[96:97], v27 offset:8704
    ds_read_b64_tr_b16 v[98:99], v27 offset:9728
    v_mfma_f32_16x16x32_bf16 v[160:163], v[48:51], v[36:39], v[160:163]
    s_add_u32 s36, s45, 1024
    v_accvgpr_read_b32 v14, a54
    v_accvgpr_read_b32 v15, a55
    v_mfma_f32_16x16x32_bf16 v[192:195], v[48:51], v[40:43], v[192:195]
    s_add_u32 m0, s42, 36864
    ds_read_b128 v[80:83], v26 offset:0
    ds_read_b128 v[84:87], v26 offset:2048
    v_mfma_f32_16x16x32_bf16 v[224:227], v[48:51], v[44:47], v[224:227]
    buffer_load_dwordx4 v17, s[24:27], s36 offen offset:0 lds
    v_mfma_f32_16x16x32_bf16 v[132:135], v[52:55], v[32:35], v[132:135]
    ds_read_b128 v[88:91], v26 offset:4096
    ds_read_b128 v[92:95], v26 offset:6144
    v_mfma_f32_16x16x32_bf16 v[164:167], v[52:55], v[36:39], v[164:167]
    v_accvgpr_read_b32 v8, a20
    v_accvgpr_read_b32 v9, a21
    v_mfma_f32_16x16x32_bf16 v[196:199], v[52:55], v[40:43], v[196:199]
    ds_read_b64_tr_b16 v[100:101], v28 offset:8704
    ds_read_b64_tr_b16 v[102:103], v28 offset:9728
    v_mfma_f32_16x16x32_bf16 v[228:231], v[52:55], v[44:47], v[228:231]
    buffer_load_dwordx4 v18, s[24:27], s36 offen offset:1024 lds
    v_mfma_f32_16x16x32_bf16 v[136:139], v[56:59], v[32:35], v[136:139]
    ds_read_b64_tr_b16 v[104:105], v29 offset:8704
    ds_read_b64_tr_b16 v[106:107], v29 offset:9728
    v_mfma_f32_16x16x32_bf16 v[168:171], v[56:59], v[36:39], v[168:171]
    v_accvgpr_read_b32 v10, a22
    v_accvgpr_read_b32 v11, a23
    v_mfma_f32_16x16x32_bf16 v[200:203], v[56:59], v[40:43], v[200:203]
    ds_read_b64_tr_b16 v[108:109], v30 offset:8704
    ds_read_b64_tr_b16 v[110:111], v30 offset:9728
    v_mfma_f32_16x16x32_bf16 v[232:235], v[56:59], v[44:47], v[232:235]
    buffer_store_dwordx4 v[0:3], v16, s[16:19], s38 offen offset:2048
    v_mfma_f32_16x16x32_bf16 v[140:143], v[60:63], v[32:35], v[140:143]
    ds_read_b64_tr_b16 v[112:113], v27 offset:8832
    ds_read_b64_tr_b16 v[114:115], v27 offset:9856
    v_mfma_f32_16x16x32_bf16 v[172:175], v[60:63], v[36:39], v[172:175]
    v_mul_f32 v8, s40, v8
    v_mul_f32 v9, s40, v9
    v_mfma_f32_16x16x32_bf16 v[204:207], v[60:63], v[40:43], v[204:207]
    ds_read_b64_tr_b16 v[116:117], v28 offset:8832
    ds_read_b64_tr_b16 v[118:119], v28 offset:9856
    v_mfma_f32_16x16x32_bf16 v[236:239], v[60:63], v[44:47], v[236:239]
    buffer_load_dwordx4 v19, s[24:27], s36 offen offset:2048 lds
    v_mfma_f32_16x16x32_bf16 v[144:147], v[64:67], v[32:35], v[144:147]
    ds_read_b64_tr_b16 v[120:121], v29 offset:8832
    ds_read_b64_tr_b16 v[122:123], v29 offset:9856
    v_mfma_f32_16x16x32_bf16 v[176:179], v[64:67], v[36:39], v[176:179]
    v_mul_f32 v10, s40, v10
    v_mul_f32 v11, s40, v11
    v_mfma_f32_16x16x32_bf16 v[208:211], v[64:67], v[40:43], v[208:211]
    ds_read_b64_tr_b16 v[124:125], v30 offset:8832
    ds_read_b64_tr_b16 v[126:127], v30 offset:9856
    v_mfma_f32_16x16x32_bf16 v[240:243], v[64:67], v[44:47], v[240:243]
    v_mul_f32 v12, s40, v12
    v_mul_f32 v13, s40, v13
    v_mfma_f32_16x16x32_bf16 v[148:151], v[68:71], v[32:35], v[148:151]
    v_mul_f32 v14, s40, v14
    v_mul_f32 v15, s40, v15
    v_mfma_f32_16x16x32_bf16 v[180:183], v[68:71], v[36:39], v[180:183]
    buffer_load_dwordx4 v20, s[24:27], s36 offen offset:3072 lds
    v_mfma_f32_16x16x32_bf16 v[212:215], v[68:71], v[40:43], v[212:215]
    s_add_u32 s37, s49, 4456448
    v_cvt_pk_bf16_f32 v8, v8, v9
    v_cvt_pk_bf16_f32 v9, v10, v11
    v_mfma_f32_16x16x32_bf16 v[244:247], v[68:71], v[44:47], v[244:247]
    s_add_u32 m0, s50, 43520
    v_cvt_pk_bf16_f32 v10, v12, v13
    v_cvt_pk_bf16_f32 v11, v14, v15
    v_mfma_f32_16x16x32_bf16 v[152:155], v[72:75], v[32:35], v[152:155]
    buffer_load_dwordx4 v21, s[20:23], s37 offen offset:0 lds
    v_mfma_f32_16x16x32_bf16 v[184:187], v[72:75], v[36:39], v[184:187]
    v_accvgpr_read_b32 v4, a244
    v_accvgpr_read_b32 v5, a245
    v_mfma_f32_16x16x32_bf16 v[216:219], v[72:75], v[40:43], v[216:219]
    v_accvgpr_read_b32 v6, a246
    v_accvgpr_read_b32 v7, a247
    v_mfma_f32_16x16x32_bf16 v[248:251], v[72:75], v[44:47], v[248:251]
    buffer_store_dwordx4 v[8:11], v16, s[16:19], s41 offen offset:0
    v_mfma_f32_16x16x32_bf16 v[156:159], v[76:79], v[32:35], v[156:159]
    v_accvgpr_read_b32 v0, a240
    v_accvgpr_read_b32 v1, a241
    v_mfma_f32_16x16x32_bf16 v[188:191], v[76:79], v[36:39], v[188:191]
    v_accvgpr_read_b32 v2, a242
    v_accvgpr_read_b32 v3, a243
    v_mfma_f32_16x16x32_bf16 v[220:223], v[76:79], v[40:43], v[220:223]
    buffer_load_dwordx4 v22, s[20:23], s37 offen offset:1024 lds
    v_mfma_f32_16x16x32_bf16 v[252:255], v[76:79], v[44:47], v[252:255]
    s_waitcnt vmcnt(16) lgkmcnt(0)
    s_barrier
    v_cvt_pk_bf16_f32 v0, v0, v1
    v_cvt_pk_bf16_f32 v1, v2, v3
    v_mfma_f32_16x16x32_bf16 v[128:131], v[96:99], v[80:83], v[128:131]
    ds_read_b64_tr_b16 v[48:49], v27 offset:17408
    ds_read_b64_tr_b16 v[50:51], v27 offset:18432
    v_mfma_f32_16x16x32_bf16 v[160:163], v[96:99], v[84:87], v[160:163]
    s_add_u32 s36, s44, 1152
    v_cvt_pk_bf16_f32 v2, v4, v5
    v_cvt_pk_bf16_f32 v3, v6, v7
    v_mfma_f32_16x16x32_bf16 v[192:195], v[96:99], v[88:91], v[192:195]
    s_add_u32 m0, s42, 65536
    ds_read_b128 v[32:35], v23 offset:0
    ds_read_b128 v[36:39], v23 offset:2048
    v_mfma_f32_16x16x32_bf16 v[224:227], v[96:99], v[92:95], v[224:227]
    buffer_load_dwordx4 v17, s[24:27], s36 offen offset:0 lds
    v_mfma_f32_16x16x32_bf16 v[132:135], v[100:103], v[80:83], v[132:135]
    ds_read_b128 v[40:43], v23 offset:4096
    ds_read_b128 v[44:47], v23 offset:6144
    v_mfma_f32_16x16x32_bf16 v[164:167], v[100:103], v[84:87], v[164:167]
    v_accvgpr_read_b32 v12, a116
    v_accvgpr_read_b32 v13, a117
    v_mfma_f32_16x16x32_bf16 v[196:199], v[100:103], v[88:91], v[196:199]
    ds_read_b64_tr_b16 v[52:53], v28 offset:17408
    ds_read_b64_tr_b16 v[54:55], v28 offset:18432
    v_mfma_f32_16x16x32_bf16 v[228:231], v[100:103], v[92:95], v[228:231]
    buffer_load_dwordx4 v18, s[24:27], s36 offen offset:1024 lds
    v_mfma_f32_16x16x32_bf16 v[136:139], v[104:107], v[80:83], v[136:139]
    ds_read_b64_tr_b16 v[56:57], v29 offset:17408
    ds_read_b64_tr_b16 v[58:59], v29 offset:18432
    v_mfma_f32_16x16x32_bf16 v[168:171], v[104:107], v[84:87], v[168:171]
    v_accvgpr_read_b32 v14, a118
    v_accvgpr_read_b32 v15, a119
    v_mfma_f32_16x16x32_bf16 v[200:203], v[104:107], v[88:91], v[200:203]
    ds_read_b64_tr_b16 v[60:61], v30 offset:17408
    ds_read_b64_tr_b16 v[62:63], v30 offset:18432
    v_mfma_f32_16x16x32_bf16 v[232:235], v[104:107], v[92:95], v[232:235]
    buffer_store_dwordx4 v[0:3], v16, s[16:19], s38 offen offset:3072
    v_mfma_f32_16x16x32_bf16 v[140:143], v[108:111], v[80:83], v[140:143]
    s_add_u32 s38, s38, 16384
    ds_read_b64_tr_b16 v[64:65], v27 offset:17536
    ds_read_b64_tr_b16 v[66:67], v27 offset:18560
    v_mfma_f32_16x16x32_bf16 v[172:175], v[108:111], v[84:87], v[172:175]
    v_accvgpr_read_b32 v8, a84
    v_accvgpr_read_b32 v9, a85
    v_mfma_f32_16x16x32_bf16 v[204:207], v[108:111], v[88:91], v[204:207]
    ds_read_b64_tr_b16 v[68:69], v28 offset:17536
    ds_read_b64_tr_b16 v[70:71], v28 offset:18560
    v_mfma_f32_16x16x32_bf16 v[236:239], v[108:111], v[92:95], v[236:239]
    buffer_load_dwordx4 v19, s[24:27], s36 offen offset:2048 lds
    v_mfma_f32_16x16x32_bf16 v[144:147], v[112:115], v[80:83], v[144:147]
    ds_read_b64_tr_b16 v[72:73], v29 offset:17536
    ds_read_b64_tr_b16 v[74:75], v29 offset:18560
    v_mfma_f32_16x16x32_bf16 v[176:179], v[112:115], v[84:87], v[176:179]
    v_accvgpr_read_b32 v10, a86
    v_accvgpr_read_b32 v11, a87
    v_mfma_f32_16x16x32_bf16 v[208:211], v[112:115], v[88:91], v[208:211]
    ds_read_b64_tr_b16 v[76:77], v30 offset:17536
    ds_read_b64_tr_b16 v[78:79], v30 offset:18560
    v_mfma_f32_16x16x32_bf16 v[240:243], v[112:115], v[92:95], v[240:243]
    v_mul_f32 v8, s40, v8
    v_mul_f32 v9, s40, v9
    v_mfma_f32_16x16x32_bf16 v[148:151], v[116:119], v[80:83], v[148:151]
    v_mul_f32 v10, s40, v10
    v_mul_f32 v11, s40, v11
    v_mfma_f32_16x16x32_bf16 v[180:183], v[116:119], v[84:87], v[180:183]
    buffer_load_dwordx4 v20, s[24:27], s36 offen offset:3072 lds
    v_mfma_f32_16x16x32_bf16 v[212:215], v[116:119], v[88:91], v[212:215]
    s_add_u32 s37, s49, 4718592
    v_mul_f32 v12, s40, v12
    v_mul_f32 v13, s40, v13
    v_mfma_f32_16x16x32_bf16 v[244:247], v[116:119], v[92:95], v[244:247]
    s_add_u32 m0, s50, 0
    v_mul_f32 v14, s40, v14
    v_mul_f32 v15, s40, v15
    v_mfma_f32_16x16x32_bf16 v[152:155], v[120:123], v[80:83], v[152:155]
    buffer_load_dwordx4 v21, s[20:23], s37 offen offset:0 lds
    v_mfma_f32_16x16x32_bf16 v[184:187], v[120:123], v[84:87], v[184:187]
    v_cvt_pk_bf16_f32 v8, v8, v9
    v_cvt_pk_bf16_f32 v9, v10, v11
    v_mfma_f32_16x16x32_bf16 v[216:219], v[120:123], v[88:91], v[216:219]
    v_cvt_pk_bf16_f32 v10, v12, v13
    v_cvt_pk_bf16_f32 v11, v14, v15
    v_mfma_f32_16x16x32_bf16 v[248:251], v[120:123], v[92:95], v[248:251]
    buffer_store_dwordx4 v[8:11], v16, s[16:19], s41 offen offset:1024
    v_mfma_f32_16x16x32_bf16 v[156:159], v[124:127], v[80:83], v[156:159]
    s_add_u32 s41, s41, 12288
    v_accvgpr_read_b32 v4, a156
    v_accvgpr_read_b32 v5, a157
    v_mfma_f32_16x16x32_bf16 v[188:191], v[124:127], v[84:87], v[188:191]
    v_accvgpr_read_b32 v6, a158
    v_accvgpr_read_b32 v7, a159
    v_mfma_f32_16x16x32_bf16 v[220:223], v[124:127], v[88:91], v[220:223]
    buffer_load_dwordx4 v22, s[20:23], s37 offen offset:1024 lds
    v_mfma_f32_16x16x32_bf16 v[252:255], v[124:127], v[92:95], v[252:255]
    s_waitcnt lgkmcnt(0)
    v_accvgpr_read_b32 v0, a152
    v_accvgpr_read_b32 v1, a153
    v_mfma_f32_16x16x32_bf16 v[128:131], v[48:51], v[32:35], v[128:131]
    ds_read_b64_tr_b16 v[96:97], v27 offset:26112
    ds_read_b64_tr_b16 v[98:99], v27 offset:27136
    v_mfma_f32_16x16x32_bf16 v[160:163], v[48:51], v[36:39], v[160:163]
    s_add_u32 s36, s45, 1152
    v_accvgpr_read_b32 v2, a154
    v_accvgpr_read_b32 v3, a155
    v_mfma_f32_16x16x32_bf16 v[192:195], v[48:51], v[40:43], v[192:195]
    s_add_u32 m0, s42, 69632
    ds_read_b128 v[80:83], v24 offset:0
    ds_read_b128 v[84:87], v24 offset:2048
    v_mfma_f32_16x16x32_bf16 v[224:227], v[48:51], v[44:47], v[224:227]
    buffer_load_dwordx4 v17, s[24:27], s36 offen offset:0 lds
    v_mfma_f32_16x16x32_bf16 v[132:135], v[52:55], v[32:35], v[132:135]
    ds_read_b128 v[88:91], v24 offset:4096
    ds_read_b128 v[92:95], v24 offset:6144
    v_mfma_f32_16x16x32_bf16 v[164:167], v[52:55], v[36:39], v[164:167]
    v_cvt_pk_bf16_f32 v0, v0, v1
    v_cvt_pk_bf16_f32 v1, v2, v3
    v_mfma_f32_16x16x32_bf16 v[196:199], v[52:55], v[40:43], v[196:199]
    ds_read_b64_tr_b16 v[100:101], v28 offset:26112
    ds_read_b64_tr_b16 v[102:103], v28 offset:27136
    v_mfma_f32_16x16x32_bf16 v[228:231], v[52:55], v[44:47], v[228:231]
    buffer_load_dwordx4 v18, s[24:27], s36 offen offset:1024 lds
    v_mfma_f32_16x16x32_bf16 v[136:139], v[56:59], v[32:35], v[136:139]
    ds_read_b64_tr_b16 v[104:105], v29 offset:26112
    ds_read_b64_tr_b16 v[106:107], v29 offset:27136
    v_mfma_f32_16x16x32_bf16 v[168:171], v[56:59], v[36:39], v[168:171]
    v_cvt_pk_bf16_f32 v2, v4, v5
    v_cvt_pk_bf16_f32 v3, v6, v7
    v_mfma_f32_16x16x32_bf16 v[200:203], v[56:59], v[40:43], v[200:203]
    ds_read_b64_tr_b16 v[108:109], v30 offset:26112
    ds_read_b64_tr_b16 v[110:111], v30 offset:27136
    v_mfma_f32_16x16x32_bf16 v[232:235], v[56:59], v[44:47], v[232:235]
    buffer_store_dwordx4 v[0:3], v16, s[16:19], s38 offen offset:0
    v_mfma_f32_16x16x32_bf16 v[140:143], v[60:63], v[32:35], v[140:143]
    ds_read_b64_tr_b16 v[112:113], v27 offset:26240
    ds_read_b64_tr_b16 v[114:115], v27 offset:27264
    v_mfma_f32_16x16x32_bf16 v[172:175], v[60:63], v[36:39], v[172:175]
    v_accvgpr_read_b32 v12, a56
    v_accvgpr_read_b32 v13, a57
    v_mfma_f32_16x16x32_bf16 v[204:207], v[60:63], v[40:43], v[204:207]
    ds_read_b64_tr_b16 v[116:117], v28 offset:26240
    ds_read_b64_tr_b16 v[118:119], v28 offset:27264
    v_mfma_f32_16x16x32_bf16 v[236:239], v[60:63], v[44:47], v[236:239]
    buffer_load_dwordx4 v19, s[24:27], s36 offen offset:2048 lds
    v_mfma_f32_16x16x32_bf16 v[144:147], v[64:67], v[32:35], v[144:147]
    ds_read_b64_tr_b16 v[120:121], v29 offset:26240
    ds_read_b64_tr_b16 v[122:123], v29 offset:27264
    v_mfma_f32_16x16x32_bf16 v[176:179], v[64:67], v[36:39], v[176:179]
    v_accvgpr_read_b32 v14, a58
    v_accvgpr_read_b32 v15, a59
    v_mfma_f32_16x16x32_bf16 v[208:211], v[64:67], v[40:43], v[208:211]
    ds_read_b64_tr_b16 v[124:125], v30 offset:26240
    ds_read_b64_tr_b16 v[126:127], v30 offset:27264
    v_mfma_f32_16x16x32_bf16 v[240:243], v[64:67], v[44:47], v[240:243]
    v_accvgpr_read_b32 v8, a24
    v_accvgpr_read_b32 v9, a25
    v_mfma_f32_16x16x32_bf16 v[148:151], v[68:71], v[32:35], v[148:151]
    v_accvgpr_read_b32 v10, a26
    v_accvgpr_read_b32 v11, a27
    v_mfma_f32_16x16x32_bf16 v[180:183], v[68:71], v[36:39], v[180:183]
    buffer_load_dwordx4 v20, s[24:27], s36 offen offset:3072 lds
    v_mfma_f32_16x16x32_bf16 v[212:215], v[68:71], v[40:43], v[212:215]
    s_add_u32 s37, s49, 4980736
    v_mul_f32 v8, s40, v8
    v_mul_f32 v9, s40, v9
    v_mfma_f32_16x16x32_bf16 v[244:247], v[68:71], v[44:47], v[244:247]
    s_add_u32 m0, s50, 8704
    v_mul_f32 v10, s40, v10
    v_mul_f32 v11, s40, v11
    v_mfma_f32_16x16x32_bf16 v[152:155], v[72:75], v[32:35], v[152:155]
    buffer_load_dwordx4 v21, s[20:23], s37 offen offset:0 lds
    v_mfma_f32_16x16x32_bf16 v[184:187], v[72:75], v[36:39], v[184:187]
    v_mul_f32 v12, s40, v12
    v_mul_f32 v13, s40, v13
    v_mfma_f32_16x16x32_bf16 v[216:219], v[72:75], v[40:43], v[216:219]
    v_mul_f32 v14, s40, v14
    v_mul_f32 v15, s40, v15
    v_mfma_f32_16x16x32_bf16 v[248:251], v[72:75], v[44:47], v[248:251]
    v_mfma_f32_16x16x32_bf16 v[156:159], v[76:79], v[32:35], v[156:159]
    v_cvt_pk_bf16_f32 v8, v8, v9
    v_cvt_pk_bf16_f32 v9, v10, v11
    v_mfma_f32_16x16x32_bf16 v[188:191], v[76:79], v[36:39], v[188:191]
    v_cvt_pk_bf16_f32 v10, v12, v13
    v_cvt_pk_bf16_f32 v11, v14, v15
    v_mfma_f32_16x16x32_bf16 v[220:223], v[76:79], v[40:43], v[220:223]
    buffer_load_dwordx4 v22, s[20:23], s37 offen offset:1024 lds
    v_mfma_f32_16x16x32_bf16 v[252:255], v[76:79], v[44:47], v[252:255]
    s_waitcnt vmcnt(15) lgkmcnt(0)
    s_barrier
    v_accvgpr_read_b32 v4, a188
    v_accvgpr_read_b32 v5, a189
    v_mfma_f32_16x16x32_bf16 v[128:131], v[96:99], v[80:83], v[128:131]
    ds_read_b64_tr_b16 v[48:49], v27 offset:34816
    ds_read_b64_tr_b16 v[50:51], v27 offset:35840
    v_mfma_f32_16x16x32_bf16 v[160:163], v[96:99], v[84:87], v[160:163]
    s_add_u32 s36, s44, 1280
    v_accvgpr_read_b32 v6, a190
    v_accvgpr_read_b32 v7, a191
    v_mfma_f32_16x16x32_bf16 v[192:195], v[96:99], v[88:91], v[192:195]
    s_add_u32 m0, s42, 0
    ds_read_b128 v[32:35], v23 offset:32768
    ds_read_b128 v[36:39], v23 offset:34816
    v_mfma_f32_16x16x32_bf16 v[224:227], v[96:99], v[92:95], v[224:227]
    buffer_load_dwordx4 v17, s[24:27], s36 offen offset:0 lds
    v_mfma_f32_16x16x32_bf16 v[132:135], v[100:103], v[80:83], v[132:135]
    ds_read_b128 v[40:43], v23 offset:36864
    ds_read_b128 v[44:47], v23 offset:38912
    v_mfma_f32_16x16x32_bf16 v[164:167], v[100:103], v[84:87], v[164:167]
    v_accvgpr_read_b32 v0, a184
    v_accvgpr_read_b32 v1, a185
    v_mfma_f32_16x16x32_bf16 v[196:199], v[100:103], v[88:91], v[196:199]
    ds_read_b64_tr_b16 v[52:53], v28 offset:34816
    ds_read_b64_tr_b16 v[54:55], v28 offset:35840
    v_mfma_f32_16x16x32_bf16 v[228:231], v[100:103], v[92:95], v[228:231]
    buffer_load_dwordx4 v18, s[24:27], s36 offen offset:1024 lds
    v_mfma_f32_16x16x32_bf16 v[136:139], v[104:107], v[80:83], v[136:139]
    ds_read_b64_tr_b16 v[56:57], v29 offset:34816
    ds_read_b64_tr_b16 v[58:59], v29 offset:35840
    v_mfma_f32_16x16x32_bf16 v[168:171], v[104:107], v[84:87], v[168:171]
    v_accvgpr_read_b32 v2, a186
    v_accvgpr_read_b32 v3, a187
    v_mfma_f32_16x16x32_bf16 v[200:203], v[104:107], v[88:91], v[200:203]
    ds_read_b64_tr_b16 v[60:61], v30 offset:34816
    ds_read_b64_tr_b16 v[62:63], v30 offset:35840
    v_mfma_f32_16x16x32_bf16 v[232:235], v[104:107], v[92:95], v[232:235]
    buffer_store_dwordx4 v[8:11], v16, s[16:19], s41 offen offset:0
    v_mfma_f32_16x16x32_bf16 v[140:143], v[108:111], v[80:83], v[140:143]
    ds_read_b64_tr_b16 v[64:65], v27 offset:34944
    ds_read_b64_tr_b16 v[66:67], v27 offset:35968
    v_mfma_f32_16x16x32_bf16 v[172:175], v[108:111], v[84:87], v[172:175]
    v_cvt_pk_bf16_f32 v0, v0, v1
    v_cvt_pk_bf16_f32 v1, v2, v3
    v_mfma_f32_16x16x32_bf16 v[204:207], v[108:111], v[88:91], v[204:207]
    ds_read_b64_tr_b16 v[68:69], v28 offset:34944
    ds_read_b64_tr_b16 v[70:71], v28 offset:35968
    v_mfma_f32_16x16x32_bf16 v[236:239], v[108:111], v[92:95], v[236:239]
    buffer_load_dwordx4 v19, s[24:27], s36 offen offset:2048 lds
    v_mfma_f32_16x16x32_bf16 v[144:147], v[112:115], v[80:83], v[144:147]
    ds_read_b64_tr_b16 v[72:73], v29 offset:34944
    ds_read_b64_tr_b16 v[74:75], v29 offset:35968
    v_mfma_f32_16x16x32_bf16 v[176:179], v[112:115], v[84:87], v[176:179]
    v_cvt_pk_bf16_f32 v2, v4, v5
    v_cvt_pk_bf16_f32 v3, v6, v7
    v_mfma_f32_16x16x32_bf16 v[208:211], v[112:115], v[88:91], v[208:211]
    ds_read_b64_tr_b16 v[76:77], v30 offset:34944
    ds_read_b64_tr_b16 v[78:79], v30 offset:35968
    v_mfma_f32_16x16x32_bf16 v[240:243], v[112:115], v[92:95], v[240:243]
    v_accvgpr_read_b32 v12, a120
    v_accvgpr_read_b32 v13, a121
    v_mfma_f32_16x16x32_bf16 v[148:151], v[116:119], v[80:83], v[148:151]
    v_accvgpr_read_b32 v14, a122
    v_accvgpr_read_b32 v15, a123
    v_mfma_f32_16x16x32_bf16 v[180:183], v[116:119], v[84:87], v[180:183]
    buffer_load_dwordx4 v20, s[24:27], s36 offen offset:3072 lds
    v_mfma_f32_16x16x32_bf16 v[212:215], v[116:119], v[88:91], v[212:215]
    s_add_u32 s37, s49, 5242880
    v_accvgpr_read_b32 v8, a88
    v_accvgpr_read_b32 v9, a89
    v_mfma_f32_16x16x32_bf16 v[244:247], v[116:119], v[92:95], v[244:247]
    s_add_u32 m0, s50, 17408
    v_accvgpr_read_b32 v10, a90
    v_accvgpr_read_b32 v11, a91
    v_mfma_f32_16x16x32_bf16 v[152:155], v[120:123], v[80:83], v[152:155]
    buffer_load_dwordx4 v21, s[20:23], s37 offen offset:0 lds
    v_mfma_f32_16x16x32_bf16 v[184:187], v[120:123], v[84:87], v[184:187]
    v_mul_f32 v8, s40, v8
    v_mul_f32 v9, s40, v9
    v_mfma_f32_16x16x32_bf16 v[216:219], v[120:123], v[88:91], v[216:219]
    v_mul_f32 v10, s40, v10
    v_mul_f32 v11, s40, v11
    v_mfma_f32_16x16x32_bf16 v[248:251], v[120:123], v[92:95], v[248:251]
    buffer_store_dwordx4 v[0:3], v16, s[16:19], s38 offen offset:1024
    v_mfma_f32_16x16x32_bf16 v[156:159], v[124:127], v[80:83], v[156:159]
    v_mul_f32 v12, s40, v12
    v_mul_f32 v13, s40, v13
    v_mfma_f32_16x16x32_bf16 v[188:191], v[124:127], v[84:87], v[188:191]
    v_mul_f32 v14, s40, v14
    v_mul_f32 v15, s40, v15
    v_mfma_f32_16x16x32_bf16 v[220:223], v[124:127], v[88:91], v[220:223]
    buffer_load_dwordx4 v22, s[20:23], s37 offen offset:1024 lds
    v_mfma_f32_16x16x32_bf16 v[252:255], v[124:127], v[92:95], v[252:255]
    s_waitcnt lgkmcnt(0)
    v_cvt_pk_bf16_f32 v8, v8, v9
    v_cvt_pk_bf16_f32 v9, v10, v11
    v_mfma_f32_16x16x32_bf16 v[128:131], v[48:51], v[32:35], v[128:131]
    ds_read_b64_tr_b16 v[96:97], v27 offset:43520
    ds_read_b64_tr_b16 v[98:99], v27 offset:44544
    v_mfma_f32_16x16x32_bf16 v[160:163], v[48:51], v[36:39], v[160:163]
    s_add_u32 s36, s45, 1280
    v_cvt_pk_bf16_f32 v10, v12, v13
    v_cvt_pk_bf16_f32 v11, v14, v15
    v_mfma_f32_16x16x32_bf16 v[192:195], v[48:51], v[40:43], v[192:195]
    s_add_u32 m0, s42, 4096
    ds_read_b128 v[80:83], v24 offset:32768
    ds_read_b128 v[84:87], v24 offset:34816
    v_mfma_f32_16x16x32_bf16 v[224:227], v[48:51], v[44:47], v[224:227]
    buffer_load_dwordx4 v17, s[24:27], s36 offen offset:0 lds
    v_mfma_f32_16x16x32_bf16 v[132:135], v[52:55], v[32:35], v[132:135]
    ds_read_b128 v[88:91], v24 offset:36864
    ds_read_b128 v[92:95], v24 offset:38912
    v_mfma_f32_16x16x32_bf16 v[164:167], v[52:55], v[36:39], v[164:167]
    v_accvgpr_read_b32 v4, a220
    v_accvgpr_read_b32 v5, a221
    v_mfma_f32_16x16x32_bf16 v[196:199], v[52:55], v[40:43], v[196:199]
    ds_read_b64_tr_b16 v[100:101], v28 offset:43520
    ds_read_b64_tr_b16 v[102:103], v28 offset:44544
    v_mfma_f32_16x16x32_bf16 v[228:231], v[52:55], v[44:47], v[228:231]
    buffer_load_dwordx4 v18, s[24:27], s36 offen offset:1024 lds
    v_mfma_f32_16x16x32_bf16 v[136:139], v[56:59], v[32:35], v[136:139]
    ds_read_b64_tr_b16 v[104:105], v29 offset:43520
    ds_read_b64_tr_b16 v[106:107], v29 offset:44544
    v_mfma_f32_16x16x32_bf16 v[168:171], v[56:59], v[36:39], v[168:171]
    v_accvgpr_read_b32 v6, a222
    v_accvgpr_read_b32 v7, a223
    v_mfma_f32_16x16x32_bf16 v[200:203], v[56:59], v[40:43], v[200:203]
    ds_read_b64_tr_b16 v[108:109], v30 offset:43520
    ds_read_b64_tr_b16 v[110:111], v30 offset:44544
    v_mfma_f32_16x16x32_bf16 v[232:235], v[56:59], v[44:47], v[232:235]
    buffer_store_dwordx4 v[8:11], v16, s[16:19], s41 offen offset:1024
    v_mfma_f32_16x16x32_bf16 v[140:143], v[60:63], v[32:35], v[140:143]
    s_add_u32 s41, s41, 4096
    ds_read_b64_tr_b16 v[112:113], v27 offset:43648
    ds_read_b64_tr_b16 v[114:115], v27 offset:44672
    v_mfma_f32_16x16x32_bf16 v[172:175], v[60:63], v[36:39], v[172:175]
    v_accvgpr_read_b32 v0, a216
    v_accvgpr_read_b32 v1, a217
    v_mfma_f32_16x16x32_bf16 v[204:207], v[60:63], v[40:43], v[204:207]
    ds_read_b64_tr_b16 v[116:117], v28 offset:43648
    ds_read_b64_tr_b16 v[118:119], v28 offset:44672
    v_mfma_f32_16x16x32_bf16 v[236:239], v[60:63], v[44:47], v[236:239]
    buffer_load_dwordx4 v19, s[24:27], s36 offen offset:2048 lds
    v_mfma_f32_16x16x32_bf16 v[144:147], v[64:67], v[32:35], v[144:147]
    ds_read_b64_tr_b16 v[120:121], v29 offset:43648
    ds_read_b64_tr_b16 v[122:123], v29 offset:44672
    v_mfma_f32_16x16x32_bf16 v[176:179], v[64:67], v[36:39], v[176:179]
    v_accvgpr_read_b32 v2, a218
    v_accvgpr_read_b32 v3, a219
    v_mfma_f32_16x16x32_bf16 v[208:211], v[64:67], v[40:43], v[208:211]
    ds_read_b64_tr_b16 v[124:125], v30 offset:43648
    ds_read_b64_tr_b16 v[126:127], v30 offset:44672
    v_mfma_f32_16x16x32_bf16 v[240:243], v[64:67], v[44:47], v[240:243]
    v_cvt_pk_bf16_f32 v0, v0, v1
    v_cvt_pk_bf16_f32 v1, v2, v3
    v_mfma_f32_16x16x32_bf16 v[148:151], v[68:71], v[32:35], v[148:151]
    v_cvt_pk_bf16_f32 v2, v4, v5
    v_cvt_pk_bf16_f32 v3, v6, v7
    v_mfma_f32_16x16x32_bf16 v[180:183], v[68:71], v[36:39], v[180:183]
    buffer_load_dwordx4 v20, s[24:27], s36 offen offset:3072 lds
    v_mfma_f32_16x16x32_bf16 v[212:215], v[68:71], v[40:43], v[212:215]
    s_add_u32 s37, s49, 5505024
    v_accvgpr_read_b32 v12, a60
    v_accvgpr_read_b32 v13, a61
    v_mfma_f32_16x16x32_bf16 v[244:247], v[68:71], v[44:47], v[244:247]
    s_add_u32 m0, s50, 26112
    v_accvgpr_read_b32 v14, a62
    v_accvgpr_read_b32 v15, a63
    v_mfma_f32_16x16x32_bf16 v[152:155], v[72:75], v[32:35], v[152:155]
    buffer_load_dwordx4 v21, s[20:23], s37 offen offset:0 lds
    v_mfma_f32_16x16x32_bf16 v[184:187], v[72:75], v[36:39], v[184:187]
    v_accvgpr_read_b32 v8, a28
    v_accvgpr_read_b32 v9, a29
    v_mfma_f32_16x16x32_bf16 v[216:219], v[72:75], v[40:43], v[216:219]
    v_accvgpr_read_b32 v10, a30
    v_accvgpr_read_b32 v11, a31
    v_mfma_f32_16x16x32_bf16 v[248:251], v[72:75], v[44:47], v[248:251]
    buffer_store_dwordx4 v[0:3], v16, s[16:19], s38 offen offset:2048
    v_mfma_f32_16x16x32_bf16 v[156:159], v[76:79], v[32:35], v[156:159]
    v_mul_f32 v8, s40, v8
    v_mul_f32 v9, s40, v9
    v_mfma_f32_16x16x32_bf16 v[188:191], v[76:79], v[36:39], v[188:191]
    v_mul_f32 v10, s40, v10
    v_mul_f32 v11, s40, v11
    v_mfma_f32_16x16x32_bf16 v[220:223], v[76:79], v[40:43], v[220:223]
    buffer_load_dwordx4 v22, s[20:23], s37 offen offset:1024 lds
    v_mfma_f32_16x16x32_bf16 v[252:255], v[76:79], v[44:47], v[252:255]
    s_waitcnt vmcnt(16) lgkmcnt(0)
    s_barrier
    v_mul_f32 v12, s40, v12
    v_mul_f32 v13, s40, v13
    v_mfma_f32_16x16x32_bf16 v[128:131], v[96:99], v[80:83], v[128:131]
    ds_read_b64_tr_b16 v[48:49], v27 offset:0
    ds_read_b64_tr_b16 v[50:51], v27 offset:1024
    v_mfma_f32_16x16x32_bf16 v[160:163], v[96:99], v[84:87], v[160:163]
    s_add_u32 s36, s44, 1408
    v_mul_f32 v14, s40, v14
    v_mul_f32 v15, s40, v15
    v_mfma_f32_16x16x32_bf16 v[192:195], v[96:99], v[88:91], v[192:195]
    s_add_u32 m0, s42, 32768
    ds_read_b128 v[32:35], v25 offset:0
    ds_read_b128 v[36:39], v25 offset:2048
    v_mfma_f32_16x16x32_bf16 v[224:227], v[96:99], v[92:95], v[224:227]
    buffer_load_dwordx4 v17, s[24:27], s36 offen offset:0 lds
    v_mfma_f32_16x16x32_bf16 v[132:135], v[100:103], v[80:83], v[132:135]
    ds_read_b128 v[40:43], v25 offset:4096
    ds_read_b128 v[44:47], v25 offset:6144
    v_mfma_f32_16x16x32_bf16 v[164:167], v[100:103], v[84:87], v[164:167]
    v_cvt_pk_bf16_f32 v8, v8, v9
    v_cvt_pk_bf16_f32 v9, v10, v11
    v_mfma_f32_16x16x32_bf16 v[196:199], v[100:103], v[88:91], v[196:199]
    ds_read_b64_tr_b16 v[52:53], v28 offset:0
    ds_read_b64_tr_b16 v[54:55], v28 offset:1024
    v_mfma_f32_16x16x32_bf16 v[228:231], v[100:103], v[92:95], v[228:231]
    buffer_load_dwordx4 v18, s[24:27], s36 offen offset:1024 lds
    v_mfma_f32_16x16x32_bf16 v[136:139], v[104:107], v[80:83], v[136:139]
    ds_read_b64_tr_b16 v[56:57], v29 offset:0
    ds_read_b64_tr_b16 v[58:59], v29 offset:1024
    v_mfma_f32_16x16x32_bf16 v[168:171], v[104:107], v[84:87], v[168:171]
    v_cvt_pk_bf16_f32 v10, v12, v13
    v_cvt_pk_bf16_f32 v11, v14, v15
    v_mfma_f32_16x16x32_bf16 v[200:203], v[104:107], v[88:91], v[200:203]
    ds_read_b64_tr_b16 v[60:61], v30 offset:0
    ds_read_b64_tr_b16 v[62:63], v30 offset:1024
    v_mfma_f32_16x16x32_bf16 v[232:235], v[104:107], v[92:95], v[232:235]
    buffer_store_dwordx4 v[8:11], v16, s[16:19], s41 offen offset:0
    v_mfma_f32_16x16x32_bf16 v[140:143], v[108:111], v[80:83], v[140:143]
    ds_read_b64_tr_b16 v[64:65], v27 offset:128
    ds_read_b64_tr_b16 v[66:67], v27 offset:1152
    v_mfma_f32_16x16x32_bf16 v[172:175], v[108:111], v[84:87], v[172:175]
    v_accvgpr_read_b32 v4, a252
    v_accvgpr_read_b32 v5, a253
    v_mfma_f32_16x16x32_bf16 v[204:207], v[108:111], v[88:91], v[204:207]
    ds_read_b64_tr_b16 v[68:69], v28 offset:128
    ds_read_b64_tr_b16 v[70:71], v28 offset:1152
    v_mfma_f32_16x16x32_bf16 v[236:239], v[108:111], v[92:95], v[236:239]
    buffer_load_dwordx4 v19, s[24:27], s36 offen offset:2048 lds
    v_mfma_f32_16x16x32_bf16 v[144:147], v[112:115], v[80:83], v[144:147]
    ds_read_b64_tr_b16 v[72:73], v29 offset:128
    ds_read_b64_tr_b16 v[74:75], v29 offset:1152
    v_mfma_f32_16x16x32_bf16 v[176:179], v[112:115], v[84:87], v[176:179]
    v_accvgpr_read_b32 v6, a254
    v_accvgpr_read_b32 v7, a255
    v_mfma_f32_16x16x32_bf16 v[208:211], v[112:115], v[88:91], v[208:211]
    ds_read_b64_tr_b16 v[76:77], v30 offset:128
    ds_read_b64_tr_b16 v[78:79], v30 offset:1152
    v_mfma_f32_16x16x32_bf16 v[240:243], v[112:115], v[92:95], v[240:243]
    v_accvgpr_read_b32 v0, a248
    v_accvgpr_read_b32 v1, a249
    v_mfma_f32_16x16x32_bf16 v[148:151], v[116:119], v[80:83], v[148:151]
    v_accvgpr_read_b32 v2, a250
    v_accvgpr_read_b32 v3, a251
    v_mfma_f32_16x16x32_bf16 v[180:183], v[116:119], v[84:87], v[180:183]
    buffer_load_dwordx4 v20, s[24:27], s36 offen offset:3072 lds
    v_mfma_f32_16x16x32_bf16 v[212:215], v[116:119], v[88:91], v[212:215]
    s_add_u32 s37, s49, 5767168
    v_cvt_pk_bf16_f32 v0, v0, v1
    v_cvt_pk_bf16_f32 v1, v2, v3
    v_mfma_f32_16x16x32_bf16 v[244:247], v[116:119], v[92:95], v[244:247]
    s_add_u32 m0, s50, 34816
    v_cvt_pk_bf16_f32 v2, v4, v5
    v_cvt_pk_bf16_f32 v3, v6, v7
    v_mfma_f32_16x16x32_bf16 v[152:155], v[120:123], v[80:83], v[152:155]
    buffer_load_dwordx4 v21, s[20:23], s37 offen offset:0 lds
    v_mfma_f32_16x16x32_bf16 v[184:187], v[120:123], v[84:87], v[184:187]
    v_accvgpr_read_b32 v12, a124
    v_accvgpr_read_b32 v13, a125
    v_mfma_f32_16x16x32_bf16 v[216:219], v[120:123], v[88:91], v[216:219]
    v_accvgpr_read_b32 v14, a126
    v_accvgpr_read_b32 v15, a127
    v_mfma_f32_16x16x32_bf16 v[248:251], v[120:123], v[92:95], v[248:251]
    buffer_store_dwordx4 v[0:3], v16, s[16:19], s38 offen offset:3072
    v_mfma_f32_16x16x32_bf16 v[156:159], v[124:127], v[80:83], v[156:159]
    s_add_u32 s38, s38, 16384
    v_accvgpr_read_b32 v8, a92
    v_accvgpr_read_b32 v9, a93
    v_mfma_f32_16x16x32_bf16 v[188:191], v[124:127], v[84:87], v[188:191]
    v_accvgpr_read_b32 v10, a94
    v_accvgpr_read_b32 v11, a95
    v_mfma_f32_16x16x32_bf16 v[220:223], v[124:127], v[88:91], v[220:223]
    buffer_load_dwordx4 v22, s[20:23], s37 offen offset:1024 lds
    v_mfma_f32_16x16x32_bf16 v[252:255], v[124:127], v[92:95], v[252:255]
    s_waitcnt lgkmcnt(0)
    v_mul_f32 v8, s40, v8
    v_mul_f32 v9, s40, v9
    v_mfma_f32_16x16x32_bf16 v[128:131], v[48:51], v[32:35], v[128:131]
    ds_read_b64_tr_b16 v[96:97], v27 offset:8704
    ds_read_b64_tr_b16 v[98:99], v27 offset:9728
    v_mfma_f32_16x16x32_bf16 v[160:163], v[48:51], v[36:39], v[160:163]
    s_add_u32 s36, s45, 1408
    v_mul_f32 v10, s40, v10
    v_mul_f32 v11, s40, v11
    v_mfma_f32_16x16x32_bf16 v[192:195], v[48:51], v[40:43], v[192:195]
    s_add_u32 m0, s42, 36864
    ds_read_b128 v[80:83], v26 offset:0
    ds_read_b128 v[84:87], v26 offset:2048
    v_mfma_f32_16x16x32_bf16 v[224:227], v[48:51], v[44:47], v[224:227]
    buffer_load_dwordx4 v17, s[24:27], s36 offen offset:0 lds
    v_mfma_f32_16x16x32_bf16 v[132:135], v[52:55], v[32:35], v[132:135]
    ds_read_b128 v[88:91], v26 offset:4096
    ds_read_b128 v[92:95], v26 offset:6144
    v_mfma_f32_16x16x32_bf16 v[164:167], v[52:55], v[36:39], v[164:167]
    v_mul_f32 v12, s40, v12
    v_mul_f32 v13, s40, v13
    v_mfma_f32_16x16x32_bf16 v[196:199], v[52:55], v[40:43], v[196:199]
    ds_read_b64_tr_b16 v[100:101], v28 offset:8704
    ds_read_b64_tr_b16 v[102:103], v28 offset:9728
    v_mfma_f32_16x16x32_bf16 v[228:231], v[52:55], v[44:47], v[228:231]
    buffer_load_dwordx4 v18, s[24:27], s36 offen offset:1024 lds
    v_mfma_f32_16x16x32_bf16 v[136:139], v[56:59], v[32:35], v[136:139]
    ds_read_b64_tr_b16 v[104:105], v29 offset:8704
    ds_read_b64_tr_b16 v[106:107], v29 offset:9728
    v_mfma_f32_16x16x32_bf16 v[168:171], v[56:59], v[36:39], v[168:171]
    v_mul_f32 v14, s40, v14
    v_mul_f32 v15, s40, v15
    v_mfma_f32_16x16x32_bf16 v[200:203], v[56:59], v[40:43], v[200:203]
    ds_read_b64_tr_b16 v[108:109], v30 offset:8704
    ds_read_b64_tr_b16 v[110:111], v30 offset:9728
    v_mfma_f32_16x16x32_bf16 v[232:235], v[56:59], v[44:47], v[232:235]
    v_mfma_f32_16x16x32_bf16 v[140:143], v[60:63], v[32:35], v[140:143]
    ds_read_b64_tr_b16 v[112:113], v27 offset:8832
    ds_read_b64_tr_b16 v[114:115], v27 offset:9856
    v_mfma_f32_16x16x32_bf16 v[172:175], v[60:63], v[36:39], v[172:175]
    v_cvt_pk_bf16_f32 v8, v8, v9
    v_cvt_pk_bf16_f32 v9, v10, v11
    v_mfma_f32_16x16x32_bf16 v[204:207], v[60:63], v[40:43], v[204:207]
    ds_read_b64_tr_b16 v[116:117], v28 offset:8832
    ds_read_b64_tr_b16 v[118:119], v28 offset:9856
    v_mfma_f32_16x16x32_bf16 v[236:239], v[60:63], v[44:47], v[236:239]
    buffer_load_dwordx4 v19, s[24:27], s36 offen offset:2048 lds
    v_mfma_f32_16x16x32_bf16 v[144:147], v[64:67], v[32:35], v[144:147]
    ds_read_b64_tr_b16 v[120:121], v29 offset:8832
    ds_read_b64_tr_b16 v[122:123], v29 offset:9856
    v_mfma_f32_16x16x32_bf16 v[176:179], v[64:67], v[36:39], v[176:179]
    v_cvt_pk_bf16_f32 v10, v12, v13
    v_cvt_pk_bf16_f32 v11, v14, v15
    v_mfma_f32_16x16x32_bf16 v[208:211], v[64:67], v[40:43], v[208:211]
    ds_read_b64_tr_b16 v[124:125], v30 offset:8832
    ds_read_b64_tr_b16 v[126:127], v30 offset:9856
    v_mfma_f32_16x16x32_bf16 v[240:243], v[64:67], v[44:47], v[240:243]
    v_mfma_f32_16x16x32_bf16 v[148:151], v[68:71], v[32:35], v[148:151]
    v_mfma_f32_16x16x32_bf16 v[180:183], v[68:71], v[36:39], v[180:183]
    buffer_load_dwordx4 v20, s[24:27], s36 offen offset:3072 lds
    v_mfma_f32_16x16x32_bf16 v[212:215], v[68:71], v[40:43], v[212:215]
    s_add_u32 s37, s49, 6029312
    v_mfma_f32_16x16x32_bf16 v[244:247], v[68:71], v[44:47], v[244:247]
    s_add_u32 m0, s50, 43520
    v_mfma_f32_16x16x32_bf16 v[152:155], v[72:75], v[32:35], v[152:155]
    buffer_load_dwordx4 v21, s[20:23], s37 offen offset:0 lds
    v_mfma_f32_16x16x32_bf16 v[184:187], v[72:75], v[36:39], v[184:187]
    v_mfma_f32_16x16x32_bf16 v[216:219], v[72:75], v[40:43], v[216:219]
    v_mfma_f32_16x16x32_bf16 v[248:251], v[72:75], v[44:47], v[248:251]
    buffer_store_dwordx4 v[8:11], v16, s[16:19], s41 offen offset:1024
    v_mfma_f32_16x16x32_bf16 v[156:159], v[76:79], v[32:35], v[156:159]
    s_add_u32 s41, s41, 12288
    v_mfma_f32_16x16x32_bf16 v[188:191], v[76:79], v[36:39], v[188:191]
    s_mov_b32 s16, s92
    v_mfma_f32_16x16x32_bf16 v[220:223], v[76:79], v[40:43], v[220:223]
    buffer_load_dwordx4 v22, s[20:23], s37 offen offset:1024 lds
    v_mfma_f32_16x16x32_bf16 v[252:255], v[76:79], v[44:47], v[252:255]
    s_waitcnt vmcnt(15) lgkmcnt(0)
    s_barrier
    v_mfma_f32_16x16x32_bf16 v[128:131], v[96:99], v[80:83], v[128:131]
    s_mov_b32 s17, s93
    ds_read_b64_tr_b16 v[48:49], v27 offset:17408
    ds_read_b64_tr_b16 v[50:51], v27 offset:18432
    v_mfma_f32_16x16x32_bf16 v[160:163], v[96:99], v[84:87], v[160:163]
    s_add_u32 s36, s44, 1536
    v_mfma_f32_16x16x32_bf16 v[192:195], v[96:99], v[88:91], v[192:195]
    s_add_u32 m0, s42, 65536
    ds_read_b128 v[32:35], v23 offset:0
    ds_read_b128 v[36:39], v23 offset:2048
    v_mfma_f32_16x16x32_bf16 v[224:227], v[96:99], v[92:95], v[224:227]
    buffer_load_dwordx4 v17, s[24:27], s36 offen offset:0 lds
    v_mfma_f32_16x16x32_bf16 v[132:135], v[100:103], v[80:83], v[132:135]
    s_mov_b32 s18, 256
    ds_read_b128 v[40:43], v23 offset:4096
    ds_read_b128 v[44:47], v23 offset:6144
    v_mfma_f32_16x16x32_bf16 v[164:167], v[100:103], v[84:87], v[164:167]
    v_or_b32 v0, s32, v16
    v_mov_b32 v1, 1
    v_mfma_f32_16x16x32_bf16 v[196:199], v[100:103], v[88:91], v[196:199]
    ds_read_b64_tr_b16 v[52:53], v28 offset:17408
    ds_read_b64_tr_b16 v[54:55], v28 offset:18432
    v_mfma_f32_16x16x32_bf16 v[228:231], v[100:103], v[92:95], v[228:231]
    buffer_load_dwordx4 v18, s[24:27], s36 offen offset:1024 lds
    v_mfma_f32_16x16x32_bf16 v[136:139], v[104:107], v[80:83], v[136:139]
    ds_read_b64_tr_b16 v[56:57], v29 offset:17408
    ds_read_b64_tr_b16 v[58:59], v29 offset:18432
    v_mfma_f32_16x16x32_bf16 v[168:171], v[104:107], v[84:87], v[168:171]
    v_mov_b32 v2, 0x80000000
    v_cmp_eq_u32 vcc, 0, v0
    v_mfma_f32_16x16x32_bf16 v[200:203], v[104:107], v[88:91], v[200:203]
    s_lshl_b32 s40, s33, 3
    ds_read_b64_tr_b16 v[60:61], v30 offset:17408
    ds_read_b64_tr_b16 v[62:63], v30 offset:18432
    v_mfma_f32_16x16x32_bf16 v[232:235], v[104:107], v[92:95], v[232:235]
    v_mfma_f32_16x16x32_bf16 v[140:143], v[108:111], v[80:83], v[140:143]
    ds_read_b64_tr_b16 v[64:65], v27 offset:17536
    ds_read_b64_tr_b16 v[66:67], v27 offset:18560
    v_mfma_f32_16x16x32_bf16 v[172:175], v[108:111], v[84:87], v[172:175]
    v_cndmask_b32 v0, v2, v0, vcc
    v_mov_b32 v3, 0
    v_mfma_f32_16x16x32_bf16 v[204:207], v[108:111], v[88:91], v[204:207]
    ds_read_b64_tr_b16 v[68:69], v28 offset:17536
    ds_read_b64_tr_b16 v[70:71], v28 offset:18560
    v_mfma_f32_16x16x32_bf16 v[236:239], v[108:111], v[92:95], v[236:239]
    buffer_load_dwordx4 v19, s[24:27], s36 offen offset:2048 lds
    v_mfma_f32_16x16x32_bf16 v[144:147], v[112:115], v[80:83], v[144:147]
    ds_read_b64_tr_b16 v[72:73], v29 offset:17536
    ds_read_b64_tr_b16 v[74:75], v29 offset:18560
    v_mfma_f32_16x16x32_bf16 v[176:179], v[112:115], v[84:87], v[176:179]
    v_mov_b32 v4, 0
    v_mov_b32 v5, 0
    v_mfma_f32_16x16x32_bf16 v[208:211], v[112:115], v[88:91], v[208:211]
    ds_read_b64_tr_b16 v[76:77], v30 offset:17536
    ds_read_b64_tr_b16 v[78:79], v30 offset:18560
    v_mfma_f32_16x16x32_bf16 v[240:243], v[112:115], v[92:95], v[240:243]
    v_mov_b32 v6, 0
    v_mov_b32 v7, 0
    v_mfma_f32_16x16x32_bf16 v[148:151], v[116:119], v[80:83], v[148:151]
    v_mov_b32 v8, 153600
    v_mfma_f32_16x16x32_bf16 v[180:183], v[116:119], v[84:87], v[180:183]
    buffer_load_dwordx4 v20, s[24:27], s36 offen offset:3072 lds
    v_mfma_f32_16x16x32_bf16 v[212:215], v[116:119], v[88:91], v[212:215]
    s_add_u32 s37, s49, 6291456
    ds_write_b128 v8, v[4:7]
    ds_read_b128 a[0:3], v8
    v_mfma_f32_16x16x32_bf16 v[244:247], v[116:119], v[92:95], v[244:247]
    s_add_u32 m0, s50, 0
    ds_read_b128 a[4:7], v8
    ds_read_b128 a[8:11], v8
    v_mfma_f32_16x16x32_bf16 v[152:155], v[120:123], v[80:83], v[152:155]
    buffer_load_dwordx4 v21, s[20:23], s37 offen offset:0 lds
    v_mfma_f32_16x16x32_bf16 v[184:187], v[120:123], v[84:87], v[184:187]
    ds_read_b128 a[12:15], v8
    ds_read_b128 a[16:19], v8
    v_mfma_f32_16x16x32_bf16 v[216:219], v[120:123], v[88:91], v[216:219]
    ds_read_b128 a[20:23], v8
    ds_read_b128 a[24:27], v8
    v_mfma_f32_16x16x32_bf16 v[248:251], v[120:123], v[92:95], v[248:251]
    buffer_load_dword v9, v3, s[16:19], s40 offen offset:4 sc1
    v_mfma_f32_16x16x32_bf16 v[156:159], v[124:127], v[80:83], v[156:159]
    v_mfma_f32_16x16x32_bf16 v[188:191], v[124:127], v[84:87], v[188:191]
    v_mfma_f32_16x16x32_bf16 v[220:223], v[124:127], v[88:91], v[220:223]
    buffer_load_dwordx4 v22, s[20:23], s37 offen offset:1024 lds
    v_mfma_f32_16x16x32_bf16 v[252:255], v[124:127], v[92:95], v[252:255]
    s_waitcnt lgkmcnt(0)
    v_mfma_f32_16x16x32_bf16 v[128:131], v[48:51], v[32:35], v[128:131]
    s_getreg_b32 s58, hwreg(HW_REG_XCC_ID, 0, 3)
    ds_read_b64_tr_b16 v[96:97], v27 offset:26112
    ds_read_b64_tr_b16 v[98:99], v27 offset:27136
    v_mfma_f32_16x16x32_bf16 v[160:163], v[48:51], v[36:39], v[160:163]
    s_add_u32 s36, s45, 1536
    ds_read_b128 a[28:31], v8
    ds_read_b128 a[32:35], v8
    v_mfma_f32_16x16x32_bf16 v[192:195], v[48:51], v[40:43], v[192:195]
    s_add_u32 m0, s42, 69632
    ds_read_b128 v[80:83], v24 offset:0
    ds_read_b128 v[84:87], v24 offset:2048
    v_mfma_f32_16x16x32_bf16 v[224:227], v[48:51], v[44:47], v[224:227]
    buffer_load_dwordx4 v17, s[24:27], s36 offen offset:0 lds
    v_mfma_f32_16x16x32_bf16 v[132:135], v[52:55], v[32:35], v[132:135]
    s_lshl_b32 s58, s58, 2
    ds_read_b128 v[88:91], v24 offset:4096
    ds_read_b128 v[92:95], v24 offset:6144
    v_mfma_f32_16x16x32_bf16 v[164:167], v[52:55], v[36:39], v[164:167]
    s_lshl_b32 s58, 8, s58
    ds_read_b128 a[36:39], v8
    ds_read_b128 a[40:43], v8
    v_mfma_f32_16x16x32_bf16 v[196:199], v[52:55], v[40:43], v[196:199]
    ds_read_b64_tr_b16 v[100:101], v28 offset:26112
    ds_read_b64_tr_b16 v[102:103], v28 offset:27136
    v_mfma_f32_16x16x32_bf16 v[228:231], v[52:55], v[44:47], v[228:231]
    buffer_load_dwordx4 v18, s[24:27], s36 offen offset:1024 lds
    v_mfma_f32_16x16x32_bf16 v[136:139], v[56:59], v[32:35], v[136:139]
    ds_read_b64_tr_b16 v[104:105], v29 offset:26112
    ds_read_b64_tr_b16 v[106:107], v29 offset:27136
    v_mfma_f32_16x16x32_bf16 v[168:171], v[56:59], v[36:39], v[168:171]
    ds_read_b128 a[44:47], v8
    ds_read_b128 a[48:51], v8
    v_mfma_f32_16x16x32_bf16 v[200:203], v[56:59], v[40:43], v[200:203]
    ds_read_b64_tr_b16 v[108:109], v30 offset:26112
    ds_read_b64_tr_b16 v[110:111], v30 offset:27136
    v_mfma_f32_16x16x32_bf16 v[232:235], v[56:59], v[44:47], v[232:235]
    v_mfma_f32_16x16x32_bf16 v[140:143], v[60:63], v[32:35], v[140:143]
    ds_read_b64_tr_b16 v[112:113], v27 offset:26240
    ds_read_b64_tr_b16 v[114:115], v27 offset:27264
    v_mfma_f32_16x16x32_bf16 v[172:175], v[60:63], v[36:39], v[172:175]
    ds_read_b128 a[52:55], v8
    ds_read_b128 a[56:59], v8
    v_mfma_f32_16x16x32_bf16 v[204:207], v[60:63], v[40:43], v[204:207]
    ds_read_b64_tr_b16 v[116:117], v28 offset:26240
    ds_read_b64_tr_b16 v[118:119], v28 offset:27264
    v_mfma_f32_16x16x32_bf16 v[236:239], v[60:63], v[44:47], v[236:239]
    buffer_load_dwordx4 v19, s[24:27], s36 offen offset:2048 lds
    v_mfma_f32_16x16x32_bf16 v[144:147], v[64:67], v[32:35], v[144:147]
    ds_read_b64_tr_b16 v[120:121], v29 offset:26240
    ds_read_b64_tr_b16 v[122:123], v29 offset:27264
    v_mfma_f32_16x16x32_bf16 v[176:179], v[64:67], v[36:39], v[176:179]
    ds_read_b128 a[60:63], v8
    ds_read_b128 a[64:67], v8
    v_mfma_f32_16x16x32_bf16 v[208:211], v[64:67], v[40:43], v[208:211]
    ds_read_b64_tr_b16 v[124:125], v30 offset:26240
    ds_read_b64_tr_b16 v[126:127], v30 offset:27264
    v_mfma_f32_16x16x32_bf16 v[240:243], v[64:67], v[44:47], v[240:243]
    ds_read_b128 a[68:71], v8
    ds_read_b128 a[72:75], v8
    v_mfma_f32_16x16x32_bf16 v[148:151], v[68:71], v[32:35], v[148:151]
    ds_read_b128 a[76:79], v8
    ds_read_b128 a[80:83], v8
    v_mfma_f32_16x16x32_bf16 v[180:183], v[68:71], v[36:39], v[180:183]
    buffer_load_dwordx4 v20, s[24:27], s36 offen offset:3072 lds
    v_mfma_f32_16x16x32_bf16 v[212:215], v[68:71], v[40:43], v[212:215]
    s_add_u32 s37, s49, 6553600
    ds_read_b128 a[84:87], v8
    ds_read_b128 a[88:91], v8
    v_mfma_f32_16x16x32_bf16 v[244:247], v[68:71], v[44:47], v[244:247]
    s_add_u32 m0, s50, 8704
    ds_read_b128 a[92:95], v8
    ds_read_b128 a[96:99], v8
    v_mfma_f32_16x16x32_bf16 v[152:155], v[72:75], v[32:35], v[152:155]
    buffer_load_dwordx4 v21, s[20:23], s37 offen offset:0 lds
    v_mfma_f32_16x16x32_bf16 v[184:187], v[72:75], v[36:39], v[184:187]
    ds_read_b128 a[100:103], v8
    ds_read_b128 a[104:107], v8
    v_mfma_f32_16x16x32_bf16 v[216:219], v[72:75], v[40:43], v[216:219]
    ds_read_b128 a[108:111], v8
    ds_read_b128 a[112:115], v8
    v_mfma_f32_16x16x32_bf16 v[248:251], v[72:75], v[44:47], v[248:251]
    v_mfma_f32_16x16x32_bf16 v[156:159], v[76:79], v[32:35], v[156:159]
    v_mfma_f32_16x16x32_bf16 v[188:191], v[76:79], v[36:39], v[188:191]
    v_mfma_f32_16x16x32_bf16 v[220:223], v[76:79], v[40:43], v[220:223]
    buffer_load_dwordx4 v22, s[20:23], s37 offen offset:1024 lds
    v_mfma_f32_16x16x32_bf16 v[252:255], v[76:79], v[44:47], v[252:255]
    s_waitcnt vmcnt(7) lgkmcnt(0)
    s_barrier
    v_cmp_ne_u32 vcc, s58, v9
    v_mfma_f32_16x16x32_bf16 v[128:131], v[96:99], v[80:83], v[128:131]
    ds_read_b64_tr_b16 v[48:49], v27 offset:34816
    ds_read_b64_tr_b16 v[50:51], v27 offset:35840
    v_mfma_f32_16x16x32_bf16 v[160:163], v[96:99], v[84:87], v[160:163]
    s_add_u32 s36, s44, 1664
    ds_read_b128 a[116:119], v8
    ds_read_b128 a[120:123], v8
    v_mfma_f32_16x16x32_bf16 v[192:195], v[96:99], v[88:91], v[192:195]
    s_add_u32 m0, s42, 0
    ds_read_b128 v[32:35], v23 offset:32768
    ds_read_b128 v[36:39], v23 offset:34816
    v_mfma_f32_16x16x32_bf16 v[224:227], v[96:99], v[92:95], v[224:227]
    buffer_load_dwordx4 v17, s[24:27], s36 offen offset:0 lds
    v_mfma_f32_16x16x32_bf16 v[132:135], v[100:103], v[80:83], v[132:135]
    s_cbranch_vccnz gated_mix__ssm_conv_h3__compressed_kv_cla__prompt_kernel_wb
gated_mix__ssm_conv_h3__compressed_kv_cla__prompt_kernel_wb_ret:
    ds_read_b128 v[40:43], v23 offset:36864
    ds_read_b128 v[44:47], v23 offset:38912
    v_mfma_f32_16x16x32_bf16 v[164:167], v[100:103], v[84:87], v[164:167]
    ds_read_b128 a[124:127], v8
    v_mfma_f32_16x16x32_bf16 v[196:199], v[100:103], v[88:91], v[196:199]
    ds_read_b64_tr_b16 v[52:53], v28 offset:34816
    ds_read_b64_tr_b16 v[54:55], v28 offset:35840
    v_mfma_f32_16x16x32_bf16 v[228:231], v[100:103], v[92:95], v[228:231]
    buffer_load_dwordx4 v18, s[24:27], s36 offen offset:1024 lds
    v_mfma_f32_16x16x32_bf16 v[136:139], v[104:107], v[80:83], v[136:139]
    ds_read_b64_tr_b16 v[56:57], v29 offset:34816
    ds_read_b64_tr_b16 v[58:59], v29 offset:35840
    v_mfma_f32_16x16x32_bf16 v[168:171], v[104:107], v[84:87], v[168:171]
    v_mfma_f32_16x16x32_bf16 v[200:203], v[104:107], v[88:91], v[200:203]
    ds_read_b64_tr_b16 v[60:61], v30 offset:34816
    ds_read_b64_tr_b16 v[62:63], v30 offset:35840
    v_mfma_f32_16x16x32_bf16 v[232:235], v[104:107], v[92:95], v[232:235]
    buffer_atomic_add v1, v0, s[16:19], s40 offen sc1
    v_mfma_f32_16x16x32_bf16 v[140:143], v[108:111], v[80:83], v[140:143]
    ds_read_b64_tr_b16 v[64:65], v27 offset:34944
    ds_read_b64_tr_b16 v[66:67], v27 offset:35968
    v_mfma_f32_16x16x32_bf16 v[172:175], v[108:111], v[84:87], v[172:175]
    v_mfma_f32_16x16x32_bf16 v[204:207], v[108:111], v[88:91], v[204:207]
    ds_read_b64_tr_b16 v[68:69], v28 offset:34944
    ds_read_b64_tr_b16 v[70:71], v28 offset:35968
    v_mfma_f32_16x16x32_bf16 v[236:239], v[108:111], v[92:95], v[236:239]
    buffer_load_dwordx4 v19, s[24:27], s36 offen offset:2048 lds
    v_mfma_f32_16x16x32_bf16 v[144:147], v[112:115], v[80:83], v[144:147]
    ds_read_b64_tr_b16 v[72:73], v29 offset:34944
    ds_read_b64_tr_b16 v[74:75], v29 offset:35968
    v_mfma_f32_16x16x32_bf16 v[176:179], v[112:115], v[84:87], v[176:179]
    v_mfma_f32_16x16x32_bf16 v[208:211], v[112:115], v[88:91], v[208:211]
    ds_read_b64_tr_b16 v[76:77], v30 offset:34944
    ds_read_b64_tr_b16 v[78:79], v30 offset:35968
    v_mfma_f32_16x16x32_bf16 v[240:243], v[112:115], v[92:95], v[240:243]
    v_mfma_f32_16x16x32_bf16 v[148:151], v[116:119], v[80:83], v[148:151]
    v_mfma_f32_16x16x32_bf16 v[180:183], v[116:119], v[84:87], v[180:183]
    buffer_load_dwordx4 v20, s[24:27], s36 offen offset:3072 lds
    v_mfma_f32_16x16x32_bf16 v[212:215], v[116:119], v[88:91], v[212:215]
    s_add_u32 s37, s49, 6815744
    v_mfma_f32_16x16x32_bf16 v[244:247], v[116:119], v[92:95], v[244:247]
    s_add_u32 m0, s50, 17408
    v_mfma_f32_16x16x32_bf16 v[152:155], v[120:123], v[80:83], v[152:155]
    buffer_load_dwordx4 v21, s[20:23], s37 offen offset:0 lds
    v_mfma_f32_16x16x32_bf16 v[184:187], v[120:123], v[84:87], v[184:187]
    v_mfma_f32_16x16x32_bf16 v[216:219], v[120:123], v[88:91], v[216:219]
    v_mfma_f32_16x16x32_bf16 v[248:251], v[120:123], v[92:95], v[248:251]
    v_mfma_f32_16x16x32_bf16 v[156:159], v[124:127], v[80:83], v[156:159]
    v_mfma_f32_16x16x32_bf16 v[188:191], v[124:127], v[84:87], v[188:191]
    v_mfma_f32_16x16x32_bf16 v[220:223], v[124:127], v[88:91], v[220:223]
    buffer_load_dwordx4 v22, s[20:23], s37 offen offset:1024 lds
    v_mfma_f32_16x16x32_bf16 v[252:255], v[124:127], v[92:95], v[252:255]
    s_waitcnt lgkmcnt(0)
    v_mfma_f32_16x16x32_bf16 v[128:131], v[48:51], v[32:35], v[128:131]
    ds_read_b64_tr_b16 v[96:97], v27 offset:43520
    ds_read_b64_tr_b16 v[98:99], v27 offset:44544
    v_mfma_f32_16x16x32_bf16 v[160:163], v[48:51], v[36:39], v[160:163]
    s_add_u32 s36, s45, 1664
    v_mfma_f32_16x16x32_bf16 v[192:195], v[48:51], v[40:43], v[192:195]
    s_add_u32 m0, s42, 4096
    ds_read_b128 v[80:83], v24 offset:32768
    ds_read_b128 v[84:87], v24 offset:34816
    v_mfma_f32_16x16x32_bf16 v[224:227], v[48:51], v[44:47], v[224:227]
    buffer_load_dwordx4 v17, s[24:27], s36 offen offset:0 lds
    v_mfma_f32_16x16x32_bf16 v[132:135], v[52:55], v[32:35], v[132:135]
    ds_read_b128 v[88:91], v24 offset:36864
    ds_read_b128 v[92:95], v24 offset:38912
    v_mfma_f32_16x16x32_bf16 v[164:167], v[52:55], v[36:39], v[164:167]
    v_mfma_f32_16x16x32_bf16 v[196:199], v[52:55], v[40:43], v[196:199]
    ds_read_b64_tr_b16 v[100:101], v28 offset:43520
    ds_read_b64_tr_b16 v[102:103], v28 offset:44544
    v_mfma_f32_16x16x32_bf16 v[228:231], v[52:55], v[44:47], v[228:231]
    buffer_load_dwordx4 v18, s[24:27], s36 offen offset:1024 lds
    v_mfma_f32_16x16x32_bf16 v[136:139], v[56:59], v[32:35], v[136:139]
    ds_read_b64_tr_b16 v[104:105], v29 offset:43520
    ds_read_b64_tr_b16 v[106:107], v29 offset:44544
    v_mfma_f32_16x16x32_bf16 v[168:171], v[56:59], v[36:39], v[168:171]
    v_mfma_f32_16x16x32_bf16 v[200:203], v[56:59], v[40:43], v[200:203]
    ds_read_b64_tr_b16 v[108:109], v30 offset:43520
    ds_read_b64_tr_b16 v[110:111], v30 offset:44544
    v_mfma_f32_16x16x32_bf16 v[232:235], v[56:59], v[44:47], v[232:235]
    v_mfma_f32_16x16x32_bf16 v[140:143], v[60:63], v[32:35], v[140:143]
    ds_read_b64_tr_b16 v[112:113], v27 offset:43648
    ds_read_b64_tr_b16 v[114:115], v27 offset:44672
    v_mfma_f32_16x16x32_bf16 v[172:175], v[60:63], v[36:39], v[172:175]
    v_mfma_f32_16x16x32_bf16 v[204:207], v[60:63], v[40:43], v[204:207]
    ds_read_b64_tr_b16 v[116:117], v28 offset:43648
    ds_read_b64_tr_b16 v[118:119], v28 offset:44672
    v_mfma_f32_16x16x32_bf16 v[236:239], v[60:63], v[44:47], v[236:239]
    buffer_load_dwordx4 v19, s[24:27], s36 offen offset:2048 lds
    v_mfma_f32_16x16x32_bf16 v[144:147], v[64:67], v[32:35], v[144:147]
    ds_read_b64_tr_b16 v[120:121], v29 offset:43648
    ds_read_b64_tr_b16 v[122:123], v29 offset:44672
    v_mfma_f32_16x16x32_bf16 v[176:179], v[64:67], v[36:39], v[176:179]
    v_mfma_f32_16x16x32_bf16 v[208:211], v[64:67], v[40:43], v[208:211]
    ds_read_b64_tr_b16 v[124:125], v30 offset:43648
    ds_read_b64_tr_b16 v[126:127], v30 offset:44672
    v_mfma_f32_16x16x32_bf16 v[240:243], v[64:67], v[44:47], v[240:243]
    v_mfma_f32_16x16x32_bf16 v[148:151], v[68:71], v[32:35], v[148:151]
    v_mfma_f32_16x16x32_bf16 v[180:183], v[68:71], v[36:39], v[180:183]
    buffer_load_dwordx4 v20, s[24:27], s36 offen offset:3072 lds
    v_mfma_f32_16x16x32_bf16 v[212:215], v[68:71], v[40:43], v[212:215]
    s_add_u32 s37, s49, 7077888
    v_mfma_f32_16x16x32_bf16 v[244:247], v[68:71], v[44:47], v[244:247]
    s_add_u32 m0, s50, 26112
    v_mfma_f32_16x16x32_bf16 v[152:155], v[72:75], v[32:35], v[152:155]
    buffer_load_dwordx4 v21, s[20:23], s37 offen offset:0 lds
    v_mfma_f32_16x16x32_bf16 v[184:187], v[72:75], v[36:39], v[184:187]
    v_mfma_f32_16x16x32_bf16 v[216:219], v[72:75], v[40:43], v[216:219]
    v_mfma_f32_16x16x32_bf16 v[248:251], v[72:75], v[44:47], v[248:251]
    v_mfma_f32_16x16x32_bf16 v[156:159], v[76:79], v[32:35], v[156:159]
    v_mfma_f32_16x16x32_bf16 v[188:191], v[76:79], v[36:39], v[188:191]
    v_mfma_f32_16x16x32_bf16 v[220:223], v[76:79], v[40:43], v[220:223]
    buffer_load_dwordx4 v22, s[20:23], s37 offen offset:1024 lds
    v_mfma_f32_16x16x32_bf16 v[252:255], v[76:79], v[44:47], v[252:255]
    s_waitcnt vmcnt(13) lgkmcnt(0)
    s_barrier
    v_mfma_f32_16x16x32_bf16 v[128:131], v[96:99], v[80:83], v[128:131]
    ds_read_b64_tr_b16 v[48:49], v27 offset:0
    ds_read_b64_tr_b16 v[50:51], v27 offset:1024
    v_mfma_f32_16x16x32_bf16 v[160:163], v[96:99], v[84:87], v[160:163]
    s_add_u32 s36, s44, 1792
    v_mfma_f32_16x16x32_bf16 v[192:195], v[96:99], v[88:91], v[192:195]
    s_add_u32 m0, s42, 32768
    ds_read_b128 v[32:35], v25 offset:0
    ds_read_b128 v[36:39], v25 offset:2048
    v_mfma_f32_16x16x32_bf16 v[224:227], v[96:99], v[92:95], v[224:227]
    buffer_load_dwordx4 v17, s[24:27], s36 offen offset:0 lds
    v_mfma_f32_16x16x32_bf16 v[132:135], v[100:103], v[80:83], v[132:135]
    ds_read_b128 v[40:43], v25 offset:4096
    ds_read_b128 v[44:47], v25 offset:6144
    v_mfma_f32_16x16x32_bf16 v[164:167], v[100:103], v[84:87], v[164:167]
    v_mfma_f32_16x16x32_bf16 v[196:199], v[100:103], v[88:91], v[196:199]
    ds_read_b64_tr_b16 v[52:53], v28 offset:0
    ds_read_b64_tr_b16 v[54:55], v28 offset:1024
    v_mfma_f32_16x16x32_bf16 v[228:231], v[100:103], v[92:95], v[228:231]
    buffer_load_dwordx4 v18, s[24:27], s36 offen offset:1024 lds
    v_mfma_f32_16x16x32_bf16 v[136:139], v[104:107], v[80:83], v[136:139]
    ds_read_b64_tr_b16 v[56:57], v29 offset:0
    ds_read_b64_tr_b16 v[58:59], v29 offset:1024
    v_mfma_f32_16x16x32_bf16 v[168:171], v[104:107], v[84:87], v[168:171]
    v_mfma_f32_16x16x32_bf16 v[200:203], v[104:107], v[88:91], v[200:203]
    ds_read_b64_tr_b16 v[60:61], v30 offset:0
    ds_read_b64_tr_b16 v[62:63], v30 offset:1024
    v_mfma_f32_16x16x32_bf16 v[232:235], v[104:107], v[92:95], v[232:235]
    v_mfma_f32_16x16x32_bf16 v[140:143], v[108:111], v[80:83], v[140:143]
    ds_read_b64_tr_b16 v[64:65], v27 offset:128
    ds_read_b64_tr_b16 v[66:67], v27 offset:1152
    v_mfma_f32_16x16x32_bf16 v[172:175], v[108:111], v[84:87], v[172:175]
    v_mfma_f32_16x16x32_bf16 v[204:207], v[108:111], v[88:91], v[204:207]
    ds_read_b64_tr_b16 v[68:69], v28 offset:128
    ds_read_b64_tr_b16 v[70:71], v28 offset:1152
    v_mfma_f32_16x16x32_bf16 v[236:239], v[108:111], v[92:95], v[236:239]
    buffer_load_dwordx4 v19, s[24:27], s36 offen offset:2048 lds
    v_mfma_f32_16x16x32_bf16 v[144:147], v[112:115], v[80:83], v[144:147]
    ds_read_b64_tr_b16 v[72:73], v29 offset:128
    ds_read_b64_tr_b16 v[74:75], v29 offset:1152
    v_mfma_f32_16x16x32_bf16 v[176:179], v[112:115], v[84:87], v[176:179]
    v_mfma_f32_16x16x32_bf16 v[208:211], v[112:115], v[88:91], v[208:211]
    ds_read_b64_tr_b16 v[76:77], v30 offset:128
    ds_read_b64_tr_b16 v[78:79], v30 offset:1152
    v_mfma_f32_16x16x32_bf16 v[240:243], v[112:115], v[92:95], v[240:243]
    v_mfma_f32_16x16x32_bf16 v[148:151], v[116:119], v[80:83], v[148:151]
    v_mfma_f32_16x16x32_bf16 v[180:183], v[116:119], v[84:87], v[180:183]
    buffer_load_dwordx4 v20, s[24:27], s36 offen offset:3072 lds
    v_mfma_f32_16x16x32_bf16 v[212:215], v[116:119], v[88:91], v[212:215]
    s_add_u32 s37, s49, 7340032
    v_mfma_f32_16x16x32_bf16 v[244:247], v[116:119], v[92:95], v[244:247]
    s_add_u32 m0, s50, 34816
    v_mfma_f32_16x16x32_bf16 v[152:155], v[120:123], v[80:83], v[152:155]
    buffer_load_dwordx4 v21, s[20:23], s37 offen offset:0 lds
    v_mfma_f32_16x16x32_bf16 v[184:187], v[120:123], v[84:87], v[184:187]
    v_mfma_f32_16x16x32_bf16 v[216:219], v[120:123], v[88:91], v[216:219]
    v_mfma_f32_16x16x32_bf16 v[248:251], v[120:123], v[92:95], v[248:251]
    v_mfma_f32_16x16x32_bf16 v[156:159], v[124:127], v[80:83], v[156:159]
    v_mfma_f32_16x16x32_bf16 v[188:191], v[124:127], v[84:87], v[188:191]
    v_mfma_f32_16x16x32_bf16 v[220:223], v[124:127], v[88:91], v[220:223]
    buffer_load_dwordx4 v22, s[20:23], s37 offen offset:1024 lds
    v_mfma_f32_16x16x32_bf16 v[252:255], v[124:127], v[92:95], v[252:255]
    s_waitcnt lgkmcnt(0)
    v_mfma_f32_16x16x32_bf16 v[128:131], v[48:51], v[32:35], v[128:131]
    ds_read_b64_tr_b16 v[96:97], v27 offset:8704
    ds_read_b64_tr_b16 v[98:99], v27 offset:9728
    v_mfma_f32_16x16x32_bf16 v[160:163], v[48:51], v[36:39], v[160:163]
    s_add_u32 s36, s45, 1792
    v_mfma_f32_16x16x32_bf16 v[192:195], v[48:51], v[40:43], v[192:195]
    s_add_u32 m0, s42, 36864
    ds_read_b128 v[80:83], v26 offset:0
    ds_read_b128 v[84:87], v26 offset:2048
    v_mfma_f32_16x16x32_bf16 v[224:227], v[48:51], v[44:47], v[224:227]
    buffer_load_dwordx4 v17, s[24:27], s36 offen offset:0 lds
    v_mfma_f32_16x16x32_bf16 v[132:135], v[52:55], v[32:35], v[132:135]
    ds_read_b128 v[88:91], v26 offset:4096
    ds_read_b128 v[92:95], v26 offset:6144
    v_mfma_f32_16x16x32_bf16 v[164:167], v[52:55], v[36:39], v[164:167]
    v_mfma_f32_16x16x32_bf16 v[196:199], v[52:55], v[40:43], v[196:199]
    ds_read_b64_tr_b16 v[100:101], v28 offset:8704
    ds_read_b64_tr_b16 v[102:103], v28 offset:9728
    v_mfma_f32_16x16x32_bf16 v[228:231], v[52:55], v[44:47], v[228:231]
    buffer_load_dwordx4 v18, s[24:27], s36 offen offset:1024 lds
    v_mfma_f32_16x16x32_bf16 v[136:139], v[56:59], v[32:35], v[136:139]
    ds_read_b64_tr_b16 v[104:105], v29 offset:8704
    ds_read_b64_tr_b16 v[106:107], v29 offset:9728
    v_mfma_f32_16x16x32_bf16 v[168:171], v[56:59], v[36:39], v[168:171]
    v_mfma_f32_16x16x32_bf16 v[200:203], v[56:59], v[40:43], v[200:203]
    ds_read_b64_tr_b16 v[108:109], v30 offset:8704
    ds_read_b64_tr_b16 v[110:111], v30 offset:9728
    v_mfma_f32_16x16x32_bf16 v[232:235], v[56:59], v[44:47], v[232:235]
    v_mfma_f32_16x16x32_bf16 v[140:143], v[60:63], v[32:35], v[140:143]
    ds_read_b64_tr_b16 v[112:113], v27 offset:8832
    ds_read_b64_tr_b16 v[114:115], v27 offset:9856
    v_mfma_f32_16x16x32_bf16 v[172:175], v[60:63], v[36:39], v[172:175]
    v_mfma_f32_16x16x32_bf16 v[204:207], v[60:63], v[40:43], v[204:207]
    ds_read_b64_tr_b16 v[116:117], v28 offset:8832
    ds_read_b64_tr_b16 v[118:119], v28 offset:9856
    v_mfma_f32_16x16x32_bf16 v[236:239], v[60:63], v[44:47], v[236:239]
    buffer_load_dwordx4 v19, s[24:27], s36 offen offset:2048 lds
    v_mfma_f32_16x16x32_bf16 v[144:147], v[64:67], v[32:35], v[144:147]
    ds_read_b64_tr_b16 v[120:121], v29 offset:8832
    ds_read_b64_tr_b16 v[122:123], v29 offset:9856
    v_mfma_f32_16x16x32_bf16 v[176:179], v[64:67], v[36:39], v[176:179]
    v_mfma_f32_16x16x32_bf16 v[208:211], v[64:67], v[40:43], v[208:211]
    ds_read_b64_tr_b16 v[124:125], v30 offset:8832
    ds_read_b64_tr_b16 v[126:127], v30 offset:9856
    v_mfma_f32_16x16x32_bf16 v[240:243], v[64:67], v[44:47], v[240:243]
    v_mfma_f32_16x16x32_bf16 v[148:151], v[68:71], v[32:35], v[148:151]
    v_mfma_f32_16x16x32_bf16 v[180:183], v[68:71], v[36:39], v[180:183]
    buffer_load_dwordx4 v20, s[24:27], s36 offen offset:3072 lds
    v_mfma_f32_16x16x32_bf16 v[212:215], v[68:71], v[40:43], v[212:215]
    s_add_u32 s37, s49, 7602176
    v_mfma_f32_16x16x32_bf16 v[244:247], v[68:71], v[44:47], v[244:247]
    s_add_u32 m0, s50, 43520
    v_mfma_f32_16x16x32_bf16 v[152:155], v[72:75], v[32:35], v[152:155]
    buffer_load_dwordx4 v21, s[20:23], s37 offen offset:0 lds
    v_mfma_f32_16x16x32_bf16 v[184:187], v[72:75], v[36:39], v[184:187]
    v_mfma_f32_16x16x32_bf16 v[216:219], v[72:75], v[40:43], v[216:219]
    v_mfma_f32_16x16x32_bf16 v[248:251], v[72:75], v[44:47], v[248:251]
    v_mfma_f32_16x16x32_bf16 v[156:159], v[76:79], v[32:35], v[156:159]
    v_mfma_f32_16x16x32_bf16 v[188:191], v[76:79], v[36:39], v[188:191]
    v_mfma_f32_16x16x32_bf16 v[220:223], v[76:79], v[40:43], v[220:223]
    buffer_load_dwordx4 v22, s[20:23], s37 offen offset:1024 lds
    v_mfma_f32_16x16x32_bf16 v[252:255], v[76:79], v[44:47], v[252:255]
    s_waitcnt vmcnt(12) lgkmcnt(0)
    s_barrier
    v_mfma_f32_16x16x32_bf16 v[128:131], v[96:99], v[80:83], v[128:131]
    ds_read_b64_tr_b16 v[48:49], v27 offset:17408
    ds_read_b64_tr_b16 v[50:51], v27 offset:18432
    v_mfma_f32_16x16x32_bf16 v[160:163], v[96:99], v[84:87], v[160:163]
    s_add_u32 s36, s44, 1920
    v_mfma_f32_16x16x32_bf16 v[192:195], v[96:99], v[88:91], v[192:195]
    s_add_u32 m0, s42, 65536
    ds_read_b128 v[32:35], v23 offset:0
    ds_read_b128 v[36:39], v23 offset:2048
    v_mfma_f32_16x16x32_bf16 v[224:227], v[96:99], v[92:95], v[224:227]
    buffer_load_dwordx4 v17, s[24:27], s36 offen offset:0 lds
    v_mfma_f32_16x16x32_bf16 v[132:135], v[100:103], v[80:83], v[132:135]
    ds_read_b128 v[40:43], v23 offset:4096
    ds_read_b128 v[44:47], v23 offset:6144
    v_mfma_f32_16x16x32_bf16 v[164:167], v[100:103], v[84:87], v[164:167]
    v_mfma_f32_16x16x32_bf16 v[196:199], v[100:103], v[88:91], v[196:199]
    ds_read_b64_tr_b16 v[52:53], v28 offset:17408
    ds_read_b64_tr_b16 v[54:55], v28 offset:18432
    v_mfma_f32_16x16x32_bf16 v[228:231], v[100:103], v[92:95], v[228:231]
    buffer_load_dwordx4 v18, s[24:27], s36 offen offset:1024 lds
    v_mfma_f32_16x16x32_bf16 v[136:139], v[104:107], v[80:83], v[136:139]
    ds_read_b64_tr_b16 v[56:57], v29 offset:17408
    ds_read_b64_tr_b16 v[58:59], v29 offset:18432
    v_mfma_f32_16x16x32_bf16 v[168:171], v[104:107], v[84:87], v[168:171]
    v_mfma_f32_16x16x32_bf16 v[200:203], v[104:107], v[88:91], v[200:203]
    ds_read_b64_tr_b16 v[60:61], v30 offset:17408
    ds_read_b64_tr_b16 v[62:63], v30 offset:18432
    v_mfma_f32_16x16x32_bf16 v[232:235], v[104:107], v[92:95], v[232:235]
    v_mfma_f32_16x16x32_bf16 v[140:143], v[108:111], v[80:83], v[140:143]
    ds_read_b64_tr_b16 v[64:65], v27 offset:17536
    ds_read_b64_tr_b16 v[66:67], v27 offset:18560
    v_mfma_f32_16x16x32_bf16 v[172:175], v[108:111], v[84:87], v[172:175]
    v_mfma_f32_16x16x32_bf16 v[204:207], v[108:111], v[88:91], v[204:207]
    ds_read_b64_tr_b16 v[68:69], v28 offset:17536
    ds_read_b64_tr_b16 v[70:71], v28 offset:18560
    v_mfma_f32_16x16x32_bf16 v[236:239], v[108:111], v[92:95], v[236:239]
    buffer_load_dwordx4 v19, s[24:27], s36 offen offset:2048 lds
    v_mfma_f32_16x16x32_bf16 v[144:147], v[112:115], v[80:83], v[144:147]
    ds_read_b64_tr_b16 v[72:73], v29 offset:17536
    ds_read_b64_tr_b16 v[74:75], v29 offset:18560
    v_mfma_f32_16x16x32_bf16 v[176:179], v[112:115], v[84:87], v[176:179]
    v_mfma_f32_16x16x32_bf16 v[208:211], v[112:115], v[88:91], v[208:211]
    ds_read_b64_tr_b16 v[76:77], v30 offset:17536
    ds_read_b64_tr_b16 v[78:79], v30 offset:18560
    v_mfma_f32_16x16x32_bf16 v[240:243], v[112:115], v[92:95], v[240:243]
    v_mfma_f32_16x16x32_bf16 v[148:151], v[116:119], v[80:83], v[148:151]
    v_mfma_f32_16x16x32_bf16 v[180:183], v[116:119], v[84:87], v[180:183]
    buffer_load_dwordx4 v20, s[24:27], s36 offen offset:3072 lds
    v_mfma_f32_16x16x32_bf16 v[212:215], v[116:119], v[88:91], v[212:215]
    s_add_u32 s37, s49, 7864320
    v_mfma_f32_16x16x32_bf16 v[244:247], v[116:119], v[92:95], v[244:247]
    s_add_u32 m0, s50, 0
    v_mfma_f32_16x16x32_bf16 v[152:155], v[120:123], v[80:83], v[152:155]
    buffer_load_dwordx4 v21, s[20:23], s37 offen offset:0 lds
    v_mfma_f32_16x16x32_bf16 v[184:187], v[120:123], v[84:87], v[184:187]
    v_mfma_f32_16x16x32_bf16 v[216:219], v[120:123], v[88:91], v[216:219]
    v_mfma_f32_16x16x32_bf16 v[248:251], v[120:123], v[92:95], v[248:251]
    v_mfma_f32_16x16x32_bf16 v[156:159], v[124:127], v[80:83], v[156:159]
    v_mfma_f32_16x16x32_bf16 v[188:191], v[124:127], v[84:87], v[188:191]
    v_mfma_f32_16x16x32_bf16 v[220:223], v[124:127], v[88:91], v[220:223]
    buffer_load_dwordx4 v22, s[20:23], s37 offen offset:1024 lds
    v_mfma_f32_16x16x32_bf16 v[252:255], v[124:127], v[92:95], v[252:255]
    s_waitcnt lgkmcnt(0)
    v_mfma_f32_16x16x32_bf16 v[128:131], v[48:51], v[32:35], v[128:131]
    ds_read_b64_tr_b16 v[96:97], v27 offset:26112
    ds_read_b64_tr_b16 v[98:99], v27 offset:27136
    v_mfma_f32_16x16x32_bf16 v[160:163], v[48:51], v[36:39], v[160:163]
    s_add_u32 s36, s45, 1920
    v_mfma_f32_16x16x32_bf16 v[192:195], v[48:51], v[40:43], v[192:195]
    s_add_u32 m0, s42, 69632
    ds_read_b128 v[80:83], v24 offset:0
    ds_read_b128 v[84:87], v24 offset:2048
    v_mfma_f32_16x16x32_bf16 v[224:227], v[48:51], v[44:47], v[224:227]
    buffer_load_dwordx4 v17, s[24:27], s36 offen offset:0 lds
    v_mfma_f32_16x16x32_bf16 v[132:135], v[52:55], v[32:35], v[132:135]
    ds_read_b128 v[88:91], v24 offset:4096
    ds_read_b128 v[92:95], v24 offset:6144
    v_mfma_f32_16x16x32_bf16 v[164:167], v[52:55], v[36:39], v[164:167]
    v_mfma_f32_16x16x32_bf16 v[196:199], v[52:55], v[40:43], v[196:199]
    ds_read_b64_tr_b16 v[100:101], v28 offset:26112
    ds_read_b64_tr_b16 v[102:103], v28 offset:27136
    v_mfma_f32_16x16x32_bf16 v[228:231], v[52:55], v[44:47], v[228:231]
    buffer_load_dwordx4 v18, s[24:27], s36 offen offset:1024 lds
    v_mfma_f32_16x16x32_bf16 v[136:139], v[56:59], v[32:35], v[136:139]
    ds_read_b64_tr_b16 v[104:105], v29 offset:26112
    ds_read_b64_tr_b16 v[106:107], v29 offset:27136
    v_mfma_f32_16x16x32_bf16 v[168:171], v[56:59], v[36:39], v[168:171]
    v_mfma_f32_16x16x32_bf16 v[200:203], v[56:59], v[40:43], v[200:203]
    ds_read_b64_tr_b16 v[108:109], v30 offset:26112
    ds_read_b64_tr_b16 v[110:111], v30 offset:27136
    v_mfma_f32_16x16x32_bf16 v[232:235], v[56:59], v[44:47], v[232:235]
    v_mfma_f32_16x16x32_bf16 v[140:143], v[60:63], v[32:35], v[140:143]
    ds_read_b64_tr_b16 v[112:113], v27 offset:26240
    ds_read_b64_tr_b16 v[114:115], v27 offset:27264
    v_mfma_f32_16x16x32_bf16 v[172:175], v[60:63], v[36:39], v[172:175]
    v_mfma_f32_16x16x32_bf16 v[204:207], v[60:63], v[40:43], v[204:207]
    ds_read_b64_tr_b16 v[116:117], v28 offset:26240
    ds_read_b64_tr_b16 v[118:119], v28 offset:27264
    v_mfma_f32_16x16x32_bf16 v[236:239], v[60:63], v[44:47], v[236:239]
    buffer_load_dwordx4 v19, s[24:27], s36 offen offset:2048 lds
    v_mfma_f32_16x16x32_bf16 v[144:147], v[64:67], v[32:35], v[144:147]
    ds_read_b64_tr_b16 v[120:121], v29 offset:26240
    ds_read_b64_tr_b16 v[122:123], v29 offset:27264
    v_mfma_f32_16x16x32_bf16 v[176:179], v[64:67], v[36:39], v[176:179]
    v_mfma_f32_16x16x32_bf16 v[208:211], v[64:67], v[40:43], v[208:211]
    ds_read_b64_tr_b16 v[124:125], v30 offset:26240
    ds_read_b64_tr_b16 v[126:127], v30 offset:27264
    v_mfma_f32_16x16x32_bf16 v[240:243], v[64:67], v[44:47], v[240:243]
    v_mfma_f32_16x16x32_bf16 v[148:151], v[68:71], v[32:35], v[148:151]
    v_mfma_f32_16x16x32_bf16 v[180:183], v[68:71], v[36:39], v[180:183]
    buffer_load_dwordx4 v20, s[24:27], s36 offen offset:3072 lds
    v_mfma_f32_16x16x32_bf16 v[212:215], v[68:71], v[40:43], v[212:215]
    s_add_u32 s37, s49, 8126464
    v_mfma_f32_16x16x32_bf16 v[244:247], v[68:71], v[44:47], v[244:247]
    s_add_u32 m0, s50, 8704
    v_mfma_f32_16x16x32_bf16 v[152:155], v[72:75], v[32:35], v[152:155]
    buffer_load_dwordx4 v21, s[20:23], s37 offen offset:0 lds
    v_mfma_f32_16x16x32_bf16 v[184:187], v[72:75], v[36:39], v[184:187]
    v_mfma_f32_16x16x32_bf16 v[216:219], v[72:75], v[40:43], v[216:219]
    v_mfma_f32_16x16x32_bf16 v[248:251], v[72:75], v[44:47], v[248:251]
    v_mfma_f32_16x16x32_bf16 v[156:159], v[76:79], v[32:35], v[156:159]
    v_mfma_f32_16x16x32_bf16 v[188:191], v[76:79], v[36:39], v[188:191]
    v_mfma_f32_16x16x32_bf16 v[220:223], v[76:79], v[40:43], v[220:223]
    buffer_load_dwordx4 v22, s[20:23], s37 offen offset:1024 lds
    v_mfma_f32_16x16x32_bf16 v[252:255], v[76:79], v[44:47], v[252:255]
    s_waitcnt vmcnt(12) lgkmcnt(0)
    s_barrier
    v_mfma_f32_16x16x32_bf16 v[128:131], v[96:99], v[80:83], v[128:131]
    s_lshl_b32 s36, s33, 20
    ds_read_b64_tr_b16 v[48:49], v27 offset:34816
    ds_read_b64_tr_b16 v[50:51], v27 offset:35840
    v_mfma_f32_16x16x32_bf16 v[160:163], v[96:99], v[84:87], v[160:163]
    s_add_u32 s12, s94, s36
    s_addc_u32 s13, s95, 0
    v_mfma_f32_16x16x32_bf16 v[192:195], v[96:99], v[88:91], v[192:195]
    s_lshl_b32 s36, s34, 16
    ds_read_b128 v[32:35], v23 offset:32768
    ds_read_b128 v[36:39], v23 offset:34816
    v_mfma_f32_16x16x32_bf16 v[224:227], v[96:99], v[92:95], v[224:227]
    v_mfma_f32_16x16x32_bf16 v[132:135], v[100:103], v[80:83], v[132:135]
    s_sub_u32 s14, 1048576, s36
    ds_read_b128 v[40:43], v23 offset:36864
    ds_read_b128 v[44:47], v23 offset:38912
    v_mfma_f32_16x16x32_bf16 v[164:167], v[100:103], v[84:87], v[164:167]
    s_lshl_b32 s59, s32, 12
    v_mfma_f32_16x16x32_bf16 v[196:199], v[100:103], v[88:91], v[196:199]
    s_lshl_b32 s36, s34, 1
    ds_read_b64_tr_b16 v[52:53], v28 offset:34816
    ds_read_b64_tr_b16 v[54:55], v28 offset:35840
    v_mfma_f32_16x16x32_bf16 v[228:231], v[100:103], v[92:95], v[228:231]
    v_mfma_f32_16x16x32_bf16 v[136:139], v[104:107], v[80:83], v[136:139]
    s_add_u32 s36, s36, 3
    ds_read_b64_tr_b16 v[56:57], v29 offset:34816
    ds_read_b64_tr_b16 v[58:59], v29 offset:35840
    v_mfma_f32_16x16x32_bf16 v[168:171], v[104:107], v[84:87], v[168:171]
    s_mul_i32 s37, s36, 52
    v_mfma_f32_16x16x32_bf16 v[200:203], v[104:107], v[88:91], v[200:203]
    s_lshr_b32 s37, s37, 8
    ds_read_b64_tr_b16 v[60:61], v30 offset:34816
    ds_read_b64_tr_b16 v[62:63], v30 offset:35840
    v_mfma_f32_16x16x32_bf16 v[232:235], v[104:107], v[92:95], v[232:235]
    v_mfma_f32_16x16x32_bf16 v[140:143], v[108:111], v[80:83], v[140:143]
    s_mul_i32 s37, s37, 5
    ds_read_b64_tr_b16 v[64:65], v27 offset:34944
    ds_read_b64_tr_b16 v[66:67], v27 offset:35968
    v_mfma_f32_16x16x32_bf16 v[172:175], v[108:111], v[84:87], v[172:175]
    s_sub_u32 s36, s36, s37
    v_mfma_f32_16x16x32_bf16 v[204:207], v[108:111], v[88:91], v[204:207]
    s_lshl_b32 s47, s36, 15
    ds_read_b64_tr_b16 v[68:69], v28 offset:34944
    ds_read_b64_tr_b16 v[70:71], v28 offset:35968
    v_mfma_f32_16x16x32_bf16 v[236:239], v[108:111], v[92:95], v[236:239]
    v_mfma_f32_16x16x32_bf16 v[144:147], v[112:115], v[80:83], v[144:147]
    s_add_u32 s48, s47, 32768
    ds_read_b64_tr_b16 v[72:73], v29 offset:34944
    ds_read_b64_tr_b16 v[74:75], v29 offset:35968
    v_mfma_f32_16x16x32_bf16 v[176:179], v[112:115], v[84:87], v[176:179]
    s_cmp_eq_u32 s48, 163840
    s_cselect_b32 s48, 0, s48
    v_mfma_f32_16x16x32_bf16 v[208:211], v[112:115], v[88:91], v[208:211]
    s_add_u32 s51, s48, 32768
    ds_read_b64_tr_b16 v[76:77], v30 offset:34944
    ds_read_b64_tr_b16 v[78:79], v30 offset:35968
    v_mfma_f32_16x16x32_bf16 v[240:243], v[112:115], v[92:95], v[240:243]
    s_cmp_eq_u32 s51, 163840
    s_cselect_b32 s51, 0, s51
    v_mfma_f32_16x16x32_bf16 v[148:151], v[116:119], v[80:83], v[148:151]
    s_add_u32 s52, s51, 32768
    v_mfma_f32_16x16x32_bf16 v[180:183], v[116:119], v[84:87], v[180:183]
    v_mfma_f32_16x16x32_bf16 v[212:215], v[116:119], v[88:91], v[212:215]
    s_cmp_eq_u32 s52, 163840
    s_cselect_b32 s52, 0, s52
    v_mfma_f32_16x16x32_bf16 v[244:247], v[116:119], v[92:95], v[244:247]
    s_add_u32 s53, s52, 32768
    v_mfma_f32_16x16x32_bf16 v[152:155], v[120:123], v[80:83], v[152:155]
    v_mfma_f32_16x16x32_bf16 v[184:187], v[120:123], v[84:87], v[184:187]
    s_cmp_eq_u32 s53, 163840
    s_cselect_b32 s53, 0, s53
    v_mfma_f32_16x16x32_bf16 v[216:219], v[120:123], v[88:91], v[216:219]
    v_mfma_f32_16x16x32_bf16 v[248:251], v[120:123], v[92:95], v[248:251]
    v_mfma_f32_16x16x32_bf16 v[156:159], v[124:127], v[80:83], v[156:159]
    v_mfma_f32_16x16x32_bf16 v[188:191], v[124:127], v[84:87], v[188:191]
    v_mfma_f32_16x16x32_bf16 v[220:223], v[124:127], v[88:91], v[220:223]
    v_mfma_f32_16x16x32_bf16 v[252:255], v[124:127], v[92:95], v[252:255]
    s_waitcnt lgkmcnt(0)
    v_mfma_f32_16x16x32_bf16 v[128:131], v[48:51], v[32:35], v[128:131]
    ds_read_b64_tr_b16 v[96:97], v27 offset:43520
    ds_read_b64_tr_b16 v[98:99], v27 offset:44544
    v_mfma_f32_16x16x32_bf16 v[160:163], v[48:51], v[36:39], v[160:163]
    v_mfma_f32_16x16x32_bf16 v[192:195], v[48:51], v[40:43], v[192:195]
    ds_read_b128 v[80:83], v24 offset:32768
    ds_read_b128 v[84:87], v24 offset:34816
    v_mfma_f32_16x16x32_bf16 v[224:227], v[48:51], v[44:47], v[224:227]
    v_mfma_f32_16x16x32_bf16 v[132:135], v[52:55], v[32:35], v[132:135]
    ds_read_b128 v[88:91], v24 offset:36864
    ds_read_b128 v[92:95], v24 offset:38912
    v_mfma_f32_16x16x32_bf16 v[164:167], v[52:55], v[36:39], v[164:167]
    v_mfma_f32_16x16x32_bf16 v[196:199], v[52:55], v[40:43], v[196:199]
    ds_read_b64_tr_b16 v[100:101], v28 offset:43520
    ds_read_b64_tr_b16 v[102:103], v28 offset:44544
    v_mfma_f32_16x16x32_bf16 v[228:231], v[52:55], v[44:47], v[228:231]
    v_mfma_f32_16x16x32_bf16 v[136:139], v[56:59], v[32:35], v[136:139]
    ds_read_b64_tr_b16 v[104:105], v29 offset:43520
    ds_read_b64_tr_b16 v[106:107], v29 offset:44544
    v_mfma_f32_16x16x32_bf16 v[168:171], v[56:59], v[36:39], v[168:171]
    v_mfma_f32_16x16x32_bf16 v[200:203], v[56:59], v[40:43], v[200:203]
    ds_read_b64_tr_b16 v[108:109], v30 offset:43520
    ds_read_b64_tr_b16 v[110:111], v30 offset:44544
    v_mfma_f32_16x16x32_bf16 v[232:235], v[56:59], v[44:47], v[232:235]
    v_mfma_f32_16x16x32_bf16 v[140:143], v[60:63], v[32:35], v[140:143]
    ds_read_b64_tr_b16 v[112:113], v27 offset:43648
    ds_read_b64_tr_b16 v[114:115], v27 offset:44672
    v_mfma_f32_16x16x32_bf16 v[172:175], v[60:63], v[36:39], v[172:175]
    v_mfma_f32_16x16x32_bf16 v[204:207], v[60:63], v[40:43], v[204:207]
    ds_read_b64_tr_b16 v[116:117], v28 offset:43648
    ds_read_b64_tr_b16 v[118:119], v28 offset:44672
    v_mfma_f32_16x16x32_bf16 v[236:239], v[60:63], v[44:47], v[236:239]
    v_mfma_f32_16x16x32_bf16 v[144:147], v[64:67], v[32:35], v[144:147]
    ds_read_b64_tr_b16 v[120:121], v29 offset:43648
    ds_read_b64_tr_b16 v[122:123], v29 offset:44672
    v_mfma_f32_16x16x32_bf16 v[176:179], v[64:67], v[36:39], v[176:179]
    v_mfma_f32_16x16x32_bf16 v[208:211], v[64:67], v[40:43], v[208:211]
    ds_read_b64_tr_b16 v[124:125], v30 offset:43648
    ds_read_b64_tr_b16 v[126:127], v30 offset:44672
    v_mfma_f32_16x16x32_bf16 v[240:243], v[64:67], v[44:47], v[240:243]
    v_mfma_f32_16x16x32_bf16 v[148:151], v[68:71], v[32:35], v[148:151]
    v_mfma_f32_16x16x32_bf16 v[180:183], v[68:71], v[36:39], v[180:183]
    v_mfma_f32_16x16x32_bf16 v[212:215], v[68:71], v[40:43], v[212:215]
    v_mfma_f32_16x16x32_bf16 v[244:247], v[68:71], v[44:47], v[244:247]
    v_mfma_f32_16x16x32_bf16 v[152:155], v[72:75], v[32:35], v[152:155]
    v_mfma_f32_16x16x32_bf16 v[184:187], v[72:75], v[36:39], v[184:187]
    v_mfma_f32_16x16x32_bf16 v[216:219], v[72:75], v[40:43], v[216:219]
    v_mfma_f32_16x16x32_bf16 v[248:251], v[72:75], v[44:47], v[248:251]
    v_mfma_f32_16x16x32_bf16 v[156:159], v[76:79], v[32:35], v[156:159]
    v_mfma_f32_16x16x32_bf16 v[188:191], v[76:79], v[36:39], v[188:191]
    v_mfma_f32_16x16x32_bf16 v[220:223], v[76:79], v[40:43], v[220:223]
    v_mfma_f32_16x16x32_bf16 v[252:255], v[76:79], v[44:47], v[252:255]
    s_waitcnt vmcnt(0) lgkmcnt(0)
    s_barrier
    v_mfma_f32_16x16x32_bf16 v[128:131], v[96:99], v[80:83], v[128:131]
    ds_read_b64_tr_b16 v[48:49], v27 offset:0
    ds_read_b64_tr_b16 v[50:51], v27 offset:1024
    v_mfma_f32_16x16x32_bf16 v[160:163], v[96:99], v[84:87], v[160:163]
    v_mfma_f32_16x16x32_bf16 v[192:195], v[96:99], v[88:91], v[192:195]
    ds_read_b128 v[32:35], v25 offset:0
    ds_read_b128 v[36:39], v25 offset:2048
    v_mfma_f32_16x16x32_bf16 v[224:227], v[96:99], v[92:95], v[224:227]
    v_mfma_f32_16x16x32_bf16 v[132:135], v[100:103], v[80:83], v[132:135]
    ds_read_b128 v[40:43], v25 offset:4096
    ds_read_b128 v[44:47], v25 offset:6144
    v_mfma_f32_16x16x32_bf16 v[164:167], v[100:103], v[84:87], v[164:167]
    v_mfma_f32_16x16x32_bf16 v[196:199], v[100:103], v[88:91], v[196:199]
    ds_read_b64_tr_b16 v[52:53], v28 offset:0
    ds_read_b64_tr_b16 v[54:55], v28 offset:1024
    v_mfma_f32_16x16x32_bf16 v[228:231], v[100:103], v[92:95], v[228:231]
    v_mfma_f32_16x16x32_bf16 v[136:139], v[104:107], v[80:83], v[136:139]
    ds_read_b64_tr_b16 v[56:57], v29 offset:0
    ds_read_b64_tr_b16 v[58:59], v29 offset:1024
    v_mfma_f32_16x16x32_bf16 v[168:171], v[104:107], v[84:87], v[168:171]
    v_mfma_f32_16x16x32_bf16 v[200:203], v[104:107], v[88:91], v[200:203]
    ds_read_b64_tr_b16 v[60:61], v30 offset:0
    ds_read_b64_tr_b16 v[62:63], v30 offset:1024
    v_mfma_f32_16x16x32_bf16 v[232:235], v[104:107], v[92:95], v[232:235]
    v_mfma_f32_16x16x32_bf16 v[140:143], v[108:111], v[80:83], v[140:143]
    ds_read_b64_tr_b16 v[64:65], v27 offset:128
    ds_read_b64_tr_b16 v[66:67], v27 offset:1152
    v_mfma_f32_16x16x32_bf16 v[172:175], v[108:111], v[84:87], v[172:175]
    v_mfma_f32_16x16x32_bf16 v[204:207], v[108:111], v[88:91], v[204:207]
    ds_read_b64_tr_b16 v[68:69], v28 offset:128
    ds_read_b64_tr_b16 v[70:71], v28 offset:1152
    v_mfma_f32_16x16x32_bf16 v[236:239], v[108:111], v[92:95], v[236:239]
    v_mfma_f32_16x16x32_bf16 v[144:147], v[112:115], v[80:83], v[144:147]
    ds_read_b64_tr_b16 v[72:73], v29 offset:128
    ds_read_b64_tr_b16 v[74:75], v29 offset:1152
    v_mfma_f32_16x16x32_bf16 v[176:179], v[112:115], v[84:87], v[176:179]
    v_mfma_f32_16x16x32_bf16 v[208:211], v[112:115], v[88:91], v[208:211]
    ds_read_b64_tr_b16 v[76:77], v30 offset:128
    ds_read_b64_tr_b16 v[78:79], v30 offset:1152
    v_mfma_f32_16x16x32_bf16 v[240:243], v[112:115], v[92:95], v[240:243]
    v_mfma_f32_16x16x32_bf16 v[148:151], v[116:119], v[80:83], v[148:151]
    v_mfma_f32_16x16x32_bf16 v[180:183], v[116:119], v[84:87], v[180:183]
    v_mfma_f32_16x16x32_bf16 v[212:215], v[116:119], v[88:91], v[212:215]
    v_mfma_f32_16x16x32_bf16 v[244:247], v[116:119], v[92:95], v[244:247]
    v_mfma_f32_16x16x32_bf16 v[152:155], v[120:123], v[80:83], v[152:155]
    v_mfma_f32_16x16x32_bf16 v[184:187], v[120:123], v[84:87], v[184:187]
    v_mfma_f32_16x16x32_bf16 v[216:219], v[120:123], v[88:91], v[216:219]
    v_mfma_f32_16x16x32_bf16 v[248:251], v[120:123], v[92:95], v[248:251]
    v_mfma_f32_16x16x32_bf16 v[156:159], v[124:127], v[80:83], v[156:159]
    v_mfma_f32_16x16x32_bf16 v[188:191], v[124:127], v[84:87], v[188:191]
    v_mfma_f32_16x16x32_bf16 v[220:223], v[124:127], v[88:91], v[220:223]
    v_mfma_f32_16x16x32_bf16 v[252:255], v[124:127], v[92:95], v[252:255]
    s_waitcnt lgkmcnt(0)
    v_mfma_f32_16x16x32_bf16 v[128:131], v[48:51], v[32:35], v[128:131]
    ds_read_b64_tr_b16 v[96:97], v27 offset:8704
    ds_read_b64_tr_b16 v[98:99], v27 offset:9728
    v_mfma_f32_16x16x32_bf16 v[160:163], v[48:51], v[36:39], v[160:163]
    v_mfma_f32_16x16x32_bf16 v[192:195], v[48:51], v[40:43], v[192:195]
    ds_read_b128 v[80:83], v26 offset:0
    ds_read_b128 v[84:87], v26 offset:2048
    v_mfma_f32_16x16x32_bf16 v[224:227], v[48:51], v[44:47], v[224:227]
    buffer_load_dword v2, v3, s[16:19], s40 offen sc1
    v_mfma_f32_16x16x32_bf16 v[132:135], v[52:55], v[32:35], v[132:135]
    ds_read_b128 v[88:91], v26 offset:4096
    ds_read_b128 v[92:95], v26 offset:6144
    v_mfma_f32_16x16x32_bf16 v[164:167], v[52:55], v[36:39], v[164:167]
    v_mfma_f32_16x16x32_bf16 v[196:199], v[52:55], v[40:43], v[196:199]
    ds_read_b64_tr_b16 v[100:101], v28 offset:8704
    ds_read_b64_tr_b16 v[102:103], v28 offset:9728
    v_mfma_f32_16x16x32_bf16 v[228:231], v[52:55], v[44:47], v[228:231]
    v_mfma_f32_16x16x32_bf16 v[136:139], v[56:59], v[32:35], v[136:139]
    ds_read_b64_tr_b16 v[104:105], v29 offset:8704
    ds_read_b64_tr_b16 v[106:107], v29 offset:9728
    v_mfma_f32_16x16x32_bf16 v[168:171], v[56:59], v[36:39], v[168:171]
    v_mfma_f32_16x16x32_bf16 v[200:203], v[56:59], v[40:43], v[200:203]
    ds_read_b64_tr_b16 v[108:109], v30 offset:8704
    ds_read_b64_tr_b16 v[110:111], v30 offset:9728
    v_mfma_f32_16x16x32_bf16 v[232:235], v[56:59], v[44:47], v[232:235]
    v_mfma_f32_16x16x32_bf16 v[140:143], v[60:63], v[32:35], v[140:143]
    ds_read_b64_tr_b16 v[112:113], v27 offset:8832
    ds_read_b64_tr_b16 v[114:115], v27 offset:9856
    v_mfma_f32_16x16x32_bf16 v[172:175], v[60:63], v[36:39], v[172:175]
    v_mfma_f32_16x16x32_bf16 v[204:207], v[60:63], v[40:43], v[204:207]
    ds_read_b64_tr_b16 v[116:117], v28 offset:8832
    ds_read_b64_tr_b16 v[118:119], v28 offset:9856
    v_mfma_f32_16x16x32_bf16 v[236:239], v[60:63], v[44:47], v[236:239]
    v_mfma_f32_16x16x32_bf16 v[144:147], v[64:67], v[32:35], v[144:147]
    ds_read_b64_tr_b16 v[120:121], v29 offset:8832
    ds_read_b64_tr_b16 v[122:123], v29 offset:9856
    v_mfma_f32_16x16x32_bf16 v[176:179], v[64:67], v[36:39], v[176:179]
    v_mfma_f32_16x16x32_bf16 v[208:211], v[64:67], v[40:43], v[208:211]
    ds_read_b64_tr_b16 v[124:125], v30 offset:8832
    ds_read_b64_tr_b16 v[126:127], v30 offset:9856
    v_mfma_f32_16x16x32_bf16 v[240:243], v[64:67], v[44:47], v[240:243]
    v_mfma_f32_16x16x32_bf16 v[148:151], v[68:71], v[32:35], v[148:151]
    v_mfma_f32_16x16x32_bf16 v[180:183], v[68:71], v[36:39], v[180:183]
    v_mfma_f32_16x16x32_bf16 v[212:215], v[68:71], v[40:43], v[212:215]
    v_mfma_f32_16x16x32_bf16 v[244:247], v[68:71], v[44:47], v[244:247]
    v_mfma_f32_16x16x32_bf16 v[152:155], v[72:75], v[32:35], v[152:155]
    v_mfma_f32_16x16x32_bf16 v[184:187], v[72:75], v[36:39], v[184:187]
    v_mfma_f32_16x16x32_bf16 v[216:219], v[72:75], v[40:43], v[216:219]
    v_mfma_f32_16x16x32_bf16 v[248:251], v[72:75], v[44:47], v[248:251]
    v_mfma_f32_16x16x32_bf16 v[156:159], v[76:79], v[32:35], v[156:159]
    v_mfma_f32_16x16x32_bf16 v[188:191], v[76:79], v[36:39], v[188:191]
    v_mfma_f32_16x16x32_bf16 v[220:223], v[76:79], v[40:43], v[220:223]
    v_mfma_f32_16x16x32_bf16 v[252:255], v[76:79], v[44:47], v[252:255]
    s_waitcnt vmcnt(0) lgkmcnt(0)
    s_barrier
    v_cmp_gt_u32 vcc, 8, v2
    v_mfma_f32_16x16x32_bf16 v[128:131], v[96:99], v[80:83], v[128:131]
    s_nop 0
    s_cbranch_vccnz gated_mix__ssm_conv_h3__compressed_kv_cla__prompt_kernel_spin_kv
gated_mix__ssm_conv_h3__compressed_kv_cla__prompt_kernel_spin_kv_ret:
    v_mfma_f32_16x16x32_bf16 v[160:163], v[96:99], v[84:87], v[160:163]
    s_add_u32 s36, s59, 0
    v_mfma_f32_16x16x32_bf16 v[192:195], v[96:99], v[88:91], v[192:195]
    s_add_u32 s37, s59, s47
    s_mov_b32 m0, s37
    v_mfma_f32_16x16x32_bf16 v[224:227], v[96:99], v[92:95], v[224:227]
    buffer_load_dwordx4 v16, s[12:15], s36 offen offset:0 sc1 lds
    v_mfma_f32_16x16x32_bf16 v[132:135], v[100:103], v[80:83], v[132:135]
    v_mfma_f32_16x16x32_bf16 v[164:167], v[100:103], v[84:87], v[164:167]
    v_mfma_f32_16x16x32_bf16 v[196:199], v[100:103], v[88:91], v[196:199]
    v_mfma_f32_16x16x32_bf16 v[228:231], v[100:103], v[92:95], v[228:231]
    buffer_load_dwordx4 v16, s[12:15], s36 offen offset:1024 sc1 lds
    v_mfma_f32_16x16x32_bf16 v[136:139], v[104:107], v[80:83], v[136:139]
    v_mfma_f32_16x16x32_bf16 v[168:171], v[104:107], v[84:87], v[168:171]
    v_mfma_f32_16x16x32_bf16 v[200:203], v[104:107], v[88:91], v[200:203]
    v_mfma_f32_16x16x32_bf16 v[232:235], v[104:107], v[92:95], v[232:235]
    buffer_load_dwordx4 v16, s[12:15], s36 offen offset:2048 sc1 lds
    v_mfma_f32_16x16x32_bf16 v[140:143], v[108:111], v[80:83], v[140:143]
    v_mfma_f32_16x16x32_bf16 v[172:175], v[108:111], v[84:87], v[172:175]
    v_mfma_f32_16x16x32_bf16 v[204:207], v[108:111], v[88:91], v[204:207]
    v_mfma_f32_16x16x32_bf16 v[236:239], v[108:111], v[92:95], v[236:239]
    buffer_load_dwordx4 v16, s[12:15], s36 offen offset:3072 sc1 lds
    v_mfma_f32_16x16x32_bf16 v[144:147], v[112:115], v[80:83], v[144:147]
    v_mfma_f32_16x16x32_bf16 v[176:179], v[112:115], v[84:87], v[176:179]
    v_mfma_f32_16x16x32_bf16 v[208:211], v[112:115], v[88:91], v[208:211]
    v_mfma_f32_16x16x32_bf16 v[240:243], v[112:115], v[92:95], v[240:243]
    s_add_u32 s36, s59, 16384
    v_mfma_f32_16x16x32_bf16 v[148:151], v[116:119], v[80:83], v[148:151]
    s_add_u32 s37, s59, s47
    s_add_u32 m0, s37, 16384
    v_mfma_f32_16x16x32_bf16 v[180:183], v[116:119], v[84:87], v[180:183]
    buffer_load_dwordx4 v16, s[12:15], s36 offen offset:0 sc1 lds
    v_mfma_f32_16x16x32_bf16 v[212:215], v[116:119], v[88:91], v[212:215]
    v_mfma_f32_16x16x32_bf16 v[244:247], v[116:119], v[92:95], v[244:247]
    v_mfma_f32_16x16x32_bf16 v[152:155], v[120:123], v[80:83], v[152:155]
    buffer_load_dwordx4 v16, s[12:15], s36 offen offset:1024 sc1 lds
    v_mfma_f32_16x16x32_bf16 v[184:187], v[120:123], v[84:87], v[184:187]
    v_mfma_f32_16x16x32_bf16 v[216:219], v[120:123], v[88:91], v[216:219]
    v_mfma_f32_16x16x32_bf16 v[248:251], v[120:123], v[92:95], v[248:251]
    buffer_load_dwordx4 v16, s[12:15], s36 offen offset:2048 sc1 lds
    v_mfma_f32_16x16x32_bf16 v[156:159], v[124:127], v[80:83], v[156:159]
    v_mfma_f32_16x16x32_bf16 v[188:191], v[124:127], v[84:87], v[188:191]
    v_mfma_f32_16x16x32_bf16 v[220:223], v[124:127], v[88:91], v[220:223]
    buffer_load_dwordx4 v16, s[12:15], s36 offen offset:3072 sc1 lds
    v_mfma_f32_16x16x32_bf16 v[252:255], v[124:127], v[92:95], v[252:255]
    s_add_u32 s36, s59, 32768
    s_add_u32 s37, s59, s48
    s_mov_b32 m0, s37
    s_nop 0
    buffer_load_dwordx4 v16, s[12:15], s36 offen offset:0 sc1 lds
    buffer_load_dwordx4 v16, s[12:15], s36 offen offset:1024 sc1 lds
    buffer_load_dwordx4 v16, s[12:15], s36 offen offset:2048 sc1 lds
    buffer_load_dwordx4 v16, s[12:15], s36 offen offset:3072 sc1 lds
    v_cvt_pk_bf16_f32 v80, v128, v129
    v_cvt_pk_bf16_f32 v81, v130, v131
    v_cvt_pk_bf16_f32 v82, v132, v133
    v_cvt_pk_bf16_f32 v83, v134, v135
    v_cvt_pk_bf16_f32 v84, v136, v137
    v_cvt_pk_bf16_f32 v85, v138, v139
    v_cvt_pk_bf16_f32 v86, v140, v141
    v_cvt_pk_bf16_f32 v87, v142, v143
    v_cvt_pk_bf16_f32 v88, v144, v145
    v_cvt_pk_bf16_f32 v89, v146, v147
    v_cvt_pk_bf16_f32 v90, v148, v149
    v_cvt_pk_bf16_f32 v91, v150, v151
    v_cvt_pk_bf16_f32 v92, v152, v153
    v_cvt_pk_bf16_f32 v93, v154, v155
    v_cvt_pk_bf16_f32 v94, v156, v157
    v_cvt_pk_bf16_f32 v95, v158, v159
    s_add_u32 s36, s59, 49152
    s_add_u32 s37, s59, s48
    s_add_u32 m0, s37, 16384
    s_nop 0
    buffer_load_dwordx4 v16, s[12:15], s36 offen offset:0 sc1 lds
    buffer_load_dwordx4 v16, s[12:15], s36 offen offset:1024 sc1 lds
    buffer_load_dwordx4 v16, s[12:15], s36 offen offset:2048 sc1 lds
    buffer_load_dwordx4 v16, s[12:15], s36 offen offset:3072 sc1 lds
    v_cvt_pk_bf16_f32 v96, v160, v161
    v_cvt_pk_bf16_f32 v97, v162, v163
    v_cvt_pk_bf16_f32 v98, v164, v165
    v_cvt_pk_bf16_f32 v99, v166, v167
    v_cvt_pk_bf16_f32 v100, v168, v169
    v_cvt_pk_bf16_f32 v101, v170, v171
    v_cvt_pk_bf16_f32 v102, v172, v173
    v_cvt_pk_bf16_f32 v103, v174, v175
    v_cvt_pk_bf16_f32 v104, v176, v177
    v_cvt_pk_bf16_f32 v105, v178, v179
    v_cvt_pk_bf16_f32 v106, v180, v181
    v_cvt_pk_bf16_f32 v107, v182, v183
    v_cvt_pk_bf16_f32 v108, v184, v185
    v_cvt_pk_bf16_f32 v109, v186, v187
    v_cvt_pk_bf16_f32 v110, v188, v189
    v_cvt_pk_bf16_f32 v111, v190, v191
    v_cvt_pk_bf16_f32 v112, v192, v193
    v_cvt_pk_bf16_f32 v113, v194, v195
    v_cvt_pk_bf16_f32 v114, v196, v197
    v_cvt_pk_bf16_f32 v115, v198, v199
    v_cvt_pk_bf16_f32 v116, v200, v201
    v_cvt_pk_bf16_f32 v117, v202, v203
    v_cvt_pk_bf16_f32 v118, v204, v205
    v_cvt_pk_bf16_f32 v119, v206, v207
    v_cvt_pk_bf16_f32 v120, v208, v209
    v_cvt_pk_bf16_f32 v121, v210, v211
    v_cvt_pk_bf16_f32 v122, v212, v213
    v_cvt_pk_bf16_f32 v123, v214, v215
    v_cvt_pk_bf16_f32 v124, v216, v217
    v_cvt_pk_bf16_f32 v125, v218, v219
    v_cvt_pk_bf16_f32 v126, v220, v221
    v_cvt_pk_bf16_f32 v127, v222, v223
    v_cvt_pk_bf16_f32 v128, v224, v225
    v_cvt_pk_bf16_f32 v129, v226, v227
    v_cvt_pk_bf16_f32 v130, v228, v229
    v_cvt_pk_bf16_f32 v131, v230, v231
    v_cvt_pk_bf16_f32 v132, v232, v233
    v_cvt_pk_bf16_f32 v133, v234, v235
    v_cvt_pk_bf16_f32 v134, v236, v237
    v_cvt_pk_bf16_f32 v135, v238, v239
    v_cvt_pk_bf16_f32 v136, v240, v241
    v_cvt_pk_bf16_f32 v137, v242, v243
    v_cvt_pk_bf16_f32 v138, v244, v245
    v_cvt_pk_bf16_f32 v139, v246, v247
    v_cvt_pk_bf16_f32 v140, v248, v249
    v_cvt_pk_bf16_f32 v141, v250, v251
    v_cvt_pk_bf16_f32 v142, v252, v253
    v_cvt_pk_bf16_f32 v143, v254, v255
    v_add_u32 v2, s47, v16
    v_mov_b32 v3, v2
    s_waitcnt vmcnt(8)
    s_barrier
    ds_read_b128 a[128:131], v2 offset:0
    ds_read_b128 a[132:135], v2 offset:1024
    ds_read_b128 a[136:139], v2 offset:2048
    ds_read_b128 a[140:143], v2 offset:3072
    ds_read_b128 a[144:147], v2 offset:4096
    ds_read_b128 a[148:151], v2 offset:5120
    ds_read_b128 a[152:155], v2 offset:6144
    ds_read_b128 a[156:159], v2 offset:7168
    s_add_u32 s36, s59, 65536
    s_add_u32 s37, s59, s51
    s_mov_b32 m0, s37
    s_nop 0
    buffer_load_dwordx4 v16, s[12:15], s36 offen offset:0 sc1 lds
    buffer_load_dwordx4 v16, s[12:15], s36 offen offset:1024 sc1 lds
    buffer_load_dwordx4 v16, s[12:15], s36 offen offset:2048 sc1 lds
    buffer_load_dwordx4 v16, s[12:15], s36 offen offset:3072 sc1 lds
    s_add_u32 s38, s59, 131072
    s_mov_b32 s42, 0x40004000
    s_mov_b32 s39, s47
    s_mov_b32 s45, s48
    s_add_u32 s40, s59, s53
    s_add_u32 s41, s40, 16384
    s_mov_b32 s44, 32768
    s_movk_i32 s49, 16384
    s_movk_i32 s50, 16384
    s_mov_b32 s20, s92
    s_mov_b32 s21, s93
    s_mov_b32 s22, 256
    s_add_u32 s16, s94, 33554432
    s_addc_u32 s17, s95, 0
    s_mov_b32 s18, 16777216
    s_mov_b32 s8, s86
    s_mov_b32 s9, s87
    s_mov_b32 s10, 8388608
    s_mov_b32 s4, s72
    s_mov_b32 s5, s73
    s_mov_b32 s6, 4194304
    s_lshl_b32 s54, s2, 2
    s_add_u32 s54, s54, s32
    s_sub_u32 s46, s54, 512
    s_lshl_b32 s46, s46, 11
    s_cmp_lt_u32 s34, 4
    s_cselect_b32 s46, 0x80000000, s46
    s_lshl_b32 s54, s54, 12
    v_lshlrev_b32 v31, 3, v16
    v_cmp_gt_u32 vcc, 256, v16
    v_mov_b32 v15, 0x80000000
    s_nop 0
    v_cndmask_b32 v31, v15, v31, vcc
    v_bfe_u32 v40, v16, 4, 4
    v_lshrrev_b32 v41, 8, v16
    v_sub_u32 v40, v40, v41
    v_lshl_add_u32 v40, v40, 2, s32
    v_mov_b32 v41, 0xff000000
    v_cmp_gt_i32 vcc, 0, v40
    v_cmp_gt_i32 s[36:37], 1, v40
    s_nop 0
    v_cndmask_b32 v48, 0, v41, vcc
    v_cndmask_b32 v49, 0, v41, s[36:37]
    v_cmp_gt_i32 vcc, 2, v40
    v_cmp_gt_i32 s[36:37], 3, v40
    s_nop 0
    v_cndmask_b32 v50, 0, v41, vcc
    v_cndmask_b32 v51, 0, v41, s[36:37]
    v_cmp_gt_i32 vcc, 16, v40
    v_cmp_gt_i32 s[36:37], 17, v40
    s_nop 0
    v_cndmask_b32 v52, 0, v41, vcc
    v_cndmask_b32 v53, 0, v41, s[36:37]
    v_cmp_gt_i32 vcc, 18, v40
    v_cmp_gt_i32 s[36:37], 19, v40
    s_nop 0
    v_cndmask_b32 v54, 0, v41, vcc
    v_cndmask_b32 v55, 0, v41, s[36:37]
    v_cmp_gt_i32 vcc, 32, v40
    v_cmp_gt_i32 s[36:37], 33, v40
    s_nop 0
    v_cndmask_b32 v56, 0, v41, vcc
    v_cndmask_b32 v57, 0, v41, s[36:37]
    v_cmp_gt_i32 vcc, 34, v40
    v_cmp_gt_i32 s[36:37], 35, v40
    s_nop 0
    v_cndmask_b32 v58, 0, v41, vcc
    v_cndmask_b32 v59, 0, v41, s[36:37]
    v_cmp_gt_i32 vcc, 48, v40
    v_cmp_gt_i32 s[36:37], 49, v40
    s_nop 0
    v_cndmask_b32 v60, 0, v41, vcc
    v_cndmask_b32 v61, 0, v41, s[36:37]
    v_cmp_gt_i32 vcc, 50, v40
    v_cmp_gt_i32 s[36:37], 51, v40
    s_nop 0
    v_cndmask_b32 v62, 0, v41, vcc
    v_cndmask_b32 v63, 0, v41, s[36:37]
    v_mov_b32 v240, 0
    v_mov_b32 v241, 0
    v_mov_b32 v242, 0
    v_mov_b32 v243, 0
    v_mov_b32 v244, 0
    v_mov_b32 v245, 0
    v_mov_b32 v246, 0
    v_mov_b32 v247, 0
    v_mov_b32 v248, 0
    v_mov_b32 v249, 0
    v_mov_b32 v250, 0
    v_mov_b32 v251, 0
    v_mov_b32 v252, 0
    v_mov_b32 v253, 0
    v_mov_b32 v254, 0
    v_mov_b32 v255, 0
    v_mov_b32 v24, 0x3f803f80
    v_mov_b32 v25, 0x3f803f80
    v_mov_b32 v26, 0x3f803f80
    v_mov_b32 v27, 0x3f803f80
    s_waitcnt lgkmcnt(7)
    v_mfma_f32_16x16x32_bf16 v[144:147], a[128:131], v[80:83], 0
    v_mfma_f32_16x16x32_bf16 v[152:155], a[128:131], v[96:99], 0
    s_add_u32 s36, s59, 81920
    s_add_u32 s37, s59, s51
    s_add_u32 m0, s37, 16384
    s_nop 0
    buffer_load_dwordx4 v16, s[12:15], s36 offen offset:0 sc1 lds
    v_mfma_f32_16x16x32_bf16 v[160:163], a[128:131], v[112:115], 0
    v_mfma_f32_16x16x32_bf16 v[168:171], a[128:131], v[128:131], 0
    s_waitcnt lgkmcnt(6)
    buffer_load_dwordx4 v16, s[12:15], s36 offen offset:1024 sc1 lds
    v_mfma_f32_16x16x32_bf16 v[144:147], a[132:135], v[84:87], v[144:147]
    v_mfma_f32_16x16x32_bf16 v[152:155], a[132:135], v[100:103], v[152:155]
    buffer_load_dwordx4 v16, s[12:15], s36 offen offset:2048 sc1 lds
    v_mfma_f32_16x16x32_bf16 v[160:163], a[132:135], v[116:119], v[160:163]
    v_mfma_f32_16x16x32_bf16 v[168:171], a[132:135], v[132:135], v[168:171]
    s_waitcnt lgkmcnt(5)
    buffer_load_dwordx4 v16, s[12:15], s36 offen offset:3072 sc1 lds
    v_mfma_f32_16x16x32_bf16 v[144:147], a[136:139], v[88:91], v[144:147]
    v_mfma_f32_16x16x32_bf16 v[152:155], a[136:139], v[104:107], v[152:155]
    s_add_u32 s36, s59, 98304
    s_add_u32 s37, s59, s52
    s_mov_b32 m0, s37
    s_nop 0
    buffer_load_dwordx4 v16, s[12:15], s36 offen offset:0 sc1 lds
    v_mfma_f32_16x16x32_bf16 v[160:163], a[136:139], v[120:123], v[160:163]
    v_mfma_f32_16x16x32_bf16 v[168:171], a[136:139], v[136:139], v[168:171]
    s_waitcnt lgkmcnt(4)
    buffer_load_dwordx4 v16, s[12:15], s36 offen offset:1024 sc1 lds
    v_mfma_f32_16x16x32_bf16 v[144:147], a[140:143], v[92:95], v[144:147]
    v_mfma_f32_16x16x32_bf16 v[152:155], a[140:143], v[108:111], v[152:155]
    buffer_load_dwordx4 v16, s[12:15], s36 offen offset:2048 sc1 lds
    v_mfma_f32_16x16x32_bf16 v[160:163], a[140:143], v[124:127], v[160:163]
    v_mfma_f32_16x16x32_bf16 v[168:171], a[140:143], v[140:143], v[168:171]
    s_waitcnt lgkmcnt(3)
    buffer_load_dwordx4 v16, s[12:15], s36 offen offset:3072 sc1 lds
    v_mfma_f32_16x16x32_bf16 v[148:151], a[144:147], v[80:83], 0
    v_mfma_f32_16x16x32_bf16 v[156:159], a[144:147], v[96:99], 0
    s_add_u32 s36, s59, 114688
    s_add_u32 s37, s59, s52
    s_add_u32 m0, s37, 16384
    s_nop 0
    buffer_load_dwordx4 v16, s[12:15], s36 offen offset:0 sc1 lds
    v_mfma_f32_16x16x32_bf16 v[164:167], a[144:147], v[112:115], 0
    v_mfma_f32_16x16x32_bf16 v[172:175], a[144:147], v[128:131], 0
    s_waitcnt lgkmcnt(2)
    buffer_load_dwordx4 v16, s[12:15], s36 offen offset:1024 sc1 lds
    v_mfma_f32_16x16x32_bf16 v[148:151], a[148:151], v[84:87], v[148:151]
    v_mfma_f32_16x16x32_bf16 v[156:159], a[148:151], v[100:103], v[156:159]
    buffer_load_dwordx4 v16, s[12:15], s36 offen offset:2048 sc1 lds
    v_mfma_f32_16x16x32_bf16 v[164:167], a[148:151], v[116:119], v[164:167]
    v_mfma_f32_16x16x32_bf16 v[172:175], a[148:151], v[132:135], v[172:175]
    s_waitcnt lgkmcnt(1)
    buffer_load_dwordx4 v16, s[12:15], s36 offen offset:3072 sc1 lds
    v_mfma_f32_16x16x32_bf16 v[148:151], a[152:155], v[88:91], v[148:151]
    v_mfma_f32_16x16x32_bf16 v[156:159], a[152:155], v[104:107], v[156:159]
    v_bfe_u32 v18, v16, 1, 8
    v_lshlrev_b32 v15, 3, v16
    buffer_load_dword v17, v18, s[20:23], 0 offen sc1
    v_mfma_f32_16x16x32_bf16 v[164:167], a[152:155], v[120:123], v[164:167]
    v_mfma_f32_16x16x32_bf16 v[172:175], a[152:155], v[136:139], v[172:175]
    s_waitcnt lgkmcnt(0)
    buffer_load_dword a200, v15, s[4:7], s54 offen
    v_mfma_f32_16x16x32_bf16 v[148:151], a[156:159], v[92:95], v[148:151]
    v_mfma_f32_16x16x32_bf16 v[156:159], a[156:159], v[108:111], v[156:159]
    v_mfma_f32_16x16x32_bf16 v[164:167], a[156:159], v[124:127], v[164:167]
    v_mfma_f32_16x16x32_bf16 v[172:175], a[156:159], v[140:143], v[172:175]
    ds_read_b128 a[128:131], v2 offset:16384
    ds_read_b128 a[132:135], v2 offset:17408
    ds_read_b128 a[136:139], v2 offset:18432
    ds_read_b128 a[140:143], v2 offset:19456
    ds_read_b128 a[144:147], v2 offset:20480
    ds_read_b128 a[148:151], v2 offset:21504
    ds_read_b128 a[152:155], v2 offset:22528
    ds_read_b128 a[156:159], v2 offset:23552
    s_cmp_lg_u32 s34, 0
    s_nop 3
    s_cbranch_scc1 gated_mix__ssm_conv_h3__compressed_kv_cla__prompt_kernel_nomask0
    v_add_f32 v144, v48, v144
    v_add_f32 v145, v49, v145
    v_add_f32 v146, v50, v146
    v_add_f32 v147, v51, v147
    v_add_f32 v148, v52, v148
    v_add_f32 v149, v53, v149
    v_add_f32 v150, v54, v150
    v_add_f32 v151, v55, v151
gated_mix__ssm_conv_h3__compressed_kv_cla__prompt_kernel_nomask0:
    v_max3_f32 v32, v144, v145, v146
    v_max3_f32 v32, v147, v148, v32
    v_max3_f32 v32, v149, v150, v32
    v_max_f32 v32, v151, v32
    v_max3_f32 v34, v152, v153, v154
    v_max3_f32 v34, v155, v156, v34
    v_max3_f32 v34, v157, v158, v34
    v_max_f32 v34, v159, v34
    v_max3_f32 v36, v160, v161, v162
    v_max3_f32 v36, v163, v164, v36
    v_max3_f32 v36, v165, v166, v36
    v_max_f32 v36, v167, v36
    v_max3_f32 v38, v168, v169, v170
    v_max3_f32 v38, v171, v172, v38
    v_max3_f32 v38, v173, v174, v38
    v_max_f32 v38, v175, v38
    v_mov_b32 v33, v32
    v_mov_b32 v35, v34
    v_mov_b32 v37, v36
    v_mov_b32 v39, v38
    v_permlane16_swap_b32 v32, v33
    v_permlane16_swap_b32 v34, v35
    v_permlane16_swap_b32 v36, v37
    v_permlane16_swap_b32 v38, v39
    v_max_f32 v32, v32, v33
    v_max_f32 v34, v34, v35
    v_max_f32 v36, v36, v37
    v_max_f32 v38, v38, v39
    v_mov_b32 v33, v32
    v_mov_b32 v35, v34
    v_mov_b32 v37, v36
    v_mov_b32 v39, v38
    v_permlane32_swap_b32 v32, v33
    v_permlane32_swap_b32 v34, v35
    v_permlane32_swap_b32 v36, v37
    v_permlane32_swap_b32 v38, v39
    v_max_f32 v32, v32, v33
    v_max_f32 v34, v34, v35
    v_max_f32 v36, v36, v37
    v_max_f32 v38, v38, v39
    v_add_f32 v32, 0x41c00000, v32
    v_sub_f32 v64, 0, v32
    v_sub_f32 v65, 0, v32
    v_sub_f32 v66, 0, v32
    v_sub_f32 v67, 0, v32
    v_sub_f32 v144, v144, v32
    v_sub_f32 v145, v145, v32
    v_sub_f32 v146, v146, v32
    v_sub_f32 v147, v147, v32
    v_sub_f32 v148, v148, v32
    v_sub_f32 v149, v149, v32
    v_sub_f32 v150, v150, v32
    v_sub_f32 v151, v151, v32
    v_add_f32 v34, 0x41c00000, v34
    v_sub_f32 v68, 0, v34
    v_sub_f32 v69, 0, v34
    v_sub_f32 v70, 0, v34
    v_sub_f32 v71, 0, v34
    v_sub_f32 v152, v152, v34
    v_sub_f32 v153, v153, v34
    v_sub_f32 v154, v154, v34
    v_sub_f32 v155, v155, v34
    v_sub_f32 v156, v156, v34
    v_sub_f32 v157, v157, v34
    v_sub_f32 v158, v158, v34
    v_sub_f32 v159, v159, v34
    v_add_f32 v36, 0x41c00000, v36
    v_sub_f32 v72, 0, v36
    v_sub_f32 v73, 0, v36
    v_sub_f32 v74, 0, v36
    v_sub_f32 v75, 0, v36
    v_sub_f32 v160, v160, v36
    v_sub_f32 v161, v161, v36
    v_sub_f32 v162, v162, v36
    v_sub_f32 v163, v163, v36
    v_sub_f32 v164, v164, v36
    v_sub_f32 v165, v165, v36
    v_sub_f32 v166, v166, v36
    v_sub_f32 v167, v167, v36
    v_add_f32 v38, 0x41c00000, v38
    v_sub_f32 v76, 0, v38
    v_sub_f32 v77, 0, v38
    v_sub_f32 v78, 0, v38
    v_sub_f32 v79, 0, v38
    v_sub_f32 v168, v168, v38
    v_sub_f32 v169, v169, v38
    v_sub_f32 v170, v170, v38
    v_sub_f32 v171, v171, v38
    v_sub_f32 v172, v172, v38
    v_sub_f32 v173, v173, v38
    v_sub_f32 v174, v174, v38
    v_sub_f32 v175, v175, v38
    v_exp_f32 v4, v168
    v_exp_f32 v5, v169
    s_nop 0
    v_cvt_pk_bf16_f32 v220, v4, v5
    v_exp_f32 v6, v170
    v_exp_f32 v7, v171
    s_nop 0
    v_cvt_pk_bf16_f32 v221, v6, v7
    v_or_b32 v12, v220, v221
    v_exp_f32 v8, v172
    v_exp_f32 v9, v173
    s_nop 0
    v_cvt_pk_bf16_f32 v222, v8, v9
    v_exp_f32 v10, v174
    v_exp_f32 v11, v175
    s_nop 0
    v_cvt_pk_bf16_f32 v223, v10, v11
    v_or3_b32 v12, v12, v222, v223
    v_exp_f32 v4, v160
    v_exp_f32 v5, v161
    s_nop 0
    v_cvt_pk_bf16_f32 v216, v4, v5
    v_exp_f32 v6, v162
    v_exp_f32 v7, v163
    s_nop 0
    v_cvt_pk_bf16_f32 v217, v6, v7
    v_or3_b32 v12, v12, v216, v217
    v_exp_f32 v8, v164
    v_exp_f32 v9, v165
    s_nop 0
    v_cvt_pk_bf16_f32 v218, v8, v9
    v_exp_f32 v10, v166
    v_exp_f32 v11, v167
    s_nop 0
    v_cvt_pk_bf16_f32 v219, v10, v11
    v_or3_b32 v12, v12, v218, v219
    v_add_u32 v2, s45, v16
    s_waitcnt vmcnt(18) lgkmcnt(0)
    s_barrier
    s_lshl_b32 s35, s34, 1
    s_add_u32 s35, s35, 1
    s_min_u32 s58, s35, 14
    s_cmp_eq_u32 s34, 7
    s_cselect_b32 s58, s58, s35
.p2align 6
gated_mix__ssm_conv_h3__compressed_kv_cla__prompt_kernel_b4_loop:
    v_mfma_f32_16x16x32_bf16 v[176:179], a[128:131], v[80:83], v[64:67]
    s_cmp_eq_u32 s35, 1
    ds_read_b128 a[160:163], v3 offset:8192
    ds_read_b128 a[164:167], v3 offset:9216
    v_mfma_f32_16x16x32_bf16 v[184:187], a[128:131], v[96:99], v[68:71]
    s_cbranch_scc1 gated_mix__ssm_conv_h3__compressed_kv_cla__prompt_kernel_b4_m0
gated_mix__ssm_conv_h3__compressed_kv_cla__prompt_kernel_b4_m0_ret:
    ds_read_b128 a[168:171], v3 offset:10240
    ds_read_b128 a[172:175], v3 offset:11264
    v_mfma_f32_16x16x32_bf16 v[192:195], a[128:131], v[112:115], v[72:75]
    ds_read_b128 a[176:179], v3 offset:12288
    ds_read_b128 a[180:183], v3 offset:13312
    v_mfma_f32_16x16x32_bf16 v[200:203], a[128:131], v[128:131], v[76:79]
    s_waitcnt vmcnt(18)
    s_barrier
    ds_read_b128 a[184:187], v3 offset:14336
    v_mfma_f32_16x16x32_bf16 v[176:179], a[132:135], v[84:87], v[176:179]
    s_mov_b32 m0, s40
    v_exp_f32 v4, v152
    v_mfma_f32_16x16x32_bf16 v[184:187], a[132:135], v[100:103], v[184:187]
    s_add_u32 s43, s38, s49
    v_exp_f32 v5, v153
    v_mfma_f32_16x16x32_bf16 v[192:195], a[132:135], v[116:119], v[192:195]
    v_exp_f32 v6, v154
    v_mfma_f32_16x16x32_bf16 v[200:203], a[132:135], v[132:135], v[200:203]
    ds_read_b128 a[188:191], v3 offset:15360
    v_cvt_pk_bf16_f32 v212, v4, v5
    v_mfma_f32_16x16x32_bf16 v[176:179], a[136:139], v[88:91], v[176:179]
    v_exp_f32 v7, v155
    v_mfma_f32_16x16x32_bf16 v[184:187], a[136:139], v[104:107], v[184:187]
    v_exp_f32 v8, v156
    v_mfma_f32_16x16x32_bf16 v[192:195], a[136:139], v[120:123], v[192:195]
    ds_read_b128 a[128:131], v2 offset:0
    v_cvt_pk_bf16_f32 v213, v6, v7
    v_mfma_f32_16x16x32_bf16 v[200:203], a[136:139], v[136:139], v[200:203]
    ds_read_b128 a[132:135], v2 offset:1024
    v_or3_b32 v12, v12, v212, v213
    v_mfma_f32_16x16x32_bf16 v[176:179], a[140:143], v[92:95], v[176:179]
    v_exp_f32 v9, v157
    v_mfma_f32_16x16x32_bf16 v[184:187], a[140:143], v[108:111], v[184:187]
    v_exp_f32 v10, v158
    v_mfma_f32_16x16x32_bf16 v[192:195], a[140:143], v[124:127], v[192:195]
    v_exp_f32 v11, v159
    v_mfma_f32_16x16x32_bf16 v[200:203], a[140:143], v[140:143], v[200:203]
    s_waitcnt lgkmcnt(10)
    ds_read_b128 a[136:139], v2 offset:2048
    v_cvt_pk_bf16_f32 v214, v8, v9
    v_mfma_f32_16x16x32_bf16 v[180:183], a[144:147], v[80:83], v[64:67]
    v_exp_f32 v4, v144
    v_mfma_f32_16x16x32_bf16 v[188:191], a[144:147], v[96:99], v[68:71]
    v_exp_f32 v5, v145
    v_mfma_f32_16x16x32_bf16 v[196:199], a[144:147], v[112:115], v[72:75]
    v_exp_f32 v6, v146
    v_mfma_f32_16x16x32_bf16 v[204:207], a[144:147], v[128:131], v[76:79]
    v_exp_f32 v7, v147
    v_mfma_f32_16x16x32_bf16 v[180:183], a[148:151], v[84:87], v[180:183]
    buffer_load_dword a200, v31, s[8:11], s46 offen
    v_mfma_f32_16x16x32_bf16 v[188:191], a[148:151], v[100:103], v[188:191]
    v_exp_f32 v8, v148
    v_mfma_f32_16x16x32_bf16 v[196:199], a[148:151], v[116:119], v[196:199]
    v_exp_f32 v9, v149
    v_mfma_f32_16x16x32_bf16 v[204:207], a[148:151], v[132:135], v[204:207]
    v_cvt_pk_bf16_f32 v215, v10, v11
    v_or3_b32 v12, v12, v214, v215
    v_mfma_f32_16x16x32_bf16 v[180:183], a[152:155], v[88:91], v[180:183]
    v_exp_f32 v10, v150
    v_mfma_f32_16x16x32_bf16 v[188:191], a[152:155], v[104:107], v[188:191]
    v_exp_f32 v11, v151
    v_mfma_f32_16x16x32_bf16 v[196:199], a[152:155], v[120:123], v[196:199]
    v_cvt_pk_bf16_f32 v208, v4, v5
    v_cvt_pk_bf16_f32 v209, v6, v7
    v_mfma_f32_16x16x32_bf16 v[204:207], a[152:155], v[136:139], v[204:207]
    v_or3_b32 v12, v12, v208, v209
    v_cvt_pk_bf16_f32 v210, v8, v9
    v_mfma_f32_16x16x32_bf16 v[180:183], a[156:159], v[92:95], v[180:183]
    v_cvt_pk_bf16_f32 v211, v10, v11
    v_or3_b32 v12, v12, v210, v211
    v_mfma_f32_16x16x32_bf16 v[188:191], a[156:159], v[108:111], v[188:191]
    v_and_b32 v12, s42, v12
    v_cmp_ne_u32 vcc, 0, v12
    v_mfma_f32_16x16x32_bf16 v[196:199], a[156:159], v[124:127], v[196:199]
    s_waitcnt lgkmcnt(7)
    ds_read_b128 a[140:143], v2 offset:3072
    v_mfma_f32_16x16x32_bf16 v[204:207], a[156:159], v[140:143], v[204:207]
    s_cbranch_vccnz gated_mix__ssm_conv_h3__compressed_kv_cla__prompt_kernel_b4_r0
gated_mix__ssm_conv_h3__compressed_kv_cla__prompt_kernel_b4_r0_ret:
    ds_read_b128 a[144:147], v2 offset:4096
    v_mfma_f32_16x16x32_bf16 a[0:3], a[160:163], v[208:211], a[0:3]
    ds_read_b128 a[148:151], v2 offset:5120
    v_mfma_f32_16x16x32_bf16 a[32:35], a[160:163], v[212:215], a[32:35]
    ds_read_b128 a[152:155], v2 offset:6144
    v_mfma_f32_16x16x32_bf16 a[64:67], a[160:163], v[216:219], a[64:67]
    buffer_load_dwordx4 v16, s[12:15], s38 offen offset:0 sc1 lds
    v_mfma_f32_16x16x32_bf16 a[96:99], a[160:163], v[220:223], a[96:99]
    s_cmp_eq_u32 s35, 1
    ds_read_b128 a[156:159], v2 offset:7168
    v_mfma_f32_16x16x32_bf16 a[4:7], a[164:167], v[208:211], a[4:7]
    s_cbranch_scc1 gated_mix__ssm_conv_h3__compressed_kv_cla__prompt_kernel_b4_m1
gated_mix__ssm_conv_h3__compressed_kv_cla__prompt_kernel_b4_m1_ret:
    v_mfma_f32_16x16x32_bf16 a[36:39], a[164:167], v[212:215], a[36:39]
    v_mfma_f32_16x16x32_bf16 a[68:71], a[164:167], v[216:219], a[68:71]
    ds_read_b128 a[160:163], v3 offset:24576
    v_mfma_f32_16x16x32_bf16 a[100:103], a[164:167], v[220:223], a[100:103]
    ds_read_b128 a[164:167], v3 offset:25600
    v_mfma_f32_16x16x32_bf16 a[8:11], a[168:171], v[208:211], a[8:11]
    v_mfma_f32_16x16x32_bf16 a[40:43], a[168:171], v[212:215], a[40:43]
    v_mfma_f32_16x16x32_bf16 a[72:75], a[168:171], v[216:219], a[72:75]
    v_exp_f32 v4, v200
    v_mfma_f32_16x16x32_bf16 a[104:107], a[168:171], v[220:223], a[104:107]
    ds_read_b128 a[168:171], v3 offset:26624
    v_mfma_f32_16x16x32_bf16 a[12:15], a[172:175], v[208:211], a[12:15]
    v_exp_f32 v5, v201
    v_mfma_f32_16x16x32_bf16 a[44:47], a[172:175], v[212:215], a[44:47]
    v_exp_f32 v6, v202
    v_mfma_f32_16x16x32_bf16 a[76:79], a[172:175], v[216:219], a[76:79]
    v_exp_f32 v7, v203
    v_mfma_f32_16x16x32_bf16 a[108:111], a[172:175], v[220:223], a[108:111]
    s_waitcnt lgkmcnt(11)
    ds_read_b128 a[172:175], v3 offset:27648
    v_cvt_pk_bf16_f32 v236, v4, v5
    v_mfma_f32_16x16x32_bf16 a[16:19], a[176:179], v[208:211], a[16:19]
    buffer_load_dwordx4 v16, s[12:15], s38 offen offset:1024 sc1 lds
    v_mfma_f32_16x16x32_bf16 a[48:51], a[176:179], v[212:215], a[48:51]
    v_exp_f32 v8, v204
    v_mfma_f32_16x16x32_bf16 a[80:83], a[176:179], v[216:219], a[80:83]
    v_exp_f32 v9, v205
    v_mfma_f32_16x16x32_bf16 a[112:115], a[176:179], v[220:223], a[112:115]
    ds_read_b128 a[176:179], v3 offset:28672
    v_cvt_pk_bf16_f32 v237, v6, v7
    v_mfma_f32_16x16x32_bf16 a[20:23], a[180:183], v[208:211], a[20:23]
    v_exp_f32 v10, v206
    v_mfma_f32_16x16x32_bf16 a[52:55], a[180:183], v[212:215], a[52:55]
    v_exp_f32 v11, v207
    v_mfma_f32_16x16x32_bf16 a[84:87], a[180:183], v[216:219], a[84:87]
    v_exp_f32 v4, v192
    v_mfma_f32_16x16x32_bf16 a[116:119], a[180:183], v[220:223], a[116:119]
    ds_read_b128 a[180:183], v3 offset:29696
    v_or_b32 v12, v236, v237
    v_mfma_f32_16x16x32_bf16 a[24:27], a[184:187], v[208:211], a[24:27]
    v_exp_f32 v5, v193
    v_mfma_f32_16x16x32_bf16 a[56:59], a[184:187], v[212:215], a[56:59]
    v_exp_f32 v6, v194
    v_mfma_f32_16x16x32_bf16 a[88:91], a[184:187], v[216:219], a[88:91]
    v_exp_f32 v7, v195
    v_mfma_f32_16x16x32_bf16 a[120:123], a[184:187], v[220:223], a[120:123]
    ds_read_b128 a[184:187], v3 offset:30720
    v_cvt_pk_bf16_f32 v238, v8, v9
    v_mfma_f32_16x16x32_bf16 a[28:31], a[188:191], v[208:211], a[28:31]
    v_exp_f32 v8, v196
    v_mfma_f32_16x16x32_bf16 a[60:63], a[188:191], v[212:215], a[60:63]
    v_exp_f32 v9, v197
    v_mfma_f32_16x16x32_bf16 a[92:95], a[188:191], v[216:219], a[92:95]
    buffer_load_dwordx4 v16, s[12:15], s38 offen offset:2048 sc1 lds
    v_mfma_f32_16x16x32_bf16 a[124:127], a[188:191], v[220:223], a[124:127]
    ds_read_b128 a[188:191], v3 offset:31744
    v_cvt_pk_bf16_f32 v239, v10, v11
    v_mfma_f32_16x16x32_bf16 v[240:243], v[24:27], v[208:211], v[240:243]
    v_exp_f32 v10, v198
    v_mfma_f32_16x16x32_bf16 v[244:247], v[24:27], v[212:215], v[244:247]
    v_exp_f32 v11, v199
    v_mfma_f32_16x16x32_bf16 v[248:251], v[24:27], v[216:219], v[248:251]
    v_or3_b32 v12, v12, v238, v239
    v_cvt_pk_bf16_f32 v232, v4, v5
    v_mfma_f32_16x16x32_bf16 v[252:255], v[24:27], v[220:223], v[252:255]
    s_waitcnt lgkmcnt(12)
    v_exp_f32 v4, v184
    v_mfma_f32_16x16x32_bf16 v[144:147], a[128:131], v[80:83], v[64:67]
    v_exp_f32 v5, v185
    v_mfma_f32_16x16x32_bf16 v[152:155], a[128:131], v[96:99], v[68:71]
    v_cvt_pk_bf16_f32 v233, v6, v7
    v_or3_b32 v12, v12, v232, v233
    v_mfma_f32_16x16x32_bf16 v[160:163], a[128:131], v[112:115], v[72:75]
    v_exp_f32 v6, v186
    v_mfma_f32_16x16x32_bf16 v[168:171], a[128:131], v[128:131], v[76:79]
    ds_read_b128 a[128:131], v2 offset:16384
    v_cvt_pk_bf16_f32 v234, v8, v9
    v_mfma_f32_16x16x32_bf16 v[144:147], a[132:135], v[84:87], v[144:147]
    v_exp_f32 v7, v187
    v_mfma_f32_16x16x32_bf16 v[152:155], a[132:135], v[100:103], v[152:155]
    v_exp_f32 v8, v188
    v_mfma_f32_16x16x32_bf16 v[160:163], a[132:135], v[116:119], v[160:163]
    v_exp_f32 v9, v189
    v_mfma_f32_16x16x32_bf16 v[168:171], a[132:135], v[132:135], v[168:171]
    ds_read_b128 a[132:135], v2 offset:17408
    v_cvt_pk_bf16_f32 v235, v10, v11
    v_mfma_f32_16x16x32_bf16 v[144:147], a[136:139], v[88:91], v[144:147]
    v_exp_f32 v10, v190
    v_mfma_f32_16x16x32_bf16 v[152:155], a[136:139], v[104:107], v[152:155]
    buffer_load_dwordx4 v16, s[12:15], s38 offen offset:3072 sc1 lds
    v_mfma_f32_16x16x32_bf16 v[160:163], a[136:139], v[120:123], v[160:163]
    s_mov_b32 m0, s41
    v_exp_f32 v11, v191
    v_mfma_f32_16x16x32_bf16 v[168:171], a[136:139], v[136:139], v[168:171]
    ds_read_b128 a[136:139], v2 offset:18432
    v_or3_b32 v12, v12, v234, v235
    v_mfma_f32_16x16x32_bf16 v[144:147], a[140:143], v[92:95], v[144:147]
    v_cvt_pk_bf16_f32 v228, v4, v5
    v_cvt_pk_bf16_f32 v229, v6, v7
    v_mfma_f32_16x16x32_bf16 v[152:155], a[140:143], v[108:111], v[152:155]
    v_exp_f32 v4, v176
    v_mfma_f32_16x16x32_bf16 v[160:163], a[140:143], v[124:127], v[160:163]
    v_exp_f32 v5, v177
    v_mfma_f32_16x16x32_bf16 v[168:171], a[140:143], v[140:143], v[168:171]
    s_waitcnt lgkmcnt(11)
    ds_read_b128 a[140:143], v2 offset:19456
    v_or3_b32 v12, v12, v228, v229
    v_mfma_f32_16x16x32_bf16 v[148:151], a[144:147], v[80:83], v[64:67]
    v_exp_f32 v6, v178
    v_mfma_f32_16x16x32_bf16 v[156:159], a[144:147], v[96:99], v[68:71]
    v_exp_f32 v7, v179
    v_mfma_f32_16x16x32_bf16 v[164:167], a[144:147], v[112:115], v[72:75]
    v_cvt_pk_bf16_f32 v230, v8, v9
    v_cvt_pk_bf16_f32 v231, v10, v11
    v_mfma_f32_16x16x32_bf16 v[172:175], a[144:147], v[128:131], v[76:79]
    ds_read_b128 a[144:147], v2 offset:20480
    v_or3_b32 v12, v12, v230, v231
    v_mfma_f32_16x16x32_bf16 v[148:151], a[148:151], v[84:87], v[148:151]
    v_exp_f32 v8, v180
    v_mfma_f32_16x16x32_bf16 v[156:159], a[148:151], v[100:103], v[156:159]
    v_exp_f32 v9, v181
    v_mfma_f32_16x16x32_bf16 v[164:167], a[148:151], v[116:119], v[164:167]
    buffer_load_dwordx4 v16, s[12:15], s43 offen offset:0 sc1 lds
    v_mfma_f32_16x16x32_bf16 v[172:175], a[148:151], v[132:135], v[172:175]
    ds_read_b128 a[148:151], v2 offset:21504
    v_cvt_pk_bf16_f32 v224, v4, v5
    v_mfma_f32_16x16x32_bf16 v[148:151], a[152:155], v[88:91], v[148:151]
    v_exp_f32 v10, v182
    v_mfma_f32_16x16x32_bf16 v[156:159], a[152:155], v[104:107], v[156:159]
    v_exp_f32 v11, v183
    v_mfma_f32_16x16x32_bf16 v[164:167], a[152:155], v[120:123], v[164:167]
    v_cvt_pk_bf16_f32 v225, v6, v7
    v_or3_b32 v12, v12, v224, v225
    v_mfma_f32_16x16x32_bf16 v[172:175], a[152:155], v[136:139], v[172:175]
    ds_read_b128 a[152:155], v2 offset:22528
    v_cvt_pk_bf16_f32 v226, v8, v9
    v_mfma_f32_16x16x32_bf16 v[148:151], a[156:159], v[92:95], v[148:151]
    v_cvt_pk_bf16_f32 v227, v10, v11
    v_or3_b32 v12, v12, v226, v227
    v_mfma_f32_16x16x32_bf16 v[156:159], a[156:159], v[108:111], v[156:159]
    v_and_b32 v12, s42, v12
    v_cmp_ne_u32 vcc, 0, v12
    v_mfma_f32_16x16x32_bf16 v[164:167], a[156:159], v[124:127], v[164:167]
    s_waitcnt lgkmcnt(11)
    v_mfma_f32_16x16x32_bf16 v[172:175], a[156:159], v[140:143], v[172:175]
    s_cbranch_vccnz gated_mix__ssm_conv_h3__compressed_kv_cla__prompt_kernel_b4_r1
gated_mix__ssm_conv_h3__compressed_kv_cla__prompt_kernel_b4_r1_ret:
    ds_read_b128 a[156:159], v2 offset:23552
    v_mfma_f32_16x16x32_bf16 a[0:3], a[160:163], v[224:227], a[0:3]
    v_mfma_f32_16x16x32_bf16 a[32:35], a[160:163], v[228:231], a[32:35]
    s_add_u32 s38, s38, s44
    v_mfma_f32_16x16x32_bf16 a[64:67], a[160:163], v[232:235], a[64:67]
    s_add_u32 s40, s39, s59
    v_mfma_f32_16x16x32_bf16 a[96:99], a[160:163], v[236:239], a[96:99]
    s_add_u32 s41, s40, s50
    v_mfma_f32_16x16x32_bf16 a[4:7], a[164:167], v[224:227], a[4:7]
    s_mov_b32 s39, s45
    v_mfma_f32_16x16x32_bf16 a[36:39], a[164:167], v[228:231], a[36:39]
    buffer_load_dwordx4 v16, s[12:15], s43 offen offset:1024 sc1 lds
    v_mfma_f32_16x16x32_bf16 a[68:71], a[164:167], v[232:235], a[68:71]
    s_add_u32 s45, s45, 32768
    v_mfma_f32_16x16x32_bf16 a[100:103], a[164:167], v[236:239], a[100:103]
    s_cmp_eq_u32 s45, 163840
    v_mfma_f32_16x16x32_bf16 a[8:11], a[168:171], v[224:227], a[8:11]
    s_cselect_b32 s45, 0, s45
    v_mfma_f32_16x16x32_bf16 a[40:43], a[168:171], v[228:231], a[40:43]
    s_add_u32 s46, s46, 1048576
    v_mfma_f32_16x16x32_bf16 a[72:75], a[168:171], v[232:235], a[72:75]
    s_sub_u32 s35, s35, 1
    v_mfma_f32_16x16x32_bf16 a[104:107], a[168:171], v[236:239], a[104:107]
    s_sub_u32 s58, s58, 1
    v_exp_f32 v4, v168
    v_mfma_f32_16x16x32_bf16 a[12:15], a[172:175], v[224:227], a[12:15]
    s_cmp_lg_u32 s58, 0
    v_exp_f32 v5, v169
    v_mfma_f32_16x16x32_bf16 a[44:47], a[172:175], v[228:231], a[44:47]
    v_exp_f32 v6, v170
    v_mfma_f32_16x16x32_bf16 a[76:79], a[172:175], v[232:235], a[76:79]
    v_exp_f32 v7, v171
    v_mfma_f32_16x16x32_bf16 a[108:111], a[172:175], v[236:239], a[108:111]
    s_waitcnt lgkmcnt(8)
    v_exp_f32 v8, v172
    v_mfma_f32_16x16x32_bf16 a[16:19], a[176:179], v[224:227], a[16:19]
    v_exp_f32 v9, v173
    v_mfma_f32_16x16x32_bf16 a[48:51], a[176:179], v[228:231], a[48:51]
    v_exp_f32 v10, v174
    v_mfma_f32_16x16x32_bf16 a[80:83], a[176:179], v[232:235], a[80:83]
    v_exp_f32 v11, v175
    v_mfma_f32_16x16x32_bf16 a[112:115], a[176:179], v[236:239], a[112:115]
    buffer_load_dwordx4 v16, s[12:15], s43 offen offset:2048 sc1 lds
    v_mfma_f32_16x16x32_bf16 a[20:23], a[180:183], v[224:227], a[20:23]
    v_cvt_pk_bf16_f32 v220, v4, v5
    v_cvt_pk_bf16_f32 v221, v6, v7
    v_mfma_f32_16x16x32_bf16 a[52:55], a[180:183], v[228:231], a[52:55]
    v_exp_f32 v4, v160
    v_mfma_f32_16x16x32_bf16 a[84:87], a[180:183], v[232:235], a[84:87]
    v_exp_f32 v5, v161
    v_mfma_f32_16x16x32_bf16 a[116:119], a[180:183], v[236:239], a[116:119]
    v_exp_f32 v6, v162
    v_mfma_f32_16x16x32_bf16 a[24:27], a[184:187], v[224:227], a[24:27]
    v_exp_f32 v7, v163
    v_mfma_f32_16x16x32_bf16 a[56:59], a[184:187], v[228:231], a[56:59]
    v_or_b32 v12, v220, v221
    v_cvt_pk_bf16_f32 v222, v8, v9
    v_mfma_f32_16x16x32_bf16 a[88:91], a[184:187], v[232:235], a[88:91]
    v_exp_f32 v8, v164
    v_mfma_f32_16x16x32_bf16 a[120:123], a[184:187], v[236:239], a[120:123]
    v_exp_f32 v9, v165
    v_mfma_f32_16x16x32_bf16 a[28:31], a[188:191], v[224:227], a[28:31]
    v_cvt_pk_bf16_f32 v223, v10, v11
    v_or3_b32 v12, v12, v222, v223
    v_mfma_f32_16x16x32_bf16 a[60:63], a[188:191], v[228:231], a[60:63]
    v_exp_f32 v10, v166
    v_mfma_f32_16x16x32_bf16 a[92:95], a[188:191], v[232:235], a[92:95]
    v_exp_f32 v11, v167
    v_mfma_f32_16x16x32_bf16 a[124:127], a[188:191], v[236:239], a[124:127]
    v_cvt_pk_bf16_f32 v216, v4, v5
    v_cvt_pk_bf16_f32 v217, v6, v7
    v_mfma_f32_16x16x32_bf16 v[240:243], v[24:27], v[224:227], v[240:243]
    v_or3_b32 v12, v12, v216, v217
    v_cvt_pk_bf16_f32 v218, v8, v9
    v_mfma_f32_16x16x32_bf16 v[244:247], v[24:27], v[228:231], v[244:247]
    v_cvt_pk_bf16_f32 v219, v10, v11
    v_or3_b32 v12, v12, v218, v219
    v_mfma_f32_16x16x32_bf16 v[248:251], v[24:27], v[232:235], v[248:251]
    buffer_load_dwordx4 v16, s[12:15], s43 offen offset:3072 sc1 lds
    v_mfma_f32_16x16x32_bf16 v[252:255], v[24:27], v[236:239], v[252:255]
    s_waitcnt lgkmcnt(4)
    v_mov_b32 v3, v2
    v_add_u32 v2, s45, v16
    s_cbranch_scc1 gated_mix__ssm_conv_h3__compressed_kv_cla__prompt_kernel_b4_loop
    s_cmp_lg_u32 s35, 0
    s_cbranch_scc1 gated_mix__ssm_conv_h3__compressed_kv_cla__prompt_kernel_b4_sw
    s_add_u32 s24, s94, 67108864
    s_addc_u32 s25, s95, 0
    s_mov_b32 s26, 8388608
    s_lshl_b32 s46, s2, 2
    s_add_u32 s46, s46, s32
    s_lshl_b32 s46, s46, 13
    s_nop 4
    v_accvgpr_read_b32 v36, a0
    v_accvgpr_read_b32 v37, a1
    v_accvgpr_read_b32 v38, a2
    v_accvgpr_read_b32 v39, a3
    v_accvgpr_read_b32 v40, a4
    v_accvgpr_read_b32 v41, a5
    v_accvgpr_read_b32 v42, a6
    v_accvgpr_read_b32 v43, a7
    v_rcp_f32 v32, v240
    s_nop 0
    v_mul_f32 v36, v36, v32
    v_mul_f32 v37, v37, v32
    v_mul_f32 v38, v38, v32
    v_mul_f32 v39, v39, v32
    v_mul_f32 v40, v40, v32
    v_mul_f32 v41, v41, v32
    v_mul_f32 v42, v42, v32
    v_mul_f32 v43, v43, v32
    v_cvt_pk_bf16_f32 v44, v36, v37
    v_cvt_pk_bf16_f32 v45, v38, v39
    v_cvt_pk_bf16_f32 v46, v40, v41
    v_cvt_pk_bf16_f32 v47, v42, v43
    buffer_store_dwordx4 v[44:47], v16, s[16:19], s60 offen offset:0 sc1
    v_accvgpr_read_b32 v36, a8
    v_accvgpr_read_b32 v37, a9
    v_accvgpr_read_b32 v38, a10
    v_accvgpr_read_b32 v39, a11
    v_accvgpr_read_b32 v40, a12
    v_accvgpr_read_b32 v41, a13
    v_accvgpr_read_b32 v42, a14
    v_accvgpr_read_b32 v43, a15
    v_mul_f32 v36, v36, v32
    v_mul_f32 v37, v37, v32
    v_mul_f32 v38, v38, v32
    v_mul_f32 v39, v39, v32
    v_mul_f32 v40, v40, v32
    v_mul_f32 v41, v41, v32
    v_mul_f32 v42, v42, v32
    v_mul_f32 v43, v43, v32
    v_cvt_pk_bf16_f32 v20, v36, v37
    v_cvt_pk_bf16_f32 v21, v38, v39
    v_cvt_pk_bf16_f32 v22, v40, v41
    v_cvt_pk_bf16_f32 v23, v42, v43
    buffer_store_dwordx4 v[20:23], v16, s[16:19], s60 offen offset:1024 sc1
    v_accvgpr_read_b32 v36, a16
    v_accvgpr_read_b32 v37, a17
    v_accvgpr_read_b32 v38, a18
    v_accvgpr_read_b32 v39, a19
    v_accvgpr_read_b32 v40, a20
    v_accvgpr_read_b32 v41, a21
    v_accvgpr_read_b32 v42, a22
    v_accvgpr_read_b32 v43, a23
    v_mul_f32 v36, v36, v32
    v_mul_f32 v37, v37, v32
    v_mul_f32 v38, v38, v32
    v_mul_f32 v39, v39, v32
    v_mul_f32 v40, v40, v32
    v_mul_f32 v41, v41, v32
    v_mul_f32 v42, v42, v32
    v_mul_f32 v43, v43, v32
    v_cvt_pk_bf16_f32 v44, v36, v37
    v_cvt_pk_bf16_f32 v45, v38, v39
    v_cvt_pk_bf16_f32 v46, v40, v41
    v_cvt_pk_bf16_f32 v47, v42, v43
    buffer_store_dwordx4 v[44:47], v16, s[16:19], s60 offen offset:2048 sc1
    v_accvgpr_read_b32 v36, a24
    v_accvgpr_read_b32 v37, a25
    v_accvgpr_read_b32 v38, a26
    v_accvgpr_read_b32 v39, a27
    v_accvgpr_read_b32 v40, a28
    v_accvgpr_read_b32 v41, a29
    v_accvgpr_read_b32 v42, a30
    v_accvgpr_read_b32 v43, a31
    v_mul_f32 v36, v36, v32
    v_mul_f32 v37, v37, v32
    v_mul_f32 v38, v38, v32
    v_mul_f32 v39, v39, v32
    v_mul_f32 v40, v40, v32
    v_mul_f32 v41, v41, v32
    v_mul_f32 v42, v42, v32
    v_mul_f32 v43, v43, v32
    v_cvt_pk_bf16_f32 v20, v36, v37
    v_cvt_pk_bf16_f32 v21, v38, v39
    v_cvt_pk_bf16_f32 v22, v40, v41
    v_cvt_pk_bf16_f32 v23, v42, v43
    buffer_store_dwordx4 v[20:23], v16, s[16:19], s60 offen offset:3072 sc1
    v_mfma_f32_16x16x32_bf16 v[184:187], a[128:131], v[96:99], v[68:71]
    ds_read_b128 a[160:163], v3 offset:8192
    ds_read_b128 a[164:167], v3 offset:9216
    v_mfma_f32_16x16x32_bf16 v[192:195], a[128:131], v[112:115], v[72:75]
    ds_read_b128 a[168:171], v3 offset:10240
    v_mov_b32 v20, -1
    v_mfma_f32_16x16x32_bf16 v[200:203], a[128:131], v[128:131], v[76:79]
    ds_read_b128 a[172:175], v3 offset:11264
    v_mov_b32 v21, -1
    v_mfma_f32_16x16x32_bf16 v[184:187], a[132:135], v[100:103], v[184:187]
    s_waitcnt vmcnt(16)
    s_barrier
    ds_read_b128 a[176:179], v3 offset:12288
    v_mfma_f32_16x16x32_bf16 v[192:195], a[132:135], v[116:119], v[192:195]
    s_mov_b32 m0, s40
    v_mov_b32 v22, -1
    v_mov_b32 v23, -1
    v_mfma_f32_16x16x32_bf16 v[200:203], a[132:135], v[132:135], v[200:203]
    s_add_u32 s43, s38, s49
    v_add_f32 v152, v48, v152
    v_add_f32 v153, v49, v153
    v_mfma_f32_16x16x32_bf16 v[184:187], a[136:139], v[104:107], v[184:187]
    v_add_f32 v154, v50, v154
    v_add_f32 v155, v51, v155
    v_mfma_f32_16x16x32_bf16 v[192:195], a[136:139], v[120:123], v[192:195]
    ds_read_b128 a[180:183], v3 offset:13312
    v_add_f32 v156, v52, v156
    v_mfma_f32_16x16x32_bf16 v[200:203], a[136:139], v[136:139], v[200:203]
    v_add_f32 v157, v53, v157
    v_add_f32 v158, v54, v158
    v_mfma_f32_16x16x32_bf16 v[184:187], a[140:143], v[108:111], v[184:187]
    v_add_f32 v159, v55, v159
    v_exp_f32 v4, v152
    v_mfma_f32_16x16x32_bf16 v[192:195], a[140:143], v[124:127], v[192:195]
    v_exp_f32 v5, v153
    v_mfma_f32_16x16x32_bf16 v[200:203], a[140:143], v[140:143], v[200:203]
    s_waitcnt lgkmcnt(6)
    v_exp_f32 v6, v154
    v_mfma_f32_16x16x32_bf16 v[188:191], a[144:147], v[96:99], v[68:71]
    v_exp_f32 v7, v155
    v_mfma_f32_16x16x32_bf16 v[196:199], a[144:147], v[112:115], v[72:75]
    buffer_store_dwordx4 v[20:23], v16, s[24:27], s46 offen offset:0 sc1
    v_mfma_f32_16x16x32_bf16 v[204:207], a[144:147], v[128:131], v[76:79]
    v_exp_f32 v8, v156
    v_mfma_f32_16x16x32_bf16 v[188:191], a[148:151], v[100:103], v[188:191]
    v_exp_f32 v9, v157
    v_mfma_f32_16x16x32_bf16 v[196:199], a[148:151], v[116:119], v[196:199]
    v_exp_f32 v10, v158
    v_mfma_f32_16x16x32_bf16 v[204:207], a[148:151], v[132:135], v[204:207]
    v_exp_f32 v11, v159
    v_mfma_f32_16x16x32_bf16 v[188:191], a[152:155], v[104:107], v[188:191]
    v_cvt_pk_bf16_f32 v212, v4, v5
    v_cvt_pk_bf16_f32 v213, v6, v7
    v_mfma_f32_16x16x32_bf16 v[196:199], a[152:155], v[120:123], v[196:199]
    v_or3_b32 v12, v12, v212, v213
    v_cvt_pk_bf16_f32 v214, v8, v9
    v_mfma_f32_16x16x32_bf16 v[204:207], a[152:155], v[136:139], v[204:207]
    v_cvt_pk_bf16_f32 v215, v10, v11
    v_or3_b32 v12, v12, v214, v215
    v_mfma_f32_16x16x32_bf16 v[188:191], a[156:159], v[108:111], v[188:191]
    buffer_store_dwordx4 v[20:23], v16, s[24:27], s46 offen offset:1024 sc1
    v_and_b32 v12, s42, v12
    v_cmp_ne_u32 vcc, 0, v12
    v_mfma_f32_16x16x32_bf16 v[196:199], a[156:159], v[124:127], v[196:199]
    s_waitcnt lgkmcnt(2)
    ds_read_b128 a[184:187], v3 offset:14336
    ds_read_b128 a[188:191], v3 offset:15360
    v_mfma_f32_16x16x32_bf16 v[204:207], a[156:159], v[140:143], v[204:207]
    s_cbranch_vccnz gated_mix__ssm_conv_h3__compressed_kv_cla__prompt_kernel_b3_r0
gated_mix__ssm_conv_h3__compressed_kv_cla__prompt_kernel_b3_r0_ret:
    ds_read_b128 a[128:131], v2 offset:0
    ds_read_b128 a[132:135], v2 offset:1024
    v_mfma_f32_16x16x32_bf16 a[32:35], a[160:163], v[212:215], a[32:35]
    ds_read_b128 a[136:139], v2 offset:2048
    ds_read_b128 a[140:143], v2 offset:3072
    v_mfma_f32_16x16x32_bf16 a[64:67], a[160:163], v[216:219], a[64:67]
    ds_read_b128 a[144:147], v2 offset:4096
    ds_read_b128 a[148:151], v2 offset:5120
    v_mfma_f32_16x16x32_bf16 a[96:99], a[160:163], v[220:223], a[96:99]
    v_exp_f32 v4, v200
    v_mfma_f32_16x16x32_bf16 a[36:39], a[164:167], v[212:215], a[36:39]
    ds_read_b128 a[152:155], v2 offset:6144
    ds_read_b128 a[156:159], v2 offset:7168
    v_mfma_f32_16x16x32_bf16 a[68:71], a[164:167], v[216:219], a[68:71]
    v_exp_f32 v5, v201
    v_mfma_f32_16x16x32_bf16 a[100:103], a[164:167], v[220:223], a[100:103]
    buffer_store_dwordx4 v[20:23], v16, s[24:27], s46 offen offset:2048 sc1
    v_mfma_f32_16x16x32_bf16 a[40:43], a[168:171], v[212:215], a[40:43]
    v_exp_f32 v6, v202
    v_mfma_f32_16x16x32_bf16 a[72:75], a[168:171], v[216:219], a[72:75]
    ds_read_b128 a[160:163], v3 offset:24576
    v_cvt_pk_bf16_f32 v236, v4, v5
    v_mfma_f32_16x16x32_bf16 a[104:107], a[168:171], v[220:223], a[104:107]
    v_exp_f32 v7, v203
    v_mfma_f32_16x16x32_bf16 a[44:47], a[172:175], v[212:215], a[44:47]
    v_exp_f32 v8, v204
    v_mfma_f32_16x16x32_bf16 a[76:79], a[172:175], v[216:219], a[76:79]
    ds_read_b128 a[164:167], v3 offset:25600
    v_cvt_pk_bf16_f32 v237, v6, v7
    v_mfma_f32_16x16x32_bf16 a[108:111], a[172:175], v[220:223], a[108:111]
    s_waitcnt lgkmcnt(10)
    ds_read_b128 a[168:171], v3 offset:26624
    v_or_b32 v12, v236, v237
    v_mfma_f32_16x16x32_bf16 a[48:51], a[176:179], v[212:215], a[48:51]
    v_exp_f32 v9, v205
    v_mfma_f32_16x16x32_bf16 a[80:83], a[176:179], v[216:219], a[80:83]
    buffer_store_dwordx4 v[20:23], v16, s[24:27], s46 offen offset:3072 sc1
    v_mfma_f32_16x16x32_bf16 a[112:115], a[176:179], v[220:223], a[112:115]
    v_exp_f32 v10, v206
    v_mfma_f32_16x16x32_bf16 a[52:55], a[180:183], v[212:215], a[52:55]
    ds_read_b128 a[172:175], v3 offset:27648
    v_cvt_pk_bf16_f32 v238, v8, v9
    v_mfma_f32_16x16x32_bf16 a[84:87], a[180:183], v[216:219], a[84:87]
    v_exp_f32 v11, v207
    v_mfma_f32_16x16x32_bf16 a[116:119], a[180:183], v[220:223], a[116:119]
    v_exp_f32 v4, v192
    v_mfma_f32_16x16x32_bf16 a[56:59], a[184:187], v[212:215], a[56:59]
    v_exp_f32 v5, v193
    v_mfma_f32_16x16x32_bf16 a[88:91], a[184:187], v[216:219], a[88:91]
    v_exp_f32 v6, v194
    v_mfma_f32_16x16x32_bf16 a[120:123], a[184:187], v[220:223], a[120:123]
    v_exp_f32 v7, v195
    v_mfma_f32_16x16x32_bf16 a[60:63], a[188:191], v[212:215], a[60:63]
    buffer_load_dwordx4 v16, s[12:15], s38 offen offset:0 sc1 lds
    v_mfma_f32_16x16x32_bf16 a[92:95], a[188:191], v[216:219], a[92:95]
    v_exp_f32 v8, v196
    v_mfma_f32_16x16x32_bf16 a[124:127], a[188:191], v[220:223], a[124:127]
    v_exp_f32 v9, v197
    v_mfma_f32_16x16x32_bf16 v[244:247], v[24:27], v[212:215], v[244:247]
    v_cvt_pk_bf16_f32 v239, v10, v11
    v_or3_b32 v12, v12, v238, v239
    v_mfma_f32_16x16x32_bf16 v[248:251], v[24:27], v[216:219], v[248:251]
    v_exp_f32 v10, v198
    v_mfma_f32_16x16x32_bf16 v[252:255], v[24:27], v[220:223], v[252:255]
    s_waitcnt lgkmcnt(8)
    v_exp_f32 v11, v199
    v_mfma_f32_16x16x32_bf16 v[152:155], a[128:131], v[96:99], v[68:71]
    v_cvt_pk_bf16_f32 v232, v4, v5
    v_cvt_pk_bf16_f32 v233, v6, v7
    v_mfma_f32_16x16x32_bf16 v[160:163], a[128:131], v[112:115], v[72:75]
    v_or3_b32 v12, v12, v232, v233
    v_cvt_pk_bf16_f32 v234, v8, v9
    v_mfma_f32_16x16x32_bf16 v[168:171], a[128:131], v[128:131], v[76:79]
    buffer_load_dwordx4 v16, s[12:15], s38 offen offset:1024 sc1 lds
    v_mfma_f32_16x16x32_bf16 v[152:155], a[132:135], v[100:103], v[152:155]
    v_cvt_pk_bf16_f32 v235, v10, v11
    v_or3_b32 v12, v12, v234, v235
    v_mfma_f32_16x16x32_bf16 v[160:163], a[132:135], v[116:119], v[160:163]
    v_add_f32 v184, v56, v184
    v_add_f32 v185, v57, v185
    v_mfma_f32_16x16x32_bf16 v[168:171], a[132:135], v[132:135], v[168:171]
    v_add_f32 v186, v58, v186
    v_add_f32 v187, v59, v187
    v_mfma_f32_16x16x32_bf16 v[152:155], a[136:139], v[104:107], v[152:155]
    v_add_f32 v188, v60, v188
    v_add_f32 v189, v61, v189
    v_mfma_f32_16x16x32_bf16 v[160:163], a[136:139], v[120:123], v[160:163]
    v_add_f32 v190, v62, v190
    v_add_f32 v191, v63, v191
    v_mfma_f32_16x16x32_bf16 v[168:171], a[136:139], v[136:139], v[168:171]
    v_exp_f32 v4, v184
    v_mfma_f32_16x16x32_bf16 v[152:155], a[140:143], v[108:111], v[152:155]
    buffer_load_dwordx4 v16, s[12:15], s38 offen offset:2048 sc1 lds
    v_mfma_f32_16x16x32_bf16 v[160:163], a[140:143], v[124:127], v[160:163]
    v_exp_f32 v5, v185
    v_mfma_f32_16x16x32_bf16 v[168:171], a[140:143], v[140:143], v[168:171]
    s_waitcnt lgkmcnt(4)
    v_exp_f32 v6, v186
    v_mfma_f32_16x16x32_bf16 v[156:159], a[144:147], v[96:99], v[68:71]
    v_exp_f32 v7, v187
    v_mfma_f32_16x16x32_bf16 v[164:167], a[144:147], v[112:115], v[72:75]
    v_exp_f32 v8, v188
    v_mfma_f32_16x16x32_bf16 v[172:175], a[144:147], v[128:131], v[76:79]
    v_exp_f32 v9, v189
    v_mfma_f32_16x16x32_bf16 v[156:159], a[148:151], v[100:103], v[156:159]
    v_exp_f32 v10, v190
    v_mfma_f32_16x16x32_bf16 v[164:167], a[148:151], v[116:119], v[164:167]
    v_exp_f32 v11, v191
    v_mfma_f32_16x16x32_bf16 v[172:175], a[148:151], v[132:135], v[172:175]
    buffer_load_dwordx4 v16, s[12:15], s38 offen offset:3072 sc1 lds
    v_mfma_f32_16x16x32_bf16 v[156:159], a[152:155], v[104:107], v[156:159]
    s_mov_b32 m0, s41
    v_cvt_pk_bf16_f32 v228, v4, v5
    v_cvt_pk_bf16_f32 v229, v6, v7
    v_mfma_f32_16x16x32_bf16 v[164:167], a[152:155], v[120:123], v[164:167]
    v_or3_b32 v12, v12, v228, v229
    v_cvt_pk_bf16_f32 v230, v8, v9
    v_mfma_f32_16x16x32_bf16 v[172:175], a[152:155], v[136:139], v[172:175]
    v_cvt_pk_bf16_f32 v231, v10, v11
    v_or3_b32 v12, v12, v230, v231
    v_mfma_f32_16x16x32_bf16 v[156:159], a[156:159], v[108:111], v[156:159]
    v_and_b32 v12, s42, v12
    v_cmp_ne_u32 vcc, 0, v12
    v_mfma_f32_16x16x32_bf16 v[164:167], a[156:159], v[124:127], v[164:167]
    s_waitcnt lgkmcnt(0)
    ds_read_b128 a[176:179], v3 offset:28672
    v_mfma_f32_16x16x32_bf16 v[172:175], a[156:159], v[140:143], v[172:175]
    s_cbranch_vccnz gated_mix__ssm_conv_h3__compressed_kv_cla__prompt_kernel_b3_r1
gated_mix__ssm_conv_h3__compressed_kv_cla__prompt_kernel_b3_r1_ret:
    ds_read_b128 a[180:183], v3 offset:29696
    v_mfma_f32_16x16x32_bf16 a[32:35], a[160:163], v[228:231], a[32:35]
    ds_read_b128 a[184:187], v3 offset:30720
    v_mfma_f32_16x16x32_bf16 a[64:67], a[160:163], v[232:235], a[64:67]
    buffer_load_dwordx4 v16, s[12:15], s43 offen offset:0 sc1 lds
    v_mfma_f32_16x16x32_bf16 a[96:99], a[160:163], v[236:239], a[96:99]
    s_add_u32 s38, s38, s44
    ds_read_b128 a[188:191], v3 offset:31744
    v_mfma_f32_16x16x32_bf16 a[36:39], a[164:167], v[228:231], a[36:39]
    s_add_u32 s40, s39, s59
    ds_read_b128 a[128:131], v2 offset:16384
    v_mfma_f32_16x16x32_bf16 a[68:71], a[164:167], v[232:235], a[68:71]
    s_add_u32 s41, s40, s50
    ds_read_b128 a[132:135], v2 offset:17408
    v_mfma_f32_16x16x32_bf16 a[100:103], a[164:167], v[236:239], a[100:103]
    s_mov_b32 s39, s45
    ds_read_b128 a[136:139], v2 offset:18432
    v_mfma_f32_16x16x32_bf16 a[40:43], a[168:171], v[228:231], a[40:43]
    s_add_u32 s45, s45, 32768
    ds_read_b128 a[140:143], v2 offset:19456
    v_mfma_f32_16x16x32_bf16 a[72:75], a[168:171], v[232:235], a[72:75]
    s_cmp_eq_u32 s45, 163840
    ds_read_b128 a[144:147], v2 offset:20480
    v_mfma_f32_16x16x32_bf16 a[104:107], a[168:171], v[236:239], a[104:107]
    s_cselect_b32 s45, 0, s45
    ds_read_b128 a[148:151], v2 offset:21504
    v_mfma_f32_16x16x32_bf16 a[44:47], a[172:175], v[228:231], a[44:47]
    buffer_load_dwordx4 v16, s[12:15], s43 offen offset:1024 sc1 lds
    v_mfma_f32_16x16x32_bf16 a[76:79], a[172:175], v[232:235], a[76:79]
    v_mfma_f32_16x16x32_bf16 a[108:111], a[172:175], v[236:239], a[108:111]
    s_waitcnt lgkmcnt(6)
    ds_read_b128 a[152:155], v2 offset:22528
    v_mfma_f32_16x16x32_bf16 a[48:51], a[176:179], v[228:231], a[48:51]
    ds_read_b128 a[156:159], v2 offset:23552
    v_mfma_f32_16x16x32_bf16 a[80:83], a[176:179], v[232:235], a[80:83]
    v_exp_f32 v4, v168
    v_mfma_f32_16x16x32_bf16 a[112:115], a[176:179], v[236:239], a[112:115]
    v_exp_f32 v5, v169
    v_mfma_f32_16x16x32_bf16 a[52:55], a[180:183], v[228:231], a[52:55]
    v_exp_f32 v6, v170
    v_mfma_f32_16x16x32_bf16 a[84:87], a[180:183], v[232:235], a[84:87]
    v_exp_f32 v7, v171
    v_mfma_f32_16x16x32_bf16 a[116:119], a[180:183], v[236:239], a[116:119]
    buffer_load_dwordx4 v16, s[12:15], s43 offen offset:2048 sc1 lds
    v_mfma_f32_16x16x32_bf16 a[56:59], a[184:187], v[228:231], a[56:59]
    v_exp_f32 v8, v172
    v_mfma_f32_16x16x32_bf16 a[88:91], a[184:187], v[232:235], a[88:91]
    v_exp_f32 v9, v173
    v_mfma_f32_16x16x32_bf16 a[120:123], a[184:187], v[236:239], a[120:123]
    v_exp_f32 v10, v174
    v_mfma_f32_16x16x32_bf16 a[60:63], a[188:191], v[228:231], a[60:63]
    v_exp_f32 v11, v175
    v_mfma_f32_16x16x32_bf16 a[92:95], a[188:191], v[232:235], a[92:95]
    v_cvt_pk_bf16_f32 v220, v4, v5
    v_cvt_pk_bf16_f32 v221, v6, v7
    v_mfma_f32_16x16x32_bf16 a[124:127], a[188:191], v[236:239], a[124:127]
    v_or_b32 v12, v220, v221
    v_cvt_pk_bf16_f32 v222, v8, v9
    v_mfma_f32_16x16x32_bf16 v[244:247], v[24:27], v[228:231], v[244:247]
    v_cvt_pk_bf16_f32 v223, v10, v11
    v_or3_b32 v12, v12, v222, v223
    v_mfma_f32_16x16x32_bf16 v[248:251], v[24:27], v[232:235], v[248:251]
    buffer_load_dwordx4 v16, s[12:15], s43 offen offset:3072 sc1 lds
    v_mfma_f32_16x16x32_bf16 v[252:255], v[24:27], v[236:239], v[252:255]
    s_waitcnt lgkmcnt(4)
    v_mov_b32 v3, v2
    v_add_u32 v2, s45, v16
    s_nop 4
    v_accvgpr_read_b32 v36, a32
    v_accvgpr_read_b32 v37, a33
    v_accvgpr_read_b32 v38, a34
    v_accvgpr_read_b32 v39, a35
    v_accvgpr_read_b32 v40, a36
    v_accvgpr_read_b32 v41, a37
    v_accvgpr_read_b32 v42, a38
    v_accvgpr_read_b32 v43, a39
    v_rcp_f32 v32, v244
    s_nop 0
    v_mul_f32 v36, v36, v32
    v_mul_f32 v37, v37, v32
    v_mul_f32 v38, v38, v32
    v_mul_f32 v39, v39, v32
    v_mul_f32 v40, v40, v32
    v_mul_f32 v41, v41, v32
    v_mul_f32 v42, v42, v32
    v_mul_f32 v43, v43, v32
    v_cvt_pk_bf16_f32 v44, v36, v37
    v_cvt_pk_bf16_f32 v45, v38, v39
    v_cvt_pk_bf16_f32 v46, v40, v41
    v_cvt_pk_bf16_f32 v47, v42, v43
    buffer_store_dwordx4 v[44:47], v16, s[16:19], s61 offen offset:0 sc1
    v_accvgpr_read_b32 v36, a40
    v_accvgpr_read_b32 v37, a41
    v_accvgpr_read_b32 v38, a42
    v_accvgpr_read_b32 v39, a43
    v_accvgpr_read_b32 v40, a44
    v_accvgpr_read_b32 v41, a45
    v_accvgpr_read_b32 v42, a46
    v_accvgpr_read_b32 v43, a47
    v_mul_f32 v36, v36, v32
    v_mul_f32 v37, v37, v32
    v_mul_f32 v38, v38, v32
    v_mul_f32 v39, v39, v32
    v_mul_f32 v40, v40, v32
    v_mul_f32 v41, v41, v32
    v_mul_f32 v42, v42, v32
    v_mul_f32 v43, v43, v32
    v_cvt_pk_bf16_f32 v20, v36, v37
    v_cvt_pk_bf16_f32 v21, v38, v39
    v_cvt_pk_bf16_f32 v22, v40, v41
    v_cvt_pk_bf16_f32 v23, v42, v43
    buffer_store_dwordx4 v[20:23], v16, s[16:19], s61 offen offset:1024 sc1
    v_accvgpr_read_b32 v36, a48
    v_accvgpr_read_b32 v37, a49
    v_accvgpr_read_b32 v38, a50
    v_accvgpr_read_b32 v39, a51
    v_accvgpr_read_b32 v40, a52
    v_accvgpr_read_b32 v41, a53
    v_accvgpr_read_b32 v42, a54
    v_accvgpr_read_b32 v43, a55
    v_mul_f32 v36, v36, v32
    v_mul_f32 v37, v37, v32
    v_mul_f32 v38, v38, v32
    v_mul_f32 v39, v39, v32
    v_mul_f32 v40, v40, v32
    v_mul_f32 v41, v41, v32
    v_mul_f32 v42, v42, v32
    v_mul_f32 v43, v43, v32
    v_cvt_pk_bf16_f32 v44, v36, v37
    v_cvt_pk_bf16_f32 v45, v38, v39
    v_cvt_pk_bf16_f32 v46, v40, v41
    v_cvt_pk_bf16_f32 v47, v42, v43
    buffer_store_dwordx4 v[44:47], v16, s[16:19], s61 offen offset:2048 sc1
    v_accvgpr_read_b32 v36, a56
    v_accvgpr_read_b32 v37, a57
    v_accvgpr_read_b32 v38, a58
    v_accvgpr_read_b32 v39, a59
    v_accvgpr_read_b32 v40, a60
    v_accvgpr_read_b32 v41, a61
    v_accvgpr_read_b32 v42, a62
    v_accvgpr_read_b32 v43, a63
    v_mul_f32 v36, v36, v32
    v_mul_f32 v37, v37, v32
    v_mul_f32 v38, v38, v32
    v_mul_f32 v39, v39, v32
    v_mul_f32 v40, v40, v32
    v_mul_f32 v41, v41, v32
    v_mul_f32 v42, v42, v32
    v_mul_f32 v43, v43, v32
    v_cvt_pk_bf16_f32 v20, v36, v37
    v_cvt_pk_bf16_f32 v21, v38, v39
    v_cvt_pk_bf16_f32 v22, v40, v41
    v_cvt_pk_bf16_f32 v23, v42, v43
    buffer_store_dwordx4 v[20:23], v16, s[16:19], s61 offen offset:3072 sc1
    s_lshl_b32 s35, s34, 2
    s_sub_u32 s35, 29, s35
    s_sub_u32 s58, s35, 3
    s_cmp_eq_u32 s34, 7
    s_cselect_b32 s58, s35, s58
.p2align 6
gated_mix__ssm_conv_h3__compressed_kv_cla__prompt_kernel_b2_loop:
    v_mfma_f32_16x16x32_bf16 v[192:195], a[128:131], v[112:115], v[72:75]
    s_cmp_eq_u32 s35, 1
    ds_read_b128 a[160:163], v3 offset:8192
    ds_read_b128 a[164:167], v3 offset:9216
    v_mfma_f32_16x16x32_bf16 v[200:203], a[128:131], v[128:131], v[76:79]
    s_cbranch_scc1 gated_mix__ssm_conv_h3__compressed_kv_cla__prompt_kernel_b2_m0
gated_mix__ssm_conv_h3__compressed_kv_cla__prompt_kernel_b2_m0_ret:
    ds_read_b128 a[168:171], v3 offset:10240
    v_exp_f32 v4, v160
    v_mfma_f32_16x16x32_bf16 v[192:195], a[132:135], v[116:119], v[192:195]
    ds_read_b128 a[172:175], v3 offset:11264
    v_exp_f32 v5, v161
    v_mfma_f32_16x16x32_bf16 v[200:203], a[132:135], v[132:135], v[200:203]
    s_waitcnt vmcnt(16)
    s_barrier
    ds_read_b128 a[176:179], v3 offset:12288
    v_mfma_f32_16x16x32_bf16 v[192:195], a[136:139], v[120:123], v[192:195]
    s_mov_b32 m0, s40
    v_exp_f32 v6, v162
    v_mfma_f32_16x16x32_bf16 v[200:203], a[136:139], v[136:139], v[200:203]
    s_add_u32 s43, s38, s49
    ds_read_b128 a[180:183], v3 offset:13312
    v_exp_f32 v7, v163
    v_mfma_f32_16x16x32_bf16 v[192:195], a[140:143], v[124:127], v[192:195]
    ds_read_b128 a[184:187], v3 offset:14336
    v_exp_f32 v8, v164
    v_mfma_f32_16x16x32_bf16 v[200:203], a[140:143], v[140:143], v[200:203]
    s_waitcnt lgkmcnt(7)
    ds_read_b128 a[188:191], v3 offset:15360
    v_exp_f32 v9, v165
    v_mfma_f32_16x16x32_bf16 v[196:199], a[144:147], v[112:115], v[72:75]
    v_exp_f32 v10, v166
    v_mfma_f32_16x16x32_bf16 v[204:207], a[144:147], v[128:131], v[76:79]
    v_exp_f32 v11, v167
    v_mfma_f32_16x16x32_bf16 v[196:199], a[148:151], v[116:119], v[196:199]
    v_cvt_pk_bf16_f32 v216, v4, v5
    v_cvt_pk_bf16_f32 v217, v6, v7
    v_mfma_f32_16x16x32_bf16 v[204:207], a[148:151], v[132:135], v[204:207]
    v_or3_b32 v12, v12, v216, v217
    v_cvt_pk_bf16_f32 v218, v8, v9
    v_mfma_f32_16x16x32_bf16 v[196:199], a[152:155], v[120:123], v[196:199]
    v_cvt_pk_bf16_f32 v219, v10, v11
    v_or3_b32 v12, v12, v218, v219
    v_mfma_f32_16x16x32_bf16 v[204:207], a[152:155], v[136:139], v[204:207]
    buffer_load_dwordx4 v16, s[12:15], s38 offen offset:0 sc1 lds
    v_and_b32 v12, s42, v12
    v_cmp_ne_u32 vcc, 0, v12
    v_mfma_f32_16x16x32_bf16 v[196:199], a[156:159], v[124:127], v[196:199]
    s_waitcnt lgkmcnt(4)
    ds_read_b128 a[128:131], v2 offset:0
    ds_read_b128 a[132:135], v2 offset:1024
    v_mfma_f32_16x16x32_bf16 v[204:207], a[156:159], v[140:143], v[204:207]
    s_cbranch_vccnz gated_mix__ssm_conv_h3__compressed_kv_cla__prompt_kernel_b2_r0
gated_mix__ssm_conv_h3__compressed_kv_cla__prompt_kernel_b2_r0_ret:
    ds_read_b128 a[136:139], v2 offset:2048
    ds_read_b128 a[140:143], v2 offset:3072
    v_mfma_f32_16x16x32_bf16 a[64:67], a[160:163], v[216:219], a[64:67]
    ds_read_b128 a[144:147], v2 offset:4096
    ds_read_b128 a[148:151], v2 offset:5120
    v_mfma_f32_16x16x32_bf16 a[96:99], a[160:163], v[220:223], a[96:99]
    ds_read_b128 a[152:155], v2 offset:6144
    ds_read_b128 a[156:159], v2 offset:7168
    v_mfma_f32_16x16x32_bf16 a[68:71], a[164:167], v[216:219], a[68:71]
    v_exp_f32 v4, v200
    v_mfma_f32_16x16x32_bf16 a[100:103], a[164:167], v[220:223], a[100:103]
    s_cmp_eq_u32 s35, 1
    ds_read_b128 a[160:163], v3 offset:24576
    ds_read_b128 a[164:167], v3 offset:25600
    v_mfma_f32_16x16x32_bf16 a[72:75], a[168:171], v[216:219], a[72:75]
    s_cbranch_scc1 gated_mix__ssm_conv_h3__compressed_kv_cla__prompt_kernel_b2_m1
gated_mix__ssm_conv_h3__compressed_kv_cla__prompt_kernel_b2_m1_ret:
    v_exp_f32 v5, v201
    v_mfma_f32_16x16x32_bf16 a[104:107], a[168:171], v[220:223], a[104:107]
    buffer_load_dwordx4 v16, s[12:15], s38 offen offset:1024 sc1 lds
    v_mfma_f32_16x16x32_bf16 a[76:79], a[172:175], v[216:219], a[76:79]
    v_exp_f32 v6, v202
    v_mfma_f32_16x16x32_bf16 a[108:111], a[172:175], v[220:223], a[108:111]
    s_waitcnt lgkmcnt(10)
    ds_read_b128 a[168:171], v3 offset:26624
    v_cvt_pk_bf16_f32 v236, v4, v5
    v_mfma_f32_16x16x32_bf16 a[80:83], a[176:179], v[216:219], a[80:83]
    v_exp_f32 v7, v203
    v_mfma_f32_16x16x32_bf16 a[112:115], a[176:179], v[220:223], a[112:115]
    v_exp_f32 v8, v204
    v_mfma_f32_16x16x32_bf16 a[84:87], a[180:183], v[216:219], a[84:87]
    ds_read_b128 a[172:175], v3 offset:27648
    v_cvt_pk_bf16_f32 v237, v6, v7
    v_mfma_f32_16x16x32_bf16 a[116:119], a[180:183], v[220:223], a[116:119]
    ds_read_b128 a[176:179], v3 offset:28672
    v_or_b32 v12, v236, v237
    v_mfma_f32_16x16x32_bf16 a[88:91], a[184:187], v[216:219], a[88:91]
    buffer_load_dwordx4 v16, s[12:15], s38 offen offset:2048 sc1 lds
    v_mfma_f32_16x16x32_bf16 a[120:123], a[184:187], v[220:223], a[120:123]
    v_exp_f32 v9, v205
    v_mfma_f32_16x16x32_bf16 a[92:95], a[188:191], v[216:219], a[92:95]
    v_exp_f32 v10, v206
    v_mfma_f32_16x16x32_bf16 a[124:127], a[188:191], v[220:223], a[124:127]
    ds_read_b128 a[180:183], v3 offset:29696
    v_cvt_pk_bf16_f32 v238, v8, v9
    v_mfma_f32_16x16x32_bf16 v[248:251], v[24:27], v[216:219], v[248:251]
    v_exp_f32 v11, v207
    v_mfma_f32_16x16x32_bf16 v[252:255], v[24:27], v[220:223], v[252:255]
    s_waitcnt lgkmcnt(10)
    v_exp_f32 v4, v192
    v_mfma_f32_16x16x32_bf16 v[160:163], a[128:131], v[112:115], v[72:75]
    v_exp_f32 v5, v193
    v_mfma_f32_16x16x32_bf16 v[168:171], a[128:131], v[128:131], v[76:79]
    v_exp_f32 v6, v194
    v_mfma_f32_16x16x32_bf16 v[160:163], a[132:135], v[116:119], v[160:163]
    buffer_load_dwordx4 v16, s[12:15], s38 offen offset:3072 sc1 lds
    v_mfma_f32_16x16x32_bf16 v[168:171], a[132:135], v[132:135], v[168:171]
    s_mov_b32 m0, s41
    v_exp_f32 v7, v195
    v_mfma_f32_16x16x32_bf16 v[160:163], a[136:139], v[120:123], v[160:163]
    v_exp_f32 v8, v196
    v_mfma_f32_16x16x32_bf16 v[168:171], a[136:139], v[136:139], v[168:171]
    v_exp_f32 v9, v197
    v_mfma_f32_16x16x32_bf16 v[160:163], a[140:143], v[124:127], v[160:163]
    v_cvt_pk_bf16_f32 v239, v10, v11
    v_or3_b32 v12, v12, v238, v239
    v_mfma_f32_16x16x32_bf16 v[168:171], a[140:143], v[140:143], v[168:171]
    s_waitcnt lgkmcnt(6)
    v_exp_f32 v10, v198
    v_mfma_f32_16x16x32_bf16 v[164:167], a[144:147], v[112:115], v[72:75]
    v_exp_f32 v11, v199
    v_mfma_f32_16x16x32_bf16 v[172:175], a[144:147], v[128:131], v[76:79]
    buffer_load_dwordx4 v16, s[12:15], s43 offen offset:0 sc1 lds
    v_mfma_f32_16x16x32_bf16 v[164:167], a[148:151], v[116:119], v[164:167]
    v_cvt_pk_bf16_f32 v232, v4, v5
    v_cvt_pk_bf16_f32 v233, v6, v7
    v_mfma_f32_16x16x32_bf16 v[172:175], a[148:151], v[132:135], v[172:175]
    v_or3_b32 v12, v12, v232, v233
    v_cvt_pk_bf16_f32 v234, v8, v9
    v_mfma_f32_16x16x32_bf16 v[164:167], a[152:155], v[120:123], v[164:167]
    v_cvt_pk_bf16_f32 v235, v10, v11
    v_or3_b32 v12, v12, v234, v235
    v_mfma_f32_16x16x32_bf16 v[172:175], a[152:155], v[136:139], v[172:175]
    s_cmp_eq_u32 s35, 1
    v_and_b32 v12, s42, v12
    v_cmp_ne_u32 vcc, 0, v12
    v_mfma_f32_16x16x32_bf16 v[164:167], a[156:159], v[124:127], v[164:167]
    s_waitcnt lgkmcnt(2)
    ds_read_b128 a[184:187], v3 offset:30720
    ds_read_b128 a[188:191], v3 offset:31744
    v_mfma_f32_16x16x32_bf16 v[172:175], a[156:159], v[140:143], v[172:175]
    s_cbranch_vccnz gated_mix__ssm_conv_h3__compressed_kv_cla__prompt_kernel_b2_r1
gated_mix__ssm_conv_h3__compressed_kv_cla__prompt_kernel_b2_r1_ret:
    ds_read_b128 a[128:131], v2 offset:16384
    ds_read_b128 a[132:135], v2 offset:17408
    v_mfma_f32_16x16x32_bf16 a[64:67], a[160:163], v[232:235], a[64:67]
    s_cbranch_scc1 gated_mix__ssm_conv_h3__compressed_kv_cla__prompt_kernel_b2_m2
gated_mix__ssm_conv_h3__compressed_kv_cla__prompt_kernel_b2_m2_ret:
    ds_read_b128 a[136:139], v2 offset:18432
    ds_read_b128 a[140:143], v2 offset:19456
    v_mfma_f32_16x16x32_bf16 a[96:99], a[160:163], v[236:239], a[96:99]
    buffer_load_dwordx4 v16, s[12:15], s43 offen offset:1024 sc1 lds
    v_mfma_f32_16x16x32_bf16 a[68:71], a[164:167], v[232:235], a[68:71]
    s_add_u32 s38, s38, s44
    v_exp_f32 v4, v168
    v_mfma_f32_16x16x32_bf16 a[100:103], a[164:167], v[236:239], a[100:103]
    s_add_u32 s40, s39, s59
    v_exp_f32 v5, v169
    v_mfma_f32_16x16x32_bf16 a[72:75], a[168:171], v[232:235], a[72:75]
    s_add_u32 s41, s40, s50
    v_exp_f32 v6, v170
    v_mfma_f32_16x16x32_bf16 a[104:107], a[168:171], v[236:239], a[104:107]
    s_mov_b32 s39, s45
    ds_read_b128 a[144:147], v2 offset:20480
    v_cvt_pk_bf16_f32 v220, v4, v5
    v_mfma_f32_16x16x32_bf16 a[76:79], a[172:175], v[232:235], a[76:79]
    s_add_u32 s45, s45, 32768
    v_exp_f32 v7, v171
    v_mfma_f32_16x16x32_bf16 a[108:111], a[172:175], v[236:239], a[108:111]
    s_waitcnt lgkmcnt(5)
    ds_read_b128 a[148:151], v2 offset:21504
    v_cvt_pk_bf16_f32 v221, v6, v7
    v_mfma_f32_16x16x32_bf16 a[80:83], a[176:179], v[232:235], a[80:83]
    buffer_load_dwordx4 v16, s[12:15], s43 offen offset:2048 sc1 lds
    v_mfma_f32_16x16x32_bf16 a[112:115], a[176:179], v[236:239], a[112:115]
    s_cmp_eq_u32 s45, 163840
    ds_read_b128 a[152:155], v2 offset:22528
    v_or_b32 v12, v220, v221
    v_mfma_f32_16x16x32_bf16 a[84:87], a[180:183], v[232:235], a[84:87]
    s_cselect_b32 s45, 0, s45
    v_exp_f32 v8, v172
    v_mfma_f32_16x16x32_bf16 a[116:119], a[180:183], v[236:239], a[116:119]
    s_sub_u32 s35, s35, 1
    v_exp_f32 v9, v173
    v_mfma_f32_16x16x32_bf16 a[88:91], a[184:187], v[232:235], a[88:91]
    s_sub_u32 s58, s58, 1
    v_exp_f32 v10, v174
    v_mfma_f32_16x16x32_bf16 a[120:123], a[184:187], v[236:239], a[120:123]
    s_cmp_lg_u32 s58, 0
    ds_read_b128 a[156:159], v2 offset:23552
    v_cvt_pk_bf16_f32 v222, v8, v9
    v_mfma_f32_16x16x32_bf16 a[92:95], a[188:191], v[232:235], a[92:95]
    v_exp_f32 v11, v175
    v_mfma_f32_16x16x32_bf16 a[124:127], a[188:191], v[236:239], a[124:127]
    v_cvt_pk_bf16_f32 v223, v10, v11
    v_or3_b32 v12, v12, v222, v223
    v_mfma_f32_16x16x32_bf16 v[248:251], v[24:27], v[232:235], v[248:251]
    buffer_load_dwordx4 v16, s[12:15], s43 offen offset:3072 sc1 lds
    v_mfma_f32_16x16x32_bf16 v[252:255], v[24:27], v[236:239], v[252:255]
    s_waitcnt lgkmcnt(4)
    v_mov_b32 v3, v2
    v_add_u32 v2, s45, v16
    s_cbranch_scc1 gated_mix__ssm_conv_h3__compressed_kv_cla__prompt_kernel_b2_loop
    s_cmp_lg_u32 s35, 0
    s_cbranch_scc1 gated_mix__ssm_conv_h3__compressed_kv_cla__prompt_kernel_b2_sw
    s_waitcnt vmcnt(8)
    v_mov_b32 v13, 0
    v_mov_b32 v14, 1
    buffer_store_dword v14, v13, s[28:31], s55 offen sc1
    s_nop 4
    v_accvgpr_read_b32 v36, a64
    v_accvgpr_read_b32 v37, a65
    v_accvgpr_read_b32 v38, a66
    v_accvgpr_read_b32 v39, a67
    v_accvgpr_read_b32 v40, a68
    v_accvgpr_read_b32 v41, a69
    v_accvgpr_read_b32 v42, a70
    v_accvgpr_read_b32 v43, a71
    v_rcp_f32 v32, v248
    s_nop 0
    v_mul_f32 v36, v36, v32
    v_mul_f32 v37, v37, v32
    v_mul_f32 v38, v38, v32
    v_mul_f32 v39, v39, v32
    v_mul_f32 v40, v40, v32
    v_mul_f32 v41, v41, v32
    v_mul_f32 v42, v42, v32
    v_mul_f32 v43, v43, v32
    v_cvt_pk_bf16_f32 v44, v36, v37
    v_cvt_pk_bf16_f32 v45, v38, v39
    v_cvt_pk_bf16_f32 v46, v40, v41
    v_cvt_pk_bf16_f32 v47, v42, v43
    buffer_store_dwordx4 v[44:47], v16, s[16:19], s62 offen offset:0 sc1
    v_accvgpr_read_b32 v36, a72
    v_accvgpr_read_b32 v37, a73
    v_accvgpr_read_b32 v38, a74
    v_accvgpr_read_b32 v39, a75
    v_accvgpr_read_b32 v40, a76
    v_accvgpr_read_b32 v41, a77
    v_accvgpr_read_b32 v42, a78
    v_accvgpr_read_b32 v43, a79
    v_mul_f32 v36, v36, v32
    v_mul_f32 v37, v37, v32
    v_mul_f32 v38, v38, v32
    v_mul_f32 v39, v39, v32
    v_mul_f32 v40, v40, v32
    v_mul_f32 v41, v41, v32
    v_mul_f32 v42, v42, v32
    v_mul_f32 v43, v43, v32
    v_cvt_pk_bf16_f32 v20, v36, v37
    v_cvt_pk_bf16_f32 v21, v38, v39
    v_cvt_pk_bf16_f32 v22, v40, v41
    v_cvt_pk_bf16_f32 v23, v42, v43
    buffer_store_dwordx4 v[20:23], v16, s[16:19], s62 offen offset:1024 sc1
    v_accvgpr_read_b32 v36, a80
    v_accvgpr_read_b32 v37, a81
    v_accvgpr_read_b32 v38, a82
    v_accvgpr_read_b32 v39, a83
    v_accvgpr_read_b32 v40, a84
    v_accvgpr_read_b32 v41, a85
    v_accvgpr_read_b32 v42, a86
    v_accvgpr_read_b32 v43, a87
    v_mul_f32 v36, v36, v32
    v_mul_f32 v37, v37, v32
    v_mul_f32 v38, v38, v32
    v_mul_f32 v39, v39, v32
    v_mul_f32 v40, v40, v32
    v_mul_f32 v41, v41, v32
    v_mul_f32 v42, v42, v32
    v_mul_f32 v43, v43, v32
    v_cvt_pk_bf16_f32 v44, v36, v37
    v_cvt_pk_bf16_f32 v45, v38, v39
    v_cvt_pk_bf16_f32 v46, v40, v41
    v_cvt_pk_bf16_f32 v47, v42, v43
    buffer_store_dwordx4 v[44:47], v16, s[16:19], s62 offen offset:2048 sc1
    v_accvgpr_read_b32 v36, a88
    v_accvgpr_read_b32 v37, a89
    v_accvgpr_read_b32 v38, a90
    v_accvgpr_read_b32 v39, a91
    v_accvgpr_read_b32 v40, a92
    v_accvgpr_read_b32 v41, a93
    v_accvgpr_read_b32 v42, a94
    v_accvgpr_read_b32 v43, a95
    v_mul_f32 v36, v36, v32
    v_mul_f32 v37, v37, v32
    v_mul_f32 v38, v38, v32
    v_mul_f32 v39, v39, v32
    v_mul_f32 v40, v40, v32
    v_mul_f32 v41, v41, v32
    v_mul_f32 v42, v42, v32
    v_mul_f32 v43, v43, v32
    v_cvt_pk_bf16_f32 v20, v36, v37
    v_cvt_pk_bf16_f32 v21, v38, v39
    v_cvt_pk_bf16_f32 v22, v40, v41
    v_cvt_pk_bf16_f32 v23, v42, v43
    buffer_store_dwordx4 v[20:23], v16, s[16:19], s62 offen offset:3072 sc1
    s_mov_b32 m0, s40
    s_add_u32 s43, s38, s49
    s_barrier
    v_and_b32 v12, s42, v12
    v_cmp_ne_u32 vcc, 0, v12
    v_mfma_f32_16x16x32_bf16 v[200:203], a[128:131], v[128:131], v[76:79]
    ds_read_b128 a[160:163], v3 offset:8192
    v_mfma_f32_16x16x32_bf16 v[200:203], a[132:135], v[132:135], v[200:203]
    ds_read_b128 a[164:167], v3 offset:9216
    buffer_load_dwordx4 v16, s[12:15], s38 offen offset:0 sc1 lds
    v_mfma_f32_16x16x32_bf16 v[200:203], a[136:139], v[136:139], v[200:203]
    ds_read_b128 a[168:171], v3 offset:10240
    v_mfma_f32_16x16x32_bf16 v[200:203], a[140:143], v[140:143], v[200:203]
    s_waitcnt lgkmcnt(3)
    ds_read_b128 a[172:175], v3 offset:11264
    buffer_load_dwordx4 v16, s[12:15], s38 offen offset:1024 sc1 lds
    v_mfma_f32_16x16x32_bf16 v[204:207], a[144:147], v[128:131], v[76:79]
    ds_read_b128 a[176:179], v3 offset:12288
    v_mfma_f32_16x16x32_bf16 v[204:207], a[148:151], v[132:135], v[204:207]
    ds_read_b128 a[180:183], v3 offset:13312
    buffer_load_dwordx4 v16, s[12:15], s38 offen offset:2048 sc1 lds
    v_mfma_f32_16x16x32_bf16 v[204:207], a[152:155], v[136:139], v[204:207]
    ds_read_b128 a[184:187], v3 offset:14336
    v_mfma_f32_16x16x32_bf16 v[204:207], a[156:159], v[140:143], v[204:207]
    s_waitcnt lgkmcnt(3)
    ds_read_b128 a[188:191], v3 offset:15360
    buffer_load_dwordx4 v16, s[12:15], s38 offen offset:3072 sc1 lds
    s_mov_b32 m0, s41
    s_cbranch_vccnz gated_mix__ssm_conv_h3__compressed_kv_cla__prompt_kernel_b1_r0
gated_mix__ssm_conv_h3__compressed_kv_cla__prompt_kernel_b1_r0_ret:
    ds_read_b128 a[128:131], v3 offset:24576
    ds_read_b128 a[132:135], v3 offset:25600
    ds_read_b128 a[136:139], v3 offset:26624
    ds_read_b128 a[140:143], v3 offset:27648
    ds_read_b128 a[144:147], v3 offset:28672
    ds_read_b128 a[148:151], v3 offset:29696
    ds_read_b128 a[152:155], v3 offset:30720
    ds_read_b128 a[156:159], v3 offset:31744
    v_mfma_f32_16x16x32_bf16 a[96:99], a[160:163], v[220:223], a[96:99]
    buffer_load_dwordx4 v16, s[12:15], s43 offen offset:0 sc1 lds
    v_mfma_f32_16x16x32_bf16 a[100:103], a[164:167], v[220:223], a[100:103]
    buffer_load_dwordx4 v16, s[12:15], s43 offen offset:1024 sc1 lds
    v_mfma_f32_16x16x32_bf16 a[104:107], a[168:171], v[220:223], a[104:107]
    buffer_load_dwordx4 v16, s[12:15], s43 offen offset:2048 sc1 lds
    v_mfma_f32_16x16x32_bf16 a[108:111], a[172:175], v[220:223], a[108:111]
    s_waitcnt lgkmcnt(8)
    buffer_load_dwordx4 v16, s[12:15], s43 offen offset:3072 sc1 lds
    v_mfma_f32_16x16x32_bf16 a[112:115], a[176:179], v[220:223], a[112:115]
    v_add_f32 v200, v56, v200
    v_add_f32 v201, v57, v201
    v_add_f32 v202, v58, v202
    v_add_f32 v203, v59, v203
    v_add_f32 v204, v60, v204
    v_add_f32 v205, v61, v205
    v_add_f32 v206, v62, v206
    v_add_f32 v207, v63, v207
    v_mfma_f32_16x16x32_bf16 a[116:119], a[180:183], v[220:223], a[116:119]
    v_exp_f32 v4, v200
    v_exp_f32 v5, v201
    s_nop 0
    v_cvt_pk_bf16_f32 v236, v4, v5
    v_mfma_f32_16x16x32_bf16 a[120:123], a[184:187], v[220:223], a[120:123]
    v_exp_f32 v6, v202
    v_exp_f32 v7, v203
    s_nop 0
    v_cvt_pk_bf16_f32 v237, v6, v7
    v_mfma_f32_16x16x32_bf16 a[124:127], a[188:191], v[220:223], a[124:127]
    v_or_b32 v12, v236, v237
    v_exp_f32 v8, v204
    v_exp_f32 v9, v205
    s_nop 0
    v_mfma_f32_16x16x32_bf16 v[252:255], v[24:27], v[220:223], v[252:255]
    s_waitcnt lgkmcnt(4)
    v_cvt_pk_bf16_f32 v238, v8, v9
    v_exp_f32 v10, v206
    v_exp_f32 v11, v207
    s_nop 0
    v_cvt_pk_bf16_f32 v239, v10, v11
    v_or3_b32 v12, v12, v238, v239
    v_and_b32 v12, s42, v12
    v_cmp_ne_u32 vcc, 0, v12
    s_cbranch_vccnz gated_mix__ssm_conv_h3__compressed_kv_cla__prompt_kernel_b1_r1
gated_mix__ssm_conv_h3__compressed_kv_cla__prompt_kernel_b1_r1_ret:
    v_mfma_f32_16x16x32_bf16 a[96:99], a[128:131], v[236:239], a[96:99]
    v_mfma_f32_16x16x32_bf16 a[100:103], a[132:135], v[236:239], a[100:103]
    v_mfma_f32_16x16x32_bf16 a[104:107], a[136:139], v[236:239], a[104:107]
    v_mfma_f32_16x16x32_bf16 a[108:111], a[140:143], v[236:239], a[108:111]
    s_waitcnt lgkmcnt(0)
    v_mfma_f32_16x16x32_bf16 a[112:115], a[144:147], v[236:239], a[112:115]
    v_mfma_f32_16x16x32_bf16 a[116:119], a[148:151], v[236:239], a[116:119]
    v_mfma_f32_16x16x32_bf16 a[120:123], a[152:155], v[236:239], a[120:123]
    v_mfma_f32_16x16x32_bf16 a[124:127], a[156:159], v[236:239], a[124:127]
    v_mfma_f32_16x16x32_bf16 v[252:255], v[24:27], v[236:239], v[252:255]
    s_mov_b32 s20, s74
    s_mov_b32 s21, s75
    s_mov_b32 s22, 2048
    s_lshl_b32 s36, s2, 2
    s_add_u32 s36, s36, s32
    s_lshl_b32 s43, s32, 15
    s_lshl_b32 s44, s36, 12
    s_lshl_b32 s47, s36, 1
    s_mul_i32 s59, s32, 2304
    v_mov_b32 v8, 0
    v_mov_b32 v9, 1
    buffer_load_dwordx2 v[10:11], v8, s[4:7], s44 offen
    buffer_load_ushort v12, v8, s[20:23], s47 offen
    s_nop 4
    v_accvgpr_read_b32 v36, a96
    v_accvgpr_read_b32 v37, a97
    v_accvgpr_read_b32 v38, a98
    v_accvgpr_read_b32 v39, a99
    v_accvgpr_read_b32 v40, a100
    v_accvgpr_read_b32 v41, a101
    v_accvgpr_read_b32 v42, a102
    v_accvgpr_read_b32 v43, a103
    v_rcp_f32 v32, v252
    s_nop 0
    v_mul_f32 v36, v36, v32
    v_mul_f32 v37, v37, v32
    v_mul_f32 v38, v38, v32
    v_mul_f32 v39, v39, v32
    v_mul_f32 v40, v40, v32
    v_mul_f32 v41, v41, v32
    v_mul_f32 v42, v42, v32
    v_mul_f32 v43, v43, v32
    v_cvt_pk_bf16_f32 v44, v36, v37
    v_cvt_pk_bf16_f32 v45, v38, v39
    v_cvt_pk_bf16_f32 v46, v40, v41
    v_cvt_pk_bf16_f32 v47, v42, v43
    buffer_store_dwordx4 v[44:47], v16, s[16:19], s63 offen offset:0 sc1
    v_accvgpr_read_b32 v36, a104
    v_accvgpr_read_b32 v37, a105
    v_accvgpr_read_b32 v38, a106
    v_accvgpr_read_b32 v39, a107
    v_accvgpr_read_b32 v40, a108
    v_accvgpr_read_b32 v41, a109
    v_accvgpr_read_b32 v42, a110
    v_accvgpr_read_b32 v43, a111
    v_mul_f32 v36, v36, v32
    v_mul_f32 v37, v37, v32
    v_mul_f32 v38, v38, v32
    v_mul_f32 v39, v39, v32
    v_mul_f32 v40, v40, v32
    v_mul_f32 v41, v41, v32
    v_mul_f32 v42, v42, v32
    v_mul_f32 v43, v43, v32
    v_cvt_pk_bf16_f32 v20, v36, v37
    v_cvt_pk_bf16_f32 v21, v38, v39
    v_cvt_pk_bf16_f32 v22, v40, v41
    v_cvt_pk_bf16_f32 v23, v42, v43
    buffer_store_dwordx4 v[20:23], v16, s[16:19], s63 offen offset:1024 sc1
    v_accvgpr_read_b32 v36, a112
    v_accvgpr_read_b32 v37, a113
    v_accvgpr_read_b32 v38, a114
    v_accvgpr_read_b32 v39, a115
    v_accvgpr_read_b32 v40, a116
    v_accvgpr_read_b32 v41, a117
    v_accvgpr_read_b32 v42, a118
    v_accvgpr_read_b32 v43, a119
    v_mul_f32 v36, v36, v32
    v_mul_f32 v37, v37, v32
    v_mul_f32 v38, v38, v32
    v_mul_f32 v39, v39, v32
    v_mul_f32 v40, v40, v32
    v_mul_f32 v41, v41, v32
    v_mul_f32 v42, v42, v32
    v_mul_f32 v43, v43, v32
    v_cvt_pk_bf16_f32 v44, v36, v37
    v_cvt_pk_bf16_f32 v45, v38, v39
    v_cvt_pk_bf16_f32 v46, v40, v41
    v_cvt_pk_bf16_f32 v47, v42, v43
    buffer_store_dwordx4 v[44:47], v16, s[16:19], s63 offen offset:2048 sc1
    v_accvgpr_read_b32 v36, a120
    v_accvgpr_read_b32 v37, a121
    v_accvgpr_read_b32 v38, a122
    v_accvgpr_read_b32 v39, a123
    v_accvgpr_read_b32 v40, a124
    v_accvgpr_read_b32 v41, a125
    v_accvgpr_read_b32 v42, a126
    v_accvgpr_read_b32 v43, a127
    v_mul_f32 v36, v36, v32
    v_mul_f32 v37, v37, v32
    v_mul_f32 v38, v38, v32
    v_mul_f32 v39, v39, v32
    v_mul_f32 v40, v40, v32
    v_mul_f32 v41, v41, v32
    v_mul_f32 v42, v42, v32
    v_mul_f32 v43, v43, v32
    v_cvt_pk_bf16_f32 v20, v36, v37
    v_cvt_pk_bf16_f32 v21, v38, v39
    v_cvt_pk_bf16_f32 v22, v40, v41
    v_cvt_pk_bf16_f32 v23, v42, v43
    buffer_store_dwordx4 v[20:23], v16, s[16:19], s63 offen offset:3072 sc1
    v_lshrrev_b32 v232, 4, v16
    v_and_b32 v6, 15, v232
    v_lshrrev_b32 v7, 4, v232
    v_and_b32 v233, 1, v6
    v_cmp_eq_u32 vcc, 1, v233
    v_mov_b32 v234, 4240
    v_lshlrev_b32 v235, 4, v7
    v_cndmask_b32 v234, v234, 8, vcc
    v_lshl_add_u32 v234, v6, 3, v234
    v_add3_u32 v3, v234, v235, s43
    v_and_b32 v236, 3, v6
    v_mul_u32_u24 v236, 4640, v236
    v_lshrrev_b32 v234, 2, v6
    v_lshlrev_b32 v234, 7, v234
    v_sub_u32 v236, v236, v234
    v_add3_u32 v4, v236, v235, s43
    v_add_u32 v4, 8864, v4
    v_mov_b32 v20, 0
    v_mov_b32 v21, 0
    v_mov_b32 v22, 0
    v_mov_b32 v23, 0
    v_and_b32 v234, 7, v232
    v_lshlrev_b32 v234, 4, v234
    v_bfe_u32 v235, v232, 3, 1
    v_mul_u32_u24 v235, 4240, v235
    v_add3_u32 v234, v234, v235, s43
    ds_write_b128 v234, v[20:23]
    v_min_u32 v235, 368, v16
    v_add_u32 v235, s43, v235
    ds_write_b128 v235, v[20:23] offset:12576
    ds_write_b128 v235, v[20:23] offset:17216
    ds_write_b128 v235, v[20:23] offset:21856
    ds_write_b128 v235, v[20:23] offset:26496
    v_lshlrev_b32 v236, 2, v6
    v_sub_u32 v236, 60, v236
    v_lshrrev_b32 v236, 3, v236
    v_sub_u32 v236, v236, v7
    v_lshl_add_u32 v236, v233, 4, v236
    s_waitcnt vmcnt(4)
    v_mov_b32 v234, s43
    ds_write_b64 v234, v[10:11] offset:4360
    v_cmp_eq_u32 vcc, 16, v236
    v_mov_b32 v25, 0
    s_nop 0
    v_cndmask_b32 v24, 0, v12, vcc
    v_cmp_eq_u32 vcc, 0, v236
    v_mov_b32 v27, 0
    s_nop 0
    v_cndmask_b32 v26, 0, v12, vcc
    v_cmp_eq_u32 vcc, 20, v236
    v_mov_b32 v29, 0
    s_nop 0
    v_cndmask_b32 v28, 0, v12, vcc
    v_cmp_eq_u32 vcc, 4, v236
    v_mov_b32 v31, 0
    s_nop 0
    v_cndmask_b32 v30, 0, v12, vcc
    s_waitcnt vmcnt(6) lgkmcnt(0)
    s_barrier
    ds_read_b128 v[96:99], v4 offset:3584
    ds_read_b128 v[64:67], v3 offset:0
    ds_read_b128 v[100:103], v4 offset:3072
    ds_read_b128 v[68:71], v3 offset:512
    ds_read_b128 v[104:107], v4 offset:2560
    ds_read_b128 v[72:75], v3 offset:1024
    ds_read_b128 v[108:111], v4 offset:2048
    ds_read_b128 v[76:79], v3 offset:1536
    ds_read_b128 v[112:115], v4 offset:1536
    ds_read_b128 v[80:83], v3 offset:2048
    ds_read_b128 v[116:119], v4 offset:1024
    ds_read_b128 v[84:87], v3 offset:2560
    ds_read_b128 v[120:123], v4 offset:512
    ds_read_b128 v[88:91], v3 offset:3072
    ds_read_b128 v[124:127], v4 offset:0
    ds_read_b128 v[92:95], v3 offset:3584
    s_waitcnt lgkmcnt(0)
    v_mfma_f32_16x16x32_bf16 v[32:35], v[24:27], v[96:99], 0
    s_and_b32 s45, s2, 1
    s_bfe_u32 s36, s2, 0x10001
    v_mfma_f32_16x16x32_bf16 v[36:39], v[24:27], v[100:103], 0
    s_lshl_b32 s38, s36, 3
    s_bfe_u32 s36, s2, 0x30003
    v_mfma_f32_16x16x32_bf16 v[40:43], v[24:27], v[104:107], 0
    ds_read_b128 v[160:163], v4 offset:3648
    s_add_u32 s38, s38, s36
    s_bfe_u32 s36, s2, 0x10002
    v_mfma_f32_16x16x32_bf16 v[44:47], v[24:27], v[108:111], 0
    s_lshl_b32 s39, s36, 2
    s_lshr_b32 s37, s2, 6
    v_mfma_f32_16x16x32_bf16 v[48:51], v[24:27], v[112:115], 0
    ds_read_b128 v[128:131], v3 offset:64
    s_add_u32 s39, s39, s37
    s_xor_b32 s37, s45, 1
    v_mfma_f32_16x16x32_bf16 v[52:55], v[24:27], v[116:119], 0
    s_lshl_b32 s37, s37, 3
    v_lshlrev_b32 v233, 1, v7
    v_xor_b32 v233, v233, v6
    v_mfma_f32_16x16x32_bf16 v[56:59], v[24:27], v[120:123], 0
    ds_read_b128 v[164:167], v4 offset:3136
    v_xor_b32 v233, s37, v233
    v_mfma_f32_16x16x32_bf16 v[60:63], v[24:27], v[124:127], 0
    v_lshlrev_b32 v233, 4, v233
    v_lshl_add_u32 v192, v7, 11, v233
    v_mfma_f32_16x16x32_bf16 v[32:35], v[64:67], v[96:99], v[32:35]
    ds_read_b128 v[132:135], v3 offset:576
    v_add_u32 v193, 7040, v192
    s_lshl_b32 s40, s45, 22
    s_lshl_b32 s37, s32, 14
    v_mfma_f32_16x16x32_bf16 v[36:39], v[64:67], v[100:103], v[36:39]
    s_add_u32 s40, s40, s37
    s_lshl_b32 s37, s39, 8
    v_mfma_f32_16x16x32_bf16 v[40:43], v[64:67], v[104:107], v[40:43]
    ds_read_b128 v[168:171], v4 offset:2624
    s_add_u32 s40, s40, s37
    s_add_u32 m0, s59, 136192
    v_mfma_f32_16x16x32_bf16 v[44:47], v[64:67], v[108:111], v[44:47]
    buffer_load_dwordx4 v192, s[8:11], s40 offen offset:0 lds
    v_mfma_f32_16x16x32_bf16 v[48:51], v[64:67], v[112:115], v[48:51]
    ds_read_b128 v[136:139], v3 offset:1088
    v_mfma_f32_16x16x32_bf16 v[52:55], v[64:67], v[116:119], v[52:55]
    buffer_load_dwordx4 v193, s[8:11], s40 offen offset:1152 lds
    v_mfma_f32_16x16x32_bf16 v[56:59], v[64:67], v[120:123], v[56:59]
    ds_read_b128 v[172:175], v4 offset:2112
    s_add_u32 s40, s40, 65536
    s_add_u32 m0, s59, 145408
    v_mfma_f32_16x16x32_bf16 v[60:63], v[64:67], v[124:127], v[60:63]
    buffer_load_dwordx4 v192, s[8:11], s40 offen offset:0 lds
    v_mfma_f32_16x16x32_bf16 v[36:39], v[68:71], v[96:99], v[36:39]
    ds_read_b128 v[140:143], v3 offset:1600
    v_mfma_f32_16x16x32_bf16 v[40:43], v[68:71], v[100:103], v[40:43]
    buffer_load_dwordx4 v193, s[8:11], s40 offen offset:1152 lds
    v_mfma_f32_16x16x32_bf16 v[44:47], v[68:71], v[104:107], v[44:47]
    ds_read_b128 v[176:179], v4 offset:1600
    s_add_u32 s40, s40, 65536
    s_add_u32 m0, s59, 154624
    v_mfma_f32_16x16x32_bf16 v[48:51], v[68:71], v[108:111], v[48:51]
    buffer_load_dwordx4 v192, s[8:11], s40 offen offset:0 lds
    v_mfma_f32_16x16x32_bf16 v[52:55], v[68:71], v[112:115], v[52:55]
    ds_read_b128 v[144:147], v3 offset:2112
    v_mfma_f32_16x16x32_bf16 v[56:59], v[68:71], v[116:119], v[56:59]
    buffer_load_dwordx4 v193, s[8:11], s40 offen offset:1152 lds
    v_mfma_f32_16x16x32_bf16 v[60:63], v[68:71], v[120:123], v[60:63]
    ds_read_b128 v[180:183], v4 offset:1088
    s_add_u32 s40, s40, 65536
    s_lshr_b32 s52, s38, 1
    v_mfma_f32_16x16x32_bf16 v[40:43], v[72:75], v[96:99], v[40:43]
    s_lshl_b32 s52, s52, 2
    s_add_u32 s52, s52, s32
    v_mfma_f32_16x16x32_bf16 v[44:47], v[72:75], v[100:103], v[44:47]
    ds_read_b128 v[148:151], v3 offset:2624
    s_lshl_b32 s52, s52, 7
    s_lshl_b32 s37, s45, 6
    v_mfma_f32_16x16x32_bf16 v[48:51], v[72:75], v[104:107], v[48:51]
    s_add_u32 s52, s52, s37
    v_lshlrev_b32 v212, 2, v6
    s_lshl_b32 s41, s38, 2
    v_mfma_f32_16x16x32_bf16 v[52:55], v[72:75], v[108:111], v[52:55]
    ds_read_b128 v[184:187], v4 offset:576
    s_add_u32 s41, s41, s32
    s_lshl_b32 s41, s41, 17
    v_mfma_f32_16x16x32_bf16 v[56:59], v[72:75], v[112:115], v[56:59]
    s_lshl_b32 s37, s45, 16
    s_add_u32 s41, s41, s37
    v_mfma_f32_16x16x32_bf16 v[60:63], v[72:75], v[116:119], v[60:63]
    ds_read_b128 v[152:155], v3 offset:3136
    s_add_u32 s42, s41, 8388608
    v_mfma_f32_16x16x32_bf16 v[44:47], v[76:79], v[96:99], v[44:47]
    buffer_load_dword v213, v212, s[28:31], s52 offen offset:0 sc1
    v_mfma_f32_16x16x32_bf16 v[48:51], v[76:79], v[100:103], v[48:51]
    ds_read_b128 v[188:191], v4 offset:64
    v_mfma_f32_16x16x32_bf16 v[52:55], v[76:79], v[104:107], v[52:55]
    v_mfma_f32_16x16x32_bf16 v[56:59], v[76:79], v[108:111], v[56:59]
    ds_read_b128 v[156:159], v3 offset:3648
    v_mfma_f32_16x16x32_bf16 v[60:63], v[76:79], v[112:115], v[60:63]
    v_mfma_f32_16x16x32_bf16 v[48:51], v[80:83], v[96:99], v[48:51]
    v_mfma_f32_16x16x32_bf16 v[52:55], v[80:83], v[100:103], v[52:55]
    v_mfma_f32_16x16x32_bf16 v[56:59], v[80:83], v[104:107], v[56:59]
    v_mfma_f32_16x16x32_bf16 v[60:63], v[80:83], v[108:111], v[60:63]
    v_mfma_f32_16x16x32_bf16 v[52:55], v[84:87], v[96:99], v[52:55]
    v_mfma_f32_16x16x32_bf16 v[56:59], v[84:87], v[100:103], v[56:59]
    v_mfma_f32_16x16x32_bf16 v[60:63], v[84:87], v[104:107], v[60:63]
    v_mfma_f32_16x16x32_bf16 v[56:59], v[88:91], v[96:99], v[56:59]
    v_mfma_f32_16x16x32_bf16 v[60:63], v[88:91], v[100:103], v[60:63]
    v_mfma_f32_16x16x32_bf16 v[60:63], v[92:95], v[96:99], v[60:63]
    s_waitcnt lgkmcnt(0)
    v_mfma_f32_16x16x32_bf16 v[32:35], v[28:31], v[160:163], v[32:35]
    s_waitcnt vmcnt(7)
    buffer_store_dword v9, v8, s[28:31], s56 offen sc1
    v_mfma_f32_16x16x32_bf16 v[36:39], v[28:31], v[164:167], v[36:39]
    v_mul_u32_u24 v233, 1152, v7
    v_lshrrev_b32 v234, 2, v6
    v_mfma_f32_16x16x32_bf16 v[40:43], v[28:31], v[168:171], v[40:43]
    ds_read_b128 v[96:99], v4 offset:3712
    v_lshl_add_u32 v233, v234, 8, v233
    v_mfma_f32_16x16x32_bf16 v[44:47], v[28:31], v[172:175], v[44:47]
    v_and_b32 v235, 3, v6
    v_lshl_add_u32 v233, v235, 3, v233
    v_mfma_f32_16x16x32_bf16 v[48:51], v[28:31], v[176:179], v[48:51]
    ds_read_b128 v[64:67], v3 offset:128
    v_add_u32 v233, 16384, v233
    v_mfma_f32_16x16x32_bf16 v[52:55], v[28:31], v[180:183], v[52:55]
    v_xor_b32 v236, 0, v234
    v_lshl_add_u32 v194, v236, 5, v233
    v_mfma_f32_16x16x32_bf16 v[56:59], v[28:31], v[184:187], v[56:59]
    ds_read_b128 v[100:103], v4 offset:3200
    v_add_u32 v198, 64512, v194
    v_mfma_f32_16x16x32_bf16 v[60:63], v[28:31], v[188:191], v[60:63]
    v_add_u32 v202, 129024, v194
    v_xor_b32 v236, 1, v234
    v_mfma_f32_16x16x32_bf16 v[32:35], v[128:131], v[160:163], v[32:35]
    ds_read_b128 v[68:71], v3 offset:640
    v_lshl_add_u32 v195, v236, 5, v233
    v_mfma_f32_16x16x32_bf16 v[36:39], v[128:131], v[164:167], v[36:39]
    v_add_u32 v199, 64512, v195
    v_add_u32 v203, 129024, v195
    v_mfma_f32_16x16x32_bf16 v[40:43], v[128:131], v[168:171], v[40:43]
    ds_read_b128 v[104:107], v4 offset:2688
    v_xor_b32 v236, 2, v234
    v_mfma_f32_16x16x32_bf16 v[44:47], v[128:131], v[172:175], v[44:47]
    v_lshl_add_u32 v196, v236, 5, v233
    v_add_u32 v200, 64512, v196
    v_mfma_f32_16x16x32_bf16 v[48:51], v[128:131], v[176:179], v[48:51]
    ds_read_b128 v[72:75], v3 offset:1152
    v_add_u32 v204, 129024, v196
    v_mfma_f32_16x16x32_bf16 v[52:55], v[128:131], v[180:183], v[52:55]
    v_xor_b32 v236, 3, v234
    v_lshl_add_u32 v197, v236, 5, v233
    v_mfma_f32_16x16x32_bf16 v[56:59], v[128:131], v[184:187], v[56:59]
    ds_read_b128 v[108:111], v4 offset:2176
    v_add_u32 v201, 64512, v197
    v_mfma_f32_16x16x32_bf16 v[60:63], v[128:131], v[188:191], v[60:63]
    v_add_u32 v205, 129024, v197
    v_lshlrev_b32 v236, 3, v7
    v_mfma_f32_16x16x32_bf16 v[36:39], v[132:135], v[160:163], v[36:39]
    ds_read_b128 v[76:79], v3 offset:1664
    v_lshl_add_u32 v206, v6, 13, v236
    v_mfma_f32_16x16x32_bf16 v[40:43], v[132:135], v[164:167], v[40:43]
    v_lshl_add_u32 v5, v6, 5, v236
    v_lshrrev_b32 v236, 2, v232
    v_mfma_f32_16x16x32_bf16 v[44:47], v[132:135], v[168:171], v[44:47]
    ds_read_b128 v[112:115], v4 offset:1664
    v_lshlrev_b32 v236, 8, v236
    v_mfma_f32_16x16x32_bf16 v[48:51], v[132:135], v[172:175], v[48:51]
    v_lshl_add_u32 v236, v235, 3, v236
    s_lshl_b32 s37, s32, 5
    v_add_u32 v207, s37, v236
    v_mfma_f32_16x16x32_bf16 v[52:55], v[132:135], v[176:179], v[52:55]
    ds_read_b128 v[80:83], v3 offset:2176
    v_lshlrev_b32 v208, 4, v6
    v_mfma_f32_16x16x32_bf16 v[56:59], v[132:135], v[180:183], v[56:59]
    v_lshlrev_b32 v209, 12, v7
    v_bfe_u32 v236, v232, 3, 1
    v_mfma_f32_16x16x32_bf16 v[60:63], v[132:135], v[184:187], v[60:63]
    ds_read_b128 v[116:119], v4 offset:1152
    v_lshl_add_u32 v209, v236, 11, v209
    v_mfma_f32_16x16x32_bf16 v[40:43], v[136:139], v[160:163], v[40:43]
    v_and_b32 v236, 7, v232
    v_lshl_add_u32 v209, v236, 4, v209
    s_lshl_b32 s48, s38, 6
    s_add_u32 s48, s48, s32
    v_mfma_f32_16x16x32_bf16 v[44:47], v[136:139], v[164:167], v[44:47]
    ds_read_b128 v[84:87], v3 offset:2688
    s_lshl_b32 s50, s48, 2
    s_lshl_b32 s48, s48, 11
    v_mfma_f32_16x16x32_bf16 v[48:51], v[136:139], v[168:171], v[48:51]
    s_lshl_b32 s37, s39, 1
    s_add_u32 s37, s37, s45
    v_mfma_f32_16x16x32_bf16 v[52:55], v[136:139], v[172:175], v[52:55]
    ds_read_b128 v[120:123], v4 offset:640
    s_lshl_b32 s51, s37, 2
    s_lshl_b32 s37, s37, 7
    v_mfma_f32_16x16x32_bf16 v[56:59], v[136:139], v[176:179], v[56:59]
    s_add_u32 s48, s48, s37
    s_add_u32 s49, s48, 2097152
    v_mfma_f32_16x16x32_bf16 v[60:63], v[136:139], v[180:183], v[60:63]
    ds_read_b128 v[88:91], v3 offset:3200
    s_add_u32 s51, s51, s32
    s_lshl_b32 s53, s51, 6
    v_mfma_f32_16x16x32_bf16 v[44:47], v[140:143], v[160:163], v[44:47]
    s_add_u32 s53, s53, 8192
    s_lshl_b32 s51, s51, 16
    v_mfma_f32_16x16x32_bf16 v[48:51], v[140:143], v[164:167], v[48:51]
    ds_read_b128 v[124:127], v4 offset:128
    s_lshl_b32 s37, s38, 7
    s_add_u32 s51, s51, s37
    v_mfma_f32_16x16x32_bf16 v[52:55], v[140:143], v[168:171], v[52:55]
    s_add_u32 s12, s94, 55574528
    s_addc_u32 s13, s95, 0
    s_mov_b32 s14, 4194304
    v_mfma_f32_16x16x32_bf16 v[56:59], v[140:143], v[172:175], v[56:59]
    ds_read_b128 v[92:95], v3 offset:3712
    s_mov_b32 s20, s90
    s_mov_b32 s21, s91
    v_mfma_f32_16x16x32_bf16 v[60:63], v[140:143], v[176:179], v[60:63]
    s_mov_b32 s22, 4194304
    v_mfma_f32_16x16x32_bf16 v[48:51], v[144:147], v[160:163], v[48:51]
    v_mfma_f32_16x16x32_bf16 v[52:55], v[144:147], v[164:167], v[52:55]
    v_mfma_f32_16x16x32_bf16 v[56:59], v[144:147], v[168:171], v[56:59]
    v_mfma_f32_16x16x32_bf16 v[60:63], v[144:147], v[172:175], v[60:63]
    v_mfma_f32_16x16x32_bf16 v[52:55], v[148:151], v[160:163], v[52:55]
    v_mfma_f32_16x16x32_bf16 v[56:59], v[148:151], v[164:167], v[56:59]
    v_mfma_f32_16x16x32_bf16 v[60:63], v[148:151], v[168:171], v[60:63]
    v_mfma_f32_16x16x32_bf16 v[56:59], v[152:155], v[160:163], v[56:59]
    v_mfma_f32_16x16x32_bf16 v[60:63], v[152:155], v[164:167], v[60:63]
    v_mfma_f32_16x16x32_bf16 v[60:63], v[156:159], v[160:163], v[60:63]
    s_waitcnt lgkmcnt(0)
    s_waitcnt vmcnt(1)
    v_cmp_ne_u32 vcc, 1, v213
    s_nop 0
    s_cbranch_vccnz gated_mix__ssm_conv_h3__compressed_kv_cla__prompt_kernel_spin_s
gated_mix__ssm_conv_h3__compressed_kv_cla__prompt_kernel_spin_s_ret:
    v_mfma_f32_16x16x32_bf16 v[32:35], v[64:67], v[96:99], v[32:35]
    buffer_load_dwordx4 a[0:3], v16, s[16:19], s41 offen offset:0 sc1
    v_mfma_f32_16x16x32_bf16 v[36:39], v[64:67], v[100:103], v[36:39]
    buffer_load_dwordx4 a[4:7], v16, s[16:19], s41 offen offset:1024 sc1
    v_mfma_f32_16x16x32_bf16 v[40:43], v[64:67], v[104:107], v[40:43]
    ds_read_b128 v[160:163], v4 offset:3776
    v_mfma_f32_16x16x32_bf16 v[44:47], v[64:67], v[108:111], v[44:47]
    buffer_load_dwordx4 a[8:11], v16, s[16:19], s41 offen offset:2048 sc1
    v_mfma_f32_16x16x32_bf16 v[48:51], v[64:67], v[112:115], v[48:51]
    ds_read_b128 v[128:131], v3 offset:192
    v_mfma_f32_16x16x32_bf16 v[52:55], v[64:67], v[116:119], v[52:55]
    buffer_load_dwordx4 a[12:15], v16, s[16:19], s41 offen offset:3072 sc1
    v_mfma_f32_16x16x32_bf16 v[56:59], v[64:67], v[120:123], v[56:59]
    ds_read_b128 v[164:167], v4 offset:3264
    s_add_u32 s41, s41, 4096
    v_mfma_f32_16x16x32_bf16 v[60:63], v[64:67], v[124:127], v[60:63]
    buffer_load_dwordx4 a[16:19], v16, s[16:19], s41 offen offset:0 sc1
    v_mfma_f32_16x16x32_bf16 v[36:39], v[68:71], v[96:99], v[36:39]
    ds_read_b128 v[132:135], v3 offset:704
    v_mfma_f32_16x16x32_bf16 v[40:43], v[68:71], v[100:103], v[40:43]
    buffer_load_dwordx4 a[20:23], v16, s[16:19], s41 offen offset:1024 sc1
    v_mfma_f32_16x16x32_bf16 v[44:47], v[68:71], v[104:107], v[44:47]
    ds_read_b128 v[168:171], v4 offset:2752
    v_mfma_f32_16x16x32_bf16 v[48:51], v[68:71], v[108:111], v[48:51]
    buffer_load_dwordx4 a[24:27], v16, s[16:19], s41 offen offset:2048 sc1
    v_mfma_f32_16x16x32_bf16 v[52:55], v[68:71], v[112:115], v[52:55]
    ds_read_b128 v[136:139], v3 offset:1216
    v_mfma_f32_16x16x32_bf16 v[56:59], v[68:71], v[116:119], v[56:59]
    buffer_load_dwordx4 a[28:31], v16, s[16:19], s41 offen offset:3072 sc1
    v_mfma_f32_16x16x32_bf16 v[60:63], v[68:71], v[120:123], v[60:63]
    ds_read_b128 v[172:175], v4 offset:2240
    s_add_u32 s41, s41, 4096
    v_mfma_f32_16x16x32_bf16 v[40:43], v[72:75], v[96:99], v[40:43]
    buffer_load_dwordx4 a[32:35], v16, s[16:19], s41 offen offset:0 sc1
    v_mfma_f32_16x16x32_bf16 v[44:47], v[72:75], v[100:103], v[44:47]
    ds_read_b128 v[140:143], v3 offset:1728
    v_mfma_f32_16x16x32_bf16 v[48:51], v[72:75], v[104:107], v[48:51]
    buffer_load_dwordx4 a[36:39], v16, s[16:19], s41 offen offset:1024 sc1
    v_mfma_f32_16x16x32_bf16 v[52:55], v[72:75], v[108:111], v[52:55]
    ds_read_b128 v[176:179], v4 offset:1728
    v_mfma_f32_16x16x32_bf16 v[56:59], v[72:75], v[112:115], v[56:59]
    buffer_load_dwordx4 a[40:43], v16, s[16:19], s41 offen offset:2048 sc1
    v_mfma_f32_16x16x32_bf16 v[60:63], v[72:75], v[116:119], v[60:63]
    ds_read_b128 v[144:147], v3 offset:2240
    v_mfma_f32_16x16x32_bf16 v[44:47], v[76:79], v[96:99], v[44:47]
    buffer_load_dwordx4 a[44:47], v16, s[16:19], s41 offen offset:3072 sc1
    v_mfma_f32_16x16x32_bf16 v[48:51], v[76:79], v[100:103], v[48:51]
    ds_read_b128 v[180:183], v4 offset:1216
    s_add_u32 s41, s41, 4096
    v_mfma_f32_16x16x32_bf16 v[52:55], v[76:79], v[104:107], v[52:55]
    buffer_load_dwordx4 a[48:51], v16, s[16:19], s41 offen offset:0 sc1
    v_mfma_f32_16x16x32_bf16 v[56:59], v[76:79], v[108:111], v[56:59]
    ds_read_b128 v[148:151], v3 offset:2752
    v_mfma_f32_16x16x32_bf16 v[60:63], v[76:79], v[112:115], v[60:63]
    buffer_load_dwordx4 a[52:55], v16, s[16:19], s41 offen offset:1024 sc1
    v_mfma_f32_16x16x32_bf16 v[48:51], v[80:83], v[96:99], v[48:51]
    ds_read_b128 v[184:187], v4 offset:704
    v_mfma_f32_16x16x32_bf16 v[52:55], v[80:83], v[100:103], v[52:55]
    buffer_load_dwordx4 a[56:59], v16, s[16:19], s41 offen offset:2048 sc1
    v_mfma_f32_16x16x32_bf16 v[56:59], v[80:83], v[104:107], v[56:59]
    ds_read_b128 v[152:155], v3 offset:3264
    v_mfma_f32_16x16x32_bf16 v[60:63], v[80:83], v[108:111], v[60:63]
    v_mfma_f32_16x16x32_bf16 v[52:55], v[84:87], v[96:99], v[52:55]
    ds_read_b128 v[188:191], v4 offset:192
    v_mfma_f32_16x16x32_bf16 v[56:59], v[84:87], v[100:103], v[56:59]
    v_mfma_f32_16x16x32_bf16 v[60:63], v[84:87], v[104:107], v[60:63]
    ds_read_b128 v[156:159], v3 offset:3776
    v_mfma_f32_16x16x32_bf16 v[56:59], v[88:91], v[96:99], v[56:59]
    v_mfma_f32_16x16x32_bf16 v[60:63], v[88:91], v[100:103], v[60:63]
    v_mfma_f32_16x16x32_bf16 v[60:63], v[92:95], v[96:99], v[60:63]
    s_waitcnt lgkmcnt(0)
    v_mfma_f32_16x16x32_bf16 v[32:35], v[128:131], v[160:163], v[32:35]
    s_add_u32 s4, s94, 59768832
    s_addc_u32 s5, s95, 0
    s_mov_b32 s6, 8192
    v_mfma_f32_16x16x32_bf16 v[36:39], v[128:131], v[164:167], v[36:39]
    s_mov_b32 s24, s64
    s_mov_b32 s25, s65
    v_mfma_f32_16x16x32_bf16 v[40:43], v[128:131], v[168:171], v[40:43]
    ds_read_b128 v[96:99], v4 offset:3840
    s_mov_b32 s26, 4194304
    s_lshl_b32 s46, s44, 1
    v_mfma_f32_16x16x32_bf16 v[44:47], v[128:131], v[172:175], v[44:47]
    buffer_load_dwordx2 v[216:217], v206, s[24:27], s48 offen offset:0
    v_mfma_f32_16x16x32_bf16 v[48:51], v[128:131], v[176:179], v[48:51]
    ds_read_b128 v[64:67], v3 offset:256
    v_mfma_f32_16x16x32_bf16 v[52:55], v[128:131], v[180:183], v[52:55]
    buffer_load_dwordx2 v[220:221], v206, s[24:27], s48 offen offset:32
    v_mfma_f32_16x16x32_bf16 v[56:59], v[128:131], v[184:187], v[56:59]
    ds_read_b128 v[100:103], v4 offset:3328
    v_mfma_f32_16x16x32_bf16 v[60:63], v[128:131], v[188:191], v[60:63]
    buffer_load_dwordx2 v[224:225], v206, s[24:27], s48 offen offset:64
    v_mfma_f32_16x16x32_bf16 v[36:39], v[132:135], v[160:163], v[36:39]
    ds_read_b128 v[68:71], v3 offset:768
    v_mfma_f32_16x16x32_bf16 v[40:43], v[132:135], v[164:167], v[40:43]
    buffer_load_dwordx2 v[228:229], v206, s[24:27], s48 offen offset:96
    v_mfma_f32_16x16x32_bf16 v[44:47], v[132:135], v[168:171], v[44:47]
    ds_read_b128 v[104:107], v4 offset:2816
    v_mfma_f32_16x16x32_bf16 v[48:51], v[132:135], v[172:175], v[48:51]
    buffer_load_dwordx2 v[218:219], v206, s[24:27], s49 offen offset:0
    v_mfma_f32_16x16x32_bf16 v[52:55], v[132:135], v[176:179], v[52:55]
    ds_read_b128 v[72:75], v3 offset:1280
    v_mfma_f32_16x16x32_bf16 v[56:59], v[132:135], v[180:183], v[56:59]
    buffer_load_dwordx2 v[222:223], v206, s[24:27], s49 offen offset:32
    v_mfma_f32_16x16x32_bf16 v[60:63], v[132:135], v[184:187], v[60:63]
    ds_read_b128 v[108:111], v4 offset:2304
    v_mfma_f32_16x16x32_bf16 v[40:43], v[136:139], v[160:163], v[40:43]
    buffer_load_dwordx2 v[226:227], v206, s[24:27], s49 offen offset:64
    v_mfma_f32_16x16x32_bf16 v[44:47], v[136:139], v[164:167], v[44:47]
    ds_read_b128 v[76:79], v3 offset:1792
    v_mfma_f32_16x16x32_bf16 v[48:51], v[136:139], v[168:171], v[48:51]
    buffer_load_dwordx2 v[230:231], v206, s[24:27], s49 offen offset:96
    v_mfma_f32_16x16x32_bf16 v[52:55], v[136:139], v[172:175], v[52:55]
    ds_read_b128 v[112:115], v4 offset:1792
    v_mfma_f32_16x16x32_bf16 v[56:59], v[136:139], v[176:179], v[56:59]
    buffer_load_dword v210, v208, s[4:7], s50 offen sc1
    v_mfma_f32_16x16x32_bf16 v[60:63], v[136:139], v[180:183], v[60:63]
    ds_read_b128 v[80:83], v3 offset:2304
    s_add_u32 s50, s50, 4096
    v_mfma_f32_16x16x32_bf16 v[44:47], v[140:143], v[160:163], v[44:47]
    buffer_load_dword v211, v208, s[4:7], s50 offen sc1
    v_mfma_f32_16x16x32_bf16 v[48:51], v[140:143], v[164:167], v[48:51]
    ds_read_b128 v[116:119], v4 offset:1280
    v_mfma_f32_16x16x32_bf16 v[52:55], v[140:143], v[168:171], v[52:55]
    v_mfma_f32_16x16x32_bf16 v[56:59], v[140:143], v[172:175], v[56:59]
    ds_read_b128 v[84:87], v3 offset:2816
    v_mfma_f32_16x16x32_bf16 v[60:63], v[140:143], v[176:179], v[60:63]
    v_mfma_f32_16x16x32_bf16 v[48:51], v[144:147], v[160:163], v[48:51]
    ds_read_b128 v[120:123], v4 offset:768
    v_mfma_f32_16x16x32_bf16 v[52:55], v[144:147], v[164:167], v[52:55]
    v_mfma_f32_16x16x32_bf16 v[56:59], v[144:147], v[168:171], v[56:59]
    ds_read_b128 v[88:91], v3 offset:3328
    v_mfma_f32_16x16x32_bf16 v[60:63], v[144:147], v[172:175], v[60:63]
    v_mfma_f32_16x16x32_bf16 v[52:55], v[148:151], v[160:163], v[52:55]
    ds_read_b128 v[124:127], v4 offset:256
    v_mfma_f32_16x16x32_bf16 v[56:59], v[148:151], v[164:167], v[56:59]
    v_mfma_f32_16x16x32_bf16 v[60:63], v[148:151], v[168:171], v[60:63]
    ds_read_b128 v[92:95], v3 offset:3840
    v_mfma_f32_16x16x32_bf16 v[56:59], v[152:155], v[160:163], v[56:59]
    v_mfma_f32_16x16x32_bf16 v[60:63], v[152:155], v[164:167], v[60:63]
    v_mfma_f32_16x16x32_bf16 v[60:63], v[156:159], v[160:163], v[60:63]
    s_waitcnt lgkmcnt(0)
    v_mfma_f32_16x16x32_bf16 v[32:35], v[64:67], v[96:99], v[32:35]
    s_add_u32 s52, s52, 4096
    buffer_load_dword v213, v212, s[28:31], s52 offen offset:0 sc1
    v_mfma_f32_16x16x32_bf16 v[36:39], v[64:67], v[100:103], v[36:39]
    v_mfma_f32_16x16x32_bf16 v[40:43], v[64:67], v[104:107], v[40:43]
    ds_read_b128 v[160:163], v4 offset:3904
    v_mfma_f32_16x16x32_bf16 v[44:47], v[64:67], v[108:111], v[44:47]
    v_mfma_f32_16x16x32_bf16 v[48:51], v[64:67], v[112:115], v[48:51]
    ds_read_b128 v[128:131], v3 offset:320
    v_mfma_f32_16x16x32_bf16 v[52:55], v[64:67], v[116:119], v[52:55]
    v_mfma_f32_16x16x32_bf16 v[56:59], v[64:67], v[120:123], v[56:59]
    ds_read_b128 v[164:167], v4 offset:3392
    v_mfma_f32_16x16x32_bf16 v[60:63], v[64:67], v[124:127], v[60:63]
    v_mfma_f32_16x16x32_bf16 v[36:39], v[68:71], v[96:99], v[36:39]
    ds_read_b128 v[132:135], v3 offset:832
    v_mfma_f32_16x16x32_bf16 v[40:43], v[68:71], v[100:103], v[40:43]
    v_mfma_f32_16x16x32_bf16 v[44:47], v[68:71], v[104:107], v[44:47]
    ds_read_b128 v[168:171], v4 offset:2880
    v_mfma_f32_16x16x32_bf16 v[48:51], v[68:71], v[108:111], v[48:51]
    v_mfma_f32_16x16x32_bf16 v[52:55], v[68:71], v[112:115], v[52:55]
    ds_read_b128 v[136:139], v3 offset:1344
    v_mfma_f32_16x16x32_bf16 v[56:59], v[68:71], v[116:119], v[56:59]
    v_mfma_f32_16x16x32_bf16 v[60:63], v[68:71], v[120:123], v[60:63]
    ds_read_b128 v[172:175], v4 offset:2368
    v_mfma_f32_16x16x32_bf16 v[40:43], v[72:75], v[96:99], v[40:43]
    v_mfma_f32_16x16x32_bf16 v[44:47], v[72:75], v[100:103], v[44:47]
    ds_read_b128 v[140:143], v3 offset:1856
    v_mfma_f32_16x16x32_bf16 v[48:51], v[72:75], v[104:107], v[48:51]
    v_mfma_f32_16x16x32_bf16 v[52:55], v[72:75], v[108:111], v[52:55]
    ds_read_b128 v[176:179], v4 offset:1856
    v_mfma_f32_16x16x32_bf16 v[56:59], v[72:75], v[112:115], v[56:59]
    v_mfma_f32_16x16x32_bf16 v[60:63], v[72:75], v[116:119], v[60:63]
    ds_read_b128 v[144:147], v3 offset:2368
    v_mfma_f32_16x16x32_bf16 v[44:47], v[76:79], v[96:99], v[44:47]
    v_mfma_f32_16x16x32_bf16 v[48:51], v[76:79], v[100:103], v[48:51]
    ds_read_b128 v[180:183], v4 offset:1344
    v_mfma_f32_16x16x32_bf16 v[52:55], v[76:79], v[104:107], v[52:55]
    v_mfma_f32_16x16x32_bf16 v[56:59], v[76:79], v[108:111], v[56:59]
    ds_read_b128 v[148:151], v3 offset:2880
    v_mfma_f32_16x16x32_bf16 v[60:63], v[76:79], v[112:115], v[60:63]
    v_mfma_f32_16x16x32_bf16 v[48:51], v[80:83], v[96:99], v[48:51]
    ds_read_b128 v[184:187], v4 offset:832
    v_mfma_f32_16x16x32_bf16 v[52:55], v[80:83], v[100:103], v[52:55]
    v_mfma_f32_16x16x32_bf16 v[56:59], v[80:83], v[104:107], v[56:59]
    ds_read_b128 v[152:155], v3 offset:3392
    v_mfma_f32_16x16x32_bf16 v[60:63], v[80:83], v[108:111], v[60:63]
    v_mfma_f32_16x16x32_bf16 v[52:55], v[84:87], v[96:99], v[52:55]
    ds_read_b128 v[188:191], v4 offset:320
    v_mfma_f32_16x16x32_bf16 v[56:59], v[84:87], v[100:103], v[56:59]
    v_mfma_f32_16x16x32_bf16 v[60:63], v[84:87], v[104:107], v[60:63]
    ds_read_b128 v[156:159], v3 offset:3904
    v_mfma_f32_16x16x32_bf16 v[56:59], v[88:91], v[96:99], v[56:59]
    v_mfma_f32_16x16x32_bf16 v[60:63], v[88:91], v[100:103], v[60:63]
    v_mfma_f32_16x16x32_bf16 v[60:63], v[92:95], v[96:99], v[60:63]
    s_waitcnt lgkmcnt(0)
    v_mfma_f32_16x16x32_bf16 v[32:35], v[128:131], v[160:163], v[32:35]
    v_mfma_f32_16x16x32_bf16 v[36:39], v[128:131], v[164:167], v[36:39]
    v_mfma_f32_16x16x32_bf16 v[40:43], v[128:131], v[168:171], v[40:43]
    ds_read_b128 v[96:99], v4 offset:3968
    v_mfma_f32_16x16x32_bf16 v[44:47], v[128:131], v[172:175], v[44:47]
    v_mfma_f32_16x16x32_bf16 v[48:51], v[128:131], v[176:179], v[48:51]
    ds_read_b128 v[64:67], v3 offset:384
    v_mfma_f32_16x16x32_bf16 v[52:55], v[128:131], v[180:183], v[52:55]
    v_mfma_f32_16x16x32_bf16 v[56:59], v[128:131], v[184:187], v[56:59]
    ds_read_b128 v[100:103], v4 offset:3456
    v_mfma_f32_16x16x32_bf16 v[60:63], v[128:131], v[188:191], v[60:63]
    v_mfma_f32_16x16x32_bf16 v[36:39], v[132:135], v[160:163], v[36:39]
    ds_read_b128 v[68:71], v3 offset:896
    v_mfma_f32_16x16x32_bf16 v[40:43], v[132:135], v[164:167], v[40:43]
    v_mfma_f32_16x16x32_bf16 v[44:47], v[132:135], v[168:171], v[44:47]
    ds_read_b128 v[104:107], v4 offset:2944
    v_mfma_f32_16x16x32_bf16 v[48:51], v[132:135], v[172:175], v[48:51]
    v_mfma_f32_16x16x32_bf16 v[52:55], v[132:135], v[176:179], v[52:55]
    ds_read_b128 v[72:75], v3 offset:1408
    v_mfma_f32_16x16x32_bf16 v[56:59], v[132:135], v[180:183], v[56:59]
    v_mfma_f32_16x16x32_bf16 v[60:63], v[132:135], v[184:187], v[60:63]
    ds_read_b128 v[108:111], v4 offset:2432
    v_mfma_f32_16x16x32_bf16 v[40:43], v[136:139], v[160:163], v[40:43]
    v_mfma_f32_16x16x32_bf16 v[44:47], v[136:139], v[164:167], v[44:47]
    ds_read_b128 v[76:79], v3 offset:1920
    v_mfma_f32_16x16x32_bf16 v[48:51], v[136:139], v[168:171], v[48:51]
    v_mfma_f32_16x16x32_bf16 v[52:55], v[136:139], v[172:175], v[52:55]
    ds_read_b128 v[112:115], v4 offset:1920
    v_mfma_f32_16x16x32_bf16 v[56:59], v[136:139], v[176:179], v[56:59]
    v_mfma_f32_16x16x32_bf16 v[60:63], v[136:139], v[180:183], v[60:63]
    ds_read_b128 v[80:83], v3 offset:2432
    v_mfma_f32_16x16x32_bf16 v[44:47], v[140:143], v[160:163], v[44:47]
    v_mfma_f32_16x16x32_bf16 v[48:51], v[140:143], v[164:167], v[48:51]
    ds_read_b128 v[116:119], v4 offset:1408
    v_mfma_f32_16x16x32_bf16 v[52:55], v[140:143], v[168:171], v[52:55]
    v_mfma_f32_16x16x32_bf16 v[56:59], v[140:143], v[172:175], v[56:59]
    ds_read_b128 v[84:87], v3 offset:2944
    v_mfma_f32_16x16x32_bf16 v[60:63], v[140:143], v[176:179], v[60:63]
    v_mfma_f32_16x16x32_bf16 v[48:51], v[144:147], v[160:163], v[48:51]
    ds_read_b128 v[120:123], v4 offset:896
    v_mfma_f32_16x16x32_bf16 v[52:55], v[144:147], v[164:167], v[52:55]
    v_mfma_f32_16x16x32_bf16 v[56:59], v[144:147], v[168:171], v[56:59]
    ds_read_b128 v[88:91], v3 offset:3456
    v_mfma_f32_16x16x32_bf16 v[60:63], v[144:147], v[172:175], v[60:63]
    v_mfma_f32_16x16x32_bf16 v[52:55], v[148:151], v[160:163], v[52:55]
    ds_read_b128 v[124:127], v4 offset:384
    v_mfma_f32_16x16x32_bf16 v[56:59], v[148:151], v[164:167], v[56:59]
    v_mfma_f32_16x16x32_bf16 v[60:63], v[148:151], v[168:171], v[60:63]
    ds_read_b128 v[92:95], v3 offset:3968
    v_mfma_f32_16x16x32_bf16 v[56:59], v[152:155], v[160:163], v[56:59]
    v_mfma_f32_16x16x32_bf16 v[60:63], v[152:155], v[164:167], v[60:63]
    v_mfma_f32_16x16x32_bf16 v[60:63], v[156:159], v[160:163], v[60:63]
    s_waitcnt lgkmcnt(0)
    s_waitcnt vmcnt(0)
    v_cmp_ne_u32 vcc, 1, v213
    s_nop 0
    s_cbranch_vccnz gated_mix__ssm_conv_h3__compressed_kv_cla__prompt_kernel_spin_l
gated_mix__ssm_conv_h3__compressed_kv_cla__prompt_kernel_spin_l_ret:
    v_mfma_f32_16x16x32_bf16 v[32:35], v[64:67], v[96:99], v[32:35]
    buffer_load_dwordx4 a[64:67], v16, s[16:19], s42 offen offset:0 sc1
    v_mfma_f32_16x16x32_bf16 v[36:39], v[64:67], v[100:103], v[36:39]
    buffer_load_dwordx4 a[68:71], v16, s[16:19], s42 offen offset:1024 sc1
    v_mfma_f32_16x16x32_bf16 v[40:43], v[64:67], v[104:107], v[40:43]
    ds_read_b128 v[160:163], v4 offset:4032
    v_mfma_f32_16x16x32_bf16 v[44:47], v[64:67], v[108:111], v[44:47]
    buffer_load_dwordx4 a[72:75], v16, s[16:19], s42 offen offset:2048 sc1
    v_mfma_f32_16x16x32_bf16 v[48:51], v[64:67], v[112:115], v[48:51]
    ds_read_b128 v[128:131], v3 offset:448
    v_mfma_f32_16x16x32_bf16 v[52:55], v[64:67], v[116:119], v[52:55]
    buffer_load_dwordx4 a[76:79], v16, s[16:19], s42 offen offset:3072 sc1
    v_mfma_f32_16x16x32_bf16 v[56:59], v[64:67], v[120:123], v[56:59]
    ds_read_b128 v[164:167], v4 offset:3520
    s_add_u32 s42, s42, 4096
    v_mfma_f32_16x16x32_bf16 v[60:63], v[64:67], v[124:127], v[60:63]
    buffer_load_dwordx4 a[80:83], v16, s[16:19], s42 offen offset:0 sc1
    v_mfma_f32_16x16x32_bf16 v[36:39], v[68:71], v[96:99], v[36:39]
    ds_read_b128 v[132:135], v3 offset:960
    v_mfma_f32_16x16x32_bf16 v[40:43], v[68:71], v[100:103], v[40:43]
    buffer_load_dwordx4 a[84:87], v16, s[16:19], s42 offen offset:1024 sc1
    v_mfma_f32_16x16x32_bf16 v[44:47], v[68:71], v[104:107], v[44:47]
    ds_read_b128 v[168:171], v4 offset:3008
    v_mfma_f32_16x16x32_bf16 v[48:51], v[68:71], v[108:111], v[48:51]
    buffer_load_dwordx4 a[88:91], v16, s[16:19], s42 offen offset:2048 sc1
    v_mfma_f32_16x16x32_bf16 v[52:55], v[68:71], v[112:115], v[52:55]
    ds_read_b128 v[136:139], v3 offset:1472
    v_mfma_f32_16x16x32_bf16 v[56:59], v[68:71], v[116:119], v[56:59]
    buffer_load_dwordx4 a[92:95], v16, s[16:19], s42 offen offset:3072 sc1
    v_mfma_f32_16x16x32_bf16 v[60:63], v[68:71], v[120:123], v[60:63]
    ds_read_b128 v[172:175], v4 offset:2496
    s_add_u32 s42, s42, 4096
    v_mfma_f32_16x16x32_bf16 v[40:43], v[72:75], v[96:99], v[40:43]
    buffer_load_dwordx4 a[96:99], v16, s[16:19], s42 offen offset:0 sc1
    v_mfma_f32_16x16x32_bf16 v[44:47], v[72:75], v[100:103], v[44:47]
    ds_read_b128 v[140:143], v3 offset:1984
    v_mfma_f32_16x16x32_bf16 v[48:51], v[72:75], v[104:107], v[48:51]
    buffer_load_dwordx4 a[100:103], v16, s[16:19], s42 offen offset:1024 sc1
    v_mfma_f32_16x16x32_bf16 v[52:55], v[72:75], v[108:111], v[52:55]
    ds_read_b128 v[176:179], v4 offset:1984
    v_mfma_f32_16x16x32_bf16 v[56:59], v[72:75], v[112:115], v[56:59]
    v_mfma_f32_16x16x32_bf16 v[60:63], v[72:75], v[116:119], v[60:63]
    ds_read_b128 v[144:147], v3 offset:2496
    v_mfma_f32_16x16x32_bf16 v[44:47], v[76:79], v[96:99], v[44:47]
    v_mfma_f32_16x16x32_bf16 v[48:51], v[76:79], v[100:103], v[48:51]
    ds_read_b128 v[180:183], v4 offset:1472
    v_mfma_f32_16x16x32_bf16 v[52:55], v[76:79], v[104:107], v[52:55]
    v_mfma_f32_16x16x32_bf16 v[56:59], v[76:79], v[108:111], v[56:59]
    ds_read_b128 v[148:151], v3 offset:3008
    v_mfma_f32_16x16x32_bf16 v[60:63], v[76:79], v[112:115], v[60:63]
    v_mfma_f32_16x16x32_bf16 v[48:51], v[80:83], v[96:99], v[48:51]
    ds_read_b128 v[184:187], v4 offset:960
    v_mfma_f32_16x16x32_bf16 v[52:55], v[80:83], v[100:103], v[52:55]
    v_mfma_f32_16x16x32_bf16 v[56:59], v[80:83], v[104:107], v[56:59]
    ds_read_b128 v[152:155], v3 offset:3520
    v_mfma_f32_16x16x32_bf16 v[60:63], v[80:83], v[108:111], v[60:63]
    v_mfma_f32_16x16x32_bf16 v[52:55], v[84:87], v[96:99], v[52:55]
    ds_read_b128 v[188:191], v4 offset:448
    v_mfma_f32_16x16x32_bf16 v[56:59], v[84:87], v[100:103], v[56:59]
    v_mfma_f32_16x16x32_bf16 v[60:63], v[84:87], v[104:107], v[60:63]
    ds_read_b128 v[156:159], v3 offset:4032
    v_mfma_f32_16x16x32_bf16 v[56:59], v[88:91], v[96:99], v[56:59]
    v_mfma_f32_16x16x32_bf16 v[60:63], v[88:91], v[100:103], v[60:63]
    v_mfma_f32_16x16x32_bf16 v[60:63], v[92:95], v[96:99], v[60:63]
    s_waitcnt lgkmcnt(0)
    s_barrier
    v_mfma_f32_16x16x32_bf16 v[32:35], v[128:131], v[160:163], v[32:35]
    ds_read_b64_tr_b16 a[128:129], v198 offset:55296
    ds_read_b64_tr_b16 a[130:131], v198 offset:59904
    v_mfma_f32_16x16x32_bf16 v[36:39], v[128:131], v[164:167], v[36:39]
    ds_read_b64_tr_b16 a[132:133], v199 offset:55296
    ds_read_b64_tr_b16 a[134:135], v199 offset:59904
    v_mfma_f32_16x16x32_bf16 v[40:43], v[128:131], v[168:171], v[40:43]
    ds_read_b64_tr_b16 a[136:137], v200 offset:55296
    ds_read_b64_tr_b16 a[138:139], v200 offset:59904
    v_mfma_f32_16x16x32_bf16 v[44:47], v[128:131], v[172:175], v[44:47]
    ds_read_b64_tr_b16 a[140:141], v201 offset:55296
    ds_read_b64_tr_b16 a[142:143], v201 offset:59904
    v_mfma_f32_16x16x32_bf16 v[48:51], v[128:131], v[176:179], v[48:51]
    ds_read_b64_tr_b16 a[144:145], v198 offset:55424
    ds_read_b64_tr_b16 a[146:147], v198 offset:60032
    v_mfma_f32_16x16x32_bf16 v[52:55], v[128:131], v[180:183], v[52:55]
    ds_read_b64_tr_b16 a[148:149], v199 offset:55424
    ds_read_b64_tr_b16 a[150:151], v199 offset:60032
    v_mfma_f32_16x16x32_bf16 v[56:59], v[128:131], v[184:187], v[56:59]
    ds_read_b64_tr_b16 a[152:153], v200 offset:55424
    ds_read_b64_tr_b16 a[154:155], v200 offset:60032
    v_mfma_f32_16x16x32_bf16 v[60:63], v[128:131], v[188:191], v[60:63]
    ds_read_b64_tr_b16 a[156:157], v201 offset:55424
    ds_read_b64_tr_b16 a[158:159], v201 offset:60032
    s_add_u32 m0, s59, 16384
    v_mfma_f32_16x16x32_bf16 v[36:39], v[132:135], v[160:163], v[36:39]
    buffer_load_dwordx4 v192, s[8:11], s40 offen offset:0 lds
    v_mfma_f32_16x16x32_bf16 v[40:43], v[132:135], v[164:167], v[40:43]
    buffer_load_dwordx4 v193, s[8:11], s40 offen offset:1152 lds
    v_mfma_f32_16x16x32_bf16 v[44:47], v[132:135], v[168:171], v[44:47]
    s_add_u32 s40, s40, 65536
    s_add_u32 m0, s59, 25600
    v_mov_b32 v64, 0
    v_mov_b32 v65, 0
    v_mfma_f32_16x16x32_bf16 v[48:51], v[132:135], v[172:175], v[48:51]
    buffer_load_dwordx4 v192, s[8:11], s40 offen offset:0 lds
    v_mfma_f32_16x16x32_bf16 v[52:55], v[132:135], v[176:179], v[52:55]
    buffer_load_dwordx4 v193, s[8:11], s40 offen offset:1152 lds
    v_mfma_f32_16x16x32_bf16 v[56:59], v[132:135], v[180:183], v[56:59]
    s_add_u32 s40, s40, 65536
    s_add_u32 m0, s59, 34816
    v_mov_b32 v66, 0
    v_mov_b32 v67, 0
    v_mfma_f32_16x16x32_bf16 v[60:63], v[132:135], v[184:187], v[60:63]
    buffer_load_dwordx4 v192, s[8:11], s40 offen offset:0 lds
    v_mfma_f32_16x16x32_bf16 v[40:43], v[136:139], v[160:163], v[40:43]
    buffer_load_dwordx4 v193, s[8:11], s40 offen offset:1152 lds
    v_mfma_f32_16x16x32_bf16 v[44:47], v[136:139], v[164:167], v[44:47]
    s_add_u32 s40, s40, 65536
    s_add_u32 m0, s59, 44032
    v_mov_b32 v68, 0
    v_mov_b32 v69, 0
    v_mfma_f32_16x16x32_bf16 v[48:51], v[136:139], v[168:171], v[48:51]
    buffer_load_dwordx4 v192, s[8:11], s40 offen offset:0 lds
    v_mfma_f32_16x16x32_bf16 v[52:55], v[136:139], v[172:175], v[52:55]
    buffer_load_dwordx4 v193, s[8:11], s40 offen offset:1152 lds
    v_mfma_f32_16x16x32_bf16 v[56:59], v[136:139], v[176:179], v[56:59]
    s_add_u32 s40, s40, 65536
    s_add_u32 m0, s59, 53248
    v_mov_b32 v70, 0
    v_mov_b32 v71, 0
    v_mfma_f32_16x16x32_bf16 v[60:63], v[136:139], v[180:183], v[60:63]
    buffer_load_dwordx4 v192, s[8:11], s40 offen offset:0 lds
    v_mfma_f32_16x16x32_bf16 v[44:47], v[140:143], v[160:163], v[44:47]
    buffer_load_dwordx4 v193, s[8:11], s40 offen offset:1152 lds
    v_mfma_f32_16x16x32_bf16 v[48:51], v[140:143], v[164:167], v[48:51]
    s_add_u32 s40, s40, 65536
    s_add_u32 m0, s59, 62464
    v_mov_b32 v72, 0
    v_mov_b32 v73, 0
    v_mfma_f32_16x16x32_bf16 v[52:55], v[140:143], v[168:171], v[52:55]
    buffer_load_dwordx4 v192, s[8:11], s40 offen offset:0 lds
    v_mfma_f32_16x16x32_bf16 v[56:59], v[140:143], v[172:175], v[56:59]
    buffer_load_dwordx4 v193, s[8:11], s40 offen offset:1152 lds
    v_mfma_f32_16x16x32_bf16 v[60:63], v[140:143], v[176:179], v[60:63]
    s_add_u32 s40, s40, 65536
    s_add_u32 m0, s59, 71680
    v_mov_b32 v74, 0
    v_mov_b32 v75, 0
    v_mfma_f32_16x16x32_bf16 v[48:51], v[144:147], v[160:163], v[48:51]
    buffer_load_dwordx4 v192, s[8:11], s40 offen offset:0 lds
    v_mfma_f32_16x16x32_bf16 v[52:55], v[144:147], v[164:167], v[52:55]
    buffer_load_dwordx4 v193, s[8:11], s40 offen offset:1152 lds
    v_mfma_f32_16x16x32_bf16 v[56:59], v[144:147], v[168:171], v[56:59]
    s_add_u32 s40, s40, 65536
    s_add_u32 m0, s59, 80896
    v_mov_b32 v76, 0
    v_mov_b32 v77, 0
    v_mfma_f32_16x16x32_bf16 v[60:63], v[144:147], v[172:175], v[60:63]
    buffer_load_dwordx4 v192, s[8:11], s40 offen offset:0 lds
    v_mfma_f32_16x16x32_bf16 v[52:55], v[148:151], v[160:163], v[52:55]
    buffer_load_dwordx4 v193, s[8:11], s40 offen offset:1152 lds
    v_mfma_f32_16x16x32_bf16 v[56:59], v[148:151], v[164:167], v[56:59]
    s_add_u32 s40, s40, 65536
    v_mov_b32 v78, 0
    v_mov_b32 v79, 0
    v_mfma_f32_16x16x32_bf16 v[60:63], v[148:151], v[168:171], v[60:63]
    v_mov_b32 v80, 0
    v_mov_b32 v81, 0
    v_mfma_f32_16x16x32_bf16 v[56:59], v[152:155], v[160:163], v[56:59]
    v_mov_b32 v82, 0
    v_mov_b32 v83, 0
    v_mfma_f32_16x16x32_bf16 v[60:63], v[152:155], v[164:167], v[60:63]
    v_mov_b32 v84, 0
    v_mov_b32 v85, 0
    v_mfma_f32_16x16x32_bf16 v[60:63], v[156:159], v[160:163], v[60:63]
    v_mov_b32 v86, 0
    v_mov_b32 v87, 0
    v_mov_b32 v88, 0
    v_mov_b32 v89, 0
    v_mov_b32 v90, 0
    v_mov_b32 v91, 0
    v_mov_b32 v92, 0
    v_mov_b32 v93, 0
    v_mov_b32 v94, 0
    v_mov_b32 v95, 0
    v_mov_b32 v96, 0
    v_mov_b32 v97, 0
    v_mov_b32 v98, 0
    v_mov_b32 v99, 0
    v_mov_b32 v100, 0
    v_mov_b32 v101, 0
    v_mov_b32 v102, 0
    v_mov_b32 v103, 0
    v_mov_b32 v104, 0
    v_mov_b32 v105, 0
    v_mov_b32 v106, 0
    v_mov_b32 v107, 0
    v_mov_b32 v108, 0
    v_mov_b32 v109, 0
    v_mov_b32 v110, 0
    v_mov_b32 v111, 0
    v_mov_b32 v112, 0
    v_mov_b32 v113, 0
    v_mov_b32 v114, 0
    v_mov_b32 v115, 0
    v_mov_b32 v116, 0
    v_mov_b32 v117, 0
    v_mov_b32 v118, 0
    v_mov_b32 v119, 0
    v_mov_b32 v120, 0
    v_mov_b32 v121, 0
    v_mov_b32 v122, 0
    v_mov_b32 v123, 0
    v_mov_b32 v124, 0
    v_mov_b32 v125, 0
    v_mov_b32 v126, 0
    v_mov_b32 v127, 0
    s_nop 4
    v_cvt_pk_bf16_f32 v32, v32, v33
    v_cvt_pk_bf16_f32 v33, v34, v35
    v_cvt_pk_bf16_f32 v36, v36, v37
    v_cvt_pk_bf16_f32 v37, v38, v39
    v_cvt_pk_bf16_f32 v40, v40, v41
    v_cvt_pk_bf16_f32 v41, v42, v43
    v_cvt_pk_bf16_f32 v44, v44, v45
    v_cvt_pk_bf16_f32 v45, v46, v47
    v_cvt_pk_bf16_f32 v48, v48, v49
    v_cvt_pk_bf16_f32 v49, v50, v51
    v_cvt_pk_bf16_f32 v52, v52, v53
    v_cvt_pk_bf16_f32 v53, v54, v55
    v_cvt_pk_bf16_f32 v56, v56, v57
    v_cvt_pk_bf16_f32 v57, v58, v59
    v_cvt_pk_bf16_f32 v60, v60, v61
    v_cvt_pk_bf16_f32 v61, v62, v63
    buffer_store_dwordx2 v[32:33], v5, s[12:15], s44 offen offset:0 sc1
    buffer_store_dwordx2 v[36:37], v5, s[12:15], s44 offen offset:512 sc1
    buffer_store_dwordx2 v[40:41], v5, s[12:15], s44 offen offset:1024 sc1
    buffer_store_dwordx2 v[44:45], v5, s[12:15], s44 offen offset:1536 sc1
    buffer_store_dwordx2 v[48:49], v5, s[12:15], s44 offen offset:2048 sc1
    buffer_store_dwordx2 v[52:53], v5, s[12:15], s44 offen offset:2560 sc1
    buffer_store_dwordx2 v[56:57], v5, s[12:15], s44 offen offset:3072 sc1
    buffer_store_dwordx2 v[60:61], v5, s[12:15], s44 offen offset:3584 sc1
    s_mov_b32 s35, 0
    s_waitcnt vmcnt(33) lgkmcnt(0)
.p2align 6
gated_mix__ssm_conv_h3__compressed_kv_cla__prompt_kernel_oloop:
    v_mfma_f32_16x16x32_bf16 v[64:67], a[128:131], a[0:3], v[64:67]
    ds_read_b64_tr_b16 a[160:161], v202 offset:0
    ds_read_b64_tr_b16 a[162:163], v202 offset:4608
    v_mfma_f32_16x16x32_bf16 v[68:71], a[128:131], a[64:67], v[68:71]
    buffer_load_dwordx4 a[60:63], v16, s[16:19], s41 offen offset:3072 sc1
    v_mfma_f32_16x16x32_bf16 v[72:75], a[132:135], a[0:3], v[72:75]
    s_add_u32 s41, s41, 4096
    ds_read_b64_tr_b16 a[164:165], v203 offset:0
    ds_read_b64_tr_b16 a[166:167], v203 offset:4608
    v_mfma_f32_16x16x32_bf16 v[76:79], a[132:135], a[64:67], v[76:79]
    s_add_u32 m0, s59, 90112
    ds_read_b64_tr_b16 a[168:169], v204 offset:0
    ds_read_b64_tr_b16 a[170:171], v204 offset:4608
    v_mfma_f32_16x16x32_bf16 v[80:83], a[136:139], a[0:3], v[80:83]
    ds_read_b64_tr_b16 a[172:173], v205 offset:0
    ds_read_b64_tr_b16 a[174:175], v205 offset:4608
    v_mfma_f32_16x16x32_bf16 v[84:87], a[136:139], a[64:67], v[84:87]
    buffer_load_dwordx4 v192, s[8:11], s40 offen offset:0 lds
    v_mfma_f32_16x16x32_bf16 v[88:91], a[140:143], a[0:3], v[88:91]
    ds_read_b64_tr_b16 a[176:177], v202 offset:128
    ds_read_b64_tr_b16 a[178:179], v202 offset:4736
    v_mfma_f32_16x16x32_bf16 v[92:95], a[140:143], a[64:67], v[92:95]
    ds_read_b64_tr_b16 a[180:181], v203 offset:128
    ds_read_b64_tr_b16 a[182:183], v203 offset:4736
    v_mfma_f32_16x16x32_bf16 v[96:99], a[144:147], a[0:3], v[96:99]
    ds_read_b64_tr_b16 a[184:185], v204 offset:128
    ds_read_b64_tr_b16 a[186:187], v204 offset:4736
    v_mfma_f32_16x16x32_bf16 v[100:103], a[144:147], a[64:67], v[100:103]
    buffer_load_dwordx4 a[104:107], v16, s[16:19], s42 offen offset:2048 sc1
    v_mfma_f32_16x16x32_bf16 v[104:107], a[148:151], a[0:3], v[104:107]
    ds_read_b64_tr_b16 a[188:189], v205 offset:128
    ds_read_b64_tr_b16 a[190:191], v205 offset:4736
    v_mfma_f32_16x16x32_bf16 v[108:111], a[148:151], a[64:67], v[108:111]
    v_mfma_f32_16x16x32_bf16 v[112:115], a[152:155], a[0:3], v[112:115]
    v_mfma_f32_16x16x32_bf16 v[116:119], a[152:155], a[64:67], v[116:119]
    buffer_load_dwordx4 v193, s[8:11], s40 offen offset:1152 lds
    v_mfma_f32_16x16x32_bf16 v[120:123], a[156:159], a[0:3], v[120:123]
    s_add_u32 s40, s40, 65536
    v_mfma_f32_16x16x32_bf16 v[124:127], a[156:159], a[64:67], v[124:127]
    s_waitcnt vmcnt(24) lgkmcnt(0)
    s_barrier
    v_mfma_f32_16x16x32_bf16 v[64:67], a[160:163], a[4:7], v[64:67]
    ds_read_b64_tr_b16 a[128:129], v202 offset:9216
    ds_read_b64_tr_b16 a[130:131], v202 offset:13824
    v_mfma_f32_16x16x32_bf16 v[68:71], a[160:163], a[68:71], v[68:71]
    buffer_load_dwordx4 a[0:3], v16, s[16:19], s41 offen offset:0 sc1
    v_mfma_f32_16x16x32_bf16 v[72:75], a[164:167], a[4:7], v[72:75]
    ds_read_b64_tr_b16 a[132:133], v203 offset:9216
    ds_read_b64_tr_b16 a[134:135], v203 offset:13824
    v_mfma_f32_16x16x32_bf16 v[76:79], a[164:167], a[68:71], v[76:79]
    s_add_u32 m0, s59, 99328
    ds_read_b64_tr_b16 a[136:137], v204 offset:9216
    ds_read_b64_tr_b16 a[138:139], v204 offset:13824
    v_mfma_f32_16x16x32_bf16 v[80:83], a[168:171], a[4:7], v[80:83]
    ds_read_b64_tr_b16 a[140:141], v205 offset:9216
    ds_read_b64_tr_b16 a[142:143], v205 offset:13824
    v_mfma_f32_16x16x32_bf16 v[84:87], a[168:171], a[68:71], v[84:87]
    buffer_load_dwordx4 v192, s[8:11], s40 offen offset:0 lds
    v_mfma_f32_16x16x32_bf16 v[88:91], a[172:175], a[4:7], v[88:91]
    ds_read_b64_tr_b16 a[144:145], v202 offset:9344
    ds_read_b64_tr_b16 a[146:147], v202 offset:13952
    v_mfma_f32_16x16x32_bf16 v[92:95], a[172:175], a[68:71], v[92:95]
    ds_read_b64_tr_b16 a[148:149], v203 offset:9344
    ds_read_b64_tr_b16 a[150:151], v203 offset:13952
    v_mfma_f32_16x16x32_bf16 v[96:99], a[176:179], a[4:7], v[96:99]
    ds_read_b64_tr_b16 a[152:153], v204 offset:9344
    ds_read_b64_tr_b16 a[154:155], v204 offset:13952
    v_mfma_f32_16x16x32_bf16 v[100:103], a[176:179], a[68:71], v[100:103]
    buffer_load_dwordx4 a[108:111], v16, s[16:19], s42 offen offset:3072 sc1
    v_mfma_f32_16x16x32_bf16 v[104:107], a[180:183], a[4:7], v[104:107]
    s_add_u32 s42, s42, 4096
    ds_read_b64_tr_b16 a[156:157], v205 offset:9344
    ds_read_b64_tr_b16 a[158:159], v205 offset:13952
    v_mfma_f32_16x16x32_bf16 v[108:111], a[180:183], a[68:71], v[108:111]
    v_mfma_f32_16x16x32_bf16 v[112:115], a[184:187], a[4:7], v[112:115]
    v_mfma_f32_16x16x32_bf16 v[116:119], a[184:187], a[68:71], v[116:119]
    buffer_load_dwordx4 v193, s[8:11], s40 offen offset:1152 lds
    v_mfma_f32_16x16x32_bf16 v[120:123], a[188:191], a[4:7], v[120:123]
    s_add_u32 s40, s40, 65536
    v_mfma_f32_16x16x32_bf16 v[124:127], a[188:191], a[68:71], v[124:127]
    s_waitcnt lgkmcnt(0)
    v_mfma_f32_16x16x32_bf16 v[64:67], a[128:131], a[8:11], v[64:67]
    ds_read_b64_tr_b16 a[160:161], v194 offset:0
    ds_read_b64_tr_b16 a[162:163], v194 offset:4608
    v_mfma_f32_16x16x32_bf16 v[68:71], a[128:131], a[72:75], v[68:71]
    buffer_load_dwordx4 a[4:7], v16, s[16:19], s41 offen offset:1024 sc1
    v_mfma_f32_16x16x32_bf16 v[72:75], a[132:135], a[8:11], v[72:75]
    ds_read_b64_tr_b16 a[164:165], v195 offset:0
    ds_read_b64_tr_b16 a[166:167], v195 offset:4608
    v_mfma_f32_16x16x32_bf16 v[76:79], a[132:135], a[72:75], v[76:79]
    s_add_u32 m0, s59, 108544
    ds_read_b64_tr_b16 a[168:169], v196 offset:0
    ds_read_b64_tr_b16 a[170:171], v196 offset:4608
    v_mfma_f32_16x16x32_bf16 v[80:83], a[136:139], a[8:11], v[80:83]
    ds_read_b64_tr_b16 a[172:173], v197 offset:0
    ds_read_b64_tr_b16 a[174:175], v197 offset:4608
    v_mfma_f32_16x16x32_bf16 v[84:87], a[136:139], a[72:75], v[84:87]
    buffer_load_dwordx4 v192, s[8:11], s40 offen offset:0 lds
    v_mfma_f32_16x16x32_bf16 v[88:91], a[140:143], a[8:11], v[88:91]
    ds_read_b64_tr_b16 a[176:177], v194 offset:128
    ds_read_b64_tr_b16 a[178:179], v194 offset:4736
    v_mfma_f32_16x16x32_bf16 v[92:95], a[140:143], a[72:75], v[92:95]
    ds_read_b64_tr_b16 a[180:181], v195 offset:128
    ds_read_b64_tr_b16 a[182:183], v195 offset:4736
    v_mfma_f32_16x16x32_bf16 v[96:99], a[144:147], a[8:11], v[96:99]
    ds_read_b64_tr_b16 a[184:185], v196 offset:128
    ds_read_b64_tr_b16 a[186:187], v196 offset:4736
    v_mfma_f32_16x16x32_bf16 v[100:103], a[144:147], a[72:75], v[100:103]
    buffer_load_dwordx4 a[112:115], v16, s[16:19], s42 offen offset:0 sc1
    v_mfma_f32_16x16x32_bf16 v[104:107], a[148:151], a[8:11], v[104:107]
    ds_read_b64_tr_b16 a[188:189], v197 offset:128
    ds_read_b64_tr_b16 a[190:191], v197 offset:4736
    v_mfma_f32_16x16x32_bf16 v[108:111], a[148:151], a[72:75], v[108:111]
    v_mfma_f32_16x16x32_bf16 v[112:115], a[152:155], a[8:11], v[112:115]
    v_mfma_f32_16x16x32_bf16 v[116:119], a[152:155], a[72:75], v[116:119]
    buffer_load_dwordx4 v193, s[8:11], s40 offen offset:1152 lds
    v_mfma_f32_16x16x32_bf16 v[120:123], a[156:159], a[8:11], v[120:123]
    s_add_u32 s40, s40, 65536
    v_mfma_f32_16x16x32_bf16 v[124:127], a[156:159], a[72:75], v[124:127]
    s_waitcnt vmcnt(24) lgkmcnt(0)
    s_barrier
    v_mfma_f32_16x16x32_bf16 v[64:67], a[160:163], a[12:15], v[64:67]
    ds_read_b64_tr_b16 a[128:129], v194 offset:9216
    ds_read_b64_tr_b16 a[130:131], v194 offset:13824
    v_mfma_f32_16x16x32_bf16 v[68:71], a[160:163], a[76:79], v[68:71]
    buffer_load_dwordx4 a[8:11], v16, s[16:19], s41 offen offset:2048 sc1
    v_mfma_f32_16x16x32_bf16 v[72:75], a[164:167], a[12:15], v[72:75]
    ds_read_b64_tr_b16 a[132:133], v195 offset:9216
    ds_read_b64_tr_b16 a[134:135], v195 offset:13824
    v_mfma_f32_16x16x32_bf16 v[76:79], a[164:167], a[76:79], v[76:79]
    s_add_u32 m0, s59, 117760
    ds_read_b64_tr_b16 a[136:137], v196 offset:9216
    ds_read_b64_tr_b16 a[138:139], v196 offset:13824
    v_mfma_f32_16x16x32_bf16 v[80:83], a[168:171], a[12:15], v[80:83]
    ds_read_b64_tr_b16 a[140:141], v197 offset:9216
    ds_read_b64_tr_b16 a[142:143], v197 offset:13824
    v_mfma_f32_16x16x32_bf16 v[84:87], a[168:171], a[76:79], v[84:87]
    buffer_load_dwordx4 v192, s[8:11], s40 offen offset:0 lds
    v_mfma_f32_16x16x32_bf16 v[88:91], a[172:175], a[12:15], v[88:91]
    ds_read_b64_tr_b16 a[144:145], v194 offset:9344
    ds_read_b64_tr_b16 a[146:147], v194 offset:13952
    v_mfma_f32_16x16x32_bf16 v[92:95], a[172:175], a[76:79], v[92:95]
    ds_read_b64_tr_b16 a[148:149], v195 offset:9344
    ds_read_b64_tr_b16 a[150:151], v195 offset:13952
    v_mfma_f32_16x16x32_bf16 v[96:99], a[176:179], a[12:15], v[96:99]
    ds_read_b64_tr_b16 a[152:153], v196 offset:9344
    ds_read_b64_tr_b16 a[154:155], v196 offset:13952
    v_mfma_f32_16x16x32_bf16 v[100:103], a[176:179], a[76:79], v[100:103]
    buffer_load_dwordx4 a[116:119], v16, s[16:19], s42 offen offset:1024 sc1
    v_mfma_f32_16x16x32_bf16 v[104:107], a[180:183], a[12:15], v[104:107]
    ds_read_b64_tr_b16 a[156:157], v197 offset:9344
    ds_read_b64_tr_b16 a[158:159], v197 offset:13952
    v_mfma_f32_16x16x32_bf16 v[108:111], a[180:183], a[76:79], v[108:111]
    v_mfma_f32_16x16x32_bf16 v[112:115], a[184:187], a[12:15], v[112:115]
    v_mfma_f32_16x16x32_bf16 v[116:119], a[184:187], a[76:79], v[116:119]
    buffer_load_dwordx4 v193, s[8:11], s40 offen offset:1152 lds
    v_mfma_f32_16x16x32_bf16 v[120:123], a[188:191], a[12:15], v[120:123]
    s_add_u32 s40, s40, 65536
    v_mfma_f32_16x16x32_bf16 v[124:127], a[188:191], a[76:79], v[124:127]
    s_waitcnt lgkmcnt(0)
    v_mfma_f32_16x16x32_bf16 v[64:67], a[128:131], a[16:19], v[64:67]
    ds_read_b64_tr_b16 a[160:161], v194 offset:18432
    ds_read_b64_tr_b16 a[162:163], v194 offset:23040
    v_mfma_f32_16x16x32_bf16 v[68:71], a[128:131], a[80:83], v[68:71]
    buffer_load_dwordx4 a[12:15], v16, s[16:19], s41 offen offset:3072 sc1
    v_mfma_f32_16x16x32_bf16 v[72:75], a[132:135], a[16:19], v[72:75]
    s_add_u32 s41, s41, 4096
    ds_read_b64_tr_b16 a[164:165], v195 offset:18432
    ds_read_b64_tr_b16 a[166:167], v195 offset:23040
    v_mfma_f32_16x16x32_bf16 v[76:79], a[132:135], a[80:83], v[76:79]
    s_add_u32 m0, s59, 126976
    ds_read_b64_tr_b16 a[168:169], v196 offset:18432
    ds_read_b64_tr_b16 a[170:171], v196 offset:23040
    v_mfma_f32_16x16x32_bf16 v[80:83], a[136:139], a[16:19], v[80:83]
    ds_read_b64_tr_b16 a[172:173], v197 offset:18432
    ds_read_b64_tr_b16 a[174:175], v197 offset:23040
    v_mfma_f32_16x16x32_bf16 v[84:87], a[136:139], a[80:83], v[84:87]
    buffer_load_dwordx4 v192, s[8:11], s40 offen offset:0 lds
    v_mfma_f32_16x16x32_bf16 v[88:91], a[140:143], a[16:19], v[88:91]
    ds_read_b64_tr_b16 a[176:177], v194 offset:18560
    ds_read_b64_tr_b16 a[178:179], v194 offset:23168
    v_mfma_f32_16x16x32_bf16 v[92:95], a[140:143], a[80:83], v[92:95]
    ds_read_b64_tr_b16 a[180:181], v195 offset:18560
    ds_read_b64_tr_b16 a[182:183], v195 offset:23168
    v_mfma_f32_16x16x32_bf16 v[96:99], a[144:147], a[16:19], v[96:99]
    ds_read_b64_tr_b16 a[184:185], v196 offset:18560
    ds_read_b64_tr_b16 a[186:187], v196 offset:23168
    v_mfma_f32_16x16x32_bf16 v[100:103], a[144:147], a[80:83], v[100:103]
    buffer_load_dwordx4 a[120:123], v16, s[16:19], s42 offen offset:2048 sc1
    v_mfma_f32_16x16x32_bf16 v[104:107], a[148:151], a[16:19], v[104:107]
    ds_read_b64_tr_b16 a[188:189], v197 offset:18560
    ds_read_b64_tr_b16 a[190:191], v197 offset:23168
    v_mfma_f32_16x16x32_bf16 v[108:111], a[148:151], a[80:83], v[108:111]
    v_mfma_f32_16x16x32_bf16 v[112:115], a[152:155], a[16:19], v[112:115]
    v_mfma_f32_16x16x32_bf16 v[116:119], a[152:155], a[80:83], v[116:119]
    buffer_load_dwordx4 v193, s[8:11], s40 offen offset:1152 lds
    v_mfma_f32_16x16x32_bf16 v[120:123], a[156:159], a[16:19], v[120:123]
    s_add_u32 s40, s40, 65536
    v_mfma_f32_16x16x32_bf16 v[124:127], a[156:159], a[80:83], v[124:127]
    s_waitcnt vmcnt(24) lgkmcnt(0)
    s_barrier
    v_mfma_f32_16x16x32_bf16 v[64:67], a[160:163], a[20:23], v[64:67]
    ds_read_b64_tr_b16 a[128:129], v194 offset:27648
    ds_read_b64_tr_b16 a[130:131], v194 offset:32256
    v_mfma_f32_16x16x32_bf16 v[68:71], a[160:163], a[84:87], v[68:71]
    buffer_load_dwordx4 a[16:19], v16, s[16:19], s41 offen offset:0 sc1
    v_mfma_f32_16x16x32_bf16 v[72:75], a[164:167], a[20:23], v[72:75]
    ds_read_b64_tr_b16 a[132:133], v195 offset:27648
    ds_read_b64_tr_b16 a[134:135], v195 offset:32256
    v_mfma_f32_16x16x32_bf16 v[76:79], a[164:167], a[84:87], v[76:79]
    s_add_u32 m0, s59, 136192
    ds_read_b64_tr_b16 a[136:137], v196 offset:27648
    ds_read_b64_tr_b16 a[138:139], v196 offset:32256
    v_mfma_f32_16x16x32_bf16 v[80:83], a[168:171], a[20:23], v[80:83]
    ds_read_b64_tr_b16 a[140:141], v197 offset:27648
    ds_read_b64_tr_b16 a[142:143], v197 offset:32256
    v_mfma_f32_16x16x32_bf16 v[84:87], a[168:171], a[84:87], v[84:87]
    buffer_load_dwordx4 v192, s[8:11], s40 offen offset:0 lds
    v_mfma_f32_16x16x32_bf16 v[88:91], a[172:175], a[20:23], v[88:91]
    ds_read_b64_tr_b16 a[144:145], v194 offset:27776
    ds_read_b64_tr_b16 a[146:147], v194 offset:32384
    v_mfma_f32_16x16x32_bf16 v[92:95], a[172:175], a[84:87], v[92:95]
    ds_read_b64_tr_b16 a[148:149], v195 offset:27776
    ds_read_b64_tr_b16 a[150:151], v195 offset:32384
    v_mfma_f32_16x16x32_bf16 v[96:99], a[176:179], a[20:23], v[96:99]
    ds_read_b64_tr_b16 a[152:153], v196 offset:27776
    ds_read_b64_tr_b16 a[154:155], v196 offset:32384
    v_mfma_f32_16x16x32_bf16 v[100:103], a[176:179], a[84:87], v[100:103]
    buffer_load_dwordx4 a[124:127], v16, s[16:19], s42 offen offset:3072 sc1
    v_mfma_f32_16x16x32_bf16 v[104:107], a[180:183], a[20:23], v[104:107]
    s_add_u32 s42, s42, 4096
    ds_read_b64_tr_b16 a[156:157], v197 offset:27776
    ds_read_b64_tr_b16 a[158:159], v197 offset:32384
    v_mfma_f32_16x16x32_bf16 v[108:111], a[180:183], a[84:87], v[108:111]
    s_cmp_lg_u32 s35, 0
    v_mfma_f32_16x16x32_bf16 v[112:115], a[184:187], a[20:23], v[112:115]
    s_cbranch_scc1 gated_mix__ssm_conv_h3__compressed_kv_cla__prompt_kernel_hook
gated_mix__ssm_conv_h3__compressed_kv_cla__prompt_kernel_hook_ret:
    v_mfma_f32_16x16x32_bf16 v[116:119], a[184:187], a[84:87], v[116:119]
    buffer_load_dwordx4 v193, s[8:11], s40 offen offset:1152 lds
    v_mfma_f32_16x16x32_bf16 v[120:123], a[188:191], a[20:23], v[120:123]
    s_add_u32 s40, s40, 65536
    v_mfma_f32_16x16x32_bf16 v[124:127], a[188:191], a[84:87], v[124:127]
    s_waitcnt lgkmcnt(0)
    v_mfma_f32_16x16x32_bf16 v[64:67], a[128:131], a[24:27], v[64:67]
    ds_read_b64_tr_b16 a[160:161], v194 offset:36864
    ds_read_b64_tr_b16 a[162:163], v194 offset:41472
    v_mfma_f32_16x16x32_bf16 v[68:71], a[128:131], a[88:91], v[68:71]
    buffer_load_dwordx4 a[20:23], v16, s[16:19], s41 offen offset:1024 sc1
    v_mfma_f32_16x16x32_bf16 v[72:75], a[132:135], a[24:27], v[72:75]
    ds_read_b64_tr_b16 a[164:165], v195 offset:36864
    ds_read_b64_tr_b16 a[166:167], v195 offset:41472
    v_mfma_f32_16x16x32_bf16 v[76:79], a[132:135], a[88:91], v[76:79]
    s_add_u32 m0, s59, 145408
    ds_read_b64_tr_b16 a[168:169], v196 offset:36864
    ds_read_b64_tr_b16 a[170:171], v196 offset:41472
    v_mfma_f32_16x16x32_bf16 v[80:83], a[136:139], a[24:27], v[80:83]
    ds_read_b64_tr_b16 a[172:173], v197 offset:36864
    ds_read_b64_tr_b16 a[174:175], v197 offset:41472
    v_mfma_f32_16x16x32_bf16 v[84:87], a[136:139], a[88:91], v[84:87]
    buffer_load_dwordx4 v192, s[8:11], s40 offen offset:0 lds
    v_mfma_f32_16x16x32_bf16 v[88:91], a[140:143], a[24:27], v[88:91]
    ds_read_b64_tr_b16 a[176:177], v194 offset:36992
    ds_read_b64_tr_b16 a[178:179], v194 offset:41600
    v_mfma_f32_16x16x32_bf16 v[92:95], a[140:143], a[88:91], v[92:95]
    ds_read_b64_tr_b16 a[180:181], v195 offset:36992
    ds_read_b64_tr_b16 a[182:183], v195 offset:41600
    v_mfma_f32_16x16x32_bf16 v[96:99], a[144:147], a[24:27], v[96:99]
    ds_read_b64_tr_b16 a[184:185], v196 offset:36992
    ds_read_b64_tr_b16 a[186:187], v196 offset:41600
    v_mfma_f32_16x16x32_bf16 v[100:103], a[144:147], a[88:91], v[100:103]
    buffer_load_dwordx4 a[64:67], v16, s[16:19], s42 offen offset:0 sc1
    v_mfma_f32_16x16x32_bf16 v[104:107], a[148:151], a[24:27], v[104:107]
    ds_read_b64_tr_b16 a[188:189], v197 offset:36992
    ds_read_b64_tr_b16 a[190:191], v197 offset:41600
    v_mfma_f32_16x16x32_bf16 v[108:111], a[148:151], a[88:91], v[108:111]
    v_mfma_f32_16x16x32_bf16 v[112:115], a[152:155], a[24:27], v[112:115]
    v_mfma_f32_16x16x32_bf16 v[116:119], a[152:155], a[88:91], v[116:119]
    buffer_load_dwordx4 v193, s[8:11], s40 offen offset:1152 lds
    v_mfma_f32_16x16x32_bf16 v[120:123], a[156:159], a[24:27], v[120:123]
    s_add_u32 s40, s40, 65536
    v_mfma_f32_16x16x32_bf16 v[124:127], a[156:159], a[88:91], v[124:127]
    s_waitcnt vmcnt(24) lgkmcnt(0)
    s_barrier
    v_mfma_f32_16x16x32_bf16 v[64:67], a[160:163], a[28:31], v[64:67]
    ds_read_b64_tr_b16 a[128:129], v194 offset:46080
    ds_read_b64_tr_b16 a[130:131], v194 offset:50688
    v_mfma_f32_16x16x32_bf16 v[68:71], a[160:163], a[92:95], v[68:71]
    buffer_load_dwordx4 a[24:27], v16, s[16:19], s41 offen offset:2048 sc1
    v_mfma_f32_16x16x32_bf16 v[72:75], a[164:167], a[28:31], v[72:75]
    ds_read_b64_tr_b16 a[132:133], v195 offset:46080
    ds_read_b64_tr_b16 a[134:135], v195 offset:50688
    v_mfma_f32_16x16x32_bf16 v[76:79], a[164:167], a[92:95], v[76:79]
    s_add_u32 m0, s59, 154624
    ds_read_b64_tr_b16 a[136:137], v196 offset:46080
    ds_read_b64_tr_b16 a[138:139], v196 offset:50688
    v_mfma_f32_16x16x32_bf16 v[80:83], a[168:171], a[28:31], v[80:83]
    ds_read_b64_tr_b16 a[140:141], v197 offset:46080
    ds_read_b64_tr_b16 a[142:143], v197 offset:50688
    v_mfma_f32_16x16x32_bf16 v[84:87], a[168:171], a[92:95], v[84:87]
    buffer_load_dwordx4 v192, s[8:11], s40 offen offset:0 lds
    v_mfma_f32_16x16x32_bf16 v[88:91], a[172:175], a[28:31], v[88:91]
    ds_read_b64_tr_b16 a[144:145], v194 offset:46208
    ds_read_b64_tr_b16 a[146:147], v194 offset:50816
    v_mfma_f32_16x16x32_bf16 v[92:95], a[172:175], a[92:95], v[92:95]
    ds_read_b64_tr_b16 a[148:149], v195 offset:46208
    ds_read_b64_tr_b16 a[150:151], v195 offset:50816
    v_mfma_f32_16x16x32_bf16 v[96:99], a[176:179], a[28:31], v[96:99]
    ds_read_b64_tr_b16 a[152:153], v196 offset:46208
    ds_read_b64_tr_b16 a[154:155], v196 offset:50816
    v_mfma_f32_16x16x32_bf16 v[100:103], a[176:179], a[92:95], v[100:103]
    buffer_load_dwordx4 a[68:71], v16, s[16:19], s42 offen offset:1024 sc1
    v_mfma_f32_16x16x32_bf16 v[104:107], a[180:183], a[28:31], v[104:107]
    ds_read_b64_tr_b16 a[156:157], v197 offset:46208
    ds_read_b64_tr_b16 a[158:159], v197 offset:50816
    v_mfma_f32_16x16x32_bf16 v[108:111], a[180:183], a[92:95], v[108:111]
    v_mfma_f32_16x16x32_bf16 v[112:115], a[184:187], a[28:31], v[112:115]
    v_mfma_f32_16x16x32_bf16 v[116:119], a[184:187], a[92:95], v[116:119]
    buffer_load_dwordx4 v193, s[8:11], s40 offen offset:1152 lds
    v_mfma_f32_16x16x32_bf16 v[120:123], a[188:191], a[28:31], v[120:123]
    s_add_u32 s40, s40, 65536
    v_mfma_f32_16x16x32_bf16 v[124:127], a[188:191], a[92:95], v[124:127]
    s_waitcnt lgkmcnt(0)
    v_mfma_f32_16x16x32_bf16 v[64:67], a[128:131], a[32:35], v[64:67]
    ds_read_b64_tr_b16 a[160:161], v194 offset:55296
    ds_read_b64_tr_b16 a[162:163], v194 offset:59904
    v_mfma_f32_16x16x32_bf16 v[68:71], a[128:131], a[96:99], v[68:71]
    buffer_load_dwordx4 a[28:31], v16, s[16:19], s41 offen offset:3072 sc1
    v_mfma_f32_16x16x32_bf16 v[72:75], a[132:135], a[32:35], v[72:75]
    s_add_u32 s41, s41, 4096
    ds_read_b64_tr_b16 a[164:165], v195 offset:55296
    ds_read_b64_tr_b16 a[166:167], v195 offset:59904
    v_mfma_f32_16x16x32_bf16 v[76:79], a[132:135], a[96:99], v[76:79]
    s_add_u32 m0, s59, 16384
    ds_read_b64_tr_b16 a[168:169], v196 offset:55296
    ds_read_b64_tr_b16 a[170:171], v196 offset:59904
    v_mfma_f32_16x16x32_bf16 v[80:83], a[136:139], a[32:35], v[80:83]
    ds_read_b64_tr_b16 a[172:173], v197 offset:55296
    ds_read_b64_tr_b16 a[174:175], v197 offset:59904
    v_mfma_f32_16x16x32_bf16 v[84:87], a[136:139], a[96:99], v[84:87]
    buffer_load_dwordx4 v192, s[8:11], s40 offen offset:0 lds
    v_mfma_f32_16x16x32_bf16 v[88:91], a[140:143], a[32:35], v[88:91]
    ds_read_b64_tr_b16 a[176:177], v194 offset:55424
    ds_read_b64_tr_b16 a[178:179], v194 offset:60032
    v_mfma_f32_16x16x32_bf16 v[92:95], a[140:143], a[96:99], v[92:95]
    ds_read_b64_tr_b16 a[180:181], v195 offset:55424
    ds_read_b64_tr_b16 a[182:183], v195 offset:60032
    v_mfma_f32_16x16x32_bf16 v[96:99], a[144:147], a[32:35], v[96:99]
    ds_read_b64_tr_b16 a[184:185], v196 offset:55424
    ds_read_b64_tr_b16 a[186:187], v196 offset:60032
    v_mfma_f32_16x16x32_bf16 v[100:103], a[144:147], a[96:99], v[100:103]
    buffer_load_dwordx4 a[72:75], v16, s[16:19], s42 offen offset:2048 sc1
    v_mfma_f32_16x16x32_bf16 v[104:107], a[148:151], a[32:35], v[104:107]
    ds_read_b64_tr_b16 a[188:189], v197 offset:55424
    ds_read_b64_tr_b16 a[190:191], v197 offset:60032
    v_mfma_f32_16x16x32_bf16 v[108:111], a[148:151], a[96:99], v[108:111]
    v_mfma_f32_16x16x32_bf16 v[112:115], a[152:155], a[32:35], v[112:115]
    v_mfma_f32_16x16x32_bf16 v[116:119], a[152:155], a[96:99], v[116:119]
    buffer_load_dwordx4 v193, s[8:11], s40 offen offset:1152 lds
    v_mfma_f32_16x16x32_bf16 v[120:123], a[156:159], a[32:35], v[120:123]
    s_add_u32 s40, s40, 65536
    v_mfma_f32_16x16x32_bf16 v[124:127], a[156:159], a[96:99], v[124:127]
    s_waitcnt vmcnt(24) lgkmcnt(0)
    s_barrier
    v_mfma_f32_16x16x32_bf16 v[64:67], a[160:163], a[36:39], v[64:67]
    ds_read_b64_tr_b16 a[128:129], v198 offset:0
    ds_read_b64_tr_b16 a[130:131], v198 offset:4608
    v_mfma_f32_16x16x32_bf16 v[68:71], a[160:163], a[100:103], v[68:71]
    buffer_load_dwordx4 a[32:35], v16, s[16:19], s41 offen offset:0 sc1
    v_mfma_f32_16x16x32_bf16 v[72:75], a[164:167], a[36:39], v[72:75]
    ds_read_b64_tr_b16 a[132:133], v199 offset:0
    ds_read_b64_tr_b16 a[134:135], v199 offset:4608
    v_mfma_f32_16x16x32_bf16 v[76:79], a[164:167], a[100:103], v[76:79]
    s_add_u32 m0, s59, 25600
    ds_read_b64_tr_b16 a[136:137], v200 offset:0
    ds_read_b64_tr_b16 a[138:139], v200 offset:4608
    v_mfma_f32_16x16x32_bf16 v[80:83], a[168:171], a[36:39], v[80:83]
    ds_read_b64_tr_b16 a[140:141], v201 offset:0
    ds_read_b64_tr_b16 a[142:143], v201 offset:4608
    v_mfma_f32_16x16x32_bf16 v[84:87], a[168:171], a[100:103], v[84:87]
    buffer_load_dwordx4 v192, s[8:11], s40 offen offset:0 lds
    v_mfma_f32_16x16x32_bf16 v[88:91], a[172:175], a[36:39], v[88:91]
    ds_read_b64_tr_b16 a[144:145], v198 offset:128
    ds_read_b64_tr_b16 a[146:147], v198 offset:4736
    v_mfma_f32_16x16x32_bf16 v[92:95], a[172:175], a[100:103], v[92:95]
    ds_read_b64_tr_b16 a[148:149], v199 offset:128
    ds_read_b64_tr_b16 a[150:151], v199 offset:4736
    v_mfma_f32_16x16x32_bf16 v[96:99], a[176:179], a[36:39], v[96:99]
    ds_read_b64_tr_b16 a[152:153], v200 offset:128
    ds_read_b64_tr_b16 a[154:155], v200 offset:4736
    v_mfma_f32_16x16x32_bf16 v[100:103], a[176:179], a[100:103], v[100:103]
    buffer_load_dwordx4 a[76:79], v16, s[16:19], s42 offen offset:3072 sc1
    v_mfma_f32_16x16x32_bf16 v[104:107], a[180:183], a[36:39], v[104:107]
    s_add_u32 s42, s42, 4096
    ds_read_b64_tr_b16 a[156:157], v201 offset:128
    ds_read_b64_tr_b16 a[158:159], v201 offset:4736
    v_mfma_f32_16x16x32_bf16 v[108:111], a[180:183], a[100:103], v[108:111]
    v_mfma_f32_16x16x32_bf16 v[112:115], a[184:187], a[36:39], v[112:115]
    v_mfma_f32_16x16x32_bf16 v[116:119], a[184:187], a[100:103], v[116:119]
    buffer_load_dwordx4 v193, s[8:11], s40 offen offset:1152 lds
    v_mfma_f32_16x16x32_bf16 v[120:123], a[188:191], a[36:39], v[120:123]
    s_add_u32 s40, s40, 65536
    v_mfma_f32_16x16x32_bf16 v[124:127], a[188:191], a[100:103], v[124:127]
    s_waitcnt lgkmcnt(0)
    v_mfma_f32_16x16x32_bf16 v[64:67], a[128:131], a[40:43], v[64:67]
    ds_read_b64_tr_b16 a[160:161], v198 offset:9216
    ds_read_b64_tr_b16 a[162:163], v198 offset:13824
    v_mfma_f32_16x16x32_bf16 v[68:71], a[128:131], a[104:107], v[68:71]
    buffer_load_dwordx4 a[36:39], v16, s[16:19], s41 offen offset:1024 sc1
    v_mfma_f32_16x16x32_bf16 v[72:75], a[132:135], a[40:43], v[72:75]
    ds_read_b64_tr_b16 a[164:165], v199 offset:9216
    ds_read_b64_tr_b16 a[166:167], v199 offset:13824
    v_mfma_f32_16x16x32_bf16 v[76:79], a[132:135], a[104:107], v[76:79]
    s_add_u32 m0, s59, 34816
    ds_read_b64_tr_b16 a[168:169], v200 offset:9216
    ds_read_b64_tr_b16 a[170:171], v200 offset:13824
    v_mfma_f32_16x16x32_bf16 v[80:83], a[136:139], a[40:43], v[80:83]
    ds_read_b64_tr_b16 a[172:173], v201 offset:9216
    ds_read_b64_tr_b16 a[174:175], v201 offset:13824
    v_mfma_f32_16x16x32_bf16 v[84:87], a[136:139], a[104:107], v[84:87]
    buffer_load_dwordx4 v192, s[8:11], s40 offen offset:0 lds
    v_mfma_f32_16x16x32_bf16 v[88:91], a[140:143], a[40:43], v[88:91]
    ds_read_b64_tr_b16 a[176:177], v198 offset:9344
    ds_read_b64_tr_b16 a[178:179], v198 offset:13952
    v_mfma_f32_16x16x32_bf16 v[92:95], a[140:143], a[104:107], v[92:95]
    ds_read_b64_tr_b16 a[180:181], v199 offset:9344
    ds_read_b64_tr_b16 a[182:183], v199 offset:13952
    v_mfma_f32_16x16x32_bf16 v[96:99], a[144:147], a[40:43], v[96:99]
    ds_read_b64_tr_b16 a[184:185], v200 offset:9344
    ds_read_b64_tr_b16 a[186:187], v200 offset:13952
    v_mfma_f32_16x16x32_bf16 v[100:103], a[144:147], a[104:107], v[100:103]
    buffer_load_dwordx4 a[80:83], v16, s[16:19], s42 offen offset:0 sc1
    v_mfma_f32_16x16x32_bf16 v[104:107], a[148:151], a[40:43], v[104:107]
    ds_read_b64_tr_b16 a[188:189], v201 offset:9344
    ds_read_b64_tr_b16 a[190:191], v201 offset:13952
    v_mfma_f32_16x16x32_bf16 v[108:111], a[148:151], a[104:107], v[108:111]
    v_mfma_f32_16x16x32_bf16 v[112:115], a[152:155], a[40:43], v[112:115]
    v_mfma_f32_16x16x32_bf16 v[116:119], a[152:155], a[104:107], v[116:119]
    buffer_load_dwordx4 v193, s[8:11], s40 offen offset:1152 lds
    v_mfma_f32_16x16x32_bf16 v[120:123], a[156:159], a[40:43], v[120:123]
    s_add_u32 s40, s40, 65536
    v_mfma_f32_16x16x32_bf16 v[124:127], a[156:159], a[104:107], v[124:127]
    s_waitcnt vmcnt(24) lgkmcnt(0)
    s_barrier
    v_mfma_f32_16x16x32_bf16 v[64:67], a[160:163], a[44:47], v[64:67]
    ds_read_b64_tr_b16 a[128:129], v198 offset:18432
    ds_read_b64_tr_b16 a[130:131], v198 offset:23040
    v_mfma_f32_16x16x32_bf16 v[68:71], a[160:163], a[108:111], v[68:71]
    buffer_load_dwordx4 a[40:43], v16, s[16:19], s41 offen offset:2048 sc1
    v_mfma_f32_16x16x32_bf16 v[72:75], a[164:167], a[44:47], v[72:75]
    ds_read_b64_tr_b16 a[132:133], v199 offset:18432
    ds_read_b64_tr_b16 a[134:135], v199 offset:23040
    v_mfma_f32_16x16x32_bf16 v[76:79], a[164:167], a[108:111], v[76:79]
    s_add_u32 m0, s59, 44032
    ds_read_b64_tr_b16 a[136:137], v200 offset:18432
    ds_read_b64_tr_b16 a[138:139], v200 offset:23040
    v_mfma_f32_16x16x32_bf16 v[80:83], a[168:171], a[44:47], v[80:83]
    ds_read_b64_tr_b16 a[140:141], v201 offset:18432
    ds_read_b64_tr_b16 a[142:143], v201 offset:23040
    v_mfma_f32_16x16x32_bf16 v[84:87], a[168:171], a[108:111], v[84:87]
    buffer_load_dwordx4 v192, s[8:11], s40 offen offset:0 lds
    v_mfma_f32_16x16x32_bf16 v[88:91], a[172:175], a[44:47], v[88:91]
    ds_read_b64_tr_b16 a[144:145], v198 offset:18560
    ds_read_b64_tr_b16 a[146:147], v198 offset:23168
    v_mfma_f32_16x16x32_bf16 v[92:95], a[172:175], a[108:111], v[92:95]
    ds_read_b64_tr_b16 a[148:149], v199 offset:18560
    ds_read_b64_tr_b16 a[150:151], v199 offset:23168
    v_mfma_f32_16x16x32_bf16 v[96:99], a[176:179], a[44:47], v[96:99]
    ds_read_b64_tr_b16 a[152:153], v200 offset:18560
    ds_read_b64_tr_b16 a[154:155], v200 offset:23168
    v_mfma_f32_16x16x32_bf16 v[100:103], a[176:179], a[108:111], v[100:103]
    buffer_load_dwordx4 a[84:87], v16, s[16:19], s42 offen offset:1024 sc1
    v_mfma_f32_16x16x32_bf16 v[104:107], a[180:183], a[44:47], v[104:107]
    ds_read_b64_tr_b16 a[156:157], v201 offset:18560
    ds_read_b64_tr_b16 a[158:159], v201 offset:23168
    v_mfma_f32_16x16x32_bf16 v[108:111], a[180:183], a[108:111], v[108:111]
    v_mfma_f32_16x16x32_bf16 v[112:115], a[184:187], a[44:47], v[112:115]
    v_mfma_f32_16x16x32_bf16 v[116:119], a[184:187], a[108:111], v[116:119]
    buffer_load_dwordx4 v193, s[8:11], s40 offen offset:1152 lds
    v_mfma_f32_16x16x32_bf16 v[120:123], a[188:191], a[44:47], v[120:123]
    s_add_u32 s40, s40, 65536
    v_mfma_f32_16x16x32_bf16 v[124:127], a[188:191], a[108:111], v[124:127]
    s_waitcnt lgkmcnt(0)
    v_mfma_f32_16x16x32_bf16 v[64:67], a[128:131], a[48:51], v[64:67]
    ds_read_b64_tr_b16 a[160:161], v198 offset:27648
    ds_read_b64_tr_b16 a[162:163], v198 offset:32256
    v_mfma_f32_16x16x32_bf16 v[68:71], a[128:131], a[112:115], v[68:71]
    buffer_load_dwordx4 a[44:47], v16, s[16:19], s41 offen offset:3072 sc1
    v_mfma_f32_16x16x32_bf16 v[72:75], a[132:135], a[48:51], v[72:75]
    s_add_u32 s41, s41, 4096
    ds_read_b64_tr_b16 a[164:165], v199 offset:27648
    ds_read_b64_tr_b16 a[166:167], v199 offset:32256
    v_mfma_f32_16x16x32_bf16 v[76:79], a[132:135], a[112:115], v[76:79]
    s_add_u32 m0, s59, 53248
    ds_read_b64_tr_b16 a[168:169], v200 offset:27648
    ds_read_b64_tr_b16 a[170:171], v200 offset:32256
    v_mfma_f32_16x16x32_bf16 v[80:83], a[136:139], a[48:51], v[80:83]
    ds_read_b64_tr_b16 a[172:173], v201 offset:27648
    ds_read_b64_tr_b16 a[174:175], v201 offset:32256
    v_mfma_f32_16x16x32_bf16 v[84:87], a[136:139], a[112:115], v[84:87]
    buffer_load_dwordx4 v192, s[8:11], s40 offen offset:0 lds
    v_mfma_f32_16x16x32_bf16 v[88:91], a[140:143], a[48:51], v[88:91]
    ds_read_b64_tr_b16 a[176:177], v198 offset:27776
    ds_read_b64_tr_b16 a[178:179], v198 offset:32384
    v_mfma_f32_16x16x32_bf16 v[92:95], a[140:143], a[112:115], v[92:95]
    ds_read_b64_tr_b16 a[180:181], v199 offset:27776
    ds_read_b64_tr_b16 a[182:183], v199 offset:32384
    v_mfma_f32_16x16x32_bf16 v[96:99], a[144:147], a[48:51], v[96:99]
    ds_read_b64_tr_b16 a[184:185], v200 offset:27776
    ds_read_b64_tr_b16 a[186:187], v200 offset:32384
    v_mfma_f32_16x16x32_bf16 v[100:103], a[144:147], a[112:115], v[100:103]
    buffer_load_dwordx4 a[88:91], v16, s[16:19], s42 offen offset:2048 sc1
    v_mfma_f32_16x16x32_bf16 v[104:107], a[148:151], a[48:51], v[104:107]
    ds_read_b64_tr_b16 a[188:189], v201 offset:27776
    ds_read_b64_tr_b16 a[190:191], v201 offset:32384
    v_mfma_f32_16x16x32_bf16 v[108:111], a[148:151], a[112:115], v[108:111]
    v_mfma_f32_16x16x32_bf16 v[112:115], a[152:155], a[48:51], v[112:115]
    v_mfma_f32_16x16x32_bf16 v[116:119], a[152:155], a[112:115], v[116:119]
    buffer_load_dwordx4 v193, s[8:11], s40 offen offset:1152 lds
    v_mfma_f32_16x16x32_bf16 v[120:123], a[156:159], a[48:51], v[120:123]
    s_add_u32 s40, s40, 65536
    v_mfma_f32_16x16x32_bf16 v[124:127], a[156:159], a[112:115], v[124:127]
    s_waitcnt vmcnt(24) lgkmcnt(0)
    s_barrier
    v_mfma_f32_16x16x32_bf16 v[64:67], a[160:163], a[52:55], v[64:67]
    ds_read_b64_tr_b16 a[128:129], v198 offset:36864
    ds_read_b64_tr_b16 a[130:131], v198 offset:41472
    v_mfma_f32_16x16x32_bf16 v[68:71], a[160:163], a[116:119], v[68:71]
    buffer_load_dwordx4 a[48:51], v16, s[16:19], s41 offen offset:0 sc1
    v_mfma_f32_16x16x32_bf16 v[72:75], a[164:167], a[52:55], v[72:75]
    ds_read_b64_tr_b16 a[132:133], v199 offset:36864
    ds_read_b64_tr_b16 a[134:135], v199 offset:41472
    v_mfma_f32_16x16x32_bf16 v[76:79], a[164:167], a[116:119], v[76:79]
    s_add_u32 m0, s59, 62464
    ds_read_b64_tr_b16 a[136:137], v200 offset:36864
    ds_read_b64_tr_b16 a[138:139], v200 offset:41472
    v_mfma_f32_16x16x32_bf16 v[80:83], a[168:171], a[52:55], v[80:83]
    ds_read_b64_tr_b16 a[140:141], v201 offset:36864
    ds_read_b64_tr_b16 a[142:143], v201 offset:41472
    v_mfma_f32_16x16x32_bf16 v[84:87], a[168:171], a[116:119], v[84:87]
    buffer_load_dwordx4 v192, s[8:11], s40 offen offset:0 lds
    v_mfma_f32_16x16x32_bf16 v[88:91], a[172:175], a[52:55], v[88:91]
    ds_read_b64_tr_b16 a[144:145], v198 offset:36992
    ds_read_b64_tr_b16 a[146:147], v198 offset:41600
    v_mfma_f32_16x16x32_bf16 v[92:95], a[172:175], a[116:119], v[92:95]
    ds_read_b64_tr_b16 a[148:149], v199 offset:36992
    ds_read_b64_tr_b16 a[150:151], v199 offset:41600
    v_mfma_f32_16x16x32_bf16 v[96:99], a[176:179], a[52:55], v[96:99]
    ds_read_b64_tr_b16 a[152:153], v200 offset:36992
    ds_read_b64_tr_b16 a[154:155], v200 offset:41600
    v_mfma_f32_16x16x32_bf16 v[100:103], a[176:179], a[116:119], v[100:103]
    buffer_load_dwordx4 a[92:95], v16, s[16:19], s42 offen offset:3072 sc1
    v_mfma_f32_16x16x32_bf16 v[104:107], a[180:183], a[52:55], v[104:107]
    s_add_u32 s42, s42, 4096
    ds_read_b64_tr_b16 a[156:157], v201 offset:36992
    ds_read_b64_tr_b16 a[158:159], v201 offset:41600
    v_mfma_f32_16x16x32_bf16 v[108:111], a[180:183], a[116:119], v[108:111]
    v_mfma_f32_16x16x32_bf16 v[112:115], a[184:187], a[52:55], v[112:115]
    v_mfma_f32_16x16x32_bf16 v[116:119], a[184:187], a[116:119], v[116:119]
    buffer_load_dwordx4 v193, s[8:11], s40 offen offset:1152 lds
    v_mfma_f32_16x16x32_bf16 v[120:123], a[188:191], a[52:55], v[120:123]
    s_add_u32 s40, s40, 65536
    v_mfma_f32_16x16x32_bf16 v[124:127], a[188:191], a[116:119], v[124:127]
    s_waitcnt lgkmcnt(0)
    v_mfma_f32_16x16x32_bf16 v[64:67], a[128:131], a[56:59], v[64:67]
    ds_read_b64_tr_b16 a[160:161], v198 offset:46080
    ds_read_b64_tr_b16 a[162:163], v198 offset:50688
    v_mfma_f32_16x16x32_bf16 v[68:71], a[128:131], a[120:123], v[68:71]
    buffer_load_dwordx4 a[52:55], v16, s[16:19], s41 offen offset:1024 sc1
    v_mfma_f32_16x16x32_bf16 v[72:75], a[132:135], a[56:59], v[72:75]
    ds_read_b64_tr_b16 a[164:165], v199 offset:46080
    ds_read_b64_tr_b16 a[166:167], v199 offset:50688
    v_mfma_f32_16x16x32_bf16 v[76:79], a[132:135], a[120:123], v[76:79]
    s_add_u32 m0, s59, 71680
    ds_read_b64_tr_b16 a[168:169], v200 offset:46080
    ds_read_b64_tr_b16 a[170:171], v200 offset:50688
    v_mfma_f32_16x16x32_bf16 v[80:83], a[136:139], a[56:59], v[80:83]
    ds_read_b64_tr_b16 a[172:173], v201 offset:46080
    ds_read_b64_tr_b16 a[174:175], v201 offset:50688
    v_mfma_f32_16x16x32_bf16 v[84:87], a[136:139], a[120:123], v[84:87]
    buffer_load_dwordx4 v192, s[8:11], s40 offen offset:0 lds
    v_mfma_f32_16x16x32_bf16 v[88:91], a[140:143], a[56:59], v[88:91]
    ds_read_b64_tr_b16 a[176:177], v198 offset:46208
    ds_read_b64_tr_b16 a[178:179], v198 offset:50816
    v_mfma_f32_16x16x32_bf16 v[92:95], a[140:143], a[120:123], v[92:95]
    ds_read_b64_tr_b16 a[180:181], v199 offset:46208
    ds_read_b64_tr_b16 a[182:183], v199 offset:50816
    v_mfma_f32_16x16x32_bf16 v[96:99], a[144:147], a[56:59], v[96:99]
    ds_read_b64_tr_b16 a[184:185], v200 offset:46208
    ds_read_b64_tr_b16 a[186:187], v200 offset:50816
    v_mfma_f32_16x16x32_bf16 v[100:103], a[144:147], a[120:123], v[100:103]
    buffer_load_dwordx4 a[96:99], v16, s[16:19], s42 offen offset:0 sc1
    v_mfma_f32_16x16x32_bf16 v[104:107], a[148:151], a[56:59], v[104:107]
    ds_read_b64_tr_b16 a[188:189], v201 offset:46208
    ds_read_b64_tr_b16 a[190:191], v201 offset:50816
    v_mfma_f32_16x16x32_bf16 v[108:111], a[148:151], a[120:123], v[108:111]
    v_mfma_f32_16x16x32_bf16 v[112:115], a[152:155], a[56:59], v[112:115]
    v_mfma_f32_16x16x32_bf16 v[116:119], a[152:155], a[120:123], v[116:119]
    buffer_load_dwordx4 v193, s[8:11], s40 offen offset:1152 lds
    v_mfma_f32_16x16x32_bf16 v[120:123], a[156:159], a[56:59], v[120:123]
    s_add_u32 s40, s40, 65536
    v_mfma_f32_16x16x32_bf16 v[124:127], a[156:159], a[120:123], v[124:127]
    s_waitcnt vmcnt(24) lgkmcnt(0)
    s_barrier
    v_mfma_f32_16x16x32_bf16 v[64:67], a[160:163], a[60:63], v[64:67]
    ds_read_b64_tr_b16 a[128:129], v198 offset:55296
    ds_read_b64_tr_b16 a[130:131], v198 offset:59904
    v_mfma_f32_16x16x32_bf16 v[68:71], a[160:163], a[124:127], v[68:71]
    buffer_load_dwordx4 a[56:59], v16, s[16:19], s41 offen offset:2048 sc1
    v_mfma_f32_16x16x32_bf16 v[72:75], a[164:167], a[60:63], v[72:75]
    ds_read_b64_tr_b16 a[132:133], v199 offset:55296
    ds_read_b64_tr_b16 a[134:135], v199 offset:59904
    v_mfma_f32_16x16x32_bf16 v[76:79], a[164:167], a[124:127], v[76:79]
    s_add_u32 m0, s59, 80896
    ds_read_b64_tr_b16 a[136:137], v200 offset:55296
    ds_read_b64_tr_b16 a[138:139], v200 offset:59904
    v_mfma_f32_16x16x32_bf16 v[80:83], a[168:171], a[60:63], v[80:83]
    ds_read_b64_tr_b16 a[140:141], v201 offset:55296
    ds_read_b64_tr_b16 a[142:143], v201 offset:59904
    v_mfma_f32_16x16x32_bf16 v[84:87], a[168:171], a[124:127], v[84:87]
    buffer_load_dwordx4 v192, s[8:11], s40 offen offset:0 lds
    v_mfma_f32_16x16x32_bf16 v[88:91], a[172:175], a[60:63], v[88:91]
    ds_read_b64_tr_b16 a[144:145], v198 offset:55424
    ds_read_b64_tr_b16 a[146:147], v198 offset:60032
    v_mfma_f32_16x16x32_bf16 v[92:95], a[172:175], a[124:127], v[92:95]
    ds_read_b64_tr_b16 a[148:149], v199 offset:55424
    ds_read_b64_tr_b16 a[150:151], v199 offset:60032
    v_mfma_f32_16x16x32_bf16 v[96:99], a[176:179], a[60:63], v[96:99]
    ds_read_b64_tr_b16 a[152:153], v200 offset:55424
    ds_read_b64_tr_b16 a[154:155], v200 offset:60032
    v_mfma_f32_16x16x32_bf16 v[100:103], a[176:179], a[124:127], v[100:103]
    buffer_load_dwordx4 a[100:103], v16, s[16:19], s42 offen offset:1024 sc1
    v_mfma_f32_16x16x32_bf16 v[104:107], a[180:183], a[60:63], v[104:107]
    ds_read_b64_tr_b16 a[156:157], v201 offset:55424
    ds_read_b64_tr_b16 a[158:159], v201 offset:60032
    v_mfma_f32_16x16x32_bf16 v[108:111], a[180:183], a[124:127], v[108:111]
    s_add_u32 s35, s35, 1
    v_mfma_f32_16x16x32_bf16 v[112:115], a[184:187], a[60:63], v[112:115]
    v_mfma_f32_16x16x32_bf16 v[116:119], a[184:187], a[124:127], v[116:119]
    buffer_load_dwordx4 v193, s[8:11], s40 offen offset:1152 lds
    v_mfma_f32_16x16x32_bf16 v[120:123], a[188:191], a[60:63], v[120:123]
    s_add_u32 s40, s40, 65536
    v_mfma_f32_16x16x32_bf16 v[124:127], a[188:191], a[124:127], v[124:127]
    s_waitcnt lgkmcnt(0)
    s_cmp_lg_u32 s35, 3
    s_cbranch_scc1 gated_mix__ssm_conv_h3__compressed_kv_cla__prompt_kernel_oloop
    s_waitcnt vmcnt(41)
    v_cmp_ne_u32 vcc, 1, v213
    s_nop 0
    s_cbranch_vccnz gated_mix__ssm_conv_h3__compressed_kv_cla__prompt_kernel_spin_y
gated_mix__ssm_conv_h3__compressed_kv_cla__prompt_kernel_spin_y_ret:
    v_mfma_f32_16x16x32_bf16 v[64:67], a[128:131], a[0:3], v[64:67]
    ds_read_b64_tr_b16 a[160:161], v202 offset:0
    ds_read_b64_tr_b16 a[162:163], v202 offset:4608
    v_mfma_f32_16x16x32_bf16 v[68:71], a[128:131], a[64:67], v[68:71]
    s_lshl_b32 s37, s32, 12
    s_add_u32 m0, s37, 0
    s_add_u32 s36, s51, 0
    buffer_load_dwordx4 v209, s[12:15], s36 offen sc1 lds
    v_mfma_f32_16x16x32_bf16 v[72:75], a[132:135], a[0:3], v[72:75]
    ds_read_b64_tr_b16 a[164:165], v203 offset:0
    ds_read_b64_tr_b16 a[166:167], v203 offset:4608
    v_mfma_f32_16x16x32_bf16 v[76:79], a[132:135], a[64:67], v[76:79]
    ds_read_b64_tr_b16 a[168:169], v204 offset:0
    ds_read_b64_tr_b16 a[170:171], v204 offset:4608
    v_mfma_f32_16x16x32_bf16 v[80:83], a[136:139], a[0:3], v[80:83]
    ds_read_b64_tr_b16 a[172:173], v205 offset:0
    ds_read_b64_tr_b16 a[174:175], v205 offset:4608
    v_mfma_f32_16x16x32_bf16 v[84:87], a[136:139], a[64:67], v[84:87]
    s_add_u32 m0, s37, 1024
    s_add_u32 s36, s51, 16384
    buffer_load_dwordx4 v209, s[12:15], s36 offen sc1 lds
    v_mfma_f32_16x16x32_bf16 v[88:91], a[140:143], a[0:3], v[88:91]
    s_add_u32 m0, s37, 2048
    s_add_u32 s36, s51, 32768
    buffer_load_dwordx4 v209, s[12:15], s36 offen sc1 lds
    v_mfma_f32_16x16x32_bf16 v[92:95], a[140:143], a[64:67], v[92:95]
    s_waitcnt vmcnt(31) lgkmcnt(0)
    s_barrier
    v_mfma_f32_16x16x32_bf16 v[64:67], a[160:163], a[4:7], v[64:67]
    ds_read_b64_tr_b16 a[128:129], v202 offset:9216
    ds_read_b64_tr_b16 a[130:131], v202 offset:13824
    v_mfma_f32_16x16x32_bf16 v[68:71], a[160:163], a[68:71], v[68:71]
    s_add_u32 m0, s37, 3072
    s_add_u32 s36, s51, 49152
    buffer_load_dwordx4 v209, s[12:15], s36 offen sc1 lds
    v_mfma_f32_16x16x32_bf16 v[72:75], a[164:167], a[4:7], v[72:75]
    ds_read_b64_tr_b16 a[132:133], v203 offset:9216
    ds_read_b64_tr_b16 a[134:135], v203 offset:13824
    v_mfma_f32_16x16x32_bf16 v[76:79], a[164:167], a[68:71], v[76:79]
    ds_read_b64_tr_b16 a[136:137], v204 offset:9216
    ds_read_b64_tr_b16 a[138:139], v204 offset:13824
    v_mfma_f32_16x16x32_bf16 v[80:83], a[168:171], a[4:7], v[80:83]
    ds_read_b64_tr_b16 a[140:141], v205 offset:9216
    ds_read_b64_tr_b16 a[142:143], v205 offset:13824
    v_mfma_f32_16x16x32_bf16 v[84:87], a[168:171], a[68:71], v[84:87]
    buffer_load_dwordx4 a[60:63], v16, s[16:19], s41 offen offset:3072 sc1
    v_mfma_f32_16x16x32_bf16 v[88:91], a[172:175], a[4:7], v[88:91]
    s_add_u32 s41, s41, 4096
    s_add_u32 m0, s59, 90112
    v_mfma_f32_16x16x32_bf16 v[92:95], a[172:175], a[68:71], v[92:95]
    s_waitcnt lgkmcnt(0)
    v_mfma_f32_16x16x32_bf16 v[64:67], a[128:131], a[8:11], v[64:67]
    ds_read_b64_tr_b16 a[160:161], v194 offset:0
    ds_read_b64_tr_b16 a[162:163], v194 offset:4608
    v_mfma_f32_16x16x32_bf16 v[68:71], a[128:131], a[72:75], v[68:71]
    buffer_load_dwordx4 v192, s[8:11], s40 offen offset:0 lds
    v_mfma_f32_16x16x32_bf16 v[72:75], a[132:135], a[8:11], v[72:75]
    ds_read_b64_tr_b16 a[164:165], v195 offset:0
    ds_read_b64_tr_b16 a[166:167], v195 offset:4608
    v_mfma_f32_16x16x32_bf16 v[76:79], a[132:135], a[72:75], v[76:79]
    ds_read_b64_tr_b16 a[168:169], v196 offset:0
    ds_read_b64_tr_b16 a[170:171], v196 offset:4608
    v_mfma_f32_16x16x32_bf16 v[80:83], a[136:139], a[8:11], v[80:83]
    ds_read_b64_tr_b16 a[172:173], v197 offset:0
    ds_read_b64_tr_b16 a[174:175], v197 offset:4608
    v_mfma_f32_16x16x32_bf16 v[84:87], a[136:139], a[72:75], v[84:87]
    buffer_load_dwordx4 v193, s[8:11], s40 offen offset:1152 lds
    v_mfma_f32_16x16x32_bf16 v[88:91], a[140:143], a[8:11], v[88:91]
    s_add_u32 s40, s40, 65536
    buffer_load_dwordx4 a[104:107], v16, s[16:19], s42 offen offset:2048 sc1
    v_mfma_f32_16x16x32_bf16 v[92:95], a[140:143], a[72:75], v[92:95]
    s_waitcnt vmcnt(28) lgkmcnt(0)
    s_barrier
    v_mfma_f32_16x16x32_bf16 v[64:67], a[160:163], a[12:15], v[64:67]
    ds_read_b64_tr_b16 a[128:129], v194 offset:9216
    ds_read_b64_tr_b16 a[130:131], v194 offset:13824
    v_mfma_f32_16x16x32_bf16 v[68:71], a[160:163], a[76:79], v[68:71]
    s_add_u32 m0, s59, 99328
    v_mfma_f32_16x16x32_bf16 v[72:75], a[164:167], a[12:15], v[72:75]
    ds_read_b64_tr_b16 a[132:133], v195 offset:9216
    ds_read_b64_tr_b16 a[134:135], v195 offset:13824
    v_mfma_f32_16x16x32_bf16 v[76:79], a[164:167], a[76:79], v[76:79]
    ds_read_b64_tr_b16 a[136:137], v196 offset:9216
    ds_read_b64_tr_b16 a[138:139], v196 offset:13824
    v_mfma_f32_16x16x32_bf16 v[80:83], a[168:171], a[12:15], v[80:83]
    ds_read_b64_tr_b16 a[140:141], v197 offset:9216
    ds_read_b64_tr_b16 a[142:143], v197 offset:13824
    v_mfma_f32_16x16x32_bf16 v[84:87], a[168:171], a[76:79], v[84:87]
    buffer_load_dwordx4 v192, s[8:11], s40 offen offset:0 lds
    v_mfma_f32_16x16x32_bf16 v[88:91], a[172:175], a[12:15], v[88:91]
    buffer_load_dwordx4 v193, s[8:11], s40 offen offset:1152 lds
    v_mfma_f32_16x16x32_bf16 v[92:95], a[172:175], a[76:79], v[92:95]
    s_waitcnt lgkmcnt(0)
    v_mfma_f32_16x16x32_bf16 v[64:67], a[128:131], a[16:19], v[64:67]
    ds_read_b64_tr_b16 a[160:161], v194 offset:18432
    ds_read_b64_tr_b16 a[162:163], v194 offset:23040
    v_mfma_f32_16x16x32_bf16 v[68:71], a[128:131], a[80:83], v[68:71]
    s_add_u32 s40, s40, 65536
    buffer_load_dwordx4 a[108:111], v16, s[16:19], s42 offen offset:3072 sc1
    v_mfma_f32_16x16x32_bf16 v[72:75], a[132:135], a[16:19], v[72:75]
    ds_read_b64_tr_b16 a[164:165], v195 offset:18432
    ds_read_b64_tr_b16 a[166:167], v195 offset:23040
    v_mfma_f32_16x16x32_bf16 v[76:79], a[132:135], a[80:83], v[76:79]
    ds_read_b64_tr_b16 a[168:169], v196 offset:18432
    ds_read_b64_tr_b16 a[170:171], v196 offset:23040
    v_mfma_f32_16x16x32_bf16 v[80:83], a[136:139], a[16:19], v[80:83]
    ds_read_b64_tr_b16 a[172:173], v197 offset:18432
    ds_read_b64_tr_b16 a[174:175], v197 offset:23040
    v_mfma_f32_16x16x32_bf16 v[84:87], a[136:139], a[80:83], v[84:87]
    s_add_u32 s42, s42, 4096
    s_add_u32 m0, s59, 108544
    v_mfma_f32_16x16x32_bf16 v[88:91], a[140:143], a[16:19], v[88:91]
    buffer_load_dwordx4 v192, s[8:11], s40 offen offset:0 lds
    v_mfma_f32_16x16x32_bf16 v[92:95], a[140:143], a[80:83], v[92:95]
    s_waitcnt vmcnt(24) lgkmcnt(0)
    s_barrier
    v_mfma_f32_16x16x32_bf16 v[64:67], a[160:163], a[20:23], v[64:67]
    ds_read_b64_tr_b16 a[128:129], v194 offset:27648
    ds_read_b64_tr_b16 a[130:131], v194 offset:32256
    v_mfma_f32_16x16x32_bf16 v[68:71], a[160:163], a[84:87], v[68:71]
    buffer_load_dwordx4 v193, s[8:11], s40 offen offset:1152 lds
    v_mfma_f32_16x16x32_bf16 v[72:75], a[164:167], a[20:23], v[72:75]
    ds_read_b64_tr_b16 a[132:133], v195 offset:27648
    ds_read_b64_tr_b16 a[134:135], v195 offset:32256
    v_mfma_f32_16x16x32_bf16 v[76:79], a[164:167], a[84:87], v[76:79]
    ds_read_b64_tr_b16 a[136:137], v196 offset:27648
    ds_read_b64_tr_b16 a[138:139], v196 offset:32256
    v_mfma_f32_16x16x32_bf16 v[80:83], a[168:171], a[20:23], v[80:83]
    ds_read_b64_tr_b16 a[140:141], v197 offset:27648
    ds_read_b64_tr_b16 a[142:143], v197 offset:32256
    v_mfma_f32_16x16x32_bf16 v[84:87], a[168:171], a[84:87], v[84:87]
    s_add_u32 s40, s40, 65536
    buffer_load_dwordx4 a[112:115], v16, s[16:19], s42 offen offset:0 sc1
    v_mfma_f32_16x16x32_bf16 v[88:91], a[172:175], a[20:23], v[88:91]
    s_add_u32 m0, s59, 117760
    v_mfma_f32_16x16x32_bf16 v[92:95], a[172:175], a[84:87], v[92:95]
    s_waitcnt lgkmcnt(0)
    v_mfma_f32_16x16x32_bf16 v[64:67], a[128:131], a[24:27], v[64:67]
    ds_read_b64_tr_b16 a[160:161], v194 offset:36864
    ds_read_b64_tr_b16 a[162:163], v194 offset:41472
    v_mfma_f32_16x16x32_bf16 v[68:71], a[128:131], a[88:91], v[68:71]
    buffer_load_dwordx4 v192, s[8:11], s40 offen offset:0 lds
    v_mfma_f32_16x16x32_bf16 v[72:75], a[132:135], a[24:27], v[72:75]
    ds_read_b64_tr_b16 a[164:165], v195 offset:36864
    ds_read_b64_tr_b16 a[166:167], v195 offset:41472
    v_mfma_f32_16x16x32_bf16 v[76:79], a[132:135], a[88:91], v[76:79]
    ds_read_b64_tr_b16 a[168:169], v196 offset:36864
    ds_read_b64_tr_b16 a[170:171], v196 offset:41472
    v_mfma_f32_16x16x32_bf16 v[80:83], a[136:139], a[24:27], v[80:83]
    ds_read_b64_tr_b16 a[172:173], v197 offset:36864
    ds_read_b64_tr_b16 a[174:175], v197 offset:41472
    v_mfma_f32_16x16x32_bf16 v[84:87], a[136:139], a[88:91], v[84:87]
    buffer_load_dwordx4 v193, s[8:11], s40 offen offset:1152 lds
    v_mfma_f32_16x16x32_bf16 v[88:91], a[140:143], a[24:27], v[88:91]
    s_add_u32 s40, s40, 65536
    buffer_load_dwordx4 a[116:119], v16, s[16:19], s42 offen offset:1024 sc1
    v_mfma_f32_16x16x32_bf16 v[92:95], a[140:143], a[88:91], v[92:95]
    s_waitcnt vmcnt(21) lgkmcnt(0)
    s_barrier
    v_mfma_f32_16x16x32_bf16 v[64:67], a[160:163], a[28:31], v[64:67]
    ds_read_b64_tr_b16 a[128:129], v194 offset:46080
    ds_read_b64_tr_b16 a[130:131], v194 offset:50688
    v_mfma_f32_16x16x32_bf16 v[68:71], a[160:163], a[92:95], v[68:71]
    s_add_u32 m0, s59, 126976
    v_mfma_f32_16x16x32_bf16 v[72:75], a[164:167], a[28:31], v[72:75]
    ds_read_b64_tr_b16 a[132:133], v195 offset:46080
    ds_read_b64_tr_b16 a[134:135], v195 offset:50688
    v_mfma_f32_16x16x32_bf16 v[76:79], a[164:167], a[92:95], v[76:79]
    ds_read_b64_tr_b16 a[136:137], v196 offset:46080
    ds_read_b64_tr_b16 a[138:139], v196 offset:50688
    v_mfma_f32_16x16x32_bf16 v[80:83], a[168:171], a[28:31], v[80:83]
    ds_read_b64_tr_b16 a[140:141], v197 offset:46080
    ds_read_b64_tr_b16 a[142:143], v197 offset:50688
    v_mfma_f32_16x16x32_bf16 v[84:87], a[168:171], a[92:95], v[84:87]
    buffer_load_dwordx4 v192, s[8:11], s40 offen offset:0 lds
    v_mfma_f32_16x16x32_bf16 v[88:91], a[172:175], a[28:31], v[88:91]
    buffer_load_dwordx4 v193, s[8:11], s40 offen offset:1152 lds
    v_mfma_f32_16x16x32_bf16 v[92:95], a[172:175], a[92:95], v[92:95]
    s_waitcnt lgkmcnt(0)
    v_mfma_f32_16x16x32_bf16 v[64:67], a[128:131], a[32:35], v[64:67]
    ds_read_b64_tr_b16 a[160:161], v194 offset:55296
    ds_read_b64_tr_b16 a[162:163], v194 offset:59904
    v_mfma_f32_16x16x32_bf16 v[68:71], a[128:131], a[96:99], v[68:71]
    s_add_u32 s40, s40, 65536
    buffer_load_dwordx4 a[120:123], v16, s[16:19], s42 offen offset:2048 sc1
    v_mfma_f32_16x16x32_bf16 v[72:75], a[132:135], a[32:35], v[72:75]
    ds_read_b64_tr_b16 a[164:165], v195 offset:55296
    ds_read_b64_tr_b16 a[166:167], v195 offset:59904
    v_mfma_f32_16x16x32_bf16 v[76:79], a[132:135], a[96:99], v[76:79]
    ds_read_b64_tr_b16 a[168:169], v196 offset:55296
    ds_read_b64_tr_b16 a[170:171], v196 offset:59904
    v_mfma_f32_16x16x32_bf16 v[80:83], a[136:139], a[32:35], v[80:83]
    ds_read_b64_tr_b16 a[172:173], v197 offset:55296
    ds_read_b64_tr_b16 a[174:175], v197 offset:59904
    v_mfma_f32_16x16x32_bf16 v[84:87], a[136:139], a[96:99], v[84:87]
    buffer_load_dwordx4 a[124:127], v16, s[16:19], s42 offen offset:3072 sc1
    v_mfma_f32_16x16x32_bf16 v[88:91], a[140:143], a[32:35], v[88:91]
    s_add_u32 s42, s42, 4096
    s_add_u32 s16, s94, 67108864
    s_addc_u32 s17, s95, 0
    s_mov_b32 s18, 8388608
    v_mfma_f32_16x16x32_bf16 v[92:95], a[140:143], a[96:99], v[92:95]
    s_waitcnt vmcnt(13) lgkmcnt(0)
    s_barrier
    v_mfma_f32_16x16x32_bf16 v[64:67], a[160:163], a[36:39], v[64:67]
    ds_read_b64_tr_b16 a[128:129], v198 offset:0
    ds_read_b64_tr_b16 a[130:131], v198 offset:4608
    v_mfma_f32_16x16x32_bf16 v[68:71], a[160:163], a[100:103], v[68:71]
    v_mfma_f32_16x16x32_bf16 v[72:75], a[164:167], a[36:39], v[72:75]
    ds_read_b64_tr_b16 a[132:133], v199 offset:0
    ds_read_b64_tr_b16 a[134:135], v199 offset:4608
    v_mfma_f32_16x16x32_bf16 v[76:79], a[164:167], a[100:103], v[76:79]
    ds_read_b64_tr_b16 a[136:137], v200 offset:0
    ds_read_b64_tr_b16 a[138:139], v200 offset:4608
    v_mfma_f32_16x16x32_bf16 v[80:83], a[168:171], a[36:39], v[80:83]
    ds_read_b64_tr_b16 a[140:141], v201 offset:0
    ds_read_b64_tr_b16 a[142:143], v201 offset:4608
    v_mfma_f32_16x16x32_bf16 v[84:87], a[168:171], a[100:103], v[84:87]
    v_mfma_f32_16x16x32_bf16 v[88:91], a[172:175], a[36:39], v[88:91]
    v_mfma_f32_16x16x32_bf16 v[92:95], a[172:175], a[100:103], v[92:95]
    s_waitcnt lgkmcnt(0)
    v_mfma_f32_16x16x32_bf16 v[64:67], a[128:131], a[40:43], v[64:67]
    ds_read_b64_tr_b16 a[160:161], v198 offset:9216
    ds_read_b64_tr_b16 a[162:163], v198 offset:13824
    v_mfma_f32_16x16x32_bf16 v[68:71], a[128:131], a[104:107], v[68:71]
    v_mfma_f32_16x16x32_bf16 v[72:75], a[132:135], a[40:43], v[72:75]
    ds_read_b64_tr_b16 a[164:165], v199 offset:9216
    ds_read_b64_tr_b16 a[166:167], v199 offset:13824
    v_mfma_f32_16x16x32_bf16 v[76:79], a[132:135], a[104:107], v[76:79]
    ds_read_b64_tr_b16 a[168:169], v200 offset:9216
    ds_read_b64_tr_b16 a[170:171], v200 offset:13824
    v_mfma_f32_16x16x32_bf16 v[80:83], a[136:139], a[40:43], v[80:83]
    ds_read_b64_tr_b16 a[172:173], v201 offset:9216
    ds_read_b64_tr_b16 a[174:175], v201 offset:13824
    v_mfma_f32_16x16x32_bf16 v[84:87], a[136:139], a[104:107], v[84:87]
    s_mov_b32 s37, 0xffff0000
    v_mfma_f32_16x16x32_bf16 v[88:91], a[140:143], a[40:43], v[88:91]
    v_mfma_f32_16x16x32_bf16 v[92:95], a[140:143], a[104:107], v[92:95]
    s_waitcnt vmcnt(7) lgkmcnt(0)
    s_barrier
    v_mfma_f32_16x16x32_bf16 v[64:67], a[160:163], a[44:47], v[64:67]
    ds_read_b64_tr_b16 a[128:129], v198 offset:18432
    ds_read_b64_tr_b16 a[130:131], v198 offset:23040
    v_mfma_f32_16x16x32_bf16 v[68:71], a[160:163], a[108:111], v[68:71]
    ds_read_b64_tr_b16 v[160:161], v207 offset:0
    ds_read_b64_tr_b16 v[164:165], v207 offset:4096
    ds_read_b64_tr_b16 v[168:169], v207 offset:8192
    v_mfma_f32_16x16x32_bf16 v[72:75], a[164:167], a[44:47], v[72:75]
    ds_read_b64_tr_b16 a[132:133], v199 offset:18432
    ds_read_b64_tr_b16 a[134:135], v199 offset:23040
    v_mfma_f32_16x16x32_bf16 v[76:79], a[164:167], a[108:111], v[76:79]
    ds_read_b64_tr_b16 a[136:137], v200 offset:18432
    ds_read_b64_tr_b16 a[138:139], v200 offset:23040
    v_mfma_f32_16x16x32_bf16 v[80:83], a[168:171], a[44:47], v[80:83]
    ds_read_b64_tr_b16 a[140:141], v201 offset:18432
    ds_read_b64_tr_b16 a[142:143], v201 offset:23040
    v_mfma_f32_16x16x32_bf16 v[84:87], a[168:171], a[108:111], v[84:87]
    ds_read_b64_tr_b16 v[172:173], v207 offset:12288
    ds_read_b64_tr_b16 v[162:163], v207 offset:128
    ds_read_b64_tr_b16 v[166:167], v207 offset:4224
    v_mfma_f32_16x16x32_bf16 v[88:91], a[172:175], a[44:47], v[88:91]
    ds_read_b64_tr_b16 v[170:171], v207 offset:8320
    ds_read_b64_tr_b16 v[174:175], v207 offset:12416
    v_mfma_f32_16x16x32_bf16 v[92:95], a[172:175], a[108:111], v[92:95]
    s_waitcnt lgkmcnt(0)
    v_mfma_f32_16x16x32_bf16 v[64:67], a[128:131], a[48:51], v[64:67]
    ds_read_b64_tr_b16 a[160:161], v198 offset:27648
    ds_read_b64_tr_b16 a[162:163], v198 offset:32256
    v_mfma_f32_16x16x32_bf16 v[68:71], a[128:131], a[112:115], v[68:71]
    v_lshlrev_b32 v176, 16, v216
    v_lshlrev_b32 v177, 16, v160
    v_mfma_f32_16x16x32_bf16 v[72:75], a[132:135], a[48:51], v[72:75]
    ds_read_b64_tr_b16 a[164:165], v199 offset:27648
    ds_read_b64_tr_b16 a[166:167], v199 offset:32256
    v_mfma_f32_16x16x32_bf16 v[76:79], a[132:135], a[112:115], v[76:79]
    ds_read_b64_tr_b16 a[168:169], v200 offset:27648
    ds_read_b64_tr_b16 a[170:171], v200 offset:32256
    v_mfma_f32_16x16x32_bf16 v[80:83], a[136:139], a[48:51], v[80:83]
    ds_read_b64_tr_b16 a[172:173], v201 offset:27648
    ds_read_b64_tr_b16 a[174:175], v201 offset:32256
    v_mfma_f32_16x16x32_bf16 v[84:87], a[136:139], a[112:115], v[84:87]
    v_mul_f32 v176, v176, v177
    v_mul_f32 v32, v210, v176
    v_mfma_f32_16x16x32_bf16 v[88:91], a[140:143], a[48:51], v[88:91]
    v_and_b32 v176, s37, v216
    v_and_b32 v177, s37, v160
    v_mfma_f32_16x16x32_bf16 v[92:95], a[140:143], a[112:115], v[92:95]
    s_waitcnt vmcnt(1) lgkmcnt(0)
    s_barrier
    v_mfma_f32_16x16x32_bf16 v[64:67], a[160:163], a[52:55], v[64:67]
    ds_read_b64_tr_b16 a[128:129], v198 offset:36864
    ds_read_b64_tr_b16 a[130:131], v198 offset:41472
    v_mfma_f32_16x16x32_bf16 v[68:71], a[160:163], a[116:119], v[68:71]
    v_mul_f32 v176, v176, v177
    v_mul_f32 v33, v210, v176
    v_mfma_f32_16x16x32_bf16 v[72:75], a[164:167], a[52:55], v[72:75]
    ds_read_b64_tr_b16 a[132:133], v199 offset:36864
    ds_read_b64_tr_b16 a[134:135], v199 offset:41472
    v_mfma_f32_16x16x32_bf16 v[76:79], a[164:167], a[116:119], v[76:79]
    ds_read_b64_tr_b16 a[136:137], v200 offset:36864
    ds_read_b64_tr_b16 a[138:139], v200 offset:41472
    v_mfma_f32_16x16x32_bf16 v[80:83], a[168:171], a[52:55], v[80:83]
    ds_read_b64_tr_b16 a[140:141], v201 offset:36864
    ds_read_b64_tr_b16 a[142:143], v201 offset:41472
    v_mfma_f32_16x16x32_bf16 v[84:87], a[168:171], a[116:119], v[84:87]
    v_lshlrev_b32 v176, 16, v217
    v_lshlrev_b32 v177, 16, v161
    v_mfma_f32_16x16x32_bf16 v[88:91], a[172:175], a[52:55], v[88:91]
    v_mul_f32 v176, v176, v177
    v_mul_f32 v34, v210, v176
    v_mfma_f32_16x16x32_bf16 v[92:95], a[172:175], a[116:119], v[92:95]
    s_waitcnt lgkmcnt(0)
    v_mfma_f32_16x16x32_bf16 v[64:67], a[128:131], a[56:59], v[64:67]
    ds_read_b64_tr_b16 a[160:161], v198 offset:46080
    ds_read_b64_tr_b16 a[162:163], v198 offset:50688
    v_mfma_f32_16x16x32_bf16 v[68:71], a[128:131], a[120:123], v[68:71]
    v_and_b32 v176, s37, v217
    v_and_b32 v177, s37, v161
    v_mfma_f32_16x16x32_bf16 v[72:75], a[132:135], a[56:59], v[72:75]
    ds_read_b64_tr_b16 a[164:165], v199 offset:46080
    ds_read_b64_tr_b16 a[166:167], v199 offset:50688
    v_mfma_f32_16x16x32_bf16 v[76:79], a[132:135], a[120:123], v[76:79]
    ds_read_b64_tr_b16 a[168:169], v200 offset:46080
    ds_read_b64_tr_b16 a[170:171], v200 offset:50688
    v_mfma_f32_16x16x32_bf16 v[80:83], a[136:139], a[56:59], v[80:83]
    ds_read_b64_tr_b16 a[172:173], v201 offset:46080
    ds_read_b64_tr_b16 a[174:175], v201 offset:50688
    v_mfma_f32_16x16x32_bf16 v[84:87], a[136:139], a[120:123], v[84:87]
    v_mul_f32 v176, v176, v177
    v_mul_f32 v35, v210, v176
    v_mfma_f32_16x16x32_bf16 v[88:91], a[140:143], a[56:59], v[88:91]
    v_lshlrev_b32 v176, 16, v218
    v_lshlrev_b32 v177, 16, v162
    v_mfma_f32_16x16x32_bf16 v[92:95], a[140:143], a[120:123], v[92:95]
    s_waitcnt vmcnt(0) lgkmcnt(0)
    v_mfma_f32_16x16x32_bf16 v[64:67], a[160:163], a[60:63], v[64:67]
    v_mfma_f32_16x16x32_bf16 v[68:71], a[160:163], a[124:127], v[68:71]
    v_mul_f32 v176, v176, v177
    v_mul_f32 v36, v211, v176
    v_mfma_f32_16x16x32_bf16 v[72:75], a[164:167], a[60:63], v[72:75]
    v_mfma_f32_16x16x32_bf16 v[76:79], a[164:167], a[124:127], v[76:79]
    v_mfma_f32_16x16x32_bf16 v[80:83], a[168:171], a[60:63], v[80:83]
    v_mfma_f32_16x16x32_bf16 v[84:87], a[168:171], a[124:127], v[84:87]
    v_and_b32 v176, s37, v218
    v_and_b32 v177, s37, v162
    v_mfma_f32_16x16x32_bf16 v[88:91], a[172:175], a[60:63], v[88:91]
    v_mul_f32 v176, v176, v177
    v_mul_f32 v37, v211, v176
    v_mfma_f32_16x16x32_bf16 v[92:95], a[172:175], a[124:127], v[92:95]
    s_waitcnt lgkmcnt(0)
    v_mfma_f32_16x16x32_bf16 v[96:99], a[144:147], a[0:3], v[96:99]
    ds_read_b64_tr_b16 a[176:177], v202 offset:128
    ds_read_b64_tr_b16 a[178:179], v202 offset:4736
    v_mfma_f32_16x16x32_bf16 v[100:103], a[144:147], a[64:67], v[100:103]
    v_mfma_f32_16x16x32_bf16 v[104:107], a[148:151], a[0:3], v[104:107]
    ds_read_b64_tr_b16 a[180:181], v203 offset:128
    ds_read_b64_tr_b16 a[182:183], v203 offset:4736
    v_mfma_f32_16x16x32_bf16 v[108:111], a[148:151], a[64:67], v[108:111]
    ds_read_b64_tr_b16 a[184:185], v204 offset:128
    ds_read_b64_tr_b16 a[186:187], v204 offset:4736
    v_mfma_f32_16x16x32_bf16 v[112:115], a[152:155], a[0:3], v[112:115]
    ds_read_b64_tr_b16 a[188:189], v205 offset:128
    ds_read_b64_tr_b16 a[190:191], v205 offset:4736
    v_mfma_f32_16x16x32_bf16 v[116:119], a[152:155], a[64:67], v[116:119]
    v_cvt_pk_bf16_f32 v64, v64, v65
    v_cvt_pk_bf16_f32 v65, v66, v67
    v_mfma_f32_16x16x32_bf16 v[120:123], a[156:159], a[0:3], v[120:123]
    v_cvt_pk_bf16_f32 v66, v68, v69
    v_cvt_pk_bf16_f32 v67, v70, v71
    v_mfma_f32_16x16x32_bf16 v[124:127], a[156:159], a[64:67], v[124:127]
    s_waitcnt lgkmcnt(0)
    v_cvt_pk_bf16_f32 v68, v72, v73
    v_cvt_pk_bf16_f32 v69, v74, v75
    v_mfma_f32_16x16x32_bf16 v[96:99], a[176:179], a[4:7], v[96:99]
    ds_read_b64_tr_b16 a[144:145], v202 offset:9344
    ds_read_b64_tr_b16 a[146:147], v202 offset:13952
    v_mfma_f32_16x16x32_bf16 v[100:103], a[176:179], a[68:71], v[100:103]
    buffer_store_dwordx4 v[64:67], v16, s[16:19], s46 offen offset:0 sc1
    v_mfma_f32_16x16x32_bf16 v[104:107], a[180:183], a[4:7], v[104:107]
    ds_read_b64_tr_b16 a[148:149], v203 offset:9344
    ds_read_b64_tr_b16 a[150:151], v203 offset:13952
    v_mfma_f32_16x16x32_bf16 v[108:111], a[180:183], a[68:71], v[108:111]
    ds_read_b64_tr_b16 a[152:153], v204 offset:9344
    ds_read_b64_tr_b16 a[154:155], v204 offset:13952
    v_mfma_f32_16x16x32_bf16 v[112:115], a[184:187], a[4:7], v[112:115]
    ds_read_b64_tr_b16 a[156:157], v205 offset:9344
    ds_read_b64_tr_b16 a[158:159], v205 offset:13952
    v_mfma_f32_16x16x32_bf16 v[116:119], a[184:187], a[68:71], v[116:119]
    v_cvt_pk_bf16_f32 v70, v76, v77
    v_cvt_pk_bf16_f32 v71, v78, v79
    v_mfma_f32_16x16x32_bf16 v[120:123], a[188:191], a[4:7], v[120:123]
    v_cvt_pk_bf16_f32 v72, v80, v81
    v_cvt_pk_bf16_f32 v73, v82, v83
    v_mfma_f32_16x16x32_bf16 v[124:127], a[188:191], a[68:71], v[124:127]
    s_waitcnt lgkmcnt(0)
    v_cvt_pk_bf16_f32 v74, v84, v85
    v_cvt_pk_bf16_f32 v75, v86, v87
    v_mfma_f32_16x16x32_bf16 v[96:99], a[144:147], a[8:11], v[96:99]
    ds_read_b64_tr_b16 a[176:177], v194 offset:128
    ds_read_b64_tr_b16 a[178:179], v194 offset:4736
    v_mfma_f32_16x16x32_bf16 v[100:103], a[144:147], a[72:75], v[100:103]
    buffer_store_dwordx4 v[68:71], v16, s[16:19], s46 offen offset:1024 sc1
    v_mfma_f32_16x16x32_bf16 v[104:107], a[148:151], a[8:11], v[104:107]
    ds_read_b64_tr_b16 a[180:181], v195 offset:128
    ds_read_b64_tr_b16 a[182:183], v195 offset:4736
    v_mfma_f32_16x16x32_bf16 v[108:111], a[148:151], a[72:75], v[108:111]
    ds_read_b64_tr_b16 a[184:185], v196 offset:128
    ds_read_b64_tr_b16 a[186:187], v196 offset:4736
    v_mfma_f32_16x16x32_bf16 v[112:115], a[152:155], a[8:11], v[112:115]
    ds_read_b64_tr_b16 a[188:189], v197 offset:128
    ds_read_b64_tr_b16 a[190:191], v197 offset:4736
    v_mfma_f32_16x16x32_bf16 v[116:119], a[152:155], a[72:75], v[116:119]
    v_cvt_pk_bf16_f32 v76, v88, v89
    v_cvt_pk_bf16_f32 v77, v90, v91
    v_mfma_f32_16x16x32_bf16 v[120:123], a[156:159], a[8:11], v[120:123]
    v_cvt_pk_bf16_f32 v78, v92, v93
    v_cvt_pk_bf16_f32 v79, v94, v95
    v_mfma_f32_16x16x32_bf16 v[124:127], a[156:159], a[72:75], v[124:127]
    s_waitcnt lgkmcnt(0)
    v_lshlrev_b32 v176, 16, v219
    v_lshlrev_b32 v177, 16, v163
    v_mfma_f32_16x16x32_bf16 v[96:99], a[176:179], a[12:15], v[96:99]
    ds_read_b64_tr_b16 a[144:145], v194 offset:9344
    ds_read_b64_tr_b16 a[146:147], v194 offset:13952
    v_mfma_f32_16x16x32_bf16 v[100:103], a[176:179], a[76:79], v[100:103]
    buffer_store_dwordx4 v[72:75], v16, s[16:19], s46 offen offset:2048 sc1
    v_mfma_f32_16x16x32_bf16 v[104:107], a[180:183], a[12:15], v[104:107]
    ds_read_b64_tr_b16 a[148:149], v195 offset:9344
    ds_read_b64_tr_b16 a[150:151], v195 offset:13952
    v_mfma_f32_16x16x32_bf16 v[108:111], a[180:183], a[76:79], v[108:111]
    ds_read_b64_tr_b16 a[152:153], v196 offset:9344
    ds_read_b64_tr_b16 a[154:155], v196 offset:13952
    v_mfma_f32_16x16x32_bf16 v[112:115], a[184:187], a[12:15], v[112:115]
    ds_read_b64_tr_b16 a[156:157], v197 offset:9344
    ds_read_b64_tr_b16 a[158:159], v197 offset:13952
    v_mfma_f32_16x16x32_bf16 v[116:119], a[184:187], a[76:79], v[116:119]
    v_mul_f32 v176, v176, v177
    v_mul_f32 v38, v211, v176
    v_mfma_f32_16x16x32_bf16 v[120:123], a[188:191], a[12:15], v[120:123]
    v_and_b32 v176, s37, v219
    v_and_b32 v177, s37, v163
    v_mfma_f32_16x16x32_bf16 v[124:127], a[188:191], a[76:79], v[124:127]
    s_waitcnt lgkmcnt(0)
    v_mul_f32 v176, v176, v177
    v_mul_f32 v39, v211, v176
    v_mfma_f32_16x16x32_bf16 v[96:99], a[144:147], a[16:19], v[96:99]
    ds_read_b64_tr_b16 a[176:177], v194 offset:18560
    ds_read_b64_tr_b16 a[178:179], v194 offset:23168
    v_mfma_f32_16x16x32_bf16 v[100:103], a[144:147], a[80:83], v[100:103]
    buffer_store_dwordx4 v[76:79], v16, s[16:19], s46 offen offset:3072 sc1
    v_mfma_f32_16x16x32_bf16 v[104:107], a[148:151], a[16:19], v[104:107]
    ds_read_b64_tr_b16 a[180:181], v195 offset:18560
    ds_read_b64_tr_b16 a[182:183], v195 offset:23168
    v_mfma_f32_16x16x32_bf16 v[108:111], a[148:151], a[80:83], v[108:111]
    ds_read_b64_tr_b16 a[184:185], v196 offset:18560
    ds_read_b64_tr_b16 a[186:187], v196 offset:23168
    v_mfma_f32_16x16x32_bf16 v[112:115], a[152:155], a[16:19], v[112:115]
    ds_read_b64_tr_b16 a[188:189], v197 offset:18560
    ds_read_b64_tr_b16 a[190:191], v197 offset:23168
    v_mfma_f32_16x16x32_bf16 v[116:119], a[152:155], a[80:83], v[116:119]
    v_lshlrev_b32 v176, 16, v220
    v_lshlrev_b32 v177, 16, v164
    v_mfma_f32_16x16x32_bf16 v[120:123], a[156:159], a[16:19], v[120:123]
    v_mul_f32 v176, v176, v177
    v_mul_f32 v40, v210, v176
    v_mfma_f32_16x16x32_bf16 v[124:127], a[156:159], a[80:83], v[124:127]
    s_waitcnt lgkmcnt(0)
    v_and_b32 v176, s37, v220
    v_and_b32 v177, s37, v164
    v_mfma_f32_16x16x32_bf16 v[96:99], a[176:179], a[20:23], v[96:99]
    ds_read_b64_tr_b16 a[144:145], v194 offset:27776
    ds_read_b64_tr_b16 a[146:147], v194 offset:32384
    v_mfma_f32_16x16x32_bf16 v[100:103], a[176:179], a[84:87], v[100:103]
    v_mul_f32 v176, v176, v177
    v_mul_f32 v41, v210, v176
    v_mfma_f32_16x16x32_bf16 v[104:107], a[180:183], a[20:23], v[104:107]
    ds_read_b64_tr_b16 a[148:149], v195 offset:27776
    ds_read_b64_tr_b16 a[150:151], v195 offset:32384
    v_mfma_f32_16x16x32_bf16 v[108:111], a[180:183], a[84:87], v[108:111]
    ds_read_b64_tr_b16 a[152:153], v196 offset:27776
    ds_read_b64_tr_b16 a[154:155], v196 offset:32384
    v_mfma_f32_16x16x32_bf16 v[112:115], a[184:187], a[20:23], v[112:115]
    ds_read_b64_tr_b16 a[156:157], v197 offset:27776
    ds_read_b64_tr_b16 a[158:159], v197 offset:32384
    v_mfma_f32_16x16x32_bf16 v[116:119], a[184:187], a[84:87], v[116:119]
    v_lshlrev_b32 v176, 16, v221
    v_lshlrev_b32 v177, 16, v165
    v_mfma_f32_16x16x32_bf16 v[120:123], a[188:191], a[20:23], v[120:123]
    v_mul_f32 v176, v176, v177
    v_mul_f32 v42, v210, v176
    v_mfma_f32_16x16x32_bf16 v[124:127], a[188:191], a[84:87], v[124:127]
    s_waitcnt lgkmcnt(0)
    v_and_b32 v176, s37, v221
    v_and_b32 v177, s37, v165
    v_mfma_f32_16x16x32_bf16 v[96:99], a[144:147], a[24:27], v[96:99]
    ds_read_b64_tr_b16 a[176:177], v194 offset:36992
    ds_read_b64_tr_b16 a[178:179], v194 offset:41600
    v_mfma_f32_16x16x32_bf16 v[100:103], a[144:147], a[88:91], v[100:103]
    v_mul_f32 v176, v176, v177
    v_mul_f32 v43, v210, v176
    v_mfma_f32_16x16x32_bf16 v[104:107], a[148:151], a[24:27], v[104:107]
    ds_read_b64_tr_b16 a[180:181], v195 offset:36992
    ds_read_b64_tr_b16 a[182:183], v195 offset:41600
    v_mfma_f32_16x16x32_bf16 v[108:111], a[148:151], a[88:91], v[108:111]
    ds_read_b64_tr_b16 a[184:185], v196 offset:36992
    ds_read_b64_tr_b16 a[186:187], v196 offset:41600
    v_mfma_f32_16x16x32_bf16 v[112:115], a[152:155], a[24:27], v[112:115]
    ds_read_b64_tr_b16 a[188:189], v197 offset:36992
    ds_read_b64_tr_b16 a[190:191], v197 offset:41600
    v_mfma_f32_16x16x32_bf16 v[116:119], a[152:155], a[88:91], v[116:119]
    v_lshlrev_b32 v176, 16, v222
    v_lshlrev_b32 v177, 16, v166
    v_mfma_f32_16x16x32_bf16 v[120:123], a[156:159], a[24:27], v[120:123]
    v_mul_f32 v176, v176, v177
    v_mul_f32 v44, v211, v176
    v_mfma_f32_16x16x32_bf16 v[124:127], a[156:159], a[88:91], v[124:127]
    s_waitcnt lgkmcnt(0)
    v_and_b32 v176, s37, v222
    v_and_b32 v177, s37, v166
    v_mfma_f32_16x16x32_bf16 v[96:99], a[176:179], a[28:31], v[96:99]
    ds_read_b64_tr_b16 a[144:145], v194 offset:46208
    ds_read_b64_tr_b16 a[146:147], v194 offset:50816
    v_mfma_f32_16x16x32_bf16 v[100:103], a[176:179], a[92:95], v[100:103]
    v_mul_f32 v176, v176, v177
    v_mul_f32 v45, v211, v176
    v_mfma_f32_16x16x32_bf16 v[104:107], a[180:183], a[28:31], v[104:107]
    ds_read_b64_tr_b16 a[148:149], v195 offset:46208
    ds_read_b64_tr_b16 a[150:151], v195 offset:50816
    v_mfma_f32_16x16x32_bf16 v[108:111], a[180:183], a[92:95], v[108:111]
    ds_read_b64_tr_b16 a[152:153], v196 offset:46208
    ds_read_b64_tr_b16 a[154:155], v196 offset:50816
    v_mfma_f32_16x16x32_bf16 v[112:115], a[184:187], a[28:31], v[112:115]
    ds_read_b64_tr_b16 a[156:157], v197 offset:46208
    ds_read_b64_tr_b16 a[158:159], v197 offset:50816
    v_mfma_f32_16x16x32_bf16 v[116:119], a[184:187], a[92:95], v[116:119]
    v_lshlrev_b32 v176, 16, v223
    v_lshlrev_b32 v177, 16, v167
    v_mfma_f32_16x16x32_bf16 v[120:123], a[188:191], a[28:31], v[120:123]
    v_mul_f32 v176, v176, v177
    v_mul_f32 v46, v211, v176
    v_mfma_f32_16x16x32_bf16 v[124:127], a[188:191], a[92:95], v[124:127]
    s_waitcnt lgkmcnt(0)
    v_and_b32 v176, s37, v223
    v_and_b32 v177, s37, v167
    v_mfma_f32_16x16x32_bf16 v[96:99], a[144:147], a[32:35], v[96:99]
    ds_read_b64_tr_b16 a[176:177], v194 offset:55424
    ds_read_b64_tr_b16 a[178:179], v194 offset:60032
    v_mfma_f32_16x16x32_bf16 v[100:103], a[144:147], a[96:99], v[100:103]
    v_mul_f32 v176, v176, v177
    v_mul_f32 v47, v211, v176
    v_mfma_f32_16x16x32_bf16 v[104:107], a[148:151], a[32:35], v[104:107]
    ds_read_b64_tr_b16 a[180:181], v195 offset:55424
    ds_read_b64_tr_b16 a[182:183], v195 offset:60032
    v_mfma_f32_16x16x32_bf16 v[108:111], a[148:151], a[96:99], v[108:111]
    ds_read_b64_tr_b16 a[184:185], v196 offset:55424
    ds_read_b64_tr_b16 a[186:187], v196 offset:60032
    v_mfma_f32_16x16x32_bf16 v[112:115], a[152:155], a[32:35], v[112:115]
    ds_read_b64_tr_b16 a[188:189], v197 offset:55424
    ds_read_b64_tr_b16 a[190:191], v197 offset:60032
    v_mfma_f32_16x16x32_bf16 v[116:119], a[152:155], a[96:99], v[116:119]
    v_lshlrev_b32 v176, 16, v224
    v_lshlrev_b32 v177, 16, v168
    v_mfma_f32_16x16x32_bf16 v[120:123], a[156:159], a[32:35], v[120:123]
    v_mul_f32 v176, v176, v177
    v_mul_f32 v48, v210, v176
    v_mfma_f32_16x16x32_bf16 v[124:127], a[156:159], a[96:99], v[124:127]
    s_waitcnt lgkmcnt(0)
    v_and_b32 v176, s37, v224
    v_and_b32 v177, s37, v168
    v_mfma_f32_16x16x32_bf16 v[96:99], a[176:179], a[36:39], v[96:99]
    ds_read_b64_tr_b16 a[144:145], v198 offset:128
    ds_read_b64_tr_b16 a[146:147], v198 offset:4736
    v_mfma_f32_16x16x32_bf16 v[100:103], a[176:179], a[100:103], v[100:103]
    v_mul_f32 v176, v176, v177
    v_mul_f32 v49, v210, v176
    v_mfma_f32_16x16x32_bf16 v[104:107], a[180:183], a[36:39], v[104:107]
    ds_read_b64_tr_b16 a[148:149], v199 offset:128
    ds_read_b64_tr_b16 a[150:151], v199 offset:4736
    v_mfma_f32_16x16x32_bf16 v[108:111], a[180:183], a[100:103], v[108:111]
    ds_read_b64_tr_b16 a[152:153], v200 offset:128
    ds_read_b64_tr_b16 a[154:155], v200 offset:4736
    v_mfma_f32_16x16x32_bf16 v[112:115], a[184:187], a[36:39], v[112:115]
    ds_read_b64_tr_b16 a[156:157], v201 offset:128
    ds_read_b64_tr_b16 a[158:159], v201 offset:4736
    v_mfma_f32_16x16x32_bf16 v[116:119], a[184:187], a[100:103], v[116:119]
    v_lshlrev_b32 v176, 16, v225
    v_lshlrev_b32 v177, 16, v169
    v_mfma_f32_16x16x32_bf16 v[120:123], a[188:191], a[36:39], v[120:123]
    v_mul_f32 v176, v176, v177
    v_mul_f32 v50, v210, v176
    v_mfma_f32_16x16x32_bf16 v[124:127], a[188:191], a[100:103], v[124:127]
    s_waitcnt lgkmcnt(0)
    v_and_b32 v176, s37, v225
    v_and_b32 v177, s37, v169
    v_mfma_f32_16x16x32_bf16 v[96:99], a[144:147], a[40:43], v[96:99]
    ds_read_b64_tr_b16 a[176:177], v198 offset:9344
    ds_read_b64_tr_b16 a[178:179], v198 offset:13952
    v_mfma_f32_16x16x32_bf16 v[100:103], a[144:147], a[104:107], v[100:103]
    v_mul_f32 v176, v176, v177
    v_mul_f32 v51, v210, v176
    v_mfma_f32_16x16x32_bf16 v[104:107], a[148:151], a[40:43], v[104:107]
    ds_read_b64_tr_b16 a[180:181], v199 offset:9344
    ds_read_b64_tr_b16 a[182:183], v199 offset:13952
    v_mfma_f32_16x16x32_bf16 v[108:111], a[148:151], a[104:107], v[108:111]
    ds_read_b64_tr_b16 a[184:185], v200 offset:9344
    ds_read_b64_tr_b16 a[186:187], v200 offset:13952
    v_mfma_f32_16x16x32_bf16 v[112:115], a[152:155], a[40:43], v[112:115]
    ds_read_b64_tr_b16 a[188:189], v201 offset:9344
    ds_read_b64_tr_b16 a[190:191], v201 offset:13952
    v_mfma_f32_16x16x32_bf16 v[116:119], a[152:155], a[104:107], v[116:119]
    v_lshlrev_b32 v176, 16, v226
    v_lshlrev_b32 v177, 16, v170
    v_mfma_f32_16x16x32_bf16 v[120:123], a[156:159], a[40:43], v[120:123]
    v_mul_f32 v176, v176, v177
    v_mul_f32 v52, v211, v176
    v_mfma_f32_16x16x32_bf16 v[124:127], a[156:159], a[104:107], v[124:127]
    s_waitcnt lgkmcnt(0)
    v_and_b32 v176, s37, v226
    v_and_b32 v177, s37, v170
    v_mfma_f32_16x16x32_bf16 v[96:99], a[176:179], a[44:47], v[96:99]
    ds_read_b64_tr_b16 a[144:145], v198 offset:18560
    ds_read_b64_tr_b16 a[146:147], v198 offset:23168
    v_mfma_f32_16x16x32_bf16 v[100:103], a[176:179], a[108:111], v[100:103]
    v_mul_f32 v176, v176, v177
    v_mul_f32 v53, v211, v176
    v_mfma_f32_16x16x32_bf16 v[104:107], a[180:183], a[44:47], v[104:107]
    ds_read_b64_tr_b16 a[148:149], v199 offset:18560
    ds_read_b64_tr_b16 a[150:151], v199 offset:23168
    v_mfma_f32_16x16x32_bf16 v[108:111], a[180:183], a[108:111], v[108:111]
    ds_read_b64_tr_b16 a[152:153], v200 offset:18560
    ds_read_b64_tr_b16 a[154:155], v200 offset:23168
    v_mfma_f32_16x16x32_bf16 v[112:115], a[184:187], a[44:47], v[112:115]
    ds_read_b64_tr_b16 a[156:157], v201 offset:18560
    ds_read_b64_tr_b16 a[158:159], v201 offset:23168
    v_mfma_f32_16x16x32_bf16 v[116:119], a[184:187], a[108:111], v[116:119]
    v_lshlrev_b32 v176, 16, v227
    v_lshlrev_b32 v177, 16, v171
    v_mfma_f32_16x16x32_bf16 v[120:123], a[188:191], a[44:47], v[120:123]
    v_mul_f32 v176, v176, v177
    v_mul_f32 v54, v211, v176
    v_mfma_f32_16x16x32_bf16 v[124:127], a[188:191], a[108:111], v[124:127]
    s_waitcnt lgkmcnt(0)
    v_and_b32 v176, s37, v227
    v_and_b32 v177, s37, v171
    v_mfma_f32_16x16x32_bf16 v[96:99], a[144:147], a[48:51], v[96:99]
    ds_read_b64_tr_b16 a[176:177], v198 offset:27776
    ds_read_b64_tr_b16 a[178:179], v198 offset:32384
    v_mfma_f32_16x16x32_bf16 v[100:103], a[144:147], a[112:115], v[100:103]
    v_mul_f32 v176, v176, v177
    v_mul_f32 v55, v211, v176
    v_mfma_f32_16x16x32_bf16 v[104:107], a[148:151], a[48:51], v[104:107]
    ds_read_b64_tr_b16 a[180:181], v199 offset:27776
    ds_read_b64_tr_b16 a[182:183], v199 offset:32384
    v_mfma_f32_16x16x32_bf16 v[108:111], a[148:151], a[112:115], v[108:111]
    ds_read_b64_tr_b16 a[184:185], v200 offset:27776
    ds_read_b64_tr_b16 a[186:187], v200 offset:32384
    v_mfma_f32_16x16x32_bf16 v[112:115], a[152:155], a[48:51], v[112:115]
    ds_read_b64_tr_b16 a[188:189], v201 offset:27776
    ds_read_b64_tr_b16 a[190:191], v201 offset:32384
    v_mfma_f32_16x16x32_bf16 v[116:119], a[152:155], a[112:115], v[116:119]
    v_lshlrev_b32 v176, 16, v228
    v_lshlrev_b32 v177, 16, v172
    v_mfma_f32_16x16x32_bf16 v[120:123], a[156:159], a[48:51], v[120:123]
    v_mul_f32 v176, v176, v177
    v_mul_f32 v56, v210, v176
    v_mfma_f32_16x16x32_bf16 v[124:127], a[156:159], a[112:115], v[124:127]
    s_waitcnt lgkmcnt(0)
    v_and_b32 v176, s37, v228
    v_and_b32 v177, s37, v172
    v_mfma_f32_16x16x32_bf16 v[96:99], a[176:179], a[52:55], v[96:99]
    ds_read_b64_tr_b16 a[144:145], v198 offset:36992
    ds_read_b64_tr_b16 a[146:147], v198 offset:41600
    v_mfma_f32_16x16x32_bf16 v[100:103], a[176:179], a[116:119], v[100:103]
    v_mul_f32 v176, v176, v177
    v_mul_f32 v57, v210, v176
    v_mfma_f32_16x16x32_bf16 v[104:107], a[180:183], a[52:55], v[104:107]
    ds_read_b64_tr_b16 a[148:149], v199 offset:36992
    ds_read_b64_tr_b16 a[150:151], v199 offset:41600
    v_mfma_f32_16x16x32_bf16 v[108:111], a[180:183], a[116:119], v[108:111]
    ds_read_b64_tr_b16 a[152:153], v200 offset:36992
    ds_read_b64_tr_b16 a[154:155], v200 offset:41600
    v_mfma_f32_16x16x32_bf16 v[112:115], a[184:187], a[52:55], v[112:115]
    ds_read_b64_tr_b16 a[156:157], v201 offset:36992
    ds_read_b64_tr_b16 a[158:159], v201 offset:41600
    v_mfma_f32_16x16x32_bf16 v[116:119], a[184:187], a[116:119], v[116:119]
    s_xor_b32 s46, s46, 32768
    v_lshlrev_b32 v176, 16, v229
    v_lshlrev_b32 v177, 16, v173
    v_mfma_f32_16x16x32_bf16 v[120:123], a[188:191], a[52:55], v[120:123]
    v_mul_f32 v176, v176, v177
    v_mul_f32 v58, v210, v176
    v_mfma_f32_16x16x32_bf16 v[124:127], a[188:191], a[116:119], v[124:127]
    s_waitcnt lgkmcnt(0)
    v_and_b32 v176, s37, v229
    v_and_b32 v177, s37, v173
    v_mfma_f32_16x16x32_bf16 v[96:99], a[144:147], a[56:59], v[96:99]
    ds_read_b64_tr_b16 a[176:177], v198 offset:46208
    ds_read_b64_tr_b16 a[178:179], v198 offset:50816
    v_mfma_f32_16x16x32_bf16 v[100:103], a[144:147], a[120:123], v[100:103]
    buffer_load_dwordx4 v[128:131], v16, s[16:19], s46 offen offset:0 sc1
    v_mfma_f32_16x16x32_bf16 v[104:107], a[148:151], a[56:59], v[104:107]
    ds_read_b64_tr_b16 a[180:181], v199 offset:46208
    ds_read_b64_tr_b16 a[182:183], v199 offset:50816
    v_mfma_f32_16x16x32_bf16 v[108:111], a[148:151], a[120:123], v[108:111]
    ds_read_b64_tr_b16 a[184:185], v200 offset:46208
    ds_read_b64_tr_b16 a[186:187], v200 offset:50816
    v_mfma_f32_16x16x32_bf16 v[112:115], a[152:155], a[56:59], v[112:115]
    ds_read_b64_tr_b16 a[188:189], v201 offset:46208
    ds_read_b64_tr_b16 a[190:191], v201 offset:50816
    v_mfma_f32_16x16x32_bf16 v[116:119], a[152:155], a[120:123], v[116:119]
    v_mul_f32 v176, v176, v177
    v_mul_f32 v59, v210, v176
    v_mfma_f32_16x16x32_bf16 v[120:123], a[156:159], a[56:59], v[120:123]
    buffer_load_dwordx4 v[132:135], v16, s[16:19], s46 offen offset:1024 sc1
    v_mfma_f32_16x16x32_bf16 v[124:127], a[156:159], a[120:123], v[124:127]
    s_waitcnt lgkmcnt(0)
    v_lshlrev_b32 v176, 16, v230
    v_lshlrev_b32 v177, 16, v174
    v_mfma_f32_16x16x32_bf16 v[96:99], a[176:179], a[60:63], v[96:99]
    v_mfma_f32_16x16x32_bf16 v[100:103], a[176:179], a[124:127], v[100:103]
    buffer_load_dwordx4 v[136:139], v16, s[16:19], s46 offen offset:2048 sc1
    v_mfma_f32_16x16x32_bf16 v[104:107], a[180:183], a[60:63], v[104:107]
    v_mfma_f32_16x16x32_bf16 v[108:111], a[180:183], a[124:127], v[108:111]
    v_mfma_f32_16x16x32_bf16 v[112:115], a[184:187], a[60:63], v[112:115]
    v_mfma_f32_16x16x32_bf16 v[116:119], a[184:187], a[124:127], v[116:119]
    v_mul_f32 v176, v176, v177
    v_mul_f32 v60, v211, v176
    v_mfma_f32_16x16x32_bf16 v[120:123], a[188:191], a[60:63], v[120:123]
    buffer_load_dwordx4 v[140:143], v16, s[16:19], s46 offen offset:3072 sc1
    v_mfma_f32_16x16x32_bf16 v[124:127], a[188:191], a[124:127], v[124:127]
    s_waitcnt lgkmcnt(0)
    v_and_b32 v176, s37, v230
    v_and_b32 v177, s37, v174
    v_mul_f32 v176, v176, v177
    v_mul_f32 v61, v211, v176
    v_lshlrev_b32 v176, 16, v231
    v_lshlrev_b32 v177, 16, v175
    v_mul_f32 v176, v176, v177
    v_mul_f32 v62, v211, v176
    v_and_b32 v176, s37, v231
    v_and_b32 v177, s37, v175
    v_mul_f32 v176, v176, v177
    v_mul_f32 v63, v211, v176
    v_sub_f32 v210, 1.0, v210
    v_sub_f32 v211, 1.0, v211
    s_waitcnt vmcnt(0)
    v_max3_u32 v178, v128, v129, v130
    v_max3_u32 v178, v178, v131, v132
    v_max3_u32 v178, v178, v133, v134
    v_max3_u32 v178, v178, v135, v136
    v_max3_u32 v178, v178, v137, v138
    v_max3_u32 v178, v178, v139, v140
    v_max3_u32 v178, v178, v141, v142
    v_max_u32 v178, v178, v143
    v_cmp_eq_u32 vcc, -1, v178
    s_nop 0
    s_cbranch_vccnz gated_mix__ssm_conv_h3__compressed_kv_cla__prompt_kernel_spin_x
gated_mix__ssm_conv_h3__compressed_kv_cla__prompt_kernel_spin_x_ret:
    v_lshlrev_b32 v176, 16, v128
    v_add_f32 v96, v96, v176
    v_and_b32 v177, s37, v128
    v_add_f32 v97, v97, v177
    v_lshlrev_b32 v178, 16, v129
    v_add_f32 v98, v98, v178
    v_and_b32 v179, s37, v129
    v_add_f32 v99, v99, v179
    v_fma_f32 v96, v96, v210, v32
    v_fma_f32 v97, v97, v210, v33
    v_fma_f32 v98, v98, v210, v34
    v_fma_f32 v99, v99, v210, v35
    v_cvt_pk_bf16_f32 v96, v96, v97
    v_cvt_pk_bf16_f32 v97, v98, v99
    buffer_store_dwordx2 v[96:97], v206, s[20:23], s48 offen offset:0
    v_lshlrev_b32 v176, 16, v130
    v_add_f32 v100, v100, v176
    v_and_b32 v177, s37, v130
    v_add_f32 v101, v101, v177
    v_lshlrev_b32 v178, 16, v131
    v_add_f32 v102, v102, v178
    v_and_b32 v179, s37, v131
    v_add_f32 v103, v103, v179
    v_fma_f32 v100, v100, v211, v36
    v_fma_f32 v101, v101, v211, v37
    v_fma_f32 v102, v102, v211, v38
    v_fma_f32 v103, v103, v211, v39
    v_cvt_pk_bf16_f32 v100, v100, v101
    v_cvt_pk_bf16_f32 v101, v102, v103
    buffer_store_dwordx2 v[100:101], v206, s[20:23], s49 offen offset:0
    v_lshlrev_b32 v176, 16, v132
    v_add_f32 v104, v104, v176
    v_and_b32 v177, s37, v132
    v_add_f32 v105, v105, v177
    v_lshlrev_b32 v178, 16, v133
    v_add_f32 v106, v106, v178
    v_and_b32 v179, s37, v133
    v_add_f32 v107, v107, v179
    v_fma_f32 v104, v104, v210, v40
    v_fma_f32 v105, v105, v210, v41
    v_fma_f32 v106, v106, v210, v42
    v_fma_f32 v107, v107, v210, v43
    v_cvt_pk_bf16_f32 v104, v104, v105
    v_cvt_pk_bf16_f32 v105, v106, v107
    buffer_store_dwordx2 v[104:105], v206, s[20:23], s48 offen offset:32
    v_lshlrev_b32 v176, 16, v134
    v_add_f32 v108, v108, v176
    v_and_b32 v177, s37, v134
    v_add_f32 v109, v109, v177
    v_lshlrev_b32 v178, 16, v135
    v_add_f32 v110, v110, v178
    v_and_b32 v179, s37, v135
    v_add_f32 v111, v111, v179
    v_fma_f32 v108, v108, v211, v44
    v_fma_f32 v109, v109, v211, v45
    v_fma_f32 v110, v110, v211, v46
    v_fma_f32 v111, v111, v211, v47
    v_cvt_pk_bf16_f32 v108, v108, v109
    v_cvt_pk_bf16_f32 v109, v110, v111
    buffer_store_dwordx2 v[108:109], v206, s[20:23], s49 offen offset:32
    v_lshlrev_b32 v176, 16, v136
    v_add_f32 v112, v112, v176
    v_and_b32 v177, s37, v136
    v_add_f32 v113, v113, v177
    v_lshlrev_b32 v178, 16, v137
    v_add_f32 v114, v114, v178
    v_and_b32 v179, s37, v137
    v_add_f32 v115, v115, v179
    v_fma_f32 v112, v112, v210, v48
    v_fma_f32 v113, v113, v210, v49
    v_fma_f32 v114, v114, v210, v50
    v_fma_f32 v115, v115, v210, v51
    v_cvt_pk_bf16_f32 v112, v112, v113
    v_cvt_pk_bf16_f32 v113, v114, v115
    buffer_store_dwordx2 v[112:113], v206, s[20:23], s48 offen offset:64
    v_lshlrev_b32 v176, 16, v138
    v_add_f32 v116, v116, v176
    v_and_b32 v177, s37, v138
    v_add_f32 v117, v117, v177
    v_lshlrev_b32 v178, 16, v139
    v_add_f32 v118, v118, v178
    v_and_b32 v179, s37, v139
    v_add_f32 v119, v119, v179
    v_fma_f32 v116, v116, v211, v52
    v_fma_f32 v117, v117, v211, v53
    v_fma_f32 v118, v118, v211, v54
    v_fma_f32 v119, v119, v211, v55
    v_cvt_pk_bf16_f32 v116, v116, v117
    v_cvt_pk_bf16_f32 v117, v118, v119
    buffer_store_dwordx2 v[116:117], v206, s[20:23], s49 offen offset:64
    v_lshlrev_b32 v176, 16, v140
    v_add_f32 v120, v120, v176
    v_and_b32 v177, s37, v140
    v_add_f32 v121, v121, v177
    v_lshlrev_b32 v178, 16, v141
    v_add_f32 v122, v122, v178
    v_and_b32 v179, s37, v141
    v_add_f32 v123, v123, v179
    v_fma_f32 v120, v120, v210, v56
    v_fma_f32 v121, v121, v210, v57
    v_fma_f32 v122, v122, v210, v58
    v_fma_f32 v123, v123, v210, v59
    v_cvt_pk_bf16_f32 v120, v120, v121
    v_cvt_pk_bf16_f32 v121, v122, v123
    buffer_store_dwordx2 v[120:121], v206, s[20:23], s48 offen offset:96
    v_lshlrev_b32 v176, 16, v142
    v_add_f32 v124, v124, v176
    v_and_b32 v177, s37, v142
    v_add_f32 v125, v125, v177
    v_lshlrev_b32 v178, 16, v143
    v_add_f32 v126, v126, v178
    v_and_b32 v179, s37, v143
    v_add_f32 v127, v127, v179
    v_fma_f32 v124, v124, v211, v60
    v_fma_f32 v125, v125, v211, v61
    v_fma_f32 v126, v126, v211, v62
    v_fma_f32 v127, v127, v211, v63
    v_cvt_pk_bf16_f32 v124, v124, v125
    v_cvt_pk_bf16_f32 v125, v126, v127
    buffer_store_dwordx2 v[124:125], v206, s[20:23], s49 offen offset:96
gated_mix__ssm_conv_h3__compressed_kv_cla__prompt_kernel_end:
    s_endpgm
gated_mix__ssm_conv_h3__compressed_kv_cla__prompt_kernel_wb:
    buffer_wbl2 sc1
    s_waitcnt vmcnt(0)
    s_branch gated_mix__ssm_conv_h3__compressed_kv_cla__prompt_kernel_wb_ret
gated_mix__ssm_conv_h3__compressed_kv_cla__prompt_kernel_spin_kv:
    s_mov_b32 s54, 0
gated_mix__ssm_conv_h3__compressed_kv_cla__prompt_kernel_spin_kv_again:
    s_sleep 2
    buffer_load_dword v2, v3, s[16:19], s40 offen sc1
    s_waitcnt vmcnt(0)
    v_cmp_gt_u32 vcc, 8, v2
    s_add_u32 s54, s54, 1
    s_cmp_gt_u32 s54, 0x40000
    s_cbranch_scc1 gated_mix__ssm_conv_h3__compressed_kv_cla__prompt_kernel_spin_kv_ret
    s_cbranch_vccnz gated_mix__ssm_conv_h3__compressed_kv_cla__prompt_kernel_spin_kv_again
    s_branch gated_mix__ssm_conv_h3__compressed_kv_cla__prompt_kernel_spin_kv_ret
gated_mix__ssm_conv_h3__compressed_kv_cla__prompt_kernel_b4_sw:
    s_waitcnt vmcnt(8)
    v_cmp_gt_u32 vcc, 8, v17
    s_mov_b32 s58, s35
    s_cbranch_vccnz gated_mix__ssm_conv_h3__compressed_kv_cla__prompt_kernel_b4_sw_spin
gated_mix__ssm_conv_h3__compressed_kv_cla__prompt_kernel_b4_sw_spin_ret:
    s_lshl_b32 s36, s2, 2
    s_cmp_eq_u32 s32, 0
    s_cbranch_scc1 gated_mix__ssm_conv_h3__compressed_kv_cla__prompt_kernel_b4_sw_h
    s_add_u32 s12, s94, 50331648
    s_addc_u32 s13, s95, 0
    s_mov_b32 s14, 4718592
    s_mov_b32 s15, 0x00020000
    s_mul_i32 s38, s36, 4608
    s_movk_i32 s44, 4608
    s_mov_b32 s49, -2
    s_movk_i32 s50, 4640
    s_lshl_b32 s37, s32, 2
    s_sub_u32 s37, 10, s37
    s_add_u32 s38, s38, s37
    s_mul_i32 s59, s32, 9280
    s_add_u32 s59, s59, 4294966496
    s_cmp_eq_u32 s32, 3
    s_cbranch_scc0 gated_mix__ssm_conv_h3__compressed_kv_cla__prompt_kernel_b4_sw_go
    s_mov_b32 s14, 0
    s_mov_b32 s38, 2
    s_movk_i32 s59, 27648
    s_mov_b32 s50, 0
    s_branch gated_mix__ssm_conv_h3__compressed_kv_cla__prompt_kernel_b4_sw_go
gated_mix__ssm_conv_h3__compressed_kv_cla__prompt_kernel_b4_sw_h:
    s_mov_b32 s12, s72
    s_mov_b32 s13, s73
    s_mov_b32 s14, 4194304
    s_mov_b32 s15, 0x00020000
    s_lshl_b32 s38, s36, 12
    s_movk_i32 s44, 4096
    s_mov_b32 s49, 8
    s_movk_i32 s50, 4240
    s_movk_i32 s59, 128
gated_mix__ssm_conv_h3__compressed_kv_cla__prompt_kernel_b4_sw_go:
    s_mov_b32 s40, s59
    s_add_u32 s41, s59, s50
    s_branch gated_mix__ssm_conv_h3__compressed_kv_cla__prompt_kernel_b4_loop
gated_mix__ssm_conv_h3__compressed_kv_cla__prompt_kernel_b4_sw_spin:
    s_mov_b32 s54, 0
gated_mix__ssm_conv_h3__compressed_kv_cla__prompt_kernel_b4_sw_spin_again:
    s_sleep 2
    buffer_load_dword v17, v18, s[20:23], 0 offen sc1
    s_waitcnt vmcnt(0)
    v_cmp_gt_u32 vcc, 8, v17
    s_add_u32 s54, s54, 1
    s_cmp_gt_u32 s54, 0x40000
    s_cbranch_scc1 gated_mix__ssm_conv_h3__compressed_kv_cla__prompt_kernel_b4_sw_spin_ret
    s_cbranch_vccnz gated_mix__ssm_conv_h3__compressed_kv_cla__prompt_kernel_b4_sw_spin_again
    s_branch gated_mix__ssm_conv_h3__compressed_kv_cla__prompt_kernel_b4_sw_spin_ret
gated_mix__ssm_conv_h3__compressed_kv_cla__prompt_kernel_b2_sw:
    s_waitcnt vmcnt(8)
    v_cmp_gt_u32 vcc, 8, v17
    s_mov_b32 s58, s35
    s_cbranch_vccnz gated_mix__ssm_conv_h3__compressed_kv_cla__prompt_kernel_b2_sw_spin
gated_mix__ssm_conv_h3__compressed_kv_cla__prompt_kernel_b2_sw_spin_ret:
    v_mov_b32 v13, 0
    v_mov_b32 v14, 1
    buffer_store_dword v14, v13, s[28:31], s55 offen sc1
    s_lshl_b32 s36, s2, 2
    s_cmp_eq_u32 s32, 0
    s_cbranch_scc1 gated_mix__ssm_conv_h3__compressed_kv_cla__prompt_kernel_b2_sw_h
    s_add_u32 s12, s94, 50331648
    s_addc_u32 s13, s95, 0
    s_mov_b32 s14, 4718592
    s_mov_b32 s15, 0x00020000
    s_mul_i32 s38, s36, 4608
    s_movk_i32 s44, 4608
    s_mov_b32 s49, -2
    s_movk_i32 s50, 4640
    s_lshl_b32 s37, s32, 2
    s_sub_u32 s37, 10, s37
    s_add_u32 s38, s38, s37
    s_mul_i32 s59, s32, 9280
    s_add_u32 s59, s59, 4294966496
    s_cmp_eq_u32 s32, 3
    s_cbranch_scc0 gated_mix__ssm_conv_h3__compressed_kv_cla__prompt_kernel_b2_sw_go
    s_mov_b32 s14, 0
    s_mov_b32 s38, 2
    s_movk_i32 s59, 27648
    s_mov_b32 s50, 0
    s_branch gated_mix__ssm_conv_h3__compressed_kv_cla__prompt_kernel_b2_sw_go
gated_mix__ssm_conv_h3__compressed_kv_cla__prompt_kernel_b2_sw_h:
    s_mov_b32 s12, s72
    s_mov_b32 s13, s73
    s_mov_b32 s14, 4194304
    s_mov_b32 s15, 0x00020000
    s_lshl_b32 s38, s36, 12
    s_movk_i32 s44, 4096
    s_mov_b32 s49, 8
    s_movk_i32 s50, 4240
    s_movk_i32 s59, 128
gated_mix__ssm_conv_h3__compressed_kv_cla__prompt_kernel_b2_sw_go:
    s_mov_b32 s40, s59
    s_add_u32 s41, s59, s50
    s_branch gated_mix__ssm_conv_h3__compressed_kv_cla__prompt_kernel_b2_loop
gated_mix__ssm_conv_h3__compressed_kv_cla__prompt_kernel_b2_sw_spin:
    s_mov_b32 s54, 0
gated_mix__ssm_conv_h3__compressed_kv_cla__prompt_kernel_b2_sw_spin_again:
    s_sleep 2
    buffer_load_dword v17, v18, s[20:23], 0 offen sc1
    s_waitcnt vmcnt(0)
    v_cmp_gt_u32 vcc, 8, v17
    s_add_u32 s54, s54, 1
    s_cmp_gt_u32 s54, 0x40000
    s_cbranch_scc1 gated_mix__ssm_conv_h3__compressed_kv_cla__prompt_kernel_b2_sw_spin_ret
    s_cbranch_vccnz gated_mix__ssm_conv_h3__compressed_kv_cla__prompt_kernel_b2_sw_spin_again
    s_branch gated_mix__ssm_conv_h3__compressed_kv_cla__prompt_kernel_b2_sw_spin_ret
gated_mix__ssm_conv_h3__compressed_kv_cla__prompt_kernel_b4_m0:
    s_nop 7
    v_add_f32 v144, v48, v144
    v_add_f32 v145, v49, v145
    v_add_f32 v146, v50, v146
    v_add_f32 v147, v51, v147
    v_add_f32 v148, v52, v148
    v_add_f32 v149, v53, v149
    v_add_f32 v150, v54, v150
    v_add_f32 v151, v55, v151
    s_branch gated_mix__ssm_conv_h3__compressed_kv_cla__prompt_kernel_b4_m0_ret
gated_mix__ssm_conv_h3__compressed_kv_cla__prompt_kernel_b4_m1:
    s_nop 7
    v_add_f32 v176, v56, v176
    v_add_f32 v177, v57, v177
    v_add_f32 v178, v58, v178
    v_add_f32 v179, v59, v179
    v_add_f32 v180, v60, v180
    v_add_f32 v181, v61, v181
    v_add_f32 v182, v62, v182
    v_add_f32 v183, v63, v183
    s_branch gated_mix__ssm_conv_h3__compressed_kv_cla__prompt_kernel_b4_m1_ret
gated_mix__ssm_conv_h3__compressed_kv_cla__prompt_kernel_b2_m0:
    s_nop 7
    v_add_f32 v160, v48, v160
    v_add_f32 v161, v49, v161
    v_add_f32 v162, v50, v162
    v_add_f32 v163, v51, v163
    v_add_f32 v164, v52, v164
    v_add_f32 v165, v53, v165
    v_add_f32 v166, v54, v166
    v_add_f32 v167, v55, v167
    s_branch gated_mix__ssm_conv_h3__compressed_kv_cla__prompt_kernel_b2_m0_ret
gated_mix__ssm_conv_h3__compressed_kv_cla__prompt_kernel_b2_m1:
    s_nop 7
    v_add_f32 v192, v56, v192
    v_add_f32 v193, v57, v193
    v_add_f32 v194, v58, v194
    v_add_f32 v195, v59, v195
    v_add_f32 v196, v60, v196
    v_add_f32 v197, v61, v197
    v_add_f32 v198, v62, v198
    v_add_f32 v199, v63, v199
    s_branch gated_mix__ssm_conv_h3__compressed_kv_cla__prompt_kernel_b2_m1_ret
gated_mix__ssm_conv_h3__compressed_kv_cla__prompt_kernel_b2_m2:
    s_nop 7
    v_add_f32 v168, v48, v168
    v_add_f32 v169, v49, v169
    v_add_f32 v170, v50, v170
    v_add_f32 v171, v51, v171
    v_add_f32 v172, v52, v172
    v_add_f32 v173, v53, v173
    v_add_f32 v174, v54, v174
    v_add_f32 v175, v55, v175
    s_branch gated_mix__ssm_conv_h3__compressed_kv_cla__prompt_kernel_b2_m2_ret
gated_mix__ssm_conv_h3__compressed_kv_cla__prompt_kernel_spin_s:
    s_mov_b32 s54, 0
gated_mix__ssm_conv_h3__compressed_kv_cla__prompt_kernel_spin_s_again:
    s_sleep 2
    buffer_load_dword v213, v212, s[28:31], s52 offen offset:0 sc1
    s_waitcnt vmcnt(0)
    v_cmp_ne_u32 vcc, 1, v213
    s_add_u32 s54, s54, 1
    s_cmp_gt_u32 s54, 0x40000
    s_cbranch_scc1 gated_mix__ssm_conv_h3__compressed_kv_cla__prompt_kernel_spin_s_ret
    s_cbranch_vccnz gated_mix__ssm_conv_h3__compressed_kv_cla__prompt_kernel_spin_s_again
    s_branch gated_mix__ssm_conv_h3__compressed_kv_cla__prompt_kernel_spin_s_ret
gated_mix__ssm_conv_h3__compressed_kv_cla__prompt_kernel_spin_l:
    s_mov_b32 s54, 0
gated_mix__ssm_conv_h3__compressed_kv_cla__prompt_kernel_spin_l_again:
    s_sleep 2
    buffer_load_dword v213, v212, s[28:31], s52 offen offset:0 sc1
    s_waitcnt vmcnt(0)
    v_cmp_ne_u32 vcc, 1, v213
    s_add_u32 s54, s54, 1
    s_cmp_gt_u32 s54, 0x40000
    s_cbranch_scc1 gated_mix__ssm_conv_h3__compressed_kv_cla__prompt_kernel_spin_l_ret
    s_cbranch_vccnz gated_mix__ssm_conv_h3__compressed_kv_cla__prompt_kernel_spin_l_again
    s_branch gated_mix__ssm_conv_h3__compressed_kv_cla__prompt_kernel_spin_l_ret
gated_mix__ssm_conv_h3__compressed_kv_cla__prompt_kernel_hook:
    s_cmp_eq_u32 s35, 2
    s_cbranch_scc1 gated_mix__ssm_conv_h3__compressed_kv_cla__prompt_kernel_ypoll
    buffer_store_dword v9, v8, s[28:31], s57 offen sc1
    s_branch gated_mix__ssm_conv_h3__compressed_kv_cla__prompt_kernel_hook_ret
gated_mix__ssm_conv_h3__compressed_kv_cla__prompt_kernel_ypoll:
    s_xor_b32 s36, s57, 16
    v_add_u32 v212, s53, v212
    v_mov_b32 v214, s36
    v_cmp_gt_u32 vcc, 256, v16
    s_mov_b32 s53, 0
    s_nop 0
    v_cndmask_b32 v212, v214, v212, vcc
    buffer_load_dword v213, v212, s[28:31], s53 offen sc1
    s_branch gated_mix__ssm_conv_h3__compressed_kv_cla__prompt_kernel_hook_ret
gated_mix__ssm_conv_h3__compressed_kv_cla__prompt_kernel_spin_y:
    s_mov_b32 s54, 0
gated_mix__ssm_conv_h3__compressed_kv_cla__prompt_kernel_spin_y_again:
    s_sleep 2
    buffer_load_dword v213, v212, s[28:31], s53 offen sc1
    s_waitcnt vmcnt(0)
    v_cmp_ne_u32 vcc, 1, v213
    s_add_u32 s54, s54, 1
    s_cmp_gt_u32 s54, 0x40000
    s_cbranch_scc1 gated_mix__ssm_conv_h3__compressed_kv_cla__prompt_kernel_spin_y_ret
    s_cbranch_vccnz gated_mix__ssm_conv_h3__compressed_kv_cla__prompt_kernel_spin_y_again
    s_branch gated_mix__ssm_conv_h3__compressed_kv_cla__prompt_kernel_spin_y_ret
gated_mix__ssm_conv_h3__compressed_kv_cla__prompt_kernel_spin_x:
    s_mov_b32 s54, 0
gated_mix__ssm_conv_h3__compressed_kv_cla__prompt_kernel_spin_x_again:
    s_sleep 2
    buffer_load_dwordx4 v[128:131], v16, s[16:19], s46 offen offset:0 sc1
    buffer_load_dwordx4 v[132:135], v16, s[16:19], s46 offen offset:1024 sc1
    buffer_load_dwordx4 v[136:139], v16, s[16:19], s46 offen offset:2048 sc1
    buffer_load_dwordx4 v[140:143], v16, s[16:19], s46 offen offset:3072 sc1
    s_waitcnt vmcnt(0)
    v_max3_u32 v178, v128, v129, v130
    v_max3_u32 v178, v178, v131, v132
    v_max3_u32 v178, v178, v133, v134
    v_max3_u32 v178, v178, v135, v136
    v_max3_u32 v178, v178, v137, v138
    v_max3_u32 v178, v178, v139, v140
    v_max3_u32 v178, v178, v141, v142
    v_max_u32 v178, v178, v143
    v_cmp_eq_u32 vcc, -1, v178
    s_add_u32 s54, s54, 1
    s_cmp_gt_u32 s54, 0x40000
    s_cbranch_scc1 gated_mix__ssm_conv_h3__compressed_kv_cla__prompt_kernel_spin_x_ret
    s_cbranch_vccnz gated_mix__ssm_conv_h3__compressed_kv_cla__prompt_kernel_spin_x_again
    s_branch gated_mix__ssm_conv_h3__compressed_kv_cla__prompt_kernel_spin_x_ret
gated_mix__ssm_conv_h3__compressed_kv_cla__prompt_kernel_hotend:
gated_mix__ssm_conv_h3__compressed_kv_cla__prompt_kernel_b4_r0:
    s_nop 7
    v_max3_f32 v32, v144, v145, v146
    v_max3_f32 v32, v147, v148, v32
    v_max3_f32 v32, v149, v150, v32
    v_max_f32 v32, v151, v32
    v_mov_b32 v33, v32
    s_nop 1
    v_permlane16_swap_b32 v32, v33
    s_nop 1
    v_max_f32 v32, v32, v33
    v_mov_b32 v33, v32
    s_nop 1
    v_permlane32_swap_b32 v32, v33
    s_nop 1
    v_max_f32 v32, v32, v33
    v_add_f32 v32, 0x41c00000, v32
    v_max_f32 v32, 0, v32
    v_exp_f32 v34, -v32
    v_sub_f32 v64, v64, v32
    v_sub_f32 v65, v65, v32
    v_sub_f32 v66, v66, v32
    v_sub_f32 v67, v67, v32
    v_sub_f32 v144, v144, v32
    v_sub_f32 v145, v145, v32
    v_sub_f32 v146, v146, v32
    v_sub_f32 v147, v147, v32
    v_sub_f32 v148, v148, v32
    v_sub_f32 v149, v149, v32
    v_sub_f32 v150, v150, v32
    v_sub_f32 v151, v151, v32
    v_sub_f32 v176, v176, v32
    v_sub_f32 v177, v177, v32
    v_sub_f32 v178, v178, v32
    v_sub_f32 v179, v179, v32
    v_sub_f32 v180, v180, v32
    v_sub_f32 v181, v181, v32
    v_sub_f32 v182, v182, v32
    v_sub_f32 v183, v183, v32
    v_mul_f32 v240, v240, v34
    v_mul_f32 v241, v241, v34
    v_mul_f32 v242, v242, v34
    v_mul_f32 v243, v243, v34
    v_accvgpr_read_b32 v33, a0
    v_mul_f32 v33, v33, v34
    v_accvgpr_write_b32 a0, v33
    v_accvgpr_read_b32 v33, a1
    v_mul_f32 v33, v33, v34
    v_accvgpr_write_b32 a1, v33
    v_accvgpr_read_b32 v33, a2
    v_mul_f32 v33, v33, v34
    v_accvgpr_write_b32 a2, v33
    v_accvgpr_read_b32 v33, a3
    v_mul_f32 v33, v33, v34
    v_accvgpr_write_b32 a3, v33
    v_accvgpr_read_b32 v33, a4
    v_mul_f32 v33, v33, v34
    v_accvgpr_write_b32 a4, v33
    v_accvgpr_read_b32 v33, a5
    v_mul_f32 v33, v33, v34
    v_accvgpr_write_b32 a5, v33
    v_accvgpr_read_b32 v33, a6
    v_mul_f32 v33, v33, v34
    v_accvgpr_write_b32 a6, v33
    v_accvgpr_read_b32 v33, a7
    v_mul_f32 v33, v33, v34
    v_accvgpr_write_b32 a7, v33
    v_accvgpr_read_b32 v33, a8
    v_mul_f32 v33, v33, v34
    v_accvgpr_write_b32 a8, v33
    v_accvgpr_read_b32 v33, a9
    v_mul_f32 v33, v33, v34
    v_accvgpr_write_b32 a9, v33
    v_accvgpr_read_b32 v33, a10
    v_mul_f32 v33, v33, v34
    v_accvgpr_write_b32 a10, v33
    v_accvgpr_read_b32 v33, a11
    v_mul_f32 v33, v33, v34
    v_accvgpr_write_b32 a11, v33
    v_accvgpr_read_b32 v33, a12
    v_mul_f32 v33, v33, v34
    v_accvgpr_write_b32 a12, v33
    v_accvgpr_read_b32 v33, a13
    v_mul_f32 v33, v33, v34
    v_accvgpr_write_b32 a13, v33
    v_accvgpr_read_b32 v33, a14
    v_mul_f32 v33, v33, v34
    v_accvgpr_write_b32 a14, v33
    v_accvgpr_read_b32 v33, a15
    v_mul_f32 v33, v33, v34
    v_accvgpr_write_b32 a15, v33
    v_accvgpr_read_b32 v33, a16
    v_mul_f32 v33, v33, v34
    v_accvgpr_write_b32 a16, v33
    v_accvgpr_read_b32 v33, a17
    v_mul_f32 v33, v33, v34
    v_accvgpr_write_b32 a17, v33
    v_accvgpr_read_b32 v33, a18
    v_mul_f32 v33, v33, v34
    v_accvgpr_write_b32 a18, v33
    v_accvgpr_read_b32 v33, a19
    v_mul_f32 v33, v33, v34
    v_accvgpr_write_b32 a19, v33
    v_accvgpr_read_b32 v33, a20
    v_mul_f32 v33, v33, v34
    v_accvgpr_write_b32 a20, v33
    v_accvgpr_read_b32 v33, a21
    v_mul_f32 v33, v33, v34
    v_accvgpr_write_b32 a21, v33
    v_accvgpr_read_b32 v33, a22
    v_mul_f32 v33, v33, v34
    v_accvgpr_write_b32 a22, v33
    v_accvgpr_read_b32 v33, a23
    v_mul_f32 v33, v33, v34
    v_accvgpr_write_b32 a23, v33
    v_accvgpr_read_b32 v33, a24
    v_mul_f32 v33, v33, v34
    v_accvgpr_write_b32 a24, v33
    v_accvgpr_read_b32 v33, a25
    v_mul_f32 v33, v33, v34
    v_accvgpr_write_b32 a25, v33
    v_accvgpr_read_b32 v33, a26
    v_mul_f32 v33, v33, v34
    v_accvgpr_write_b32 a26, v33
    v_accvgpr_read_b32 v33, a27
    v_mul_f32 v33, v33, v34
    v_accvgpr_write_b32 a27, v33
    v_accvgpr_read_b32 v33, a28
    v_mul_f32 v33, v33, v34
    v_accvgpr_write_b32 a28, v33
    v_accvgpr_read_b32 v33, a29
    v_mul_f32 v33, v33, v34
    v_accvgpr_write_b32 a29, v33
    v_accvgpr_read_b32 v33, a30
    v_mul_f32 v33, v33, v34
    v_accvgpr_write_b32 a30, v33
    v_accvgpr_read_b32 v33, a31
    v_mul_f32 v33, v33, v34
    v_accvgpr_write_b32 a31, v33
    v_exp_f32 v36, v144
    v_exp_f32 v37, v145
    s_nop 0
    v_cvt_pk_bf16_f32 v208, v36, v37
    v_exp_f32 v36, v146
    v_exp_f32 v37, v147
    s_nop 0
    v_cvt_pk_bf16_f32 v209, v36, v37
    v_exp_f32 v36, v148
    v_exp_f32 v37, v149
    s_nop 0
    v_cvt_pk_bf16_f32 v210, v36, v37
    v_exp_f32 v36, v150
    v_exp_f32 v37, v151
    s_nop 0
    v_cvt_pk_bf16_f32 v211, v36, v37
    v_max3_f32 v32, v152, v153, v154
    v_max3_f32 v32, v155, v156, v32
    v_max3_f32 v32, v157, v158, v32
    v_max_f32 v32, v159, v32
    v_mov_b32 v33, v32
    s_nop 1
    v_permlane16_swap_b32 v32, v33
    s_nop 1
    v_max_f32 v32, v32, v33
    v_mov_b32 v33, v32
    s_nop 1
    v_permlane32_swap_b32 v32, v33
    s_nop 1
    v_max_f32 v32, v32, v33
    v_add_f32 v32, 0x41c00000, v32
    v_max_f32 v32, 0, v32
    v_exp_f32 v34, -v32
    v_sub_f32 v68, v68, v32
    v_sub_f32 v69, v69, v32
    v_sub_f32 v70, v70, v32
    v_sub_f32 v71, v71, v32
    v_sub_f32 v152, v152, v32
    v_sub_f32 v153, v153, v32
    v_sub_f32 v154, v154, v32
    v_sub_f32 v155, v155, v32
    v_sub_f32 v156, v156, v32
    v_sub_f32 v157, v157, v32
    v_sub_f32 v158, v158, v32
    v_sub_f32 v159, v159, v32
    v_sub_f32 v184, v184, v32
    v_sub_f32 v185, v185, v32
    v_sub_f32 v186, v186, v32
    v_sub_f32 v187, v187, v32
    v_sub_f32 v188, v188, v32
    v_sub_f32 v189, v189, v32
    v_sub_f32 v190, v190, v32
    v_sub_f32 v191, v191, v32
    v_mul_f32 v244, v244, v34
    v_mul_f32 v245, v245, v34
    v_mul_f32 v246, v246, v34
    v_mul_f32 v247, v247, v34
    v_accvgpr_read_b32 v33, a32
    v_mul_f32 v33, v33, v34
    v_accvgpr_write_b32 a32, v33
    v_accvgpr_read_b32 v33, a33
    v_mul_f32 v33, v33, v34
    v_accvgpr_write_b32 a33, v33
    v_accvgpr_read_b32 v33, a34
    v_mul_f32 v33, v33, v34
    v_accvgpr_write_b32 a34, v33
    v_accvgpr_read_b32 v33, a35
    v_mul_f32 v33, v33, v34
    v_accvgpr_write_b32 a35, v33
    v_accvgpr_read_b32 v33, a36
    v_mul_f32 v33, v33, v34
    v_accvgpr_write_b32 a36, v33
    v_accvgpr_read_b32 v33, a37
    v_mul_f32 v33, v33, v34
    v_accvgpr_write_b32 a37, v33
    v_accvgpr_read_b32 v33, a38
    v_mul_f32 v33, v33, v34
    v_accvgpr_write_b32 a38, v33
    v_accvgpr_read_b32 v33, a39
    v_mul_f32 v33, v33, v34
    v_accvgpr_write_b32 a39, v33
    v_accvgpr_read_b32 v33, a40
    v_mul_f32 v33, v33, v34
    v_accvgpr_write_b32 a40, v33
    v_accvgpr_read_b32 v33, a41
    v_mul_f32 v33, v33, v34
    v_accvgpr_write_b32 a41, v33
    v_accvgpr_read_b32 v33, a42
    v_mul_f32 v33, v33, v34
    v_accvgpr_write_b32 a42, v33
    v_accvgpr_read_b32 v33, a43
    v_mul_f32 v33, v33, v34
    v_accvgpr_write_b32 a43, v33
    v_accvgpr_read_b32 v33, a44
    v_mul_f32 v33, v33, v34
    v_accvgpr_write_b32 a44, v33
    v_accvgpr_read_b32 v33, a45
    v_mul_f32 v33, v33, v34
    v_accvgpr_write_b32 a45, v33
    v_accvgpr_read_b32 v33, a46
    v_mul_f32 v33, v33, v34
    v_accvgpr_write_b32 a46, v33
    v_accvgpr_read_b32 v33, a47
    v_mul_f32 v33, v33, v34
    v_accvgpr_write_b32 a47, v33
    v_accvgpr_read_b32 v33, a48
    v_mul_f32 v33, v33, v34
    v_accvgpr_write_b32 a48, v33
    v_accvgpr_read_b32 v33, a49
    v_mul_f32 v33, v33, v34
    v_accvgpr_write_b32 a49, v33
    v_accvgpr_read_b32 v33, a50
    v_mul_f32 v33, v33, v34
    v_accvgpr_write_b32 a50, v33
    v_accvgpr_read_b32 v33, a51
    v_mul_f32 v33, v33, v34
    v_accvgpr_write_b32 a51, v33
    v_accvgpr_read_b32 v33, a52
    v_mul_f32 v33, v33, v34
    v_accvgpr_write_b32 a52, v33
    v_accvgpr_read_b32 v33, a53
    v_mul_f32 v33, v33, v34
    v_accvgpr_write_b32 a53, v33
    v_accvgpr_read_b32 v33, a54
    v_mul_f32 v33, v33, v34
    v_accvgpr_write_b32 a54, v33
    v_accvgpr_read_b32 v33, a55
    v_mul_f32 v33, v33, v34
    v_accvgpr_write_b32 a55, v33
    v_accvgpr_read_b32 v33, a56
    v_mul_f32 v33, v33, v34
    v_accvgpr_write_b32 a56, v33
    v_accvgpr_read_b32 v33, a57
    v_mul_f32 v33, v33, v34
    v_accvgpr_write_b32 a57, v33
    v_accvgpr_read_b32 v33, a58
    v_mul_f32 v33, v33, v34
    v_accvgpr_write_b32 a58, v33
    v_accvgpr_read_b32 v33, a59
    v_mul_f32 v33, v33, v34
    v_accvgpr_write_b32 a59, v33
    v_accvgpr_read_b32 v33, a60
    v_mul_f32 v33, v33, v34
    v_accvgpr_write_b32 a60, v33
    v_accvgpr_read_b32 v33, a61
    v_mul_f32 v33, v33, v34
    v_accvgpr_write_b32 a61, v33
    v_accvgpr_read_b32 v33, a62
    v_mul_f32 v33, v33, v34
    v_accvgpr_write_b32 a62, v33
    v_accvgpr_read_b32 v33, a63
    v_mul_f32 v33, v33, v34
    v_accvgpr_write_b32 a63, v33
    v_exp_f32 v36, v152
    v_exp_f32 v37, v153
    s_nop 0
    v_cvt_pk_bf16_f32 v212, v36, v37
    v_exp_f32 v36, v154
    v_exp_f32 v37, v155
    s_nop 0
    v_cvt_pk_bf16_f32 v213, v36, v37
    v_exp_f32 v36, v156
    v_exp_f32 v37, v157
    s_nop 0
    v_cvt_pk_bf16_f32 v214, v36, v37
    v_exp_f32 v36, v158
    v_exp_f32 v37, v159
    s_nop 0
    v_cvt_pk_bf16_f32 v215, v36, v37
    v_max3_f32 v32, v160, v161, v162
    v_max3_f32 v32, v163, v164, v32
    v_max3_f32 v32, v165, v166, v32
    v_max_f32 v32, v167, v32
    v_mov_b32 v33, v32
    s_nop 1
    v_permlane16_swap_b32 v32, v33
    s_nop 1
    v_max_f32 v32, v32, v33
    v_mov_b32 v33, v32
    s_nop 1
    v_permlane32_swap_b32 v32, v33
    s_nop 1
    v_max_f32 v32, v32, v33
    v_add_f32 v32, 0x41c00000, v32
    v_max_f32 v32, 0, v32
    v_exp_f32 v34, -v32
    v_sub_f32 v72, v72, v32
    v_sub_f32 v73, v73, v32
    v_sub_f32 v74, v74, v32
    v_sub_f32 v75, v75, v32
    v_sub_f32 v160, v160, v32
    v_sub_f32 v161, v161, v32
    v_sub_f32 v162, v162, v32
    v_sub_f32 v163, v163, v32
    v_sub_f32 v164, v164, v32
    v_sub_f32 v165, v165, v32
    v_sub_f32 v166, v166, v32
    v_sub_f32 v167, v167, v32
    v_sub_f32 v192, v192, v32
    v_sub_f32 v193, v193, v32
    v_sub_f32 v194, v194, v32
    v_sub_f32 v195, v195, v32
    v_sub_f32 v196, v196, v32
    v_sub_f32 v197, v197, v32
    v_sub_f32 v198, v198, v32
    v_sub_f32 v199, v199, v32
    v_mul_f32 v248, v248, v34
    v_mul_f32 v249, v249, v34
    v_mul_f32 v250, v250, v34
    v_mul_f32 v251, v251, v34
    v_accvgpr_read_b32 v33, a64
    v_mul_f32 v33, v33, v34
    v_accvgpr_write_b32 a64, v33
    v_accvgpr_read_b32 v33, a65
    v_mul_f32 v33, v33, v34
    v_accvgpr_write_b32 a65, v33
    v_accvgpr_read_b32 v33, a66
    v_mul_f32 v33, v33, v34
    v_accvgpr_write_b32 a66, v33
    v_accvgpr_read_b32 v33, a67
    v_mul_f32 v33, v33, v34
    v_accvgpr_write_b32 a67, v33
    v_accvgpr_read_b32 v33, a68
    v_mul_f32 v33, v33, v34
    v_accvgpr_write_b32 a68, v33
    v_accvgpr_read_b32 v33, a69
    v_mul_f32 v33, v33, v34
    v_accvgpr_write_b32 a69, v33
    v_accvgpr_read_b32 v33, a70
    v_mul_f32 v33, v33, v34
    v_accvgpr_write_b32 a70, v33
    v_accvgpr_read_b32 v33, a71
    v_mul_f32 v33, v33, v34
    v_accvgpr_write_b32 a71, v33
    v_accvgpr_read_b32 v33, a72
    v_mul_f32 v33, v33, v34
    v_accvgpr_write_b32 a72, v33
    v_accvgpr_read_b32 v33, a73
    v_mul_f32 v33, v33, v34
    v_accvgpr_write_b32 a73, v33
    v_accvgpr_read_b32 v33, a74
    v_mul_f32 v33, v33, v34
    v_accvgpr_write_b32 a74, v33
    v_accvgpr_read_b32 v33, a75
    v_mul_f32 v33, v33, v34
    v_accvgpr_write_b32 a75, v33
    v_accvgpr_read_b32 v33, a76
    v_mul_f32 v33, v33, v34
    v_accvgpr_write_b32 a76, v33
    v_accvgpr_read_b32 v33, a77
    v_mul_f32 v33, v33, v34
    v_accvgpr_write_b32 a77, v33
    v_accvgpr_read_b32 v33, a78
    v_mul_f32 v33, v33, v34
    v_accvgpr_write_b32 a78, v33
    v_accvgpr_read_b32 v33, a79
    v_mul_f32 v33, v33, v34
    v_accvgpr_write_b32 a79, v33
    v_accvgpr_read_b32 v33, a80
    v_mul_f32 v33, v33, v34
    v_accvgpr_write_b32 a80, v33
    v_accvgpr_read_b32 v33, a81
    v_mul_f32 v33, v33, v34
    v_accvgpr_write_b32 a81, v33
    v_accvgpr_read_b32 v33, a82
    v_mul_f32 v33, v33, v34
    v_accvgpr_write_b32 a82, v33
    v_accvgpr_read_b32 v33, a83
    v_mul_f32 v33, v33, v34
    v_accvgpr_write_b32 a83, v33
    v_accvgpr_read_b32 v33, a84
    v_mul_f32 v33, v33, v34
    v_accvgpr_write_b32 a84, v33
    v_accvgpr_read_b32 v33, a85
    v_mul_f32 v33, v33, v34
    v_accvgpr_write_b32 a85, v33
    v_accvgpr_read_b32 v33, a86
    v_mul_f32 v33, v33, v34
    v_accvgpr_write_b32 a86, v33
    v_accvgpr_read_b32 v33, a87
    v_mul_f32 v33, v33, v34
    v_accvgpr_write_b32 a87, v33
    v_accvgpr_read_b32 v33, a88
    v_mul_f32 v33, v33, v34
    v_accvgpr_write_b32 a88, v33
    v_accvgpr_read_b32 v33, a89
    v_mul_f32 v33, v33, v34
    v_accvgpr_write_b32 a89, v33
    v_accvgpr_read_b32 v33, a90
    v_mul_f32 v33, v33, v34
    v_accvgpr_write_b32 a90, v33
    v_accvgpr_read_b32 v33, a91
    v_mul_f32 v33, v33, v34
    v_accvgpr_write_b32 a91, v33
    v_accvgpr_read_b32 v33, a92
    v_mul_f32 v33, v33, v34
    v_accvgpr_write_b32 a92, v33
    v_accvgpr_read_b32 v33, a93
    v_mul_f32 v33, v33, v34
    v_accvgpr_write_b32 a93, v33
    v_accvgpr_read_b32 v33, a94
    v_mul_f32 v33, v33, v34
    v_accvgpr_write_b32 a94, v33
    v_accvgpr_read_b32 v33, a95
    v_mul_f32 v33, v33, v34
    v_accvgpr_write_b32 a95, v33
    v_exp_f32 v36, v160
    v_exp_f32 v37, v161
    s_nop 0
    v_cvt_pk_bf16_f32 v216, v36, v37
    v_exp_f32 v36, v162
    v_exp_f32 v37, v163
    s_nop 0
    v_cvt_pk_bf16_f32 v217, v36, v37
    v_exp_f32 v36, v164
    v_exp_f32 v37, v165
    s_nop 0
    v_cvt_pk_bf16_f32 v218, v36, v37
    v_exp_f32 v36, v166
    v_exp_f32 v37, v167
    s_nop 0
    v_cvt_pk_bf16_f32 v219, v36, v37
    v_max3_f32 v32, v168, v169, v170
    v_max3_f32 v32, v171, v172, v32
    v_max3_f32 v32, v173, v174, v32
    v_max_f32 v32, v175, v32
    v_mov_b32 v33, v32
    s_nop 1
    v_permlane16_swap_b32 v32, v33
    s_nop 1
    v_max_f32 v32, v32, v33
    v_mov_b32 v33, v32
    s_nop 1
    v_permlane32_swap_b32 v32, v33
    s_nop 1
    v_max_f32 v32, v32, v33
    v_add_f32 v32, 0x41c00000, v32
    v_max_f32 v32, 0, v32
    v_exp_f32 v34, -v32
    v_sub_f32 v76, v76, v32
    v_sub_f32 v77, v77, v32
    v_sub_f32 v78, v78, v32
    v_sub_f32 v79, v79, v32
    v_sub_f32 v168, v168, v32
    v_sub_f32 v169, v169, v32
    v_sub_f32 v170, v170, v32
    v_sub_f32 v171, v171, v32
    v_sub_f32 v172, v172, v32
    v_sub_f32 v173, v173, v32
    v_sub_f32 v174, v174, v32
    v_sub_f32 v175, v175, v32
    v_sub_f32 v200, v200, v32
    v_sub_f32 v201, v201, v32
    v_sub_f32 v202, v202, v32
    v_sub_f32 v203, v203, v32
    v_sub_f32 v204, v204, v32
    v_sub_f32 v205, v205, v32
    v_sub_f32 v206, v206, v32
    v_sub_f32 v207, v207, v32
    v_mul_f32 v252, v252, v34
    v_mul_f32 v253, v253, v34
    v_mul_f32 v254, v254, v34
    v_mul_f32 v255, v255, v34
    v_accvgpr_read_b32 v33, a96
    v_mul_f32 v33, v33, v34
    v_accvgpr_write_b32 a96, v33
    v_accvgpr_read_b32 v33, a97
    v_mul_f32 v33, v33, v34
    v_accvgpr_write_b32 a97, v33
    v_accvgpr_read_b32 v33, a98
    v_mul_f32 v33, v33, v34
    v_accvgpr_write_b32 a98, v33
    v_accvgpr_read_b32 v33, a99
    v_mul_f32 v33, v33, v34
    v_accvgpr_write_b32 a99, v33
    v_accvgpr_read_b32 v33, a100
    v_mul_f32 v33, v33, v34
    v_accvgpr_write_b32 a100, v33
    v_accvgpr_read_b32 v33, a101
    v_mul_f32 v33, v33, v34
    v_accvgpr_write_b32 a101, v33
    v_accvgpr_read_b32 v33, a102
    v_mul_f32 v33, v33, v34
    v_accvgpr_write_b32 a102, v33
    v_accvgpr_read_b32 v33, a103
    v_mul_f32 v33, v33, v34
    v_accvgpr_write_b32 a103, v33
    v_accvgpr_read_b32 v33, a104
    v_mul_f32 v33, v33, v34
    v_accvgpr_write_b32 a104, v33
    v_accvgpr_read_b32 v33, a105
    v_mul_f32 v33, v33, v34
    v_accvgpr_write_b32 a105, v33
    v_accvgpr_read_b32 v33, a106
    v_mul_f32 v33, v33, v34
    v_accvgpr_write_b32 a106, v33
    v_accvgpr_read_b32 v33, a107
    v_mul_f32 v33, v33, v34
    v_accvgpr_write_b32 a107, v33
    v_accvgpr_read_b32 v33, a108
    v_mul_f32 v33, v33, v34
    v_accvgpr_write_b32 a108, v33
    v_accvgpr_read_b32 v33, a109
    v_mul_f32 v33, v33, v34
    v_accvgpr_write_b32 a109, v33
    v_accvgpr_read_b32 v33, a110
    v_mul_f32 v33, v33, v34
    v_accvgpr_write_b32 a110, v33
    v_accvgpr_read_b32 v33, a111
    v_mul_f32 v33, v33, v34
    v_accvgpr_write_b32 a111, v33
    v_accvgpr_read_b32 v33, a112
    v_mul_f32 v33, v33, v34
    v_accvgpr_write_b32 a112, v33
    v_accvgpr_read_b32 v33, a113
    v_mul_f32 v33, v33, v34
    v_accvgpr_write_b32 a113, v33
    v_accvgpr_read_b32 v33, a114
    v_mul_f32 v33, v33, v34
    v_accvgpr_write_b32 a114, v33
    v_accvgpr_read_b32 v33, a115
    v_mul_f32 v33, v33, v34
    v_accvgpr_write_b32 a115, v33
    v_accvgpr_read_b32 v33, a116
    v_mul_f32 v33, v33, v34
    v_accvgpr_write_b32 a116, v33
    v_accvgpr_read_b32 v33, a117
    v_mul_f32 v33, v33, v34
    v_accvgpr_write_b32 a117, v33
    v_accvgpr_read_b32 v33, a118
    v_mul_f32 v33, v33, v34
    v_accvgpr_write_b32 a118, v33
    v_accvgpr_read_b32 v33, a119
    v_mul_f32 v33, v33, v34
    v_accvgpr_write_b32 a119, v33
    v_accvgpr_read_b32 v33, a120
    v_mul_f32 v33, v33, v34
    v_accvgpr_write_b32 a120, v33
    v_accvgpr_read_b32 v33, a121
    v_mul_f32 v33, v33, v34
    v_accvgpr_write_b32 a121, v33
    v_accvgpr_read_b32 v33, a122
    v_mul_f32 v33, v33, v34
    v_accvgpr_write_b32 a122, v33
    v_accvgpr_read_b32 v33, a123
    v_mul_f32 v33, v33, v34
    v_accvgpr_write_b32 a123, v33
    v_accvgpr_read_b32 v33, a124
    v_mul_f32 v33, v33, v34
    v_accvgpr_write_b32 a124, v33
    v_accvgpr_read_b32 v33, a125
    v_mul_f32 v33, v33, v34
    v_accvgpr_write_b32 a125, v33
    v_accvgpr_read_b32 v33, a126
    v_mul_f32 v33, v33, v34
    v_accvgpr_write_b32 a126, v33
    v_accvgpr_read_b32 v33, a127
    v_mul_f32 v33, v33, v34
    v_accvgpr_write_b32 a127, v33
    v_exp_f32 v36, v168
    v_exp_f32 v37, v169
    s_nop 0
    v_cvt_pk_bf16_f32 v220, v36, v37
    v_exp_f32 v36, v170
    v_exp_f32 v37, v171
    s_nop 0
    v_cvt_pk_bf16_f32 v221, v36, v37
    v_exp_f32 v36, v172
    v_exp_f32 v37, v173
    s_nop 0
    v_cvt_pk_bf16_f32 v222, v36, v37
    v_exp_f32 v36, v174
    v_exp_f32 v37, v175
    s_nop 0
    v_cvt_pk_bf16_f32 v223, v36, v37
    s_nop 1
    s_branch gated_mix__ssm_conv_h3__compressed_kv_cla__prompt_kernel_b4_r0_ret
gated_mix__ssm_conv_h3__compressed_kv_cla__prompt_kernel_b4_r1:
    s_nop 7
    v_max3_f32 v32, v176, v177, v178
    v_max3_f32 v32, v179, v180, v32
    v_max3_f32 v32, v181, v182, v32
    v_max_f32 v32, v183, v32
    v_mov_b32 v33, v32
    s_nop 1
    v_permlane16_swap_b32 v32, v33
    s_nop 1
    v_max_f32 v32, v32, v33
    v_mov_b32 v33, v32
    s_nop 1
    v_permlane32_swap_b32 v32, v33
    s_nop 1
    v_max_f32 v32, v32, v33
    v_add_f32 v32, 0x41c00000, v32
    v_max_f32 v32, 0, v32
    v_exp_f32 v34, -v32
    v_sub_f32 v64, v64, v32
    v_sub_f32 v65, v65, v32
    v_sub_f32 v66, v66, v32
    v_sub_f32 v67, v67, v32
    v_sub_f32 v176, v176, v32
    v_sub_f32 v177, v177, v32
    v_sub_f32 v178, v178, v32
    v_sub_f32 v179, v179, v32
    v_sub_f32 v180, v180, v32
    v_sub_f32 v181, v181, v32
    v_sub_f32 v182, v182, v32
    v_sub_f32 v183, v183, v32
    v_sub_f32 v144, v144, v32
    v_sub_f32 v145, v145, v32
    v_sub_f32 v146, v146, v32
    v_sub_f32 v147, v147, v32
    v_sub_f32 v148, v148, v32
    v_sub_f32 v149, v149, v32
    v_sub_f32 v150, v150, v32
    v_sub_f32 v151, v151, v32
    v_mul_f32 v240, v240, v34
    v_mul_f32 v241, v241, v34
    v_mul_f32 v242, v242, v34
    v_mul_f32 v243, v243, v34
    v_accvgpr_read_b32 v33, a0
    v_mul_f32 v33, v33, v34
    v_accvgpr_write_b32 a0, v33
    v_accvgpr_read_b32 v33, a1
    v_mul_f32 v33, v33, v34
    v_accvgpr_write_b32 a1, v33
    v_accvgpr_read_b32 v33, a2
    v_mul_f32 v33, v33, v34
    v_accvgpr_write_b32 a2, v33
    v_accvgpr_read_b32 v33, a3
    v_mul_f32 v33, v33, v34
    v_accvgpr_write_b32 a3, v33
    v_accvgpr_read_b32 v33, a4
    v_mul_f32 v33, v33, v34
    v_accvgpr_write_b32 a4, v33
    v_accvgpr_read_b32 v33, a5
    v_mul_f32 v33, v33, v34
    v_accvgpr_write_b32 a5, v33
    v_accvgpr_read_b32 v33, a6
    v_mul_f32 v33, v33, v34
    v_accvgpr_write_b32 a6, v33
    v_accvgpr_read_b32 v33, a7
    v_mul_f32 v33, v33, v34
    v_accvgpr_write_b32 a7, v33
    v_accvgpr_read_b32 v33, a8
    v_mul_f32 v33, v33, v34
    v_accvgpr_write_b32 a8, v33
    v_accvgpr_read_b32 v33, a9
    v_mul_f32 v33, v33, v34
    v_accvgpr_write_b32 a9, v33
    v_accvgpr_read_b32 v33, a10
    v_mul_f32 v33, v33, v34
    v_accvgpr_write_b32 a10, v33
    v_accvgpr_read_b32 v33, a11
    v_mul_f32 v33, v33, v34
    v_accvgpr_write_b32 a11, v33
    v_accvgpr_read_b32 v33, a12
    v_mul_f32 v33, v33, v34
    v_accvgpr_write_b32 a12, v33
    v_accvgpr_read_b32 v33, a13
    v_mul_f32 v33, v33, v34
    v_accvgpr_write_b32 a13, v33
    v_accvgpr_read_b32 v33, a14
    v_mul_f32 v33, v33, v34
    v_accvgpr_write_b32 a14, v33
    v_accvgpr_read_b32 v33, a15
    v_mul_f32 v33, v33, v34
    v_accvgpr_write_b32 a15, v33
    v_accvgpr_read_b32 v33, a16
    v_mul_f32 v33, v33, v34
    v_accvgpr_write_b32 a16, v33
    v_accvgpr_read_b32 v33, a17
    v_mul_f32 v33, v33, v34
    v_accvgpr_write_b32 a17, v33
    v_accvgpr_read_b32 v33, a18
    v_mul_f32 v33, v33, v34
    v_accvgpr_write_b32 a18, v33
    v_accvgpr_read_b32 v33, a19
    v_mul_f32 v33, v33, v34
    v_accvgpr_write_b32 a19, v33
    v_accvgpr_read_b32 v33, a20
    v_mul_f32 v33, v33, v34
    v_accvgpr_write_b32 a20, v33
    v_accvgpr_read_b32 v33, a21
    v_mul_f32 v33, v33, v34
    v_accvgpr_write_b32 a21, v33
    v_accvgpr_read_b32 v33, a22
    v_mul_f32 v33, v33, v34
    v_accvgpr_write_b32 a22, v33
    v_accvgpr_read_b32 v33, a23
    v_mul_f32 v33, v33, v34
    v_accvgpr_write_b32 a23, v33
    v_accvgpr_read_b32 v33, a24
    v_mul_f32 v33, v33, v34
    v_accvgpr_write_b32 a24, v33
    v_accvgpr_read_b32 v33, a25
    v_mul_f32 v33, v33, v34
    v_accvgpr_write_b32 a25, v33
    v_accvgpr_read_b32 v33, a26
    v_mul_f32 v33, v33, v34
    v_accvgpr_write_b32 a26, v33
    v_accvgpr_read_b32 v33, a27
    v_mul_f32 v33, v33, v34
    v_accvgpr_write_b32 a27, v33
    v_accvgpr_read_b32 v33, a28
    v_mul_f32 v33, v33, v34
    v_accvgpr_write_b32 a28, v33
    v_accvgpr_read_b32 v33, a29
    v_mul_f32 v33, v33, v34
    v_accvgpr_write_b32 a29, v33
    v_accvgpr_read_b32 v33, a30
    v_mul_f32 v33, v33, v34
    v_accvgpr_write_b32 a30, v33
    v_accvgpr_read_b32 v33, a31
    v_mul_f32 v33, v33, v34
    v_accvgpr_write_b32 a31, v33
    v_exp_f32 v36, v176
    v_exp_f32 v37, v177
    s_nop 0
    v_cvt_pk_bf16_f32 v224, v36, v37
    v_exp_f32 v36, v178
    v_exp_f32 v37, v179
    s_nop 0
    v_cvt_pk_bf16_f32 v225, v36, v37
    v_exp_f32 v36, v180
    v_exp_f32 v37, v181
    s_nop 0
    v_cvt_pk_bf16_f32 v226, v36, v37
    v_exp_f32 v36, v182
    v_exp_f32 v37, v183
    s_nop 0
    v_cvt_pk_bf16_f32 v227, v36, v37
    v_max3_f32 v32, v184, v185, v186
    v_max3_f32 v32, v187, v188, v32
    v_max3_f32 v32, v189, v190, v32
    v_max_f32 v32, v191, v32
    v_mov_b32 v33, v32
    s_nop 1
    v_permlane16_swap_b32 v32, v33
    s_nop 1
    v_max_f32 v32, v32, v33
    v_mov_b32 v33, v32
    s_nop 1
    v_permlane32_swap_b32 v32, v33
    s_nop 1
    v_max_f32 v32, v32, v33
    v_add_f32 v32, 0x41c00000, v32
    v_max_f32 v32, 0, v32
    v_exp_f32 v34, -v32
    v_sub_f32 v68, v68, v32
    v_sub_f32 v69, v69, v32
    v_sub_f32 v70, v70, v32
    v_sub_f32 v71, v71, v32
    v_sub_f32 v184, v184, v32
    v_sub_f32 v185, v185, v32
    v_sub_f32 v186, v186, v32
    v_sub_f32 v187, v187, v32
    v_sub_f32 v188, v188, v32
    v_sub_f32 v189, v189, v32
    v_sub_f32 v190, v190, v32
    v_sub_f32 v191, v191, v32
    v_sub_f32 v152, v152, v32
    v_sub_f32 v153, v153, v32
    v_sub_f32 v154, v154, v32
    v_sub_f32 v155, v155, v32
    v_sub_f32 v156, v156, v32
    v_sub_f32 v157, v157, v32
    v_sub_f32 v158, v158, v32
    v_sub_f32 v159, v159, v32
    v_mul_f32 v244, v244, v34
    v_mul_f32 v245, v245, v34
    v_mul_f32 v246, v246, v34
    v_mul_f32 v247, v247, v34
    v_accvgpr_read_b32 v33, a32
    v_mul_f32 v33, v33, v34
    v_accvgpr_write_b32 a32, v33
    v_accvgpr_read_b32 v33, a33
    v_mul_f32 v33, v33, v34
    v_accvgpr_write_b32 a33, v33
    v_accvgpr_read_b32 v33, a34
    v_mul_f32 v33, v33, v34
    v_accvgpr_write_b32 a34, v33
    v_accvgpr_read_b32 v33, a35
    v_mul_f32 v33, v33, v34
    v_accvgpr_write_b32 a35, v33
    v_accvgpr_read_b32 v33, a36
    v_mul_f32 v33, v33, v34
    v_accvgpr_write_b32 a36, v33
    v_accvgpr_read_b32 v33, a37
    v_mul_f32 v33, v33, v34
    v_accvgpr_write_b32 a37, v33
    v_accvgpr_read_b32 v33, a38
    v_mul_f32 v33, v33, v34
    v_accvgpr_write_b32 a38, v33
    v_accvgpr_read_b32 v33, a39
    v_mul_f32 v33, v33, v34
    v_accvgpr_write_b32 a39, v33
    v_accvgpr_read_b32 v33, a40
    v_mul_f32 v33, v33, v34
    v_accvgpr_write_b32 a40, v33
    v_accvgpr_read_b32 v33, a41
    v_mul_f32 v33, v33, v34
    v_accvgpr_write_b32 a41, v33
    v_accvgpr_read_b32 v33, a42
    v_mul_f32 v33, v33, v34
    v_accvgpr_write_b32 a42, v33
    v_accvgpr_read_b32 v33, a43
    v_mul_f32 v33, v33, v34
    v_accvgpr_write_b32 a43, v33
    v_accvgpr_read_b32 v33, a44
    v_mul_f32 v33, v33, v34
    v_accvgpr_write_b32 a44, v33
    v_accvgpr_read_b32 v33, a45
    v_mul_f32 v33, v33, v34
    v_accvgpr_write_b32 a45, v33
    v_accvgpr_read_b32 v33, a46
    v_mul_f32 v33, v33, v34
    v_accvgpr_write_b32 a46, v33
    v_accvgpr_read_b32 v33, a47
    v_mul_f32 v33, v33, v34
    v_accvgpr_write_b32 a47, v33
    v_accvgpr_read_b32 v33, a48
    v_mul_f32 v33, v33, v34
    v_accvgpr_write_b32 a48, v33
    v_accvgpr_read_b32 v33, a49
    v_mul_f32 v33, v33, v34
    v_accvgpr_write_b32 a49, v33
    v_accvgpr_read_b32 v33, a50
    v_mul_f32 v33, v33, v34
    v_accvgpr_write_b32 a50, v33
    v_accvgpr_read_b32 v33, a51
    v_mul_f32 v33, v33, v34
    v_accvgpr_write_b32 a51, v33
    v_accvgpr_read_b32 v33, a52
    v_mul_f32 v33, v33, v34
    v_accvgpr_write_b32 a52, v33
    v_accvgpr_read_b32 v33, a53
    v_mul_f32 v33, v33, v34
    v_accvgpr_write_b32 a53, v33
    v_accvgpr_read_b32 v33, a54
    v_mul_f32 v33, v33, v34
    v_accvgpr_write_b32 a54, v33
    v_accvgpr_read_b32 v33, a55
    v_mul_f32 v33, v33, v34
    v_accvgpr_write_b32 a55, v33
    v_accvgpr_read_b32 v33, a56
    v_mul_f32 v33, v33, v34
    v_accvgpr_write_b32 a56, v33
    v_accvgpr_read_b32 v33, a57
    v_mul_f32 v33, v33, v34
    v_accvgpr_write_b32 a57, v33
    v_accvgpr_read_b32 v33, a58
    v_mul_f32 v33, v33, v34
    v_accvgpr_write_b32 a58, v33
    v_accvgpr_read_b32 v33, a59
    v_mul_f32 v33, v33, v34
    v_accvgpr_write_b32 a59, v33
    v_accvgpr_read_b32 v33, a60
    v_mul_f32 v33, v33, v34
    v_accvgpr_write_b32 a60, v33
    v_accvgpr_read_b32 v33, a61
    v_mul_f32 v33, v33, v34
    v_accvgpr_write_b32 a61, v33
    v_accvgpr_read_b32 v33, a62
    v_mul_f32 v33, v33, v34
    v_accvgpr_write_b32 a62, v33
    v_accvgpr_read_b32 v33, a63
    v_mul_f32 v33, v33, v34
    v_accvgpr_write_b32 a63, v33
    v_exp_f32 v36, v184
    v_exp_f32 v37, v185
    s_nop 0
    v_cvt_pk_bf16_f32 v228, v36, v37
    v_exp_f32 v36, v186
    v_exp_f32 v37, v187
    s_nop 0
    v_cvt_pk_bf16_f32 v229, v36, v37
    v_exp_f32 v36, v188
    v_exp_f32 v37, v189
    s_nop 0
    v_cvt_pk_bf16_f32 v230, v36, v37
    v_exp_f32 v36, v190
    v_exp_f32 v37, v191
    s_nop 0
    v_cvt_pk_bf16_f32 v231, v36, v37
    v_max3_f32 v32, v192, v193, v194
    v_max3_f32 v32, v195, v196, v32
    v_max3_f32 v32, v197, v198, v32
    v_max_f32 v32, v199, v32
    v_mov_b32 v33, v32
    s_nop 1
    v_permlane16_swap_b32 v32, v33
    s_nop 1
    v_max_f32 v32, v32, v33
    v_mov_b32 v33, v32
    s_nop 1
    v_permlane32_swap_b32 v32, v33
    s_nop 1
    v_max_f32 v32, v32, v33
    v_add_f32 v32, 0x41c00000, v32
    v_max_f32 v32, 0, v32
    v_exp_f32 v34, -v32
    v_sub_f32 v72, v72, v32
    v_sub_f32 v73, v73, v32
    v_sub_f32 v74, v74, v32
    v_sub_f32 v75, v75, v32
    v_sub_f32 v192, v192, v32
    v_sub_f32 v193, v193, v32
    v_sub_f32 v194, v194, v32
    v_sub_f32 v195, v195, v32
    v_sub_f32 v196, v196, v32
    v_sub_f32 v197, v197, v32
    v_sub_f32 v198, v198, v32
    v_sub_f32 v199, v199, v32
    v_sub_f32 v160, v160, v32
    v_sub_f32 v161, v161, v32
    v_sub_f32 v162, v162, v32
    v_sub_f32 v163, v163, v32
    v_sub_f32 v164, v164, v32
    v_sub_f32 v165, v165, v32
    v_sub_f32 v166, v166, v32
    v_sub_f32 v167, v167, v32
    v_mul_f32 v248, v248, v34
    v_mul_f32 v249, v249, v34
    v_mul_f32 v250, v250, v34
    v_mul_f32 v251, v251, v34
    v_accvgpr_read_b32 v33, a64
    v_mul_f32 v33, v33, v34
    v_accvgpr_write_b32 a64, v33
    v_accvgpr_read_b32 v33, a65
    v_mul_f32 v33, v33, v34
    v_accvgpr_write_b32 a65, v33
    v_accvgpr_read_b32 v33, a66
    v_mul_f32 v33, v33, v34
    v_accvgpr_write_b32 a66, v33
    v_accvgpr_read_b32 v33, a67
    v_mul_f32 v33, v33, v34
    v_accvgpr_write_b32 a67, v33
    v_accvgpr_read_b32 v33, a68
    v_mul_f32 v33, v33, v34
    v_accvgpr_write_b32 a68, v33
    v_accvgpr_read_b32 v33, a69
    v_mul_f32 v33, v33, v34
    v_accvgpr_write_b32 a69, v33
    v_accvgpr_read_b32 v33, a70
    v_mul_f32 v33, v33, v34
    v_accvgpr_write_b32 a70, v33
    v_accvgpr_read_b32 v33, a71
    v_mul_f32 v33, v33, v34
    v_accvgpr_write_b32 a71, v33
    v_accvgpr_read_b32 v33, a72
    v_mul_f32 v33, v33, v34
    v_accvgpr_write_b32 a72, v33
    v_accvgpr_read_b32 v33, a73
    v_mul_f32 v33, v33, v34
    v_accvgpr_write_b32 a73, v33
    v_accvgpr_read_b32 v33, a74
    v_mul_f32 v33, v33, v34
    v_accvgpr_write_b32 a74, v33
    v_accvgpr_read_b32 v33, a75
    v_mul_f32 v33, v33, v34
    v_accvgpr_write_b32 a75, v33
    v_accvgpr_read_b32 v33, a76
    v_mul_f32 v33, v33, v34
    v_accvgpr_write_b32 a76, v33
    v_accvgpr_read_b32 v33, a77
    v_mul_f32 v33, v33, v34
    v_accvgpr_write_b32 a77, v33
    v_accvgpr_read_b32 v33, a78
    v_mul_f32 v33, v33, v34
    v_accvgpr_write_b32 a78, v33
    v_accvgpr_read_b32 v33, a79
    v_mul_f32 v33, v33, v34
    v_accvgpr_write_b32 a79, v33
    v_accvgpr_read_b32 v33, a80
    v_mul_f32 v33, v33, v34
    v_accvgpr_write_b32 a80, v33
    v_accvgpr_read_b32 v33, a81
    v_mul_f32 v33, v33, v34
    v_accvgpr_write_b32 a81, v33
    v_accvgpr_read_b32 v33, a82
    v_mul_f32 v33, v33, v34
    v_accvgpr_write_b32 a82, v33
    v_accvgpr_read_b32 v33, a83
    v_mul_f32 v33, v33, v34
    v_accvgpr_write_b32 a83, v33
    v_accvgpr_read_b32 v33, a84
    v_mul_f32 v33, v33, v34
    v_accvgpr_write_b32 a84, v33
    v_accvgpr_read_b32 v33, a85
    v_mul_f32 v33, v33, v34
    v_accvgpr_write_b32 a85, v33
    v_accvgpr_read_b32 v33, a86
    v_mul_f32 v33, v33, v34
    v_accvgpr_write_b32 a86, v33
    v_accvgpr_read_b32 v33, a87
    v_mul_f32 v33, v33, v34
    v_accvgpr_write_b32 a87, v33
    v_accvgpr_read_b32 v33, a88
    v_mul_f32 v33, v33, v34
    v_accvgpr_write_b32 a88, v33
    v_accvgpr_read_b32 v33, a89
    v_mul_f32 v33, v33, v34
    v_accvgpr_write_b32 a89, v33
    v_accvgpr_read_b32 v33, a90
    v_mul_f32 v33, v33, v34
    v_accvgpr_write_b32 a90, v33
    v_accvgpr_read_b32 v33, a91
    v_mul_f32 v33, v33, v34
    v_accvgpr_write_b32 a91, v33
    v_accvgpr_read_b32 v33, a92
    v_mul_f32 v33, v33, v34
    v_accvgpr_write_b32 a92, v33
    v_accvgpr_read_b32 v33, a93
    v_mul_f32 v33, v33, v34
    v_accvgpr_write_b32 a93, v33
    v_accvgpr_read_b32 v33, a94
    v_mul_f32 v33, v33, v34
    v_accvgpr_write_b32 a94, v33
    v_accvgpr_read_b32 v33, a95
    v_mul_f32 v33, v33, v34
    v_accvgpr_write_b32 a95, v33
    v_exp_f32 v36, v192
    v_exp_f32 v37, v193
    s_nop 0
    v_cvt_pk_bf16_f32 v232, v36, v37
    v_exp_f32 v36, v194
    v_exp_f32 v37, v195
    s_nop 0
    v_cvt_pk_bf16_f32 v233, v36, v37
    v_exp_f32 v36, v196
    v_exp_f32 v37, v197
    s_nop 0
    v_cvt_pk_bf16_f32 v234, v36, v37
    v_exp_f32 v36, v198
    v_exp_f32 v37, v199
    s_nop 0
    v_cvt_pk_bf16_f32 v235, v36, v37
    v_max3_f32 v32, v200, v201, v202
    v_max3_f32 v32, v203, v204, v32
    v_max3_f32 v32, v205, v206, v32
    v_max_f32 v32, v207, v32
    v_mov_b32 v33, v32
    s_nop 1
    v_permlane16_swap_b32 v32, v33
    s_nop 1
    v_max_f32 v32, v32, v33
    v_mov_b32 v33, v32
    s_nop 1
    v_permlane32_swap_b32 v32, v33
    s_nop 1
    v_max_f32 v32, v32, v33
    v_add_f32 v32, 0x41c00000, v32
    v_max_f32 v32, 0, v32
    v_exp_f32 v34, -v32
    v_sub_f32 v76, v76, v32
    v_sub_f32 v77, v77, v32
    v_sub_f32 v78, v78, v32
    v_sub_f32 v79, v79, v32
    v_sub_f32 v200, v200, v32
    v_sub_f32 v201, v201, v32
    v_sub_f32 v202, v202, v32
    v_sub_f32 v203, v203, v32
    v_sub_f32 v204, v204, v32
    v_sub_f32 v205, v205, v32
    v_sub_f32 v206, v206, v32
    v_sub_f32 v207, v207, v32
    v_sub_f32 v168, v168, v32
    v_sub_f32 v169, v169, v32
    v_sub_f32 v170, v170, v32
    v_sub_f32 v171, v171, v32
    v_sub_f32 v172, v172, v32
    v_sub_f32 v173, v173, v32
    v_sub_f32 v174, v174, v32
    v_sub_f32 v175, v175, v32
    v_mul_f32 v252, v252, v34
    v_mul_f32 v253, v253, v34
    v_mul_f32 v254, v254, v34
    v_mul_f32 v255, v255, v34
    v_accvgpr_read_b32 v33, a96
    v_mul_f32 v33, v33, v34
    v_accvgpr_write_b32 a96, v33
    v_accvgpr_read_b32 v33, a97
    v_mul_f32 v33, v33, v34
    v_accvgpr_write_b32 a97, v33
    v_accvgpr_read_b32 v33, a98
    v_mul_f32 v33, v33, v34
    v_accvgpr_write_b32 a98, v33
    v_accvgpr_read_b32 v33, a99
    v_mul_f32 v33, v33, v34
    v_accvgpr_write_b32 a99, v33
    v_accvgpr_read_b32 v33, a100
    v_mul_f32 v33, v33, v34
    v_accvgpr_write_b32 a100, v33
    v_accvgpr_read_b32 v33, a101
    v_mul_f32 v33, v33, v34
    v_accvgpr_write_b32 a101, v33
    v_accvgpr_read_b32 v33, a102
    v_mul_f32 v33, v33, v34
    v_accvgpr_write_b32 a102, v33
    v_accvgpr_read_b32 v33, a103
    v_mul_f32 v33, v33, v34
    v_accvgpr_write_b32 a103, v33
    v_accvgpr_read_b32 v33, a104
    v_mul_f32 v33, v33, v34
    v_accvgpr_write_b32 a104, v33
    v_accvgpr_read_b32 v33, a105
    v_mul_f32 v33, v33, v34
    v_accvgpr_write_b32 a105, v33
    v_accvgpr_read_b32 v33, a106
    v_mul_f32 v33, v33, v34
    v_accvgpr_write_b32 a106, v33
    v_accvgpr_read_b32 v33, a107
    v_mul_f32 v33, v33, v34
    v_accvgpr_write_b32 a107, v33
    v_accvgpr_read_b32 v33, a108
    v_mul_f32 v33, v33, v34
    v_accvgpr_write_b32 a108, v33
    v_accvgpr_read_b32 v33, a109
    v_mul_f32 v33, v33, v34
    v_accvgpr_write_b32 a109, v33
    v_accvgpr_read_b32 v33, a110
    v_mul_f32 v33, v33, v34
    v_accvgpr_write_b32 a110, v33
    v_accvgpr_read_b32 v33, a111
    v_mul_f32 v33, v33, v34
    v_accvgpr_write_b32 a111, v33
    v_accvgpr_read_b32 v33, a112
    v_mul_f32 v33, v33, v34
    v_accvgpr_write_b32 a112, v33
    v_accvgpr_read_b32 v33, a113
    v_mul_f32 v33, v33, v34
    v_accvgpr_write_b32 a113, v33
    v_accvgpr_read_b32 v33, a114
    v_mul_f32 v33, v33, v34
    v_accvgpr_write_b32 a114, v33
    v_accvgpr_read_b32 v33, a115
    v_mul_f32 v33, v33, v34
    v_accvgpr_write_b32 a115, v33
    v_accvgpr_read_b32 v33, a116
    v_mul_f32 v33, v33, v34
    v_accvgpr_write_b32 a116, v33
    v_accvgpr_read_b32 v33, a117
    v_mul_f32 v33, v33, v34
    v_accvgpr_write_b32 a117, v33
    v_accvgpr_read_b32 v33, a118
    v_mul_f32 v33, v33, v34
    v_accvgpr_write_b32 a118, v33
    v_accvgpr_read_b32 v33, a119
    v_mul_f32 v33, v33, v34
    v_accvgpr_write_b32 a119, v33
    v_accvgpr_read_b32 v33, a120
    v_mul_f32 v33, v33, v34
    v_accvgpr_write_b32 a120, v33
    v_accvgpr_read_b32 v33, a121
    v_mul_f32 v33, v33, v34
    v_accvgpr_write_b32 a121, v33
    v_accvgpr_read_b32 v33, a122
    v_mul_f32 v33, v33, v34
    v_accvgpr_write_b32 a122, v33
    v_accvgpr_read_b32 v33, a123
    v_mul_f32 v33, v33, v34
    v_accvgpr_write_b32 a123, v33
    v_accvgpr_read_b32 v33, a124
    v_mul_f32 v33, v33, v34
    v_accvgpr_write_b32 a124, v33
    v_accvgpr_read_b32 v33, a125
    v_mul_f32 v33, v33, v34
    v_accvgpr_write_b32 a125, v33
    v_accvgpr_read_b32 v33, a126
    v_mul_f32 v33, v33, v34
    v_accvgpr_write_b32 a126, v33
    v_accvgpr_read_b32 v33, a127
    v_mul_f32 v33, v33, v34
    v_accvgpr_write_b32 a127, v33
    v_exp_f32 v36, v200
    v_exp_f32 v37, v201
    s_nop 0
    v_cvt_pk_bf16_f32 v236, v36, v37
    v_exp_f32 v36, v202
    v_exp_f32 v37, v203
    s_nop 0
    v_cvt_pk_bf16_f32 v237, v36, v37
    v_exp_f32 v36, v204
    v_exp_f32 v37, v205
    s_nop 0
    v_cvt_pk_bf16_f32 v238, v36, v37
    v_exp_f32 v36, v206
    v_exp_f32 v37, v207
    s_nop 0
    v_cvt_pk_bf16_f32 v239, v36, v37
    s_nop 1
    s_branch gated_mix__ssm_conv_h3__compressed_kv_cla__prompt_kernel_b4_r1_ret
gated_mix__ssm_conv_h3__compressed_kv_cla__prompt_kernel_b3_r0:
    s_nop 7
    v_max3_f32 v32, v152, v153, v154
    v_max3_f32 v32, v155, v156, v32
    v_max3_f32 v32, v157, v158, v32
    v_max_f32 v32, v159, v32
    v_mov_b32 v33, v32
    s_nop 1
    v_permlane16_swap_b32 v32, v33
    s_nop 1
    v_max_f32 v32, v32, v33
    v_mov_b32 v33, v32
    s_nop 1
    v_permlane32_swap_b32 v32, v33
    s_nop 1
    v_max_f32 v32, v32, v33
    v_add_f32 v32, 0x41c00000, v32
    v_max_f32 v32, 0, v32
    v_exp_f32 v34, -v32
    v_sub_f32 v68, v68, v32
    v_sub_f32 v69, v69, v32
    v_sub_f32 v70, v70, v32
    v_sub_f32 v71, v71, v32
    v_sub_f32 v152, v152, v32
    v_sub_f32 v153, v153, v32
    v_sub_f32 v154, v154, v32
    v_sub_f32 v155, v155, v32
    v_sub_f32 v156, v156, v32
    v_sub_f32 v157, v157, v32
    v_sub_f32 v158, v158, v32
    v_sub_f32 v159, v159, v32
    v_sub_f32 v184, v184, v32
    v_sub_f32 v185, v185, v32
    v_sub_f32 v186, v186, v32
    v_sub_f32 v187, v187, v32
    v_sub_f32 v188, v188, v32
    v_sub_f32 v189, v189, v32
    v_sub_f32 v190, v190, v32
    v_sub_f32 v191, v191, v32
    v_mul_f32 v244, v244, v34
    v_mul_f32 v245, v245, v34
    v_mul_f32 v246, v246, v34
    v_mul_f32 v247, v247, v34
    v_accvgpr_read_b32 v33, a32
    v_mul_f32 v33, v33, v34
    v_accvgpr_write_b32 a32, v33
    v_accvgpr_read_b32 v33, a33
    v_mul_f32 v33, v33, v34
    v_accvgpr_write_b32 a33, v33
    v_accvgpr_read_b32 v33, a34
    v_mul_f32 v33, v33, v34
    v_accvgpr_write_b32 a34, v33
    v_accvgpr_read_b32 v33, a35
    v_mul_f32 v33, v33, v34
    v_accvgpr_write_b32 a35, v33
    v_accvgpr_read_b32 v33, a36
    v_mul_f32 v33, v33, v34
    v_accvgpr_write_b32 a36, v33
    v_accvgpr_read_b32 v33, a37
    v_mul_f32 v33, v33, v34
    v_accvgpr_write_b32 a37, v33
    v_accvgpr_read_b32 v33, a38
    v_mul_f32 v33, v33, v34
    v_accvgpr_write_b32 a38, v33
    v_accvgpr_read_b32 v33, a39
    v_mul_f32 v33, v33, v34
    v_accvgpr_write_b32 a39, v33
    v_accvgpr_read_b32 v33, a40
    v_mul_f32 v33, v33, v34
    v_accvgpr_write_b32 a40, v33
    v_accvgpr_read_b32 v33, a41
    v_mul_f32 v33, v33, v34
    v_accvgpr_write_b32 a41, v33
    v_accvgpr_read_b32 v33, a42
    v_mul_f32 v33, v33, v34
    v_accvgpr_write_b32 a42, v33
    v_accvgpr_read_b32 v33, a43
    v_mul_f32 v33, v33, v34
    v_accvgpr_write_b32 a43, v33
    v_accvgpr_read_b32 v33, a44
    v_mul_f32 v33, v33, v34
    v_accvgpr_write_b32 a44, v33
    v_accvgpr_read_b32 v33, a45
    v_mul_f32 v33, v33, v34
    v_accvgpr_write_b32 a45, v33
    v_accvgpr_read_b32 v33, a46
    v_mul_f32 v33, v33, v34
    v_accvgpr_write_b32 a46, v33
    v_accvgpr_read_b32 v33, a47
    v_mul_f32 v33, v33, v34
    v_accvgpr_write_b32 a47, v33
    v_accvgpr_read_b32 v33, a48
    v_mul_f32 v33, v33, v34
    v_accvgpr_write_b32 a48, v33
    v_accvgpr_read_b32 v33, a49
    v_mul_f32 v33, v33, v34
    v_accvgpr_write_b32 a49, v33
    v_accvgpr_read_b32 v33, a50
    v_mul_f32 v33, v33, v34
    v_accvgpr_write_b32 a50, v33
    v_accvgpr_read_b32 v33, a51
    v_mul_f32 v33, v33, v34
    v_accvgpr_write_b32 a51, v33
    v_accvgpr_read_b32 v33, a52
    v_mul_f32 v33, v33, v34
    v_accvgpr_write_b32 a52, v33
    v_accvgpr_read_b32 v33, a53
    v_mul_f32 v33, v33, v34
    v_accvgpr_write_b32 a53, v33
    v_accvgpr_read_b32 v33, a54
    v_mul_f32 v33, v33, v34
    v_accvgpr_write_b32 a54, v33
    v_accvgpr_read_b32 v33, a55
    v_mul_f32 v33, v33, v34
    v_accvgpr_write_b32 a55, v33
    v_accvgpr_read_b32 v33, a56
    v_mul_f32 v33, v33, v34
    v_accvgpr_write_b32 a56, v33
    v_accvgpr_read_b32 v33, a57
    v_mul_f32 v33, v33, v34
    v_accvgpr_write_b32 a57, v33
    v_accvgpr_read_b32 v33, a58
    v_mul_f32 v33, v33, v34
    v_accvgpr_write_b32 a58, v33
    v_accvgpr_read_b32 v33, a59
    v_mul_f32 v33, v33, v34
    v_accvgpr_write_b32 a59, v33
    v_accvgpr_read_b32 v33, a60
    v_mul_f32 v33, v33, v34
    v_accvgpr_write_b32 a60, v33
    v_accvgpr_read_b32 v33, a61
    v_mul_f32 v33, v33, v34
    v_accvgpr_write_b32 a61, v33
    v_accvgpr_read_b32 v33, a62
    v_mul_f32 v33, v33, v34
    v_accvgpr_write_b32 a62, v33
    v_accvgpr_read_b32 v33, a63
    v_mul_f32 v33, v33, v34
    v_accvgpr_write_b32 a63, v33
    v_exp_f32 v36, v152
    v_exp_f32 v37, v153
    s_nop 0
    v_cvt_pk_bf16_f32 v212, v36, v37
    v_exp_f32 v36, v154
    v_exp_f32 v37, v155
    s_nop 0
    v_cvt_pk_bf16_f32 v213, v36, v37
    v_exp_f32 v36, v156
    v_exp_f32 v37, v157
    s_nop 0
    v_cvt_pk_bf16_f32 v214, v36, v37
    v_exp_f32 v36, v158
    v_exp_f32 v37, v159
    s_nop 0
    v_cvt_pk_bf16_f32 v215, v36, v37
    v_max3_f32 v32, v160, v161, v162
    v_max3_f32 v32, v163, v164, v32
    v_max3_f32 v32, v165, v166, v32
    v_max_f32 v32, v167, v32
    v_mov_b32 v33, v32
    s_nop 1
    v_permlane16_swap_b32 v32, v33
    s_nop 1
    v_max_f32 v32, v32, v33
    v_mov_b32 v33, v32
    s_nop 1
    v_permlane32_swap_b32 v32, v33
    s_nop 1
    v_max_f32 v32, v32, v33
    v_add_f32 v32, 0x41c00000, v32
    v_max_f32 v32, 0, v32
    v_exp_f32 v34, -v32
    v_sub_f32 v72, v72, v32
    v_sub_f32 v73, v73, v32
    v_sub_f32 v74, v74, v32
    v_sub_f32 v75, v75, v32
    v_sub_f32 v160, v160, v32
    v_sub_f32 v161, v161, v32
    v_sub_f32 v162, v162, v32
    v_sub_f32 v163, v163, v32
    v_sub_f32 v164, v164, v32
    v_sub_f32 v165, v165, v32
    v_sub_f32 v166, v166, v32
    v_sub_f32 v167, v167, v32
    v_sub_f32 v192, v192, v32
    v_sub_f32 v193, v193, v32
    v_sub_f32 v194, v194, v32
    v_sub_f32 v195, v195, v32
    v_sub_f32 v196, v196, v32
    v_sub_f32 v197, v197, v32
    v_sub_f32 v198, v198, v32
    v_sub_f32 v199, v199, v32
    v_mul_f32 v248, v248, v34
    v_mul_f32 v249, v249, v34
    v_mul_f32 v250, v250, v34
    v_mul_f32 v251, v251, v34
    v_accvgpr_read_b32 v33, a64
    v_mul_f32 v33, v33, v34
    v_accvgpr_write_b32 a64, v33
    v_accvgpr_read_b32 v33, a65
    v_mul_f32 v33, v33, v34
    v_accvgpr_write_b32 a65, v33
    v_accvgpr_read_b32 v33, a66
    v_mul_f32 v33, v33, v34
    v_accvgpr_write_b32 a66, v33
    v_accvgpr_read_b32 v33, a67
    v_mul_f32 v33, v33, v34
    v_accvgpr_write_b32 a67, v33
    v_accvgpr_read_b32 v33, a68
    v_mul_f32 v33, v33, v34
    v_accvgpr_write_b32 a68, v33
    v_accvgpr_read_b32 v33, a69
    v_mul_f32 v33, v33, v34
    v_accvgpr_write_b32 a69, v33
    v_accvgpr_read_b32 v33, a70
    v_mul_f32 v33, v33, v34
    v_accvgpr_write_b32 a70, v33
    v_accvgpr_read_b32 v33, a71
    v_mul_f32 v33, v33, v34
    v_accvgpr_write_b32 a71, v33
    v_accvgpr_read_b32 v33, a72
    v_mul_f32 v33, v33, v34
    v_accvgpr_write_b32 a72, v33
    v_accvgpr_read_b32 v33, a73
    v_mul_f32 v33, v33, v34
    v_accvgpr_write_b32 a73, v33
    v_accvgpr_read_b32 v33, a74
    v_mul_f32 v33, v33, v34
    v_accvgpr_write_b32 a74, v33
    v_accvgpr_read_b32 v33, a75
    v_mul_f32 v33, v33, v34
    v_accvgpr_write_b32 a75, v33
    v_accvgpr_read_b32 v33, a76
    v_mul_f32 v33, v33, v34
    v_accvgpr_write_b32 a76, v33
    v_accvgpr_read_b32 v33, a77
    v_mul_f32 v33, v33, v34
    v_accvgpr_write_b32 a77, v33
    v_accvgpr_read_b32 v33, a78
    v_mul_f32 v33, v33, v34
    v_accvgpr_write_b32 a78, v33
    v_accvgpr_read_b32 v33, a79
    v_mul_f32 v33, v33, v34
    v_accvgpr_write_b32 a79, v33
    v_accvgpr_read_b32 v33, a80
    v_mul_f32 v33, v33, v34
    v_accvgpr_write_b32 a80, v33
    v_accvgpr_read_b32 v33, a81
    v_mul_f32 v33, v33, v34
    v_accvgpr_write_b32 a81, v33
    v_accvgpr_read_b32 v33, a82
    v_mul_f32 v33, v33, v34
    v_accvgpr_write_b32 a82, v33
    v_accvgpr_read_b32 v33, a83
    v_mul_f32 v33, v33, v34
    v_accvgpr_write_b32 a83, v33
    v_accvgpr_read_b32 v33, a84
    v_mul_f32 v33, v33, v34
    v_accvgpr_write_b32 a84, v33
    v_accvgpr_read_b32 v33, a85
    v_mul_f32 v33, v33, v34
    v_accvgpr_write_b32 a85, v33
    v_accvgpr_read_b32 v33, a86
    v_mul_f32 v33, v33, v34
    v_accvgpr_write_b32 a86, v33
    v_accvgpr_read_b32 v33, a87
    v_mul_f32 v33, v33, v34
    v_accvgpr_write_b32 a87, v33
    v_accvgpr_read_b32 v33, a88
    v_mul_f32 v33, v33, v34
    v_accvgpr_write_b32 a88, v33
    v_accvgpr_read_b32 v33, a89
    v_mul_f32 v33, v33, v34
    v_accvgpr_write_b32 a89, v33
    v_accvgpr_read_b32 v33, a90
    v_mul_f32 v33, v33, v34
    v_accvgpr_write_b32 a90, v33
    v_accvgpr_read_b32 v33, a91
    v_mul_f32 v33, v33, v34
    v_accvgpr_write_b32 a91, v33
    v_accvgpr_read_b32 v33, a92
    v_mul_f32 v33, v33, v34
    v_accvgpr_write_b32 a92, v33
    v_accvgpr_read_b32 v33, a93
    v_mul_f32 v33, v33, v34
    v_accvgpr_write_b32 a93, v33
    v_accvgpr_read_b32 v33, a94
    v_mul_f32 v33, v33, v34
    v_accvgpr_write_b32 a94, v33
    v_accvgpr_read_b32 v33, a95
    v_mul_f32 v33, v33, v34
    v_accvgpr_write_b32 a95, v33
    v_exp_f32 v36, v160
    v_exp_f32 v37, v161
    s_nop 0
    v_cvt_pk_bf16_f32 v216, v36, v37
    v_exp_f32 v36, v162
    v_exp_f32 v37, v163
    s_nop 0
    v_cvt_pk_bf16_f32 v217, v36, v37
    v_exp_f32 v36, v164
    v_exp_f32 v37, v165
    s_nop 0
    v_cvt_pk_bf16_f32 v218, v36, v37
    v_exp_f32 v36, v166
    v_exp_f32 v37, v167
    s_nop 0
    v_cvt_pk_bf16_f32 v219, v36, v37
    v_max3_f32 v32, v168, v169, v170
    v_max3_f32 v32, v171, v172, v32
    v_max3_f32 v32, v173, v174, v32
    v_max_f32 v32, v175, v32
    v_mov_b32 v33, v32
    s_nop 1
    v_permlane16_swap_b32 v32, v33
    s_nop 1
    v_max_f32 v32, v32, v33
    v_mov_b32 v33, v32
    s_nop 1
    v_permlane32_swap_b32 v32, v33
    s_nop 1
    v_max_f32 v32, v32, v33
    v_add_f32 v32, 0x41c00000, v32
    v_max_f32 v32, 0, v32
    v_exp_f32 v34, -v32
    v_sub_f32 v76, v76, v32
    v_sub_f32 v77, v77, v32
    v_sub_f32 v78, v78, v32
    v_sub_f32 v79, v79, v32
    v_sub_f32 v168, v168, v32
    v_sub_f32 v169, v169, v32
    v_sub_f32 v170, v170, v32
    v_sub_f32 v171, v171, v32
    v_sub_f32 v172, v172, v32
    v_sub_f32 v173, v173, v32
    v_sub_f32 v174, v174, v32
    v_sub_f32 v175, v175, v32
    v_sub_f32 v200, v200, v32
    v_sub_f32 v201, v201, v32
    v_sub_f32 v202, v202, v32
    v_sub_f32 v203, v203, v32
    v_sub_f32 v204, v204, v32
    v_sub_f32 v205, v205, v32
    v_sub_f32 v206, v206, v32
    v_sub_f32 v207, v207, v32
    v_mul_f32 v252, v252, v34
    v_mul_f32 v253, v253, v34
    v_mul_f32 v254, v254, v34
    v_mul_f32 v255, v255, v34
    v_accvgpr_read_b32 v33, a96
    v_mul_f32 v33, v33, v34
    v_accvgpr_write_b32 a96, v33
    v_accvgpr_read_b32 v33, a97
    v_mul_f32 v33, v33, v34
    v_accvgpr_write_b32 a97, v33
    v_accvgpr_read_b32 v33, a98
    v_mul_f32 v33, v33, v34
    v_accvgpr_write_b32 a98, v33
    v_accvgpr_read_b32 v33, a99
    v_mul_f32 v33, v33, v34
    v_accvgpr_write_b32 a99, v33
    v_accvgpr_read_b32 v33, a100
    v_mul_f32 v33, v33, v34
    v_accvgpr_write_b32 a100, v33
    v_accvgpr_read_b32 v33, a101
    v_mul_f32 v33, v33, v34
    v_accvgpr_write_b32 a101, v33
    v_accvgpr_read_b32 v33, a102
    v_mul_f32 v33, v33, v34
    v_accvgpr_write_b32 a102, v33
    v_accvgpr_read_b32 v33, a103
    v_mul_f32 v33, v33, v34
    v_accvgpr_write_b32 a103, v33
    v_accvgpr_read_b32 v33, a104
    v_mul_f32 v33, v33, v34
    v_accvgpr_write_b32 a104, v33
    v_accvgpr_read_b32 v33, a105
    v_mul_f32 v33, v33, v34
    v_accvgpr_write_b32 a105, v33
    v_accvgpr_read_b32 v33, a106
    v_mul_f32 v33, v33, v34
    v_accvgpr_write_b32 a106, v33
    v_accvgpr_read_b32 v33, a107
    v_mul_f32 v33, v33, v34
    v_accvgpr_write_b32 a107, v33
    v_accvgpr_read_b32 v33, a108
    v_mul_f32 v33, v33, v34
    v_accvgpr_write_b32 a108, v33
    v_accvgpr_read_b32 v33, a109
    v_mul_f32 v33, v33, v34
    v_accvgpr_write_b32 a109, v33
    v_accvgpr_read_b32 v33, a110
    v_mul_f32 v33, v33, v34
    v_accvgpr_write_b32 a110, v33
    v_accvgpr_read_b32 v33, a111
    v_mul_f32 v33, v33, v34
    v_accvgpr_write_b32 a111, v33
    v_accvgpr_read_b32 v33, a112
    v_mul_f32 v33, v33, v34
    v_accvgpr_write_b32 a112, v33
    v_accvgpr_read_b32 v33, a113
    v_mul_f32 v33, v33, v34
    v_accvgpr_write_b32 a113, v33
    v_accvgpr_read_b32 v33, a114
    v_mul_f32 v33, v33, v34
    v_accvgpr_write_b32 a114, v33
    v_accvgpr_read_b32 v33, a115
    v_mul_f32 v33, v33, v34
    v_accvgpr_write_b32 a115, v33
    v_accvgpr_read_b32 v33, a116
    v_mul_f32 v33, v33, v34
    v_accvgpr_write_b32 a116, v33
    v_accvgpr_read_b32 v33, a117
    v_mul_f32 v33, v33, v34
    v_accvgpr_write_b32 a117, v33
    v_accvgpr_read_b32 v33, a118
    v_mul_f32 v33, v33, v34
    v_accvgpr_write_b32 a118, v33
    v_accvgpr_read_b32 v33, a119
    v_mul_f32 v33, v33, v34
    v_accvgpr_write_b32 a119, v33
    v_accvgpr_read_b32 v33, a120
    v_mul_f32 v33, v33, v34
    v_accvgpr_write_b32 a120, v33
    v_accvgpr_read_b32 v33, a121
    v_mul_f32 v33, v33, v34
    v_accvgpr_write_b32 a121, v33
    v_accvgpr_read_b32 v33, a122
    v_mul_f32 v33, v33, v34
    v_accvgpr_write_b32 a122, v33
    v_accvgpr_read_b32 v33, a123
    v_mul_f32 v33, v33, v34
    v_accvgpr_write_b32 a123, v33
    v_accvgpr_read_b32 v33, a124
    v_mul_f32 v33, v33, v34
    v_accvgpr_write_b32 a124, v33
    v_accvgpr_read_b32 v33, a125
    v_mul_f32 v33, v33, v34
    v_accvgpr_write_b32 a125, v33
    v_accvgpr_read_b32 v33, a126
    v_mul_f32 v33, v33, v34
    v_accvgpr_write_b32 a126, v33
    v_accvgpr_read_b32 v33, a127
    v_mul_f32 v33, v33, v34
    v_accvgpr_write_b32 a127, v33
    v_exp_f32 v36, v168
    v_exp_f32 v37, v169
    s_nop 0
    v_cvt_pk_bf16_f32 v220, v36, v37
    v_exp_f32 v36, v170
    v_exp_f32 v37, v171
    s_nop 0
    v_cvt_pk_bf16_f32 v221, v36, v37
    v_exp_f32 v36, v172
    v_exp_f32 v37, v173
    s_nop 0
    v_cvt_pk_bf16_f32 v222, v36, v37
    v_exp_f32 v36, v174
    v_exp_f32 v37, v175
    s_nop 0
    v_cvt_pk_bf16_f32 v223, v36, v37
    s_nop 1
    s_branch gated_mix__ssm_conv_h3__compressed_kv_cla__prompt_kernel_b3_r0_ret
gated_mix__ssm_conv_h3__compressed_kv_cla__prompt_kernel_b3_r1:
    s_nop 7
    v_max3_f32 v32, v184, v185, v186
    v_max3_f32 v32, v187, v188, v32
    v_max3_f32 v32, v189, v190, v32
    v_max_f32 v32, v191, v32
    v_mov_b32 v33, v32
    s_nop 1
    v_permlane16_swap_b32 v32, v33
    s_nop 1
    v_max_f32 v32, v32, v33
    v_mov_b32 v33, v32
    s_nop 1
    v_permlane32_swap_b32 v32, v33
    s_nop 1
    v_max_f32 v32, v32, v33
    v_add_f32 v32, 0x41c00000, v32
    v_max_f32 v32, 0, v32
    v_exp_f32 v34, -v32
    v_sub_f32 v68, v68, v32
    v_sub_f32 v69, v69, v32
    v_sub_f32 v70, v70, v32
    v_sub_f32 v71, v71, v32
    v_sub_f32 v184, v184, v32
    v_sub_f32 v185, v185, v32
    v_sub_f32 v186, v186, v32
    v_sub_f32 v187, v187, v32
    v_sub_f32 v188, v188, v32
    v_sub_f32 v189, v189, v32
    v_sub_f32 v190, v190, v32
    v_sub_f32 v191, v191, v32
    v_sub_f32 v152, v152, v32
    v_sub_f32 v153, v153, v32
    v_sub_f32 v154, v154, v32
    v_sub_f32 v155, v155, v32
    v_sub_f32 v156, v156, v32
    v_sub_f32 v157, v157, v32
    v_sub_f32 v158, v158, v32
    v_sub_f32 v159, v159, v32
    v_mul_f32 v244, v244, v34
    v_mul_f32 v245, v245, v34
    v_mul_f32 v246, v246, v34
    v_mul_f32 v247, v247, v34
    v_accvgpr_read_b32 v33, a32
    v_mul_f32 v33, v33, v34
    v_accvgpr_write_b32 a32, v33
    v_accvgpr_read_b32 v33, a33
    v_mul_f32 v33, v33, v34
    v_accvgpr_write_b32 a33, v33
    v_accvgpr_read_b32 v33, a34
    v_mul_f32 v33, v33, v34
    v_accvgpr_write_b32 a34, v33
    v_accvgpr_read_b32 v33, a35
    v_mul_f32 v33, v33, v34
    v_accvgpr_write_b32 a35, v33
    v_accvgpr_read_b32 v33, a36
    v_mul_f32 v33, v33, v34
    v_accvgpr_write_b32 a36, v33
    v_accvgpr_read_b32 v33, a37
    v_mul_f32 v33, v33, v34
    v_accvgpr_write_b32 a37, v33
    v_accvgpr_read_b32 v33, a38
    v_mul_f32 v33, v33, v34
    v_accvgpr_write_b32 a38, v33
    v_accvgpr_read_b32 v33, a39
    v_mul_f32 v33, v33, v34
    v_accvgpr_write_b32 a39, v33
    v_accvgpr_read_b32 v33, a40
    v_mul_f32 v33, v33, v34
    v_accvgpr_write_b32 a40, v33
    v_accvgpr_read_b32 v33, a41
    v_mul_f32 v33, v33, v34
    v_accvgpr_write_b32 a41, v33
    v_accvgpr_read_b32 v33, a42
    v_mul_f32 v33, v33, v34
    v_accvgpr_write_b32 a42, v33
    v_accvgpr_read_b32 v33, a43
    v_mul_f32 v33, v33, v34
    v_accvgpr_write_b32 a43, v33
    v_accvgpr_read_b32 v33, a44
    v_mul_f32 v33, v33, v34
    v_accvgpr_write_b32 a44, v33
    v_accvgpr_read_b32 v33, a45
    v_mul_f32 v33, v33, v34
    v_accvgpr_write_b32 a45, v33
    v_accvgpr_read_b32 v33, a46
    v_mul_f32 v33, v33, v34
    v_accvgpr_write_b32 a46, v33
    v_accvgpr_read_b32 v33, a47
    v_mul_f32 v33, v33, v34
    v_accvgpr_write_b32 a47, v33
    v_accvgpr_read_b32 v33, a48
    v_mul_f32 v33, v33, v34
    v_accvgpr_write_b32 a48, v33
    v_accvgpr_read_b32 v33, a49
    v_mul_f32 v33, v33, v34
    v_accvgpr_write_b32 a49, v33
    v_accvgpr_read_b32 v33, a50
    v_mul_f32 v33, v33, v34
    v_accvgpr_write_b32 a50, v33
    v_accvgpr_read_b32 v33, a51
    v_mul_f32 v33, v33, v34
    v_accvgpr_write_b32 a51, v33
    v_accvgpr_read_b32 v33, a52
    v_mul_f32 v33, v33, v34
    v_accvgpr_write_b32 a52, v33
    v_accvgpr_read_b32 v33, a53
    v_mul_f32 v33, v33, v34
    v_accvgpr_write_b32 a53, v33
    v_accvgpr_read_b32 v33, a54
    v_mul_f32 v33, v33, v34
    v_accvgpr_write_b32 a54, v33
    v_accvgpr_read_b32 v33, a55
    v_mul_f32 v33, v33, v34
    v_accvgpr_write_b32 a55, v33
    v_accvgpr_read_b32 v33, a56
    v_mul_f32 v33, v33, v34
    v_accvgpr_write_b32 a56, v33
    v_accvgpr_read_b32 v33, a57
    v_mul_f32 v33, v33, v34
    v_accvgpr_write_b32 a57, v33
    v_accvgpr_read_b32 v33, a58
    v_mul_f32 v33, v33, v34
    v_accvgpr_write_b32 a58, v33
    v_accvgpr_read_b32 v33, a59
    v_mul_f32 v33, v33, v34
    v_accvgpr_write_b32 a59, v33
    v_accvgpr_read_b32 v33, a60
    v_mul_f32 v33, v33, v34
    v_accvgpr_write_b32 a60, v33
    v_accvgpr_read_b32 v33, a61
    v_mul_f32 v33, v33, v34
    v_accvgpr_write_b32 a61, v33
    v_accvgpr_read_b32 v33, a62
    v_mul_f32 v33, v33, v34
    v_accvgpr_write_b32 a62, v33
    v_accvgpr_read_b32 v33, a63
    v_mul_f32 v33, v33, v34
    v_accvgpr_write_b32 a63, v33
    v_exp_f32 v36, v184
    v_exp_f32 v37, v185
    s_nop 0
    v_cvt_pk_bf16_f32 v228, v36, v37
    v_exp_f32 v36, v186
    v_exp_f32 v37, v187
    s_nop 0
    v_cvt_pk_bf16_f32 v229, v36, v37
    v_exp_f32 v36, v188
    v_exp_f32 v37, v189
    s_nop 0
    v_cvt_pk_bf16_f32 v230, v36, v37
    v_exp_f32 v36, v190
    v_exp_f32 v37, v191
    s_nop 0
    v_cvt_pk_bf16_f32 v231, v36, v37
    v_max3_f32 v32, v192, v193, v194
    v_max3_f32 v32, v195, v196, v32
    v_max3_f32 v32, v197, v198, v32
    v_max_f32 v32, v199, v32
    v_mov_b32 v33, v32
    s_nop 1
    v_permlane16_swap_b32 v32, v33
    s_nop 1
    v_max_f32 v32, v32, v33
    v_mov_b32 v33, v32
    s_nop 1
    v_permlane32_swap_b32 v32, v33
    s_nop 1
    v_max_f32 v32, v32, v33
    v_add_f32 v32, 0x41c00000, v32
    v_max_f32 v32, 0, v32
    v_exp_f32 v34, -v32
    v_sub_f32 v72, v72, v32
    v_sub_f32 v73, v73, v32
    v_sub_f32 v74, v74, v32
    v_sub_f32 v75, v75, v32
    v_sub_f32 v192, v192, v32
    v_sub_f32 v193, v193, v32
    v_sub_f32 v194, v194, v32
    v_sub_f32 v195, v195, v32
    v_sub_f32 v196, v196, v32
    v_sub_f32 v197, v197, v32
    v_sub_f32 v198, v198, v32
    v_sub_f32 v199, v199, v32
    v_sub_f32 v160, v160, v32
    v_sub_f32 v161, v161, v32
    v_sub_f32 v162, v162, v32
    v_sub_f32 v163, v163, v32
    v_sub_f32 v164, v164, v32
    v_sub_f32 v165, v165, v32
    v_sub_f32 v166, v166, v32
    v_sub_f32 v167, v167, v32
    v_mul_f32 v248, v248, v34
    v_mul_f32 v249, v249, v34
    v_mul_f32 v250, v250, v34
    v_mul_f32 v251, v251, v34
    v_accvgpr_read_b32 v33, a64
    v_mul_f32 v33, v33, v34
    v_accvgpr_write_b32 a64, v33
    v_accvgpr_read_b32 v33, a65
    v_mul_f32 v33, v33, v34
    v_accvgpr_write_b32 a65, v33
    v_accvgpr_read_b32 v33, a66
    v_mul_f32 v33, v33, v34
    v_accvgpr_write_b32 a66, v33
    v_accvgpr_read_b32 v33, a67
    v_mul_f32 v33, v33, v34
    v_accvgpr_write_b32 a67, v33
    v_accvgpr_read_b32 v33, a68
    v_mul_f32 v33, v33, v34
    v_accvgpr_write_b32 a68, v33
    v_accvgpr_read_b32 v33, a69
    v_mul_f32 v33, v33, v34
    v_accvgpr_write_b32 a69, v33
    v_accvgpr_read_b32 v33, a70
    v_mul_f32 v33, v33, v34
    v_accvgpr_write_b32 a70, v33
    v_accvgpr_read_b32 v33, a71
    v_mul_f32 v33, v33, v34
    v_accvgpr_write_b32 a71, v33
    v_accvgpr_read_b32 v33, a72
    v_mul_f32 v33, v33, v34
    v_accvgpr_write_b32 a72, v33
    v_accvgpr_read_b32 v33, a73
    v_mul_f32 v33, v33, v34
    v_accvgpr_write_b32 a73, v33
    v_accvgpr_read_b32 v33, a74
    v_mul_f32 v33, v33, v34
    v_accvgpr_write_b32 a74, v33
    v_accvgpr_read_b32 v33, a75
    v_mul_f32 v33, v33, v34
    v_accvgpr_write_b32 a75, v33
    v_accvgpr_read_b32 v33, a76
    v_mul_f32 v33, v33, v34
    v_accvgpr_write_b32 a76, v33
    v_accvgpr_read_b32 v33, a77
    v_mul_f32 v33, v33, v34
    v_accvgpr_write_b32 a77, v33
    v_accvgpr_read_b32 v33, a78
    v_mul_f32 v33, v33, v34
    v_accvgpr_write_b32 a78, v33
    v_accvgpr_read_b32 v33, a79
    v_mul_f32 v33, v33, v34
    v_accvgpr_write_b32 a79, v33
    v_accvgpr_read_b32 v33, a80
    v_mul_f32 v33, v33, v34
    v_accvgpr_write_b32 a80, v33
    v_accvgpr_read_b32 v33, a81
    v_mul_f32 v33, v33, v34
    v_accvgpr_write_b32 a81, v33
    v_accvgpr_read_b32 v33, a82
    v_mul_f32 v33, v33, v34
    v_accvgpr_write_b32 a82, v33
    v_accvgpr_read_b32 v33, a83
    v_mul_f32 v33, v33, v34
    v_accvgpr_write_b32 a83, v33
    v_accvgpr_read_b32 v33, a84
    v_mul_f32 v33, v33, v34
    v_accvgpr_write_b32 a84, v33
    v_accvgpr_read_b32 v33, a85
    v_mul_f32 v33, v33, v34
    v_accvgpr_write_b32 a85, v33
    v_accvgpr_read_b32 v33, a86
    v_mul_f32 v33, v33, v34
    v_accvgpr_write_b32 a86, v33
    v_accvgpr_read_b32 v33, a87
    v_mul_f32 v33, v33, v34
    v_accvgpr_write_b32 a87, v33
    v_accvgpr_read_b32 v33, a88
    v_mul_f32 v33, v33, v34
    v_accvgpr_write_b32 a88, v33
    v_accvgpr_read_b32 v33, a89
    v_mul_f32 v33, v33, v34
    v_accvgpr_write_b32 a89, v33
    v_accvgpr_read_b32 v33, a90
    v_mul_f32 v33, v33, v34
    v_accvgpr_write_b32 a90, v33
    v_accvgpr_read_b32 v33, a91
    v_mul_f32 v33, v33, v34
    v_accvgpr_write_b32 a91, v33
    v_accvgpr_read_b32 v33, a92
    v_mul_f32 v33, v33, v34
    v_accvgpr_write_b32 a92, v33
    v_accvgpr_read_b32 v33, a93
    v_mul_f32 v33, v33, v34
    v_accvgpr_write_b32 a93, v33
    v_accvgpr_read_b32 v33, a94
    v_mul_f32 v33, v33, v34
    v_accvgpr_write_b32 a94, v33
    v_accvgpr_read_b32 v33, a95
    v_mul_f32 v33, v33, v34
    v_accvgpr_write_b32 a95, v33
    v_exp_f32 v36, v192
    v_exp_f32 v37, v193
    s_nop 0
    v_cvt_pk_bf16_f32 v232, v36, v37
    v_exp_f32 v36, v194
    v_exp_f32 v37, v195
    s_nop 0
    v_cvt_pk_bf16_f32 v233, v36, v37
    v_exp_f32 v36, v196
    v_exp_f32 v37, v197
    s_nop 0
    v_cvt_pk_bf16_f32 v234, v36, v37
    v_exp_f32 v36, v198
    v_exp_f32 v37, v199
    s_nop 0
    v_cvt_pk_bf16_f32 v235, v36, v37
    v_max3_f32 v32, v200, v201, v202
    v_max3_f32 v32, v203, v204, v32
    v_max3_f32 v32, v205, v206, v32
    v_max_f32 v32, v207, v32
    v_mov_b32 v33, v32
    s_nop 1
    v_permlane16_swap_b32 v32, v33
    s_nop 1
    v_max_f32 v32, v32, v33
    v_mov_b32 v33, v32
    s_nop 1
    v_permlane32_swap_b32 v32, v33
    s_nop 1
    v_max_f32 v32, v32, v33
    v_add_f32 v32, 0x41c00000, v32
    v_max_f32 v32, 0, v32
    v_exp_f32 v34, -v32
    v_sub_f32 v76, v76, v32
    v_sub_f32 v77, v77, v32
    v_sub_f32 v78, v78, v32
    v_sub_f32 v79, v79, v32
    v_sub_f32 v200, v200, v32
    v_sub_f32 v201, v201, v32
    v_sub_f32 v202, v202, v32
    v_sub_f32 v203, v203, v32
    v_sub_f32 v204, v204, v32
    v_sub_f32 v205, v205, v32
    v_sub_f32 v206, v206, v32
    v_sub_f32 v207, v207, v32
    v_sub_f32 v168, v168, v32
    v_sub_f32 v169, v169, v32
    v_sub_f32 v170, v170, v32
    v_sub_f32 v171, v171, v32
    v_sub_f32 v172, v172, v32
    v_sub_f32 v173, v173, v32
    v_sub_f32 v174, v174, v32
    v_sub_f32 v175, v175, v32
    v_mul_f32 v252, v252, v34
    v_mul_f32 v253, v253, v34
    v_mul_f32 v254, v254, v34
    v_mul_f32 v255, v255, v34
    v_accvgpr_read_b32 v33, a96
    v_mul_f32 v33, v33, v34
    v_accvgpr_write_b32 a96, v33
    v_accvgpr_read_b32 v33, a97
    v_mul_f32 v33, v33, v34
    v_accvgpr_write_b32 a97, v33
    v_accvgpr_read_b32 v33, a98
    v_mul_f32 v33, v33, v34
    v_accvgpr_write_b32 a98, v33
    v_accvgpr_read_b32 v33, a99
    v_mul_f32 v33, v33, v34
    v_accvgpr_write_b32 a99, v33
    v_accvgpr_read_b32 v33, a100
    v_mul_f32 v33, v33, v34
    v_accvgpr_write_b32 a100, v33
    v_accvgpr_read_b32 v33, a101
    v_mul_f32 v33, v33, v34
    v_accvgpr_write_b32 a101, v33
    v_accvgpr_read_b32 v33, a102
    v_mul_f32 v33, v33, v34
    v_accvgpr_write_b32 a102, v33
    v_accvgpr_read_b32 v33, a103
    v_mul_f32 v33, v33, v34
    v_accvgpr_write_b32 a103, v33
    v_accvgpr_read_b32 v33, a104
    v_mul_f32 v33, v33, v34
    v_accvgpr_write_b32 a104, v33
    v_accvgpr_read_b32 v33, a105
    v_mul_f32 v33, v33, v34
    v_accvgpr_write_b32 a105, v33
    v_accvgpr_read_b32 v33, a106
    v_mul_f32 v33, v33, v34
    v_accvgpr_write_b32 a106, v33
    v_accvgpr_read_b32 v33, a107
    v_mul_f32 v33, v33, v34
    v_accvgpr_write_b32 a107, v33
    v_accvgpr_read_b32 v33, a108
    v_mul_f32 v33, v33, v34
    v_accvgpr_write_b32 a108, v33
    v_accvgpr_read_b32 v33, a109
    v_mul_f32 v33, v33, v34
    v_accvgpr_write_b32 a109, v33
    v_accvgpr_read_b32 v33, a110
    v_mul_f32 v33, v33, v34
    v_accvgpr_write_b32 a110, v33
    v_accvgpr_read_b32 v33, a111
    v_mul_f32 v33, v33, v34
    v_accvgpr_write_b32 a111, v33
    v_accvgpr_read_b32 v33, a112
    v_mul_f32 v33, v33, v34
    v_accvgpr_write_b32 a112, v33
    v_accvgpr_read_b32 v33, a113
    v_mul_f32 v33, v33, v34
    v_accvgpr_write_b32 a113, v33
    v_accvgpr_read_b32 v33, a114
    v_mul_f32 v33, v33, v34
    v_accvgpr_write_b32 a114, v33
    v_accvgpr_read_b32 v33, a115
    v_mul_f32 v33, v33, v34
    v_accvgpr_write_b32 a115, v33
    v_accvgpr_read_b32 v33, a116
    v_mul_f32 v33, v33, v34
    v_accvgpr_write_b32 a116, v33
    v_accvgpr_read_b32 v33, a117
    v_mul_f32 v33, v33, v34
    v_accvgpr_write_b32 a117, v33
    v_accvgpr_read_b32 v33, a118
    v_mul_f32 v33, v33, v34
    v_accvgpr_write_b32 a118, v33
    v_accvgpr_read_b32 v33, a119
    v_mul_f32 v33, v33, v34
    v_accvgpr_write_b32 a119, v33
    v_accvgpr_read_b32 v33, a120
    v_mul_f32 v33, v33, v34
    v_accvgpr_write_b32 a120, v33
    v_accvgpr_read_b32 v33, a121
    v_mul_f32 v33, v33, v34
    v_accvgpr_write_b32 a121, v33
    v_accvgpr_read_b32 v33, a122
    v_mul_f32 v33, v33, v34
    v_accvgpr_write_b32 a122, v33
    v_accvgpr_read_b32 v33, a123
    v_mul_f32 v33, v33, v34
    v_accvgpr_write_b32 a123, v33
    v_accvgpr_read_b32 v33, a124
    v_mul_f32 v33, v33, v34
    v_accvgpr_write_b32 a124, v33
    v_accvgpr_read_b32 v33, a125
    v_mul_f32 v33, v33, v34
    v_accvgpr_write_b32 a125, v33
    v_accvgpr_read_b32 v33, a126
    v_mul_f32 v33, v33, v34
    v_accvgpr_write_b32 a126, v33
    v_accvgpr_read_b32 v33, a127
    v_mul_f32 v33, v33, v34
    v_accvgpr_write_b32 a127, v33
    v_exp_f32 v36, v200
    v_exp_f32 v37, v201
    s_nop 0
    v_cvt_pk_bf16_f32 v236, v36, v37
    v_exp_f32 v36, v202
    v_exp_f32 v37, v203
    s_nop 0
    v_cvt_pk_bf16_f32 v237, v36, v37
    v_exp_f32 v36, v204
    v_exp_f32 v37, v205
    s_nop 0
    v_cvt_pk_bf16_f32 v238, v36, v37
    v_exp_f32 v36, v206
    v_exp_f32 v37, v207
    s_nop 0
    v_cvt_pk_bf16_f32 v239, v36, v37
    s_nop 1
    s_branch gated_mix__ssm_conv_h3__compressed_kv_cla__prompt_kernel_b3_r1_ret
gated_mix__ssm_conv_h3__compressed_kv_cla__prompt_kernel_b2_r0:
    s_nop 7
    v_max3_f32 v32, v160, v161, v162
    v_max3_f32 v32, v163, v164, v32
    v_max3_f32 v32, v165, v166, v32
    v_max_f32 v32, v167, v32
    v_mov_b32 v33, v32
    s_nop 1
    v_permlane16_swap_b32 v32, v33
    s_nop 1
    v_max_f32 v32, v32, v33
    v_mov_b32 v33, v32
    s_nop 1
    v_permlane32_swap_b32 v32, v33
    s_nop 1
    v_max_f32 v32, v32, v33
    v_add_f32 v32, 0x41c00000, v32
    v_max_f32 v32, 0, v32
    v_exp_f32 v34, -v32
    v_sub_f32 v72, v72, v32
    v_sub_f32 v73, v73, v32
    v_sub_f32 v74, v74, v32
    v_sub_f32 v75, v75, v32
    v_sub_f32 v160, v160, v32
    v_sub_f32 v161, v161, v32
    v_sub_f32 v162, v162, v32
    v_sub_f32 v163, v163, v32
    v_sub_f32 v164, v164, v32
    v_sub_f32 v165, v165, v32
    v_sub_f32 v166, v166, v32
    v_sub_f32 v167, v167, v32
    v_sub_f32 v192, v192, v32
    v_sub_f32 v193, v193, v32
    v_sub_f32 v194, v194, v32
    v_sub_f32 v195, v195, v32
    v_sub_f32 v196, v196, v32
    v_sub_f32 v197, v197, v32
    v_sub_f32 v198, v198, v32
    v_sub_f32 v199, v199, v32
    v_mul_f32 v248, v248, v34
    v_mul_f32 v249, v249, v34
    v_mul_f32 v250, v250, v34
    v_mul_f32 v251, v251, v34
    v_accvgpr_read_b32 v33, a64
    v_mul_f32 v33, v33, v34
    v_accvgpr_write_b32 a64, v33
    v_accvgpr_read_b32 v33, a65
    v_mul_f32 v33, v33, v34
    v_accvgpr_write_b32 a65, v33
    v_accvgpr_read_b32 v33, a66
    v_mul_f32 v33, v33, v34
    v_accvgpr_write_b32 a66, v33
    v_accvgpr_read_b32 v33, a67
    v_mul_f32 v33, v33, v34
    v_accvgpr_write_b32 a67, v33
    v_accvgpr_read_b32 v33, a68
    v_mul_f32 v33, v33, v34
    v_accvgpr_write_b32 a68, v33
    v_accvgpr_read_b32 v33, a69
    v_mul_f32 v33, v33, v34
    v_accvgpr_write_b32 a69, v33
    v_accvgpr_read_b32 v33, a70
    v_mul_f32 v33, v33, v34
    v_accvgpr_write_b32 a70, v33
    v_accvgpr_read_b32 v33, a71
    v_mul_f32 v33, v33, v34
    v_accvgpr_write_b32 a71, v33
    v_accvgpr_read_b32 v33, a72
    v_mul_f32 v33, v33, v34
    v_accvgpr_write_b32 a72, v33
    v_accvgpr_read_b32 v33, a73
    v_mul_f32 v33, v33, v34
    v_accvgpr_write_b32 a73, v33
    v_accvgpr_read_b32 v33, a74
    v_mul_f32 v33, v33, v34
    v_accvgpr_write_b32 a74, v33
    v_accvgpr_read_b32 v33, a75
    v_mul_f32 v33, v33, v34
    v_accvgpr_write_b32 a75, v33
    v_accvgpr_read_b32 v33, a76
    v_mul_f32 v33, v33, v34
    v_accvgpr_write_b32 a76, v33
    v_accvgpr_read_b32 v33, a77
    v_mul_f32 v33, v33, v34
    v_accvgpr_write_b32 a77, v33
    v_accvgpr_read_b32 v33, a78
    v_mul_f32 v33, v33, v34
    v_accvgpr_write_b32 a78, v33
    v_accvgpr_read_b32 v33, a79
    v_mul_f32 v33, v33, v34
    v_accvgpr_write_b32 a79, v33
    v_accvgpr_read_b32 v33, a80
    v_mul_f32 v33, v33, v34
    v_accvgpr_write_b32 a80, v33
    v_accvgpr_read_b32 v33, a81
    v_mul_f32 v33, v33, v34
    v_accvgpr_write_b32 a81, v33
    v_accvgpr_read_b32 v33, a82
    v_mul_f32 v33, v33, v34
    v_accvgpr_write_b32 a82, v33
    v_accvgpr_read_b32 v33, a83
    v_mul_f32 v33, v33, v34
    v_accvgpr_write_b32 a83, v33
    v_accvgpr_read_b32 v33, a84
    v_mul_f32 v33, v33, v34
    v_accvgpr_write_b32 a84, v33
    v_accvgpr_read_b32 v33, a85
    v_mul_f32 v33, v33, v34
    v_accvgpr_write_b32 a85, v33
    v_accvgpr_read_b32 v33, a86
    v_mul_f32 v33, v33, v34
    v_accvgpr_write_b32 a86, v33
    v_accvgpr_read_b32 v33, a87
    v_mul_f32 v33, v33, v34
    v_accvgpr_write_b32 a87, v33
    v_accvgpr_read_b32 v33, a88
    v_mul_f32 v33, v33, v34
    v_accvgpr_write_b32 a88, v33
    v_accvgpr_read_b32 v33, a89
    v_mul_f32 v33, v33, v34
    v_accvgpr_write_b32 a89, v33
    v_accvgpr_read_b32 v33, a90
    v_mul_f32 v33, v33, v34
    v_accvgpr_write_b32 a90, v33
    v_accvgpr_read_b32 v33, a91
    v_mul_f32 v33, v33, v34
    v_accvgpr_write_b32 a91, v33
    v_accvgpr_read_b32 v33, a92
    v_mul_f32 v33, v33, v34
    v_accvgpr_write_b32 a92, v33
    v_accvgpr_read_b32 v33, a93
    v_mul_f32 v33, v33, v34
    v_accvgpr_write_b32 a93, v33
    v_accvgpr_read_b32 v33, a94
    v_mul_f32 v33, v33, v34
    v_accvgpr_write_b32 a94, v33
    v_accvgpr_read_b32 v33, a95
    v_mul_f32 v33, v33, v34
    v_accvgpr_write_b32 a95, v33
    v_exp_f32 v36, v160
    v_exp_f32 v37, v161
    s_nop 0
    v_cvt_pk_bf16_f32 v216, v36, v37
    v_exp_f32 v36, v162
    v_exp_f32 v37, v163
    s_nop 0
    v_cvt_pk_bf16_f32 v217, v36, v37
    v_exp_f32 v36, v164
    v_exp_f32 v37, v165
    s_nop 0
    v_cvt_pk_bf16_f32 v218, v36, v37
    v_exp_f32 v36, v166
    v_exp_f32 v37, v167
    s_nop 0
    v_cvt_pk_bf16_f32 v219, v36, v37
    v_max3_f32 v32, v168, v169, v170
    v_max3_f32 v32, v171, v172, v32
    v_max3_f32 v32, v173, v174, v32
    v_max_f32 v32, v175, v32
    v_mov_b32 v33, v32
    s_nop 1
    v_permlane16_swap_b32 v32, v33
    s_nop 1
    v_max_f32 v32, v32, v33
    v_mov_b32 v33, v32
    s_nop 1
    v_permlane32_swap_b32 v32, v33
    s_nop 1
    v_max_f32 v32, v32, v33
    v_add_f32 v32, 0x41c00000, v32
    v_max_f32 v32, 0, v32
    v_exp_f32 v34, -v32
    v_sub_f32 v76, v76, v32
    v_sub_f32 v77, v77, v32
    v_sub_f32 v78, v78, v32
    v_sub_f32 v79, v79, v32
    v_sub_f32 v168, v168, v32
    v_sub_f32 v169, v169, v32
    v_sub_f32 v170, v170, v32
    v_sub_f32 v171, v171, v32
    v_sub_f32 v172, v172, v32
    v_sub_f32 v173, v173, v32
    v_sub_f32 v174, v174, v32
    v_sub_f32 v175, v175, v32
    v_sub_f32 v200, v200, v32
    v_sub_f32 v201, v201, v32
    v_sub_f32 v202, v202, v32
    v_sub_f32 v203, v203, v32
    v_sub_f32 v204, v204, v32
    v_sub_f32 v205, v205, v32
    v_sub_f32 v206, v206, v32
    v_sub_f32 v207, v207, v32
    v_mul_f32 v252, v252, v34
    v_mul_f32 v253, v253, v34
    v_mul_f32 v254, v254, v34
    v_mul_f32 v255, v255, v34
    v_accvgpr_read_b32 v33, a96
    v_mul_f32 v33, v33, v34
    v_accvgpr_write_b32 a96, v33
    v_accvgpr_read_b32 v33, a97
    v_mul_f32 v33, v33, v34
    v_accvgpr_write_b32 a97, v33
    v_accvgpr_read_b32 v33, a98
    v_mul_f32 v33, v33, v34
    v_accvgpr_write_b32 a98, v33
    v_accvgpr_read_b32 v33, a99
    v_mul_f32 v33, v33, v34
    v_accvgpr_write_b32 a99, v33
    v_accvgpr_read_b32 v33, a100
    v_mul_f32 v33, v33, v34
    v_accvgpr_write_b32 a100, v33
    v_accvgpr_read_b32 v33, a101
    v_mul_f32 v33, v33, v34
    v_accvgpr_write_b32 a101, v33
    v_accvgpr_read_b32 v33, a102
    v_mul_f32 v33, v33, v34
    v_accvgpr_write_b32 a102, v33
    v_accvgpr_read_b32 v33, a103
    v_mul_f32 v33, v33, v34
    v_accvgpr_write_b32 a103, v33
    v_accvgpr_read_b32 v33, a104
    v_mul_f32 v33, v33, v34
    v_accvgpr_write_b32 a104, v33
    v_accvgpr_read_b32 v33, a105
    v_mul_f32 v33, v33, v34
    v_accvgpr_write_b32 a105, v33
    v_accvgpr_read_b32 v33, a106
    v_mul_f32 v33, v33, v34
    v_accvgpr_write_b32 a106, v33
    v_accvgpr_read_b32 v33, a107
    v_mul_f32 v33, v33, v34
    v_accvgpr_write_b32 a107, v33
    v_accvgpr_read_b32 v33, a108
    v_mul_f32 v33, v33, v34
    v_accvgpr_write_b32 a108, v33
    v_accvgpr_read_b32 v33, a109
    v_mul_f32 v33, v33, v34
    v_accvgpr_write_b32 a109, v33
    v_accvgpr_read_b32 v33, a110
    v_mul_f32 v33, v33, v34
    v_accvgpr_write_b32 a110, v33
    v_accvgpr_read_b32 v33, a111
    v_mul_f32 v33, v33, v34
    v_accvgpr_write_b32 a111, v33
    v_accvgpr_read_b32 v33, a112
    v_mul_f32 v33, v33, v34
    v_accvgpr_write_b32 a112, v33
    v_accvgpr_read_b32 v33, a113
    v_mul_f32 v33, v33, v34
    v_accvgpr_write_b32 a113, v33
    v_accvgpr_read_b32 v33, a114
    v_mul_f32 v33, v33, v34
    v_accvgpr_write_b32 a114, v33
    v_accvgpr_read_b32 v33, a115
    v_mul_f32 v33, v33, v34
    v_accvgpr_write_b32 a115, v33
    v_accvgpr_read_b32 v33, a116
    v_mul_f32 v33, v33, v34
    v_accvgpr_write_b32 a116, v33
    v_accvgpr_read_b32 v33, a117
    v_mul_f32 v33, v33, v34
    v_accvgpr_write_b32 a117, v33
    v_accvgpr_read_b32 v33, a118
    v_mul_f32 v33, v33, v34
    v_accvgpr_write_b32 a118, v33
    v_accvgpr_read_b32 v33, a119
    v_mul_f32 v33, v33, v34
    v_accvgpr_write_b32 a119, v33
    v_accvgpr_read_b32 v33, a120
    v_mul_f32 v33, v33, v34
    v_accvgpr_write_b32 a120, v33
    v_accvgpr_read_b32 v33, a121
    v_mul_f32 v33, v33, v34
    v_accvgpr_write_b32 a121, v33
    v_accvgpr_read_b32 v33, a122
    v_mul_f32 v33, v33, v34
    v_accvgpr_write_b32 a122, v33
    v_accvgpr_read_b32 v33, a123
    v_mul_f32 v33, v33, v34
    v_accvgpr_write_b32 a123, v33
    v_accvgpr_read_b32 v33, a124
    v_mul_f32 v33, v33, v34
    v_accvgpr_write_b32 a124, v33
    v_accvgpr_read_b32 v33, a125
    v_mul_f32 v33, v33, v34
    v_accvgpr_write_b32 a125, v33
    v_accvgpr_read_b32 v33, a126
    v_mul_f32 v33, v33, v34
    v_accvgpr_write_b32 a126, v33
    v_accvgpr_read_b32 v33, a127
    v_mul_f32 v33, v33, v34
    v_accvgpr_write_b32 a127, v33
    v_exp_f32 v36, v168
    v_exp_f32 v37, v169
    s_nop 0
    v_cvt_pk_bf16_f32 v220, v36, v37
    v_exp_f32 v36, v170
    v_exp_f32 v37, v171
    s_nop 0
    v_cvt_pk_bf16_f32 v221, v36, v37
    v_exp_f32 v36, v172
    v_exp_f32 v37, v173
    s_nop 0
    v_cvt_pk_bf16_f32 v222, v36, v37
    v_exp_f32 v36, v174
    v_exp_f32 v37, v175
    s_nop 0
    v_cvt_pk_bf16_f32 v223, v36, v37
    s_nop 1
    s_branch gated_mix__ssm_conv_h3__compressed_kv_cla__prompt_kernel_b2_r0_ret
gated_mix__ssm_conv_h3__compressed_kv_cla__prompt_kernel_b2_r1:
    s_nop 7
    v_max3_f32 v32, v192, v193, v194
    v_max3_f32 v32, v195, v196, v32
    v_max3_f32 v32, v197, v198, v32
    v_max_f32 v32, v199, v32
    v_mov_b32 v33, v32
    s_nop 1
    v_permlane16_swap_b32 v32, v33
    s_nop 1
    v_max_f32 v32, v32, v33
    v_mov_b32 v33, v32
    s_nop 1
    v_permlane32_swap_b32 v32, v33
    s_nop 1
    v_max_f32 v32, v32, v33
    v_add_f32 v32, 0x41c00000, v32
    v_max_f32 v32, 0, v32
    v_exp_f32 v34, -v32
    v_sub_f32 v72, v72, v32
    v_sub_f32 v73, v73, v32
    v_sub_f32 v74, v74, v32
    v_sub_f32 v75, v75, v32
    v_sub_f32 v192, v192, v32
    v_sub_f32 v193, v193, v32
    v_sub_f32 v194, v194, v32
    v_sub_f32 v195, v195, v32
    v_sub_f32 v196, v196, v32
    v_sub_f32 v197, v197, v32
    v_sub_f32 v198, v198, v32
    v_sub_f32 v199, v199, v32
    v_sub_f32 v160, v160, v32
    v_sub_f32 v161, v161, v32
    v_sub_f32 v162, v162, v32
    v_sub_f32 v163, v163, v32
    v_sub_f32 v164, v164, v32
    v_sub_f32 v165, v165, v32
    v_sub_f32 v166, v166, v32
    v_sub_f32 v167, v167, v32
    v_mul_f32 v248, v248, v34
    v_mul_f32 v249, v249, v34
    v_mul_f32 v250, v250, v34
    v_mul_f32 v251, v251, v34
    v_accvgpr_read_b32 v33, a64
    v_mul_f32 v33, v33, v34
    v_accvgpr_write_b32 a64, v33
    v_accvgpr_read_b32 v33, a65
    v_mul_f32 v33, v33, v34
    v_accvgpr_write_b32 a65, v33
    v_accvgpr_read_b32 v33, a66
    v_mul_f32 v33, v33, v34
    v_accvgpr_write_b32 a66, v33
    v_accvgpr_read_b32 v33, a67
    v_mul_f32 v33, v33, v34
    v_accvgpr_write_b32 a67, v33
    v_accvgpr_read_b32 v33, a68
    v_mul_f32 v33, v33, v34
    v_accvgpr_write_b32 a68, v33
    v_accvgpr_read_b32 v33, a69
    v_mul_f32 v33, v33, v34
    v_accvgpr_write_b32 a69, v33
    v_accvgpr_read_b32 v33, a70
    v_mul_f32 v33, v33, v34
    v_accvgpr_write_b32 a70, v33
    v_accvgpr_read_b32 v33, a71
    v_mul_f32 v33, v33, v34
    v_accvgpr_write_b32 a71, v33
    v_accvgpr_read_b32 v33, a72
    v_mul_f32 v33, v33, v34
    v_accvgpr_write_b32 a72, v33
    v_accvgpr_read_b32 v33, a73
    v_mul_f32 v33, v33, v34
    v_accvgpr_write_b32 a73, v33
    v_accvgpr_read_b32 v33, a74
    v_mul_f32 v33, v33, v34
    v_accvgpr_write_b32 a74, v33
    v_accvgpr_read_b32 v33, a75
    v_mul_f32 v33, v33, v34
    v_accvgpr_write_b32 a75, v33
    v_accvgpr_read_b32 v33, a76
    v_mul_f32 v33, v33, v34
    v_accvgpr_write_b32 a76, v33
    v_accvgpr_read_b32 v33, a77
    v_mul_f32 v33, v33, v34
    v_accvgpr_write_b32 a77, v33
    v_accvgpr_read_b32 v33, a78
    v_mul_f32 v33, v33, v34
    v_accvgpr_write_b32 a78, v33
    v_accvgpr_read_b32 v33, a79
    v_mul_f32 v33, v33, v34
    v_accvgpr_write_b32 a79, v33
    v_accvgpr_read_b32 v33, a80
    v_mul_f32 v33, v33, v34
    v_accvgpr_write_b32 a80, v33
    v_accvgpr_read_b32 v33, a81
    v_mul_f32 v33, v33, v34
    v_accvgpr_write_b32 a81, v33
    v_accvgpr_read_b32 v33, a82
    v_mul_f32 v33, v33, v34
    v_accvgpr_write_b32 a82, v33
    v_accvgpr_read_b32 v33, a83
    v_mul_f32 v33, v33, v34
    v_accvgpr_write_b32 a83, v33
    v_accvgpr_read_b32 v33, a84
    v_mul_f32 v33, v33, v34
    v_accvgpr_write_b32 a84, v33
    v_accvgpr_read_b32 v33, a85
    v_mul_f32 v33, v33, v34
    v_accvgpr_write_b32 a85, v33
    v_accvgpr_read_b32 v33, a86
    v_mul_f32 v33, v33, v34
    v_accvgpr_write_b32 a86, v33
    v_accvgpr_read_b32 v33, a87
    v_mul_f32 v33, v33, v34
    v_accvgpr_write_b32 a87, v33
    v_accvgpr_read_b32 v33, a88
    v_mul_f32 v33, v33, v34
    v_accvgpr_write_b32 a88, v33
    v_accvgpr_read_b32 v33, a89
    v_mul_f32 v33, v33, v34
    v_accvgpr_write_b32 a89, v33
    v_accvgpr_read_b32 v33, a90
    v_mul_f32 v33, v33, v34
    v_accvgpr_write_b32 a90, v33
    v_accvgpr_read_b32 v33, a91
    v_mul_f32 v33, v33, v34
    v_accvgpr_write_b32 a91, v33
    v_accvgpr_read_b32 v33, a92
    v_mul_f32 v33, v33, v34
    v_accvgpr_write_b32 a92, v33
    v_accvgpr_read_b32 v33, a93
    v_mul_f32 v33, v33, v34
    v_accvgpr_write_b32 a93, v33
    v_accvgpr_read_b32 v33, a94
    v_mul_f32 v33, v33, v34
    v_accvgpr_write_b32 a94, v33
    v_accvgpr_read_b32 v33, a95
    v_mul_f32 v33, v33, v34
    v_accvgpr_write_b32 a95, v33
    v_exp_f32 v36, v192
    v_exp_f32 v37, v193
    s_nop 0
    v_cvt_pk_bf16_f32 v232, v36, v37
    v_exp_f32 v36, v194
    v_exp_f32 v37, v195
    s_nop 0
    v_cvt_pk_bf16_f32 v233, v36, v37
    v_exp_f32 v36, v196
    v_exp_f32 v37, v197
    s_nop 0
    v_cvt_pk_bf16_f32 v234, v36, v37
    v_exp_f32 v36, v198
    v_exp_f32 v37, v199
    s_nop 0
    v_cvt_pk_bf16_f32 v235, v36, v37
    v_max3_f32 v32, v200, v201, v202
    v_max3_f32 v32, v203, v204, v32
    v_max3_f32 v32, v205, v206, v32
    v_max_f32 v32, v207, v32
    v_mov_b32 v33, v32
    s_nop 1
    v_permlane16_swap_b32 v32, v33
    s_nop 1
    v_max_f32 v32, v32, v33
    v_mov_b32 v33, v32
    s_nop 1
    v_permlane32_swap_b32 v32, v33
    s_nop 1
    v_max_f32 v32, v32, v33
    v_add_f32 v32, 0x41c00000, v32
    v_max_f32 v32, 0, v32
    v_exp_f32 v34, -v32
    v_sub_f32 v76, v76, v32
    v_sub_f32 v77, v77, v32
    v_sub_f32 v78, v78, v32
    v_sub_f32 v79, v79, v32
    v_sub_f32 v200, v200, v32
    v_sub_f32 v201, v201, v32
    v_sub_f32 v202, v202, v32
    v_sub_f32 v203, v203, v32
    v_sub_f32 v204, v204, v32
    v_sub_f32 v205, v205, v32
    v_sub_f32 v206, v206, v32
    v_sub_f32 v207, v207, v32
    v_sub_f32 v168, v168, v32
    v_sub_f32 v169, v169, v32
    v_sub_f32 v170, v170, v32
    v_sub_f32 v171, v171, v32
    v_sub_f32 v172, v172, v32
    v_sub_f32 v173, v173, v32
    v_sub_f32 v174, v174, v32
    v_sub_f32 v175, v175, v32
    v_mul_f32 v252, v252, v34
    v_mul_f32 v253, v253, v34
    v_mul_f32 v254, v254, v34
    v_mul_f32 v255, v255, v34
    v_accvgpr_read_b32 v33, a96
    v_mul_f32 v33, v33, v34
    v_accvgpr_write_b32 a96, v33
    v_accvgpr_read_b32 v33, a97
    v_mul_f32 v33, v33, v34
    v_accvgpr_write_b32 a97, v33
    v_accvgpr_read_b32 v33, a98
    v_mul_f32 v33, v33, v34
    v_accvgpr_write_b32 a98, v33
    v_accvgpr_read_b32 v33, a99
    v_mul_f32 v33, v33, v34
    v_accvgpr_write_b32 a99, v33
    v_accvgpr_read_b32 v33, a100
    v_mul_f32 v33, v33, v34
    v_accvgpr_write_b32 a100, v33
    v_accvgpr_read_b32 v33, a101
    v_mul_f32 v33, v33, v34
    v_accvgpr_write_b32 a101, v33
    v_accvgpr_read_b32 v33, a102
    v_mul_f32 v33, v33, v34
    v_accvgpr_write_b32 a102, v33
    v_accvgpr_read_b32 v33, a103
    v_mul_f32 v33, v33, v34
    v_accvgpr_write_b32 a103, v33
    v_accvgpr_read_b32 v33, a104
    v_mul_f32 v33, v33, v34
    v_accvgpr_write_b32 a104, v33
    v_accvgpr_read_b32 v33, a105
    v_mul_f32 v33, v33, v34
    v_accvgpr_write_b32 a105, v33
    v_accvgpr_read_b32 v33, a106
    v_mul_f32 v33, v33, v34
    v_accvgpr_write_b32 a106, v33
    v_accvgpr_read_b32 v33, a107
    v_mul_f32 v33, v33, v34
    v_accvgpr_write_b32 a107, v33
    v_accvgpr_read_b32 v33, a108
    v_mul_f32 v33, v33, v34
    v_accvgpr_write_b32 a108, v33
    v_accvgpr_read_b32 v33, a109
    v_mul_f32 v33, v33, v34
    v_accvgpr_write_b32 a109, v33
    v_accvgpr_read_b32 v33, a110
    v_mul_f32 v33, v33, v34
    v_accvgpr_write_b32 a110, v33
    v_accvgpr_read_b32 v33, a111
    v_mul_f32 v33, v33, v34
    v_accvgpr_write_b32 a111, v33
    v_accvgpr_read_b32 v33, a112
    v_mul_f32 v33, v33, v34
    v_accvgpr_write_b32 a112, v33
    v_accvgpr_read_b32 v33, a113
    v_mul_f32 v33, v33, v34
    v_accvgpr_write_b32 a113, v33
    v_accvgpr_read_b32 v33, a114
    v_mul_f32 v33, v33, v34
    v_accvgpr_write_b32 a114, v33
    v_accvgpr_read_b32 v33, a115
    v_mul_f32 v33, v33, v34
    v_accvgpr_write_b32 a115, v33
    v_accvgpr_read_b32 v33, a116
    v_mul_f32 v33, v33, v34
    v_accvgpr_write_b32 a116, v33
    v_accvgpr_read_b32 v33, a117
    v_mul_f32 v33, v33, v34
    v_accvgpr_write_b32 a117, v33
    v_accvgpr_read_b32 v33, a118
    v_mul_f32 v33, v33, v34
    v_accvgpr_write_b32 a118, v33
    v_accvgpr_read_b32 v33, a119
    v_mul_f32 v33, v33, v34
    v_accvgpr_write_b32 a119, v33
    v_accvgpr_read_b32 v33, a120
    v_mul_f32 v33, v33, v34
    v_accvgpr_write_b32 a120, v33
    v_accvgpr_read_b32 v33, a121
    v_mul_f32 v33, v33, v34
    v_accvgpr_write_b32 a121, v33
    v_accvgpr_read_b32 v33, a122
    v_mul_f32 v33, v33, v34
    v_accvgpr_write_b32 a122, v33
    v_accvgpr_read_b32 v33, a123
    v_mul_f32 v33, v33, v34
    v_accvgpr_write_b32 a123, v33
    v_accvgpr_read_b32 v33, a124
    v_mul_f32 v33, v33, v34
    v_accvgpr_write_b32 a124, v33
    v_accvgpr_read_b32 v33, a125
    v_mul_f32 v33, v33, v34
    v_accvgpr_write_b32 a125, v33
    v_accvgpr_read_b32 v33, a126
    v_mul_f32 v33, v33, v34
    v_accvgpr_write_b32 a126, v33
    v_accvgpr_read_b32 v33, a127
    v_mul_f32 v33, v33, v34
    v_accvgpr_write_b32 a127, v33
    v_exp_f32 v36, v200
    v_exp_f32 v37, v201
    s_nop 0
    v_cvt_pk_bf16_f32 v236, v36, v37
    v_exp_f32 v36, v202
    v_exp_f32 v37, v203
    s_nop 0
    v_cvt_pk_bf16_f32 v237, v36, v37
    v_exp_f32 v36, v204
    v_exp_f32 v37, v205
    s_nop 0
    v_cvt_pk_bf16_f32 v238, v36, v37
    v_exp_f32 v36, v206
    v_exp_f32 v37, v207
    s_nop 0
    v_cvt_pk_bf16_f32 v239, v36, v37
    s_nop 1
    s_branch gated_mix__ssm_conv_h3__compressed_kv_cla__prompt_kernel_b2_r1_ret
gated_mix__ssm_conv_h3__compressed_kv_cla__prompt_kernel_b1_r0:
    s_nop 7
    v_max3_f32 v32, v168, v169, v170
    v_max3_f32 v32, v171, v172, v32
    v_max3_f32 v32, v173, v174, v32
    v_max_f32 v32, v175, v32
    v_mov_b32 v33, v32
    s_nop 1
    v_permlane16_swap_b32 v32, v33
    s_nop 1
    v_max_f32 v32, v32, v33
    v_mov_b32 v33, v32
    s_nop 1
    v_permlane32_swap_b32 v32, v33
    s_nop 1
    v_max_f32 v32, v32, v33
    v_add_f32 v32, 0x41c00000, v32
    v_max_f32 v32, 0, v32
    v_exp_f32 v34, -v32
    v_sub_f32 v76, v76, v32
    v_sub_f32 v77, v77, v32
    v_sub_f32 v78, v78, v32
    v_sub_f32 v79, v79, v32
    v_sub_f32 v168, v168, v32
    v_sub_f32 v169, v169, v32
    v_sub_f32 v170, v170, v32
    v_sub_f32 v171, v171, v32
    v_sub_f32 v172, v172, v32
    v_sub_f32 v173, v173, v32
    v_sub_f32 v174, v174, v32
    v_sub_f32 v175, v175, v32
    v_sub_f32 v200, v200, v32
    v_sub_f32 v201, v201, v32
    v_sub_f32 v202, v202, v32
    v_sub_f32 v203, v203, v32
    v_sub_f32 v204, v204, v32
    v_sub_f32 v205, v205, v32
    v_sub_f32 v206, v206, v32
    v_sub_f32 v207, v207, v32
    v_mul_f32 v252, v252, v34
    v_mul_f32 v253, v253, v34
    v_mul_f32 v254, v254, v34
    v_mul_f32 v255, v255, v34
    v_accvgpr_read_b32 v33, a96
    v_mul_f32 v33, v33, v34
    v_accvgpr_write_b32 a96, v33
    v_accvgpr_read_b32 v33, a97
    v_mul_f32 v33, v33, v34
    v_accvgpr_write_b32 a97, v33
    v_accvgpr_read_b32 v33, a98
    v_mul_f32 v33, v33, v34
    v_accvgpr_write_b32 a98, v33
    v_accvgpr_read_b32 v33, a99
    v_mul_f32 v33, v33, v34
    v_accvgpr_write_b32 a99, v33
    v_accvgpr_read_b32 v33, a100
    v_mul_f32 v33, v33, v34
    v_accvgpr_write_b32 a100, v33
    v_accvgpr_read_b32 v33, a101
    v_mul_f32 v33, v33, v34
    v_accvgpr_write_b32 a101, v33
    v_accvgpr_read_b32 v33, a102
    v_mul_f32 v33, v33, v34
    v_accvgpr_write_b32 a102, v33
    v_accvgpr_read_b32 v33, a103
    v_mul_f32 v33, v33, v34
    v_accvgpr_write_b32 a103, v33
    v_accvgpr_read_b32 v33, a104
    v_mul_f32 v33, v33, v34
    v_accvgpr_write_b32 a104, v33
    v_accvgpr_read_b32 v33, a105
    v_mul_f32 v33, v33, v34
    v_accvgpr_write_b32 a105, v33
    v_accvgpr_read_b32 v33, a106
    v_mul_f32 v33, v33, v34
    v_accvgpr_write_b32 a106, v33
    v_accvgpr_read_b32 v33, a107
    v_mul_f32 v33, v33, v34
    v_accvgpr_write_b32 a107, v33
    v_accvgpr_read_b32 v33, a108
    v_mul_f32 v33, v33, v34
    v_accvgpr_write_b32 a108, v33
    v_accvgpr_read_b32 v33, a109
    v_mul_f32 v33, v33, v34
    v_accvgpr_write_b32 a109, v33
    v_accvgpr_read_b32 v33, a110
    v_mul_f32 v33, v33, v34
    v_accvgpr_write_b32 a110, v33
    v_accvgpr_read_b32 v33, a111
    v_mul_f32 v33, v33, v34
    v_accvgpr_write_b32 a111, v33
    v_accvgpr_read_b32 v33, a112
    v_mul_f32 v33, v33, v34
    v_accvgpr_write_b32 a112, v33
    v_accvgpr_read_b32 v33, a113
    v_mul_f32 v33, v33, v34
    v_accvgpr_write_b32 a113, v33
    v_accvgpr_read_b32 v33, a114
    v_mul_f32 v33, v33, v34
    v_accvgpr_write_b32 a114, v33
    v_accvgpr_read_b32 v33, a115
    v_mul_f32 v33, v33, v34
    v_accvgpr_write_b32 a115, v33
    v_accvgpr_read_b32 v33, a116
    v_mul_f32 v33, v33, v34
    v_accvgpr_write_b32 a116, v33
    v_accvgpr_read_b32 v33, a117
    v_mul_f32 v33, v33, v34
    v_accvgpr_write_b32 a117, v33
    v_accvgpr_read_b32 v33, a118
    v_mul_f32 v33, v33, v34
    v_accvgpr_write_b32 a118, v33
    v_accvgpr_read_b32 v33, a119
    v_mul_f32 v33, v33, v34
    v_accvgpr_write_b32 a119, v33
    v_accvgpr_read_b32 v33, a120
    v_mul_f32 v33, v33, v34
    v_accvgpr_write_b32 a120, v33
    v_accvgpr_read_b32 v33, a121
    v_mul_f32 v33, v33, v34
    v_accvgpr_write_b32 a121, v33
    v_accvgpr_read_b32 v33, a122
    v_mul_f32 v33, v33, v34
    v_accvgpr_write_b32 a122, v33
    v_accvgpr_read_b32 v33, a123
    v_mul_f32 v33, v33, v34
    v_accvgpr_write_b32 a123, v33
    v_accvgpr_read_b32 v33, a124
    v_mul_f32 v33, v33, v34
    v_accvgpr_write_b32 a124, v33
    v_accvgpr_read_b32 v33, a125
    v_mul_f32 v33, v33, v34
    v_accvgpr_write_b32 a125, v33
    v_accvgpr_read_b32 v33, a126
    v_mul_f32 v33, v33, v34
    v_accvgpr_write_b32 a126, v33
    v_accvgpr_read_b32 v33, a127
    v_mul_f32 v33, v33, v34
    v_accvgpr_write_b32 a127, v33
    v_exp_f32 v36, v168
    v_exp_f32 v37, v169
    s_nop 0
    v_cvt_pk_bf16_f32 v220, v36, v37
    v_exp_f32 v36, v170
    v_exp_f32 v37, v171
    s_nop 0
    v_cvt_pk_bf16_f32 v221, v36, v37
    v_exp_f32 v36, v172
    v_exp_f32 v37, v173
    s_nop 0
    v_cvt_pk_bf16_f32 v222, v36, v37
    v_exp_f32 v36, v174
    v_exp_f32 v37, v175
    s_nop 0
    v_cvt_pk_bf16_f32 v223, v36, v37
    s_nop 1
    s_branch gated_mix__ssm_conv_h3__compressed_kv_cla__prompt_kernel_b1_r0_ret
gated_mix__ssm_conv_h3__compressed_kv_cla__prompt_kernel_b1_r1:
    s_nop 7
    v_max3_f32 v32, v200, v201, v202
    v_max3_f32 v32, v203, v204, v32
    v_max3_f32 v32, v205, v206, v32
    v_max_f32 v32, v207, v32
    v_mov_b32 v33, v32
    s_nop 1
    v_permlane16_swap_b32 v32, v33
    s_nop 1
    v_max_f32 v32, v32, v33
    v_mov_b32 v33, v32
    s_nop 1
    v_permlane32_swap_b32 v32, v33
    s_nop 1
    v_max_f32 v32, v32, v33
    v_add_f32 v32, 0x41c00000, v32
    v_max_f32 v32, 0, v32
    v_exp_f32 v34, -v32
    v_sub_f32 v76, v76, v32
    v_sub_f32 v77, v77, v32
    v_sub_f32 v78, v78, v32
    v_sub_f32 v79, v79, v32
    v_sub_f32 v200, v200, v32
    v_sub_f32 v201, v201, v32
    v_sub_f32 v202, v202, v32
    v_sub_f32 v203, v203, v32
    v_sub_f32 v204, v204, v32
    v_sub_f32 v205, v205, v32
    v_sub_f32 v206, v206, v32
    v_sub_f32 v207, v207, v32
    v_mul_f32 v252, v252, v34
    v_mul_f32 v253, v253, v34
    v_mul_f32 v254, v254, v34
    v_mul_f32 v255, v255, v34
    v_accvgpr_read_b32 v33, a96
    v_mul_f32 v33, v33, v34
    v_accvgpr_write_b32 a96, v33
    v_accvgpr_read_b32 v33, a97
    v_mul_f32 v33, v33, v34
    v_accvgpr_write_b32 a97, v33
    v_accvgpr_read_b32 v33, a98
    v_mul_f32 v33, v33, v34
    v_accvgpr_write_b32 a98, v33
    v_accvgpr_read_b32 v33, a99
    v_mul_f32 v33, v33, v34
    v_accvgpr_write_b32 a99, v33
    v_accvgpr_read_b32 v33, a100
    v_mul_f32 v33, v33, v34
    v_accvgpr_write_b32 a100, v33
    v_accvgpr_read_b32 v33, a101
    v_mul_f32 v33, v33, v34
    v_accvgpr_write_b32 a101, v33
    v_accvgpr_read_b32 v33, a102
    v_mul_f32 v33, v33, v34
    v_accvgpr_write_b32 a102, v33
    v_accvgpr_read_b32 v33, a103
    v_mul_f32 v33, v33, v34
    v_accvgpr_write_b32 a103, v33
    v_accvgpr_read_b32 v33, a104
    v_mul_f32 v33, v33, v34
    v_accvgpr_write_b32 a104, v33
    v_accvgpr_read_b32 v33, a105
    v_mul_f32 v33, v33, v34
    v_accvgpr_write_b32 a105, v33
    v_accvgpr_read_b32 v33, a106
    v_mul_f32 v33, v33, v34
    v_accvgpr_write_b32 a106, v33
    v_accvgpr_read_b32 v33, a107
    v_mul_f32 v33, v33, v34
    v_accvgpr_write_b32 a107, v33
    v_accvgpr_read_b32 v33, a108
    v_mul_f32 v33, v33, v34
    v_accvgpr_write_b32 a108, v33
    v_accvgpr_read_b32 v33, a109
    v_mul_f32 v33, v33, v34
    v_accvgpr_write_b32 a109, v33
    v_accvgpr_read_b32 v33, a110
    v_mul_f32 v33, v33, v34
    v_accvgpr_write_b32 a110, v33
    v_accvgpr_read_b32 v33, a111
    v_mul_f32 v33, v33, v34
    v_accvgpr_write_b32 a111, v33
    v_accvgpr_read_b32 v33, a112
    v_mul_f32 v33, v33, v34
    v_accvgpr_write_b32 a112, v33
    v_accvgpr_read_b32 v33, a113
    v_mul_f32 v33, v33, v34
    v_accvgpr_write_b32 a113, v33
    v_accvgpr_read_b32 v33, a114
    v_mul_f32 v33, v33, v34
    v_accvgpr_write_b32 a114, v33
    v_accvgpr_read_b32 v33, a115
    v_mul_f32 v33, v33, v34
    v_accvgpr_write_b32 a115, v33
    v_accvgpr_read_b32 v33, a116
    v_mul_f32 v33, v33, v34
    v_accvgpr_write_b32 a116, v33
    v_accvgpr_read_b32 v33, a117
    v_mul_f32 v33, v33, v34
    v_accvgpr_write_b32 a117, v33
    v_accvgpr_read_b32 v33, a118
    v_mul_f32 v33, v33, v34
    v_accvgpr_write_b32 a118, v33
    v_accvgpr_read_b32 v33, a119
    v_mul_f32 v33, v33, v34
    v_accvgpr_write_b32 a119, v33
    v_accvgpr_read_b32 v33, a120
    v_mul_f32 v33, v33, v34
    v_accvgpr_write_b32 a120, v33
    v_accvgpr_read_b32 v33, a121
    v_mul_f32 v33, v33, v34
    v_accvgpr_write_b32 a121, v33
    v_accvgpr_read_b32 v33, a122
    v_mul_f32 v33, v33, v34
    v_accvgpr_write_b32 a122, v33
    v_accvgpr_read_b32 v33, a123
    v_mul_f32 v33, v33, v34
    v_accvgpr_write_b32 a123, v33
    v_accvgpr_read_b32 v33, a124
    v_mul_f32 v33, v33, v34
    v_accvgpr_write_b32 a124, v33
    v_accvgpr_read_b32 v33, a125
    v_mul_f32 v33, v33, v34
    v_accvgpr_write_b32 a125, v33
    v_accvgpr_read_b32 v33, a126
    v_mul_f32 v33, v33, v34
    v_accvgpr_write_b32 a126, v33
    v_accvgpr_read_b32 v33, a127
    v_mul_f32 v33, v33, v34
    v_accvgpr_write_b32 a127, v33
    v_exp_f32 v36, v200
    v_exp_f32 v37, v201
    s_nop 0
    v_cvt_pk_bf16_f32 v236, v36, v37
    v_exp_f32 v36, v202
    v_exp_f32 v37, v203
    s_nop 0
    v_cvt_pk_bf16_f32 v237, v36, v37
    v_exp_f32 v36, v204
    v_exp_f32 v37, v205
    s_nop 0
    v_cvt_pk_bf16_f32 v238, v36, v37
    v_exp_f32 v36, v206
    v_exp_f32 v37, v207
    s_nop 0
    v_cvt_pk_bf16_f32 v239, v36, v37
    s_nop 1
    s_branch gated_mix__ssm_conv_h3__compressed_kv_cla__prompt_kernel_b1_r1_ret

.section .rodata,"a"
.p2align 6
.amdhsa_kernel gated_mix__ssm_conv_h3__compressed_kv_cla__prompt_kernel
  .amdhsa_next_free_vgpr 512
  .amdhsa_next_free_sgpr 102
  .amdhsa_accum_offset 256
  .amdhsa_group_segment_fixed_size 0
  .amdhsa_kernarg_size 128
  .amdhsa_user_sgpr_count 2
  .amdhsa_user_sgpr_kernarg_segment_ptr 1
  .amdhsa_system_sgpr_workgroup_id_x 1
  .amdhsa_float_denorm_mode_32 3
.end_amdhsa_kernel
```

```asm
; @launch grid=(256,1,1) block=(256,1,1) lds=163840
.amdgcn_target "amdgcn-amd-amdhsa--gfx950"
.text
.globl gated_mix__ssm_conv_h3__compressed_kv_cla__prompt_kernel
.p2align 8
.type gated_mix__ssm_conv_h3__compressed_kv_cla__prompt_kernel,@function
gated_mix__ssm_conv_h3__compressed_kv_cla__prompt_kernel:
    s_cmp_ge_u32 s2, 256
    s_cbranch_scc1 gated_mix__ssm_conv_h3__compressed_kv_cla__prompt_kernel_end
    s_load_dwordx16 s[64:79], s[0:1], 0
    s_load_dwordx16 s[80:95], s[0:1], 64
    s_getpc_b64 s[4:5]
gated_mix__ssm_conv_h3__compressed_kv_cla__prompt_kernel_pc:
    v_lshlrev_b32 v242, 7, v0
    v_add_u32 v243, 0x8000, v242
    v_min_u32 v243, gated_mix__ssm_conv_h3__compressed_kv_cla__prompt_kernel_hotend-gated_mix__ssm_conv_h3__compressed_kv_cla__prompt_kernel_pc, v243
    global_load_dword v255, v242, s[4:5]
    global_load_dword v255, v243, s[4:5]
    v_add_u32 v244, 0x10000, v242
    v_min_u32 v244, gated_mix__ssm_conv_h3__compressed_kv_cla__prompt_kernel_hotend-gated_mix__ssm_conv_h3__compressed_kv_cla__prompt_kernel_pc, v244
    global_load_dword v255, v244, s[4:5]
    v_lshrrev_b32 v242, 6, v0
    v_and_b32 v240, 63, v0
    v_readfirstlane_b32 s32, v242
    v_lshlrev_b32 v16, 4, v240
    s_and_b32 s36, s2, 7
    s_lshl_b32 s36, s36, 2
    s_bfe_u32 s33, s2, 0x20003
    s_add_u32 s33, s33, s36
    s_lshr_b32 s34, s2, 5
    v_lshrrev_b32 v242, 3, v240
    v_and_b32 v247, 7, v240
    v_lshrrev_b32 v245, 4, v240
    v_xor_b32 v243, v245, v247
    v_lshlrev_b32 v243, 4, v243
    v_xor_b32 v244, 64, v243
    v_lshl_add_u32 v2, v242, 10, v243
    v_lshl_add_u32 v3, v242, 10, v244
    v_add_u32 v3, 7168, v3
    v_add_u32 v4, 14336, v2
    v_add_u32 v5, 14336, v3
    v_and_b32 v246, 15, v240
    v_lshlrev_b32 v247, 1, v245
    v_xor_b32 v247, v247, v246
    v_lshlrev_b32 v247, 4, v247
    v_lshl_add_u32 v21, v245, 13, v247
    s_and_b32 s36, s32, 1
    s_lshl_b32 s36, s36, 7
    v_xor_b32 v6, s36, v21
    v_add_u32 v7, 31744, v6
    s_lshl_b32 s38, s34, 18
    s_lshl_b32 s36, s32, 16
    s_add_u32 s38, s38, s36
    s_lshl_b32 s39, s33, 8
    s_add_u32 s39, s39, s36
    s_lshl_b32 s42, s32, 13
    s_lshl_b32 s43, s32, 12
    s_add_u32 s43, s43, 98304
    s_waitcnt lgkmcnt(0)
    s_mov_b32 s4, s78
    s_mov_b32 s5, s79
    s_mov_b32 s6, 2097152
    s_mov_b32 s7, 0x00020000
    s_mov_b32 s8, s82
    s_mov_b32 s9, s83
    s_mov_b32 s10, 4194304
    s_mov_b32 s11, 0x00020000
    s_mov_b32 s12, s84
    s_mov_b32 s13, s85
    s_mov_b32 s14, 4194304
    s_mov_b32 s15, 0x00020000
    s_add_u32 s35, s2, s34
    s_and_b32 s35, s35, 7
    s_lshl_b32 s58, s35, 19
    s_lshl_b32 s35, s35, 7
    s_add_u32 s59, s38, 32768
    s_add_u32 s36, s35, 0
    s_and_b32 s36, s36, 1023
    s_add_u32 s36, s36, s38
    s_add_u32 m0, s42, 0
    s_nop 0
    buffer_load_dwordx4 v2, s[4:7], s36 offen offset:0 lds
    buffer_load_dwordx4 v3, s[4:7], s36 offen offset:1024 lds
    buffer_load_dwordx4 v4, s[4:7], s36 offen offset:2048 lds
    buffer_load_dwordx4 v5, s[4:7], s36 offen offset:3072 lds
    s_add_u32 s36, s35, 0
    s_and_b32 s36, s36, 1023
    s_add_u32 s36, s36, s59
    s_add_u32 m0, s42, 4096
    s_nop 0
    buffer_load_dwordx4 v2, s[4:7], s36 offen offset:0 lds
    buffer_load_dwordx4 v3, s[4:7], s36 offen offset:1024 lds
    buffer_load_dwordx4 v4, s[4:7], s36 offen offset:2048 lds
    buffer_load_dwordx4 v5, s[4:7], s36 offen offset:3072 lds
    s_add_u32 s37, s58, 0
    s_and_b32 s37, s37, 4194303
    s_add_u32 s37, s37, s39
    s_add_u32 m0, s43, 0
    s_nop 0
    buffer_load_dwordx4 v6, s[8:11], s37 offen offset:0 lds
    buffer_load_dwordx4 v7, s[8:11], s37 offen offset:1024 lds
    s_add_u32 m0, s43, 2048
    s_nop 0
    buffer_load_dwordx4 v6, s[12:15], s37 offen offset:0 lds
    buffer_load_dwordx4 v7, s[12:15], s37 offen offset:1024 lds
    s_add_u32 s37, s58, 262144
    s_and_b32 s37, s37, 4194303
    s_add_u32 s37, s37, s39
    s_add_u32 m0, s43, 16384
    s_nop 0
    buffer_load_dwordx4 v6, s[8:11], s37 offen offset:0 lds
    buffer_load_dwordx4 v7, s[8:11], s37 offen offset:1024 lds
    s_add_u32 m0, s43, 18432
    s_nop 0
    buffer_load_dwordx4 v6, s[12:15], s37 offen offset:0 lds
    buffer_load_dwordx4 v7, s[12:15], s37 offen offset:1024 lds
    s_add_u32 s36, s35, 128
    s_and_b32 s36, s36, 1023
    s_add_u32 s36, s36, s38
    s_add_u32 m0, s42, 32768
    s_nop 0
    buffer_load_dwordx4 v2, s[4:7], s36 offen offset:0 lds
    buffer_load_dwordx4 v3, s[4:7], s36 offen offset:1024 lds
    buffer_load_dwordx4 v4, s[4:7], s36 offen offset:2048 lds
    buffer_load_dwordx4 v5, s[4:7], s36 offen offset:3072 lds
    v_lshrrev_b32 v247, 1, v246
    v_xor_b32 v247, v245, v247
    v_lshlrev_b32 v247, 4, v247
    v_lshl_add_u32 v247, v246, 7, v247
    s_lshr_b32 s36, s32, 1
    s_lshl_b32 s36, s36, 14
    v_add_u32 v8, s36, v247
    v_xor_b32 v9, 64, v8
    v_add_u32 v14, 65536, v8
    v_add_u32 v15, 65536, v9
    v_add_u32 v23, s42, v247
    v_xor_b32 v24, 64, v23
    v_add_u32 v25, 65536, v23
    v_add_u32 v26, 65536, v24
    v_lshrrev_b32 v247, 2, v246
    v_and_b32 v248, 3, v246
    v_lshlrev_b32 v248, 3, v248
    v_lshl_add_u32 v248, v247, 8, v248
    v_add_u32 v248, 98304, v248
    v_lshl_add_u32 v249, v245, 12, v248
    v_mul_u32_u24 v250, 2176, v245
    v_add_u32 v250, v250, v248
    v_xor_b32 v248, s32, v245
    v_and_b32 v248, 1, v248
    v_lshl_add_u32 v249, v248, 7, v249
    v_xor_b32 v248, 0, v247
    v_lshl_add_u32 v10, v248, 5, v249
    v_lshl_add_u32 v27, v248, 5, v250
    v_xor_b32 v248, 1, v247
    v_lshl_add_u32 v11, v248, 5, v249
    v_lshl_add_u32 v28, v248, 5, v250
    v_xor_b32 v248, 2, v247
    v_lshl_add_u32 v12, v248, 5, v249
    v_lshl_add_u32 v29, v248, 5, v250
    v_xor_b32 v248, 3, v247
    v_lshl_add_u32 v13, v248, 5, v249
    v_lshl_add_u32 v30, v248, 5, v250
    v_lshl_add_u32 v17, v242, 13, v243
    v_lshl_add_u32 v18, v242, 13, v244
    v_add_u32 v18, 64512, v18
    v_add_u32 v19, 129024, v17
    v_add_u32 v20, 129024, v18
    v_add_u32 v22, 31744, v21
    s_lshl_b32 s54, s2, 2
    s_add_u32 s54, s54, s32
    v_lshlrev_b32 v254, 7, v240
    s_lshl_b32 s46, s54, 13
    s_mov_b32 s20, s80
    s_mov_b32 s21, s81
    s_mov_b32 s22, 8388608
    s_mov_b32 s23, 0x00020000
    s_mov_b32 s24, s64
    s_mov_b32 s25, s65
    s_mov_b32 s26, 4194304
    s_mov_b32 s27, 0x00020000
    s_add_u32 s28, s94, 60817408
    s_addc_u32 s29, s95, 0
    s_mov_b32 s30, 16384
    s_mov_b32 s31, 0x00020000
    s_mov_b32 s49, s39
    s_mul_i32 s50, s32, 2176
    s_add_u32 s50, s50, 98304
    s_lshl_b32 s44, s34, 7
    s_add_u32 s44, s44, s32
    s_lshl_b32 s44, s44, 11
    s_lshl_b32 s37, s34, 1
    s_sub_u32 s45, 15, s37
    s_lshl_b32 s45, s45, 18
    s_add_u32 s45, s45, s44
    s_lshl_b32 s57, s54, 2
    s_add_u32 s57, s57, 8192
    s_lshl_b32 s36, s32, 5
    s_add_u32 s36, s36, s33
    s_lshl_b32 s36, s36, 2
    s_lshl_b32 s37, s34, 9
    s_add_u32 s55, s36, s37
    s_sub_u32 s56, 7680, s37
    s_add_u32 s56, s56, s36
    s_lshl_b32 s36, s34, 3
    s_add_u32 s36, s36, 0
    s_add_u32 s36, s36, s32
    s_lshl_b32 s36, s36, 5
    s_add_u32 s36, s36, s33
    s_lshl_b32 s60, s36, 12
    s_lshl_b32 s36, s34, 3
    s_add_u32 s36, s36, 4
    s_add_u32 s36, s36, s32
    s_lshl_b32 s36, s36, 5
    s_add_u32 s36, s36, s33
    s_lshl_b32 s61, s36, 12
    s_lshl_b32 s36, s34, 3
    s_sub_u32 s36, 120, s36
    s_add_u32 s36, s36, s32
    s_lshl_b32 s36, s36, 5
    s_add_u32 s36, s36, s33
    s_lshl_b32 s62, s36, 12
    s_lshl_b32 s36, s34, 3
    s_sub_u32 s36, 124, s36
    s_add_u32 s36, s36, s32
    s_lshl_b32 s36, s36, 5
    s_add_u32 s36, s36, s33
    s_lshl_b32 s63, s36, 12
    s_lshr_b32 s36, s2, 4
    s_lshl_b32 s36, s36, 4
    s_lshl_b32 s37, s32, 2
    s_add_u32 s36, s36, s37
    s_and_b32 s37, s2, 15
    s_lshl_b32 s37, s37, 6
    v_add_u32 v247, s36, v245
    v_lshl_add_u32 v248, v246, 2, s37
    v_lshlrev_b32 v0, 14, v247
    v_lshl_add_u32 v0, v248, 1, v0
    v_subrev_u32 v1, 6144, v0
    v_lshlrev_b32 v232, 3, v248
    v_lshlrev_b32 v233, 4, v240
    v_mul_u32_u24 v234, 4608, v248
    v_lshlrev_b32 v247, 4, v247
    v_sub_u32 v247, 4080, v247
    v_add_u32 v234, v234, v247
    v_add_u32 v235, s37, v240
    v_mul_u32_u24 v235, 4608, v235
    s_movk_i32 s47, 4096
    s_movk_i32 s48, 8192
    s_movk_i32 s51, 12288
    s_mov_b32 s52, 0xffff0000
    s_lshr_b32 s37, s2, 4
    s_or_b32 s37, s37, s32
    s_cmp_eq_u32 s37, 0
    s_cselect_b32 s53, s47, 0x80000000
    s_lshl_b32 s36, s33, 13
    s_add_u32 s40, s44, s36
    s_add_u32 s41, s45, s36
    s_waitcnt vmcnt(20)
    s_mov_b64 exec, 0
    s_cmp_eq_u32 s32, 0
    s_cbranch_scc1 gated_mix__ssm_conv_h3__compressed_kv_cla__prompt_kernel_pad0
    s_cmp_eq_u32 s32, 1
    s_cbranch_scc1 gated_mix__ssm_conv_h3__compressed_kv_cla__prompt_kernel_pad1
    s_cmp_eq_u32 s32, 2
    s_cbranch_scc1 gated_mix__ssm_conv_h3__compressed_kv_cla__prompt_kernel_pad2
    s_cmp_eq_u32 s32, 3
    s_cbranch_scc1 gated_mix__ssm_conv_h3__compressed_kv_cla__prompt_kernel_pad3
    s_branch gated_mix__ssm_conv_h3__compressed_kv_cla__prompt_kernel_body
.p2align 12
gated_mix__ssm_conv_h3__compressed_kv_cla__prompt_kernel_body:
    s_mov_b64 exec, -1
    s_waitcnt vmcnt(8)
    s_barrier
    ds_read_b64_tr_b16 v[64:65], v10 offset:0
    ds_read_b64_tr_b16 v[66:67], v10 offset:1024
    ds_read_b64_tr_b16 v[68:69], v11 offset:0
    ds_read_b64_tr_b16 v[70:71], v11 offset:1024
    ds_read_b128 v[32:35], v8 offset:0
    ds_read_b64_tr_b16 v[72:73], v12 offset:0
    ds_read_b64_tr_b16 v[74:75], v12 offset:1024
    ds_read_b128 v[36:39], v8 offset:2048
    ds_read_b64_tr_b16 v[76:77], v13 offset:0
    ds_read_b64_tr_b16 v[78:79], v13 offset:1024
    ds_read_b128 v[40:43], v8 offset:4096
    ds_read_b64_tr_b16 v[80:81], v10 offset:2048
    ds_read_b64_tr_b16 v[82:83], v10 offset:3072
    ds_read_b128 v[44:47], v8 offset:6144
    ds_read_b64_tr_b16 v[84:85], v11 offset:2048
    ds_read_b64_tr_b16 v[86:87], v11 offset:3072
    ds_read_b128 v[48:51], v8 offset:8192
    ds_read_b64_tr_b16 v[88:89], v12 offset:2048
    ds_read_b64_tr_b16 v[90:91], v12 offset:3072
    ds_read_b128 v[52:55], v8 offset:10240
    ds_read_b64_tr_b16 v[92:93], v13 offset:2048
    ds_read_b64_tr_b16 v[94:95], v13 offset:3072
    ds_read_b128 v[56:59], v8 offset:12288
    ds_read_b128 v[60:63], v8 offset:14336
    s_waitcnt vmcnt(4) lgkmcnt(0)
    s_barrier
    v_mfma_f32_16x16x32_bf16 a[0:3], v[64:67], v[32:35], 0
    ds_read_b64_tr_b16 v[128:129], v10 offset:16384
    v_mfma_f32_16x16x32_bf16 a[4:7], v[64:67], v[36:39], 0
    s_add_u32 s36, s35, 128
    s_and_b32 s36, s36, 1023
    s_add_u32 s36, s36, s59
    v_mfma_f32_16x16x32_bf16 a[8:11], v[64:67], v[40:43], 0
    s_add_u32 m0, s42, 36864
    ds_read_b64_tr_b16 v[130:131], v10 offset:17408
    v_mfma_f32_16x16x32_bf16 a[12:15], v[64:67], v[44:47], 0
    buffer_load_dwordx4 v2, s[4:7], s36 offen offset:0 lds
    v_mfma_f32_16x16x32_bf16 a[16:19], v[64:67], v[48:51], 0
    ds_read_b64_tr_b16 v[132:133], v11 offset:16384
    v_mfma_f32_16x16x32_bf16 a[20:23], v[64:67], v[52:55], 0
    v_mfma_f32_16x16x32_bf16 a[24:27], v[64:67], v[56:59], 0
    ds_read_b64_tr_b16 v[134:135], v11 offset:17408
    v_mfma_f32_16x16x32_bf16 a[28:31], v[64:67], v[60:63], 0
    buffer_load_dwordx4 v3, s[4:7], s36 offen offset:1024 lds
    v_mfma_f32_16x16x32_bf16 a[32:35], v[68:71], v[32:35], 0
    ds_read_b128 v[96:99], v9 offset:0
    v_mfma_f32_16x16x32_bf16 a[36:39], v[68:71], v[36:39], 0
    v_mfma_f32_16x16x32_bf16 a[40:43], v[68:71], v[40:43], 0
    ds_read_b64_tr_b16 v[136:137], v12 offset:16384
    v_mfma_f32_16x16x32_bf16 a[44:47], v[68:71], v[44:47], 0
    buffer_load_dwordx4 v4, s[4:7], s36 offen offset:2048 lds
    v_mfma_f32_16x16x32_bf16 a[48:51], v[68:71], v[48:51], 0
    ds_read_b64_tr_b16 v[138:139], v12 offset:17408
    v_mfma_f32_16x16x32_bf16 a[52:55], v[68:71], v[52:55], 0
    v_mfma_f32_16x16x32_bf16 a[56:59], v[68:71], v[56:59], 0
    ds_read_b128 v[100:103], v9 offset:2048
    v_mfma_f32_16x16x32_bf16 a[60:63], v[68:71], v[60:63], 0
    buffer_load_dwordx4 v5, s[4:7], s36 offen offset:3072 lds
    v_mfma_f32_16x16x32_bf16 a[64:67], v[72:75], v[32:35], 0
    ds_read_b64_tr_b16 v[140:141], v13 offset:16384
    v_mfma_f32_16x16x32_bf16 a[68:71], v[72:75], v[36:39], 0
    s_add_u32 s37, s58, 524288
    s_and_b32 s37, s37, 4194303
    s_add_u32 s37, s37, s39
    v_mfma_f32_16x16x32_bf16 a[72:75], v[72:75], v[40:43], 0
    s_add_u32 m0, s43, 32768
    ds_read_b64_tr_b16 v[142:143], v13 offset:17408
    v_mfma_f32_16x16x32_bf16 a[76:79], v[72:75], v[44:47], 0
    buffer_load_dwordx4 v6, s[8:11], s37 offen offset:0 lds
    v_mfma_f32_16x16x32_bf16 a[80:83], v[72:75], v[48:51], 0
    ds_read_b128 v[104:107], v9 offset:4096
    v_mfma_f32_16x16x32_bf16 a[84:87], v[72:75], v[52:55], 0
    v_mfma_f32_16x16x32_bf16 a[88:91], v[72:75], v[56:59], 0
    ds_read_b64_tr_b16 v[144:145], v10 offset:18432
    v_mfma_f32_16x16x32_bf16 a[92:95], v[72:75], v[60:63], 0
    buffer_load_dwordx4 v7, s[8:11], s37 offen offset:1024 lds
    v_mfma_f32_16x16x32_bf16 a[96:99], v[76:79], v[32:35], 0
    ds_read_b64_tr_b16 v[146:147], v10 offset:19456
    v_mfma_f32_16x16x32_bf16 a[100:103], v[76:79], v[36:39], 0
    v_mfma_f32_16x16x32_bf16 a[104:107], v[76:79], v[40:43], 0
    s_add_u32 m0, s43, 34816
    ds_read_b128 v[108:111], v9 offset:6144
    v_mfma_f32_16x16x32_bf16 a[108:111], v[76:79], v[44:47], 0
    buffer_load_dwordx4 v6, s[12:15], s37 offen offset:0 lds
    v_mfma_f32_16x16x32_bf16 a[112:115], v[76:79], v[48:51], 0
    ds_read_b64_tr_b16 v[148:149], v11 offset:18432
    v_mfma_f32_16x16x32_bf16 a[116:119], v[76:79], v[52:55], 0
    v_mfma_f32_16x16x32_bf16 a[120:123], v[76:79], v[56:59], 0
    ds_read_b64_tr_b16 v[150:151], v11 offset:19456
    v_mfma_f32_16x16x32_bf16 a[124:127], v[76:79], v[60:63], 0
    buffer_load_dwordx4 v7, s[12:15], s37 offen offset:1024 lds
    v_mfma_f32_16x16x32_bf16 a[128:131], v[32:35], v[80:83], 0
    ds_read_b128 v[112:115], v9 offset:8192
    v_mfma_f32_16x16x32_bf16 a[132:135], v[36:39], v[80:83], 0
    s_add_u32 s37, s58, 786432
    s_and_b32 s37, s37, 4194303
    s_add_u32 s37, s37, s39
    v_mfma_f32_16x16x32_bf16 a[136:139], v[40:43], v[80:83], 0
    s_add_u32 m0, s43, 49152
    ds_read_b64_tr_b16 v[152:153], v12 offset:18432
    v_mfma_f32_16x16x32_bf16 a[140:143], v[44:47], v[80:83], 0
    buffer_load_dwordx4 v6, s[8:11], s37 offen offset:0 lds
    v_mfma_f32_16x16x32_bf16 a[144:147], v[48:51], v[80:83], 0
    ds_read_b64_tr_b16 v[154:155], v12 offset:19456
    v_mfma_f32_16x16x32_bf16 a[148:151], v[52:55], v[80:83], 0
    v_mfma_f32_16x16x32_bf16 a[152:155], v[56:59], v[80:83], 0
    ds_read_b128 v[116:119], v9 offset:10240
    v_mfma_f32_16x16x32_bf16 a[156:159], v[60:63], v[80:83], 0
    buffer_load_dwordx4 v7, s[8:11], s37 offen offset:1024 lds
    v_mfma_f32_16x16x32_bf16 a[160:163], v[32:35], v[84:87], 0
    ds_read_b64_tr_b16 v[156:157], v13 offset:18432
    v_mfma_f32_16x16x32_bf16 a[164:167], v[36:39], v[84:87], 0
    v_mfma_f32_16x16x32_bf16 a[168:171], v[40:43], v[84:87], 0
    s_add_u32 m0, s43, 51200
    ds_read_b64_tr_b16 v[158:159], v13 offset:19456
    v_mfma_f32_16x16x32_bf16 a[172:175], v[44:47], v[84:87], 0
    buffer_load_dwordx4 v6, s[12:15], s37 offen offset:0 lds
    v_mfma_f32_16x16x32_bf16 a[176:179], v[48:51], v[84:87], 0
    ds_read_b128 v[120:123], v9 offset:12288
    v_mfma_f32_16x16x32_bf16 a[180:183], v[52:55], v[84:87], 0
    v_mfma_f32_16x16x32_bf16 a[184:187], v[56:59], v[84:87], 0
    ds_read_b128 v[124:127], v9 offset:14336
    v_mfma_f32_16x16x32_bf16 a[188:191], v[60:63], v[84:87], 0
    buffer_load_dwordx4 v7, s[12:15], s37 offen offset:1024 lds
    v_mfma_f32_16x16x32_bf16 a[192:195], v[32:35], v[88:91], 0
    v_mfma_f32_16x16x32_bf16 a[196:199], v[36:39], v[88:91], 0
    v_mfma_f32_16x16x32_bf16 a[200:203], v[40:43], v[88:91], 0
    v_mfma_f32_16x16x32_bf16 a[204:207], v[44:47], v[88:91], 0
    v_mfma_f32_16x16x32_bf16 a[208:211], v[48:51], v[88:91], 0
    v_mfma_f32_16x16x32_bf16 a[212:215], v[52:55], v[88:91], 0
    v_mfma_f32_16x16x32_bf16 a[216:219], v[56:59], v[88:91], 0
    v_mfma_f32_16x16x32_bf16 a[220:223], v[60:63], v[88:91], 0
    v_mfma_f32_16x16x32_bf16 a[224:227], v[32:35], v[92:95], 0
    v_mfma_f32_16x16x32_bf16 a[228:231], v[36:39], v[92:95], 0
    v_mfma_f32_16x16x32_bf16 a[232:235], v[40:43], v[92:95], 0
    v_mfma_f32_16x16x32_bf16 a[236:239], v[44:47], v[92:95], 0
    v_mfma_f32_16x16x32_bf16 a[240:243], v[48:51], v[92:95], 0
    v_mfma_f32_16x16x32_bf16 a[244:247], v[52:55], v[92:95], 0
    v_mfma_f32_16x16x32_bf16 a[248:251], v[56:59], v[92:95], 0
    v_mfma_f32_16x16x32_bf16 a[252:255], v[60:63], v[92:95], 0
    s_waitcnt vmcnt(4) lgkmcnt(0)
    s_barrier
    v_mfma_f32_16x16x32_bf16 a[0:3], v[128:131], v[96:99], a[0:3]
    ds_read_b64_tr_b16 v[64:65], v10 offset:32768
    v_mfma_f32_16x16x32_bf16 a[4:7], v[128:131], v[100:103], a[4:7]
    s_add_u32 s36, s35, 256
    s_and_b32 s36, s36, 1023
    s_add_u32 s36, s36, s38
    v_mfma_f32_16x16x32_bf16 a[8:11], v[128:131], v[104:107], a[8:11]
    s_add_u32 m0, s42, 65536
    ds_read_b64_tr_b16 v[66:67], v10 offset:33792
    v_mfma_f32_16x16x32_bf16 a[12:15], v[128:131], v[108:111], a[12:15]
    buffer_load_dwordx4 v2, s[4:7], s36 offen offset:0 lds
    v_mfma_f32_16x16x32_bf16 a[16:19], v[128:131], v[112:115], a[16:19]
    ds_read_b64_tr_b16 v[68:69], v11 offset:32768
    v_mfma_f32_16x16x32_bf16 a[20:23], v[128:131], v[116:119], a[20:23]
    v_mfma_f32_16x16x32_bf16 a[24:27], v[128:131], v[120:123], a[24:27]
    ds_read_b64_tr_b16 v[70:71], v11 offset:33792
    v_mfma_f32_16x16x32_bf16 a[28:31], v[128:131], v[124:127], a[28:31]
    buffer_load_dwordx4 v3, s[4:7], s36 offen offset:1024 lds
    v_mfma_f32_16x16x32_bf16 a[32:35], v[132:135], v[96:99], a[32:35]
    ds_read_b128 v[32:35], v8 offset:32768
    v_mfma_f32_16x16x32_bf16 a[36:39], v[132:135], v[100:103], a[36:39]
    v_mfma_f32_16x16x32_bf16 a[40:43], v[132:135], v[104:107], a[40:43]
    ds_read_b64_tr_b16 v[72:73], v12 offset:32768
    v_mfma_f32_16x16x32_bf16 a[44:47], v[132:135], v[108:111], a[44:47]
    buffer_load_dwordx4 v4, s[4:7], s36 offen offset:2048 lds
    v_mfma_f32_16x16x32_bf16 a[48:51], v[132:135], v[112:115], a[48:51]
    ds_read_b64_tr_b16 v[74:75], v12 offset:33792
    v_mfma_f32_16x16x32_bf16 a[52:55], v[132:135], v[116:119], a[52:55]
    v_mfma_f32_16x16x32_bf16 a[56:59], v[132:135], v[120:123], a[56:59]
    ds_read_b128 v[36:39], v8 offset:34816
    v_mfma_f32_16x16x32_bf16 a[60:63], v[132:135], v[124:127], a[60:63]
    buffer_load_dwordx4 v5, s[4:7], s36 offen offset:3072 lds
    v_mfma_f32_16x16x32_bf16 a[64:67], v[136:139], v[96:99], a[64:67]
    ds_read_b64_tr_b16 v[76:77], v13 offset:32768
    v_mfma_f32_16x16x32_bf16 a[68:71], v[136:139], v[100:103], a[68:71]
    s_add_u32 s36, s35, 256
    s_and_b32 s36, s36, 1023
    s_add_u32 s36, s36, s59
    v_mfma_f32_16x16x32_bf16 a[72:75], v[136:139], v[104:107], a[72:75]
    s_add_u32 m0, s42, 69632
    ds_read_b64_tr_b16 v[78:79], v13 offset:33792
    v_mfma_f32_16x16x32_bf16 a[76:79], v[136:139], v[108:111], a[76:79]
    buffer_load_dwordx4 v2, s[4:7], s36 offen offset:0 lds
    v_mfma_f32_16x16x32_bf16 a[80:83], v[136:139], v[112:115], a[80:83]
    ds_read_b128 v[40:43], v8 offset:36864
    v_mfma_f32_16x16x32_bf16 a[84:87], v[136:139], v[116:119], a[84:87]
    v_mfma_f32_16x16x32_bf16 a[88:91], v[136:139], v[120:123], a[88:91]
    ds_read_b64_tr_b16 v[80:81], v10 offset:34816
    v_mfma_f32_16x16x32_bf16 a[92:95], v[136:139], v[124:127], a[92:95]
    buffer_load_dwordx4 v3, s[4:7], s36 offen offset:1024 lds
    v_mfma_f32_16x16x32_bf16 a[96:99], v[140:143], v[96:99], a[96:99]
    ds_read_b64_tr_b16 v[82:83], v10 offset:35840
    v_mfma_f32_16x16x32_bf16 a[100:103], v[140:143], v[100:103], a[100:103]
    v_mfma_f32_16x16x32_bf16 a[104:107], v[140:143], v[104:107], a[104:107]
    ds_read_b128 v[44:47], v8 offset:38912
    v_mfma_f32_16x16x32_bf16 a[108:111], v[140:143], v[108:111], a[108:111]
    buffer_load_dwordx4 v4, s[4:7], s36 offen offset:2048 lds
    v_mfma_f32_16x16x32_bf16 a[112:115], v[140:143], v[112:115], a[112:115]
    ds_read_b64_tr_b16 v[84:85], v11 offset:34816
    v_mfma_f32_16x16x32_bf16 a[116:119], v[140:143], v[116:119], a[116:119]
    v_mfma_f32_16x16x32_bf16 a[120:123], v[140:143], v[120:123], a[120:123]
    ds_read_b64_tr_b16 v[86:87], v11 offset:35840
    v_mfma_f32_16x16x32_bf16 a[124:127], v[140:143], v[124:127], a[124:127]
    buffer_load_dwordx4 v5, s[4:7], s36 offen offset:3072 lds
    v_mfma_f32_16x16x32_bf16 a[128:131], v[96:99], v[144:147], a[128:131]
    ds_read_b128 v[48:51], v8 offset:40960
    v_mfma_f32_16x16x32_bf16 a[132:135], v[100:103], v[144:147], a[132:135]
    s_add_u32 s37, s58, 1048576
    s_and_b32 s37, s37, 4194303
    s_add_u32 s37, s37, s39
    v_mfma_f32_16x16x32_bf16 a[136:139], v[104:107], v[144:147], a[136:139]
    s_add_u32 m0, s43, 0
    ds_read_b64_tr_b16 v[88:89], v12 offset:34816
    v_mfma_f32_16x16x32_bf16 a[140:143], v[108:111], v[144:147], a[140:143]
    buffer_load_dwordx4 v6, s[8:11], s37 offen offset:0 lds
    v_mfma_f32_16x16x32_bf16 a[144:147], v[112:115], v[144:147], a[144:147]
    ds_read_b64_tr_b16 v[90:91], v12 offset:35840
    v_mfma_f32_16x16x32_bf16 a[148:151], v[116:119], v[144:147], a[148:151]
    v_mfma_f32_16x16x32_bf16 a[152:155], v[120:123], v[144:147], a[152:155]
    ds_read_b128 v[52:55], v8 offset:43008
    v_mfma_f32_16x16x32_bf16 a[156:159], v[124:127], v[144:147], a[156:159]
    buffer_load_dwordx4 v7, s[8:11], s37 offen offset:1024 lds
    v_mfma_f32_16x16x32_bf16 a[160:163], v[96:99], v[148:151], a[160:163]
    s_lshl_b32 s3, s33, 3
    ds_read_b64_tr_b16 v[92:93], v13 offset:34816
    v_mfma_f32_16x16x32_bf16 a[164:167], v[100:103], v[148:151], a[164:167]
    s_add_u32 s3, s3, s34
    v_mfma_f32_16x16x32_bf16 a[168:171], v[104:107], v[148:151], a[168:171]
    s_add_u32 m0, s43, 2048
    ds_read_b64_tr_b16 v[94:95], v13 offset:35840
    v_mfma_f32_16x16x32_bf16 a[172:175], v[108:111], v[148:151], a[172:175]
    buffer_load_dwordx4 v6, s[12:15], s37 offen offset:0 lds
    v_mfma_f32_16x16x32_bf16 a[176:179], v[112:115], v[148:151], a[176:179]
    s_lshl_b32 s3, s3, 2
    ds_read_b128 v[56:59], v8 offset:45056
    v_mfma_f32_16x16x32_bf16 a[180:183], v[116:119], v[148:151], a[180:183]
    s_add_u32 s3, s3, 12288
    v_mfma_f32_16x16x32_bf16 a[184:187], v[120:123], v[148:151], a[184:187]
    ds_read_b128 v[60:63], v8 offset:47104
    v_mov_b32 v241, 0
    v_mfma_f32_16x16x32_bf16 a[188:191], v[124:127], v[148:151], a[188:191]
    buffer_load_dwordx4 v7, s[12:15], s37 offen offset:1024 lds
    v_mfma_f32_16x16x32_bf16 a[192:195], v[96:99], v[152:155], a[192:195]
    s_mov_b32 s16, s66
    v_mfma_f32_16x16x32_bf16 a[196:199], v[100:103], v[152:155], a[196:199]
    s_mov_b32 s17, s67
    v_mfma_f32_16x16x32_bf16 a[200:203], v[104:107], v[152:155], a[200:203]
    s_mov_b32 s18, 4194304
    v_mfma_f32_16x16x32_bf16 a[204:207], v[108:111], v[152:155], a[204:207]
    v_mfma_f32_16x16x32_bf16 a[208:211], v[112:115], v[152:155], a[208:211]
    s_mov_b32 s19, 0x00020000
    v_mfma_f32_16x16x32_bf16 a[212:215], v[116:119], v[152:155], a[212:215]
    s_mov_b32 s76, s68
    v_mfma_f32_16x16x32_bf16 a[216:219], v[120:123], v[152:155], a[216:219]
    s_mov_b32 s77, s69
    v_mfma_f32_16x16x32_bf16 a[220:223], v[124:127], v[152:155], a[220:223]
    v_mfma_f32_16x16x32_bf16 a[224:227], v[96:99], v[156:159], a[224:227]
    s_mov_b32 s78, 4194304
    v_mfma_f32_16x16x32_bf16 a[228:231], v[100:103], v[156:159], a[228:231]
    s_mov_b32 s79, 0x00020000
    v_mfma_f32_16x16x32_bf16 a[232:235], v[104:107], v[156:159], a[232:235]
    v_mfma_f32_16x16x32_bf16 a[236:239], v[108:111], v[156:159], a[236:239]
    v_mfma_f32_16x16x32_bf16 a[240:243], v[112:115], v[156:159], a[240:243]
    v_mfma_f32_16x16x32_bf16 a[244:247], v[116:119], v[156:159], a[244:247]
    v_mfma_f32_16x16x32_bf16 a[248:251], v[120:123], v[156:159], a[248:251]
    v_mfma_f32_16x16x32_bf16 a[252:255], v[124:127], v[156:159], a[252:255]
    s_waitcnt vmcnt(12) lgkmcnt(0)
    s_barrier
    v_mfma_f32_16x16x32_bf16 a[0:3], v[64:67], v[32:35], a[0:3]
    ds_read_b64_tr_b16 v[128:129], v10 offset:49152
    v_mfma_f32_16x16x32_bf16 a[4:7], v[64:67], v[36:39], a[4:7]
    s_add_u32 s36, s35, 384
    s_and_b32 s36, s36, 1023
    s_add_u32 s36, s36, s38
    v_mfma_f32_16x16x32_bf16 a[8:11], v[64:67], v[40:43], a[8:11]
    s_add_u32 m0, s42, 0
    ds_read_b64_tr_b16 v[130:131], v10 offset:50176
    v_mfma_f32_16x16x32_bf16 a[12:15], v[64:67], v[44:47], a[12:15]
    buffer_load_dwordx4 v2, s[4:7], s36 offen offset:0 lds
    v_mfma_f32_16x16x32_bf16 a[16:19], v[64:67], v[48:51], a[16:19]
    ds_read_b64_tr_b16 v[132:133], v11 offset:49152
    v_mfma_f32_16x16x32_bf16 a[20:23], v[64:67], v[52:55], a[20:23]
    v_mfma_f32_16x16x32_bf16 a[24:27], v[64:67], v[56:59], a[24:27]
    ds_read_b64_tr_b16 v[134:135], v11 offset:50176
    v_mfma_f32_16x16x32_bf16 a[28:31], v[64:67], v[60:63], a[28:31]
    buffer_load_dwordx4 v3, s[4:7], s36 offen offset:1024 lds
    v_mfma_f32_16x16x32_bf16 a[32:35], v[68:71], v[32:35], a[32:35]
    ds_read_b128 v[96:99], v9 offset:32768
    v_mfma_f32_16x16x32_bf16 a[36:39], v[68:71], v[36:39], a[36:39]
    v_mfma_f32_16x16x32_bf16 a[40:43], v[68:71], v[40:43], a[40:43]
    ds_read_b64_tr_b16 v[136:137], v12 offset:49152
    v_mfma_f32_16x16x32_bf16 a[44:47], v[68:71], v[44:47], a[44:47]
    buffer_load_dwordx4 v4, s[4:7], s36 offen offset:2048 lds
    v_mfma_f32_16x16x32_bf16 a[48:51], v[68:71], v[48:51], a[48:51]
    ds_read_b64_tr_b16 v[138:139], v12 offset:50176
    v_mfma_f32_16x16x32_bf16 a[52:55], v[68:71], v[52:55], a[52:55]
    v_mfma_f32_16x16x32_bf16 a[56:59], v[68:71], v[56:59], a[56:59]
    ds_read_b128 v[100:103], v9 offset:34816
    v_mfma_f32_16x16x32_bf16 a[60:63], v[68:71], v[60:63], a[60:63]
    buffer_load_dwordx4 v5, s[4:7], s36 offen offset:3072 lds
    v_mfma_f32_16x16x32_bf16 a[64:67], v[72:75], v[32:35], a[64:67]
    ds_read_b64_tr_b16 v[140:141], v13 offset:49152
    v_mfma_f32_16x16x32_bf16 a[68:71], v[72:75], v[36:39], a[68:71]
    s_add_u32 s37, s58, 1310720
    s_and_b32 s37, s37, 4194303
    s_add_u32 s37, s37, s39
    v_mfma_f32_16x16x32_bf16 a[72:75], v[72:75], v[40:43], a[72:75]
    s_add_u32 m0, s43, 16384
    ds_read_b64_tr_b16 v[142:143], v13 offset:50176
    v_mfma_f32_16x16x32_bf16 a[76:79], v[72:75], v[44:47], a[76:79]
    buffer_load_dwordx4 v6, s[8:11], s37 offen offset:0 lds
    v_mfma_f32_16x16x32_bf16 a[80:83], v[72:75], v[48:51], a[80:83]
    ds_read_b128 v[104:107], v9 offset:36864
    v_mfma_f32_16x16x32_bf16 a[84:87], v[72:75], v[52:55], a[84:87]
    v_mfma_f32_16x16x32_bf16 a[88:91], v[72:75], v[56:59], a[88:91]
    ds_read_b64_tr_b16 v[144:145], v10 offset:51200
    v_mfma_f32_16x16x32_bf16 a[92:95], v[72:75], v[60:63], a[92:95]
    buffer_load_dwordx4 v7, s[8:11], s37 offen offset:1024 lds
    v_mfma_f32_16x16x32_bf16 a[96:99], v[76:79], v[32:35], a[96:99]
    ds_read_b64_tr_b16 v[146:147], v10 offset:52224
    v_mfma_f32_16x16x32_bf16 a[100:103], v[76:79], v[36:39], a[100:103]
    v_mfma_f32_16x16x32_bf16 a[104:107], v[76:79], v[40:43], a[104:107]
    s_add_u32 m0, s43, 18432
    ds_read_b128 v[108:111], v9 offset:38912
    v_mfma_f32_16x16x32_bf16 a[108:111], v[76:79], v[44:47], a[108:111]
    buffer_load_dwordx4 v6, s[12:15], s37 offen offset:0 lds
    v_mfma_f32_16x16x32_bf16 a[112:115], v[76:79], v[48:51], a[112:115]
    ds_read_b64_tr_b16 v[148:149], v11 offset:51200
    v_mfma_f32_16x16x32_bf16 a[116:119], v[76:79], v[52:55], a[116:119]
    v_mfma_f32_16x16x32_bf16 a[120:123], v[76:79], v[56:59], a[120:123]
    ds_read_b64_tr_b16 v[150:151], v11 offset:52224
    v_mfma_f32_16x16x32_bf16 a[124:127], v[76:79], v[60:63], a[124:127]
    buffer_load_dwordx4 v7, s[12:15], s37 offen offset:1024 lds
    v_mfma_f32_16x16x32_bf16 a[128:131], v[32:35], v[80:83], a[128:131]
    ds_read_b128 v[112:115], v9 offset:40960
    v_mfma_f32_16x16x32_bf16 a[132:135], v[36:39], v[80:83], a[132:135]
    s_add_u32 s36, s35, 384
    s_and_b32 s36, s36, 1023
    s_add_u32 s36, s36, s59
    v_mfma_f32_16x16x32_bf16 a[136:139], v[40:43], v[80:83], a[136:139]
    s_add_u32 m0, s42, 4096
    ds_read_b64_tr_b16 v[152:153], v12 offset:51200
    v_mfma_f32_16x16x32_bf16 a[140:143], v[44:47], v[80:83], a[140:143]
    buffer_load_dwordx4 v2, s[4:7], s36 offen offset:0 lds
    v_mfma_f32_16x16x32_bf16 a[144:147], v[48:51], v[80:83], a[144:147]
    ds_read_b64_tr_b16 v[154:155], v12 offset:52224
    v_mfma_f32_16x16x32_bf16 a[148:151], v[52:55], v[80:83], a[148:151]
    v_mfma_f32_16x16x32_bf16 a[152:155], v[56:59], v[80:83], a[152:155]
    ds_read_b128 v[116:119], v9 offset:43008
    v_mfma_f32_16x16x32_bf16 a[156:159], v[60:63], v[80:83], a[156:159]
    buffer_load_dwordx4 v3, s[4:7], s36 offen offset:1024 lds
    v_mfma_f32_16x16x32_bf16 a[160:163], v[32:35], v[84:87], a[160:163]
    ds_read_b64_tr_b16 v[156:157], v13 offset:51200
    v_mfma_f32_16x16x32_bf16 a[164:167], v[36:39], v[84:87], a[164:167]
    v_mfma_f32_16x16x32_bf16 a[168:171], v[40:43], v[84:87], a[168:171]
    ds_read_b64_tr_b16 v[158:159], v13 offset:52224
    v_mfma_f32_16x16x32_bf16 a[172:175], v[44:47], v[84:87], a[172:175]
    buffer_load_dwordx4 v4, s[4:7], s36 offen offset:2048 lds
    v_mfma_f32_16x16x32_bf16 a[176:179], v[48:51], v[84:87], a[176:179]
    ds_read_b128 v[120:123], v9 offset:45056
    v_mfma_f32_16x16x32_bf16 a[180:183], v[52:55], v[84:87], a[180:183]
    v_mfma_f32_16x16x32_bf16 a[184:187], v[56:59], v[84:87], a[184:187]
    ds_read_b128 v[124:127], v9 offset:47104
    v_mfma_f32_16x16x32_bf16 a[188:191], v[60:63], v[84:87], a[188:191]
    buffer_load_dwordx4 v5, s[4:7], s36 offen offset:3072 lds
    v_mfma_f32_16x16x32_bf16 a[192:195], v[32:35], v[88:91], a[192:195]
    v_mfma_f32_16x16x32_bf16 a[196:199], v[36:39], v[88:91], a[196:199]
    v_mfma_f32_16x16x32_bf16 a[200:203], v[40:43], v[88:91], a[200:203]
    v_mfma_f32_16x16x32_bf16 a[204:207], v[44:47], v[88:91], a[204:207]
    v_mfma_f32_16x16x32_bf16 a[208:211], v[48:51], v[88:91], a[208:211]
    v_mfma_f32_16x16x32_bf16 a[212:215], v[52:55], v[88:91], a[212:215]
    v_mfma_f32_16x16x32_bf16 a[216:219], v[56:59], v[88:91], a[216:219]
    v_mfma_f32_16x16x32_bf16 a[220:223], v[60:63], v[88:91], a[220:223]
    v_mfma_f32_16x16x32_bf16 a[224:227], v[32:35], v[92:95], a[224:227]
    v_mfma_f32_16x16x32_bf16 a[228:231], v[36:39], v[92:95], a[228:231]
    v_mfma_f32_16x16x32_bf16 a[232:235], v[40:43], v[92:95], a[232:235]
    v_mfma_f32_16x16x32_bf16 a[236:239], v[44:47], v[92:95], a[236:239]
    v_mfma_f32_16x16x32_bf16 a[240:243], v[48:51], v[92:95], a[240:243]
    v_mfma_f32_16x16x32_bf16 a[244:247], v[52:55], v[92:95], a[244:247]
    v_mfma_f32_16x16x32_bf16 a[248:251], v[56:59], v[92:95], a[248:251]
    v_mfma_f32_16x16x32_bf16 a[252:255], v[60:63], v[92:95], a[252:255]
    s_waitcnt vmcnt(12) lgkmcnt(0)
    s_barrier
    v_mfma_f32_16x16x32_bf16 a[0:3], v[128:131], v[96:99], a[0:3]
    ds_read_b64_tr_b16 v[64:65], v10 offset:0
    v_mfma_f32_16x16x32_bf16 a[4:7], v[128:131], v[100:103], a[4:7]
    s_add_u32 s37, s58, 1572864
    s_and_b32 s37, s37, 4194303
    s_add_u32 s37, s37, s39
    v_mfma_f32_16x16x32_bf16 a[8:11], v[128:131], v[104:107], a[8:11]
    s_add_u32 m0, s43, 32768
    ds_read_b64_tr_b16 v[66:67], v10 offset:1024
    v_mfma_f32_16x16x32_bf16 a[12:15], v[128:131], v[108:111], a[12:15]
    buffer_load_dwordx4 v6, s[8:11], s37 offen offset:0 lds
    v_mfma_f32_16x16x32_bf16 a[16:19], v[128:131], v[112:115], a[16:19]
    ds_read_b64_tr_b16 v[68:69], v11 offset:0
    v_mfma_f32_16x16x32_bf16 a[20:23], v[128:131], v[116:119], a[20:23]
    v_mfma_f32_16x16x32_bf16 a[24:27], v[128:131], v[120:123], a[24:27]
    ds_read_b64_tr_b16 v[70:71], v11 offset:1024
    v_mfma_f32_16x16x32_bf16 a[28:31], v[128:131], v[124:127], a[28:31]
    buffer_load_dwordx4 v7, s[8:11], s37 offen offset:1024 lds
    v_mfma_f32_16x16x32_bf16 a[32:35], v[132:135], v[96:99], a[32:35]
    ds_read_b128 v[32:35], v14 offset:0
    v_mfma_f32_16x16x32_bf16 a[36:39], v[132:135], v[100:103], a[36:39]
    v_mfma_f32_16x16x32_bf16 a[40:43], v[132:135], v[104:107], a[40:43]
    s_add_u32 m0, s43, 34816
    ds_read_b64_tr_b16 v[72:73], v12 offset:0
    v_mfma_f32_16x16x32_bf16 a[44:47], v[132:135], v[108:111], a[44:47]
    buffer_load_dwordx4 v6, s[12:15], s37 offen offset:0 lds
    v_mfma_f32_16x16x32_bf16 a[48:51], v[132:135], v[112:115], a[48:51]
    ds_read_b64_tr_b16 v[74:75], v12 offset:1024
    v_mfma_f32_16x16x32_bf16 a[52:55], v[132:135], v[116:119], a[52:55]
    v_mfma_f32_16x16x32_bf16 a[56:59], v[132:135], v[120:123], a[56:59]
    ds_read_b128 v[36:39], v14 offset:2048
    v_mfma_f32_16x16x32_bf16 a[60:63], v[132:135], v[124:127], a[60:63]
    buffer_load_dwordx4 v7, s[12:15], s37 offen offset:1024 lds
    v_mfma_f32_16x16x32_bf16 a[64:67], v[136:139], v[96:99], a[64:67]
    ds_read_b64_tr_b16 v[76:77], v13 offset:0
    v_mfma_f32_16x16x32_bf16 a[68:71], v[136:139], v[100:103], a[68:71]
    s_add_u32 s36, s35, 512
    s_and_b32 s36, s36, 1023
    s_add_u32 s36, s36, s38
    v_mfma_f32_16x16x32_bf16 a[72:75], v[136:139], v[104:107], a[72:75]
    s_add_u32 m0, s42, 32768
    ds_read_b64_tr_b16 v[78:79], v13 offset:1024
    v_mfma_f32_16x16x32_bf16 a[76:79], v[136:139], v[108:111], a[76:79]
    buffer_load_dwordx4 v2, s[4:7], s36 offen offset:0 lds
    v_mfma_f32_16x16x32_bf16 a[80:83], v[136:139], v[112:115], a[80:83]
    ds_read_b128 v[40:43], v14 offset:4096
    v_mfma_f32_16x16x32_bf16 a[84:87], v[136:139], v[116:119], a[84:87]
    v_mfma_f32_16x16x32_bf16 a[88:91], v[136:139], v[120:123], a[88:91]
    ds_read_b64_tr_b16 v[80:81], v10 offset:2048
    v_mfma_f32_16x16x32_bf16 a[92:95], v[136:139], v[124:127], a[92:95]
    buffer_load_dwordx4 v3, s[4:7], s36 offen offset:1024 lds
    v_mfma_f32_16x16x32_bf16 a[96:99], v[140:143], v[96:99], a[96:99]
    ds_read_b64_tr_b16 v[82:83], v10 offset:3072
    v_mfma_f32_16x16x32_bf16 a[100:103], v[140:143], v[100:103], a[100:103]
    v_mfma_f32_16x16x32_bf16 a[104:107], v[140:143], v[104:107], a[104:107]
    ds_read_b128 v[44:47], v14 offset:6144
    v_mfma_f32_16x16x32_bf16 a[108:111], v[140:143], v[108:111], a[108:111]
    buffer_load_dwordx4 v4, s[4:7], s36 offen offset:2048 lds
    v_mfma_f32_16x16x32_bf16 a[112:115], v[140:143], v[112:115], a[112:115]
    ds_read_b64_tr_b16 v[84:85], v11 offset:2048
    v_mfma_f32_16x16x32_bf16 a[116:119], v[140:143], v[116:119], a[116:119]
    v_mfma_f32_16x16x32_bf16 a[120:123], v[140:143], v[120:123], a[120:123]
    ds_read_b64_tr_b16 v[86:87], v11 offset:3072
    v_mfma_f32_16x16x32_bf16 a[124:127], v[140:143], v[124:127], a[124:127]
    buffer_load_dwordx4 v5, s[4:7], s36 offen offset:3072 lds
    v_mfma_f32_16x16x32_bf16 a[128:131], v[96:99], v[144:147], a[128:131]
    ds_read_b128 v[48:51], v14 offset:8192
    v_mfma_f32_16x16x32_bf16 a[132:135], v[100:103], v[144:147], a[132:135]
    s_add_u32 s37, s58, 1835008
    s_and_b32 s37, s37, 4194303
    s_add_u32 s37, s37, s39
    v_mfma_f32_16x16x32_bf16 a[136:139], v[104:107], v[144:147], a[136:139]
    s_add_u32 m0, s43, 49152
    ds_read_b64_tr_b16 v[88:89], v12 offset:2048
    v_mfma_f32_16x16x32_bf16 a[140:143], v[108:111], v[144:147], a[140:143]
    buffer_load_dwordx4 v6, s[8:11], s37 offen offset:0 lds
    v_mfma_f32_16x16x32_bf16 a[144:147], v[112:115], v[144:147], a[144:147]
    ds_read_b64_tr_b16 v[90:91], v12 offset:3072
    v_mfma_f32_16x16x32_bf16 a[148:151], v[116:119], v[144:147], a[148:151]
    v_mfma_f32_16x16x32_bf16 a[152:155], v[120:123], v[144:147], a[152:155]
    ds_read_b128 v[52:55], v14 offset:10240
    v_mfma_f32_16x16x32_bf16 a[156:159], v[124:127], v[144:147], a[156:159]
    buffer_load_dwordx4 v7, s[8:11], s37 offen offset:1024 lds
    v_mfma_f32_16x16x32_bf16 a[160:163], v[96:99], v[148:151], a[160:163]
    ds_read_b64_tr_b16 v[92:93], v13 offset:2048
    v_mfma_f32_16x16x32_bf16 a[164:167], v[100:103], v[148:151], a[164:167]
    v_mfma_f32_16x16x32_bf16 a[168:171], v[104:107], v[148:151], a[168:171]
    s_add_u32 m0, s43, 51200
    ds_read_b64_tr_b16 v[94:95], v13 offset:3072
    v_mfma_f32_16x16x32_bf16 a[172:175], v[108:111], v[148:151], a[172:175]
    buffer_load_dwordx4 v6, s[12:15], s37 offen offset:0 lds
    v_mfma_f32_16x16x32_bf16 a[176:179], v[112:115], v[148:151], a[176:179]
    ds_read_b128 v[56:59], v14 offset:12288
    v_mfma_f32_16x16x32_bf16 a[180:183], v[116:119], v[148:151], a[180:183]
    v_mfma_f32_16x16x32_bf16 a[184:187], v[120:123], v[148:151], a[184:187]
    ds_read_b128 v[60:63], v14 offset:14336
    v_mfma_f32_16x16x32_bf16 a[188:191], v[124:127], v[148:151], a[188:191]
    buffer_load_dwordx4 v7, s[12:15], s37 offen offset:1024 lds
    v_mfma_f32_16x16x32_bf16 a[192:195], v[96:99], v[152:155], a[192:195]
    v_mfma_f32_16x16x32_bf16 a[196:199], v[100:103], v[152:155], a[196:199]
    v_mfma_f32_16x16x32_bf16 a[200:203], v[104:107], v[152:155], a[200:203]
    v_mfma_f32_16x16x32_bf16 a[204:207], v[108:111], v[152:155], a[204:207]
    v_mfma_f32_16x16x32_bf16 a[208:211], v[112:115], v[152:155], a[208:211]
    v_mfma_f32_16x16x32_bf16 a[212:215], v[116:119], v[152:155], a[212:215]
    v_mfma_f32_16x16x32_bf16 a[216:219], v[120:123], v[152:155], a[216:219]
    v_mfma_f32_16x16x32_bf16 a[220:223], v[124:127], v[152:155], a[220:223]
    v_mfma_f32_16x16x32_bf16 a[224:227], v[96:99], v[156:159], a[224:227]
    v_mfma_f32_16x16x32_bf16 a[228:231], v[100:103], v[156:159], a[228:231]
    v_mfma_f32_16x16x32_bf16 a[232:235], v[104:107], v[156:159], a[232:235]
    v_mfma_f32_16x16x32_bf16 a[236:239], v[108:111], v[156:159], a[236:239]
    v_mfma_f32_16x16x32_bf16 a[240:243], v[112:115], v[156:159], a[240:243]
    v_mfma_f32_16x16x32_bf16 a[244:247], v[116:119], v[156:159], a[244:247]
    v_mfma_f32_16x16x32_bf16 a[248:251], v[120:123], v[156:159], a[248:251]
    v_mfma_f32_16x16x32_bf16 a[252:255], v[124:127], v[156:159], a[252:255]
    s_waitcnt vmcnt(16) lgkmcnt(0)
    s_barrier
    v_mfma_f32_16x16x32_bf16 a[0:3], v[64:67], v[32:35], a[0:3]
    ds_read_b64_tr_b16 v[128:129], v10 offset:16384
    v_mfma_f32_16x16x32_bf16 a[4:7], v[64:67], v[36:39], a[4:7]
    s_add_u32 s36, s35, 512
    s_and_b32 s36, s36, 1023
    s_add_u32 s36, s36, s59
    v_mfma_f32_16x16x32_bf16 a[8:11], v[64:67], v[40:43], a[8:11]
    s_add_u32 m0, s42, 36864
    ds_read_b64_tr_b16 v[130:131], v10 offset:17408
    v_mfma_f32_16x16x32_bf16 a[12:15], v[64:67], v[44:47], a[12:15]
    buffer_load_dwordx4 v2, s[4:7], s36 offen offset:0 lds
    v_mfma_f32_16x16x32_bf16 a[16:19], v[64:67], v[48:51], a[16:19]
    ds_read_b64_tr_b16 v[132:133], v11 offset:16384
    v_mfma_f32_16x16x32_bf16 a[20:23], v[64:67], v[52:55], a[20:23]
    v_mfma_f32_16x16x32_bf16 a[24:27], v[64:67], v[56:59], a[24:27]
    ds_read_b64_tr_b16 v[134:135], v11 offset:17408
    v_mfma_f32_16x16x32_bf16 a[28:31], v[64:67], v[60:63], a[28:31]
    buffer_load_dwordx4 v3, s[4:7], s36 offen offset:1024 lds
    v_mfma_f32_16x16x32_bf16 a[32:35], v[68:71], v[32:35], a[32:35]
    ds_read_b128 v[96:99], v15 offset:0
    v_mfma_f32_16x16x32_bf16 a[36:39], v[68:71], v[36:39], a[36:39]
    v_mfma_f32_16x16x32_bf16 a[40:43], v[68:71], v[40:43], a[40:43]
    ds_read_b64_tr_b16 v[136:137], v12 offset:16384
    v_mfma_f32_16x16x32_bf16 a[44:47], v[68:71], v[44:47], a[44:47]
    buffer_load_dwordx4 v4, s[4:7], s36 offen offset:2048 lds
    v_mfma_f32_16x16x32_bf16 a[48:51], v[68:71], v[48:51], a[48:51]
gated_mix__ssm_conv_h3__compressed_kv_cla__prompt_kernel_pad0:
    s_cbranch_execz gated_mix__ssm_conv_h3__compressed_kv_cla__prompt_kernel_pad4
    ds_read_b64_tr_b16 v[138:139], v12 offset:17408
    v_mfma_f32_16x16x32_bf16 a[52:55], v[68:71], v[52:55], a[52:55]
    v_mfma_f32_16x16x32_bf16 a[56:59], v[68:71], v[56:59], a[56:59]
    ds_read_b128 v[100:103], v15 offset:2048
    v_mfma_f32_16x16x32_bf16 a[60:63], v[68:71], v[60:63], a[60:63]
    buffer_load_dwordx4 v5, s[4:7], s36 offen offset:3072 lds
    v_mfma_f32_16x16x32_bf16 a[64:67], v[72:75], v[32:35], a[64:67]
    ds_read_b64_tr_b16 v[140:141], v13 offset:16384
    v_mfma_f32_16x16x32_bf16 a[68:71], v[72:75], v[36:39], a[68:71]
    s_add_u32 s37, s58, 2097152
    s_and_b32 s37, s37, 4194303
    s_add_u32 s37, s37, s39
    v_mfma_f32_16x16x32_bf16 a[72:75], v[72:75], v[40:43], a[72:75]
    s_add_u32 m0, s43, 0
    ds_read_b64_tr_b16 v[142:143], v13 offset:17408
    v_mfma_f32_16x16x32_bf16 a[76:79], v[72:75], v[44:47], a[76:79]
    buffer_load_dwordx4 v6, s[8:11], s37 offen offset:0 lds
    v_mfma_f32_16x16x32_bf16 a[80:83], v[72:75], v[48:51], a[80:83]
    ds_read_b128 v[104:107], v15 offset:4096
    v_mfma_f32_16x16x32_bf16 a[84:87], v[72:75], v[52:55], a[84:87]
    v_mfma_f32_16x16x32_bf16 a[88:91], v[72:75], v[56:59], a[88:91]
    ds_read_b64_tr_b16 v[144:145], v10 offset:18432
    v_mfma_f32_16x16x32_bf16 a[92:95], v[72:75], v[60:63], a[92:95]
    buffer_load_dwordx4 v7, s[8:11], s37 offen offset:1024 lds
    v_mfma_f32_16x16x32_bf16 a[96:99], v[76:79], v[32:35], a[96:99]
    ds_read_b64_tr_b16 v[146:147], v10 offset:19456
    v_mfma_f32_16x16x32_bf16 a[100:103], v[76:79], v[36:39], a[100:103]
    v_mfma_f32_16x16x32_bf16 a[104:107], v[76:79], v[40:43], a[104:107]
    s_add_u32 m0, s43, 2048
    ds_read_b128 v[108:111], v15 offset:6144
    v_mfma_f32_16x16x32_bf16 a[108:111], v[76:79], v[44:47], a[108:111]
    buffer_load_dwordx4 v6, s[12:15], s37 offen offset:0 lds
    v_mfma_f32_16x16x32_bf16 a[112:115], v[76:79], v[48:51], a[112:115]
    ds_read_b64_tr_b16 v[148:149], v11 offset:18432
    v_mfma_f32_16x16x32_bf16 a[116:119], v[76:79], v[52:55], a[116:119]
    v_mfma_f32_16x16x32_bf16 a[120:123], v[76:79], v[56:59], a[120:123]
    ds_read_b64_tr_b16 v[150:151], v11 offset:19456
    v_mfma_f32_16x16x32_bf16 a[124:127], v[76:79], v[60:63], a[124:127]
    buffer_load_dwordx4 v7, s[12:15], s37 offen offset:1024 lds
    v_mfma_f32_16x16x32_bf16 a[128:131], v[32:35], v[80:83], a[128:131]
    ds_read_b128 v[112:115], v15 offset:8192
    v_mfma_f32_16x16x32_bf16 a[132:135], v[36:39], v[80:83], a[132:135]
    buffer_load_dwordx2 v[160:161], v1, s[16:19], 0 offen offset:0
    v_mfma_f32_16x16x32_bf16 a[136:139], v[40:43], v[80:83], a[136:139]
    ds_read_b64_tr_b16 v[152:153], v12 offset:18432
    v_mfma_f32_16x16x32_bf16 a[140:143], v[44:47], v[80:83], a[140:143]
    buffer_load_dwordx2 v[162:163], v1, s[16:19], 0 offen offset:2048
    v_mfma_f32_16x16x32_bf16 a[144:147], v[48:51], v[80:83], a[144:147]
    ds_read_b64_tr_b16 v[154:155], v12 offset:19456
    v_mfma_f32_16x16x32_bf16 a[148:151], v[52:55], v[80:83], a[148:151]
    buffer_load_dwordx2 v[164:165], v1, s[16:19], s47 offen offset:0
    v_mfma_f32_16x16x32_bf16 a[152:155], v[56:59], v[80:83], a[152:155]
    ds_read_b128 v[116:119], v15 offset:10240
    v_mfma_f32_16x16x32_bf16 a[156:159], v[60:63], v[80:83], a[156:159]
    buffer_load_dwordx2 v[166:167], v0, s[16:19], 0 offen offset:0
    v_mfma_f32_16x16x32_bf16 a[160:163], v[32:35], v[84:87], a[160:163]
    ds_read_b64_tr_b16 v[156:157], v13 offset:18432
    v_mfma_f32_16x16x32_bf16 a[164:167], v[36:39], v[84:87], a[164:167]
    buffer_load_dwordx2 v[168:169], v0, s[16:19], 0 offen offset:2048
    v_mfma_f32_16x16x32_bf16 a[168:171], v[40:43], v[84:87], a[168:171]
    ds_read_b64_tr_b16 v[158:159], v13 offset:19456
    v_mfma_f32_16x16x32_bf16 a[172:175], v[44:47], v[84:87], a[172:175]
    buffer_load_dwordx2 v[170:171], v0, s[16:19], s47 offen offset:0
    v_mfma_f32_16x16x32_bf16 a[176:179], v[48:51], v[84:87], a[176:179]
    ds_read_b128 v[120:123], v15 offset:12288
    v_mfma_f32_16x16x32_bf16 a[180:183], v[52:55], v[84:87], a[180:183]
    buffer_load_dwordx2 v[172:173], v0, s[16:19], s47 offen offset:2048
    v_mfma_f32_16x16x32_bf16 a[184:187], v[56:59], v[84:87], a[184:187]
    ds_read_b128 v[124:127], v15 offset:14336
    v_mfma_f32_16x16x32_bf16 a[188:191], v[60:63], v[84:87], a[188:191]
    buffer_load_dwordx2 v[174:175], v0, s[16:19], s48 offen offset:0
    v_mfma_f32_16x16x32_bf16 a[192:195], v[32:35], v[88:91], a[192:195]
    buffer_load_dwordx2 v[176:177], v0, s[16:19], s48 offen offset:2048
    v_mfma_f32_16x16x32_bf16 a[196:199], v[36:39], v[88:91], a[196:199]
    buffer_load_dwordx2 v[178:179], v0, s[16:19], s51 offen offset:0
    v_mfma_f32_16x16x32_bf16 a[200:203], v[40:43], v[88:91], a[200:203]
    buffer_load_dwordx2 v[180:181], v0, s[16:19], s51 offen offset:2048
    v_mfma_f32_16x16x32_bf16 a[204:207], v[44:47], v[88:91], a[204:207]
    buffer_load_dwordx2 v[182:183], v0, s[76:79], 0 offen offset:0
    v_mfma_f32_16x16x32_bf16 a[208:211], v[48:51], v[88:91], a[208:211]
    buffer_load_dwordx2 v[184:185], v0, s[76:79], 0 offen offset:2048
    v_mfma_f32_16x16x32_bf16 a[212:215], v[52:55], v[88:91], a[212:215]
    buffer_load_dwordx2 v[186:187], v0, s[76:79], s47 offen offset:0
    v_mfma_f32_16x16x32_bf16 a[216:219], v[56:59], v[88:91], a[216:219]
    buffer_load_dwordx2 v[188:189], v0, s[76:79], s47 offen offset:2048
    v_mfma_f32_16x16x32_bf16 a[220:223], v[60:63], v[88:91], a[220:223]
    buffer_load_dwordx2 v[190:191], v0, s[76:79], s48 offen offset:0
    v_mfma_f32_16x16x32_bf16 a[224:227], v[32:35], v[92:95], a[224:227]
    buffer_load_dwordx2 v[192:193], v0, s[76:79], s48 offen offset:2048
    v_mfma_f32_16x16x32_bf16 a[228:231], v[36:39], v[92:95], a[228:231]
    buffer_load_dwordx2 v[194:195], v0, s[76:79], s51 offen offset:0
    v_mfma_f32_16x16x32_bf16 a[232:235], v[40:43], v[92:95], a[232:235]
    buffer_load_dwordx2 v[196:197], v0, s[76:79], s51 offen offset:2048
    v_mfma_f32_16x16x32_bf16 a[236:239], v[44:47], v[92:95], a[236:239]
    v_mfma_f32_16x16x32_bf16 a[240:243], v[48:51], v[92:95], a[240:243]
    v_mfma_f32_16x16x32_bf16 a[244:247], v[52:55], v[92:95], a[244:247]
    v_mfma_f32_16x16x32_bf16 a[248:251], v[56:59], v[92:95], a[248:251]
    v_mfma_f32_16x16x32_bf16 a[252:255], v[60:63], v[92:95], a[252:255]
    s_waitcnt vmcnt(35) lgkmcnt(0)
    s_barrier
    v_mfma_f32_16x16x32_bf16 a[0:3], v[128:131], v[96:99], a[0:3]
    s_mov_b32 s16, s88
    ds_read_b64_tr_b16 v[64:65], v10 offset:32768
    v_mfma_f32_16x16x32_bf16 a[4:7], v[128:131], v[100:103], a[4:7]
    s_add_u32 s36, s35, 640
    s_and_b32 s36, s36, 1023
    s_add_u32 s36, s36, s38
    v_mfma_f32_16x16x32_bf16 a[8:11], v[128:131], v[104:107], a[8:11]
    s_add_u32 m0, s42, 65536
    ds_read_b64_tr_b16 v[66:67], v10 offset:33792
    v_mfma_f32_16x16x32_bf16 a[12:15], v[128:131], v[108:111], a[12:15]
    buffer_load_dwordx4 v2, s[4:7], s36 offen offset:0 lds
    v_mfma_f32_16x16x32_bf16 a[16:19], v[128:131], v[112:115], a[16:19]
    s_mov_b32 s17, s89
    ds_read_b64_tr_b16 v[68:69], v11 offset:32768
    v_mfma_f32_16x16x32_bf16 a[20:23], v[128:131], v[116:119], a[20:23]
    s_mov_b32 s18, 2048
    v_mfma_f32_16x16x32_bf16 a[24:27], v[128:131], v[120:123], a[24:27]
    s_mov_b32 s76, s70
    ds_read_b64_tr_b16 v[70:71], v11 offset:33792
    v_mfma_f32_16x16x32_bf16 a[28:31], v[128:131], v[124:127], a[28:31]
    buffer_load_dwordx4 v3, s[4:7], s36 offen offset:1024 lds
    v_mfma_f32_16x16x32_bf16 a[32:35], v[132:135], v[96:99], a[32:35]
    s_mov_b32 s77, s71
    ds_read_b128 v[32:35], v8 offset:0
    v_mfma_f32_16x16x32_bf16 a[36:39], v[132:135], v[100:103], a[36:39]
    s_mov_b32 s78, 8192
    v_mfma_f32_16x16x32_bf16 a[40:43], v[132:135], v[104:107], a[40:43]
    ds_read_b64_tr_b16 v[72:73], v12 offset:32768
    v_mfma_f32_16x16x32_bf16 a[44:47], v[132:135], v[108:111], a[44:47]
    buffer_load_dwordx4 v4, s[4:7], s36 offen offset:2048 lds
    v_mfma_f32_16x16x32_bf16 a[48:51], v[132:135], v[112:115], a[48:51]
    ds_read_b64_tr_b16 v[74:75], v12 offset:33792
    v_mfma_f32_16x16x32_bf16 a[52:55], v[132:135], v[116:119], a[52:55]
    v_mfma_f32_16x16x32_bf16 a[56:59], v[132:135], v[120:123], a[56:59]
    ds_read_b128 v[36:39], v8 offset:2048
    v_mfma_f32_16x16x32_bf16 a[60:63], v[132:135], v[124:127], a[60:63]
    buffer_load_dwordx4 v5, s[4:7], s36 offen offset:3072 lds
    v_mfma_f32_16x16x32_bf16 a[64:67], v[136:139], v[96:99], a[64:67]
    ds_read_b64_tr_b16 v[76:77], v13 offset:32768
    v_mfma_f32_16x16x32_bf16 a[68:71], v[136:139], v[100:103], a[68:71]
    s_add_u32 s37, s58, 2359296
    s_and_b32 s37, s37, 4194303
    s_add_u32 s37, s37, s39
    v_mfma_f32_16x16x32_bf16 a[72:75], v[136:139], v[104:107], a[72:75]
    s_add_u32 m0, s43, 16384
    ds_read_b64_tr_b16 v[78:79], v13 offset:33792
    v_mfma_f32_16x16x32_bf16 a[76:79], v[136:139], v[108:111], a[76:79]
    buffer_load_dwordx4 v6, s[8:11], s37 offen offset:0 lds
    v_mfma_f32_16x16x32_bf16 a[80:83], v[136:139], v[112:115], a[80:83]
    ds_read_b128 v[40:43], v8 offset:4096
    v_mfma_f32_16x16x32_bf16 a[84:87], v[136:139], v[116:119], a[84:87]
    v_mfma_f32_16x16x32_bf16 a[88:91], v[136:139], v[120:123], a[88:91]
    ds_read_b64_tr_b16 v[80:81], v10 offset:34816
    v_mfma_f32_16x16x32_bf16 a[92:95], v[136:139], v[124:127], a[92:95]
    buffer_load_dwordx4 v7, s[8:11], s37 offen offset:1024 lds
    v_mfma_f32_16x16x32_bf16 a[96:99], v[140:143], v[96:99], a[96:99]
    ds_read_b64_tr_b16 v[82:83], v10 offset:35840
    v_mfma_f32_16x16x32_bf16 a[100:103], v[140:143], v[100:103], a[100:103]
    v_mfma_f32_16x16x32_bf16 a[104:107], v[140:143], v[104:107], a[104:107]
    s_add_u32 m0, s43, 18432
    ds_read_b128 v[44:47], v8 offset:6144
    v_mfma_f32_16x16x32_bf16 a[108:111], v[140:143], v[108:111], a[108:111]
    buffer_load_dwordx4 v6, s[12:15], s37 offen offset:0 lds
    v_mfma_f32_16x16x32_bf16 a[112:115], v[140:143], v[112:115], a[112:115]
    ds_read_b64_tr_b16 v[84:85], v11 offset:34816
    v_mfma_f32_16x16x32_bf16 a[116:119], v[140:143], v[116:119], a[116:119]
    v_mfma_f32_16x16x32_bf16 a[120:123], v[140:143], v[120:123], a[120:123]
    ds_read_b64_tr_b16 v[86:87], v11 offset:35840
    v_mfma_f32_16x16x32_bf16 a[124:127], v[140:143], v[124:127], a[124:127]
    buffer_load_dwordx4 v7, s[12:15], s37 offen offset:1024 lds
    v_mfma_f32_16x16x32_bf16 a[128:131], v[96:99], v[144:147], a[128:131]
    ds_read_b128 v[48:51], v8 offset:8192
    v_mfma_f32_16x16x32_bf16 a[132:135], v[100:103], v[144:147], a[132:135]
    v_mfma_f32_16x16x32_bf16 a[136:139], v[104:107], v[144:147], a[136:139]
    ds_read_b64_tr_b16 v[88:89], v12 offset:34816
    v_mfma_f32_16x16x32_bf16 a[140:143], v[108:111], v[144:147], a[140:143]
    v_mfma_f32_16x16x32_bf16 a[144:147], v[112:115], v[144:147], a[144:147]
    ds_read_b64_tr_b16 v[90:91], v12 offset:35840
    v_mfma_f32_16x16x32_bf16 a[148:151], v[116:119], v[144:147], a[148:151]
    v_mfma_f32_16x16x32_bf16 a[152:155], v[120:123], v[144:147], a[152:155]
    ds_read_b128 v[52:55], v8 offset:10240
    v_mfma_f32_16x16x32_bf16 a[156:159], v[124:127], v[144:147], a[156:159]
    v_mfma_f32_16x16x32_bf16 a[160:163], v[96:99], v[148:151], a[160:163]
    ds_read_b64_tr_b16 v[92:93], v13 offset:34816
    v_mfma_f32_16x16x32_bf16 a[164:167], v[100:103], v[148:151], a[164:167]
    v_mfma_f32_16x16x32_bf16 a[168:171], v[104:107], v[148:151], a[168:171]
    ds_read_b64_tr_b16 v[94:95], v13 offset:35840
    v_mfma_f32_16x16x32_bf16 a[172:175], v[108:111], v[148:151], a[172:175]
    v_mfma_f32_16x16x32_bf16 a[176:179], v[112:115], v[148:151], a[176:179]
    ds_read_b128 v[56:59], v8 offset:12288
    v_mfma_f32_16x16x32_bf16 a[180:183], v[116:119], v[148:151], a[180:183]
    v_mfma_f32_16x16x32_bf16 a[184:187], v[120:123], v[148:151], a[184:187]
    ds_read_b128 v[60:63], v8 offset:14336
    v_mfma_f32_16x16x32_bf16 a[188:191], v[124:127], v[148:151], a[188:191]
    v_mfma_f32_16x16x32_bf16 a[192:195], v[96:99], v[152:155], a[192:195]
    v_mfma_f32_16x16x32_bf16 a[196:199], v[100:103], v[152:155], a[196:199]
    v_mfma_f32_16x16x32_bf16 a[200:203], v[104:107], v[152:155], a[200:203]
    v_mfma_f32_16x16x32_bf16 a[204:207], v[108:111], v[152:155], a[204:207]
    v_mfma_f32_16x16x32_bf16 a[208:211], v[112:115], v[152:155], a[208:211]
    v_mfma_f32_16x16x32_bf16 a[212:215], v[116:119], v[152:155], a[212:215]
    v_mfma_f32_16x16x32_bf16 a[216:219], v[120:123], v[152:155], a[216:219]
    v_mfma_f32_16x16x32_bf16 a[220:223], v[124:127], v[152:155], a[220:223]
    v_mfma_f32_16x16x32_bf16 a[224:227], v[96:99], v[156:159], a[224:227]
    v_mfma_f32_16x16x32_bf16 a[228:231], v[100:103], v[156:159], a[228:231]
    v_mfma_f32_16x16x32_bf16 a[232:235], v[104:107], v[156:159], a[232:235]
    v_mfma_f32_16x16x32_bf16 a[236:239], v[108:111], v[156:159], a[236:239]
    v_mfma_f32_16x16x32_bf16 a[240:243], v[112:115], v[156:159], a[240:243]
    v_mfma_f32_16x16x32_bf16 a[244:247], v[116:119], v[156:159], a[244:247]
    v_mfma_f32_16x16x32_bf16 a[248:251], v[120:123], v[156:159], a[248:251]
    v_mfma_f32_16x16x32_bf16 a[252:255], v[124:127], v[156:159], a[252:255]
    s_waitcnt vmcnt(35) lgkmcnt(0)
    s_barrier
    v_mfma_f32_16x16x32_bf16 a[0:3], v[64:67], v[32:35], a[0:3]
    ds_read_b64_tr_b16 v[128:129], v10 offset:49152
    v_mfma_f32_16x16x32_bf16 a[4:7], v[64:67], v[36:39], a[4:7]
    s_add_u32 s36, s35, 640
    s_and_b32 s36, s36, 1023
    s_add_u32 s36, s36, s59
    v_mfma_f32_16x16x32_bf16 a[8:11], v[64:67], v[40:43], a[8:11]
    s_add_u32 m0, s42, 69632
    ds_read_b64_tr_b16 v[130:131], v10 offset:50176
    v_mfma_f32_16x16x32_bf16 a[12:15], v[64:67], v[44:47], a[12:15]
    buffer_load_dwordx4 v2, s[4:7], s36 offen offset:0 lds
    v_mfma_f32_16x16x32_bf16 a[16:19], v[64:67], v[48:51], a[16:19]
    ds_read_b64_tr_b16 v[132:133], v11 offset:49152
    v_mfma_f32_16x16x32_bf16 a[20:23], v[64:67], v[52:55], a[20:23]
    v_mfma_f32_16x16x32_bf16 a[24:27], v[64:67], v[56:59], a[24:27]
    ds_read_b64_tr_b16 v[134:135], v11 offset:50176
    v_mfma_f32_16x16x32_bf16 a[28:31], v[64:67], v[60:63], a[28:31]
    buffer_load_dwordx4 v3, s[4:7], s36 offen offset:1024 lds
    v_mfma_f32_16x16x32_bf16 a[32:35], v[68:71], v[32:35], a[32:35]
    ds_read_b128 v[96:99], v9 offset:0
    v_mfma_f32_16x16x32_bf16 a[36:39], v[68:71], v[36:39], a[36:39]
    v_mfma_f32_16x16x32_bf16 a[40:43], v[68:71], v[40:43], a[40:43]
    ds_read_b64_tr_b16 v[136:137], v12 offset:49152
    v_mfma_f32_16x16x32_bf16 a[44:47], v[68:71], v[44:47], a[44:47]
    buffer_load_dwordx4 v4, s[4:7], s36 offen offset:2048 lds
    v_mfma_f32_16x16x32_bf16 a[48:51], v[68:71], v[48:51], a[48:51]
    ds_read_b64_tr_b16 v[138:139], v12 offset:50176
    v_mfma_f32_16x16x32_bf16 a[52:55], v[68:71], v[52:55], a[52:55]
    v_mfma_f32_16x16x32_bf16 a[56:59], v[68:71], v[56:59], a[56:59]
    ds_read_b128 v[100:103], v9 offset:2048
    v_mfma_f32_16x16x32_bf16 a[60:63], v[68:71], v[60:63], a[60:63]
    buffer_load_dwordx4 v5, s[4:7], s36 offen offset:3072 lds
    v_mfma_f32_16x16x32_bf16 a[64:67], v[72:75], v[32:35], a[64:67]
    ds_read_b64_tr_b16 v[140:141], v13 offset:49152
    v_mfma_f32_16x16x32_bf16 a[68:71], v[72:75], v[36:39], a[68:71]
    s_add_u32 s37, s58, 2621440
    s_and_b32 s37, s37, 4194303
    s_add_u32 s37, s37, s39
    v_mfma_f32_16x16x32_bf16 a[72:75], v[72:75], v[40:43], a[72:75]
    s_add_u32 m0, s43, 32768
    ds_read_b64_tr_b16 v[142:143], v13 offset:50176
    v_mfma_f32_16x16x32_bf16 a[76:79], v[72:75], v[44:47], a[76:79]
    buffer_load_dwordx4 v6, s[8:11], s37 offen offset:0 lds
    v_mfma_f32_16x16x32_bf16 a[80:83], v[72:75], v[48:51], a[80:83]
    ds_read_b128 v[104:107], v9 offset:4096
    v_mfma_f32_16x16x32_bf16 a[84:87], v[72:75], v[52:55], a[84:87]
    v_mfma_f32_16x16x32_bf16 a[88:91], v[72:75], v[56:59], a[88:91]
    ds_read_b64_tr_b16 v[144:145], v10 offset:51200
    v_mfma_f32_16x16x32_bf16 a[92:95], v[72:75], v[60:63], a[92:95]
    buffer_load_dwordx4 v7, s[8:11], s37 offen offset:1024 lds
    v_mfma_f32_16x16x32_bf16 a[96:99], v[76:79], v[32:35], a[96:99]
    ds_read_b64_tr_b16 v[146:147], v10 offset:52224
    v_mfma_f32_16x16x32_bf16 a[100:103], v[76:79], v[36:39], a[100:103]
    v_mfma_f32_16x16x32_bf16 a[104:107], v[76:79], v[40:43], a[104:107]
    s_add_u32 m0, s43, 34816
    ds_read_b128 v[108:111], v9 offset:6144
    v_mfma_f32_16x16x32_bf16 a[108:111], v[76:79], v[44:47], a[108:111]
    buffer_load_dwordx4 v6, s[12:15], s37 offen offset:0 lds
    v_mfma_f32_16x16x32_bf16 a[112:115], v[76:79], v[48:51], a[112:115]
    ds_read_b64_tr_b16 v[148:149], v11 offset:51200
    v_mfma_f32_16x16x32_bf16 a[116:119], v[76:79], v[52:55], a[116:119]
    v_mfma_f32_16x16x32_bf16 a[120:123], v[76:79], v[56:59], a[120:123]
    ds_read_b64_tr_b16 v[150:151], v11 offset:52224
    v_mfma_f32_16x16x32_bf16 a[124:127], v[76:79], v[60:63], a[124:127]
    buffer_load_dwordx4 v7, s[12:15], s37 offen offset:1024 lds
    v_mfma_f32_16x16x32_bf16 a[128:131], v[32:35], v[80:83], a[128:131]
    ds_read_b128 v[112:115], v9 offset:8192
    v_mfma_f32_16x16x32_bf16 a[132:135], v[36:39], v[80:83], a[132:135]
    v_mfma_f32_16x16x32_bf16 a[136:139], v[40:43], v[80:83], a[136:139]
    ds_read_b64_tr_b16 v[152:153], v12 offset:51200
    v_mfma_f32_16x16x32_bf16 a[140:143], v[44:47], v[80:83], a[140:143]
    v_mfma_f32_16x16x32_bf16 a[144:147], v[48:51], v[80:83], a[144:147]
    ds_read_b64_tr_b16 v[154:155], v12 offset:52224
    v_mfma_f32_16x16x32_bf16 a[148:151], v[52:55], v[80:83], a[148:151]
    v_mfma_f32_16x16x32_bf16 a[152:155], v[56:59], v[80:83], a[152:155]
    ds_read_b128 v[116:119], v9 offset:10240
    v_mfma_f32_16x16x32_bf16 a[156:159], v[60:63], v[80:83], a[156:159]
    v_mfma_f32_16x16x32_bf16 a[160:163], v[32:35], v[84:87], a[160:163]
    ds_read_b64_tr_b16 v[156:157], v13 offset:51200
    v_mfma_f32_16x16x32_bf16 a[164:167], v[36:39], v[84:87], a[164:167]
    v_mfma_f32_16x16x32_bf16 a[168:171], v[40:43], v[84:87], a[168:171]
    ds_read_b64_tr_b16 v[158:159], v13 offset:52224
    v_mfma_f32_16x16x32_bf16 a[172:175], v[44:47], v[84:87], a[172:175]
    v_mfma_f32_16x16x32_bf16 a[176:179], v[48:51], v[84:87], a[176:179]
    ds_read_b128 v[120:123], v9 offset:12288
    v_mfma_f32_16x16x32_bf16 a[180:183], v[52:55], v[84:87], a[180:183]
    v_mfma_f32_16x16x32_bf16 a[184:187], v[56:59], v[84:87], a[184:187]
    ds_read_b128 v[124:127], v9 offset:14336
    v_mfma_f32_16x16x32_bf16 a[188:191], v[60:63], v[84:87], a[188:191]
    v_mfma_f32_16x16x32_bf16 a[192:195], v[32:35], v[88:91], a[192:195]
    v_mfma_f32_16x16x32_bf16 a[196:199], v[36:39], v[88:91], a[196:199]
    v_mfma_f32_16x16x32_bf16 a[200:203], v[40:43], v[88:91], a[200:203]
    v_mfma_f32_16x16x32_bf16 a[204:207], v[44:47], v[88:91], a[204:207]
    v_mfma_f32_16x16x32_bf16 a[208:211], v[48:51], v[88:91], a[208:211]
    v_mfma_f32_16x16x32_bf16 a[212:215], v[52:55], v[88:91], a[212:215]
    v_mfma_f32_16x16x32_bf16 a[216:219], v[56:59], v[88:91], a[216:219]
    v_mfma_f32_16x16x32_bf16 a[220:223], v[60:63], v[88:91], a[220:223]
    v_mfma_f32_16x16x32_bf16 a[224:227], v[32:35], v[92:95], a[224:227]
    v_mfma_f32_16x16x32_bf16 a[228:231], v[36:39], v[92:95], a[228:231]
    v_mfma_f32_16x16x32_bf16 a[232:235], v[40:43], v[92:95], a[232:235]
    v_mfma_f32_16x16x32_bf16 a[236:239], v[44:47], v[92:95], a[236:239]
    v_mfma_f32_16x16x32_bf16 a[240:243], v[48:51], v[92:95], a[240:243]
    v_mfma_f32_16x16x32_bf16 a[244:247], v[52:55], v[92:95], a[244:247]
    v_mfma_f32_16x16x32_bf16 a[248:251], v[56:59], v[92:95], a[248:251]
    v_mfma_f32_16x16x32_bf16 a[252:255], v[60:63], v[92:95], a[252:255]
    s_waitcnt vmcnt(35) lgkmcnt(0)
    s_barrier
    v_mfma_f32_16x16x32_bf16 a[0:3], v[128:131], v[96:99], a[0:3]
    ds_read_b64_tr_b16 v[64:65], v10 offset:0
    v_mfma_f32_16x16x32_bf16 a[4:7], v[128:131], v[100:103], a[4:7]
    s_add_u32 s36, s35, 768
    s_and_b32 s36, s36, 1023
    s_add_u32 s36, s36, s38
    v_mfma_f32_16x16x32_bf16 a[8:11], v[128:131], v[104:107], a[8:11]
    s_add_u32 m0, s42, 0
    ds_read_b64_tr_b16 v[66:67], v10 offset:1024
    v_mfma_f32_16x16x32_bf16 a[12:15], v[128:131], v[108:111], a[12:15]
    buffer_load_dwordx4 v2, s[4:7], s36 offen offset:0 lds
    v_mfma_f32_16x16x32_bf16 a[16:19], v[128:131], v[112:115], a[16:19]
    ds_read_b64_tr_b16 v[68:69], v11 offset:0
    v_mfma_f32_16x16x32_bf16 a[20:23], v[128:131], v[116:119], a[20:23]
    v_mfma_f32_16x16x32_bf16 a[24:27], v[128:131], v[120:123], a[24:27]
    ds_read_b64_tr_b16 v[70:71], v11 offset:1024
    v_mfma_f32_16x16x32_bf16 a[28:31], v[128:131], v[124:127], a[28:31]
    buffer_load_dwordx4 v3, s[4:7], s36 offen offset:1024 lds
    v_mfma_f32_16x16x32_bf16 a[32:35], v[132:135], v[96:99], a[32:35]
    ds_read_b128 v[32:35], v8 offset:32768
    v_mfma_f32_16x16x32_bf16 a[36:39], v[132:135], v[100:103], a[36:39]
    v_mfma_f32_16x16x32_bf16 a[40:43], v[132:135], v[104:107], a[40:43]
    ds_read_b64_tr_b16 v[72:73], v12 offset:0
    v_mfma_f32_16x16x32_bf16 a[44:47], v[132:135], v[108:111], a[44:47]
    buffer_load_dwordx4 v4, s[4:7], s36 offen offset:2048 lds
    v_mfma_f32_16x16x32_bf16 a[48:51], v[132:135], v[112:115], a[48:51]
    ds_read_b64_tr_b16 v[74:75], v12 offset:1024
    v_mfma_f32_16x16x32_bf16 a[52:55], v[132:135], v[116:119], a[52:55]
    v_mfma_f32_16x16x32_bf16 a[56:59], v[132:135], v[120:123], a[56:59]
    ds_read_b128 v[36:39], v8 offset:34816
    v_mfma_f32_16x16x32_bf16 a[60:63], v[132:135], v[124:127], a[60:63]
    buffer_load_dwordx4 v5, s[4:7], s36 offen offset:3072 lds
    v_mfma_f32_16x16x32_bf16 a[64:67], v[136:139], v[96:99], a[64:67]
    ds_read_b64_tr_b16 v[76:77], v13 offset:0
    v_mfma_f32_16x16x32_bf16 a[68:71], v[136:139], v[100:103], a[68:71]
    s_add_u32 s37, s58, 2883584
    s_and_b32 s37, s37, 4194303
    s_add_u32 s37, s37, s39
    v_mfma_f32_16x16x32_bf16 a[72:75], v[136:139], v[104:107], a[72:75]
    s_add_u32 m0, s43, 49152
    ds_read_b64_tr_b16 v[78:79], v13 offset:1024
    v_mfma_f32_16x16x32_bf16 a[76:79], v[136:139], v[108:111], a[76:79]
    buffer_load_dwordx4 v6, s[8:11], s37 offen offset:0 lds
    v_mfma_f32_16x16x32_bf16 a[80:83], v[136:139], v[112:115], a[80:83]
    ds_read_b128 v[40:43], v8 offset:36864
    v_mfma_f32_16x16x32_bf16 a[84:87], v[136:139], v[116:119], a[84:87]
    v_mfma_f32_16x16x32_bf16 a[88:91], v[136:139], v[120:123], a[88:91]
    ds_read_b64_tr_b16 v[80:81], v10 offset:2048
    v_mfma_f32_16x16x32_bf16 a[92:95], v[136:139], v[124:127], a[92:95]
    buffer_load_dwordx4 v7, s[8:11], s37 offen offset:1024 lds
    v_mfma_f32_16x16x32_bf16 a[96:99], v[140:143], v[96:99], a[96:99]
    ds_read_b64_tr_b16 v[82:83], v10 offset:3072
    v_mfma_f32_16x16x32_bf16 a[100:103], v[140:143], v[100:103], a[100:103]
    v_mfma_f32_16x16x32_bf16 a[104:107], v[140:143], v[104:107], a[104:107]
    s_add_u32 m0, s43, 51200
    ds_read_b128 v[44:47], v8 offset:38912
    v_mfma_f32_16x16x32_bf16 a[108:111], v[140:143], v[108:111], a[108:111]
    buffer_load_dwordx4 v6, s[12:15], s37 offen offset:0 lds
    v_mfma_f32_16x16x32_bf16 a[112:115], v[140:143], v[112:115], a[112:115]
    ds_read_b64_tr_b16 v[84:85], v11 offset:2048
    v_mfma_f32_16x16x32_bf16 a[116:119], v[140:143], v[116:119], a[116:119]
    v_mfma_f32_16x16x32_bf16 a[120:123], v[140:143], v[120:123], a[120:123]
    ds_read_b64_tr_b16 v[86:87], v11 offset:3072
    v_mfma_f32_16x16x32_bf16 a[124:127], v[140:143], v[124:127], a[124:127]
    buffer_load_dwordx4 v7, s[12:15], s37 offen offset:1024 lds
    v_mfma_f32_16x16x32_bf16 a[128:131], v[96:99], v[144:147], a[128:131]
    ds_read_b128 v[48:51], v8 offset:40960
    v_mfma_f32_16x16x32_bf16 a[132:135], v[100:103], v[144:147], a[132:135]
    buffer_load_dwordx4 v[206:209], v233, s[24:27], s40 offen offset:0
    v_mfma_f32_16x16x32_bf16 a[136:139], v[104:107], v[144:147], a[136:139]
    ds_read_b64_tr_b16 v[88:89], v12 offset:2048
    v_mfma_f32_16x16x32_bf16 a[140:143], v[108:111], v[144:147], a[140:143]
    buffer_load_dwordx4 v[210:213], v233, s[24:27], s40 offen offset:1024
    v_mfma_f32_16x16x32_bf16 a[144:147], v[112:115], v[144:147], a[144:147]
    ds_read_b64_tr_b16 v[90:91], v12 offset:3072
    v_mfma_f32_16x16x32_bf16 a[148:151], v[116:119], v[144:147], a[148:151]
    buffer_load_dwordx4 v[214:217], v233, s[24:27], s41 offen offset:0
    v_mfma_f32_16x16x32_bf16 a[152:155], v[120:123], v[144:147], a[152:155]
    ds_read_b128 v[52:55], v8 offset:43008
    v_mfma_f32_16x16x32_bf16 a[156:159], v[124:127], v[144:147], a[156:159]
    buffer_load_dwordx4 v[218:221], v233, s[24:27], s41 offen offset:1024
    v_mfma_f32_16x16x32_bf16 a[160:163], v[96:99], v[148:151], a[160:163]
    ds_read_b64_tr_b16 v[92:93], v13 offset:2048
    v_mfma_f32_16x16x32_bf16 a[164:167], v[100:103], v[148:151], a[164:167]
    buffer_load_dwordx4 v[222:225], v233, s[16:19], 0 offen offset:0
    v_mfma_f32_16x16x32_bf16 a[168:171], v[104:107], v[148:151], a[168:171]
    ds_read_b64_tr_b16 v[94:95], v13 offset:3072
    v_mfma_f32_16x16x32_bf16 a[172:175], v[108:111], v[148:151], a[172:175]
    buffer_load_dwordx4 v[226:229], v233, s[16:19], 0 offen offset:1024
    v_mfma_f32_16x16x32_bf16 a[176:179], v[112:115], v[148:151], a[176:179]
    ds_read_b128 v[56:59], v8 offset:45056
    v_mfma_f32_16x16x32_bf16 a[180:183], v[116:119], v[148:151], a[180:183]
    buffer_load_dwordx4 v[198:201], v232, s[76:79], 0 offen offset:0
    v_mfma_f32_16x16x32_bf16 a[184:187], v[120:123], v[148:151], a[184:187]
    ds_read_b128 v[60:63], v8 offset:47104
    v_mfma_f32_16x16x32_bf16 a[188:191], v[124:127], v[148:151], a[188:191]
    buffer_load_dwordx4 v[202:205], v232, s[76:79], 0 offen offset:16
    v_mfma_f32_16x16x32_bf16 a[192:195], v[96:99], v[152:155], a[192:195]
    buffer_store_dword v241, v241, s[28:31], s55 offen sc1
    v_mfma_f32_16x16x32_bf16 a[196:199], v[100:103], v[152:155], a[196:199]
    buffer_store_dword v241, v241, s[28:31], s56 offen sc1
    v_mfma_f32_16x16x32_bf16 a[200:203], v[104:107], v[152:155], a[200:203]
    buffer_store_dword v241, v241, s[28:31], s57 offen sc1
    v_mfma_f32_16x16x32_bf16 a[204:207], v[108:111], v[152:155], a[204:207]
    buffer_store_dword v241, v241, s[28:31], s3 offen sc1
    v_mfma_f32_16x16x32_bf16 a[208:211], v[112:115], v[152:155], a[208:211]
    v_mfma_f32_16x16x32_bf16 a[212:215], v[116:119], v[152:155], a[212:215]
    v_mfma_f32_16x16x32_bf16 a[216:219], v[120:123], v[152:155], a[216:219]
    v_mfma_f32_16x16x32_bf16 a[220:223], v[124:127], v[152:155], a[220:223]
    v_mfma_f32_16x16x32_bf16 a[224:227], v[96:99], v[156:159], a[224:227]
    v_mfma_f32_16x16x32_bf16 a[228:231], v[100:103], v[156:159], a[228:231]
    v_mfma_f32_16x16x32_bf16 a[232:235], v[104:107], v[156:159], a[232:235]
    v_mfma_f32_16x16x32_bf16 a[236:239], v[108:111], v[156:159], a[236:239]
    v_mfma_f32_16x16x32_bf16 a[240:243], v[112:115], v[156:159], a[240:243]
    v_mfma_f32_16x16x32_bf16 a[244:247], v[116:119], v[156:159], a[244:247]
    v_mfma_f32_16x16x32_bf16 a[248:251], v[120:123], v[156:159], a[248:251]
    v_mfma_f32_16x16x32_bf16 a[252:255], v[124:127], v[156:159], a[252:255]
    s_waitcnt vmcnt(28) lgkmcnt(0)
    s_barrier
    v_mfma_f32_16x16x32_bf16 a[0:3], v[64:67], v[32:35], a[0:3]
    ds_read_b64_tr_b16 v[128:129], v10 offset:16384
    v_mfma_f32_16x16x32_bf16 a[4:7], v[64:67], v[36:39], a[4:7]
    s_add_u32 s36, s35, 768
    s_and_b32 s36, s36, 1023
    s_add_u32 s36, s36, s59
    v_mfma_f32_16x16x32_bf16 a[8:11], v[64:67], v[40:43], a[8:11]
    s_add_u32 m0, s42, 4096
    ds_read_b64_tr_b16 v[130:131], v10 offset:17408
    v_mfma_f32_16x16x32_bf16 a[12:15], v[64:67], v[44:47], a[12:15]
    buffer_load_dwordx4 v2, s[4:7], s36 offen offset:0 lds
    v_mfma_f32_16x16x32_bf16 a[16:19], v[64:67], v[48:51], a[16:19]
    ds_read_b64_tr_b16 v[132:133], v11 offset:16384
    v_mfma_f32_16x16x32_bf16 a[20:23], v[64:67], v[52:55], a[20:23]
    v_mfma_f32_16x16x32_bf16 a[24:27], v[64:67], v[56:59], a[24:27]
    ds_read_b64_tr_b16 v[134:135], v11 offset:17408
    v_mfma_f32_16x16x32_bf16 a[28:31], v[64:67], v[60:63], a[28:31]
    buffer_load_dwordx4 v3, s[4:7], s36 offen offset:1024 lds
    v_mfma_f32_16x16x32_bf16 a[32:35], v[68:71], v[32:35], a[32:35]
    ds_read_b128 v[96:99], v9 offset:32768
    v_mfma_f32_16x16x32_bf16 a[36:39], v[68:71], v[36:39], a[36:39]
    v_mfma_f32_16x16x32_bf16 a[40:43], v[68:71], v[40:43], a[40:43]
    ds_read_b64_tr_b16 v[136:137], v12 offset:16384
    v_mfma_f32_16x16x32_bf16 a[44:47], v[68:71], v[44:47], a[44:47]
    buffer_load_dwordx4 v4, s[4:7], s36 offen offset:2048 lds
    v_mfma_f32_16x16x32_bf16 a[48:51], v[68:71], v[48:51], a[48:51]
    ds_read_b64_tr_b16 v[138:139], v12 offset:17408
    v_mfma_f32_16x16x32_bf16 a[52:55], v[68:71], v[52:55], a[52:55]
    v_mfma_f32_16x16x32_bf16 a[56:59], v[68:71], v[56:59], a[56:59]
    ds_read_b128 v[100:103], v9 offset:34816
    v_mfma_f32_16x16x32_bf16 a[60:63], v[68:71], v[60:63], a[60:63]
    buffer_load_dwordx4 v5, s[4:7], s36 offen offset:3072 lds
    v_mfma_f32_16x16x32_bf16 a[64:67], v[72:75], v[32:35], a[64:67]
    ds_read_b64_tr_b16 v[140:141], v13 offset:16384
    v_mfma_f32_16x16x32_bf16 a[68:71], v[72:75], v[36:39], a[68:71]
    s_add_u32 s37, s58, 3145728
    s_and_b32 s37, s37, 4194303
    s_add_u32 s37, s37, s39
    v_mfma_f32_16x16x32_bf16 a[72:75], v[72:75], v[40:43], a[72:75]
    s_add_u32 m0, s43, 0
    ds_read_b64_tr_b16 v[142:143], v13 offset:17408
    v_mfma_f32_16x16x32_bf16 a[76:79], v[72:75], v[44:47], a[76:79]
    buffer_load_dwordx4 v6, s[8:11], s37 offen offset:0 lds
    v_mfma_f32_16x16x32_bf16 a[80:83], v[72:75], v[48:51], a[80:83]
    ds_read_b128 v[104:107], v9 offset:36864
    v_mfma_f32_16x16x32_bf16 a[84:87], v[72:75], v[52:55], a[84:87]
    v_mfma_f32_16x16x32_bf16 a[88:91], v[72:75], v[56:59], a[88:91]
    ds_read_b64_tr_b16 v[144:145], v10 offset:18432
    v_mfma_f32_16x16x32_bf16 a[92:95], v[72:75], v[60:63], a[92:95]
    buffer_load_dwordx4 v7, s[8:11], s37 offen offset:1024 lds
    v_mfma_f32_16x16x32_bf16 a[96:99], v[76:79], v[32:35], a[96:99]
    ds_read_b64_tr_b16 v[146:147], v10 offset:19456
    v_mfma_f32_16x16x32_bf16 a[100:103], v[76:79], v[36:39], a[100:103]
    v_mfma_f32_16x16x32_bf16 a[104:107], v[76:79], v[40:43], a[104:107]
    s_add_u32 m0, s43, 2048
    ds_read_b128 v[108:111], v9 offset:38912
    v_mfma_f32_16x16x32_bf16 a[108:111], v[76:79], v[44:47], a[108:111]
    buffer_load_dwordx4 v6, s[12:15], s37 offen offset:0 lds
    v_mfma_f32_16x16x32_bf16 a[112:115], v[76:79], v[48:51], a[112:115]
    ds_read_b64_tr_b16 v[148:149], v11 offset:18432
    v_mfma_f32_16x16x32_bf16 a[116:119], v[76:79], v[52:55], a[116:119]
    v_mfma_f32_16x16x32_bf16 a[120:123], v[76:79], v[56:59], a[120:123]
    ds_read_b64_tr_b16 v[150:151], v11 offset:19456
    v_mfma_f32_16x16x32_bf16 a[124:127], v[76:79], v[60:63], a[124:127]
    buffer_load_dwordx4 v7, s[12:15], s37 offen offset:1024 lds
    v_mfma_f32_16x16x32_bf16 a[128:131], v[32:35], v[80:83], a[128:131]
    ds_read_b128 v[112:115], v9 offset:40960
    v_mfma_f32_16x16x32_bf16 a[132:135], v[36:39], v[80:83], a[132:135]
    v_mfma_f32_16x16x32_bf16 a[136:139], v[40:43], v[80:83], a[136:139]
    ds_read_b64_tr_b16 v[152:153], v12 offset:18432
    v_mfma_f32_16x16x32_bf16 a[140:143], v[44:47], v[80:83], a[140:143]
    v_mfma_f32_16x16x32_bf16 a[144:147], v[48:51], v[80:83], a[144:147]
    ds_read_b64_tr_b16 v[154:155], v12 offset:19456
    v_mfma_f32_16x16x32_bf16 a[148:151], v[52:55], v[80:83], a[148:151]
    v_mfma_f32_16x16x32_bf16 a[152:155], v[56:59], v[80:83], a[152:155]
    ds_read_b128 v[116:119], v9 offset:43008
    v_mfma_f32_16x16x32_bf16 a[156:159], v[60:63], v[80:83], a[156:159]
    v_mfma_f32_16x16x32_bf16 a[160:163], v[32:35], v[84:87], a[160:163]
    ds_read_b64_tr_b16 v[156:157], v13 offset:18432
    v_mfma_f32_16x16x32_bf16 a[164:167], v[36:39], v[84:87], a[164:167]
    v_mfma_f32_16x16x32_bf16 a[168:171], v[40:43], v[84:87], a[168:171]
    ds_read_b64_tr_b16 v[158:159], v13 offset:19456
    v_mfma_f32_16x16x32_bf16 a[172:175], v[44:47], v[84:87], a[172:175]
    v_mfma_f32_16x16x32_bf16 a[176:179], v[48:51], v[84:87], a[176:179]
    ds_read_b128 v[120:123], v9 offset:45056
    v_mfma_f32_16x16x32_bf16 a[180:183], v[52:55], v[84:87], a[180:183]
gated_mix__ssm_conv_h3__compressed_kv_cla__prompt_kernel_pad1:
    s_cbranch_execz gated_mix__ssm_conv_h3__compressed_kv_cla__prompt_kernel_pad5
    v_mfma_f32_16x16x32_bf16 a[184:187], v[56:59], v[84:87], a[184:187]
    ds_read_b128 v[124:127], v9 offset:47104
    v_mfma_f32_16x16x32_bf16 a[188:191], v[60:63], v[84:87], a[188:191]
    v_mfma_f32_16x16x32_bf16 a[192:195], v[32:35], v[88:91], a[192:195]
    v_mfma_f32_16x16x32_bf16 a[196:199], v[36:39], v[88:91], a[196:199]
    v_mfma_f32_16x16x32_bf16 a[200:203], v[40:43], v[88:91], a[200:203]
    v_mfma_f32_16x16x32_bf16 a[204:207], v[44:47], v[88:91], a[204:207]
    v_mfma_f32_16x16x32_bf16 a[208:211], v[48:51], v[88:91], a[208:211]
    v_mfma_f32_16x16x32_bf16 a[212:215], v[52:55], v[88:91], a[212:215]
    v_mfma_f32_16x16x32_bf16 a[216:219], v[56:59], v[88:91], a[216:219]
    v_mfma_f32_16x16x32_bf16 a[220:223], v[60:63], v[88:91], a[220:223]
    v_mfma_f32_16x16x32_bf16 a[224:227], v[32:35], v[92:95], a[224:227]
    v_mfma_f32_16x16x32_bf16 a[228:231], v[36:39], v[92:95], a[228:231]
    v_mfma_f32_16x16x32_bf16 a[232:235], v[40:43], v[92:95], a[232:235]
    v_mfma_f32_16x16x32_bf16 a[236:239], v[44:47], v[92:95], a[236:239]
    v_mfma_f32_16x16x32_bf16 a[240:243], v[48:51], v[92:95], a[240:243]
    v_mfma_f32_16x16x32_bf16 a[244:247], v[52:55], v[92:95], a[244:247]
    v_mfma_f32_16x16x32_bf16 a[248:251], v[56:59], v[92:95], a[248:251]
    v_mfma_f32_16x16x32_bf16 a[252:255], v[60:63], v[92:95], a[252:255]
    s_waitcnt vmcnt(28) lgkmcnt(0)
    s_barrier
    v_mfma_f32_16x16x32_bf16 a[0:3], v[128:131], v[96:99], a[0:3]
    s_mov_b32 s76, s92
    ds_read_b64_tr_b16 v[64:65], v10 offset:32768
    v_mfma_f32_16x16x32_bf16 a[4:7], v[128:131], v[100:103], a[4:7]
    s_add_u32 s36, s35, 896
    s_and_b32 s36, s36, 1023
    s_add_u32 s36, s36, s38
    v_mfma_f32_16x16x32_bf16 a[8:11], v[128:131], v[104:107], a[8:11]
    s_add_u32 m0, s42, 32768
    ds_read_b64_tr_b16 v[66:67], v10 offset:33792
    v_mfma_f32_16x16x32_bf16 a[12:15], v[128:131], v[108:111], a[12:15]
    buffer_load_dwordx4 v2, s[4:7], s36 offen offset:0 lds
    v_mfma_f32_16x16x32_bf16 a[16:19], v[128:131], v[112:115], a[16:19]
    s_mov_b32 s77, s93
    ds_read_b64_tr_b16 v[68:69], v11 offset:32768
    v_mfma_f32_16x16x32_bf16 a[20:23], v[128:131], v[116:119], a[20:23]
    s_mov_b32 s78, 256
    v_mfma_f32_16x16x32_bf16 a[24:27], v[128:131], v[120:123], a[24:27]
    s_mov_b32 s79, 0x00020000
    ds_read_b64_tr_b16 v[70:71], v11 offset:33792
    v_mfma_f32_16x16x32_bf16 a[28:31], v[128:131], v[124:127], a[28:31]
    buffer_load_dwordx4 v3, s[4:7], s36 offen offset:1024 lds
    v_mfma_f32_16x16x32_bf16 a[32:35], v[132:135], v[96:99], a[32:35]
    s_getreg_b32 s88, hwreg(HW_REG_XCC_ID, 0, 3)
    ds_read_b128 v[32:35], v14 offset:0
    v_mfma_f32_16x16x32_bf16 a[36:39], v[132:135], v[100:103], a[36:39]
    s_lshl_b32 s88, s88, 2
    v_mfma_f32_16x16x32_bf16 a[40:43], v[132:135], v[104:107], a[40:43]
    s_lshl_b32 s88, 1, s88
    ds_read_b64_tr_b16 v[72:73], v12 offset:32768
    v_mfma_f32_16x16x32_bf16 a[44:47], v[132:135], v[108:111], a[44:47]
    buffer_load_dwordx4 v4, s[4:7], s36 offen offset:2048 lds
    v_mfma_f32_16x16x32_bf16 a[48:51], v[132:135], v[112:115], a[48:51]
    ds_read_b64_tr_b16 v[74:75], v12 offset:33792
    v_or_b32 v242, s32, v16
    v_mfma_f32_16x16x32_bf16 a[52:55], v[132:135], v[116:119], a[52:55]
    v_mov_b32 v243, 0x80000000
    v_cmp_eq_u32 vcc, 0, v242
    v_mfma_f32_16x16x32_bf16 a[56:59], v[132:135], v[120:123], a[56:59]
    ds_read_b128 v[36:39], v14 offset:2048
    v_mov_b32 v241, s88
    v_mfma_f32_16x16x32_bf16 a[60:63], v[132:135], v[124:127], a[60:63]
    buffer_load_dwordx4 v5, s[4:7], s36 offen offset:3072 lds
    v_mfma_f32_16x16x32_bf16 a[64:67], v[136:139], v[96:99], a[64:67]
    s_lshl_b32 s88, s33, 3
    ds_read_b64_tr_b16 v[76:77], v13 offset:32768
    v_mfma_f32_16x16x32_bf16 a[68:71], v[136:139], v[100:103], a[68:71]
    s_add_u32 s37, s58, 3407872
    s_and_b32 s37, s37, 4194303
    s_add_u32 s37, s37, s39
    v_mfma_f32_16x16x32_bf16 a[72:75], v[136:139], v[104:107], a[72:75]
    s_add_u32 m0, s43, 16384
    ds_read_b64_tr_b16 v[78:79], v13 offset:33792
    v_cndmask_b32 v242, v243, v242, vcc
    v_mfma_f32_16x16x32_bf16 a[76:79], v[136:139], v[108:111], a[76:79]
    buffer_load_dwordx4 v6, s[8:11], s37 offen offset:0 lds
    v_mfma_f32_16x16x32_bf16 a[80:83], v[136:139], v[112:115], a[80:83]
    ds_read_b128 v[40:43], v14 offset:4096
    v_mfma_f32_16x16x32_bf16 a[84:87], v[136:139], v[116:119], a[84:87]
    v_mfma_f32_16x16x32_bf16 a[88:91], v[136:139], v[120:123], a[88:91]
    ds_read_b64_tr_b16 v[80:81], v10 offset:34816
    v_mfma_f32_16x16x32_bf16 a[92:95], v[136:139], v[124:127], a[92:95]
    buffer_load_dwordx4 v7, s[8:11], s37 offen offset:1024 lds
    v_mfma_f32_16x16x32_bf16 a[96:99], v[140:143], v[96:99], a[96:99]
    ds_read_b64_tr_b16 v[82:83], v10 offset:35840
    v_mfma_f32_16x16x32_bf16 a[100:103], v[140:143], v[100:103], a[100:103]
    v_mfma_f32_16x16x32_bf16 a[104:107], v[140:143], v[104:107], a[104:107]
    s_add_u32 m0, s43, 18432
    ds_read_b128 v[44:47], v14 offset:6144
    v_mfma_f32_16x16x32_bf16 a[108:111], v[140:143], v[108:111], a[108:111]
    buffer_load_dwordx4 v6, s[12:15], s37 offen offset:0 lds
    v_mfma_f32_16x16x32_bf16 a[112:115], v[140:143], v[112:115], a[112:115]
    ds_read_b64_tr_b16 v[84:85], v11 offset:34816
    v_mfma_f32_16x16x32_bf16 a[116:119], v[140:143], v[116:119], a[116:119]
    v_mfma_f32_16x16x32_bf16 a[120:123], v[140:143], v[120:123], a[120:123]
    ds_read_b64_tr_b16 v[86:87], v11 offset:35840
    v_mfma_f32_16x16x32_bf16 a[124:127], v[140:143], v[124:127], a[124:127]
    buffer_load_dwordx4 v7, s[12:15], s37 offen offset:1024 lds
    v_mfma_f32_16x16x32_bf16 a[128:131], v[96:99], v[144:147], a[128:131]
    ds_read_b128 v[48:51], v14 offset:8192
    v_mfma_f32_16x16x32_bf16 a[132:135], v[100:103], v[144:147], a[132:135]
    v_mfma_f32_16x16x32_bf16 a[136:139], v[104:107], v[144:147], a[136:139]
    ds_read_b64_tr_b16 v[88:89], v12 offset:34816
    v_mfma_f32_16x16x32_bf16 a[140:143], v[108:111], v[144:147], a[140:143]
    v_mfma_f32_16x16x32_bf16 a[144:147], v[112:115], v[144:147], a[144:147]
    ds_read_b64_tr_b16 v[90:91], v12 offset:35840
    v_mfma_f32_16x16x32_bf16 a[148:151], v[116:119], v[144:147], a[148:151]
    v_mfma_f32_16x16x32_bf16 a[152:155], v[120:123], v[144:147], a[152:155]
    ds_read_b128 v[52:55], v14 offset:10240
    v_mfma_f32_16x16x32_bf16 a[156:159], v[124:127], v[144:147], a[156:159]
    v_mfma_f32_16x16x32_bf16 a[160:163], v[96:99], v[148:151], a[160:163]
    ds_read_b64_tr_b16 v[92:93], v13 offset:34816
    v_mfma_f32_16x16x32_bf16 a[164:167], v[100:103], v[148:151], a[164:167]
    v_mfma_f32_16x16x32_bf16 a[168:171], v[104:107], v[148:151], a[168:171]
    ds_read_b64_tr_b16 v[94:95], v13 offset:35840
    v_mfma_f32_16x16x32_bf16 a[172:175], v[108:111], v[148:151], a[172:175]
    v_mfma_f32_16x16x32_bf16 a[176:179], v[112:115], v[148:151], a[176:179]
    ds_read_b128 v[56:59], v14 offset:12288
    v_mfma_f32_16x16x32_bf16 a[180:183], v[116:119], v[148:151], a[180:183]
    v_mfma_f32_16x16x32_bf16 a[184:187], v[120:123], v[148:151], a[184:187]
    ds_read_b128 v[60:63], v14 offset:14336
    v_mfma_f32_16x16x32_bf16 a[188:191], v[124:127], v[148:151], a[188:191]
    v_mfma_f32_16x16x32_bf16 a[192:195], v[96:99], v[152:155], a[192:195]
    v_mfma_f32_16x16x32_bf16 a[196:199], v[100:103], v[152:155], a[196:199]
    v_mfma_f32_16x16x32_bf16 a[200:203], v[104:107], v[152:155], a[200:203]
    v_mfma_f32_16x16x32_bf16 a[204:207], v[108:111], v[152:155], a[204:207]
    v_mfma_f32_16x16x32_bf16 a[208:211], v[112:115], v[152:155], a[208:211]
    v_mfma_f32_16x16x32_bf16 a[212:215], v[116:119], v[152:155], a[212:215]
    v_mfma_f32_16x16x32_bf16 a[216:219], v[120:123], v[152:155], a[216:219]
    v_mfma_f32_16x16x32_bf16 a[220:223], v[124:127], v[152:155], a[220:223]
    v_mfma_f32_16x16x32_bf16 a[224:227], v[96:99], v[156:159], a[224:227]
    v_mfma_f32_16x16x32_bf16 a[228:231], v[100:103], v[156:159], a[228:231]
    v_mfma_f32_16x16x32_bf16 a[232:235], v[104:107], v[156:159], a[232:235]
    v_mfma_f32_16x16x32_bf16 a[236:239], v[108:111], v[156:159], a[236:239]
    v_mfma_f32_16x16x32_bf16 a[240:243], v[112:115], v[156:159], a[240:243]
    v_mfma_f32_16x16x32_bf16 a[244:247], v[116:119], v[156:159], a[244:247]
    v_mfma_f32_16x16x32_bf16 a[248:251], v[120:123], v[156:159], a[248:251]
    v_mfma_f32_16x16x32_bf16 a[252:255], v[124:127], v[156:159], a[252:255]
    s_waitcnt vmcnt(16) lgkmcnt(0)
    s_barrier
    v_mfma_f32_16x16x32_bf16 a[0:3], v[64:67], v[32:35], a[0:3]
    ds_read_b64_tr_b16 v[128:129], v10 offset:49152
    v_lshlrev_b32 v240, 16, v222
    v_mfma_f32_16x16x32_bf16 a[4:7], v[64:67], v[36:39], a[4:7]
    s_add_u32 s36, s35, 896
    s_and_b32 s36, s36, 1023
    s_add_u32 s36, s36, s59
    v_lshlrev_b32 v238, 16, v206
    v_lshlrev_b32 v239, 16, v214
    v_mfma_f32_16x16x32_bf16 a[8:11], v[64:67], v[40:43], a[8:11]
    s_add_u32 m0, s42, 36864
    ds_read_b64_tr_b16 v[130:131], v10 offset:50176
    v_mul_f32 v236, v238, v240
    v_mfma_f32_16x16x32_bf16 a[12:15], v[64:67], v[44:47], a[12:15]
    buffer_load_dwordx4 v2, s[4:7], s36 offen offset:0 lds
    v_mfma_f32_16x16x32_bf16 a[16:19], v[64:67], v[48:51], a[16:19]
    ds_read_b64_tr_b16 v[132:133], v11 offset:49152
    v_mul_f32 v237, v239, v240
    v_mfma_f32_16x16x32_bf16 a[20:23], v[64:67], v[52:55], a[20:23]
    v_and_b32 v240, s52, v222
    v_and_b32 v238, s52, v206
    v_mfma_f32_16x16x32_bf16 a[24:27], v[64:67], v[56:59], a[24:27]
    ds_read_b64_tr_b16 v[134:135], v11 offset:50176
    v_and_b32 v239, s52, v214
    v_mfma_f32_16x16x32_bf16 a[28:31], v[64:67], v[60:63], a[28:31]
    buffer_load_dwordx4 v3, s[4:7], s36 offen offset:1024 lds
    v_mfma_f32_16x16x32_bf16 a[32:35], v[68:71], v[32:35], a[32:35]
    ds_read_b128 v[96:99], v15 offset:0
    v_fmac_f32 v236, v238, v240
    v_mfma_f32_16x16x32_bf16 a[36:39], v[68:71], v[36:39], a[36:39]
    v_fmac_f32 v237, v239, v240
    v_lshlrev_b32 v240, 16, v223
    v_mfma_f32_16x16x32_bf16 a[40:43], v[68:71], v[40:43], a[40:43]
    ds_read_b64_tr_b16 v[136:137], v12 offset:49152
    v_lshlrev_b32 v238, 16, v207
    v_mfma_f32_16x16x32_bf16 a[44:47], v[68:71], v[44:47], a[44:47]
    buffer_load_dwordx4 v4, s[4:7], s36 offen offset:2048 lds
    v_mfma_f32_16x16x32_bf16 a[48:51], v[68:71], v[48:51], a[48:51]
    ds_read_b64_tr_b16 v[138:139], v12 offset:50176
    v_lshlrev_b32 v239, 16, v215
    v_mfma_f32_16x16x32_bf16 a[52:55], v[68:71], v[52:55], a[52:55]
    v_fmac_f32 v236, v238, v240
    v_fmac_f32 v237, v239, v240
    v_mfma_f32_16x16x32_bf16 a[56:59], v[68:71], v[56:59], a[56:59]
    ds_read_b128 v[100:103], v15 offset:2048
    v_and_b32 v240, s52, v223
    v_mfma_f32_16x16x32_bf16 a[60:63], v[68:71], v[60:63], a[60:63]
    buffer_load_dwordx4 v5, s[4:7], s36 offen offset:3072 lds
    v_mfma_f32_16x16x32_bf16 a[64:67], v[72:75], v[32:35], a[64:67]
    ds_read_b64_tr_b16 v[140:141], v13 offset:49152
    v_and_b32 v238, s52, v207
    v_mfma_f32_16x16x32_bf16 a[68:71], v[72:75], v[36:39], a[68:71]
    s_add_u32 s37, s58, 3670016
    s_and_b32 s37, s37, 4194303
    s_add_u32 s37, s37, s39
    v_and_b32 v239, s52, v215
    v_fmac_f32 v236, v238, v240
    v_mfma_f32_16x16x32_bf16 a[72:75], v[72:75], v[40:43], a[72:75]
    s_add_u32 m0, s43, 32768
    ds_read_b64_tr_b16 v[142:143], v13 offset:50176
    v_fmac_f32 v237, v239, v240
    v_mfma_f32_16x16x32_bf16 a[76:79], v[72:75], v[44:47], a[76:79]
    buffer_load_dwordx4 v6, s[8:11], s37 offen offset:0 lds
    v_mfma_f32_16x16x32_bf16 a[80:83], v[72:75], v[48:51], a[80:83]
    ds_read_b128 v[104:107], v15 offset:4096
    v_lshlrev_b32 v240, 16, v224
    v_mfma_f32_16x16x32_bf16 a[84:87], v[72:75], v[52:55], a[84:87]
    v_lshlrev_b32 v238, 16, v208
    v_lshlrev_b32 v239, 16, v216
    v_mfma_f32_16x16x32_bf16 a[88:91], v[72:75], v[56:59], a[88:91]
    ds_read_b64_tr_b16 v[144:145], v10 offset:51200
    v_fmac_f32 v236, v238, v240
    v_mfma_f32_16x16x32_bf16 a[92:95], v[72:75], v[60:63], a[92:95]
    buffer_load_dwordx4 v7, s[8:11], s37 offen offset:1024 lds
    v_mfma_f32_16x16x32_bf16 a[96:99], v[76:79], v[32:35], a[96:99]
    ds_read_b64_tr_b16 v[146:147], v10 offset:52224
    v_fmac_f32 v237, v239, v240
    v_mfma_f32_16x16x32_bf16 a[100:103], v[76:79], v[36:39], a[100:103]
    v_and_b32 v240, s52, v224
    v_and_b32 v238, s52, v208
    v_mfma_f32_16x16x32_bf16 a[104:107], v[76:79], v[40:43], a[104:107]
    s_add_u32 m0, s43, 34816
    ds_read_b128 v[108:111], v15 offset:6144
    v_and_b32 v239, s52, v216
    v_mfma_f32_16x16x32_bf16 a[108:111], v[76:79], v[44:47], a[108:111]
    buffer_load_dwordx4 v6, s[12:15], s37 offen offset:0 lds
    v_mfma_f32_16x16x32_bf16 a[112:115], v[76:79], v[48:51], a[112:115]
    ds_read_b64_tr_b16 v[148:149], v11 offset:51200
    v_fmac_f32 v236, v238, v240
    v_mfma_f32_16x16x32_bf16 a[116:119], v[76:79], v[52:55], a[116:119]
    v_fmac_f32 v237, v239, v240
    v_lshlrev_b32 v240, 16, v225
    v_mfma_f32_16x16x32_bf16 a[120:123], v[76:79], v[56:59], a[120:123]
    ds_read_b64_tr_b16 v[150:151], v11 offset:52224
    v_lshlrev_b32 v238, 16, v209
    v_mfma_f32_16x16x32_bf16 a[124:127], v[76:79], v[60:63], a[124:127]
    buffer_load_dwordx4 v7, s[12:15], s37 offen offset:1024 lds
    v_mfma_f32_16x16x32_bf16 a[128:131], v[32:35], v[80:83], a[128:131]
    ds_read_b128 v[112:115], v15 offset:8192
    v_lshlrev_b32 v239, 16, v217
    v_mfma_f32_16x16x32_bf16 a[132:135], v[36:39], v[80:83], a[132:135]
    buffer_load_dword v31, v254, s[20:23], s46 offen
    v_mfma_f32_16x16x32_bf16 a[136:139], v[40:43], v[80:83], a[136:139]
    ds_read_b64_tr_b16 v[152:153], v12 offset:51200
    v_fmac_f32 v236, v238, v240
    v_mfma_f32_16x16x32_bf16 a[140:143], v[44:47], v[80:83], a[140:143]
    buffer_atomic_add v241, v242, s[76:79], s88 offen sc1
    v_mfma_f32_16x16x32_bf16 a[144:147], v[48:51], v[80:83], a[144:147]
    ds_read_b64_tr_b16 v[154:155], v12 offset:52224
    v_fmac_f32 v237, v239, v240
    v_mfma_f32_16x16x32_bf16 a[148:151], v[52:55], v[80:83], a[148:151]
    v_and_b32 v240, s52, v225
    v_and_b32 v238, s52, v209
    v_mfma_f32_16x16x32_bf16 a[152:155], v[56:59], v[80:83], a[152:155]
    ds_read_b128 v[116:119], v15 offset:10240
    v_and_b32 v239, s52, v217
    v_mfma_f32_16x16x32_bf16 a[156:159], v[60:63], v[80:83], a[156:159]
    v_mfma_f32_16x16x32_bf16 a[160:163], v[32:35], v[84:87], a[160:163]
    ds_read_b64_tr_b16 v[156:157], v13 offset:51200
    v_fmac_f32 v236, v238, v240
    v_mfma_f32_16x16x32_bf16 a[164:167], v[36:39], v[84:87], a[164:167]
    v_fmac_f32 v237, v239, v240
    v_lshlrev_b32 v240, 16, v226
    v_mfma_f32_16x16x32_bf16 a[168:171], v[40:43], v[84:87], a[168:171]
    ds_read_b64_tr_b16 v[158:159], v13 offset:52224
    v_lshlrev_b32 v238, 16, v210
    v_mfma_f32_16x16x32_bf16 a[172:175], v[44:47], v[84:87], a[172:175]
    v_mfma_f32_16x16x32_bf16 a[176:179], v[48:51], v[84:87], a[176:179]
    ds_read_b128 v[120:123], v15 offset:12288
    v_lshlrev_b32 v239, 16, v218
    v_mfma_f32_16x16x32_bf16 a[180:183], v[52:55], v[84:87], a[180:183]
    v_fmac_f32 v236, v238, v240
    v_fmac_f32 v237, v239, v240
    v_mfma_f32_16x16x32_bf16 a[184:187], v[56:59], v[84:87], a[184:187]
    ds_read_b128 v[124:127], v15 offset:14336
    v_and_b32 v240, s52, v226
    v_mfma_f32_16x16x32_bf16 a[188:191], v[60:63], v[84:87], a[188:191]
    v_mfma_f32_16x16x32_bf16 a[192:195], v[32:35], v[88:91], a[192:195]
    v_and_b32 v238, s52, v210
    v_and_b32 v239, s52, v218
    v_mfma_f32_16x16x32_bf16 a[196:199], v[36:39], v[88:91], a[196:199]
    v_fmac_f32 v236, v238, v240
    v_fmac_f32 v237, v239, v240
    v_mfma_f32_16x16x32_bf16 a[200:203], v[40:43], v[88:91], a[200:203]
    v_lshlrev_b32 v240, 16, v227
    v_lshlrev_b32 v238, 16, v211
    v_mfma_f32_16x16x32_bf16 a[204:207], v[44:47], v[88:91], a[204:207]
    v_mfma_f32_16x16x32_bf16 a[208:211], v[48:51], v[88:91], a[208:211]
    v_lshlrev_b32 v239, 16, v219
    v_fmac_f32 v236, v238, v240
    v_mfma_f32_16x16x32_bf16 a[212:215], v[52:55], v[88:91], a[212:215]
    v_fmac_f32 v237, v239, v240
    v_and_b32 v240, s52, v227
    v_mfma_f32_16x16x32_bf16 a[216:219], v[56:59], v[88:91], a[216:219]
    v_and_b32 v238, s52, v211
    v_and_b32 v239, s52, v219
    v_mfma_f32_16x16x32_bf16 a[220:223], v[60:63], v[88:91], a[220:223]
    v_mfma_f32_16x16x32_bf16 a[224:227], v[32:35], v[92:95], a[224:227]
    v_fmac_f32 v236, v238, v240
    v_fmac_f32 v237, v239, v240
    v_mfma_f32_16x16x32_bf16 a[228:231], v[36:39], v[92:95], a[228:231]
    v_lshlrev_b32 v240, 16, v228
    v_lshlrev_b32 v238, 16, v212
    v_mfma_f32_16x16x32_bf16 a[232:235], v[40:43], v[92:95], a[232:235]
    v_lshlrev_b32 v239, 16, v220
    v_fmac_f32 v236, v238, v240
    v_mfma_f32_16x16x32_bf16 a[236:239], v[44:47], v[92:95], a[236:239]
    v_mfma_f32_16x16x32_bf16 a[240:243], v[48:51], v[92:95], a[240:243]
    v_fmac_f32 v237, v239, v240
    v_and_b32 v240, s52, v228
    v_mfma_f32_16x16x32_bf16 a[244:247], v[52:55], v[92:95], a[244:247]
    v_and_b32 v238, s52, v212
    v_and_b32 v239, s52, v220
    v_mfma_f32_16x16x32_bf16 a[248:251], v[56:59], v[92:95], a[248:251]
    v_fmac_f32 v236, v238, v240
    v_fmac_f32 v237, v239, v240
    v_mfma_f32_16x16x32_bf16 a[252:255], v[60:63], v[92:95], a[252:255]
    s_waitcnt vmcnt(18) lgkmcnt(0)
    s_barrier
    v_lshlrev_b32 v240, 16, v229
    v_lshlrev_b32 v238, 16, v213
    v_mfma_f32_16x16x32_bf16 a[0:3], v[128:131], v[96:99], a[0:3]
    ds_read_b64_tr_b16 v[64:65], v10 offset:0
    v_lshlrev_b32 v239, 16, v221
    v_mfma_f32_16x16x32_bf16 a[4:7], v[128:131], v[100:103], a[4:7]
    s_add_u32 s36, s44, 0
    v_fmac_f32 v236, v238, v240
    v_fmac_f32 v237, v239, v240
    v_mfma_f32_16x16x32_bf16 a[8:11], v[128:131], v[104:107], a[8:11]
    s_add_u32 m0, s42, 65536
    ds_read_b64_tr_b16 v[66:67], v10 offset:1024
    v_and_b32 v240, s52, v229
    v_mfma_f32_16x16x32_bf16 a[12:15], v[128:131], v[108:111], a[12:15]
    buffer_load_dwordx4 v17, s[24:27], s36 offen offset:0 lds
    v_mfma_f32_16x16x32_bf16 a[16:19], v[128:131], v[112:115], a[16:19]
    ds_read_b64_tr_b16 v[68:69], v11 offset:0
    v_and_b32 v238, s52, v213
    v_mfma_f32_16x16x32_bf16 a[20:23], v[128:131], v[116:119], a[20:23]
    v_and_b32 v239, s52, v221
    v_fmac_f32 v236, v238, v240
    v_mfma_f32_16x16x32_bf16 a[24:27], v[128:131], v[120:123], a[24:27]
    ds_read_b64_tr_b16 v[70:71], v11 offset:1024
    v_fmac_f32 v237, v239, v240
    v_mfma_f32_16x16x32_bf16 a[28:31], v[128:131], v[124:127], a[28:31]
    buffer_load_dwordx4 v18, s[24:27], s36 offen offset:1024 lds
    v_mfma_f32_16x16x32_bf16 a[32:35], v[132:135], v[96:99], a[32:35]
    ds_read_b128 v[32:35], v8 offset:0
    v_add_f32_dpp v236, v236, v236 quad_perm:[1,0,3,2] row_mask:0xf bank_mask:0xf
    v_mfma_f32_16x16x32_bf16 a[36:39], v[132:135], v[100:103], a[36:39]
    v_add_f32_dpp v237, v237, v237 quad_perm:[1,0,3,2] row_mask:0xf bank_mask:0xf
    v_mfma_f32_16x16x32_bf16 a[40:43], v[132:135], v[104:107], a[40:43]
    ds_read_b64_tr_b16 v[72:73], v12 offset:0
    v_mfma_f32_16x16x32_bf16 a[44:47], v[132:135], v[108:111], a[44:47]
    buffer_load_dwordx4 v19, s[24:27], s36 offen offset:2048 lds
    v_mfma_f32_16x16x32_bf16 a[48:51], v[132:135], v[112:115], a[48:51]
    ds_read_b64_tr_b16 v[74:75], v12 offset:1024
    v_add_f32_dpp v236, v236, v236 quad_perm:[2,3,0,1] row_mask:0xf bank_mask:0xf
    v_mfma_f32_16x16x32_bf16 a[52:55], v[132:135], v[116:119], a[52:55]
    v_add_f32_dpp v237, v237, v237 quad_perm:[2,3,0,1] row_mask:0xf bank_mask:0xf
    v_mfma_f32_16x16x32_bf16 a[56:59], v[132:135], v[120:123], a[56:59]
    ds_read_b128 v[36:39], v8 offset:2048
    v_mfma_f32_16x16x32_bf16 a[60:63], v[132:135], v[124:127], a[60:63]
    buffer_load_dwordx4 v20, s[24:27], s36 offen offset:3072 lds
    v_mfma_f32_16x16x32_bf16 a[64:67], v[136:139], v[96:99], a[64:67]
    ds_read_b64_tr_b16 v[76:77], v13 offset:0
    v_add_f32_dpp v236, v236, v236 row_half_mirror row_mask:0xf bank_mask:0xf
    v_mfma_f32_16x16x32_bf16 a[68:71], v[136:139], v[100:103], a[68:71]
    s_add_u32 s37, s58, 3932160
    s_and_b32 s37, s37, 4194303
    s_add_u32 s37, s37, s39
    v_add_f32_dpp v237, v237, v237 row_half_mirror row_mask:0xf bank_mask:0xf
    v_mfma_f32_16x16x32_bf16 a[72:75], v[136:139], v[104:107], a[72:75]
    s_add_u32 m0, s43, 49152
    ds_read_b64_tr_b16 v[78:79], v13 offset:1024
    v_mfma_f32_16x16x32_bf16 a[76:79], v[136:139], v[108:111], a[76:79]
    buffer_load_dwordx4 v6, s[8:11], s37 offen offset:0 lds
    v_mfma_f32_16x16x32_bf16 a[80:83], v[136:139], v[112:115], a[80:83]
    ds_read_b128 v[40:43], v8 offset:4096
    v_add_f32_dpp v236, v236, v236 row_mirror row_mask:0xf bank_mask:0xf
    v_mfma_f32_16x16x32_bf16 a[84:87], v[136:139], v[116:119], a[84:87]
    v_add_f32_dpp v237, v237, v237 row_mirror row_mask:0xf bank_mask:0xf
    v_mov_b32 v238, v236
    v_mfma_f32_16x16x32_bf16 a[88:91], v[136:139], v[120:123], a[88:91]
    ds_read_b64_tr_b16 v[80:81], v10 offset:2048
    v_mov_b32 v239, v237
    v_mfma_f32_16x16x32_bf16 a[92:95], v[136:139], v[124:127], a[92:95]
    buffer_load_dwordx4 v7, s[8:11], s37 offen offset:1024 lds
    v_mfma_f32_16x16x32_bf16 a[96:99], v[140:143], v[96:99], a[96:99]
    ds_read_b64_tr_b16 v[82:83], v10 offset:3072
    v_permlane16_swap_b32 v236, v238
    v_mfma_f32_16x16x32_bf16 a[100:103], v[140:143], v[100:103], a[100:103]
    v_permlane16_swap_b32 v237, v239
    v_mfma_f32_16x16x32_bf16 a[104:107], v[140:143], v[104:107], a[104:107]
    s_add_u32 m0, s43, 51200
    ds_read_b128 v[44:47], v8 offset:6144
    v_add_f32 v236, v236, v238
    v_mfma_f32_16x16x32_bf16 a[108:111], v[140:143], v[108:111], a[108:111]
    buffer_load_dwordx4 v6, s[12:15], s37 offen offset:0 lds
    v_mfma_f32_16x16x32_bf16 a[112:115], v[140:143], v[112:115], a[112:115]
    ds_read_b64_tr_b16 v[84:85], v11 offset:2048
    v_add_f32 v237, v237, v239
    v_mfma_f32_16x16x32_bf16 a[116:119], v[140:143], v[116:119], a[116:119]
    v_mov_b32 v238, v236
    v_mov_b32 v239, v237
    v_mfma_f32_16x16x32_bf16 a[120:123], v[140:143], v[120:123], a[120:123]
    ds_read_b64_tr_b16 v[86:87], v11 offset:3072
    v_mfma_f32_16x16x32_bf16 a[124:127], v[140:143], v[124:127], a[124:127]
    buffer_load_dwordx4 v7, s[12:15], s37 offen offset:1024 lds
    v_mfma_f32_16x16x32_bf16 a[128:131], v[96:99], v[144:147], a[128:131]
    ds_read_b128 v[48:51], v8 offset:8192
    v_permlane32_swap_b32 v236, v238
    v_mfma_f32_16x16x32_bf16 a[132:135], v[100:103], v[144:147], a[132:135]
    v_permlane32_swap_b32 v237, v239
    v_mfma_f32_16x16x32_bf16 a[136:139], v[104:107], v[144:147], a[136:139]
    ds_read_b64_tr_b16 v[88:89], v12 offset:2048
    v_add_f32 v236, v236, v238
    v_mfma_f32_16x16x32_bf16 a[140:143], v[108:111], v[144:147], a[140:143]
    v_mfma_f32_16x16x32_bf16 a[144:147], v[112:115], v[144:147], a[144:147]
    ds_read_b64_tr_b16 v[90:91], v12 offset:3072
    v_add_f32 v237, v237, v239
    v_mfma_f32_16x16x32_bf16 a[148:151], v[116:119], v[144:147], a[148:151]
    v_mul_f32 v236, 0xbfb8aa3b, v236
    v_mul_f32 v237, 0xbfb8aa3b, v237
    v_mfma_f32_16x16x32_bf16 a[152:155], v[120:123], v[144:147], a[152:155]
    ds_read_b128 v[52:55], v8 offset:10240
    v_exp_f32 v236, v236
    v_mfma_f32_16x16x32_bf16 a[156:159], v[124:127], v[144:147], a[156:159]
    v_mfma_f32_16x16x32_bf16 a[160:163], v[96:99], v[148:151], a[160:163]
    ds_read_b64_tr_b16 v[92:93], v13 offset:2048
    v_exp_f32 v237, v237
    v_mfma_f32_16x16x32_bf16 a[164:167], v[100:103], v[148:151], a[164:167]
    v_mov_b32 v238, 0
    v_add_f32 v236, 1.0, v236
    v_mfma_f32_16x16x32_bf16 a[168:171], v[104:107], v[148:151], a[168:171]
    ds_read_b64_tr_b16 v[94:95], v13 offset:3072
    v_add_f32 v237, 1.0, v237
    v_mfma_f32_16x16x32_bf16 a[172:175], v[108:111], v[148:151], a[172:175]
    v_mfma_f32_16x16x32_bf16 a[176:179], v[112:115], v[148:151], a[176:179]
    ds_read_b128 v[56:59], v8 offset:12288
    v_rcp_f32 v236, v236
    v_mfma_f32_16x16x32_bf16 a[180:183], v[116:119], v[148:151], a[180:183]
    v_rcp_f32 v237, v237
    v_mfma_f32_16x16x32_bf16 a[184:187], v[120:123], v[148:151], a[184:187]
    s_add_u32 s16, s94, 59768832
    s_addc_u32 s17, s95, 0
    ds_read_b128 v[60:63], v8 offset:14336
    v_mfma_f32_16x16x32_bf16 a[188:191], v[124:127], v[148:151], a[188:191]
    v_mfma_f32_16x16x32_bf16 a[192:195], v[96:99], v[152:155], a[192:195]
    s_mov_b32 s18, 8192
    v_mfma_f32_16x16x32_bf16 a[196:199], v[100:103], v[152:155], a[196:199]
    s_lshr_b32 s40, s40, 9
    v_mfma_f32_16x16x32_bf16 a[200:203], v[104:107], v[152:155], a[200:203]
    s_lshr_b32 s41, s41, 9
    v_mfma_f32_16x16x32_bf16 a[204:207], v[108:111], v[152:155], a[204:207]
    buffer_store_dword v236, v238, s[16:19], s40 offen sc1
    v_mfma_f32_16x16x32_bf16 a[208:211], v[112:115], v[152:155], a[208:211]
    v_mfma_f32_16x16x32_bf16 a[212:215], v[116:119], v[152:155], a[212:215]
    v_mfma_f32_16x16x32_bf16 a[216:219], v[120:123], v[152:155], a[216:219]
    v_mfma_f32_16x16x32_bf16 a[220:223], v[124:127], v[152:155], a[220:223]
    buffer_store_dword v237, v238, s[16:19], s41 offen sc1
    v_mfma_f32_16x16x32_bf16 a[224:227], v[96:99], v[156:159], a[224:227]
    s_add_u32 s16, s94, 50331648
    s_addc_u32 s17, s95, 0
    v_mfma_f32_16x16x32_bf16 a[228:231], v[100:103], v[156:159], a[228:231]
    s_mov_b32 s18, 4718592
    v_mfma_f32_16x16x32_bf16 a[232:235], v[104:107], v[156:159], a[232:235]
    v_mfma_f32_16x16x32_bf16 a[236:239], v[108:111], v[156:159], a[236:239]
    v_mfma_f32_16x16x32_bf16 a[240:243], v[112:115], v[156:159], a[240:243]
    v_mfma_f32_16x16x32_bf16 a[244:247], v[116:119], v[156:159], a[244:247]
    v_mfma_f32_16x16x32_bf16 a[248:251], v[120:123], v[156:159], a[248:251]
    v_mfma_f32_16x16x32_bf16 a[252:255], v[124:127], v[156:159], a[252:255]
    s_waitcnt vmcnt(20) lgkmcnt(0)
    s_barrier
    v_mfma_f32_16x16x32_bf16 a[0:3], v[64:67], v[32:35], a[0:3]
    ds_read_b64_tr_b16 v[128:129], v10 offset:16384
    v_lshlrev_b32 v206, 16, v160
    v_mfma_f32_16x16x32_bf16 a[4:7], v[64:67], v[36:39], a[4:7]
    s_add_u32 s36, s45, 0
    v_lshlrev_b32 v207, 16, v162
    v_lshlrev_b32 v208, 16, v164
    v_mfma_f32_16x16x32_bf16 a[8:11], v[64:67], v[40:43], a[8:11]
    s_add_u32 m0, s42, 69632
    ds_read_b64_tr_b16 v[130:131], v10 offset:17408
    v_lshlrev_b32 v209, 16, v166
    v_mfma_f32_16x16x32_bf16 a[12:15], v[64:67], v[44:47], a[12:15]
    buffer_load_dwordx4 v17, s[24:27], s36 offen offset:0 lds
    v_mfma_f32_16x16x32_bf16 a[16:19], v[64:67], v[48:51], a[16:19]
    ds_read_b64_tr_b16 v[132:133], v11 offset:16384
    v_lshlrev_b32 v210, 16, v168
    v_mfma_f32_16x16x32_bf16 a[20:23], v[64:67], v[52:55], a[20:23]
    v_lshlrev_b32 v211, 16, v170
    v_lshlrev_b32 v212, 16, v172
    v_mfma_f32_16x16x32_bf16 a[24:27], v[64:67], v[56:59], a[24:27]
    ds_read_b64_tr_b16 v[134:135], v11 offset:17408
    v_lshlrev_b32 v213, 16, v174
    v_mfma_f32_16x16x32_bf16 a[28:31], v[64:67], v[60:63], a[28:31]
    buffer_load_dwordx4 v18, s[24:27], s36 offen offset:1024 lds
    v_mfma_f32_16x16x32_bf16 a[32:35], v[68:71], v[32:35], a[32:35]
    ds_read_b128 v[96:99], v9 offset:0
    v_lshlrev_b32 v214, 16, v176
    v_mfma_f32_16x16x32_bf16 a[36:39], v[68:71], v[36:39], a[36:39]
    v_lshlrev_b32 v215, 16, v178
    v_lshlrev_b32 v216, 16, v180
    v_mfma_f32_16x16x32_bf16 a[40:43], v[68:71], v[40:43], a[40:43]
    ds_read_b64_tr_b16 v[136:137], v12 offset:16384
    v_lshlrev_b32 v217, 16, v198
    v_mfma_f32_16x16x32_bf16 a[44:47], v[68:71], v[44:47], a[44:47]
    buffer_load_dwordx4 v19, s[24:27], s36 offen offset:2048 lds
    v_mfma_f32_16x16x32_bf16 a[48:51], v[68:71], v[48:51], a[48:51]
    ds_read_b64_tr_b16 v[138:139], v12 offset:17408
    v_and_b32 v218, s52, v198
    v_mfma_f32_16x16x32_bf16 a[52:55], v[68:71], v[52:55], a[52:55]
    v_lshlrev_b32 v219, 16, v199
    v_and_b32 v220, s52, v199
    v_mfma_f32_16x16x32_bf16 a[56:59], v[68:71], v[56:59], a[56:59]
    ds_read_b128 v[100:103], v9 offset:2048
    v_mul_f32 v221, v209, v217
    v_mfma_f32_16x16x32_bf16 a[60:63], v[68:71], v[60:63], a[60:63]
    buffer_load_dwordx4 v20, s[24:27], s36 offen offset:3072 lds
    v_mfma_f32_16x16x32_bf16 a[64:67], v[72:75], v[32:35], a[64:67]
    ds_read_b64_tr_b16 v[140:141], v13 offset:16384
    v_mul_f32 v222, v210, v217
    v_mfma_f32_16x16x32_bf16 a[68:71], v[72:75], v[36:39], a[68:71]
    s_add_u32 s37, s49, 0
    v_mul_f32 v223, v211, v217
    v_mul_f32 v224, v212, v217
    v_mfma_f32_16x16x32_bf16 a[72:75], v[72:75], v[40:43], a[72:75]
    s_add_u32 m0, s50, 0
    ds_read_b64_tr_b16 v[142:143], v13 offset:17408
    v_mul_f32 v225, v213, v217
    v_mfma_f32_16x16x32_bf16 a[76:79], v[72:75], v[44:47], a[76:79]
    buffer_load_dwordx4 v21, s[20:23], s37 offen offset:0 lds
    v_mfma_f32_16x16x32_bf16 a[80:83], v[72:75], v[48:51], a[80:83]
    ds_read_b128 v[104:107], v9 offset:4096
    v_mul_f32 v226, v214, v217
    v_mfma_f32_16x16x32_bf16 a[84:87], v[72:75], v[52:55], a[84:87]
    v_mul_f32 v227, v215, v217
    v_mul_f32 v228, v216, v217
    v_mfma_f32_16x16x32_bf16 a[88:91], v[72:75], v[56:59], a[88:91]
    ds_read_b64_tr_b16 v[144:145], v10 offset:18432
    v_fmac_f32 v221, v208, v218
    v_mfma_f32_16x16x32_bf16 a[92:95], v[72:75], v[60:63], a[92:95]
    buffer_load_dwordx4 v22, s[20:23], s37 offen offset:1024 lds
    v_mfma_f32_16x16x32_bf16 a[96:99], v[76:79], v[32:35], a[96:99]
    ds_read_b64_tr_b16 v[146:147], v10 offset:19456
    v_fmac_f32 v222, v209, v218
    v_mfma_f32_16x16x32_bf16 a[100:103], v[76:79], v[36:39], a[100:103]
    v_fmac_f32 v223, v210, v218
    v_fmac_f32 v224, v211, v218
    v_mfma_f32_16x16x32_bf16 a[104:107], v[76:79], v[40:43], a[104:107]
    ds_read_b128 v[108:111], v9 offset:6144
    v_fmac_f32 v225, v212, v218
    v_mfma_f32_16x16x32_bf16 a[108:111], v[76:79], v[44:47], a[108:111]
    v_mfma_f32_16x16x32_bf16 a[112:115], v[76:79], v[48:51], a[112:115]
    ds_read_b64_tr_b16 v[148:149], v11 offset:18432
    v_fmac_f32 v226, v213, v218
    v_mfma_f32_16x16x32_bf16 a[116:119], v[76:79], v[52:55], a[116:119]
    v_fmac_f32 v227, v214, v218
    v_fmac_f32 v228, v215, v218
    v_mfma_f32_16x16x32_bf16 a[120:123], v[76:79], v[56:59], a[120:123]
    ds_read_b64_tr_b16 v[150:151], v11 offset:19456
    v_fmac_f32 v221, v207, v219
    v_mfma_f32_16x16x32_bf16 a[124:127], v[76:79], v[60:63], a[124:127]
    v_mfma_f32_16x16x32_bf16 a[128:131], v[32:35], v[80:83], a[128:131]
    ds_read_b128 v[112:115], v9 offset:8192
    v_fmac_f32 v222, v208, v219
    v_mfma_f32_16x16x32_bf16 a[132:135], v[36:39], v[80:83], a[132:135]
    v_fmac_f32 v223, v209, v219
    v_fmac_f32 v224, v210, v219
    v_mfma_f32_16x16x32_bf16 a[136:139], v[40:43], v[80:83], a[136:139]
    ds_read_b64_tr_b16 v[152:153], v12 offset:18432
    v_fmac_f32 v225, v211, v219
    v_mfma_f32_16x16x32_bf16 a[140:143], v[44:47], v[80:83], a[140:143]
    v_mfma_f32_16x16x32_bf16 a[144:147], v[48:51], v[80:83], a[144:147]
    ds_read_b64_tr_b16 v[154:155], v12 offset:19456
    v_fmac_f32 v226, v212, v219
    v_mfma_f32_16x16x32_bf16 a[148:151], v[52:55], v[80:83], a[148:151]
    v_fmac_f32 v227, v213, v219
    v_fmac_f32 v228, v214, v219
    v_mfma_f32_16x16x32_bf16 a[152:155], v[56:59], v[80:83], a[152:155]
    ds_read_b128 v[116:119], v9 offset:10240
    v_fmac_f32 v221, v206, v220
    v_mfma_f32_16x16x32_bf16 a[156:159], v[60:63], v[80:83], a[156:159]
    v_mfma_f32_16x16x32_bf16 a[160:163], v[32:35], v[84:87], a[160:163]
    ds_read_b64_tr_b16 v[156:157], v13 offset:18432
    v_fmac_f32 v222, v207, v220
    v_mfma_f32_16x16x32_bf16 a[164:167], v[36:39], v[84:87], a[164:167]
    v_fmac_f32 v223, v208, v220
    v_fmac_f32 v224, v209, v220
    v_mfma_f32_16x16x32_bf16 a[168:171], v[40:43], v[84:87], a[168:171]
    ds_read_b64_tr_b16 v[158:159], v13 offset:19456
    v_fmac_f32 v225, v210, v220
    v_mfma_f32_16x16x32_bf16 a[172:175], v[44:47], v[84:87], a[172:175]
    v_mfma_f32_16x16x32_bf16 a[176:179], v[48:51], v[84:87], a[176:179]
    ds_read_b128 v[120:123], v9 offset:12288
    v_fmac_f32 v226, v211, v220
    v_mfma_f32_16x16x32_bf16 a[180:183], v[52:55], v[84:87], a[180:183]
gated_mix__ssm_conv_h3__compressed_kv_cla__prompt_kernel_pad2:
    s_cbranch_execz gated_mix__ssm_conv_h3__compressed_kv_cla__prompt_kernel_pad6
    v_fmac_f32 v227, v212, v220
    v_fmac_f32 v228, v213, v220
    v_mfma_f32_16x16x32_bf16 a[184:187], v[56:59], v[84:87], a[184:187]
    ds_read_b128 v[124:127], v9 offset:14336
    v_lshlrev_b32 v206, 16, v182
    v_mfma_f32_16x16x32_bf16 a[188:191], v[60:63], v[84:87], a[188:191]
    v_mfma_f32_16x16x32_bf16 a[192:195], v[32:35], v[88:91], a[192:195]
    v_lshlrev_b32 v207, 16, v184
    v_lshlrev_b32 v208, 16, v186
    v_mfma_f32_16x16x32_bf16 a[196:199], v[36:39], v[88:91], a[196:199]
    v_lshlrev_b32 v209, 16, v188
    v_lshlrev_b32 v210, 16, v190
    v_mfma_f32_16x16x32_bf16 a[200:203], v[40:43], v[88:91], a[200:203]
    v_lshlrev_b32 v211, 16, v192
    v_lshlrev_b32 v212, 16, v194
    v_mfma_f32_16x16x32_bf16 a[204:207], v[44:47], v[88:91], a[204:207]
    v_mfma_f32_16x16x32_bf16 a[208:211], v[48:51], v[88:91], a[208:211]
    v_lshlrev_b32 v213, 16, v196
    v_mul_f32 v221, v221, v206
    v_mfma_f32_16x16x32_bf16 a[212:215], v[52:55], v[88:91], a[212:215]
    v_mul_f32 v222, v222, v207
    v_mul_f32 v223, v223, v208
    v_mfma_f32_16x16x32_bf16 a[216:219], v[56:59], v[88:91], a[216:219]
    v_mul_f32 v224, v224, v209
    v_mul_f32 v225, v225, v210
    v_mfma_f32_16x16x32_bf16 a[220:223], v[60:63], v[88:91], a[220:223]
    v_mfma_f32_16x16x32_bf16 a[224:227], v[32:35], v[92:95], a[224:227]
    v_mul_f32 v226, v226, v211
    v_mul_f32 v227, v227, v212
    v_mfma_f32_16x16x32_bf16 a[228:231], v[36:39], v[92:95], a[228:231]
    v_mul_f32 v228, v228, v213
    v_cvt_pk_bf16_f32 v244, v228, v227
    v_mfma_f32_16x16x32_bf16 a[232:235], v[40:43], v[92:95], a[232:235]
    v_cvt_pk_bf16_f32 v245, v226, v225
    v_cvt_pk_bf16_f32 v246, v224, v223
    v_mfma_f32_16x16x32_bf16 a[236:239], v[44:47], v[92:95], a[236:239]
    v_mfma_f32_16x16x32_bf16 a[240:243], v[48:51], v[92:95], a[240:243]
    v_cvt_pk_bf16_f32 v247, v222, v221
    v_and_b32 v206, s52, v160
    v_mfma_f32_16x16x32_bf16 a[244:247], v[52:55], v[92:95], a[244:247]
    v_and_b32 v207, s52, v162
    v_and_b32 v208, s52, v164
    v_mfma_f32_16x16x32_bf16 a[248:251], v[56:59], v[92:95], a[248:251]
    v_and_b32 v209, s52, v166
    v_and_b32 v210, s52, v168
    v_mfma_f32_16x16x32_bf16 a[252:255], v[60:63], v[92:95], a[252:255]
    s_waitcnt vmcnt(18) lgkmcnt(0)
    s_barrier
    v_and_b32 v211, s52, v170
    v_and_b32 v212, s52, v172
    v_mfma_f32_16x16x32_bf16 a[0:3], v[128:131], v[96:99], a[0:3]
    ds_read_b64_tr_b16 v[64:65], v10 offset:32768
    v_and_b32 v213, s52, v174
    v_mfma_f32_16x16x32_bf16 a[4:7], v[128:131], v[100:103], a[4:7]
    s_add_u32 s36, s44, 128
    v_and_b32 v214, s52, v176
    v_and_b32 v215, s52, v178
    v_mfma_f32_16x16x32_bf16 a[8:11], v[128:131], v[104:107], a[8:11]
    s_add_u32 m0, s42, 0
    ds_read_b64_tr_b16 v[66:67], v10 offset:33792
    v_and_b32 v216, s52, v180
    v_mfma_f32_16x16x32_bf16 a[12:15], v[128:131], v[108:111], a[12:15]
    buffer_load_dwordx4 v17, s[24:27], s36 offen offset:0 lds
    v_mfma_f32_16x16x32_bf16 a[16:19], v[128:131], v[112:115], a[16:19]
    ds_read_b64_tr_b16 v[68:69], v11 offset:32768
    v_lshlrev_b32 v217, 16, v200
    v_mfma_f32_16x16x32_bf16 a[20:23], v[128:131], v[116:119], a[20:23]
    v_and_b32 v218, s52, v200
    v_lshlrev_b32 v219, 16, v201
    v_mfma_f32_16x16x32_bf16 a[24:27], v[128:131], v[120:123], a[24:27]
    ds_read_b64_tr_b16 v[70:71], v11 offset:33792
    v_and_b32 v220, s52, v201
    v_mfma_f32_16x16x32_bf16 a[28:31], v[128:131], v[124:127], a[28:31]
    buffer_load_dwordx4 v18, s[24:27], s36 offen offset:1024 lds
    v_mfma_f32_16x16x32_bf16 a[32:35], v[132:135], v[96:99], a[32:35]
    ds_read_b128 v[32:35], v8 offset:32768
    v_mul_f32 v221, v209, v217
    v_mfma_f32_16x16x32_bf16 a[36:39], v[132:135], v[100:103], a[36:39]
    v_mul_f32 v222, v210, v217
    v_mul_f32 v223, v211, v217
    v_mfma_f32_16x16x32_bf16 a[40:43], v[132:135], v[104:107], a[40:43]
    ds_read_b64_tr_b16 v[72:73], v12 offset:32768
    v_mul_f32 v224, v212, v217
    v_mfma_f32_16x16x32_bf16 a[44:47], v[132:135], v[108:111], a[44:47]
    buffer_load_dwordx4 v19, s[24:27], s36 offen offset:2048 lds
    v_mfma_f32_16x16x32_bf16 a[48:51], v[132:135], v[112:115], a[48:51]
    ds_read_b64_tr_b16 v[74:75], v12 offset:33792
    v_mul_f32 v225, v213, v217
    v_mfma_f32_16x16x32_bf16 a[52:55], v[132:135], v[116:119], a[52:55]
    v_mul_f32 v226, v214, v217
    v_mul_f32 v227, v215, v217
    v_mfma_f32_16x16x32_bf16 a[56:59], v[132:135], v[120:123], a[56:59]
    ds_read_b128 v[36:39], v8 offset:34816
    v_mul_f32 v228, v216, v217
    v_mfma_f32_16x16x32_bf16 a[60:63], v[132:135], v[124:127], a[60:63]
    buffer_load_dwordx4 v20, s[24:27], s36 offen offset:3072 lds
    v_mfma_f32_16x16x32_bf16 a[64:67], v[136:139], v[96:99], a[64:67]
    ds_read_b64_tr_b16 v[76:77], v13 offset:32768
    v_fmac_f32 v221, v208, v218
    v_mfma_f32_16x16x32_bf16 a[68:71], v[136:139], v[100:103], a[68:71]
    s_add_u32 s37, s49, 262144
    v_fmac_f32 v222, v209, v218
    v_fmac_f32 v223, v210, v218
    v_mfma_f32_16x16x32_bf16 a[72:75], v[136:139], v[104:107], a[72:75]
    s_add_u32 m0, s50, 8704
    ds_read_b64_tr_b16 v[78:79], v13 offset:33792
    v_fmac_f32 v224, v211, v218
    v_mfma_f32_16x16x32_bf16 a[76:79], v[136:139], v[108:111], a[76:79]
    buffer_load_dwordx4 v21, s[20:23], s37 offen offset:0 lds
    v_mfma_f32_16x16x32_bf16 a[80:83], v[136:139], v[112:115], a[80:83]
    ds_read_b128 v[40:43], v8 offset:36864
    v_fmac_f32 v225, v212, v218
    v_mfma_f32_16x16x32_bf16 a[84:87], v[136:139], v[116:119], a[84:87]
    v_fmac_f32 v226, v213, v218
    v_fmac_f32 v227, v214, v218
    v_mfma_f32_16x16x32_bf16 a[88:91], v[136:139], v[120:123], a[88:91]
    ds_read_b64_tr_b16 v[80:81], v10 offset:34816
    v_fmac_f32 v228, v215, v218
    v_mfma_f32_16x16x32_bf16 a[92:95], v[136:139], v[124:127], a[92:95]
    buffer_load_dwordx4 v22, s[20:23], s37 offen offset:1024 lds
    v_mfma_f32_16x16x32_bf16 a[96:99], v[140:143], v[96:99], a[96:99]
    ds_read_b64_tr_b16 v[82:83], v10 offset:35840
    v_fmac_f32 v221, v207, v219
    v_mfma_f32_16x16x32_bf16 a[100:103], v[140:143], v[100:103], a[100:103]
    s_add_u32 s37, s49, 524288
    v_fmac_f32 v222, v208, v219
    v_fmac_f32 v223, v209, v219
    v_mfma_f32_16x16x32_bf16 a[104:107], v[140:143], v[104:107], a[104:107]
    s_add_u32 m0, s50, 17408
    ds_read_b128 v[44:47], v8 offset:38912
    v_fmac_f32 v224, v210, v219
    v_mfma_f32_16x16x32_bf16 a[108:111], v[140:143], v[108:111], a[108:111]
    buffer_load_dwordx4 v21, s[20:23], s37 offen offset:0 lds
    v_mfma_f32_16x16x32_bf16 a[112:115], v[140:143], v[112:115], a[112:115]
    ds_read_b64_tr_b16 v[84:85], v11 offset:34816
    v_fmac_f32 v225, v211, v219
    v_mfma_f32_16x16x32_bf16 a[116:119], v[140:143], v[116:119], a[116:119]
    v_fmac_f32 v226, v212, v219
    v_fmac_f32 v227, v213, v219
    v_mfma_f32_16x16x32_bf16 a[120:123], v[140:143], v[120:123], a[120:123]
    ds_read_b64_tr_b16 v[86:87], v11 offset:35840
    v_fmac_f32 v228, v214, v219
    v_mfma_f32_16x16x32_bf16 a[124:127], v[140:143], v[124:127], a[124:127]
    buffer_load_dwordx4 v22, s[20:23], s37 offen offset:1024 lds
    v_mfma_f32_16x16x32_bf16 a[128:131], v[96:99], v[144:147], a[128:131]
    ds_read_b128 v[48:51], v8 offset:40960
    v_fmac_f32 v221, v206, v220
    v_mfma_f32_16x16x32_bf16 a[132:135], v[100:103], v[144:147], a[132:135]
    v_fmac_f32 v222, v207, v220
    v_fmac_f32 v223, v208, v220
    v_mfma_f32_16x16x32_bf16 a[136:139], v[104:107], v[144:147], a[136:139]
    ds_read_b64_tr_b16 v[88:89], v12 offset:34816
    v_fmac_f32 v224, v209, v220
    v_mfma_f32_16x16x32_bf16 a[140:143], v[108:111], v[144:147], a[140:143]
    buffer_store_dwordx4 v[244:247], v234, s[16:19], 0 offen sc1
    v_mfma_f32_16x16x32_bf16 a[144:147], v[112:115], v[144:147], a[144:147]
    s_movk_i32 s54, 4608
    ds_read_b64_tr_b16 v[90:91], v12 offset:35840
    v_fmac_f32 v225, v210, v220
    v_mfma_f32_16x16x32_bf16 a[148:151], v[116:119], v[144:147], a[148:151]
    v_fmac_f32 v226, v211, v220
    v_fmac_f32 v227, v212, v220
    v_mfma_f32_16x16x32_bf16 a[152:155], v[120:123], v[144:147], a[152:155]
    ds_read_b128 v[52:55], v8 offset:43008
    v_fmac_f32 v228, v213, v220
    v_mfma_f32_16x16x32_bf16 a[156:159], v[124:127], v[144:147], a[156:159]
    v_mfma_f32_16x16x32_bf16 a[160:163], v[96:99], v[148:151], a[160:163]
    ds_read_b64_tr_b16 v[92:93], v13 offset:34816
    v_and_b32 v206, s52, v182
    v_mfma_f32_16x16x32_bf16 a[164:167], v[100:103], v[148:151], a[164:167]
    v_and_b32 v207, s52, v184
    v_and_b32 v208, s52, v186
    v_mfma_f32_16x16x32_bf16 a[168:171], v[104:107], v[148:151], a[168:171]
    ds_read_b64_tr_b16 v[94:95], v13 offset:35840
    v_and_b32 v209, s52, v188
    v_mfma_f32_16x16x32_bf16 a[172:175], v[108:111], v[148:151], a[172:175]
    v_mfma_f32_16x16x32_bf16 a[176:179], v[112:115], v[148:151], a[176:179]
    ds_read_b128 v[56:59], v8 offset:45056
    v_and_b32 v210, s52, v190
    v_mfma_f32_16x16x32_bf16 a[180:183], v[116:119], v[148:151], a[180:183]
    v_and_b32 v211, s52, v192
    v_and_b32 v212, s52, v194
    v_mfma_f32_16x16x32_bf16 a[184:187], v[120:123], v[148:151], a[184:187]
    ds_read_b128 v[60:63], v8 offset:47104
    v_and_b32 v213, s52, v196
    v_mfma_f32_16x16x32_bf16 a[188:191], v[124:127], v[148:151], a[188:191]
    v_mfma_f32_16x16x32_bf16 a[192:195], v[96:99], v[152:155], a[192:195]
    v_mul_f32 v221, v221, v206
    v_mul_f32 v222, v222, v207
    v_mfma_f32_16x16x32_bf16 a[196:199], v[100:103], v[152:155], a[196:199]
    v_mul_f32 v223, v223, v208
    v_mul_f32 v224, v224, v209
    v_mfma_f32_16x16x32_bf16 a[200:203], v[104:107], v[152:155], a[200:203]
    v_mul_f32 v225, v225, v210
    v_mul_f32 v226, v226, v211
    v_mfma_f32_16x16x32_bf16 a[204:207], v[108:111], v[152:155], a[204:207]
    v_mfma_f32_16x16x32_bf16 a[208:211], v[112:115], v[152:155], a[208:211]
    v_mul_f32 v227, v227, v212
    v_mul_f32 v228, v228, v213
    v_mfma_f32_16x16x32_bf16 a[212:215], v[116:119], v[152:155], a[212:215]
    v_cvt_pk_bf16_f32 v248, v228, v227
    v_cvt_pk_bf16_f32 v249, v226, v225
    v_mfma_f32_16x16x32_bf16 a[216:219], v[120:123], v[152:155], a[216:219]
    v_cvt_pk_bf16_f32 v250, v224, v223
    v_cvt_pk_bf16_f32 v251, v222, v221
    v_mfma_f32_16x16x32_bf16 a[220:223], v[124:127], v[152:155], a[220:223]
    buffer_store_dwordx4 v[248:251], v234, s[16:19], s54 offen sc1
    v_mfma_f32_16x16x32_bf16 a[224:227], v[96:99], v[156:159], a[224:227]
    s_movk_i32 s54, 9216
    v_lshlrev_b32 v206, 16, v161
    v_lshlrev_b32 v207, 16, v163
    v_mfma_f32_16x16x32_bf16 a[228:231], v[100:103], v[156:159], a[228:231]
    v_lshlrev_b32 v208, 16, v165
    v_lshlrev_b32 v209, 16, v167
    v_mfma_f32_16x16x32_bf16 a[232:235], v[104:107], v[156:159], a[232:235]
    v_lshlrev_b32 v210, 16, v169
    v_lshlrev_b32 v211, 16, v171
    v_mfma_f32_16x16x32_bf16 a[236:239], v[108:111], v[156:159], a[236:239]
    v_mfma_f32_16x16x32_bf16 a[240:243], v[112:115], v[156:159], a[240:243]
    v_lshlrev_b32 v212, 16, v173
    v_lshlrev_b32 v213, 16, v175
    v_mfma_f32_16x16x32_bf16 a[244:247], v[116:119], v[156:159], a[244:247]
    v_lshlrev_b32 v214, 16, v177
    v_lshlrev_b32 v215, 16, v179
    v_mfma_f32_16x16x32_bf16 a[248:251], v[120:123], v[156:159], a[248:251]
    v_lshlrev_b32 v216, 16, v181
    v_lshlrev_b32 v217, 16, v202
    v_mfma_f32_16x16x32_bf16 a[252:255], v[124:127], v[156:159], a[252:255]
    s_waitcnt vmcnt(18) lgkmcnt(0)
    s_barrier
    v_and_b32 v218, s52, v202
    v_lshlrev_b32 v219, 16, v203
    v_mfma_f32_16x16x32_bf16 a[0:3], v[64:67], v[32:35], a[0:3]
    ds_read_b64_tr_b16 v[128:129], v10 offset:49152
    v_and_b32 v220, s52, v203
    v_mfma_f32_16x16x32_bf16 a[4:7], v[64:67], v[36:39], a[4:7]
    s_add_u32 s36, s45, 128
    v_mul_f32 v221, v209, v217
    v_mul_f32 v222, v210, v217
    v_mfma_f32_16x16x32_bf16 a[8:11], v[64:67], v[40:43], a[8:11]
    s_add_u32 m0, s42, 4096
    ds_read_b64_tr_b16 v[130:131], v10 offset:50176
    v_mul_f32 v223, v211, v217
    v_mfma_f32_16x16x32_bf16 a[12:15], v[64:67], v[44:47], a[12:15]
    buffer_load_dwordx4 v17, s[24:27], s36 offen offset:0 lds
    v_mfma_f32_16x16x32_bf16 a[16:19], v[64:67], v[48:51], a[16:19]
    ds_read_b64_tr_b16 v[132:133], v11 offset:49152
    v_mul_f32 v224, v212, v217
    v_mfma_f32_16x16x32_bf16 a[20:23], v[64:67], v[52:55], a[20:23]
    v_mul_f32 v225, v213, v217
    v_mul_f32 v226, v214, v217
    v_mfma_f32_16x16x32_bf16 a[24:27], v[64:67], v[56:59], a[24:27]
    ds_read_b64_tr_b16 v[134:135], v11 offset:50176
    v_mul_f32 v227, v215, v217
    v_mfma_f32_16x16x32_bf16 a[28:31], v[64:67], v[60:63], a[28:31]
    buffer_load_dwordx4 v18, s[24:27], s36 offen offset:1024 lds
    v_mfma_f32_16x16x32_bf16 a[32:35], v[68:71], v[32:35], a[32:35]
    ds_read_b128 v[96:99], v9 offset:32768
    v_mul_f32 v228, v216, v217
    v_mfma_f32_16x16x32_bf16 a[36:39], v[68:71], v[36:39], a[36:39]
    v_fmac_f32 v221, v208, v218
    v_fmac_f32 v222, v209, v218
    v_mfma_f32_16x16x32_bf16 a[40:43], v[68:71], v[40:43], a[40:43]
    ds_read_b64_tr_b16 v[136:137], v12 offset:49152
    v_fmac_f32 v223, v210, v218
    v_mfma_f32_16x16x32_bf16 a[44:47], v[68:71], v[44:47], a[44:47]
    buffer_load_dwordx4 v19, s[24:27], s36 offen offset:2048 lds
    v_mfma_f32_16x16x32_bf16 a[48:51], v[68:71], v[48:51], a[48:51]
    ds_read_b64_tr_b16 v[138:139], v12 offset:50176
    v_fmac_f32 v224, v211, v218
    v_mfma_f32_16x16x32_bf16 a[52:55], v[68:71], v[52:55], a[52:55]
    v_fmac_f32 v225, v212, v218
    v_fmac_f32 v226, v213, v218
    v_mfma_f32_16x16x32_bf16 a[56:59], v[68:71], v[56:59], a[56:59]
    ds_read_b128 v[100:103], v9 offset:34816
    v_fmac_f32 v227, v214, v218
    v_mfma_f32_16x16x32_bf16 a[60:63], v[68:71], v[60:63], a[60:63]
    buffer_load_dwordx4 v20, s[24:27], s36 offen offset:3072 lds
    v_mfma_f32_16x16x32_bf16 a[64:67], v[72:75], v[32:35], a[64:67]
    ds_read_b64_tr_b16 v[140:141], v13 offset:49152
    v_fmac_f32 v228, v215, v218
    v_mfma_f32_16x16x32_bf16 a[68:71], v[72:75], v[36:39], a[68:71]
    s_add_u32 s37, s49, 786432
    v_fmac_f32 v221, v207, v219
    v_fmac_f32 v222, v208, v219
    v_mfma_f32_16x16x32_bf16 a[72:75], v[72:75], v[40:43], a[72:75]
    s_add_u32 m0, s50, 26112
    ds_read_b64_tr_b16 v[142:143], v13 offset:50176
    v_fmac_f32 v223, v209, v219
    v_mfma_f32_16x16x32_bf16 a[76:79], v[72:75], v[44:47], a[76:79]
    buffer_load_dwordx4 v21, s[20:23], s37 offen offset:0 lds
    v_mfma_f32_16x16x32_bf16 a[80:83], v[72:75], v[48:51], a[80:83]
    ds_read_b128 v[104:107], v9 offset:36864
    v_fmac_f32 v224, v210, v219
    v_mfma_f32_16x16x32_bf16 a[84:87], v[72:75], v[52:55], a[84:87]
    v_fmac_f32 v225, v211, v219
    v_fmac_f32 v226, v212, v219
    v_mfma_f32_16x16x32_bf16 a[88:91], v[72:75], v[56:59], a[88:91]
    ds_read_b64_tr_b16 v[144:145], v10 offset:51200
    v_fmac_f32 v227, v213, v219
    v_mfma_f32_16x16x32_bf16 a[92:95], v[72:75], v[60:63], a[92:95]
    buffer_load_dwordx4 v22, s[20:23], s37 offen offset:1024 lds
    v_mfma_f32_16x16x32_bf16 a[96:99], v[76:79], v[32:35], a[96:99]
    ds_read_b64_tr_b16 v[146:147], v10 offset:52224
    v_fmac_f32 v228, v214, v219
    v_mfma_f32_16x16x32_bf16 a[100:103], v[76:79], v[36:39], a[100:103]
    s_add_u32 s37, s49, 1048576
    v_fmac_f32 v221, v206, v220
    v_fmac_f32 v222, v207, v220
    v_mfma_f32_16x16x32_bf16 a[104:107], v[76:79], v[40:43], a[104:107]
    s_add_u32 m0, s50, 34816
    ds_read_b128 v[108:111], v9 offset:38912
    v_fmac_f32 v223, v208, v220
    v_mfma_f32_16x16x32_bf16 a[108:111], v[76:79], v[44:47], a[108:111]
    buffer_load_dwordx4 v21, s[20:23], s37 offen offset:0 lds
    v_mfma_f32_16x16x32_bf16 a[112:115], v[76:79], v[48:51], a[112:115]
    ds_read_b64_tr_b16 v[148:149], v11 offset:51200
    v_fmac_f32 v224, v209, v220
    v_mfma_f32_16x16x32_bf16 a[116:119], v[76:79], v[52:55], a[116:119]
    v_fmac_f32 v225, v210, v220
    v_fmac_f32 v226, v211, v220
    v_mfma_f32_16x16x32_bf16 a[120:123], v[76:79], v[56:59], a[120:123]
    ds_read_b64_tr_b16 v[150:151], v11 offset:52224
    v_fmac_f32 v227, v212, v220
    v_mfma_f32_16x16x32_bf16 a[124:127], v[76:79], v[60:63], a[124:127]
    buffer_load_dwordx4 v22, s[20:23], s37 offen offset:1024 lds
    v_mfma_f32_16x16x32_bf16 a[128:131], v[32:35], v[80:83], a[128:131]
    ds_read_b128 v[112:115], v9 offset:40960
    v_fmac_f32 v228, v213, v220
    v_mfma_f32_16x16x32_bf16 a[132:135], v[36:39], v[80:83], a[132:135]
    v_lshlrev_b32 v206, 16, v183
    v_lshlrev_b32 v207, 16, v185
    v_mfma_f32_16x16x32_bf16 a[136:139], v[40:43], v[80:83], a[136:139]
    ds_read_b64_tr_b16 v[152:153], v12 offset:51200
    v_lshlrev_b32 v208, 16, v187
    v_mfma_f32_16x16x32_bf16 a[140:143], v[44:47], v[80:83], a[140:143]
    v_mfma_f32_16x16x32_bf16 a[144:147], v[48:51], v[80:83], a[144:147]
    ds_read_b64_tr_b16 v[154:155], v12 offset:52224
    v_lshlrev_b32 v209, 16, v189
    v_mfma_f32_16x16x32_bf16 a[148:151], v[52:55], v[80:83], a[148:151]
    v_lshlrev_b32 v210, 16, v191
    v_lshlrev_b32 v211, 16, v193
    v_mfma_f32_16x16x32_bf16 a[152:155], v[56:59], v[80:83], a[152:155]
    ds_read_b128 v[116:119], v9 offset:43008
    v_lshlrev_b32 v212, 16, v195
    v_mfma_f32_16x16x32_bf16 a[156:159], v[60:63], v[80:83], a[156:159]
    v_mfma_f32_16x16x32_bf16 a[160:163], v[32:35], v[84:87], a[160:163]
    ds_read_b64_tr_b16 v[156:157], v13 offset:51200
    v_lshlrev_b32 v213, 16, v197
    v_mfma_f32_16x16x32_bf16 a[164:167], v[36:39], v[84:87], a[164:167]
    v_mul_f32 v221, v221, v206
    v_mul_f32 v222, v222, v207
    v_mfma_f32_16x16x32_bf16 a[168:171], v[40:43], v[84:87], a[168:171]
    ds_read_b64_tr_b16 v[158:159], v13 offset:52224
    v_mul_f32 v223, v223, v208
    v_mfma_f32_16x16x32_bf16 a[172:175], v[44:47], v[84:87], a[172:175]
    v_mfma_f32_16x16x32_bf16 a[176:179], v[48:51], v[84:87], a[176:179]
    ds_read_b128 v[120:123], v9 offset:45056
    v_mul_f32 v224, v224, v209
    v_mfma_f32_16x16x32_bf16 a[180:183], v[52:55], v[84:87], a[180:183]
    v_mul_f32 v225, v225, v210
    v_mul_f32 v226, v226, v211
    v_mfma_f32_16x16x32_bf16 a[184:187], v[56:59], v[84:87], a[184:187]
    ds_read_b128 v[124:127], v9 offset:47104
    v_mul_f32 v227, v227, v212
    v_mfma_f32_16x16x32_bf16 a[188:191], v[60:63], v[84:87], a[188:191]
    v_mfma_f32_16x16x32_bf16 a[192:195], v[32:35], v[88:91], a[192:195]
    v_mul_f32 v228, v228, v213
    v_cvt_pk_bf16_f32 v244, v228, v227
    v_mfma_f32_16x16x32_bf16 a[196:199], v[36:39], v[88:91], a[196:199]
    v_cvt_pk_bf16_f32 v245, v226, v225
    v_cvt_pk_bf16_f32 v246, v224, v223
    v_mfma_f32_16x16x32_bf16 a[200:203], v[40:43], v[88:91], a[200:203]
    v_cvt_pk_bf16_f32 v247, v222, v221
    v_and_b32 v206, s52, v161
    v_mfma_f32_16x16x32_bf16 a[204:207], v[44:47], v[88:91], a[204:207]
    buffer_store_dwordx4 v[244:247], v234, s[16:19], s54 offen sc1
    v_mfma_f32_16x16x32_bf16 a[208:211], v[48:51], v[88:91], a[208:211]
    s_movk_i32 s54, 13824
    v_and_b32 v207, s52, v163
    v_and_b32 v208, s52, v165
    v_mfma_f32_16x16x32_bf16 a[212:215], v[52:55], v[88:91], a[212:215]
    v_and_b32 v209, s52, v167
    v_and_b32 v210, s52, v169
    v_mfma_f32_16x16x32_bf16 a[216:219], v[56:59], v[88:91], a[216:219]
    v_and_b32 v211, s52, v171
    v_and_b32 v212, s52, v173
    v_mfma_f32_16x16x32_bf16 a[220:223], v[60:63], v[88:91], a[220:223]
    v_mfma_f32_16x16x32_bf16 a[224:227], v[32:35], v[92:95], a[224:227]
    v_and_b32 v213, s52, v175
    v_and_b32 v214, s52, v177
    v_mfma_f32_16x16x32_bf16 a[228:231], v[36:39], v[92:95], a[228:231]
    v_and_b32 v215, s52, v179
    v_and_b32 v216, s52, v181
    v_mfma_f32_16x16x32_bf16 a[232:235], v[40:43], v[92:95], a[232:235]
    v_lshlrev_b32 v217, 16, v204
    v_and_b32 v218, s52, v204
    v_mfma_f32_16x16x32_bf16 a[236:239], v[44:47], v[92:95], a[236:239]
    v_mfma_f32_16x16x32_bf16 a[240:243], v[48:51], v[92:95], a[240:243]
    v_lshlrev_b32 v219, 16, v205
    v_and_b32 v220, s52, v205
    v_mfma_f32_16x16x32_bf16 a[244:247], v[52:55], v[92:95], a[244:247]
    v_mul_f32 v221, v209, v217
    v_mul_f32 v222, v210, v217
    v_mfma_f32_16x16x32_bf16 a[248:251], v[56:59], v[92:95], a[248:251]
    v_mul_f32 v223, v211, v217
    v_mul_f32 v224, v212, v217
    v_mfma_f32_16x16x32_bf16 a[252:255], v[60:63], v[92:95], a[252:255]
    s_waitcnt vmcnt(19) lgkmcnt(0)
    s_barrier
    v_mul_f32 v225, v213, v217
    v_mul_f32 v226, v214, v217
    v_mfma_f32_16x16x32_bf16 a[0:3], v[128:131], v[96:99], a[0:3]
    ds_read_b64_tr_b16 v[48:49], v27 offset:0
    v_mul_f32 v227, v215, v217
    v_mfma_f32_16x16x32_bf16 a[4:7], v[128:131], v[100:103], a[4:7]
    s_add_u32 s36, s44, 256
    v_mul_f32 v228, v216, v217
    v_fmac_f32 v221, v208, v218
    v_mfma_f32_16x16x32_bf16 a[8:11], v[128:131], v[104:107], a[8:11]
    s_add_u32 m0, s42, 32768
    ds_read_b64_tr_b16 v[50:51], v27 offset:1024
    v_fmac_f32 v222, v209, v218
    v_mfma_f32_16x16x32_bf16 a[12:15], v[128:131], v[108:111], a[12:15]
    buffer_load_dwordx4 v17, s[24:27], s36 offen offset:0 lds
    v_mfma_f32_16x16x32_bf16 a[16:19], v[128:131], v[112:115], a[16:19]
    ds_read_b128 v[32:35], v25 offset:0
    v_fmac_f32 v223, v210, v218
    v_mfma_f32_16x16x32_bf16 a[20:23], v[128:131], v[116:119], a[20:23]
    v_fmac_f32 v224, v211, v218
    v_fmac_f32 v225, v212, v218
    v_mfma_f32_16x16x32_bf16 a[24:27], v[128:131], v[120:123], a[24:27]
    ds_read_b128 v[36:39], v25 offset:2048
    v_fmac_f32 v226, v213, v218
    v_mfma_f32_16x16x32_bf16 a[28:31], v[128:131], v[124:127], a[28:31]
    buffer_load_dwordx4 v18, s[24:27], s36 offen offset:1024 lds
    v_mfma_f32_16x16x32_bf16 a[32:35], v[132:135], v[96:99], a[32:35]
    ds_read_b128 v[40:43], v25 offset:4096
    v_fmac_f32 v227, v214, v218
    v_mfma_f32_16x16x32_bf16 a[36:39], v[132:135], v[100:103], a[36:39]
    v_fmac_f32 v228, v215, v218
    v_fmac_f32 v221, v207, v219
    v_mfma_f32_16x16x32_bf16 a[40:43], v[132:135], v[104:107], a[40:43]
    ds_read_b128 v[44:47], v25 offset:6144
    v_fmac_f32 v222, v208, v219
    v_mfma_f32_16x16x32_bf16 a[44:47], v[132:135], v[108:111], a[44:47]
    buffer_load_dwordx4 v19, s[24:27], s36 offen offset:2048 lds
    v_mfma_f32_16x16x32_bf16 a[48:51], v[132:135], v[112:115], a[48:51]
    ds_read_b64_tr_b16 v[52:53], v28 offset:0
    v_fmac_f32 v223, v209, v219
    v_mfma_f32_16x16x32_bf16 a[52:55], v[132:135], v[116:119], a[52:55]
    v_fmac_f32 v224, v210, v219
    v_fmac_f32 v225, v211, v219
    v_mfma_f32_16x16x32_bf16 a[56:59], v[132:135], v[120:123], a[56:59]
    ds_read_b64_tr_b16 v[54:55], v28 offset:1024
    v_fmac_f32 v226, v212, v219
    v_mfma_f32_16x16x32_bf16 a[60:63], v[132:135], v[124:127], a[60:63]
    buffer_load_dwordx4 v20, s[24:27], s36 offen offset:3072 lds
    v_mfma_f32_16x16x32_bf16 a[64:67], v[136:139], v[96:99], a[64:67]
    ds_read_b64_tr_b16 v[56:57], v29 offset:0
    v_fmac_f32 v227, v213, v219
    v_mfma_f32_16x16x32_bf16 a[68:71], v[136:139], v[100:103], a[68:71]
    v_fmac_f32 v228, v214, v219
    v_fmac_f32 v221, v206, v220
    v_mfma_f32_16x16x32_bf16 a[72:75], v[136:139], v[104:107], a[72:75]
    ds_read_b64_tr_b16 v[58:59], v29 offset:1024
    v_fmac_f32 v222, v207, v220
    v_mfma_f32_16x16x32_bf16 a[76:79], v[136:139], v[108:111], a[76:79]
    v_mfma_f32_16x16x32_bf16 a[80:83], v[136:139], v[112:115], a[80:83]
    ds_read_b64_tr_b16 v[60:61], v30 offset:0
    v_fmac_f32 v223, v208, v220
    v_mfma_f32_16x16x32_bf16 a[84:87], v[136:139], v[116:119], a[84:87]
    v_fmac_f32 v224, v209, v220
    v_fmac_f32 v225, v210, v220
    v_mfma_f32_16x16x32_bf16 a[88:91], v[136:139], v[120:123], a[88:91]
    ds_read_b64_tr_b16 v[62:63], v30 offset:1024
    v_fmac_f32 v226, v211, v220
    v_mfma_f32_16x16x32_bf16 a[92:95], v[136:139], v[124:127], a[92:95]
    v_mfma_f32_16x16x32_bf16 a[96:99], v[140:143], v[96:99], a[96:99]
    ds_read_b64_tr_b16 v[64:65], v27 offset:128
    v_fmac_f32 v227, v212, v220
    v_mfma_f32_16x16x32_bf16 a[100:103], v[140:143], v[100:103], a[100:103]
    v_fmac_f32 v228, v213, v220
    v_and_b32 v206, s52, v183
    v_mfma_f32_16x16x32_bf16 a[104:107], v[140:143], v[104:107], a[104:107]
    ds_read_b64_tr_b16 v[66:67], v27 offset:1152
    v_and_b32 v207, s52, v185
    v_mfma_f32_16x16x32_bf16 a[108:111], v[140:143], v[108:111], a[108:111]
    v_mfma_f32_16x16x32_bf16 a[112:115], v[140:143], v[112:115], a[112:115]
    ds_read_b64_tr_b16 v[68:69], v28 offset:128
    v_and_b32 v208, s52, v187
    v_mfma_f32_16x16x32_bf16 a[116:119], v[140:143], v[116:119], a[116:119]
    v_and_b32 v209, s52, v189
    v_and_b32 v210, s52, v191
    v_mfma_f32_16x16x32_bf16 a[120:123], v[140:143], v[120:123], a[120:123]
    ds_read_b64_tr_b16 v[70:71], v28 offset:1152
    v_and_b32 v211, s52, v193
    v_mfma_f32_16x16x32_bf16 a[124:127], v[140:143], v[124:127], a[124:127]
    v_mfma_f32_16x16x32_bf16 a[128:131], v[96:99], v[144:147], a[128:131]
    ds_read_b64_tr_b16 v[72:73], v29 offset:128
    v_and_b32 v212, s52, v195
    v_mfma_f32_16x16x32_bf16 a[132:135], v[100:103], v[144:147], a[132:135]
    v_and_b32 v213, s52, v197
    v_mul_f32 v221, v221, v206
    v_mfma_f32_16x16x32_bf16 a[136:139], v[104:107], v[144:147], a[136:139]
    ds_read_b64_tr_b16 v[74:75], v29 offset:1152
    v_mul_f32 v222, v222, v207
    v_mfma_f32_16x16x32_bf16 a[140:143], v[108:111], v[144:147], a[140:143]
    v_mfma_f32_16x16x32_bf16 a[144:147], v[112:115], v[144:147], a[144:147]
    ds_read_b64_tr_b16 v[76:77], v30 offset:128
    v_mul_f32 v223, v223, v208
    v_mfma_f32_16x16x32_bf16 a[148:151], v[116:119], v[144:147], a[148:151]
    v_mul_f32 v224, v224, v209
    v_mul_f32 v225, v225, v210
    v_mfma_f32_16x16x32_bf16 a[152:155], v[120:123], v[144:147], a[152:155]
    ds_read_b64_tr_b16 v[78:79], v30 offset:1152
    v_mul_f32 v226, v226, v211
    v_mfma_f32_16x16x32_bf16 a[156:159], v[124:127], v[144:147], a[156:159]
    v_mfma_f32_16x16x32_bf16 a[160:163], v[96:99], v[148:151], a[160:163]
    v_mul_f32 v227, v227, v212
    v_mul_f32 v228, v228, v213
    v_mfma_f32_16x16x32_bf16 a[164:167], v[100:103], v[148:151], a[164:167]
    v_cvt_pk_bf16_f32 v248, v228, v227
    v_cvt_pk_bf16_f32 v249, v226, v225
    v_mfma_f32_16x16x32_bf16 a[168:171], v[104:107], v[148:151], a[168:171]
    v_cvt_pk_bf16_f32 v250, v224, v223
    v_cvt_pk_bf16_f32 v251, v222, v221
    v_mfma_f32_16x16x32_bf16 a[172:175], v[108:111], v[148:151], a[172:175]
    buffer_store_dwordx4 v[248:251], v234, s[16:19], s54 offen sc1
    v_mfma_f32_16x16x32_bf16 a[176:179], v[112:115], v[148:151], a[176:179]
    v_mov_b32 v160, 0
    v_mov_b32 v161, 0
    v_mfma_f32_16x16x32_bf16 a[180:183], v[116:119], v[148:151], a[180:183]
    v_mov_b32 v162, 0
    v_mov_b32 v163, 0
    v_mfma_f32_16x16x32_bf16 a[184:187], v[120:123], v[148:151], a[184:187]
    v_mfma_f32_16x16x32_bf16 a[188:191], v[124:127], v[148:151], a[188:191]
    buffer_store_dwordx4 v[160:163], v235, s[16:19], s53 offen sc1
    v_mfma_f32_16x16x32_bf16 a[192:195], v[96:99], v[152:155], a[192:195]
    v_mfma_f32_16x16x32_bf16 a[196:199], v[100:103], v[152:155], a[196:199]
    v_mfma_f32_16x16x32_bf16 a[200:203], v[104:107], v[152:155], a[200:203]
    v_mfma_f32_16x16x32_bf16 a[204:207], v[108:111], v[152:155], a[204:207]
    v_mfma_f32_16x16x32_bf16 a[208:211], v[112:115], v[152:155], a[208:211]
    v_mfma_f32_16x16x32_bf16 a[212:215], v[116:119], v[152:155], a[212:215]
    v_mfma_f32_16x16x32_bf16 a[216:219], v[120:123], v[152:155], a[216:219]
    v_mfma_f32_16x16x32_bf16 a[220:223], v[124:127], v[152:155], a[220:223]
    v_mfma_f32_16x16x32_bf16 a[224:227], v[96:99], v[156:159], a[224:227]
    v_mfma_f32_16x16x32_bf16 a[228:231], v[100:103], v[156:159], a[228:231]
    v_mfma_f32_16x16x32_bf16 a[232:235], v[104:107], v[156:159], a[232:235]
    v_mfma_f32_16x16x32_bf16 a[236:239], v[108:111], v[156:159], a[236:239]
    v_mfma_f32_16x16x32_bf16 a[240:243], v[112:115], v[156:159], a[240:243]
    v_mfma_f32_16x16x32_bf16 a[244:247], v[116:119], v[156:159], a[244:247]
    v_mfma_f32_16x16x32_bf16 a[248:251], v[120:123], v[156:159], a[248:251]
    v_mfma_f32_16x16x32_bf16 a[252:255], v[124:127], v[156:159], a[252:255]
    s_waitcnt vmcnt(19) lgkmcnt(0)
    s_barrier
    v_mfma_f32_16x16x32_bf16 v[128:131], v[48:51], v[32:35], 0
    s_lshl_b32 s38, s33, 6
    ds_read_b64_tr_b16 v[96:97], v27 offset:8704
    ds_read_b64_tr_b16 v[98:99], v27 offset:9728
    v_mfma_f32_16x16x32_bf16 v[160:163], v[48:51], v[36:39], 0
    s_add_u32 s36, s45, 256
    v_mfma_f32_16x16x32_bf16 v[192:195], v[48:51], v[40:43], 0
    s_add_u32 m0, s42, 36864
    ds_read_b128 v[80:83], v26 offset:0
    ds_read_b128 v[84:87], v26 offset:2048
    v_mfma_f32_16x16x32_bf16 v[224:227], v[48:51], v[44:47], 0
    buffer_load_dwordx4 v17, s[24:27], s36 offen offset:0 lds
    v_mfma_f32_16x16x32_bf16 v[132:135], v[52:55], v[32:35], 0
    s_lshl_b32 s54, s34, 3
    ds_read_b128 v[88:91], v26 offset:4096
    ds_read_b128 v[92:95], v26 offset:6144
    v_mfma_f32_16x16x32_bf16 v[164:167], v[52:55], v[36:39], 0
    s_add_u32 s38, s38, s54
    v_accvgpr_read_b32 v4, a132
    v_accvgpr_read_b32 v5, a133
    v_mfma_f32_16x16x32_bf16 v[196:199], v[52:55], v[40:43], 0
    s_lshr_b32 s54, s32, 1
    ds_read_b64_tr_b16 v[100:101], v28 offset:8704
    ds_read_b64_tr_b16 v[102:103], v28 offset:9728
    v_mfma_f32_16x16x32_bf16 v[228:231], v[52:55], v[44:47], 0
    buffer_load_dwordx4 v18, s[24:27], s36 offen offset:1024 lds
    v_mfma_f32_16x16x32_bf16 v[136:139], v[56:59], v[32:35], 0
    s_lshl_b32 s54, s54, 2
    ds_read_b64_tr_b16 v[104:105], v29 offset:8704
    ds_read_b64_tr_b16 v[106:107], v29 offset:9728
    v_mfma_f32_16x16x32_bf16 v[168:171], v[56:59], v[36:39], 0
    s_add_u32 s38, s38, s54
    v_accvgpr_read_b32 v6, a134
    v_accvgpr_read_b32 v7, a135
    v_mfma_f32_16x16x32_bf16 v[200:203], v[56:59], v[40:43], 0
    s_lshl_b32 s38, s38, 14
    ds_read_b64_tr_b16 v[108:109], v30 offset:8704
    ds_read_b64_tr_b16 v[110:111], v30 offset:9728
    v_mfma_f32_16x16x32_bf16 v[232:235], v[56:59], v[44:47], 0
    v_mfma_f32_16x16x32_bf16 v[140:143], v[60:63], v[32:35], 0
    s_and_b32 s54, s32, 1
    ds_read_b64_tr_b16 v[112:113], v27 offset:8832
    ds_read_b64_tr_b16 v[114:115], v27 offset:9856
    v_mfma_f32_16x16x32_bf16 v[172:175], v[60:63], v[36:39], 0
    s_lshl_b32 s54, s54, 11
    v_accvgpr_read_b32 v0, a128
    v_accvgpr_read_b32 v1, a129
    v_mfma_f32_16x16x32_bf16 v[204:207], v[60:63], v[40:43], 0
    s_add_u32 s41, s38, s54
    ds_read_b64_tr_b16 v[116:117], v28 offset:8832
    ds_read_b64_tr_b16 v[118:119], v28 offset:9856
    v_mfma_f32_16x16x32_bf16 v[236:239], v[60:63], v[44:47], 0
    buffer_load_dwordx4 v19, s[24:27], s36 offen offset:2048 lds
    v_mfma_f32_16x16x32_bf16 v[144:147], v[64:67], v[32:35], 0
    s_add_u32 s38, s41, s54
    ds_read_b64_tr_b16 v[120:121], v29 offset:8832
    ds_read_b64_tr_b16 v[122:123], v29 offset:9856
    v_mfma_f32_16x16x32_bf16 v[176:179], v[64:67], v[36:39], 0
    s_add_u32 s38, s38, 8192
    v_accvgpr_read_b32 v2, a130
    v_accvgpr_read_b32 v3, a131
    v_mfma_f32_16x16x32_bf16 v[208:211], v[64:67], v[40:43], 0
    s_mov_b32 s40, 0x3e0293ee
    ds_read_b64_tr_b16 v[124:125], v30 offset:8832
    ds_read_b64_tr_b16 v[126:127], v30 offset:9856
    v_mfma_f32_16x16x32_bf16 v[240:243], v[64:67], v[44:47], 0
    s_mov_b32 s16, s94
    v_cvt_pk_bf16_f32 v0, v0, v1
    v_cvt_pk_bf16_f32 v1, v2, v3
    v_mfma_f32_16x16x32_bf16 v[148:151], v[68:71], v[32:35], 0
    s_mov_b32 s17, s95
    v_cvt_pk_bf16_f32 v2, v4, v5
    v_cvt_pk_bf16_f32 v3, v6, v7
    v_mfma_f32_16x16x32_bf16 v[180:183], v[68:71], v[36:39], 0
gated_mix__ssm_conv_h3__compressed_kv_cla__prompt_kernel_pad3:
    s_cbranch_execz gated_mix__ssm_conv_h3__compressed_kv_cla__prompt_kernel_pad7
    buffer_load_dwordx4 v20, s[24:27], s36 offen offset:3072 lds
    v_mfma_f32_16x16x32_bf16 v[212:215], v[68:71], v[40:43], 0
    s_add_u32 s37, s49, 1310720
    v_accvgpr_read_b32 v12, a32
    v_accvgpr_read_b32 v13, a33
    v_mfma_f32_16x16x32_bf16 v[244:247], v[68:71], v[44:47], 0
    s_add_u32 m0, s50, 43520
    v_accvgpr_read_b32 v14, a34
    v_accvgpr_read_b32 v15, a35
    v_mfma_f32_16x16x32_bf16 v[152:155], v[72:75], v[32:35], 0
    buffer_load_dwordx4 v21, s[20:23], s37 offen offset:0 lds
    v_mfma_f32_16x16x32_bf16 v[184:187], v[72:75], v[36:39], 0
    s_mov_b32 s18, 33554432
    v_accvgpr_read_b32 v8, a0
    v_accvgpr_read_b32 v9, a1
    v_mfma_f32_16x16x32_bf16 v[216:219], v[72:75], v[40:43], 0
    v_accvgpr_read_b32 v10, a2
    v_accvgpr_read_b32 v11, a3
    v_mfma_f32_16x16x32_bf16 v[248:251], v[72:75], v[44:47], 0
    buffer_store_dwordx4 v[0:3], v16, s[16:19], s38 offen offset:0
    v_mfma_f32_16x16x32_bf16 v[156:159], v[76:79], v[32:35], 0
    v_mul_f32 v8, s40, v8
    v_mul_f32 v9, s40, v9
    v_mfma_f32_16x16x32_bf16 v[188:191], v[76:79], v[36:39], 0
    v_mul_f32 v10, s40, v10
    v_mul_f32 v11, s40, v11
    v_mfma_f32_16x16x32_bf16 v[220:223], v[76:79], v[40:43], 0
    buffer_load_dwordx4 v22, s[20:23], s37 offen offset:1024 lds
    v_mfma_f32_16x16x32_bf16 v[252:255], v[76:79], v[44:47], 0
    s_waitcnt vmcnt(16) lgkmcnt(0)
    s_barrier
    v_mul_f32 v12, s40, v12
    v_mul_f32 v13, s40, v13
    v_mfma_f32_16x16x32_bf16 v[128:131], v[96:99], v[80:83], v[128:131]
    ds_read_b64_tr_b16 v[48:49], v27 offset:17408
    ds_read_b64_tr_b16 v[50:51], v27 offset:18432
    v_mfma_f32_16x16x32_bf16 v[160:163], v[96:99], v[84:87], v[160:163]
    s_add_u32 s36, s44, 384
    v_mul_f32 v14, s40, v14
    v_mul_f32 v15, s40, v15
    v_mfma_f32_16x16x32_bf16 v[192:195], v[96:99], v[88:91], v[192:195]
    s_add_u32 m0, s42, 65536
    ds_read_b128 v[32:35], v23 offset:0
    ds_read_b128 v[36:39], v23 offset:2048
    v_mfma_f32_16x16x32_bf16 v[224:227], v[96:99], v[92:95], v[224:227]
    buffer_load_dwordx4 v17, s[24:27], s36 offen offset:0 lds
    v_mfma_f32_16x16x32_bf16 v[132:135], v[100:103], v[80:83], v[132:135]
    ds_read_b128 v[40:43], v23 offset:4096
    ds_read_b128 v[44:47], v23 offset:6144
    v_mfma_f32_16x16x32_bf16 v[164:167], v[100:103], v[84:87], v[164:167]
    v_cvt_pk_bf16_f32 v8, v8, v9
    v_cvt_pk_bf16_f32 v9, v10, v11
    v_mfma_f32_16x16x32_bf16 v[196:199], v[100:103], v[88:91], v[196:199]
    ds_read_b64_tr_b16 v[52:53], v28 offset:17408
    ds_read_b64_tr_b16 v[54:55], v28 offset:18432
    v_mfma_f32_16x16x32_bf16 v[228:231], v[100:103], v[92:95], v[228:231]
    buffer_load_dwordx4 v18, s[24:27], s36 offen offset:1024 lds
    v_mfma_f32_16x16x32_bf16 v[136:139], v[104:107], v[80:83], v[136:139]
    ds_read_b64_tr_b16 v[56:57], v29 offset:17408
    ds_read_b64_tr_b16 v[58:59], v29 offset:18432
    v_mfma_f32_16x16x32_bf16 v[168:171], v[104:107], v[84:87], v[168:171]
    v_cvt_pk_bf16_f32 v10, v12, v13
    v_cvt_pk_bf16_f32 v11, v14, v15
    v_mfma_f32_16x16x32_bf16 v[200:203], v[104:107], v[88:91], v[200:203]
    ds_read_b64_tr_b16 v[60:61], v30 offset:17408
    ds_read_b64_tr_b16 v[62:63], v30 offset:18432
    v_mfma_f32_16x16x32_bf16 v[232:235], v[104:107], v[92:95], v[232:235]
    buffer_store_dwordx4 v[8:11], v16, s[16:19], s41 offen offset:0
    v_mfma_f32_16x16x32_bf16 v[140:143], v[108:111], v[80:83], v[140:143]
    ds_read_b64_tr_b16 v[64:65], v27 offset:17536
    ds_read_b64_tr_b16 v[66:67], v27 offset:18560
    v_mfma_f32_16x16x32_bf16 v[172:175], v[108:111], v[84:87], v[172:175]
    v_accvgpr_read_b32 v4, a164
    v_accvgpr_read_b32 v5, a165
    v_mfma_f32_16x16x32_bf16 v[204:207], v[108:111], v[88:91], v[204:207]
    ds_read_b64_tr_b16 v[68:69], v28 offset:17536
    ds_read_b64_tr_b16 v[70:71], v28 offset:18560
    v_mfma_f32_16x16x32_bf16 v[236:239], v[108:111], v[92:95], v[236:239]
    buffer_load_dwordx4 v19, s[24:27], s36 offen offset:2048 lds
    v_mfma_f32_16x16x32_bf16 v[144:147], v[112:115], v[80:83], v[144:147]
    ds_read_b64_tr_b16 v[72:73], v29 offset:17536
    ds_read_b64_tr_b16 v[74:75], v29 offset:18560
    v_mfma_f32_16x16x32_bf16 v[176:179], v[112:115], v[84:87], v[176:179]
    v_accvgpr_read_b32 v6, a166
    v_accvgpr_read_b32 v7, a167
    v_mfma_f32_16x16x32_bf16 v[208:211], v[112:115], v[88:91], v[208:211]
    ds_read_b64_tr_b16 v[76:77], v30 offset:17536
    ds_read_b64_tr_b16 v[78:79], v30 offset:18560
    v_mfma_f32_16x16x32_bf16 v[240:243], v[112:115], v[92:95], v[240:243]
    v_accvgpr_read_b32 v0, a160
    v_accvgpr_read_b32 v1, a161
    v_mfma_f32_16x16x32_bf16 v[148:151], v[116:119], v[80:83], v[148:151]
    v_accvgpr_read_b32 v2, a162
    v_accvgpr_read_b32 v3, a163
    v_mfma_f32_16x16x32_bf16 v[180:183], v[116:119], v[84:87], v[180:183]
    buffer_load_dwordx4 v20, s[24:27], s36 offen offset:3072 lds
    v_mfma_f32_16x16x32_bf16 v[212:215], v[116:119], v[88:91], v[212:215]
    s_add_u32 s37, s49, 1572864
    v_cvt_pk_bf16_f32 v0, v0, v1
    v_cvt_pk_bf16_f32 v1, v2, v3
    v_mfma_f32_16x16x32_bf16 v[244:247], v[116:119], v[92:95], v[244:247]
    s_add_u32 m0, s50, 0
    v_cvt_pk_bf16_f32 v2, v4, v5
    v_cvt_pk_bf16_f32 v3, v6, v7
    v_mfma_f32_16x16x32_bf16 v[152:155], v[120:123], v[80:83], v[152:155]
    buffer_load_dwordx4 v21, s[20:23], s37 offen offset:0 lds
    v_mfma_f32_16x16x32_bf16 v[184:187], v[120:123], v[84:87], v[184:187]
    v_accvgpr_read_b32 v12, a96
    v_accvgpr_read_b32 v13, a97
    v_mfma_f32_16x16x32_bf16 v[216:219], v[120:123], v[88:91], v[216:219]
    v_accvgpr_read_b32 v14, a98
    v_accvgpr_read_b32 v15, a99
    v_mfma_f32_16x16x32_bf16 v[248:251], v[120:123], v[92:95], v[248:251]
    buffer_store_dwordx4 v[0:3], v16, s[16:19], s38 offen offset:1024
    v_mfma_f32_16x16x32_bf16 v[156:159], v[124:127], v[80:83], v[156:159]
    v_accvgpr_read_b32 v8, a64
    v_accvgpr_read_b32 v9, a65
    v_mfma_f32_16x16x32_bf16 v[188:191], v[124:127], v[84:87], v[188:191]
    v_accvgpr_read_b32 v10, a66
    v_accvgpr_read_b32 v11, a67
    v_mfma_f32_16x16x32_bf16 v[220:223], v[124:127], v[88:91], v[220:223]
    buffer_load_dwordx4 v22, s[20:23], s37 offen offset:1024 lds
    v_mfma_f32_16x16x32_bf16 v[252:255], v[124:127], v[92:95], v[252:255]
    s_waitcnt lgkmcnt(0)
    v_mul_f32 v8, s40, v8
    v_mul_f32 v9, s40, v9
    v_mfma_f32_16x16x32_bf16 v[128:131], v[48:51], v[32:35], v[128:131]
    ds_read_b64_tr_b16 v[96:97], v27 offset:26112
    ds_read_b64_tr_b16 v[98:99], v27 offset:27136
    v_mfma_f32_16x16x32_bf16 v[160:163], v[48:51], v[36:39], v[160:163]
    s_add_u32 s36, s45, 384
    v_mul_f32 v10, s40, v10
    v_mul_f32 v11, s40, v11
    v_mfma_f32_16x16x32_bf16 v[192:195], v[48:51], v[40:43], v[192:195]
    s_add_u32 m0, s42, 69632
    ds_read_b128 v[80:83], v24 offset:0
    ds_read_b128 v[84:87], v24 offset:2048
    v_mfma_f32_16x16x32_bf16 v[224:227], v[48:51], v[44:47], v[224:227]
    buffer_load_dwordx4 v17, s[24:27], s36 offen offset:0 lds
    v_mfma_f32_16x16x32_bf16 v[132:135], v[52:55], v[32:35], v[132:135]
    ds_read_b128 v[88:91], v24 offset:4096
    ds_read_b128 v[92:95], v24 offset:6144
    v_mfma_f32_16x16x32_bf16 v[164:167], v[52:55], v[36:39], v[164:167]
    v_mul_f32 v12, s40, v12
    v_mul_f32 v13, s40, v13
    v_mfma_f32_16x16x32_bf16 v[196:199], v[52:55], v[40:43], v[196:199]
    ds_read_b64_tr_b16 v[100:101], v28 offset:26112
    ds_read_b64_tr_b16 v[102:103], v28 offset:27136
    v_mfma_f32_16x16x32_bf16 v[228:231], v[52:55], v[44:47], v[228:231]
    buffer_load_dwordx4 v18, s[24:27], s36 offen offset:1024 lds
    v_mfma_f32_16x16x32_bf16 v[136:139], v[56:59], v[32:35], v[136:139]
    ds_read_b64_tr_b16 v[104:105], v29 offset:26112
    ds_read_b64_tr_b16 v[106:107], v29 offset:27136
    v_mfma_f32_16x16x32_bf16 v[168:171], v[56:59], v[36:39], v[168:171]
    v_mul_f32 v14, s40, v14
    v_mul_f32 v15, s40, v15
    v_mfma_f32_16x16x32_bf16 v[200:203], v[56:59], v[40:43], v[200:203]
    ds_read_b64_tr_b16 v[108:109], v30 offset:26112
    ds_read_b64_tr_b16 v[110:111], v30 offset:27136
    v_mfma_f32_16x16x32_bf16 v[232:235], v[56:59], v[44:47], v[232:235]
    v_mfma_f32_16x16x32_bf16 v[140:143], v[60:63], v[32:35], v[140:143]
    ds_read_b64_tr_b16 v[112:113], v27 offset:26240
    ds_read_b64_tr_b16 v[114:115], v27 offset:27264
    v_mfma_f32_16x16x32_bf16 v[172:175], v[60:63], v[36:39], v[172:175]
    v_cvt_pk_bf16_f32 v8, v8, v9
    v_cvt_pk_bf16_f32 v9, v10, v11
    v_mfma_f32_16x16x32_bf16 v[204:207], v[60:63], v[40:43], v[204:207]
    ds_read_b64_tr_b16 v[116:117], v28 offset:26240
    ds_read_b64_tr_b16 v[118:119], v28 offset:27264
    v_mfma_f32_16x16x32_bf16 v[236:239], v[60:63], v[44:47], v[236:239]
    buffer_load_dwordx4 v19, s[24:27], s36 offen offset:2048 lds
    v_mfma_f32_16x16x32_bf16 v[144:147], v[64:67], v[32:35], v[144:147]
    ds_read_b64_tr_b16 v[120:121], v29 offset:26240
    ds_read_b64_tr_b16 v[122:123], v29 offset:27264
    v_mfma_f32_16x16x32_bf16 v[176:179], v[64:67], v[36:39], v[176:179]
    v_cvt_pk_bf16_f32 v10, v12, v13
    v_cvt_pk_bf16_f32 v11, v14, v15
    v_mfma_f32_16x16x32_bf16 v[208:211], v[64:67], v[40:43], v[208:211]
    ds_read_b64_tr_b16 v[124:125], v30 offset:26240
    ds_read_b64_tr_b16 v[126:127], v30 offset:27264
    v_mfma_f32_16x16x32_bf16 v[240:243], v[64:67], v[44:47], v[240:243]
    v_accvgpr_read_b32 v4, a196
    v_accvgpr_read_b32 v5, a197
    v_mfma_f32_16x16x32_bf16 v[148:151], v[68:71], v[32:35], v[148:151]
    v_accvgpr_read_b32 v6, a198
    v_accvgpr_read_b32 v7, a199
    v_mfma_f32_16x16x32_bf16 v[180:183], v[68:71], v[36:39], v[180:183]
    buffer_load_dwordx4 v20, s[24:27], s36 offen offset:3072 lds
    v_mfma_f32_16x16x32_bf16 v[212:215], v[68:71], v[40:43], v[212:215]
    s_add_u32 s37, s49, 1835008
    v_accvgpr_read_b32 v0, a192
    v_accvgpr_read_b32 v1, a193
    v_mfma_f32_16x16x32_bf16 v[244:247], v[68:71], v[44:47], v[244:247]
    s_add_u32 m0, s50, 8704
    v_accvgpr_read_b32 v2, a194
    v_accvgpr_read_b32 v3, a195
    v_mfma_f32_16x16x32_bf16 v[152:155], v[72:75], v[32:35], v[152:155]
    buffer_load_dwordx4 v21, s[20:23], s37 offen offset:0 lds
    v_mfma_f32_16x16x32_bf16 v[184:187], v[72:75], v[36:39], v[184:187]
    v_cvt_pk_bf16_f32 v0, v0, v1
    v_cvt_pk_bf16_f32 v1, v2, v3
    v_mfma_f32_16x16x32_bf16 v[216:219], v[72:75], v[40:43], v[216:219]
    v_cvt_pk_bf16_f32 v2, v4, v5
    v_cvt_pk_bf16_f32 v3, v6, v7
    v_mfma_f32_16x16x32_bf16 v[248:251], v[72:75], v[44:47], v[248:251]
    buffer_store_dwordx4 v[8:11], v16, s[16:19], s41 offen offset:1024
    v_mfma_f32_16x16x32_bf16 v[156:159], v[76:79], v[32:35], v[156:159]
    s_add_u32 s41, s41, 4096
    v_accvgpr_read_b32 v12, a36
    v_accvgpr_read_b32 v13, a37
    v_mfma_f32_16x16x32_bf16 v[188:191], v[76:79], v[36:39], v[188:191]
    v_accvgpr_read_b32 v14, a38
    v_accvgpr_read_b32 v15, a39
    v_mfma_f32_16x16x32_bf16 v[220:223], v[76:79], v[40:43], v[220:223]
    buffer_load_dwordx4 v22, s[20:23], s37 offen offset:1024 lds
    v_mfma_f32_16x16x32_bf16 v[252:255], v[76:79], v[44:47], v[252:255]
    s_waitcnt vmcnt(15) lgkmcnt(0)
    s_barrier
    v_accvgpr_read_b32 v8, a4
    v_accvgpr_read_b32 v9, a5
    v_mfma_f32_16x16x32_bf16 v[128:131], v[96:99], v[80:83], v[128:131]
    ds_read_b64_tr_b16 v[48:49], v27 offset:34816
    ds_read_b64_tr_b16 v[50:51], v27 offset:35840
    v_mfma_f32_16x16x32_bf16 v[160:163], v[96:99], v[84:87], v[160:163]
    s_add_u32 s36, s44, 512
    v_accvgpr_read_b32 v10, a6
    v_accvgpr_read_b32 v11, a7
    v_mfma_f32_16x16x32_bf16 v[192:195], v[96:99], v[88:91], v[192:195]
    s_add_u32 m0, s42, 0
    ds_read_b128 v[32:35], v23 offset:32768
    ds_read_b128 v[36:39], v23 offset:34816
    v_mfma_f32_16x16x32_bf16 v[224:227], v[96:99], v[92:95], v[224:227]
    buffer_load_dwordx4 v17, s[24:27], s36 offen offset:0 lds
    v_mfma_f32_16x16x32_bf16 v[132:135], v[100:103], v[80:83], v[132:135]
    ds_read_b128 v[40:43], v23 offset:36864
    ds_read_b128 v[44:47], v23 offset:38912
    v_mfma_f32_16x16x32_bf16 v[164:167], v[100:103], v[84:87], v[164:167]
    v_mul_f32 v8, s40, v8
    v_mul_f32 v9, s40, v9
    v_mfma_f32_16x16x32_bf16 v[196:199], v[100:103], v[88:91], v[196:199]
    ds_read_b64_tr_b16 v[52:53], v28 offset:34816
    ds_read_b64_tr_b16 v[54:55], v28 offset:35840
    v_mfma_f32_16x16x32_bf16 v[228:231], v[100:103], v[92:95], v[228:231]
    buffer_load_dwordx4 v18, s[24:27], s36 offen offset:1024 lds
    v_mfma_f32_16x16x32_bf16 v[136:139], v[104:107], v[80:83], v[136:139]
    ds_read_b64_tr_b16 v[56:57], v29 offset:34816
    ds_read_b64_tr_b16 v[58:59], v29 offset:35840
    v_mfma_f32_16x16x32_bf16 v[168:171], v[104:107], v[84:87], v[168:171]
    v_mul_f32 v10, s40, v10
    v_mul_f32 v11, s40, v11
    v_mfma_f32_16x16x32_bf16 v[200:203], v[104:107], v[88:91], v[200:203]
    ds_read_b64_tr_b16 v[60:61], v30 offset:34816
    ds_read_b64_tr_b16 v[62:63], v30 offset:35840
    v_mfma_f32_16x16x32_bf16 v[232:235], v[104:107], v[92:95], v[232:235]
    buffer_store_dwordx4 v[0:3], v16, s[16:19], s38 offen offset:2048
    v_mfma_f32_16x16x32_bf16 v[140:143], v[108:111], v[80:83], v[140:143]
    ds_read_b64_tr_b16 v[64:65], v27 offset:34944
    ds_read_b64_tr_b16 v[66:67], v27 offset:35968
    v_mfma_f32_16x16x32_bf16 v[172:175], v[108:111], v[84:87], v[172:175]
    v_mul_f32 v12, s40, v12
    v_mul_f32 v13, s40, v13
    v_mfma_f32_16x16x32_bf16 v[204:207], v[108:111], v[88:91], v[204:207]
    ds_read_b64_tr_b16 v[68:69], v28 offset:34944
    ds_read_b64_tr_b16 v[70:71], v28 offset:35968
    v_mfma_f32_16x16x32_bf16 v[236:239], v[108:111], v[92:95], v[236:239]
    buffer_load_dwordx4 v19, s[24:27], s36 offen offset:2048 lds
    v_mfma_f32_16x16x32_bf16 v[144:147], v[112:115], v[80:83], v[144:147]
    ds_read_b64_tr_b16 v[72:73], v29 offset:34944
    ds_read_b64_tr_b16 v[74:75], v29 offset:35968
    v_mfma_f32_16x16x32_bf16 v[176:179], v[112:115], v[84:87], v[176:179]
    v_mul_f32 v14, s40, v14
    v_mul_f32 v15, s40, v15
    v_mfma_f32_16x16x32_bf16 v[208:211], v[112:115], v[88:91], v[208:211]
    ds_read_b64_tr_b16 v[76:77], v30 offset:34944
    ds_read_b64_tr_b16 v[78:79], v30 offset:35968
    v_mfma_f32_16x16x32_bf16 v[240:243], v[112:115], v[92:95], v[240:243]
    v_cvt_pk_bf16_f32 v8, v8, v9
    v_cvt_pk_bf16_f32 v9, v10, v11
    v_mfma_f32_16x16x32_bf16 v[148:151], v[116:119], v[80:83], v[148:151]
    v_cvt_pk_bf16_f32 v10, v12, v13
    v_cvt_pk_bf16_f32 v11, v14, v15
    v_mfma_f32_16x16x32_bf16 v[180:183], v[116:119], v[84:87], v[180:183]
    buffer_load_dwordx4 v20, s[24:27], s36 offen offset:3072 lds
    v_mfma_f32_16x16x32_bf16 v[212:215], v[116:119], v[88:91], v[212:215]
    s_add_u32 s37, s49, 2097152
    v_accvgpr_read_b32 v4, a228
    v_accvgpr_read_b32 v5, a229
    v_mfma_f32_16x16x32_bf16 v[244:247], v[116:119], v[92:95], v[244:247]
    s_add_u32 m0, s50, 17408
    v_accvgpr_read_b32 v6, a230
    v_accvgpr_read_b32 v7, a231
    v_mfma_f32_16x16x32_bf16 v[152:155], v[120:123], v[80:83], v[152:155]
    buffer_load_dwordx4 v21, s[20:23], s37 offen offset:0 lds
    v_mfma_f32_16x16x32_bf16 v[184:187], v[120:123], v[84:87], v[184:187]
    v_accvgpr_read_b32 v0, a224
    v_accvgpr_read_b32 v1, a225
    v_mfma_f32_16x16x32_bf16 v[216:219], v[120:123], v[88:91], v[216:219]
    v_accvgpr_read_b32 v2, a226
    v_accvgpr_read_b32 v3, a227
    v_mfma_f32_16x16x32_bf16 v[248:251], v[120:123], v[92:95], v[248:251]
    buffer_store_dwordx4 v[8:11], v16, s[16:19], s41 offen offset:0
    v_mfma_f32_16x16x32_bf16 v[156:159], v[124:127], v[80:83], v[156:159]
    v_cvt_pk_bf16_f32 v0, v0, v1
    v_cvt_pk_bf16_f32 v1, v2, v3
    v_mfma_f32_16x16x32_bf16 v[188:191], v[124:127], v[84:87], v[188:191]
    v_cvt_pk_bf16_f32 v2, v4, v5
    v_cvt_pk_bf16_f32 v3, v6, v7
    v_mfma_f32_16x16x32_bf16 v[220:223], v[124:127], v[88:91], v[220:223]
    buffer_load_dwordx4 v22, s[20:23], s37 offen offset:1024 lds
    v_mfma_f32_16x16x32_bf16 v[252:255], v[124:127], v[92:95], v[252:255]
    s_waitcnt lgkmcnt(0)
    v_accvgpr_read_b32 v12, a100
    v_accvgpr_read_b32 v13, a101
    v_mfma_f32_16x16x32_bf16 v[128:131], v[48:51], v[32:35], v[128:131]
    ds_read_b64_tr_b16 v[96:97], v27 offset:43520
    ds_read_b64_tr_b16 v[98:99], v27 offset:44544
    v_mfma_f32_16x16x32_bf16 v[160:163], v[48:51], v[36:39], v[160:163]
    s_add_u32 s36, s45, 512
    v_accvgpr_read_b32 v14, a102
    v_accvgpr_read_b32 v15, a103
    v_mfma_f32_16x16x32_bf16 v[192:195], v[48:51], v[40:43], v[192:195]
    s_add_u32 m0, s42, 4096
    ds_read_b128 v[80:83], v24 offset:32768
    ds_read_b128 v[84:87], v24 offset:34816
    v_mfma_f32_16x16x32_bf16 v[224:227], v[48:51], v[44:47], v[224:227]
    buffer_load_dwordx4 v17, s[24:27], s36 offen offset:0 lds
    v_mfma_f32_16x16x32_bf16 v[132:135], v[52:55], v[32:35], v[132:135]
    ds_read_b128 v[88:91], v24 offset:36864
    ds_read_b128 v[92:95], v24 offset:38912
    v_mfma_f32_16x16x32_bf16 v[164:167], v[52:55], v[36:39], v[164:167]
    v_accvgpr_read_b32 v8, a68
    v_accvgpr_read_b32 v9, a69
    v_mfma_f32_16x16x32_bf16 v[196:199], v[52:55], v[40:43], v[196:199]
    ds_read_b64_tr_b16 v[100:101], v28 offset:43520
    ds_read_b64_tr_b16 v[102:103], v28 offset:44544
    v_mfma_f32_16x16x32_bf16 v[228:231], v[52:55], v[44:47], v[228:231]
    buffer_load_dwordx4 v18, s[24:27], s36 offen offset:1024 lds
    v_mfma_f32_16x16x32_bf16 v[136:139], v[56:59], v[32:35], v[136:139]
    ds_read_b64_tr_b16 v[104:105], v29 offset:43520
    ds_read_b64_tr_b16 v[106:107], v29 offset:44544
    v_mfma_f32_16x16x32_bf16 v[168:171], v[56:59], v[36:39], v[168:171]
    v_accvgpr_read_b32 v10, a70
    v_accvgpr_read_b32 v11, a71
    v_mfma_f32_16x16x32_bf16 v[200:203], v[56:59], v[40:43], v[200:203]
    ds_read_b64_tr_b16 v[108:109], v30 offset:43520
    ds_read_b64_tr_b16 v[110:111], v30 offset:44544
    v_mfma_f32_16x16x32_bf16 v[232:235], v[56:59], v[44:47], v[232:235]
    buffer_store_dwordx4 v[0:3], v16, s[16:19], s38 offen offset:3072
    v_mfma_f32_16x16x32_bf16 v[140:143], v[60:63], v[32:35], v[140:143]
    s_add_u32 s38, s38, 16384
    ds_read_b64_tr_b16 v[112:113], v27 offset:43648
    ds_read_b64_tr_b16 v[114:115], v27 offset:44672
    v_mfma_f32_16x16x32_bf16 v[172:175], v[60:63], v[36:39], v[172:175]
    v_mul_f32 v8, s40, v8
    v_mul_f32 v9, s40, v9
    v_mfma_f32_16x16x32_bf16 v[204:207], v[60:63], v[40:43], v[204:207]
    ds_read_b64_tr_b16 v[116:117], v28 offset:43648
    ds_read_b64_tr_b16 v[118:119], v28 offset:44672
    v_mfma_f32_16x16x32_bf16 v[236:239], v[60:63], v[44:47], v[236:239]
    buffer_load_dwordx4 v19, s[24:27], s36 offen offset:2048 lds
    v_mfma_f32_16x16x32_bf16 v[144:147], v[64:67], v[32:35], v[144:147]
    ds_read_b64_tr_b16 v[120:121], v29 offset:43648
    ds_read_b64_tr_b16 v[122:123], v29 offset:44672
    v_mfma_f32_16x16x32_bf16 v[176:179], v[64:67], v[36:39], v[176:179]
    v_mul_f32 v10, s40, v10
    v_mul_f32 v11, s40, v11
    v_mfma_f32_16x16x32_bf16 v[208:211], v[64:67], v[40:43], v[208:211]
    ds_read_b64_tr_b16 v[124:125], v30 offset:43648
    ds_read_b64_tr_b16 v[126:127], v30 offset:44672
    v_mfma_f32_16x16x32_bf16 v[240:243], v[64:67], v[44:47], v[240:243]
    v_mul_f32 v12, s40, v12
    v_mul_f32 v13, s40, v13
    v_mfma_f32_16x16x32_bf16 v[148:151], v[68:71], v[32:35], v[148:151]
    v_mul_f32 v14, s40, v14
    v_mul_f32 v15, s40, v15
    v_mfma_f32_16x16x32_bf16 v[180:183], v[68:71], v[36:39], v[180:183]
    buffer_load_dwordx4 v20, s[24:27], s36 offen offset:3072 lds
    v_mfma_f32_16x16x32_bf16 v[212:215], v[68:71], v[40:43], v[212:215]
    s_add_u32 s37, s49, 2359296
    v_cvt_pk_bf16_f32 v8, v8, v9
    v_cvt_pk_bf16_f32 v9, v10, v11
    v_mfma_f32_16x16x32_bf16 v[244:247], v[68:71], v[44:47], v[244:247]
    s_add_u32 m0, s50, 26112
    v_cvt_pk_bf16_f32 v10, v12, v13
    v_cvt_pk_bf16_f32 v11, v14, v15
    v_mfma_f32_16x16x32_bf16 v[152:155], v[72:75], v[32:35], v[152:155]
    buffer_load_dwordx4 v21, s[20:23], s37 offen offset:0 lds
    v_mfma_f32_16x16x32_bf16 v[184:187], v[72:75], v[36:39], v[184:187]
    v_accvgpr_read_b32 v4, a140
    v_accvgpr_read_b32 v5, a141
    v_mfma_f32_16x16x32_bf16 v[216:219], v[72:75], v[40:43], v[216:219]
    v_accvgpr_read_b32 v6, a142
    v_accvgpr_read_b32 v7, a143
    v_mfma_f32_16x16x32_bf16 v[248:251], v[72:75], v[44:47], v[248:251]
    buffer_store_dwordx4 v[8:11], v16, s[16:19], s41 offen offset:1024
    v_mfma_f32_16x16x32_bf16 v[156:159], v[76:79], v[32:35], v[156:159]
    s_add_u32 s41, s41, 12288
    v_accvgpr_read_b32 v0, a136
    v_accvgpr_read_b32 v1, a137
    v_mfma_f32_16x16x32_bf16 v[188:191], v[76:79], v[36:39], v[188:191]
    v_accvgpr_read_b32 v2, a138
    v_accvgpr_read_b32 v3, a139
    v_mfma_f32_16x16x32_bf16 v[220:223], v[76:79], v[40:43], v[220:223]
    buffer_load_dwordx4 v22, s[20:23], s37 offen offset:1024 lds
    v_mfma_f32_16x16x32_bf16 v[252:255], v[76:79], v[44:47], v[252:255]
    s_waitcnt vmcnt(16) lgkmcnt(0)
    s_barrier
    v_cvt_pk_bf16_f32 v0, v0, v1
    v_cvt_pk_bf16_f32 v1, v2, v3
    v_mfma_f32_16x16x32_bf16 v[128:131], v[96:99], v[80:83], v[128:131]
    ds_read_b64_tr_b16 v[48:49], v27 offset:0
    ds_read_b64_tr_b16 v[50:51], v27 offset:1024
    v_mfma_f32_16x16x32_bf16 v[160:163], v[96:99], v[84:87], v[160:163]
    s_add_u32 s36, s44, 640
    v_cvt_pk_bf16_f32 v2, v4, v5
    v_cvt_pk_bf16_f32 v3, v6, v7
    v_mfma_f32_16x16x32_bf16 v[192:195], v[96:99], v[88:91], v[192:195]
    s_add_u32 m0, s42, 32768
    ds_read_b128 v[32:35], v25 offset:0
    ds_read_b128 v[36:39], v25 offset:2048
    v_mfma_f32_16x16x32_bf16 v[224:227], v[96:99], v[92:95], v[224:227]
    buffer_load_dwordx4 v17, s[24:27], s36 offen offset:0 lds
    v_mfma_f32_16x16x32_bf16 v[132:135], v[100:103], v[80:83], v[132:135]
    ds_read_b128 v[40:43], v25 offset:4096
    ds_read_b128 v[44:47], v25 offset:6144
    v_mfma_f32_16x16x32_bf16 v[164:167], v[100:103], v[84:87], v[164:167]
    v_accvgpr_read_b32 v12, a40
    v_accvgpr_read_b32 v13, a41
    v_mfma_f32_16x16x32_bf16 v[196:199], v[100:103], v[88:91], v[196:199]
    ds_read_b64_tr_b16 v[52:53], v28 offset:0
    ds_read_b64_tr_b16 v[54:55], v28 offset:1024
    v_mfma_f32_16x16x32_bf16 v[228:231], v[100:103], v[92:95], v[228:231]
    buffer_load_dwordx4 v18, s[24:27], s36 offen offset:1024 lds
    v_mfma_f32_16x16x32_bf16 v[136:139], v[104:107], v[80:83], v[136:139]
    ds_read_b64_tr_b16 v[56:57], v29 offset:0
    ds_read_b64_tr_b16 v[58:59], v29 offset:1024
    v_mfma_f32_16x16x32_bf16 v[168:171], v[104:107], v[84:87], v[168:171]
    v_accvgpr_read_b32 v14, a42
    v_accvgpr_read_b32 v15, a43
    v_mfma_f32_16x16x32_bf16 v[200:203], v[104:107], v[88:91], v[200:203]
    ds_read_b64_tr_b16 v[60:61], v30 offset:0
    ds_read_b64_tr_b16 v[62:63], v30 offset:1024
    v_mfma_f32_16x16x32_bf16 v[232:235], v[104:107], v[92:95], v[232:235]
    buffer_store_dwordx4 v[0:3], v16, s[16:19], s38 offen offset:0
    v_mfma_f32_16x16x32_bf16 v[140:143], v[108:111], v[80:83], v[140:143]
    ds_read_b64_tr_b16 v[64:65], v27 offset:128
    ds_read_b64_tr_b16 v[66:67], v27 offset:1152
    v_mfma_f32_16x16x32_bf16 v[172:175], v[108:111], v[84:87], v[172:175]
    v_accvgpr_read_b32 v8, a8
    v_accvgpr_read_b32 v9, a9
    v_mfma_f32_16x16x32_bf16 v[204:207], v[108:111], v[88:91], v[204:207]
    ds_read_b64_tr_b16 v[68:69], v28 offset:128
    ds_read_b64_tr_b16 v[70:71], v28 offset:1152
    v_mfma_f32_16x16x32_bf16 v[236:239], v[108:111], v[92:95], v[236:239]
    buffer_load_dwordx4 v19, s[24:27], s36 offen offset:2048 lds
    v_mfma_f32_16x16x32_bf16 v[144:147], v[112:115], v[80:83], v[144:147]
    ds_read_b64_tr_b16 v[72:73], v29 offset:128
    ds_read_b64_tr_b16 v[74:75], v29 offset:1152
    v_mfma_f32_16x16x32_bf16 v[176:179], v[112:115], v[84:87], v[176:179]
    v_accvgpr_read_b32 v10, a10
    v_accvgpr_read_b32 v11, a11
    v_mfma_f32_16x16x32_bf16 v[208:211], v[112:115], v[88:91], v[208:211]
    ds_read_b64_tr_b16 v[76:77], v30 offset:128
    ds_read_b64_tr_b16 v[78:79], v30 offset:1152
    v_mfma_f32_16x16x32_bf16 v[240:243], v[112:115], v[92:95], v[240:243]
    v_mul_f32 v8, s40, v8
    v_mul_f32 v9, s40, v9
    v_mfma_f32_16x16x32_bf16 v[148:151], v[116:119], v[80:83], v[148:151]
    v_mul_f32 v10, s40, v10
    v_mul_f32 v11, s40, v11
    v_mfma_f32_16x16x32_bf16 v[180:183], v[116:119], v[84:87], v[180:183]
    buffer_load_dwordx4 v20, s[24:27], s36 offen offset:3072 lds
    v_mfma_f32_16x16x32_bf16 v[212:215], v[116:119], v[88:91], v[212:215]
    s_add_u32 s37, s49, 2621440
    v_mul_f32 v12, s40, v12
    v_mul_f32 v13, s40, v13
    v_mfma_f32_16x16x32_bf16 v[244:247], v[116:119], v[92:95], v[244:247]
    s_add_u32 m0, s50, 34816
    v_mul_f32 v14, s40, v14
    v_mul_f32 v15, s40, v15
    v_mfma_f32_16x16x32_bf16 v[152:155], v[120:123], v[80:83], v[152:155]
    buffer_load_dwordx4 v21, s[20:23], s37 offen offset:0 lds
    v_mfma_f32_16x16x32_bf16 v[184:187], v[120:123], v[84:87], v[184:187]
    v_cvt_pk_bf16_f32 v8, v8, v9
    v_cvt_pk_bf16_f32 v9, v10, v11
    v_mfma_f32_16x16x32_bf16 v[216:219], v[120:123], v[88:91], v[216:219]
    v_cvt_pk_bf16_f32 v10, v12, v13
    v_cvt_pk_bf16_f32 v11, v14, v15
    v_mfma_f32_16x16x32_bf16 v[248:251], v[120:123], v[92:95], v[248:251]
    buffer_store_dwordx4 v[8:11], v16, s[16:19], s41 offen offset:0
    v_mfma_f32_16x16x32_bf16 v[156:159], v[124:127], v[80:83], v[156:159]
    v_accvgpr_read_b32 v4, a172
    v_accvgpr_read_b32 v5, a173
    v_mfma_f32_16x16x32_bf16 v[188:191], v[124:127], v[84:87], v[188:191]
    v_accvgpr_read_b32 v6, a174
    v_accvgpr_read_b32 v7, a175
    v_mfma_f32_16x16x32_bf16 v[220:223], v[124:127], v[88:91], v[220:223]
    buffer_load_dwordx4 v22, s[20:23], s37 offen offset:1024 lds
    v_mfma_f32_16x16x32_bf16 v[252:255], v[124:127], v[92:95], v[252:255]
    s_waitcnt lgkmcnt(0)
    v_accvgpr_read_b32 v0, a168
    v_accvgpr_read_b32 v1, a169
    v_mfma_f32_16x16x32_bf16 v[128:131], v[48:51], v[32:35], v[128:131]
    ds_read_b64_tr_b16 v[96:97], v27 offset:8704
    ds_read_b64_tr_b16 v[98:99], v27 offset:9728
    v_mfma_f32_16x16x32_bf16 v[160:163], v[48:51], v[36:39], v[160:163]
    s_add_u32 s36, s45, 640
    v_accvgpr_read_b32 v2, a170
    v_accvgpr_read_b32 v3, a171
    v_mfma_f32_16x16x32_bf16 v[192:195], v[48:51], v[40:43], v[192:195]
    s_add_u32 m0, s42, 36864
    ds_read_b128 v[80:83], v26 offset:0
    ds_read_b128 v[84:87], v26 offset:2048
    v_mfma_f32_16x16x32_bf16 v[224:227], v[48:51], v[44:47], v[224:227]
    buffer_load_dwordx4 v17, s[24:27], s36 offen offset:0 lds
    v_mfma_f32_16x16x32_bf16 v[132:135], v[52:55], v[32:35], v[132:135]
    ds_read_b128 v[88:91], v26 offset:4096
    ds_read_b128 v[92:95], v26 offset:6144
    v_mfma_f32_16x16x32_bf16 v[164:167], v[52:55], v[36:39], v[164:167]
    v_cvt_pk_bf16_f32 v0, v0, v1
    v_cvt_pk_bf16_f32 v1, v2, v3
    v_mfma_f32_16x16x32_bf16 v[196:199], v[52:55], v[40:43], v[196:199]
    ds_read_b64_tr_b16 v[100:101], v28 offset:8704
    ds_read_b64_tr_b16 v[102:103], v28 offset:9728
    v_mfma_f32_16x16x32_bf16 v[228:231], v[52:55], v[44:47], v[228:231]
    buffer_load_dwordx4 v18, s[24:27], s36 offen offset:1024 lds
    v_mfma_f32_16x16x32_bf16 v[136:139], v[56:59], v[32:35], v[136:139]
    ds_read_b64_tr_b16 v[104:105], v29 offset:8704
    ds_read_b64_tr_b16 v[106:107], v29 offset:9728
    v_mfma_f32_16x16x32_bf16 v[168:171], v[56:59], v[36:39], v[168:171]
    v_cvt_pk_bf16_f32 v2, v4, v5
    v_cvt_pk_bf16_f32 v3, v6, v7
    v_mfma_f32_16x16x32_bf16 v[200:203], v[56:59], v[40:43], v[200:203]
    ds_read_b64_tr_b16 v[108:109], v30 offset:8704
    ds_read_b64_tr_b16 v[110:111], v30 offset:9728
    v_mfma_f32_16x16x32_bf16 v[232:235], v[56:59], v[44:47], v[232:235]
gated_mix__ssm_conv_h3__compressed_kv_cla__prompt_kernel_pad4:
    s_cbranch_execz gated_mix__ssm_conv_h3__compressed_kv_cla__prompt_kernel_pad8
    buffer_store_dwordx4 v[0:3], v16, s[16:19], s38 offen offset:1024
    v_mfma_f32_16x16x32_bf16 v[140:143], v[60:63], v[32:35], v[140:143]
    ds_read_b64_tr_b16 v[112:113], v27 offset:8832
    ds_read_b64_tr_b16 v[114:115], v27 offset:9856
    v_mfma_f32_16x16x32_bf16 v[172:175], v[60:63], v[36:39], v[172:175]
    v_accvgpr_read_b32 v12, a104
    v_accvgpr_read_b32 v13, a105
    v_mfma_f32_16x16x32_bf16 v[204:207], v[60:63], v[40:43], v[204:207]
    ds_read_b64_tr_b16 v[116:117], v28 offset:8832
    ds_read_b64_tr_b16 v[118:119], v28 offset:9856
    v_mfma_f32_16x16x32_bf16 v[236:239], v[60:63], v[44:47], v[236:239]
    buffer_load_dwordx4 v19, s[24:27], s36 offen offset:2048 lds
    v_mfma_f32_16x16x32_bf16 v[144:147], v[64:67], v[32:35], v[144:147]
    ds_read_b64_tr_b16 v[120:121], v29 offset:8832
    ds_read_b64_tr_b16 v[122:123], v29 offset:9856
    v_mfma_f32_16x16x32_bf16 v[176:179], v[64:67], v[36:39], v[176:179]
    v_accvgpr_read_b32 v14, a106
    v_accvgpr_read_b32 v15, a107
    v_mfma_f32_16x16x32_bf16 v[208:211], v[64:67], v[40:43], v[208:211]
    ds_read_b64_tr_b16 v[124:125], v30 offset:8832
    ds_read_b64_tr_b16 v[126:127], v30 offset:9856
    v_mfma_f32_16x16x32_bf16 v[240:243], v[64:67], v[44:47], v[240:243]
    v_accvgpr_read_b32 v8, a72
    v_accvgpr_read_b32 v9, a73
    v_mfma_f32_16x16x32_bf16 v[148:151], v[68:71], v[32:35], v[148:151]
    v_accvgpr_read_b32 v10, a74
    v_accvgpr_read_b32 v11, a75
    v_mfma_f32_16x16x32_bf16 v[180:183], v[68:71], v[36:39], v[180:183]
    buffer_load_dwordx4 v20, s[24:27], s36 offen offset:3072 lds
    v_mfma_f32_16x16x32_bf16 v[212:215], v[68:71], v[40:43], v[212:215]
    s_add_u32 s37, s49, 2883584
    v_mul_f32 v8, s40, v8
    v_mul_f32 v9, s40, v9
    v_mfma_f32_16x16x32_bf16 v[244:247], v[68:71], v[44:47], v[244:247]
    s_add_u32 m0, s50, 43520
    v_mul_f32 v10, s40, v10
    v_mul_f32 v11, s40, v11
    v_mfma_f32_16x16x32_bf16 v[152:155], v[72:75], v[32:35], v[152:155]
    buffer_load_dwordx4 v21, s[20:23], s37 offen offset:0 lds
    v_mfma_f32_16x16x32_bf16 v[184:187], v[72:75], v[36:39], v[184:187]
    v_mul_f32 v12, s40, v12
    v_mul_f32 v13, s40, v13
    v_mfma_f32_16x16x32_bf16 v[216:219], v[72:75], v[40:43], v[216:219]
    v_mul_f32 v14, s40, v14
    v_mul_f32 v15, s40, v15
    v_mfma_f32_16x16x32_bf16 v[248:251], v[72:75], v[44:47], v[248:251]
    v_mfma_f32_16x16x32_bf16 v[156:159], v[76:79], v[32:35], v[156:159]
    v_cvt_pk_bf16_f32 v8, v8, v9
    v_cvt_pk_bf16_f32 v9, v10, v11
    v_mfma_f32_16x16x32_bf16 v[188:191], v[76:79], v[36:39], v[188:191]
    v_cvt_pk_bf16_f32 v10, v12, v13
    v_cvt_pk_bf16_f32 v11, v14, v15
    v_mfma_f32_16x16x32_bf16 v[220:223], v[76:79], v[40:43], v[220:223]
    buffer_load_dwordx4 v22, s[20:23], s37 offen offset:1024 lds
    v_mfma_f32_16x16x32_bf16 v[252:255], v[76:79], v[44:47], v[252:255]
    s_waitcnt vmcnt(15) lgkmcnt(0)
    s_barrier
    v_accvgpr_read_b32 v4, a204
    v_accvgpr_read_b32 v5, a205
    v_mfma_f32_16x16x32_bf16 v[128:131], v[96:99], v[80:83], v[128:131]
    ds_read_b64_tr_b16 v[48:49], v27 offset:17408
    ds_read_b64_tr_b16 v[50:51], v27 offset:18432
    v_mfma_f32_16x16x32_bf16 v[160:163], v[96:99], v[84:87], v[160:163]
    s_add_u32 s36, s44, 768
    v_accvgpr_read_b32 v6, a206
    v_accvgpr_read_b32 v7, a207
    v_mfma_f32_16x16x32_bf16 v[192:195], v[96:99], v[88:91], v[192:195]
    s_add_u32 m0, s42, 65536
    ds_read_b128 v[32:35], v23 offset:0
    ds_read_b128 v[36:39], v23 offset:2048
    v_mfma_f32_16x16x32_bf16 v[224:227], v[96:99], v[92:95], v[224:227]
    buffer_load_dwordx4 v17, s[24:27], s36 offen offset:0 lds
    v_mfma_f32_16x16x32_bf16 v[132:135], v[100:103], v[80:83], v[132:135]
    ds_read_b128 v[40:43], v23 offset:4096
    ds_read_b128 v[44:47], v23 offset:6144
    v_mfma_f32_16x16x32_bf16 v[164:167], v[100:103], v[84:87], v[164:167]
    v_accvgpr_read_b32 v0, a200
    v_accvgpr_read_b32 v1, a201
    v_mfma_f32_16x16x32_bf16 v[196:199], v[100:103], v[88:91], v[196:199]
    ds_read_b64_tr_b16 v[52:53], v28 offset:17408
    ds_read_b64_tr_b16 v[54:55], v28 offset:18432
    v_mfma_f32_16x16x32_bf16 v[228:231], v[100:103], v[92:95], v[228:231]
    buffer_load_dwordx4 v18, s[24:27], s36 offen offset:1024 lds
    v_mfma_f32_16x16x32_bf16 v[136:139], v[104:107], v[80:83], v[136:139]
    ds_read_b64_tr_b16 v[56:57], v29 offset:17408
    ds_read_b64_tr_b16 v[58:59], v29 offset:18432
    v_mfma_f32_16x16x32_bf16 v[168:171], v[104:107], v[84:87], v[168:171]
    v_accvgpr_read_b32 v2, a202
    v_accvgpr_read_b32 v3, a203
    v_mfma_f32_16x16x32_bf16 v[200:203], v[104:107], v[88:91], v[200:203]
    ds_read_b64_tr_b16 v[60:61], v30 offset:17408
    ds_read_b64_tr_b16 v[62:63], v30 offset:18432
    v_mfma_f32_16x16x32_bf16 v[232:235], v[104:107], v[92:95], v[232:235]
    buffer_store_dwordx4 v[8:11], v16, s[16:19], s41 offen offset:1024
    v_mfma_f32_16x16x32_bf16 v[140:143], v[108:111], v[80:83], v[140:143]
    s_add_u32 s41, s41, 4096
    ds_read_b64_tr_b16 v[64:65], v27 offset:17536
    ds_read_b64_tr_b16 v[66:67], v27 offset:18560
    v_mfma_f32_16x16x32_bf16 v[172:175], v[108:111], v[84:87], v[172:175]
    v_cvt_pk_bf16_f32 v0, v0, v1
    v_cvt_pk_bf16_f32 v1, v2, v3
    v_mfma_f32_16x16x32_bf16 v[204:207], v[108:111], v[88:91], v[204:207]
    ds_read_b64_tr_b16 v[68:69], v28 offset:17536
    ds_read_b64_tr_b16 v[70:71], v28 offset:18560
    v_mfma_f32_16x16x32_bf16 v[236:239], v[108:111], v[92:95], v[236:239]
    buffer_load_dwordx4 v19, s[24:27], s36 offen offset:2048 lds
    v_mfma_f32_16x16x32_bf16 v[144:147], v[112:115], v[80:83], v[144:147]
    ds_read_b64_tr_b16 v[72:73], v29 offset:17536
    ds_read_b64_tr_b16 v[74:75], v29 offset:18560
    v_mfma_f32_16x16x32_bf16 v[176:179], v[112:115], v[84:87], v[176:179]
    v_cvt_pk_bf16_f32 v2, v4, v5
    v_cvt_pk_bf16_f32 v3, v6, v7
    v_mfma_f32_16x16x32_bf16 v[208:211], v[112:115], v[88:91], v[208:211]
    ds_read_b64_tr_b16 v[76:77], v30 offset:17536
    ds_read_b64_tr_b16 v[78:79], v30 offset:18560
    v_mfma_f32_16x16x32_bf16 v[240:243], v[112:115], v[92:95], v[240:243]
    v_accvgpr_read_b32 v12, a44
    v_accvgpr_read_b32 v13, a45
    v_mfma_f32_16x16x32_bf16 v[148:151], v[116:119], v[80:83], v[148:151]
    v_accvgpr_read_b32 v14, a46
    v_accvgpr_read_b32 v15, a47
    v_mfma_f32_16x16x32_bf16 v[180:183], v[116:119], v[84:87], v[180:183]
    buffer_load_dwordx4 v20, s[24:27], s36 offen offset:3072 lds
    v_mfma_f32_16x16x32_bf16 v[212:215], v[116:119], v[88:91], v[212:215]
    s_add_u32 s37, s49, 3145728
    v_accvgpr_read_b32 v8, a12
    v_accvgpr_read_b32 v9, a13
    v_mfma_f32_16x16x32_bf16 v[244:247], v[116:119], v[92:95], v[244:247]
    s_add_u32 m0, s50, 0
    v_accvgpr_read_b32 v10, a14
    v_accvgpr_read_b32 v11, a15
    v_mfma_f32_16x16x32_bf16 v[152:155], v[120:123], v[80:83], v[152:155]
    buffer_load_dwordx4 v21, s[20:23], s37 offen offset:0 lds
    v_mfma_f32_16x16x32_bf16 v[184:187], v[120:123], v[84:87], v[184:187]
    v_mul_f32 v8, s40, v8
    v_mul_f32 v9, s40, v9
    v_mfma_f32_16x16x32_bf16 v[216:219], v[120:123], v[88:91], v[216:219]
    v_mul_f32 v10, s40, v10
    v_mul_f32 v11, s40, v11
    v_mfma_f32_16x16x32_bf16 v[248:251], v[120:123], v[92:95], v[248:251]
    buffer_store_dwordx4 v[0:3], v16, s[16:19], s38 offen offset:2048
    v_mfma_f32_16x16x32_bf16 v[156:159], v[124:127], v[80:83], v[156:159]
    v_mul_f32 v12, s40, v12
    v_mul_f32 v13, s40, v13
    v_mfma_f32_16x16x32_bf16 v[188:191], v[124:127], v[84:87], v[188:191]
    v_mul_f32 v14, s40, v14
    v_mul_f32 v15, s40, v15
    v_mfma_f32_16x16x32_bf16 v[220:223], v[124:127], v[88:91], v[220:223]
    buffer_load_dwordx4 v22, s[20:23], s37 offen offset:1024 lds
    v_mfma_f32_16x16x32_bf16 v[252:255], v[124:127], v[92:95], v[252:255]
    s_waitcnt lgkmcnt(0)
    v_cvt_pk_bf16_f32 v8, v8, v9
    v_cvt_pk_bf16_f32 v9, v10, v11
    v_mfma_f32_16x16x32_bf16 v[128:131], v[48:51], v[32:35], v[128:131]
    ds_read_b64_tr_b16 v[96:97], v27 offset:26112
    ds_read_b64_tr_b16 v[98:99], v27 offset:27136
    v_mfma_f32_16x16x32_bf16 v[160:163], v[48:51], v[36:39], v[160:163]
    s_add_u32 s36, s45, 768
    v_cvt_pk_bf16_f32 v10, v12, v13
    v_cvt_pk_bf16_f32 v11, v14, v15
    v_mfma_f32_16x16x32_bf16 v[192:195], v[48:51], v[40:43], v[192:195]
    s_add_u32 m0, s42, 69632
    ds_read_b128 v[80:83], v24 offset:0
    ds_read_b128 v[84:87], v24 offset:2048
    v_mfma_f32_16x16x32_bf16 v[224:227], v[48:51], v[44:47], v[224:227]
    buffer_load_dwordx4 v17, s[24:27], s36 offen offset:0 lds
    v_mfma_f32_16x16x32_bf16 v[132:135], v[52:55], v[32:35], v[132:135]
    ds_read_b128 v[88:91], v24 offset:4096
    ds_read_b128 v[92:95], v24 offset:6144
    v_mfma_f32_16x16x32_bf16 v[164:167], v[52:55], v[36:39], v[164:167]
    v_accvgpr_read_b32 v4, a236
    v_accvgpr_read_b32 v5, a237
    v_mfma_f32_16x16x32_bf16 v[196:199], v[52:55], v[40:43], v[196:199]
    ds_read_b64_tr_b16 v[100:101], v28 offset:26112
    ds_read_b64_tr_b16 v[102:103], v28 offset:27136
    v_mfma_f32_16x16x32_bf16 v[228:231], v[52:55], v[44:47], v[228:231]
    buffer_load_dwordx4 v18, s[24:27], s36 offen offset:1024 lds
    v_mfma_f32_16x16x32_bf16 v[136:139], v[56:59], v[32:35], v[136:139]
    ds_read_b64_tr_b16 v[104:105], v29 offset:26112
    ds_read_b64_tr_b16 v[106:107], v29 offset:27136
    v_mfma_f32_16x16x32_bf16 v[168:171], v[56:59], v[36:39], v[168:171]
    v_accvgpr_read_b32 v6, a238
    v_accvgpr_read_b32 v7, a239
    v_mfma_f32_16x16x32_bf16 v[200:203], v[56:59], v[40:43], v[200:203]
    ds_read_b64_tr_b16 v[108:109], v30 offset:26112
    ds_read_b64_tr_b16 v[110:111], v30 offset:27136
    v_mfma_f32_16x16x32_bf16 v[232:235], v[56:59], v[44:47], v[232:235]
    buffer_store_dwordx4 v[8:11], v16, s[16:19], s41 offen offset:0
    v_mfma_f32_16x16x32_bf16 v[140:143], v[60:63], v[32:35], v[140:143]
    ds_read_b64_tr_b16 v[112:113], v27 offset:26240
    ds_read_b64_tr_b16 v[114:115], v27 offset:27264
    v_mfma_f32_16x16x32_bf16 v[172:175], v[60:63], v[36:39], v[172:175]
    v_accvgpr_read_b32 v0, a232
    v_accvgpr_read_b32 v1, a233
    v_mfma_f32_16x16x32_bf16 v[204:207], v[60:63], v[40:43], v[204:207]
    ds_read_b64_tr_b16 v[116:117], v28 offset:26240
    ds_read_b64_tr_b16 v[118:119], v28 offset:27264
    v_mfma_f32_16x16x32_bf16 v[236:239], v[60:63], v[44:47], v[236:239]
    buffer_load_dwordx4 v19, s[24:27], s36 offen offset:2048 lds
    v_mfma_f32_16x16x32_bf16 v[144:147], v[64:67], v[32:35], v[144:147]
    ds_read_b64_tr_b16 v[120:121], v29 offset:26240
    ds_read_b64_tr_b16 v[122:123], v29 offset:27264
    v_mfma_f32_16x16x32_bf16 v[176:179], v[64:67], v[36:39], v[176:179]
    v_accvgpr_read_b32 v2, a234
    v_accvgpr_read_b32 v3, a235
    v_mfma_f32_16x16x32_bf16 v[208:211], v[64:67], v[40:43], v[208:211]
    ds_read_b64_tr_b16 v[124:125], v30 offset:26240
    ds_read_b64_tr_b16 v[126:127], v30 offset:27264
    v_mfma_f32_16x16x32_bf16 v[240:243], v[64:67], v[44:47], v[240:243]
    v_cvt_pk_bf16_f32 v0, v0, v1
    v_cvt_pk_bf16_f32 v1, v2, v3
    v_mfma_f32_16x16x32_bf16 v[148:151], v[68:71], v[32:35], v[148:151]
    v_cvt_pk_bf16_f32 v2, v4, v5
    v_cvt_pk_bf16_f32 v3, v6, v7
    v_mfma_f32_16x16x32_bf16 v[180:183], v[68:71], v[36:39], v[180:183]
    buffer_load_dwordx4 v20, s[24:27], s36 offen offset:3072 lds
    v_mfma_f32_16x16x32_bf16 v[212:215], v[68:71], v[40:43], v[212:215]
    s_add_u32 s37, s49, 3407872
    v_accvgpr_read_b32 v12, a108
    v_accvgpr_read_b32 v13, a109
    v_mfma_f32_16x16x32_bf16 v[244:247], v[68:71], v[44:47], v[244:247]
    s_add_u32 m0, s50, 8704
    v_accvgpr_read_b32 v14, a110
    v_accvgpr_read_b32 v15, a111
    v_mfma_f32_16x16x32_bf16 v[152:155], v[72:75], v[32:35], v[152:155]
    buffer_load_dwordx4 v21, s[20:23], s37 offen offset:0 lds
    v_mfma_f32_16x16x32_bf16 v[184:187], v[72:75], v[36:39], v[184:187]
    v_accvgpr_read_b32 v8, a76
    v_accvgpr_read_b32 v9, a77
    v_mfma_f32_16x16x32_bf16 v[216:219], v[72:75], v[40:43], v[216:219]
    v_accvgpr_read_b32 v10, a78
    v_accvgpr_read_b32 v11, a79
    v_mfma_f32_16x16x32_bf16 v[248:251], v[72:75], v[44:47], v[248:251]
    buffer_store_dwordx4 v[0:3], v16, s[16:19], s38 offen offset:3072
    v_mfma_f32_16x16x32_bf16 v[156:159], v[76:79], v[32:35], v[156:159]
    s_add_u32 s38, s38, 16384
    v_mul_f32 v8, s40, v8
    v_mul_f32 v9, s40, v9
    v_mfma_f32_16x16x32_bf16 v[188:191], v[76:79], v[36:39], v[188:191]
    v_mul_f32 v10, s40, v10
    v_mul_f32 v11, s40, v11
    v_mfma_f32_16x16x32_bf16 v[220:223], v[76:79], v[40:43], v[220:223]
    buffer_load_dwordx4 v22, s[20:23], s37 offen offset:1024 lds
    v_mfma_f32_16x16x32_bf16 v[252:255], v[76:79], v[44:47], v[252:255]
    s_waitcnt vmcnt(16) lgkmcnt(0)
    s_barrier
    v_mul_f32 v12, s40, v12
    v_mul_f32 v13, s40, v13
    v_mfma_f32_16x16x32_bf16 v[128:131], v[96:99], v[80:83], v[128:131]
    ds_read_b64_tr_b16 v[48:49], v27 offset:34816
    ds_read_b64_tr_b16 v[50:51], v27 offset:35840
    v_mfma_f32_16x16x32_bf16 v[160:163], v[96:99], v[84:87], v[160:163]
    s_add_u32 s36, s44, 896
    v_mul_f32 v14, s40, v14
    v_mul_f32 v15, s40, v15
    v_mfma_f32_16x16x32_bf16 v[192:195], v[96:99], v[88:91], v[192:195]
    s_add_u32 m0, s42, 0
    ds_read_b128 v[32:35], v23 offset:32768
    ds_read_b128 v[36:39], v23 offset:34816
    v_mfma_f32_16x16x32_bf16 v[224:227], v[96:99], v[92:95], v[224:227]
    buffer_load_dwordx4 v17, s[24:27], s36 offen offset:0 lds
    v_mfma_f32_16x16x32_bf16 v[132:135], v[100:103], v[80:83], v[132:135]
    ds_read_b128 v[40:43], v23 offset:36864
    ds_read_b128 v[44:47], v23 offset:38912
    v_mfma_f32_16x16x32_bf16 v[164:167], v[100:103], v[84:87], v[164:167]
    v_cvt_pk_bf16_f32 v8, v8, v9
    v_cvt_pk_bf16_f32 v9, v10, v11
    v_mfma_f32_16x16x32_bf16 v[196:199], v[100:103], v[88:91], v[196:199]
    ds_read_b64_tr_b16 v[52:53], v28 offset:34816
    ds_read_b64_tr_b16 v[54:55], v28 offset:35840
    v_mfma_f32_16x16x32_bf16 v[228:231], v[100:103], v[92:95], v[228:231]
    buffer_load_dwordx4 v18, s[24:27], s36 offen offset:1024 lds
    v_mfma_f32_16x16x32_bf16 v[136:139], v[104:107], v[80:83], v[136:139]
    ds_read_b64_tr_b16 v[56:57], v29 offset:34816
    ds_read_b64_tr_b16 v[58:59], v29 offset:35840
    v_mfma_f32_16x16x32_bf16 v[168:171], v[104:107], v[84:87], v[168:171]
    v_cvt_pk_bf16_f32 v10, v12, v13
    v_cvt_pk_bf16_f32 v11, v14, v15
    v_mfma_f32_16x16x32_bf16 v[200:203], v[104:107], v[88:91], v[200:203]
    ds_read_b64_tr_b16 v[60:61], v30 offset:34816
    ds_read_b64_tr_b16 v[62:63], v30 offset:35840
    v_mfma_f32_16x16x32_bf16 v[232:235], v[104:107], v[92:95], v[232:235]
    buffer_store_dwordx4 v[8:11], v16, s[16:19], s41 offen offset:1024
    v_mfma_f32_16x16x32_bf16 v[140:143], v[108:111], v[80:83], v[140:143]
    s_add_u32 s41, s41, 12288
    ds_read_b64_tr_b16 v[64:65], v27 offset:34944
    ds_read_b64_tr_b16 v[66:67], v27 offset:35968
    v_mfma_f32_16x16x32_bf16 v[172:175], v[108:111], v[84:87], v[172:175]
    v_accvgpr_read_b32 v4, a148
    v_accvgpr_read_b32 v5, a149
    v_mfma_f32_16x16x32_bf16 v[204:207], v[108:111], v[88:91], v[204:207]
    ds_read_b64_tr_b16 v[68:69], v28 offset:34944
    ds_read_b64_tr_b16 v[70:71], v28 offset:35968
    v_mfma_f32_16x16x32_bf16 v[236:239], v[108:111], v[92:95], v[236:239]
    buffer_load_dwordx4 v19, s[24:27], s36 offen offset:2048 lds
    v_mfma_f32_16x16x32_bf16 v[144:147], v[112:115], v[80:83], v[144:147]
    ds_read_b64_tr_b16 v[72:73], v29 offset:34944
    ds_read_b64_tr_b16 v[74:75], v29 offset:35968
    v_mfma_f32_16x16x32_bf16 v[176:179], v[112:115], v[84:87], v[176:179]
    v_accvgpr_read_b32 v6, a150
    v_accvgpr_read_b32 v7, a151
    v_mfma_f32_16x16x32_bf16 v[208:211], v[112:115], v[88:91], v[208:211]
    ds_read_b64_tr_b16 v[76:77], v30 offset:34944
    ds_read_b64_tr_b16 v[78:79], v30 offset:35968
    v_mfma_f32_16x16x32_bf16 v[240:243], v[112:115], v[92:95], v[240:243]
    v_accvgpr_read_b32 v0, a144
    v_accvgpr_read_b32 v1, a145
    v_mfma_f32_16x16x32_bf16 v[148:151], v[116:119], v[80:83], v[148:151]
    v_accvgpr_read_b32 v2, a146
    v_accvgpr_read_b32 v3, a147
    v_mfma_f32_16x16x32_bf16 v[180:183], v[116:119], v[84:87], v[180:183]
    buffer_load_dwordx4 v20, s[24:27], s36 offen offset:3072 lds
    v_mfma_f32_16x16x32_bf16 v[212:215], v[116:119], v[88:91], v[212:215]
    s_add_u32 s37, s49, 3670016
    v_cvt_pk_bf16_f32 v0, v0, v1
    v_cvt_pk_bf16_f32 v1, v2, v3
    v_mfma_f32_16x16x32_bf16 v[244:247], v[116:119], v[92:95], v[244:247]
    s_add_u32 m0, s50, 17408
    v_cvt_pk_bf16_f32 v2, v4, v5
    v_cvt_pk_bf16_f32 v3, v6, v7
    v_mfma_f32_16x16x32_bf16 v[152:155], v[120:123], v[80:83], v[152:155]
    buffer_load_dwordx4 v21, s[20:23], s37 offen offset:0 lds
    v_mfma_f32_16x16x32_bf16 v[184:187], v[120:123], v[84:87], v[184:187]
    v_accvgpr_read_b32 v12, a48
    v_accvgpr_read_b32 v13, a49
    v_mfma_f32_16x16x32_bf16 v[216:219], v[120:123], v[88:91], v[216:219]
    v_accvgpr_read_b32 v14, a50
    v_accvgpr_read_b32 v15, a51
    v_mfma_f32_16x16x32_bf16 v[248:251], v[120:123], v[92:95], v[248:251]
    buffer_store_dwordx4 v[0:3], v16, s[16:19], s38 offen offset:0
    v_mfma_f32_16x16x32_bf16 v[156:159], v[124:127], v[80:83], v[156:159]
    v_accvgpr_read_b32 v8, a16
    v_accvgpr_read_b32 v9, a17
    v_mfma_f32_16x16x32_bf16 v[188:191], v[124:127], v[84:87], v[188:191]
    v_accvgpr_read_b32 v10, a18
    v_accvgpr_read_b32 v11, a19
    v_mfma_f32_16x16x32_bf16 v[220:223], v[124:127], v[88:91], v[220:223]
    buffer_load_dwordx4 v22, s[20:23], s37 offen offset:1024 lds
    v_mfma_f32_16x16x32_bf16 v[252:255], v[124:127], v[92:95], v[252:255]
    s_waitcnt lgkmcnt(0)
    v_mul_f32 v8, s40, v8
    v_mul_f32 v9, s40, v9
    v_mfma_f32_16x16x32_bf16 v[128:131], v[48:51], v[32:35], v[128:131]
    ds_read_b64_tr_b16 v[96:97], v27 offset:43520
    ds_read_b64_tr_b16 v[98:99], v27 offset:44544
    v_mfma_f32_16x16x32_bf16 v[160:163], v[48:51], v[36:39], v[160:163]
    s_add_u32 s36, s45, 896
    v_mul_f32 v10, s40, v10
    v_mul_f32 v11, s40, v11
    v_mfma_f32_16x16x32_bf16 v[192:195], v[48:51], v[40:43], v[192:195]
    s_add_u32 m0, s42, 4096
    ds_read_b128 v[80:83], v24 offset:32768
    ds_read_b128 v[84:87], v24 offset:34816
    v_mfma_f32_16x16x32_bf16 v[224:227], v[48:51], v[44:47], v[224:227]
    buffer_load_dwordx4 v17, s[24:27], s36 offen offset:0 lds
    v_mfma_f32_16x16x32_bf16 v[132:135], v[52:55], v[32:35], v[132:135]
    ds_read_b128 v[88:91], v24 offset:36864
    ds_read_b128 v[92:95], v24 offset:38912
    v_mfma_f32_16x16x32_bf16 v[164:167], v[52:55], v[36:39], v[164:167]
    v_mul_f32 v12, s40, v12
    v_mul_f32 v13, s40, v13
    v_mfma_f32_16x16x32_bf16 v[196:199], v[52:55], v[40:43], v[196:199]
    ds_read_b64_tr_b16 v[100:101], v28 offset:43520
    ds_read_b64_tr_b16 v[102:103], v28 offset:44544
    v_mfma_f32_16x16x32_bf16 v[228:231], v[52:55], v[44:47], v[228:231]
    buffer_load_dwordx4 v18, s[24:27], s36 offen offset:1024 lds
    v_mfma_f32_16x16x32_bf16 v[136:139], v[56:59], v[32:35], v[136:139]
    ds_read_b64_tr_b16 v[104:105], v29 offset:43520
    ds_read_b64_tr_b16 v[106:107], v29 offset:44544
    v_mfma_f32_16x16x32_bf16 v[168:171], v[56:59], v[36:39], v[168:171]
    v_mul_f32 v14, s40, v14
    v_mul_f32 v15, s40, v15
    v_mfma_f32_16x16x32_bf16 v[200:203], v[56:59], v[40:43], v[200:203]
    ds_read_b64_tr_b16 v[108:109], v30 offset:43520
    ds_read_b64_tr_b16 v[110:111], v30 offset:44544
    v_mfma_f32_16x16x32_bf16 v[232:235], v[56:59], v[44:47], v[232:235]
    v_mfma_f32_16x16x32_bf16 v[140:143], v[60:63], v[32:35], v[140:143]
    ds_read_b64_tr_b16 v[112:113], v27 offset:43648
    ds_read_b64_tr_b16 v[114:115], v27 offset:44672
    v_mfma_f32_16x16x32_bf16 v[172:175], v[60:63], v[36:39], v[172:175]
    v_cvt_pk_bf16_f32 v8, v8, v9
    v_cvt_pk_bf16_f32 v9, v10, v11
    v_mfma_f32_16x16x32_bf16 v[204:207], v[60:63], v[40:43], v[204:207]
    ds_read_b64_tr_b16 v[116:117], v28 offset:43648
    ds_read_b64_tr_b16 v[118:119], v28 offset:44672
    v_mfma_f32_16x16x32_bf16 v[236:239], v[60:63], v[44:47], v[236:239]
    buffer_load_dwordx4 v19, s[24:27], s36 offen offset:2048 lds
    v_mfma_f32_16x16x32_bf16 v[144:147], v[64:67], v[32:35], v[144:147]
    ds_read_b64_tr_b16 v[120:121], v29 offset:43648
    ds_read_b64_tr_b16 v[122:123], v29 offset:44672
    v_mfma_f32_16x16x32_bf16 v[176:179], v[64:67], v[36:39], v[176:179]
    v_cvt_pk_bf16_f32 v10, v12, v13
    v_cvt_pk_bf16_f32 v11, v14, v15
    v_mfma_f32_16x16x32_bf16 v[208:211], v[64:67], v[40:43], v[208:211]
    ds_read_b64_tr_b16 v[124:125], v30 offset:43648
    ds_read_b64_tr_b16 v[126:127], v30 offset:44672
    v_mfma_f32_16x16x32_bf16 v[240:243], v[64:67], v[44:47], v[240:243]
    v_accvgpr_read_b32 v4, a180
    v_accvgpr_read_b32 v5, a181
    v_mfma_f32_16x16x32_bf16 v[148:151], v[68:71], v[32:35], v[148:151]
    v_accvgpr_read_b32 v6, a182
    v_accvgpr_read_b32 v7, a183
    v_mfma_f32_16x16x32_bf16 v[180:183], v[68:71], v[36:39], v[180:183]
    buffer_load_dwordx4 v20, s[24:27], s36 offen offset:3072 lds
    v_mfma_f32_16x16x32_bf16 v[212:215], v[68:71], v[40:43], v[212:215]
    s_add_u32 s37, s49, 3932160
    v_accvgpr_read_b32 v0, a176
    v_accvgpr_read_b32 v1, a177
    v_mfma_f32_16x16x32_bf16 v[244:247], v[68:71], v[44:47], v[244:247]
    s_add_u32 m0, s50, 26112
    v_accvgpr_read_b32 v2, a178
    v_accvgpr_read_b32 v3, a179
    v_mfma_f32_16x16x32_bf16 v[152:155], v[72:75], v[32:35], v[152:155]
    buffer_load_dwordx4 v21, s[20:23], s37 offen offset:0 lds
    v_mfma_f32_16x16x32_bf16 v[184:187], v[72:75], v[36:39], v[184:187]
    v_cvt_pk_bf16_f32 v0, v0, v1
    v_cvt_pk_bf16_f32 v1, v2, v3
    v_mfma_f32_16x16x32_bf16 v[216:219], v[72:75], v[40:43], v[216:219]
    v_cvt_pk_bf16_f32 v2, v4, v5
    v_cvt_pk_bf16_f32 v3, v6, v7
    v_mfma_f32_16x16x32_bf16 v[248:251], v[72:75], v[44:47], v[248:251]
    buffer_store_dwordx4 v[8:11], v16, s[16:19], s41 offen offset:0
    v_mfma_f32_16x16x32_bf16 v[156:159], v[76:79], v[32:35], v[156:159]
    v_accvgpr_read_b32 v12, a112
    v_accvgpr_read_b32 v13, a113
    v_mfma_f32_16x16x32_bf16 v[188:191], v[76:79], v[36:39], v[188:191]
    v_accvgpr_read_b32 v14, a114
    v_accvgpr_read_b32 v15, a115
    v_mfma_f32_16x16x32_bf16 v[220:223], v[76:79], v[40:43], v[220:223]
    buffer_load_dwordx4 v22, s[20:23], s37 offen offset:1024 lds
    v_mfma_f32_16x16x32_bf16 v[252:255], v[76:79], v[44:47], v[252:255]
    s_waitcnt vmcnt(15) lgkmcnt(0)
    s_barrier
    v_accvgpr_read_b32 v8, a80
    v_accvgpr_read_b32 v9, a81
    v_mfma_f32_16x16x32_bf16 v[128:131], v[96:99], v[80:83], v[128:131]
    ds_read_b64_tr_b16 v[48:49], v27 offset:0
    ds_read_b64_tr_b16 v[50:51], v27 offset:1024
    v_mfma_f32_16x16x32_bf16 v[160:163], v[96:99], v[84:87], v[160:163]
    s_add_u32 s36, s44, 1024
    v_accvgpr_read_b32 v10, a82
    v_accvgpr_read_b32 v11, a83
    v_mfma_f32_16x16x32_bf16 v[192:195], v[96:99], v[88:91], v[192:195]
    s_add_u32 m0, s42, 32768
    ds_read_b128 v[32:35], v25 offset:0
    ds_read_b128 v[36:39], v25 offset:2048
    v_mfma_f32_16x16x32_bf16 v[224:227], v[96:99], v[92:95], v[224:227]
    buffer_load_dwordx4 v17, s[24:27], s36 offen offset:0 lds
    v_mfma_f32_16x16x32_bf16 v[132:135], v[100:103], v[80:83], v[132:135]
    ds_read_b128 v[40:43], v25 offset:4096
    ds_read_b128 v[44:47], v25 offset:6144
    v_mfma_f32_16x16x32_bf16 v[164:167], v[100:103], v[84:87], v[164:167]
    v_mul_f32 v8, s40, v8
    v_mul_f32 v9, s40, v9
    v_mfma_f32_16x16x32_bf16 v[196:199], v[100:103], v[88:91], v[196:199]
    ds_read_b64_tr_b16 v[52:53], v28 offset:0
    ds_read_b64_tr_b16 v[54:55], v28 offset:1024
    v_mfma_f32_16x16x32_bf16 v[228:231], v[100:103], v[92:95], v[228:231]
    buffer_load_dwordx4 v18, s[24:27], s36 offen offset:1024 lds
    v_mfma_f32_16x16x32_bf16 v[136:139], v[104:107], v[80:83], v[136:139]
    ds_read_b64_tr_b16 v[56:57], v29 offset:0
    ds_read_b64_tr_b16 v[58:59], v29 offset:1024
    v_mfma_f32_16x16x32_bf16 v[168:171], v[104:107], v[84:87], v[168:171]
    v_mul_f32 v10, s40, v10
    v_mul_f32 v11, s40, v11
    v_mfma_f32_16x16x32_bf16 v[200:203], v[104:107], v[88:91], v[200:203]
    ds_read_b64_tr_b16 v[60:61], v30 offset:0
    ds_read_b64_tr_b16 v[62:63], v30 offset:1024
    v_mfma_f32_16x16x32_bf16 v[232:235], v[104:107], v[92:95], v[232:235]
    buffer_store_dwordx4 v[0:3], v16, s[16:19], s38 offen offset:1024
    v_mfma_f32_16x16x32_bf16 v[140:143], v[108:111], v[80:83], v[140:143]
    ds_read_b64_tr_b16 v[64:65], v27 offset:128
    ds_read_b64_tr_b16 v[66:67], v27 offset:1152
    v_mfma_f32_16x16x32_bf16 v[172:175], v[108:111], v[84:87], v[172:175]
    v_mul_f32 v12, s40, v12
    v_mul_f32 v13, s40, v13
    v_mfma_f32_16x16x32_bf16 v[204:207], v[108:111], v[88:91], v[204:207]
    ds_read_b64_tr_b16 v[68:69], v28 offset:128
    ds_read_b64_tr_b16 v[70:71], v28 offset:1152
    v_mfma_f32_16x16x32_bf16 v[236:239], v[108:111], v[92:95], v[236:239]
    buffer_load_dwordx4 v19, s[24:27], s36 offen offset:2048 lds
    v_mfma_f32_16x16x32_bf16 v[144:147], v[112:115], v[80:83], v[144:147]
    ds_read_b64_tr_b16 v[72:73], v29 offset:128
    ds_read_b64_tr_b16 v[74:75], v29 offset:1152
    v_mfma_f32_16x16x32_bf16 v[176:179], v[112:115], v[84:87], v[176:179]
    v_mul_f32 v14, s40, v14
    v_mul_f32 v15, s40, v15
    v_mfma_f32_16x16x32_bf16 v[208:211], v[112:115], v[88:91], v[208:211]
    ds_read_b64_tr_b16 v[76:77], v30 offset:128
    ds_read_b64_tr_b16 v[78:79], v30 offset:1152
    v_mfma_f32_16x16x32_bf16 v[240:243], v[112:115], v[92:95], v[240:243]
    v_cvt_pk_bf16_f32 v8, v8, v9
    v_cvt_pk_bf16_f32 v9, v10, v11
    v_mfma_f32_16x16x32_bf16 v[148:151], v[116:119], v[80:83], v[148:151]
    v_cvt_pk_bf16_f32 v10, v12, v13
    v_cvt_pk_bf16_f32 v11, v14, v15
    v_mfma_f32_16x16x32_bf16 v[180:183], v[116:119], v[84:87], v[180:183]
    buffer_load_dwordx4 v20, s[24:27], s36 offen offset:3072 lds
    v_mfma_f32_16x16x32_bf16 v[212:215], v[116:119], v[88:91], v[212:215]
    s_add_u32 s37, s49, 4194304
    v_accvgpr_read_b32 v4, a212
    v_accvgpr_read_b32 v5, a213
    v_mfma_f32_16x16x32_bf16 v[244:247], v[116:119], v[92:95], v[244:247]
    s_add_u32 m0, s50, 34816
    v_accvgpr_read_b32 v6, a214
    v_accvgpr_read_b32 v7, a215
    v_mfma_f32_16x16x32_bf16 v[152:155], v[120:123], v[80:83], v[152:155]
    buffer_load_dwordx4 v21, s[20:23], s37 offen offset:0 lds
    v_mfma_f32_16x16x32_bf16 v[184:187], v[120:123], v[84:87], v[184:187]
    v_accvgpr_read_b32 v0, a208
    v_accvgpr_read_b32 v1, a209
    v_mfma_f32_16x16x32_bf16 v[216:219], v[120:123], v[88:91], v[216:219]
    v_accvgpr_read_b32 v2, a210
    v_accvgpr_read_b32 v3, a211
    v_mfma_f32_16x16x32_bf16 v[248:251], v[120:123], v[92:95], v[248:251]
    buffer_store_dwordx4 v[8:11], v16, s[16:19], s41 offen offset:1024
    v_mfma_f32_16x16x32_bf16 v[156:159], v[124:127], v[80:83], v[156:159]
    s_add_u32 s41, s41, 4096
    v_cvt_pk_bf16_f32 v0, v0, v1
    v_cvt_pk_bf16_f32 v1, v2, v3
    v_mfma_f32_16x16x32_bf16 v[188:191], v[124:127], v[84:87], v[188:191]
    v_cvt_pk_bf16_f32 v2, v4, v5
    v_cvt_pk_bf16_f32 v3, v6, v7
    v_mfma_f32_16x16x32_bf16 v[220:223], v[124:127], v[88:91], v[220:223]
    buffer_load_dwordx4 v22, s[20:23], s37 offen offset:1024 lds
    v_mfma_f32_16x16x32_bf16 v[252:255], v[124:127], v[92:95], v[252:255]
    s_waitcnt lgkmcnt(0)
    v_accvgpr_read_b32 v12, a52
    v_accvgpr_read_b32 v13, a53
    v_mfma_f32_16x16x32_bf16 v[128:131], v[48:51], v[32:35], v[128:131]
    ds_read_b64_tr_b16 v[96:97], v27 offset:8704
    ds_read_b64_tr_b16 v[98:99], v27 offset:9728
    v_mfma_f32_16x16x32_bf16 v[160:163], v[48:51], v[36:39], v[160:163]
    s_add_u32 s36, s45, 1024
    v_accvgpr_read_b32 v14, a54
    v_accvgpr_read_b32 v15, a55
    v_mfma_f32_16x16x32_bf16 v[192:195], v[48:51], v[40:43], v[192:195]
gated_mix__ssm_conv_h3__compressed_kv_cla__prompt_kernel_pad5:
    s_cbranch_execz gated_mix__ssm_conv_h3__compressed_kv_cla__prompt_kernel_pad9
    s_add_u32 m0, s42, 36864
    ds_read_b128 v[80:83], v26 offset:0
    ds_read_b128 v[84:87], v26 offset:2048
    v_mfma_f32_16x16x32_bf16 v[224:227], v[48:51], v[44:47], v[224:227]
    buffer_load_dwordx4 v17, s[24:27], s36 offen offset:0 lds
    v_mfma_f32_16x16x32_bf16 v[132:135], v[52:55], v[32:35], v[132:135]
    ds_read_b128 v[88:91], v26 offset:4096
    ds_read_b128 v[92:95], v26 offset:6144
    v_mfma_f32_16x16x32_bf16 v[164:167], v[52:55], v[36:39], v[164:167]
    v_accvgpr_read_b32 v8, a20
    v_accvgpr_read_b32 v9, a21
    v_mfma_f32_16x16x32_bf16 v[196:199], v[52:55], v[40:43], v[196:199]
    ds_read_b64_tr_b16 v[100:101], v28 offset:8704
    ds_read_b64_tr_b16 v[102:103], v28 offset:9728
    v_mfma_f32_16x16x32_bf16 v[228:231], v[52:55], v[44:47], v[228:231]
    buffer_load_dwordx4 v18, s[24:27], s36 offen offset:1024 lds
    v_mfma_f32_16x16x32_bf16 v[136:139], v[56:59], v[32:35], v[136:139]
    ds_read_b64_tr_b16 v[104:105], v29 offset:8704
    ds_read_b64_tr_b16 v[106:107], v29 offset:9728
    v_mfma_f32_16x16x32_bf16 v[168:171], v[56:59], v[36:39], v[168:171]
    v_accvgpr_read_b32 v10, a22
    v_accvgpr_read_b32 v11, a23
    v_mfma_f32_16x16x32_bf16 v[200:203], v[56:59], v[40:43], v[200:203]
    ds_read_b64_tr_b16 v[108:109], v30 offset:8704
    ds_read_b64_tr_b16 v[110:111], v30 offset:9728
    v_mfma_f32_16x16x32_bf16 v[232:235], v[56:59], v[44:47], v[232:235]
    buffer_store_dwordx4 v[0:3], v16, s[16:19], s38 offen offset:2048
    v_mfma_f32_16x16x32_bf16 v[140:143], v[60:63], v[32:35], v[140:143]
    ds_read_b64_tr_b16 v[112:113], v27 offset:8832
    ds_read_b64_tr_b16 v[114:115], v27 offset:9856
    v_mfma_f32_16x16x32_bf16 v[172:175], v[60:63], v[36:39], v[172:175]
    v_mul_f32 v8, s40, v8
    v_mul_f32 v9, s40, v9
    v_mfma_f32_16x16x32_bf16 v[204:207], v[60:63], v[40:43], v[204:207]
    ds_read_b64_tr_b16 v[116:117], v28 offset:8832
    ds_read_b64_tr_b16 v[118:119], v28 offset:9856
    v_mfma_f32_16x16x32_bf16 v[236:239], v[60:63], v[44:47], v[236:239]
    buffer_load_dwordx4 v19, s[24:27], s36 offen offset:2048 lds
    v_mfma_f32_16x16x32_bf16 v[144:147], v[64:67], v[32:35], v[144:147]
    ds_read_b64_tr_b16 v[120:121], v29 offset:8832
    ds_read_b64_tr_b16 v[122:123], v29 offset:9856
    v_mfma_f32_16x16x32_bf16 v[176:179], v[64:67], v[36:39], v[176:179]
    v_mul_f32 v10, s40, v10
    v_mul_f32 v11, s40, v11
    v_mfma_f32_16x16x32_bf16 v[208:211], v[64:67], v[40:43], v[208:211]
    ds_read_b64_tr_b16 v[124:125], v30 offset:8832
    ds_read_b64_tr_b16 v[126:127], v30 offset:9856
    v_mfma_f32_16x16x32_bf16 v[240:243], v[64:67], v[44:47], v[240:243]
    v_mul_f32 v12, s40, v12
    v_mul_f32 v13, s40, v13
    v_mfma_f32_16x16x32_bf16 v[148:151], v[68:71], v[32:35], v[148:151]
    v_mul_f32 v14, s40, v14
    v_mul_f32 v15, s40, v15
    v_mfma_f32_16x16x32_bf16 v[180:183], v[68:71], v[36:39], v[180:183]
    buffer_load_dwordx4 v20, s[24:27], s36 offen offset:3072 lds
    v_mfma_f32_16x16x32_bf16 v[212:215], v[68:71], v[40:43], v[212:215]
    s_add_u32 s37, s49, 4456448
    v_cvt_pk_bf16_f32 v8, v8, v9
    v_cvt_pk_bf16_f32 v9, v10, v11
    v_mfma_f32_16x16x32_bf16 v[244:247], v[68:71], v[44:47], v[244:247]
    s_add_u32 m0, s50, 43520
    v_cvt_pk_bf16_f32 v10, v12, v13
    v_cvt_pk_bf16_f32 v11, v14, v15
    v_mfma_f32_16x16x32_bf16 v[152:155], v[72:75], v[32:35], v[152:155]
    buffer_load_dwordx4 v21, s[20:23], s37 offen offset:0 lds
    v_mfma_f32_16x16x32_bf16 v[184:187], v[72:75], v[36:39], v[184:187]
    v_accvgpr_read_b32 v4, a244
    v_accvgpr_read_b32 v5, a245
    v_mfma_f32_16x16x32_bf16 v[216:219], v[72:75], v[40:43], v[216:219]
    v_accvgpr_read_b32 v6, a246
    v_accvgpr_read_b32 v7, a247
    v_mfma_f32_16x16x32_bf16 v[248:251], v[72:75], v[44:47], v[248:251]
    buffer_store_dwordx4 v[8:11], v16, s[16:19], s41 offen offset:0
    v_mfma_f32_16x16x32_bf16 v[156:159], v[76:79], v[32:35], v[156:159]
    v_accvgpr_read_b32 v0, a240
    v_accvgpr_read_b32 v1, a241
    v_mfma_f32_16x16x32_bf16 v[188:191], v[76:79], v[36:39], v[188:191]
    v_accvgpr_read_b32 v2, a242
    v_accvgpr_read_b32 v3, a243
    v_mfma_f32_16x16x32_bf16 v[220:223], v[76:79], v[40:43], v[220:223]
    buffer_load_dwordx4 v22, s[20:23], s37 offen offset:1024 lds
    v_mfma_f32_16x16x32_bf16 v[252:255], v[76:79], v[44:47], v[252:255]
    s_waitcnt vmcnt(16) lgkmcnt(0)
    s_barrier
    v_cvt_pk_bf16_f32 v0, v0, v1
    v_cvt_pk_bf16_f32 v1, v2, v3
    v_mfma_f32_16x16x32_bf16 v[128:131], v[96:99], v[80:83], v[128:131]
    ds_read_b64_tr_b16 v[48:49], v27 offset:17408
    ds_read_b64_tr_b16 v[50:51], v27 offset:18432
    v_mfma_f32_16x16x32_bf16 v[160:163], v[96:99], v[84:87], v[160:163]
    s_add_u32 s36, s44, 1152
    v_cvt_pk_bf16_f32 v2, v4, v5
    v_cvt_pk_bf16_f32 v3, v6, v7
    v_mfma_f32_16x16x32_bf16 v[192:195], v[96:99], v[88:91], v[192:195]
    s_add_u32 m0, s42, 65536
    ds_read_b128 v[32:35], v23 offset:0
    ds_read_b128 v[36:39], v23 offset:2048
    v_mfma_f32_16x16x32_bf16 v[224:227], v[96:99], v[92:95], v[224:227]
    buffer_load_dwordx4 v17, s[24:27], s36 offen offset:0 lds
    v_mfma_f32_16x16x32_bf16 v[132:135], v[100:103], v[80:83], v[132:135]
    ds_read_b128 v[40:43], v23 offset:4096
    ds_read_b128 v[44:47], v23 offset:6144
    v_mfma_f32_16x16x32_bf16 v[164:167], v[100:103], v[84:87], v[164:167]
    v_accvgpr_read_b32 v12, a116
    v_accvgpr_read_b32 v13, a117
    v_mfma_f32_16x16x32_bf16 v[196:199], v[100:103], v[88:91], v[196:199]
    ds_read_b64_tr_b16 v[52:53], v28 offset:17408
    ds_read_b64_tr_b16 v[54:55], v28 offset:18432
    v_mfma_f32_16x16x32_bf16 v[228:231], v[100:103], v[92:95], v[228:231]
    buffer_load_dwordx4 v18, s[24:27], s36 offen offset:1024 lds
    v_mfma_f32_16x16x32_bf16 v[136:139], v[104:107], v[80:83], v[136:139]
    ds_read_b64_tr_b16 v[56:57], v29 offset:17408
    ds_read_b64_tr_b16 v[58:59], v29 offset:18432
    v_mfma_f32_16x16x32_bf16 v[168:171], v[104:107], v[84:87], v[168:171]
    v_accvgpr_read_b32 v14, a118
    v_accvgpr_read_b32 v15, a119
    v_mfma_f32_16x16x32_bf16 v[200:203], v[104:107], v[88:91], v[200:203]
    ds_read_b64_tr_b16 v[60:61], v30 offset:17408
    ds_read_b64_tr_b16 v[62:63], v30 offset:18432
    v_mfma_f32_16x16x32_bf16 v[232:235], v[104:107], v[92:95], v[232:235]
    buffer_store_dwordx4 v[0:3], v16, s[16:19], s38 offen offset:3072
    v_mfma_f32_16x16x32_bf16 v[140:143], v[108:111], v[80:83], v[140:143]
    s_add_u32 s38, s38, 16384
    ds_read_b64_tr_b16 v[64:65], v27 offset:17536
    ds_read_b64_tr_b16 v[66:67], v27 offset:18560
    v_mfma_f32_16x16x32_bf16 v[172:175], v[108:111], v[84:87], v[172:175]
    v_accvgpr_read_b32 v8, a84
    v_accvgpr_read_b32 v9, a85
    v_mfma_f32_16x16x32_bf16 v[204:207], v[108:111], v[88:91], v[204:207]
    ds_read_b64_tr_b16 v[68:69], v28 offset:17536
    ds_read_b64_tr_b16 v[70:71], v28 offset:18560
    v_mfma_f32_16x16x32_bf16 v[236:239], v[108:111], v[92:95], v[236:239]
    buffer_load_dwordx4 v19, s[24:27], s36 offen offset:2048 lds
    v_mfma_f32_16x16x32_bf16 v[144:147], v[112:115], v[80:83], v[144:147]
    ds_read_b64_tr_b16 v[72:73], v29 offset:17536
    ds_read_b64_tr_b16 v[74:75], v29 offset:18560
    v_mfma_f32_16x16x32_bf16 v[176:179], v[112:115], v[84:87], v[176:179]
    v_accvgpr_read_b32 v10, a86
    v_accvgpr_read_b32 v11, a87
    v_mfma_f32_16x16x32_bf16 v[208:211], v[112:115], v[88:91], v[208:211]
    ds_read_b64_tr_b16 v[76:77], v30 offset:17536
    ds_read_b64_tr_b16 v[78:79], v30 offset:18560
    v_mfma_f32_16x16x32_bf16 v[240:243], v[112:115], v[92:95], v[240:243]
    v_mul_f32 v8, s40, v8
    v_mul_f32 v9, s40, v9
    v_mfma_f32_16x16x32_bf16 v[148:151], v[116:119], v[80:83], v[148:151]
    v_mul_f32 v10, s40, v10
    v_mul_f32 v11, s40, v11
    v_mfma_f32_16x16x32_bf16 v[180:183], v[116:119], v[84:87], v[180:183]
    buffer_load_dwordx4 v20, s[24:27], s36 offen offset:3072 lds
    v_mfma_f32_16x16x32_bf16 v[212:215], v[116:119], v[88:91], v[212:215]
    s_add_u32 s37, s49, 4718592
    v_mul_f32 v12, s40, v12
    v_mul_f32 v13, s40, v13
    v_mfma_f32_16x16x32_bf16 v[244:247], v[116:119], v[92:95], v[244:247]
    s_add_u32 m0, s50, 0
    v_mul_f32 v14, s40, v14
    v_mul_f32 v15, s40, v15
    v_mfma_f32_16x16x32_bf16 v[152:155], v[120:123], v[80:83], v[152:155]
    buffer_load_dwordx4 v21, s[20:23], s37 offen offset:0 lds
    v_mfma_f32_16x16x32_bf16 v[184:187], v[120:123], v[84:87], v[184:187]
    v_cvt_pk_bf16_f32 v8, v8, v9
    v_cvt_pk_bf16_f32 v9, v10, v11
    v_mfma_f32_16x16x32_bf16 v[216:219], v[120:123], v[88:91], v[216:219]
    v_cvt_pk_bf16_f32 v10, v12, v13
    v_cvt_pk_bf16_f32 v11, v14, v15
    v_mfma_f32_16x16x32_bf16 v[248:251], v[120:123], v[92:95], v[248:251]
    buffer_store_dwordx4 v[8:11], v16, s[16:19], s41 offen offset:1024
    v_mfma_f32_16x16x32_bf16 v[156:159], v[124:127], v[80:83], v[156:159]
    s_add_u32 s41, s41, 12288
    v_accvgpr_read_b32 v4, a156
    v_accvgpr_read_b32 v5, a157
    v_mfma_f32_16x16x32_bf16 v[188:191], v[124:127], v[84:87], v[188:191]
    v_accvgpr_read_b32 v6, a158
    v_accvgpr_read_b32 v7, a159
    v_mfma_f32_16x16x32_bf16 v[220:223], v[124:127], v[88:91], v[220:223]
    buffer_load_dwordx4 v22, s[20:23], s37 offen offset:1024 lds
    v_mfma_f32_16x16x32_bf16 v[252:255], v[124:127], v[92:95], v[252:255]
    s_waitcnt lgkmcnt(0)
    v_accvgpr_read_b32 v0, a152
    v_accvgpr_read_b32 v1, a153
    v_mfma_f32_16x16x32_bf16 v[128:131], v[48:51], v[32:35], v[128:131]
    ds_read_b64_tr_b16 v[96:97], v27 offset:26112
    ds_read_b64_tr_b16 v[98:99], v27 offset:27136
    v_mfma_f32_16x16x32_bf16 v[160:163], v[48:51], v[36:39], v[160:163]
    s_add_u32 s36, s45, 1152
    v_accvgpr_read_b32 v2, a154
    v_accvgpr_read_b32 v3, a155
    v_mfma_f32_16x16x32_bf16 v[192:195], v[48:51], v[40:43], v[192:195]
    s_add_u32 m0, s42, 69632
    ds_read_b128 v[80:83], v24 offset:0
    ds_read_b128 v[84:87], v24 offset:2048
    v_mfma_f32_16x16x32_bf16 v[224:227], v[48:51], v[44:47], v[224:227]
    buffer_load_dwordx4 v17, s[24:27], s36 offen offset:0 lds
    v_mfma_f32_16x16x32_bf16 v[132:135], v[52:55], v[32:35], v[132:135]
    ds_read_b128 v[88:91], v24 offset:4096
    ds_read_b128 v[92:95], v24 offset:6144
    v_mfma_f32_16x16x32_bf16 v[164:167], v[52:55], v[36:39], v[164:167]
    v_cvt_pk_bf16_f32 v0, v0, v1
    v_cvt_pk_bf16_f32 v1, v2, v3
    v_mfma_f32_16x16x32_bf16 v[196:199], v[52:55], v[40:43], v[196:199]
    ds_read_b64_tr_b16 v[100:101], v28 offset:26112
    ds_read_b64_tr_b16 v[102:103], v28 offset:27136
    v_mfma_f32_16x16x32_bf16 v[228:231], v[52:55], v[44:47], v[228:231]
    buffer_load_dwordx4 v18, s[24:27], s36 offen offset:1024 lds
    v_mfma_f32_16x16x32_bf16 v[136:139], v[56:59], v[32:35], v[136:139]
    ds_read_b64_tr_b16 v[104:105], v29 offset:26112
    ds_read_b64_tr_b16 v[106:107], v29 offset:27136
    v_mfma_f32_16x16x32_bf16 v[168:171], v[56:59], v[36:39], v[168:171]
    v_cvt_pk_bf16_f32 v2, v4, v5
    v_cvt_pk_bf16_f32 v3, v6, v7
    v_mfma_f32_16x16x32_bf16 v[200:203], v[56:59], v[40:43], v[200:203]
    ds_read_b64_tr_b16 v[108:109], v30 offset:26112
    ds_read_b64_tr_b16 v[110:111], v30 offset:27136
    v_mfma_f32_16x16x32_bf16 v[232:235], v[56:59], v[44:47], v[232:235]
    buffer_store_dwordx4 v[0:3], v16, s[16:19], s38 offen offset:0
    v_mfma_f32_16x16x32_bf16 v[140:143], v[60:63], v[32:35], v[140:143]
    ds_read_b64_tr_b16 v[112:113], v27 offset:26240
    ds_read_b64_tr_b16 v[114:115], v27 offset:27264
    v_mfma_f32_16x16x32_bf16 v[172:175], v[60:63], v[36:39], v[172:175]
    v_accvgpr_read_b32 v12, a56
    v_accvgpr_read_b32 v13, a57
    v_mfma_f32_16x16x32_bf16 v[204:207], v[60:63], v[40:43], v[204:207]
    ds_read_b64_tr_b16 v[116:117], v28 offset:26240
    ds_read_b64_tr_b16 v[118:119], v28 offset:27264
    v_mfma_f32_16x16x32_bf16 v[236:239], v[60:63], v[44:47], v[236:239]
    buffer_load_dwordx4 v19, s[24:27], s36 offen offset:2048 lds
    v_mfma_f32_16x16x32_bf16 v[144:147], v[64:67], v[32:35], v[144:147]
    ds_read_b64_tr_b16 v[120:121], v29 offset:26240
    ds_read_b64_tr_b16 v[122:123], v29 offset:27264
    v_mfma_f32_16x16x32_bf16 v[176:179], v[64:67], v[36:39], v[176:179]
    v_accvgpr_read_b32 v14, a58
    v_accvgpr_read_b32 v15, a59
    v_mfma_f32_16x16x32_bf16 v[208:211], v[64:67], v[40:43], v[208:211]
    ds_read_b64_tr_b16 v[124:125], v30 offset:26240
    ds_read_b64_tr_b16 v[126:127], v30 offset:27264
    v_mfma_f32_16x16x32_bf16 v[240:243], v[64:67], v[44:47], v[240:243]
    v_accvgpr_read_b32 v8, a24
    v_accvgpr_read_b32 v9, a25
    v_mfma_f32_16x16x32_bf16 v[148:151], v[68:71], v[32:35], v[148:151]
    v_accvgpr_read_b32 v10, a26
    v_accvgpr_read_b32 v11, a27
    v_mfma_f32_16x16x32_bf16 v[180:183], v[68:71], v[36:39], v[180:183]
    buffer_load_dwordx4 v20, s[24:27], s36 offen offset:3072 lds
    v_mfma_f32_16x16x32_bf16 v[212:215], v[68:71], v[40:43], v[212:215]
    s_add_u32 s37, s49, 4980736
    v_mul_f32 v8, s40, v8
    v_mul_f32 v9, s40, v9
    v_mfma_f32_16x16x32_bf16 v[244:247], v[68:71], v[44:47], v[244:247]
    s_add_u32 m0, s50, 8704
    v_mul_f32 v10, s40, v10
    v_mul_f32 v11, s40, v11
    v_mfma_f32_16x16x32_bf16 v[152:155], v[72:75], v[32:35], v[152:155]
    buffer_load_dwordx4 v21, s[20:23], s37 offen offset:0 lds
    v_mfma_f32_16x16x32_bf16 v[184:187], v[72:75], v[36:39], v[184:187]
    v_mul_f32 v12, s40, v12
    v_mul_f32 v13, s40, v13
    v_mfma_f32_16x16x32_bf16 v[216:219], v[72:75], v[40:43], v[216:219]
    v_mul_f32 v14, s40, v14
    v_mul_f32 v15, s40, v15
    v_mfma_f32_16x16x32_bf16 v[248:251], v[72:75], v[44:47], v[248:251]
    v_mfma_f32_16x16x32_bf16 v[156:159], v[76:79], v[32:35], v[156:159]
    v_cvt_pk_bf16_f32 v8, v8, v9
    v_cvt_pk_bf16_f32 v9, v10, v11
    v_mfma_f32_16x16x32_bf16 v[188:191], v[76:79], v[36:39], v[188:191]
    v_cvt_pk_bf16_f32 v10, v12, v13
    v_cvt_pk_bf16_f32 v11, v14, v15
    v_mfma_f32_16x16x32_bf16 v[220:223], v[76:79], v[40:43], v[220:223]
    buffer_load_dwordx4 v22, s[20:23], s37 offen offset:1024 lds
    v_mfma_f32_16x16x32_bf16 v[252:255], v[76:79], v[44:47], v[252:255]
    s_waitcnt vmcnt(15) lgkmcnt(0)
    s_barrier
    v_accvgpr_read_b32 v4, a188
    v_accvgpr_read_b32 v5, a189
    v_mfma_f32_16x16x32_bf16 v[128:131], v[96:99], v[80:83], v[128:131]
    ds_read_b64_tr_b16 v[48:49], v27 offset:34816
    ds_read_b64_tr_b16 v[50:51], v27 offset:35840
    v_mfma_f32_16x16x32_bf16 v[160:163], v[96:99], v[84:87], v[160:163]
    s_add_u32 s36, s44, 1280
    v_accvgpr_read_b32 v6, a190
    v_accvgpr_read_b32 v7, a191
    v_mfma_f32_16x16x32_bf16 v[192:195], v[96:99], v[88:91], v[192:195]
    s_add_u32 m0, s42, 0
    ds_read_b128 v[32:35], v23 offset:32768
    ds_read_b128 v[36:39], v23 offset:34816
    v_mfma_f32_16x16x32_bf16 v[224:227], v[96:99], v[92:95], v[224:227]
    buffer_load_dwordx4 v17, s[24:27], s36 offen offset:0 lds
    v_mfma_f32_16x16x32_bf16 v[132:135], v[100:103], v[80:83], v[132:135]
    ds_read_b128 v[40:43], v23 offset:36864
    ds_read_b128 v[44:47], v23 offset:38912
    v_mfma_f32_16x16x32_bf16 v[164:167], v[100:103], v[84:87], v[164:167]
    v_accvgpr_read_b32 v0, a184
    v_accvgpr_read_b32 v1, a185
    v_mfma_f32_16x16x32_bf16 v[196:199], v[100:103], v[88:91], v[196:199]
    ds_read_b64_tr_b16 v[52:53], v28 offset:34816
    ds_read_b64_tr_b16 v[54:55], v28 offset:35840
    v_mfma_f32_16x16x32_bf16 v[228:231], v[100:103], v[92:95], v[228:231]
    buffer_load_dwordx4 v18, s[24:27], s36 offen offset:1024 lds
    v_mfma_f32_16x16x32_bf16 v[136:139], v[104:107], v[80:83], v[136:139]
    ds_read_b64_tr_b16 v[56:57], v29 offset:34816
    ds_read_b64_tr_b16 v[58:59], v29 offset:35840
    v_mfma_f32_16x16x32_bf16 v[168:171], v[104:107], v[84:87], v[168:171]
    v_accvgpr_read_b32 v2, a186
    v_accvgpr_read_b32 v3, a187
    v_mfma_f32_16x16x32_bf16 v[200:203], v[104:107], v[88:91], v[200:203]
    ds_read_b64_tr_b16 v[60:61], v30 offset:34816
    ds_read_b64_tr_b16 v[62:63], v30 offset:35840
    v_mfma_f32_16x16x32_bf16 v[232:235], v[104:107], v[92:95], v[232:235]
    buffer_store_dwordx4 v[8:11], v16, s[16:19], s41 offen offset:0
    v_mfma_f32_16x16x32_bf16 v[140:143], v[108:111], v[80:83], v[140:143]
    ds_read_b64_tr_b16 v[64:65], v27 offset:34944
    ds_read_b64_tr_b16 v[66:67], v27 offset:35968
    v_mfma_f32_16x16x32_bf16 v[172:175], v[108:111], v[84:87], v[172:175]
    v_cvt_pk_bf16_f32 v0, v0, v1
    v_cvt_pk_bf16_f32 v1, v2, v3
    v_mfma_f32_16x16x32_bf16 v[204:207], v[108:111], v[88:91], v[204:207]
    ds_read_b64_tr_b16 v[68:69], v28 offset:34944
    ds_read_b64_tr_b16 v[70:71], v28 offset:35968
    v_mfma_f32_16x16x32_bf16 v[236:239], v[108:111], v[92:95], v[236:239]
    buffer_load_dwordx4 v19, s[24:27], s36 offen offset:2048 lds
    v_mfma_f32_16x16x32_bf16 v[144:147], v[112:115], v[80:83], v[144:147]
    ds_read_b64_tr_b16 v[72:73], v29 offset:34944
    ds_read_b64_tr_b16 v[74:75], v29 offset:35968
    v_mfma_f32_16x16x32_bf16 v[176:179], v[112:115], v[84:87], v[176:179]
    v_cvt_pk_bf16_f32 v2, v4, v5
    v_cvt_pk_bf16_f32 v3, v6, v7
    v_mfma_f32_16x16x32_bf16 v[208:211], v[112:115], v[88:91], v[208:211]
    ds_read_b64_tr_b16 v[76:77], v30 offset:34944
    ds_read_b64_tr_b16 v[78:79], v30 offset:35968
    v_mfma_f32_16x16x32_bf16 v[240:243], v[112:115], v[92:95], v[240:243]
    v_accvgpr_read_b32 v12, a120
    v_accvgpr_read_b32 v13, a121
    v_mfma_f32_16x16x32_bf16 v[148:151], v[116:119], v[80:83], v[148:151]
    v_accvgpr_read_b32 v14, a122
    v_accvgpr_read_b32 v15, a123
    v_mfma_f32_16x16x32_bf16 v[180:183], v[116:119], v[84:87], v[180:183]
    buffer_load_dwordx4 v20, s[24:27], s36 offen offset:3072 lds
    v_mfma_f32_16x16x32_bf16 v[212:215], v[116:119], v[88:91], v[212:215]
    s_add_u32 s37, s49, 5242880
    v_accvgpr_read_b32 v8, a88
    v_accvgpr_read_b32 v9, a89
    v_mfma_f32_16x16x32_bf16 v[244:247], v[116:119], v[92:95], v[244:247]
    s_add_u32 m0, s50, 17408
    v_accvgpr_read_b32 v10, a90
    v_accvgpr_read_b32 v11, a91
    v_mfma_f32_16x16x32_bf16 v[152:155], v[120:123], v[80:83], v[152:155]
    buffer_load_dwordx4 v21, s[20:23], s37 offen offset:0 lds
    v_mfma_f32_16x16x32_bf16 v[184:187], v[120:123], v[84:87], v[184:187]
    v_mul_f32 v8, s40, v8
    v_mul_f32 v9, s40, v9
    v_mfma_f32_16x16x32_bf16 v[216:219], v[120:123], v[88:91], v[216:219]
    v_mul_f32 v10, s40, v10
    v_mul_f32 v11, s40, v11
    v_mfma_f32_16x16x32_bf16 v[248:251], v[120:123], v[92:95], v[248:251]
    buffer_store_dwordx4 v[0:3], v16, s[16:19], s38 offen offset:1024
    v_mfma_f32_16x16x32_bf16 v[156:159], v[124:127], v[80:83], v[156:159]
    v_mul_f32 v12, s40, v12
    v_mul_f32 v13, s40, v13
    v_mfma_f32_16x16x32_bf16 v[188:191], v[124:127], v[84:87], v[188:191]
    v_mul_f32 v14, s40, v14
    v_mul_f32 v15, s40, v15
    v_mfma_f32_16x16x32_bf16 v[220:223], v[124:127], v[88:91], v[220:223]
    buffer_load_dwordx4 v22, s[20:23], s37 offen offset:1024 lds
    v_mfma_f32_16x16x32_bf16 v[252:255], v[124:127], v[92:95], v[252:255]
    s_waitcnt lgkmcnt(0)
    v_cvt_pk_bf16_f32 v8, v8, v9
    v_cvt_pk_bf16_f32 v9, v10, v11
    v_mfma_f32_16x16x32_bf16 v[128:131], v[48:51], v[32:35], v[128:131]
    ds_read_b64_tr_b16 v[96:97], v27 offset:43520
    ds_read_b64_tr_b16 v[98:99], v27 offset:44544
    v_mfma_f32_16x16x32_bf16 v[160:163], v[48:51], v[36:39], v[160:163]
    s_add_u32 s36, s45, 1280
    v_cvt_pk_bf16_f32 v10, v12, v13
    v_cvt_pk_bf16_f32 v11, v14, v15
    v_mfma_f32_16x16x32_bf16 v[192:195], v[48:51], v[40:43], v[192:195]
    s_add_u32 m0, s42, 4096
    ds_read_b128 v[80:83], v24 offset:32768
    ds_read_b128 v[84:87], v24 offset:34816
    v_mfma_f32_16x16x32_bf16 v[224:227], v[48:51], v[44:47], v[224:227]
    buffer_load_dwordx4 v17, s[24:27], s36 offen offset:0 lds
    v_mfma_f32_16x16x32_bf16 v[132:135], v[52:55], v[32:35], v[132:135]
    ds_read_b128 v[88:91], v24 offset:36864
    ds_read_b128 v[92:95], v24 offset:38912
    v_mfma_f32_16x16x32_bf16 v[164:167], v[52:55], v[36:39], v[164:167]
    v_accvgpr_read_b32 v4, a220
    v_accvgpr_read_b32 v5, a221
    v_mfma_f32_16x16x32_bf16 v[196:199], v[52:55], v[40:43], v[196:199]
    ds_read_b64_tr_b16 v[100:101], v28 offset:43520
    ds_read_b64_tr_b16 v[102:103], v28 offset:44544
    v_mfma_f32_16x16x32_bf16 v[228:231], v[52:55], v[44:47], v[228:231]
    buffer_load_dwordx4 v18, s[24:27], s36 offen offset:1024 lds
    v_mfma_f32_16x16x32_bf16 v[136:139], v[56:59], v[32:35], v[136:139]
    ds_read_b64_tr_b16 v[104:105], v29 offset:43520
    ds_read_b64_tr_b16 v[106:107], v29 offset:44544
    v_mfma_f32_16x16x32_bf16 v[168:171], v[56:59], v[36:39], v[168:171]
    v_accvgpr_read_b32 v6, a222
    v_accvgpr_read_b32 v7, a223
    v_mfma_f32_16x16x32_bf16 v[200:203], v[56:59], v[40:43], v[200:203]
    ds_read_b64_tr_b16 v[108:109], v30 offset:43520
    ds_read_b64_tr_b16 v[110:111], v30 offset:44544
    v_mfma_f32_16x16x32_bf16 v[232:235], v[56:59], v[44:47], v[232:235]
    buffer_store_dwordx4 v[8:11], v16, s[16:19], s41 offen offset:1024
    v_mfma_f32_16x16x32_bf16 v[140:143], v[60:63], v[32:35], v[140:143]
    s_add_u32 s41, s41, 4096
    ds_read_b64_tr_b16 v[112:113], v27 offset:43648
    ds_read_b64_tr_b16 v[114:115], v27 offset:44672
    v_mfma_f32_16x16x32_bf16 v[172:175], v[60:63], v[36:39], v[172:175]
    v_accvgpr_read_b32 v0, a216
    v_accvgpr_read_b32 v1, a217
    v_mfma_f32_16x16x32_bf16 v[204:207], v[60:63], v[40:43], v[204:207]
    ds_read_b64_tr_b16 v[116:117], v28 offset:43648
    ds_read_b64_tr_b16 v[118:119], v28 offset:44672
    v_mfma_f32_16x16x32_bf16 v[236:239], v[60:63], v[44:47], v[236:239]
    buffer_load_dwordx4 v19, s[24:27], s36 offen offset:2048 lds
    v_mfma_f32_16x16x32_bf16 v[144:147], v[64:67], v[32:35], v[144:147]
    ds_read_b64_tr_b16 v[120:121], v29 offset:43648
    ds_read_b64_tr_b16 v[122:123], v29 offset:44672
    v_mfma_f32_16x16x32_bf16 v[176:179], v[64:67], v[36:39], v[176:179]
    v_accvgpr_read_b32 v2, a218
    v_accvgpr_read_b32 v3, a219
    v_mfma_f32_16x16x32_bf16 v[208:211], v[64:67], v[40:43], v[208:211]
    ds_read_b64_tr_b16 v[124:125], v30 offset:43648
    ds_read_b64_tr_b16 v[126:127], v30 offset:44672
    v_mfma_f32_16x16x32_bf16 v[240:243], v[64:67], v[44:47], v[240:243]
    v_cvt_pk_bf16_f32 v0, v0, v1
    v_cvt_pk_bf16_f32 v1, v2, v3
    v_mfma_f32_16x16x32_bf16 v[148:151], v[68:71], v[32:35], v[148:151]
    v_cvt_pk_bf16_f32 v2, v4, v5
    v_cvt_pk_bf16_f32 v3, v6, v7
    v_mfma_f32_16x16x32_bf16 v[180:183], v[68:71], v[36:39], v[180:183]
    buffer_load_dwordx4 v20, s[24:27], s36 offen offset:3072 lds
    v_mfma_f32_16x16x32_bf16 v[212:215], v[68:71], v[40:43], v[212:215]
    s_add_u32 s37, s49, 5505024
    v_accvgpr_read_b32 v12, a60
    v_accvgpr_read_b32 v13, a61
    v_mfma_f32_16x16x32_bf16 v[244:247], v[68:71], v[44:47], v[244:247]
    s_add_u32 m0, s50, 26112
    v_accvgpr_read_b32 v14, a62
    v_accvgpr_read_b32 v15, a63
    v_mfma_f32_16x16x32_bf16 v[152:155], v[72:75], v[32:35], v[152:155]
    buffer_load_dwordx4 v21, s[20:23], s37 offen offset:0 lds
    v_mfma_f32_16x16x32_bf16 v[184:187], v[72:75], v[36:39], v[184:187]
    v_accvgpr_read_b32 v8, a28
    v_accvgpr_read_b32 v9, a29
    v_mfma_f32_16x16x32_bf16 v[216:219], v[72:75], v[40:43], v[216:219]
    v_accvgpr_read_b32 v10, a30
    v_accvgpr_read_b32 v11, a31
    v_mfma_f32_16x16x32_bf16 v[248:251], v[72:75], v[44:47], v[248:251]
    buffer_store_dwordx4 v[0:3], v16, s[16:19], s38 offen offset:2048
    v_mfma_f32_16x16x32_bf16 v[156:159], v[76:79], v[32:35], v[156:159]
    v_mul_f32 v8, s40, v8
    v_mul_f32 v9, s40, v9
    v_mfma_f32_16x16x32_bf16 v[188:191], v[76:79], v[36:39], v[188:191]
    v_mul_f32 v10, s40, v10
    v_mul_f32 v11, s40, v11
    v_mfma_f32_16x16x32_bf16 v[220:223], v[76:79], v[40:43], v[220:223]
    buffer_load_dwordx4 v22, s[20:23], s37 offen offset:1024 lds
    v_mfma_f32_16x16x32_bf16 v[252:255], v[76:79], v[44:47], v[252:255]
    s_waitcnt vmcnt(16) lgkmcnt(0)
    s_barrier
    v_mul_f32 v12, s40, v12
    v_mul_f32 v13, s40, v13
    v_mfma_f32_16x16x32_bf16 v[128:131], v[96:99], v[80:83], v[128:131]
    ds_read_b64_tr_b16 v[48:49], v27 offset:0
    ds_read_b64_tr_b16 v[50:51], v27 offset:1024
    v_mfma_f32_16x16x32_bf16 v[160:163], v[96:99], v[84:87], v[160:163]
    s_add_u32 s36, s44, 1408
    v_mul_f32 v14, s40, v14
    v_mul_f32 v15, s40, v15
    v_mfma_f32_16x16x32_bf16 v[192:195], v[96:99], v[88:91], v[192:195]
    s_add_u32 m0, s42, 32768
    ds_read_b128 v[32:35], v25 offset:0
    ds_read_b128 v[36:39], v25 offset:2048
    v_mfma_f32_16x16x32_bf16 v[224:227], v[96:99], v[92:95], v[224:227]
    buffer_load_dwordx4 v17, s[24:27], s36 offen offset:0 lds
    v_mfma_f32_16x16x32_bf16 v[132:135], v[100:103], v[80:83], v[132:135]
    ds_read_b128 v[40:43], v25 offset:4096
    ds_read_b128 v[44:47], v25 offset:6144
    v_mfma_f32_16x16x32_bf16 v[164:167], v[100:103], v[84:87], v[164:167]
    v_cvt_pk_bf16_f32 v8, v8, v9
    v_cvt_pk_bf16_f32 v9, v10, v11
    v_mfma_f32_16x16x32_bf16 v[196:199], v[100:103], v[88:91], v[196:199]
    ds_read_b64_tr_b16 v[52:53], v28 offset:0
    ds_read_b64_tr_b16 v[54:55], v28 offset:1024
    v_mfma_f32_16x16x32_bf16 v[228:231], v[100:103], v[92:95], v[228:231]
    buffer_load_dwordx4 v18, s[24:27], s36 offen offset:1024 lds
    v_mfma_f32_16x16x32_bf16 v[136:139], v[104:107], v[80:83], v[136:139]
    ds_read_b64_tr_b16 v[56:57], v29 offset:0
    ds_read_b64_tr_b16 v[58:59], v29 offset:1024
    v_mfma_f32_16x16x32_bf16 v[168:171], v[104:107], v[84:87], v[168:171]
    v_cvt_pk_bf16_f32 v10, v12, v13
    v_cvt_pk_bf16_f32 v11, v14, v15
    v_mfma_f32_16x16x32_bf16 v[200:203], v[104:107], v[88:91], v[200:203]
    ds_read_b64_tr_b16 v[60:61], v30 offset:0
    ds_read_b64_tr_b16 v[62:63], v30 offset:1024
    v_mfma_f32_16x16x32_bf16 v[232:235], v[104:107], v[92:95], v[232:235]
    buffer_store_dwordx4 v[8:11], v16, s[16:19], s41 offen offset:0
    v_mfma_f32_16x16x32_bf16 v[140:143], v[108:111], v[80:83], v[140:143]
    ds_read_b64_tr_b16 v[64:65], v27 offset:128
    ds_read_b64_tr_b16 v[66:67], v27 offset:1152
    v_mfma_f32_16x16x32_bf16 v[172:175], v[108:111], v[84:87], v[172:175]
    v_accvgpr_read_b32 v4, a252
    v_accvgpr_read_b32 v5, a253
    v_mfma_f32_16x16x32_bf16 v[204:207], v[108:111], v[88:91], v[204:207]
    ds_read_b64_tr_b16 v[68:69], v28 offset:128
    ds_read_b64_tr_b16 v[70:71], v28 offset:1152
    v_mfma_f32_16x16x32_bf16 v[236:239], v[108:111], v[92:95], v[236:239]
    buffer_load_dwordx4 v19, s[24:27], s36 offen offset:2048 lds
    v_mfma_f32_16x16x32_bf16 v[144:147], v[112:115], v[80:83], v[144:147]
    ds_read_b64_tr_b16 v[72:73], v29 offset:128
    ds_read_b64_tr_b16 v[74:75], v29 offset:1152
    v_mfma_f32_16x16x32_bf16 v[176:179], v[112:115], v[84:87], v[176:179]
    v_accvgpr_read_b32 v6, a254
    v_accvgpr_read_b32 v7, a255
    v_mfma_f32_16x16x32_bf16 v[208:211], v[112:115], v[88:91], v[208:211]
    ds_read_b64_tr_b16 v[76:77], v30 offset:128
    ds_read_b64_tr_b16 v[78:79], v30 offset:1152
    v_mfma_f32_16x16x32_bf16 v[240:243], v[112:115], v[92:95], v[240:243]
    v_accvgpr_read_b32 v0, a248
    v_accvgpr_read_b32 v1, a249
    v_mfma_f32_16x16x32_bf16 v[148:151], v[116:119], v[80:83], v[148:151]
    v_accvgpr_read_b32 v2, a250
    v_accvgpr_read_b32 v3, a251
    v_mfma_f32_16x16x32_bf16 v[180:183], v[116:119], v[84:87], v[180:183]
    buffer_load_dwordx4 v20, s[24:27], s36 offen offset:3072 lds
    v_mfma_f32_16x16x32_bf16 v[212:215], v[116:119], v[88:91], v[212:215]
    s_add_u32 s37, s49, 5767168
    v_cvt_pk_bf16_f32 v0, v0, v1
    v_cvt_pk_bf16_f32 v1, v2, v3
    v_mfma_f32_16x16x32_bf16 v[244:247], v[116:119], v[92:95], v[244:247]
    s_add_u32 m0, s50, 34816
    v_cvt_pk_bf16_f32 v2, v4, v5
    v_cvt_pk_bf16_f32 v3, v6, v7
    v_mfma_f32_16x16x32_bf16 v[152:155], v[120:123], v[80:83], v[152:155]
    buffer_load_dwordx4 v21, s[20:23], s37 offen offset:0 lds
    v_mfma_f32_16x16x32_bf16 v[184:187], v[120:123], v[84:87], v[184:187]
    v_accvgpr_read_b32 v12, a124
    v_accvgpr_read_b32 v13, a125
    v_mfma_f32_16x16x32_bf16 v[216:219], v[120:123], v[88:91], v[216:219]
gated_mix__ssm_conv_h3__compressed_kv_cla__prompt_kernel_pad6:
    s_cbranch_execz gated_mix__ssm_conv_h3__compressed_kv_cla__prompt_kernel_pad10
    v_accvgpr_read_b32 v14, a126
    v_accvgpr_read_b32 v15, a127
    v_mfma_f32_16x16x32_bf16 v[248:251], v[120:123], v[92:95], v[248:251]
    buffer_store_dwordx4 v[0:3], v16, s[16:19], s38 offen offset:3072
    v_mfma_f32_16x16x32_bf16 v[156:159], v[124:127], v[80:83], v[156:159]
    s_add_u32 s38, s38, 16384
    v_accvgpr_read_b32 v8, a92
    v_accvgpr_read_b32 v9, a93
    v_mfma_f32_16x16x32_bf16 v[188:191], v[124:127], v[84:87], v[188:191]
    v_accvgpr_read_b32 v10, a94
    v_accvgpr_read_b32 v11, a95
    v_mfma_f32_16x16x32_bf16 v[220:223], v[124:127], v[88:91], v[220:223]
    buffer_load_dwordx4 v22, s[20:23], s37 offen offset:1024 lds
    v_mfma_f32_16x16x32_bf16 v[252:255], v[124:127], v[92:95], v[252:255]
    s_waitcnt lgkmcnt(0)
    v_mul_f32 v8, s40, v8
    v_mul_f32 v9, s40, v9
    v_mfma_f32_16x16x32_bf16 v[128:131], v[48:51], v[32:35], v[128:131]
    ds_read_b64_tr_b16 v[96:97], v27 offset:8704
    ds_read_b64_tr_b16 v[98:99], v27 offset:9728
    v_mfma_f32_16x16x32_bf16 v[160:163], v[48:51], v[36:39], v[160:163]
    s_add_u32 s36, s45, 1408
    v_mul_f32 v10, s40, v10
    v_mul_f32 v11, s40, v11
    v_mfma_f32_16x16x32_bf16 v[192:195], v[48:51], v[40:43], v[192:195]
    s_add_u32 m0, s42, 36864
    ds_read_b128 v[80:83], v26 offset:0
    ds_read_b128 v[84:87], v26 offset:2048
    v_mfma_f32_16x16x32_bf16 v[224:227], v[48:51], v[44:47], v[224:227]
    buffer_load_dwordx4 v17, s[24:27], s36 offen offset:0 lds
    v_mfma_f32_16x16x32_bf16 v[132:135], v[52:55], v[32:35], v[132:135]
    ds_read_b128 v[88:91], v26 offset:4096
    ds_read_b128 v[92:95], v26 offset:6144
    v_mfma_f32_16x16x32_bf16 v[164:167], v[52:55], v[36:39], v[164:167]
    v_mul_f32 v12, s40, v12
    v_mul_f32 v13, s40, v13
    v_mfma_f32_16x16x32_bf16 v[196:199], v[52:55], v[40:43], v[196:199]
    ds_read_b64_tr_b16 v[100:101], v28 offset:8704
    ds_read_b64_tr_b16 v[102:103], v28 offset:9728
    v_mfma_f32_16x16x32_bf16 v[228:231], v[52:55], v[44:47], v[228:231]
    buffer_load_dwordx4 v18, s[24:27], s36 offen offset:1024 lds
    v_mfma_f32_16x16x32_bf16 v[136:139], v[56:59], v[32:35], v[136:139]
    ds_read_b64_tr_b16 v[104:105], v29 offset:8704
    ds_read_b64_tr_b16 v[106:107], v29 offset:9728
    v_mfma_f32_16x16x32_bf16 v[168:171], v[56:59], v[36:39], v[168:171]
    v_mul_f32 v14, s40, v14
    v_mul_f32 v15, s40, v15
    v_mfma_f32_16x16x32_bf16 v[200:203], v[56:59], v[40:43], v[200:203]
    ds_read_b64_tr_b16 v[108:109], v30 offset:8704
    ds_read_b64_tr_b16 v[110:111], v30 offset:9728
    v_mfma_f32_16x16x32_bf16 v[232:235], v[56:59], v[44:47], v[232:235]
    v_mfma_f32_16x16x32_bf16 v[140:143], v[60:63], v[32:35], v[140:143]
    ds_read_b64_tr_b16 v[112:113], v27 offset:8832
    ds_read_b64_tr_b16 v[114:115], v27 offset:9856
    v_mfma_f32_16x16x32_bf16 v[172:175], v[60:63], v[36:39], v[172:175]
    v_cvt_pk_bf16_f32 v8, v8, v9
    v_cvt_pk_bf16_f32 v9, v10, v11
    v_mfma_f32_16x16x32_bf16 v[204:207], v[60:63], v[40:43], v[204:207]
    ds_read_b64_tr_b16 v[116:117], v28 offset:8832
    ds_read_b64_tr_b16 v[118:119], v28 offset:9856
    v_mfma_f32_16x16x32_bf16 v[236:239], v[60:63], v[44:47], v[236:239]
    buffer_load_dwordx4 v19, s[24:27], s36 offen offset:2048 lds
    v_mfma_f32_16x16x32_bf16 v[144:147], v[64:67], v[32:35], v[144:147]
    ds_read_b64_tr_b16 v[120:121], v29 offset:8832
    ds_read_b64_tr_b16 v[122:123], v29 offset:9856
    v_mfma_f32_16x16x32_bf16 v[176:179], v[64:67], v[36:39], v[176:179]
    v_cvt_pk_bf16_f32 v10, v12, v13
    v_cvt_pk_bf16_f32 v11, v14, v15
    v_mfma_f32_16x16x32_bf16 v[208:211], v[64:67], v[40:43], v[208:211]
    ds_read_b64_tr_b16 v[124:125], v30 offset:8832
    ds_read_b64_tr_b16 v[126:127], v30 offset:9856
    v_mfma_f32_16x16x32_bf16 v[240:243], v[64:67], v[44:47], v[240:243]
    v_mfma_f32_16x16x32_bf16 v[148:151], v[68:71], v[32:35], v[148:151]
    v_mfma_f32_16x16x32_bf16 v[180:183], v[68:71], v[36:39], v[180:183]
    buffer_load_dwordx4 v20, s[24:27], s36 offen offset:3072 lds
    v_mfma_f32_16x16x32_bf16 v[212:215], v[68:71], v[40:43], v[212:215]
    s_add_u32 s37, s49, 6029312
    v_mfma_f32_16x16x32_bf16 v[244:247], v[68:71], v[44:47], v[244:247]
    s_add_u32 m0, s50, 43520
    v_mfma_f32_16x16x32_bf16 v[152:155], v[72:75], v[32:35], v[152:155]
    buffer_load_dwordx4 v21, s[20:23], s37 offen offset:0 lds
    v_mfma_f32_16x16x32_bf16 v[184:187], v[72:75], v[36:39], v[184:187]
    v_mfma_f32_16x16x32_bf16 v[216:219], v[72:75], v[40:43], v[216:219]
    v_mfma_f32_16x16x32_bf16 v[248:251], v[72:75], v[44:47], v[248:251]
    buffer_store_dwordx4 v[8:11], v16, s[16:19], s41 offen offset:1024
    v_mfma_f32_16x16x32_bf16 v[156:159], v[76:79], v[32:35], v[156:159]
    s_add_u32 s41, s41, 12288
    v_mfma_f32_16x16x32_bf16 v[188:191], v[76:79], v[36:39], v[188:191]
    v_mov_b32 v1, 1
    v_mov_b32 v0, 0
    v_mfma_f32_16x16x32_bf16 v[220:223], v[76:79], v[40:43], v[220:223]
    buffer_load_dwordx4 v22, s[20:23], s37 offen offset:1024 lds
    v_mfma_f32_16x16x32_bf16 v[252:255], v[76:79], v[44:47], v[252:255]
    s_waitcnt vmcnt(15) lgkmcnt(0)
    s_barrier
    v_bfe_u32 v3, v16, 1, 8
    v_mfma_f32_16x16x32_bf16 v[128:131], v[96:99], v[80:83], v[128:131]
    s_and_b32 s40, s3, 4294967264
    ds_read_b64_tr_b16 v[48:49], v27 offset:17408
    ds_read_b64_tr_b16 v[50:51], v27 offset:18432
    v_mfma_f32_16x16x32_bf16 v[160:163], v[96:99], v[84:87], v[160:163]
    s_add_u32 s36, s44, 1536
    v_mov_b32 v10, 0x0f0f0f0f
    v_mov_b32 v4, 0
    v_mfma_f32_16x16x32_bf16 v[192:195], v[96:99], v[88:91], v[192:195]
    s_add_u32 m0, s42, 65536
    ds_read_b128 v[32:35], v23 offset:0
    ds_read_b128 v[36:39], v23 offset:2048
    v_mfma_f32_16x16x32_bf16 v[224:227], v[96:99], v[92:95], v[224:227]
    buffer_load_dwordx4 v17, s[24:27], s36 offen offset:0 lds
    v_mfma_f32_16x16x32_bf16 v[132:135], v[100:103], v[80:83], v[132:135]
    ds_read_b128 v[40:43], v23 offset:4096
    ds_read_b128 v[44:47], v23 offset:6144
    v_mfma_f32_16x16x32_bf16 v[164:167], v[100:103], v[84:87], v[164:167]
    v_mov_b32 v5, 0
    v_mov_b32 v6, 0
    v_mfma_f32_16x16x32_bf16 v[196:199], v[100:103], v[88:91], v[196:199]
    ds_read_b64_tr_b16 v[52:53], v28 offset:17408
    ds_read_b64_tr_b16 v[54:55], v28 offset:18432
    v_mfma_f32_16x16x32_bf16 v[228:231], v[100:103], v[92:95], v[228:231]
    buffer_load_dwordx4 v18, s[24:27], s36 offen offset:1024 lds
    v_mfma_f32_16x16x32_bf16 v[136:139], v[104:107], v[80:83], v[136:139]
    ds_read_b64_tr_b16 v[56:57], v29 offset:17408
    ds_read_b64_tr_b16 v[58:59], v29 offset:18432
    v_mfma_f32_16x16x32_bf16 v[168:171], v[104:107], v[84:87], v[168:171]
    v_mov_b32 v7, 0
    v_mov_b32 v8, 153600
    v_mfma_f32_16x16x32_bf16 v[200:203], v[104:107], v[88:91], v[200:203]
    ds_read_b64_tr_b16 v[60:61], v30 offset:17408
    ds_read_b64_tr_b16 v[62:63], v30 offset:18432
    v_mfma_f32_16x16x32_bf16 v[232:235], v[104:107], v[92:95], v[232:235]
    buffer_load_dword v9, v3, s[76:79], 0 offen sc1
    v_mfma_f32_16x16x32_bf16 v[140:143], v[108:111], v[80:83], v[140:143]
    ds_read_b64_tr_b16 v[64:65], v27 offset:17536
    ds_read_b64_tr_b16 v[66:67], v27 offset:18560
    v_mfma_f32_16x16x32_bf16 v[172:175], v[108:111], v[84:87], v[172:175]
    ds_write_b128 v8, v[4:7]
    ds_read_b128 a[0:3], v8
    v_mfma_f32_16x16x32_bf16 v[204:207], v[108:111], v[88:91], v[204:207]
    ds_read_b64_tr_b16 v[68:69], v28 offset:17536
    ds_read_b64_tr_b16 v[70:71], v28 offset:18560
    v_mfma_f32_16x16x32_bf16 v[236:239], v[108:111], v[92:95], v[236:239]
    buffer_load_dwordx4 v19, s[24:27], s36 offen offset:2048 lds
    v_mfma_f32_16x16x32_bf16 v[144:147], v[112:115], v[80:83], v[144:147]
    ds_read_b64_tr_b16 v[72:73], v29 offset:17536
    ds_read_b64_tr_b16 v[74:75], v29 offset:18560
    v_mfma_f32_16x16x32_bf16 v[176:179], v[112:115], v[84:87], v[176:179]
    ds_read_b128 a[4:7], v8
    ds_read_b128 a[8:11], v8
    v_mfma_f32_16x16x32_bf16 v[208:211], v[112:115], v[88:91], v[208:211]
    ds_read_b64_tr_b16 v[76:77], v30 offset:17536
    ds_read_b64_tr_b16 v[78:79], v30 offset:18560
    v_mfma_f32_16x16x32_bf16 v[240:243], v[112:115], v[92:95], v[240:243]
    ds_read_b128 a[12:15], v8
    ds_read_b128 a[16:19], v8
    v_mfma_f32_16x16x32_bf16 v[148:151], v[116:119], v[80:83], v[148:151]
    ds_read_b128 a[20:23], v8
    ds_read_b128 a[24:27], v8
    v_mfma_f32_16x16x32_bf16 v[180:183], v[116:119], v[84:87], v[180:183]
    buffer_load_dwordx4 v20, s[24:27], s36 offen offset:3072 lds
    v_mfma_f32_16x16x32_bf16 v[212:215], v[116:119], v[88:91], v[212:215]
    s_add_u32 s37, s49, 6291456
    ds_read_b128 a[28:31], v8
    ds_read_b128 a[32:35], v8
    v_mfma_f32_16x16x32_bf16 v[244:247], v[116:119], v[92:95], v[244:247]
    s_add_u32 m0, s50, 0
    ds_read_b128 a[36:39], v8
    ds_read_b128 a[40:43], v8
    v_mfma_f32_16x16x32_bf16 v[152:155], v[120:123], v[80:83], v[152:155]
    buffer_load_dwordx4 v21, s[20:23], s37 offen offset:0 lds
    v_mfma_f32_16x16x32_bf16 v[184:187], v[120:123], v[84:87], v[184:187]
    ds_read_b128 a[44:47], v8
    ds_read_b128 a[48:51], v8
    v_mfma_f32_16x16x32_bf16 v[216:219], v[120:123], v[88:91], v[216:219]
    ds_read_b128 a[52:55], v8
    ds_read_b128 a[56:59], v8
    v_mfma_f32_16x16x32_bf16 v[248:251], v[120:123], v[92:95], v[248:251]
    v_mfma_f32_16x16x32_bf16 v[156:159], v[124:127], v[80:83], v[156:159]
    v_mfma_f32_16x16x32_bf16 v[188:191], v[124:127], v[84:87], v[188:191]
    v_mfma_f32_16x16x32_bf16 v[220:223], v[124:127], v[88:91], v[220:223]
    buffer_load_dwordx4 v22, s[20:23], s37 offen offset:1024 lds
    v_mfma_f32_16x16x32_bf16 v[252:255], v[124:127], v[92:95], v[252:255]
    s_waitcnt lgkmcnt(0)
    v_mfma_f32_16x16x32_bf16 v[128:131], v[48:51], v[32:35], v[128:131]
    s_getreg_b32 s58, hwreg(HW_REG_XCC_ID, 0, 3)
    ds_read_b64_tr_b16 v[96:97], v27 offset:26112
    ds_read_b64_tr_b16 v[98:99], v27 offset:27136
    v_mfma_f32_16x16x32_bf16 v[160:163], v[48:51], v[36:39], v[160:163]
    s_add_u32 s36, s45, 1536
    ds_read_b128 a[60:63], v8
    ds_read_b128 a[64:67], v8
    v_mfma_f32_16x16x32_bf16 v[192:195], v[48:51], v[40:43], v[192:195]
    s_add_u32 m0, s42, 69632
    ds_read_b128 v[80:83], v24 offset:0
    ds_read_b128 v[84:87], v24 offset:2048
    v_mfma_f32_16x16x32_bf16 v[224:227], v[48:51], v[44:47], v[224:227]
    buffer_load_dwordx4 v17, s[24:27], s36 offen offset:0 lds
    v_mfma_f32_16x16x32_bf16 v[132:135], v[52:55], v[32:35], v[132:135]
    s_lshl_b32 s58, s58, 2
    ds_read_b128 v[88:91], v24 offset:4096
    ds_read_b128 v[92:95], v24 offset:6144
    v_mfma_f32_16x16x32_bf16 v[164:167], v[52:55], v[36:39], v[164:167]
    s_lshl_b32 s58, 8, s58
    ds_read_b128 a[68:71], v8
    ds_read_b128 a[72:75], v8
    v_mfma_f32_16x16x32_bf16 v[196:199], v[52:55], v[40:43], v[196:199]
    ds_read_b64_tr_b16 v[100:101], v28 offset:26112
    ds_read_b64_tr_b16 v[102:103], v28 offset:27136
    v_mfma_f32_16x16x32_bf16 v[228:231], v[52:55], v[44:47], v[228:231]
    buffer_load_dwordx4 v18, s[24:27], s36 offen offset:1024 lds
    v_mfma_f32_16x16x32_bf16 v[136:139], v[56:59], v[32:35], v[136:139]
    ds_read_b64_tr_b16 v[104:105], v29 offset:26112
    ds_read_b64_tr_b16 v[106:107], v29 offset:27136
    v_mfma_f32_16x16x32_bf16 v[168:171], v[56:59], v[36:39], v[168:171]
    ds_read_b128 a[76:79], v8
    ds_read_b128 a[80:83], v8
    v_mfma_f32_16x16x32_bf16 v[200:203], v[56:59], v[40:43], v[200:203]
    ds_read_b64_tr_b16 v[108:109], v30 offset:26112
    ds_read_b64_tr_b16 v[110:111], v30 offset:27136
    v_mfma_f32_16x16x32_bf16 v[232:235], v[56:59], v[44:47], v[232:235]
    v_mfma_f32_16x16x32_bf16 v[140:143], v[60:63], v[32:35], v[140:143]
    ds_read_b64_tr_b16 v[112:113], v27 offset:26240
    ds_read_b64_tr_b16 v[114:115], v27 offset:27264
    v_mfma_f32_16x16x32_bf16 v[172:175], v[60:63], v[36:39], v[172:175]
    ds_read_b128 a[84:87], v8
    ds_read_b128 a[88:91], v8
    v_mfma_f32_16x16x32_bf16 v[204:207], v[60:63], v[40:43], v[204:207]
    ds_read_b64_tr_b16 v[116:117], v28 offset:26240
    ds_read_b64_tr_b16 v[118:119], v28 offset:27264
    v_mfma_f32_16x16x32_bf16 v[236:239], v[60:63], v[44:47], v[236:239]
    buffer_load_dwordx4 v19, s[24:27], s36 offen offset:2048 lds
    v_mfma_f32_16x16x32_bf16 v[144:147], v[64:67], v[32:35], v[144:147]
    ds_read_b64_tr_b16 v[120:121], v29 offset:26240
    ds_read_b64_tr_b16 v[122:123], v29 offset:27264
    v_mfma_f32_16x16x32_bf16 v[176:179], v[64:67], v[36:39], v[176:179]
    ds_read_b128 a[92:95], v8
    ds_read_b128 a[96:99], v8
    v_mfma_f32_16x16x32_bf16 v[208:211], v[64:67], v[40:43], v[208:211]
    ds_read_b64_tr_b16 v[124:125], v30 offset:26240
    ds_read_b64_tr_b16 v[126:127], v30 offset:27264
    v_mfma_f32_16x16x32_bf16 v[240:243], v[64:67], v[44:47], v[240:243]
    ds_read_b128 a[100:103], v8
    ds_read_b128 a[104:107], v8
    v_mfma_f32_16x16x32_bf16 v[148:151], v[68:71], v[32:35], v[148:151]
    ds_read_b128 a[108:111], v8
    ds_read_b128 a[112:115], v8
    v_mfma_f32_16x16x32_bf16 v[180:183], v[68:71], v[36:39], v[180:183]
    buffer_load_dwordx4 v20, s[24:27], s36 offen offset:3072 lds
    v_mfma_f32_16x16x32_bf16 v[212:215], v[68:71], v[40:43], v[212:215]
    s_add_u32 s37, s49, 6553600
    ds_read_b128 a[116:119], v8
    ds_read_b128 a[120:123], v8
    v_mfma_f32_16x16x32_bf16 v[244:247], v[68:71], v[44:47], v[244:247]
    s_add_u32 m0, s50, 8704
    ds_read_b128 a[124:127], v8
    v_mfma_f32_16x16x32_bf16 v[152:155], v[72:75], v[32:35], v[152:155]
    buffer_load_dwordx4 v21, s[20:23], s37 offen offset:0 lds
    v_mfma_f32_16x16x32_bf16 v[184:187], v[72:75], v[36:39], v[184:187]
    v_mfma_f32_16x16x32_bf16 v[216:219], v[72:75], v[40:43], v[216:219]
    v_mfma_f32_16x16x32_bf16 v[248:251], v[72:75], v[44:47], v[248:251]
    v_mfma_f32_16x16x32_bf16 v[156:159], v[76:79], v[32:35], v[156:159]
    v_mfma_f32_16x16x32_bf16 v[188:191], v[76:79], v[36:39], v[188:191]
    v_mfma_f32_16x16x32_bf16 v[220:223], v[76:79], v[40:43], v[220:223]
    buffer_load_dwordx4 v22, s[20:23], s37 offen offset:1024 lds
    v_mfma_f32_16x16x32_bf16 v[252:255], v[76:79], v[44:47], v[252:255]
    s_waitcnt vmcnt(10) lgkmcnt(0)
    s_barrier
    v_readlane_b32 s54, v9, s33
    v_and_b32 v11, v10, v9
    v_mfma_f32_16x16x32_bf16 v[128:131], v[96:99], v[80:83], v[128:131]
    ds_read_b64_tr_b16 v[48:49], v27 offset:34816
    ds_read_b64_tr_b16 v[50:51], v27 offset:35840
    v_mfma_f32_16x16x32_bf16 v[160:163], v[96:99], v[84:87], v[160:163]
    s_add_u32 s36, s44, 1664
    v_lshrrev_b32 v12, 4, v9
    v_and_b32 v12, v10, v12
    v_mfma_f32_16x16x32_bf16 v[192:195], v[96:99], v[88:91], v[192:195]
    s_add_u32 m0, s42, 0
    ds_read_b128 v[32:35], v23 offset:32768
    ds_read_b128 v[36:39], v23 offset:34816
    v_mfma_f32_16x16x32_bf16 v[224:227], v[96:99], v[92:95], v[224:227]
    buffer_load_dwordx4 v17, s[24:27], s36 offen offset:0 lds
    v_mfma_f32_16x16x32_bf16 v[132:135], v[100:103], v[80:83], v[132:135]
    ds_read_b128 v[40:43], v23 offset:36864
    ds_read_b128 v[44:47], v23 offset:38912
    v_mfma_f32_16x16x32_bf16 v[164:167], v[100:103], v[84:87], v[164:167]
    v_sad_u8 v11, v11, 0, 0
    v_sad_u8 v11, v12, 0, v11
    v_mfma_f32_16x16x32_bf16 v[196:199], v[100:103], v[88:91], v[196:199]
    ds_read_b64_tr_b16 v[52:53], v28 offset:34816
    ds_read_b64_tr_b16 v[54:55], v28 offset:35840
    v_mfma_f32_16x16x32_bf16 v[228:231], v[100:103], v[92:95], v[228:231]
    buffer_load_dwordx4 v18, s[24:27], s36 offen offset:1024 lds
    v_mfma_f32_16x16x32_bf16 v[136:139], v[104:107], v[80:83], v[136:139]
    ds_read_b64_tr_b16 v[56:57], v29 offset:34816
    ds_read_b64_tr_b16 v[58:59], v29 offset:35840
    v_mfma_f32_16x16x32_bf16 v[168:171], v[104:107], v[84:87], v[168:171]
    v_cmp_ne_u32 vcc, 8, v11
    v_bfe_u32 v3, v16, 2, 5
    v_mfma_f32_16x16x32_bf16 v[200:203], v[104:107], v[88:91], v[200:203]
    ds_read_b64_tr_b16 v[60:61], v30 offset:34816
    ds_read_b64_tr_b16 v[62:63], v30 offset:35840
    v_mfma_f32_16x16x32_bf16 v[232:235], v[104:107], v[92:95], v[232:235]
    v_mfma_f32_16x16x32_bf16 v[140:143], v[108:111], v[80:83], v[140:143]
    s_cbranch_vccnz gated_mix__ssm_conv_h3__compressed_kv_cla__prompt_kernel_wb
    ds_read_b64_tr_b16 v[64:65], v27 offset:34944
    ds_read_b64_tr_b16 v[66:67], v27 offset:35968
    v_mfma_f32_16x16x32_bf16 v[172:175], v[108:111], v[84:87], v[172:175]
    s_cmp_lg_u32 s54, s58
    s_cbranch_scc1 gated_mix__ssm_conv_h3__compressed_kv_cla__prompt_kernel_wb
gated_mix__ssm_conv_h3__compressed_kv_cla__prompt_kernel_wb_ret:
    v_mfma_f32_16x16x32_bf16 v[204:207], v[108:111], v[88:91], v[204:207]
    ds_read_b64_tr_b16 v[68:69], v28 offset:34944
    ds_read_b64_tr_b16 v[70:71], v28 offset:35968
    v_mfma_f32_16x16x32_bf16 v[236:239], v[108:111], v[92:95], v[236:239]
    buffer_load_dwordx4 v19, s[24:27], s36 offen offset:2048 lds
    v_mfma_f32_16x16x32_bf16 v[144:147], v[112:115], v[80:83], v[144:147]
    ds_read_b64_tr_b16 v[72:73], v29 offset:34944
    ds_read_b64_tr_b16 v[74:75], v29 offset:35968
    v_mfma_f32_16x16x32_bf16 v[176:179], v[112:115], v[84:87], v[176:179]
    v_mfma_f32_16x16x32_bf16 v[208:211], v[112:115], v[88:91], v[208:211]
    ds_read_b64_tr_b16 v[76:77], v30 offset:34944
    ds_read_b64_tr_b16 v[78:79], v30 offset:35968
    v_mfma_f32_16x16x32_bf16 v[240:243], v[112:115], v[92:95], v[240:243]
    v_mfma_f32_16x16x32_bf16 v[148:151], v[116:119], v[80:83], v[148:151]
    v_mfma_f32_16x16x32_bf16 v[180:183], v[116:119], v[84:87], v[180:183]
    buffer_load_dwordx4 v20, s[24:27], s36 offen offset:3072 lds
    v_mfma_f32_16x16x32_bf16 v[212:215], v[116:119], v[88:91], v[212:215]
    s_add_u32 s37, s49, 6815744
    v_mfma_f32_16x16x32_bf16 v[244:247], v[116:119], v[92:95], v[244:247]
    s_add_u32 m0, s50, 17408
    v_mfma_f32_16x16x32_bf16 v[152:155], v[120:123], v[80:83], v[152:155]
    buffer_load_dwordx4 v21, s[20:23], s37 offen offset:0 lds
    v_mfma_f32_16x16x32_bf16 v[184:187], v[120:123], v[84:87], v[184:187]
    v_mfma_f32_16x16x32_bf16 v[216:219], v[120:123], v[88:91], v[216:219]
    v_mfma_f32_16x16x32_bf16 v[248:251], v[120:123], v[92:95], v[248:251]
    buffer_store_dword v1, v0, s[28:31], s3 offen sc1
    v_mfma_f32_16x16x32_bf16 v[156:159], v[124:127], v[80:83], v[156:159]
    v_mfma_f32_16x16x32_bf16 v[188:191], v[124:127], v[84:87], v[188:191]
    v_mfma_f32_16x16x32_bf16 v[220:223], v[124:127], v[88:91], v[220:223]
    buffer_load_dwordx4 v22, s[20:23], s37 offen offset:1024 lds
    v_mfma_f32_16x16x32_bf16 v[252:255], v[124:127], v[92:95], v[252:255]
    s_waitcnt lgkmcnt(0)
    v_mfma_f32_16x16x32_bf16 v[128:131], v[48:51], v[32:35], v[128:131]
    ds_read_b64_tr_b16 v[96:97], v27 offset:43520
    ds_read_b64_tr_b16 v[98:99], v27 offset:44544
    v_mfma_f32_16x16x32_bf16 v[160:163], v[48:51], v[36:39], v[160:163]
    s_add_u32 s36, s45, 1664
    v_mfma_f32_16x16x32_bf16 v[192:195], v[48:51], v[40:43], v[192:195]
    s_add_u32 m0, s42, 4096
    ds_read_b128 v[80:83], v24 offset:32768
    ds_read_b128 v[84:87], v24 offset:34816
    v_mfma_f32_16x16x32_bf16 v[224:227], v[48:51], v[44:47], v[224:227]
    buffer_load_dwordx4 v17, s[24:27], s36 offen offset:0 lds
    v_mfma_f32_16x16x32_bf16 v[132:135], v[52:55], v[32:35], v[132:135]
    ds_read_b128 v[88:91], v24 offset:36864
    ds_read_b128 v[92:95], v24 offset:38912
    v_mfma_f32_16x16x32_bf16 v[164:167], v[52:55], v[36:39], v[164:167]
    v_mfma_f32_16x16x32_bf16 v[196:199], v[52:55], v[40:43], v[196:199]
    ds_read_b64_tr_b16 v[100:101], v28 offset:43520
    ds_read_b64_tr_b16 v[102:103], v28 offset:44544
    v_mfma_f32_16x16x32_bf16 v[228:231], v[52:55], v[44:47], v[228:231]
    buffer_load_dwordx4 v18, s[24:27], s36 offen offset:1024 lds
    v_mfma_f32_16x16x32_bf16 v[136:139], v[56:59], v[32:35], v[136:139]
    ds_read_b64_tr_b16 v[104:105], v29 offset:43520
    ds_read_b64_tr_b16 v[106:107], v29 offset:44544
    v_mfma_f32_16x16x32_bf16 v[168:171], v[56:59], v[36:39], v[168:171]
    v_mfma_f32_16x16x32_bf16 v[200:203], v[56:59], v[40:43], v[200:203]
    ds_read_b64_tr_b16 v[108:109], v30 offset:43520
    ds_read_b64_tr_b16 v[110:111], v30 offset:44544
    v_mfma_f32_16x16x32_bf16 v[232:235], v[56:59], v[44:47], v[232:235]
    v_mfma_f32_16x16x32_bf16 v[140:143], v[60:63], v[32:35], v[140:143]
    ds_read_b64_tr_b16 v[112:113], v27 offset:43648
    ds_read_b64_tr_b16 v[114:115], v27 offset:44672
    v_mfma_f32_16x16x32_bf16 v[172:175], v[60:63], v[36:39], v[172:175]
    v_mfma_f32_16x16x32_bf16 v[204:207], v[60:63], v[40:43], v[204:207]
    ds_read_b64_tr_b16 v[116:117], v28 offset:43648
    ds_read_b64_tr_b16 v[118:119], v28 offset:44672
    v_mfma_f32_16x16x32_bf16 v[236:239], v[60:63], v[44:47], v[236:239]
    buffer_load_dwordx4 v19, s[24:27], s36 offen offset:2048 lds
    v_mfma_f32_16x16x32_bf16 v[144:147], v[64:67], v[32:35], v[144:147]
    ds_read_b64_tr_b16 v[120:121], v29 offset:43648
    ds_read_b64_tr_b16 v[122:123], v29 offset:44672
    v_mfma_f32_16x16x32_bf16 v[176:179], v[64:67], v[36:39], v[176:179]
    v_mfma_f32_16x16x32_bf16 v[208:211], v[64:67], v[40:43], v[208:211]
    ds_read_b64_tr_b16 v[124:125], v30 offset:43648
    ds_read_b64_tr_b16 v[126:127], v30 offset:44672
    v_mfma_f32_16x16x32_bf16 v[240:243], v[64:67], v[44:47], v[240:243]
    v_mfma_f32_16x16x32_bf16 v[148:151], v[68:71], v[32:35], v[148:151]
    v_mfma_f32_16x16x32_bf16 v[180:183], v[68:71], v[36:39], v[180:183]
    buffer_load_dwordx4 v20, s[24:27], s36 offen offset:3072 lds
    v_mfma_f32_16x16x32_bf16 v[212:215], v[68:71], v[40:43], v[212:215]
    s_add_u32 s37, s49, 7077888
    v_mfma_f32_16x16x32_bf16 v[244:247], v[68:71], v[44:47], v[244:247]
    s_add_u32 m0, s50, 26112
    v_mfma_f32_16x16x32_bf16 v[152:155], v[72:75], v[32:35], v[152:155]
    buffer_load_dwordx4 v21, s[20:23], s37 offen offset:0 lds
    v_mfma_f32_16x16x32_bf16 v[184:187], v[72:75], v[36:39], v[184:187]
    v_mfma_f32_16x16x32_bf16 v[216:219], v[72:75], v[40:43], v[216:219]
    v_mfma_f32_16x16x32_bf16 v[248:251], v[72:75], v[44:47], v[248:251]
    v_mfma_f32_16x16x32_bf16 v[156:159], v[76:79], v[32:35], v[156:159]
    v_mfma_f32_16x16x32_bf16 v[188:191], v[76:79], v[36:39], v[188:191]
    v_mfma_f32_16x16x32_bf16 v[220:223], v[76:79], v[40:43], v[220:223]
    buffer_load_dwordx4 v22, s[20:23], s37 offen offset:1024 lds
    v_mfma_f32_16x16x32_bf16 v[252:255], v[76:79], v[44:47], v[252:255]
    s_waitcnt vmcnt(13) lgkmcnt(0)
    s_barrier
    v_mfma_f32_16x16x32_bf16 v[128:131], v[96:99], v[80:83], v[128:131]
    ds_read_b64_tr_b16 v[48:49], v27 offset:0
    ds_read_b64_tr_b16 v[50:51], v27 offset:1024
    v_mfma_f32_16x16x32_bf16 v[160:163], v[96:99], v[84:87], v[160:163]
    s_add_u32 s36, s44, 1792
    v_mfma_f32_16x16x32_bf16 v[192:195], v[96:99], v[88:91], v[192:195]
    s_add_u32 m0, s42, 32768
    ds_read_b128 v[32:35], v25 offset:0
    ds_read_b128 v[36:39], v25 offset:2048
    v_mfma_f32_16x16x32_bf16 v[224:227], v[96:99], v[92:95], v[224:227]
    buffer_load_dwordx4 v17, s[24:27], s36 offen offset:0 lds
    v_mfma_f32_16x16x32_bf16 v[132:135], v[100:103], v[80:83], v[132:135]
    ds_read_b128 v[40:43], v25 offset:4096
    ds_read_b128 v[44:47], v25 offset:6144
    v_mfma_f32_16x16x32_bf16 v[164:167], v[100:103], v[84:87], v[164:167]
    v_mfma_f32_16x16x32_bf16 v[196:199], v[100:103], v[88:91], v[196:199]
    ds_read_b64_tr_b16 v[52:53], v28 offset:0
    ds_read_b64_tr_b16 v[54:55], v28 offset:1024
    v_mfma_f32_16x16x32_bf16 v[228:231], v[100:103], v[92:95], v[228:231]
    buffer_load_dwordx4 v18, s[24:27], s36 offen offset:1024 lds
    v_mfma_f32_16x16x32_bf16 v[136:139], v[104:107], v[80:83], v[136:139]
    ds_read_b64_tr_b16 v[56:57], v29 offset:0
    ds_read_b64_tr_b16 v[58:59], v29 offset:1024
    v_mfma_f32_16x16x32_bf16 v[168:171], v[104:107], v[84:87], v[168:171]
    v_mfma_f32_16x16x32_bf16 v[200:203], v[104:107], v[88:91], v[200:203]
    ds_read_b64_tr_b16 v[60:61], v30 offset:0
    ds_read_b64_tr_b16 v[62:63], v30 offset:1024
    v_mfma_f32_16x16x32_bf16 v[232:235], v[104:107], v[92:95], v[232:235]
    v_mfma_f32_16x16x32_bf16 v[140:143], v[108:111], v[80:83], v[140:143]
    ds_read_b64_tr_b16 v[64:65], v27 offset:128
    ds_read_b64_tr_b16 v[66:67], v27 offset:1152
    v_mfma_f32_16x16x32_bf16 v[172:175], v[108:111], v[84:87], v[172:175]
    v_mfma_f32_16x16x32_bf16 v[204:207], v[108:111], v[88:91], v[204:207]
    ds_read_b64_tr_b16 v[68:69], v28 offset:128
    ds_read_b64_tr_b16 v[70:71], v28 offset:1152
    v_mfma_f32_16x16x32_bf16 v[236:239], v[108:111], v[92:95], v[236:239]
    buffer_load_dwordx4 v19, s[24:27], s36 offen offset:2048 lds
    v_mfma_f32_16x16x32_bf16 v[144:147], v[112:115], v[80:83], v[144:147]
    ds_read_b64_tr_b16 v[72:73], v29 offset:128
    ds_read_b64_tr_b16 v[74:75], v29 offset:1152
    v_mfma_f32_16x16x32_bf16 v[176:179], v[112:115], v[84:87], v[176:179]
    v_mfma_f32_16x16x32_bf16 v[208:211], v[112:115], v[88:91], v[208:211]
    ds_read_b64_tr_b16 v[76:77], v30 offset:128
    ds_read_b64_tr_b16 v[78:79], v30 offset:1152
    v_mfma_f32_16x16x32_bf16 v[240:243], v[112:115], v[92:95], v[240:243]
    v_mfma_f32_16x16x32_bf16 v[148:151], v[116:119], v[80:83], v[148:151]
    v_mfma_f32_16x16x32_bf16 v[180:183], v[116:119], v[84:87], v[180:183]
    buffer_load_dwordx4 v20, s[24:27], s36 offen offset:3072 lds
    v_mfma_f32_16x16x32_bf16 v[212:215], v[116:119], v[88:91], v[212:215]
    s_add_u32 s37, s49, 7340032
    v_mfma_f32_16x16x32_bf16 v[244:247], v[116:119], v[92:95], v[244:247]
    s_add_u32 m0, s50, 34816
    v_mfma_f32_16x16x32_bf16 v[152:155], v[120:123], v[80:83], v[152:155]
    buffer_load_dwordx4 v21, s[20:23], s37 offen offset:0 lds
    v_mfma_f32_16x16x32_bf16 v[184:187], v[120:123], v[84:87], v[184:187]
    v_mfma_f32_16x16x32_bf16 v[216:219], v[120:123], v[88:91], v[216:219]
    v_mfma_f32_16x16x32_bf16 v[248:251], v[120:123], v[92:95], v[248:251]
    v_mfma_f32_16x16x32_bf16 v[156:159], v[124:127], v[80:83], v[156:159]
    v_mfma_f32_16x16x32_bf16 v[188:191], v[124:127], v[84:87], v[188:191]
    v_mfma_f32_16x16x32_bf16 v[220:223], v[124:127], v[88:91], v[220:223]
    buffer_load_dwordx4 v22, s[20:23], s37 offen offset:1024 lds
    v_mfma_f32_16x16x32_bf16 v[252:255], v[124:127], v[92:95], v[252:255]
    s_waitcnt lgkmcnt(0)
    v_mfma_f32_16x16x32_bf16 v[128:131], v[48:51], v[32:35], v[128:131]
    ds_read_b64_tr_b16 v[96:97], v27 offset:8704
    ds_read_b64_tr_b16 v[98:99], v27 offset:9728
    v_mfma_f32_16x16x32_bf16 v[160:163], v[48:51], v[36:39], v[160:163]
    s_add_u32 s36, s45, 1792
    v_mfma_f32_16x16x32_bf16 v[192:195], v[48:51], v[40:43], v[192:195]
    s_add_u32 m0, s42, 36864
    ds_read_b128 v[80:83], v26 offset:0
    ds_read_b128 v[84:87], v26 offset:2048
    v_mfma_f32_16x16x32_bf16 v[224:227], v[48:51], v[44:47], v[224:227]
    buffer_load_dwordx4 v17, s[24:27], s36 offen offset:0 lds
    v_mfma_f32_16x16x32_bf16 v[132:135], v[52:55], v[32:35], v[132:135]
    ds_read_b128 v[88:91], v26 offset:4096
    ds_read_b128 v[92:95], v26 offset:6144
    v_mfma_f32_16x16x32_bf16 v[164:167], v[52:55], v[36:39], v[164:167]
    v_mfma_f32_16x16x32_bf16 v[196:199], v[52:55], v[40:43], v[196:199]
    ds_read_b64_tr_b16 v[100:101], v28 offset:8704
    ds_read_b64_tr_b16 v[102:103], v28 offset:9728
    v_mfma_f32_16x16x32_bf16 v[228:231], v[52:55], v[44:47], v[228:231]
    buffer_load_dwordx4 v18, s[24:27], s36 offen offset:1024 lds
    v_mfma_f32_16x16x32_bf16 v[136:139], v[56:59], v[32:35], v[136:139]
    ds_read_b64_tr_b16 v[104:105], v29 offset:8704
    ds_read_b64_tr_b16 v[106:107], v29 offset:9728
    v_mfma_f32_16x16x32_bf16 v[168:171], v[56:59], v[36:39], v[168:171]
    v_mfma_f32_16x16x32_bf16 v[200:203], v[56:59], v[40:43], v[200:203]
    ds_read_b64_tr_b16 v[108:109], v30 offset:8704
    ds_read_b64_tr_b16 v[110:111], v30 offset:9728
    v_mfma_f32_16x16x32_bf16 v[232:235], v[56:59], v[44:47], v[232:235]
    v_mfma_f32_16x16x32_bf16 v[140:143], v[60:63], v[32:35], v[140:143]
    ds_read_b64_tr_b16 v[112:113], v27 offset:8832
    ds_read_b64_tr_b16 v[114:115], v27 offset:9856
    v_mfma_f32_16x16x32_bf16 v[172:175], v[60:63], v[36:39], v[172:175]
    v_mfma_f32_16x16x32_bf16 v[204:207], v[60:63], v[40:43], v[204:207]
    ds_read_b64_tr_b16 v[116:117], v28 offset:8832
    ds_read_b64_tr_b16 v[118:119], v28 offset:9856
    v_mfma_f32_16x16x32_bf16 v[236:239], v[60:63], v[44:47], v[236:239]
    buffer_load_dwordx4 v19, s[24:27], s36 offen offset:2048 lds
    v_mfma_f32_16x16x32_bf16 v[144:147], v[64:67], v[32:35], v[144:147]
    ds_read_b64_tr_b16 v[120:121], v29 offset:8832
    ds_read_b64_tr_b16 v[122:123], v29 offset:9856
    v_mfma_f32_16x16x32_bf16 v[176:179], v[64:67], v[36:39], v[176:179]
    v_mfma_f32_16x16x32_bf16 v[208:211], v[64:67], v[40:43], v[208:211]
    ds_read_b64_tr_b16 v[124:125], v30 offset:8832
    ds_read_b64_tr_b16 v[126:127], v30 offset:9856
    v_mfma_f32_16x16x32_bf16 v[240:243], v[64:67], v[44:47], v[240:243]
    v_mfma_f32_16x16x32_bf16 v[148:151], v[68:71], v[32:35], v[148:151]
    v_mfma_f32_16x16x32_bf16 v[180:183], v[68:71], v[36:39], v[180:183]
    buffer_load_dwordx4 v20, s[24:27], s36 offen offset:3072 lds
    v_mfma_f32_16x16x32_bf16 v[212:215], v[68:71], v[40:43], v[212:215]
    s_add_u32 s37, s49, 7602176
    v_mfma_f32_16x16x32_bf16 v[244:247], v[68:71], v[44:47], v[244:247]
    s_add_u32 m0, s50, 43520
    v_mfma_f32_16x16x32_bf16 v[152:155], v[72:75], v[32:35], v[152:155]
    buffer_load_dwordx4 v21, s[20:23], s37 offen offset:0 lds
    v_mfma_f32_16x16x32_bf16 v[184:187], v[72:75], v[36:39], v[184:187]
    v_mfma_f32_16x16x32_bf16 v[216:219], v[72:75], v[40:43], v[216:219]
    v_mfma_f32_16x16x32_bf16 v[248:251], v[72:75], v[44:47], v[248:251]
    v_mfma_f32_16x16x32_bf16 v[156:159], v[76:79], v[32:35], v[156:159]
gated_mix__ssm_conv_h3__compressed_kv_cla__prompt_kernel_pad7:
    s_cbranch_execz gated_mix__ssm_conv_h3__compressed_kv_cla__prompt_kernel_pad11
    v_mfma_f32_16x16x32_bf16 v[188:191], v[76:79], v[36:39], v[188:191]
    v_mfma_f32_16x16x32_bf16 v[220:223], v[76:79], v[40:43], v[220:223]
    buffer_load_dwordx4 v22, s[20:23], s37 offen offset:1024 lds
    v_mfma_f32_16x16x32_bf16 v[252:255], v[76:79], v[44:47], v[252:255]
    s_waitcnt vmcnt(12) lgkmcnt(0)
    s_barrier
    v_mfma_f32_16x16x32_bf16 v[128:131], v[96:99], v[80:83], v[128:131]
    ds_read_b64_tr_b16 v[48:49], v27 offset:17408
    ds_read_b64_tr_b16 v[50:51], v27 offset:18432
    v_mfma_f32_16x16x32_bf16 v[160:163], v[96:99], v[84:87], v[160:163]
    s_add_u32 s36, s44, 1920
    v_mfma_f32_16x16x32_bf16 v[192:195], v[96:99], v[88:91], v[192:195]
    s_add_u32 m0, s42, 65536
    ds_read_b128 v[32:35], v23 offset:0
    ds_read_b128 v[36:39], v23 offset:2048
    v_mfma_f32_16x16x32_bf16 v[224:227], v[96:99], v[92:95], v[224:227]
    buffer_load_dwordx4 v17, s[24:27], s36 offen offset:0 lds
    v_mfma_f32_16x16x32_bf16 v[132:135], v[100:103], v[80:83], v[132:135]
    ds_read_b128 v[40:43], v23 offset:4096
    ds_read_b128 v[44:47], v23 offset:6144
    v_mfma_f32_16x16x32_bf16 v[164:167], v[100:103], v[84:87], v[164:167]
    v_mfma_f32_16x16x32_bf16 v[196:199], v[100:103], v[88:91], v[196:199]
    ds_read_b64_tr_b16 v[52:53], v28 offset:17408
    ds_read_b64_tr_b16 v[54:55], v28 offset:18432
    v_mfma_f32_16x16x32_bf16 v[228:231], v[100:103], v[92:95], v[228:231]
    buffer_load_dwordx4 v18, s[24:27], s36 offen offset:1024 lds
    v_mfma_f32_16x16x32_bf16 v[136:139], v[104:107], v[80:83], v[136:139]
    ds_read_b64_tr_b16 v[56:57], v29 offset:17408
    ds_read_b64_tr_b16 v[58:59], v29 offset:18432
    v_mfma_f32_16x16x32_bf16 v[168:171], v[104:107], v[84:87], v[168:171]
    v_mfma_f32_16x16x32_bf16 v[200:203], v[104:107], v[88:91], v[200:203]
    ds_read_b64_tr_b16 v[60:61], v30 offset:17408
    ds_read_b64_tr_b16 v[62:63], v30 offset:18432
    v_mfma_f32_16x16x32_bf16 v[232:235], v[104:107], v[92:95], v[232:235]
    v_mfma_f32_16x16x32_bf16 v[140:143], v[108:111], v[80:83], v[140:143]
    ds_read_b64_tr_b16 v[64:65], v27 offset:17536
    ds_read_b64_tr_b16 v[66:67], v27 offset:18560
    v_mfma_f32_16x16x32_bf16 v[172:175], v[108:111], v[84:87], v[172:175]
    v_mfma_f32_16x16x32_bf16 v[204:207], v[108:111], v[88:91], v[204:207]
    ds_read_b64_tr_b16 v[68:69], v28 offset:17536
    ds_read_b64_tr_b16 v[70:71], v28 offset:18560
    v_mfma_f32_16x16x32_bf16 v[236:239], v[108:111], v[92:95], v[236:239]
    buffer_load_dwordx4 v19, s[24:27], s36 offen offset:2048 lds
    v_mfma_f32_16x16x32_bf16 v[144:147], v[112:115], v[80:83], v[144:147]
    ds_read_b64_tr_b16 v[72:73], v29 offset:17536
    ds_read_b64_tr_b16 v[74:75], v29 offset:18560
    v_mfma_f32_16x16x32_bf16 v[176:179], v[112:115], v[84:87], v[176:179]
    v_mfma_f32_16x16x32_bf16 v[208:211], v[112:115], v[88:91], v[208:211]
    ds_read_b64_tr_b16 v[76:77], v30 offset:17536
    ds_read_b64_tr_b16 v[78:79], v30 offset:18560
    v_mfma_f32_16x16x32_bf16 v[240:243], v[112:115], v[92:95], v[240:243]
    v_mfma_f32_16x16x32_bf16 v[148:151], v[116:119], v[80:83], v[148:151]
    v_mfma_f32_16x16x32_bf16 v[180:183], v[116:119], v[84:87], v[180:183]
    buffer_load_dwordx4 v20, s[24:27], s36 offen offset:3072 lds
    v_mfma_f32_16x16x32_bf16 v[212:215], v[116:119], v[88:91], v[212:215]
    s_add_u32 s37, s49, 7864320
    v_mfma_f32_16x16x32_bf16 v[244:247], v[116:119], v[92:95], v[244:247]
    s_add_u32 m0, s50, 0
    v_mfma_f32_16x16x32_bf16 v[152:155], v[120:123], v[80:83], v[152:155]
    buffer_load_dwordx4 v21, s[20:23], s37 offen offset:0 lds
    v_mfma_f32_16x16x32_bf16 v[184:187], v[120:123], v[84:87], v[184:187]
    v_mfma_f32_16x16x32_bf16 v[216:219], v[120:123], v[88:91], v[216:219]
    v_mfma_f32_16x16x32_bf16 v[248:251], v[120:123], v[92:95], v[248:251]
    v_mfma_f32_16x16x32_bf16 v[156:159], v[124:127], v[80:83], v[156:159]
    v_mfma_f32_16x16x32_bf16 v[188:191], v[124:127], v[84:87], v[188:191]
    v_mfma_f32_16x16x32_bf16 v[220:223], v[124:127], v[88:91], v[220:223]
    buffer_load_dwordx4 v22, s[20:23], s37 offen offset:1024 lds
    v_mfma_f32_16x16x32_bf16 v[252:255], v[124:127], v[92:95], v[252:255]
    s_waitcnt lgkmcnt(0)
    v_mfma_f32_16x16x32_bf16 v[128:131], v[48:51], v[32:35], v[128:131]
    ds_read_b64_tr_b16 v[96:97], v27 offset:26112
    ds_read_b64_tr_b16 v[98:99], v27 offset:27136
    v_mfma_f32_16x16x32_bf16 v[160:163], v[48:51], v[36:39], v[160:163]
    s_add_u32 s36, s45, 1920
    v_mfma_f32_16x16x32_bf16 v[192:195], v[48:51], v[40:43], v[192:195]
    s_add_u32 m0, s42, 69632
    ds_read_b128 v[80:83], v24 offset:0
    ds_read_b128 v[84:87], v24 offset:2048
    v_mfma_f32_16x16x32_bf16 v[224:227], v[48:51], v[44:47], v[224:227]
    buffer_load_dwordx4 v17, s[24:27], s36 offen offset:0 lds
    v_mfma_f32_16x16x32_bf16 v[132:135], v[52:55], v[32:35], v[132:135]
    ds_read_b128 v[88:91], v24 offset:4096
    ds_read_b128 v[92:95], v24 offset:6144
    v_mfma_f32_16x16x32_bf16 v[164:167], v[52:55], v[36:39], v[164:167]
    v_mfma_f32_16x16x32_bf16 v[196:199], v[52:55], v[40:43], v[196:199]
    ds_read_b64_tr_b16 v[100:101], v28 offset:26112
    ds_read_b64_tr_b16 v[102:103], v28 offset:27136
    v_mfma_f32_16x16x32_bf16 v[228:231], v[52:55], v[44:47], v[228:231]
    buffer_load_dwordx4 v18, s[24:27], s36 offen offset:1024 lds
    v_mfma_f32_16x16x32_bf16 v[136:139], v[56:59], v[32:35], v[136:139]
    ds_read_b64_tr_b16 v[104:105], v29 offset:26112
    ds_read_b64_tr_b16 v[106:107], v29 offset:27136
    v_mfma_f32_16x16x32_bf16 v[168:171], v[56:59], v[36:39], v[168:171]
    v_mfma_f32_16x16x32_bf16 v[200:203], v[56:59], v[40:43], v[200:203]
    ds_read_b64_tr_b16 v[108:109], v30 offset:26112
    ds_read_b64_tr_b16 v[110:111], v30 offset:27136
    v_mfma_f32_16x16x32_bf16 v[232:235], v[56:59], v[44:47], v[232:235]
    v_mfma_f32_16x16x32_bf16 v[140:143], v[60:63], v[32:35], v[140:143]
    ds_read_b64_tr_b16 v[112:113], v27 offset:26240
    ds_read_b64_tr_b16 v[114:115], v27 offset:27264
    v_mfma_f32_16x16x32_bf16 v[172:175], v[60:63], v[36:39], v[172:175]
    v_mfma_f32_16x16x32_bf16 v[204:207], v[60:63], v[40:43], v[204:207]
    ds_read_b64_tr_b16 v[116:117], v28 offset:26240
    ds_read_b64_tr_b16 v[118:119], v28 offset:27264
    v_mfma_f32_16x16x32_bf16 v[236:239], v[60:63], v[44:47], v[236:239]
    buffer_load_dwordx4 v19, s[24:27], s36 offen offset:2048 lds
    v_mfma_f32_16x16x32_bf16 v[144:147], v[64:67], v[32:35], v[144:147]
    ds_read_b64_tr_b16 v[120:121], v29 offset:26240
    ds_read_b64_tr_b16 v[122:123], v29 offset:27264
    v_mfma_f32_16x16x32_bf16 v[176:179], v[64:67], v[36:39], v[176:179]
    v_mfma_f32_16x16x32_bf16 v[208:211], v[64:67], v[40:43], v[208:211]
    ds_read_b64_tr_b16 v[124:125], v30 offset:26240
    ds_read_b64_tr_b16 v[126:127], v30 offset:27264
    v_mfma_f32_16x16x32_bf16 v[240:243], v[64:67], v[44:47], v[240:243]
    v_mfma_f32_16x16x32_bf16 v[148:151], v[68:71], v[32:35], v[148:151]
    v_mfma_f32_16x16x32_bf16 v[180:183], v[68:71], v[36:39], v[180:183]
    buffer_load_dwordx4 v20, s[24:27], s36 offen offset:3072 lds
    v_mfma_f32_16x16x32_bf16 v[212:215], v[68:71], v[40:43], v[212:215]
    s_add_u32 s37, s49, 8126464
    v_mfma_f32_16x16x32_bf16 v[244:247], v[68:71], v[44:47], v[244:247]
    s_add_u32 m0, s50, 8704
    v_mfma_f32_16x16x32_bf16 v[152:155], v[72:75], v[32:35], v[152:155]
    buffer_load_dwordx4 v21, s[20:23], s37 offen offset:0 lds
    v_mfma_f32_16x16x32_bf16 v[184:187], v[72:75], v[36:39], v[184:187]
    v_mfma_f32_16x16x32_bf16 v[216:219], v[72:75], v[40:43], v[216:219]
    v_mfma_f32_16x16x32_bf16 v[248:251], v[72:75], v[44:47], v[248:251]
    v_mfma_f32_16x16x32_bf16 v[156:159], v[76:79], v[32:35], v[156:159]
    v_mfma_f32_16x16x32_bf16 v[188:191], v[76:79], v[36:39], v[188:191]
    v_mfma_f32_16x16x32_bf16 v[220:223], v[76:79], v[40:43], v[220:223]
    buffer_load_dwordx4 v22, s[20:23], s37 offen offset:1024 lds
    v_mfma_f32_16x16x32_bf16 v[252:255], v[76:79], v[44:47], v[252:255]
    s_waitcnt vmcnt(12) lgkmcnt(0)
    s_barrier
    v_mfma_f32_16x16x32_bf16 v[128:131], v[96:99], v[80:83], v[128:131]
    s_lshl_b32 s36, s33, 20
    ds_read_b64_tr_b16 v[48:49], v27 offset:34816
    ds_read_b64_tr_b16 v[50:51], v27 offset:35840
    v_mfma_f32_16x16x32_bf16 v[160:163], v[96:99], v[84:87], v[160:163]
    s_add_u32 s12, s94, s36
    s_addc_u32 s13, s95, 0
    v_mfma_f32_16x16x32_bf16 v[192:195], v[96:99], v[88:91], v[192:195]
    s_lshl_b32 s36, s34, 16
    ds_read_b128 v[32:35], v23 offset:32768
    ds_read_b128 v[36:39], v23 offset:34816
    v_mfma_f32_16x16x32_bf16 v[224:227], v[96:99], v[92:95], v[224:227]
    v_mfma_f32_16x16x32_bf16 v[132:135], v[100:103], v[80:83], v[132:135]
    s_sub_u32 s14, 1048576, s36
    ds_read_b128 v[40:43], v23 offset:36864
    ds_read_b128 v[44:47], v23 offset:38912
    v_mfma_f32_16x16x32_bf16 v[164:167], v[100:103], v[84:87], v[164:167]
    s_lshl_b32 s59, s32, 12
    v_mfma_f32_16x16x32_bf16 v[196:199], v[100:103], v[88:91], v[196:199]
    s_lshl_b32 s36, s34, 1
    ds_read_b64_tr_b16 v[52:53], v28 offset:34816
    ds_read_b64_tr_b16 v[54:55], v28 offset:35840
    v_mfma_f32_16x16x32_bf16 v[228:231], v[100:103], v[92:95], v[228:231]
    v_mfma_f32_16x16x32_bf16 v[136:139], v[104:107], v[80:83], v[136:139]
    s_add_u32 s36, s36, 3
    ds_read_b64_tr_b16 v[56:57], v29 offset:34816
    ds_read_b64_tr_b16 v[58:59], v29 offset:35840
    v_mfma_f32_16x16x32_bf16 v[168:171], v[104:107], v[84:87], v[168:171]
    s_mul_i32 s37, s36, 52
    v_mfma_f32_16x16x32_bf16 v[200:203], v[104:107], v[88:91], v[200:203]
    s_lshr_b32 s37, s37, 8
    ds_read_b64_tr_b16 v[60:61], v30 offset:34816
    ds_read_b64_tr_b16 v[62:63], v30 offset:35840
    v_mfma_f32_16x16x32_bf16 v[232:235], v[104:107], v[92:95], v[232:235]
    v_mfma_f32_16x16x32_bf16 v[140:143], v[108:111], v[80:83], v[140:143]
    s_mul_i32 s37, s37, 5
    ds_read_b64_tr_b16 v[64:65], v27 offset:34944
    ds_read_b64_tr_b16 v[66:67], v27 offset:35968
    v_mfma_f32_16x16x32_bf16 v[172:175], v[108:111], v[84:87], v[172:175]
    s_sub_u32 s36, s36, s37
    v_mfma_f32_16x16x32_bf16 v[204:207], v[108:111], v[88:91], v[204:207]
    s_lshl_b32 s47, s36, 15
    ds_read_b64_tr_b16 v[68:69], v28 offset:34944
    ds_read_b64_tr_b16 v[70:71], v28 offset:35968
    v_mfma_f32_16x16x32_bf16 v[236:239], v[108:111], v[92:95], v[236:239]
    v_mfma_f32_16x16x32_bf16 v[144:147], v[112:115], v[80:83], v[144:147]
    s_add_u32 s48, s47, 32768
    ds_read_b64_tr_b16 v[72:73], v29 offset:34944
    ds_read_b64_tr_b16 v[74:75], v29 offset:35968
    v_mfma_f32_16x16x32_bf16 v[176:179], v[112:115], v[84:87], v[176:179]
    s_cmp_eq_u32 s48, 163840
    s_cselect_b32 s48, 0, s48
    v_mfma_f32_16x16x32_bf16 v[208:211], v[112:115], v[88:91], v[208:211]
    s_add_u32 s51, s48, 32768
    ds_read_b64_tr_b16 v[76:77], v30 offset:34944
    ds_read_b64_tr_b16 v[78:79], v30 offset:35968
    v_mfma_f32_16x16x32_bf16 v[240:243], v[112:115], v[92:95], v[240:243]
    s_cmp_eq_u32 s51, 163840
    s_cselect_b32 s51, 0, s51
    v_mfma_f32_16x16x32_bf16 v[148:151], v[116:119], v[80:83], v[148:151]
    s_add_u32 s52, s51, 32768
    v_mfma_f32_16x16x32_bf16 v[180:183], v[116:119], v[84:87], v[180:183]
    v_mfma_f32_16x16x32_bf16 v[212:215], v[116:119], v[88:91], v[212:215]
    s_cmp_eq_u32 s52, 163840
    s_cselect_b32 s52, 0, s52
    v_mfma_f32_16x16x32_bf16 v[244:247], v[116:119], v[92:95], v[244:247]
    s_add_u32 s53, s52, 32768
    v_mfma_f32_16x16x32_bf16 v[152:155], v[120:123], v[80:83], v[152:155]
    v_mfma_f32_16x16x32_bf16 v[184:187], v[120:123], v[84:87], v[184:187]
    s_cmp_eq_u32 s53, 163840
    s_cselect_b32 s53, 0, s53
    v_mfma_f32_16x16x32_bf16 v[216:219], v[120:123], v[88:91], v[216:219]
    v_mfma_f32_16x16x32_bf16 v[248:251], v[120:123], v[92:95], v[248:251]
    v_mfma_f32_16x16x32_bf16 v[156:159], v[124:127], v[80:83], v[156:159]
    v_mfma_f32_16x16x32_bf16 v[188:191], v[124:127], v[84:87], v[188:191]
    v_mfma_f32_16x16x32_bf16 v[220:223], v[124:127], v[88:91], v[220:223]
    v_mfma_f32_16x16x32_bf16 v[252:255], v[124:127], v[92:95], v[252:255]
    s_waitcnt lgkmcnt(0)
    v_mfma_f32_16x16x32_bf16 v[128:131], v[48:51], v[32:35], v[128:131]
    ds_read_b64_tr_b16 v[96:97], v27 offset:43520
    ds_read_b64_tr_b16 v[98:99], v27 offset:44544
    v_mfma_f32_16x16x32_bf16 v[160:163], v[48:51], v[36:39], v[160:163]
    v_mfma_f32_16x16x32_bf16 v[192:195], v[48:51], v[40:43], v[192:195]
    ds_read_b128 v[80:83], v24 offset:32768
    ds_read_b128 v[84:87], v24 offset:34816
    v_mfma_f32_16x16x32_bf16 v[224:227], v[48:51], v[44:47], v[224:227]
    v_mfma_f32_16x16x32_bf16 v[132:135], v[52:55], v[32:35], v[132:135]
    ds_read_b128 v[88:91], v24 offset:36864
    ds_read_b128 v[92:95], v24 offset:38912
    v_mfma_f32_16x16x32_bf16 v[164:167], v[52:55], v[36:39], v[164:167]
    v_mfma_f32_16x16x32_bf16 v[196:199], v[52:55], v[40:43], v[196:199]
    ds_read_b64_tr_b16 v[100:101], v28 offset:43520
    ds_read_b64_tr_b16 v[102:103], v28 offset:44544
    v_mfma_f32_16x16x32_bf16 v[228:231], v[52:55], v[44:47], v[228:231]
    v_mfma_f32_16x16x32_bf16 v[136:139], v[56:59], v[32:35], v[136:139]
    ds_read_b64_tr_b16 v[104:105], v29 offset:43520
    ds_read_b64_tr_b16 v[106:107], v29 offset:44544
    v_mfma_f32_16x16x32_bf16 v[168:171], v[56:59], v[36:39], v[168:171]
    v_mfma_f32_16x16x32_bf16 v[200:203], v[56:59], v[40:43], v[200:203]
    ds_read_b64_tr_b16 v[108:109], v30 offset:43520
    ds_read_b64_tr_b16 v[110:111], v30 offset:44544
    v_mfma_f32_16x16x32_bf16 v[232:235], v[56:59], v[44:47], v[232:235]
    v_mfma_f32_16x16x32_bf16 v[140:143], v[60:63], v[32:35], v[140:143]
    ds_read_b64_tr_b16 v[112:113], v27 offset:43648
    ds_read_b64_tr_b16 v[114:115], v27 offset:44672
    v_mfma_f32_16x16x32_bf16 v[172:175], v[60:63], v[36:39], v[172:175]
    v_mfma_f32_16x16x32_bf16 v[204:207], v[60:63], v[40:43], v[204:207]
    ds_read_b64_tr_b16 v[116:117], v28 offset:43648
    ds_read_b64_tr_b16 v[118:119], v28 offset:44672
    v_mfma_f32_16x16x32_bf16 v[236:239], v[60:63], v[44:47], v[236:239]
    v_mfma_f32_16x16x32_bf16 v[144:147], v[64:67], v[32:35], v[144:147]
    ds_read_b64_tr_b16 v[120:121], v29 offset:43648
    ds_read_b64_tr_b16 v[122:123], v29 offset:44672
    v_mfma_f32_16x16x32_bf16 v[176:179], v[64:67], v[36:39], v[176:179]
    v_mfma_f32_16x16x32_bf16 v[208:211], v[64:67], v[40:43], v[208:211]
    ds_read_b64_tr_b16 v[124:125], v30 offset:43648
    ds_read_b64_tr_b16 v[126:127], v30 offset:44672
    v_mfma_f32_16x16x32_bf16 v[240:243], v[64:67], v[44:47], v[240:243]
    v_mfma_f32_16x16x32_bf16 v[148:151], v[68:71], v[32:35], v[148:151]
    v_mfma_f32_16x16x32_bf16 v[180:183], v[68:71], v[36:39], v[180:183]
    v_mfma_f32_16x16x32_bf16 v[212:215], v[68:71], v[40:43], v[212:215]
    v_mfma_f32_16x16x32_bf16 v[244:247], v[68:71], v[44:47], v[244:247]
    v_mfma_f32_16x16x32_bf16 v[152:155], v[72:75], v[32:35], v[152:155]
    v_mfma_f32_16x16x32_bf16 v[184:187], v[72:75], v[36:39], v[184:187]
    v_mfma_f32_16x16x32_bf16 v[216:219], v[72:75], v[40:43], v[216:219]
    v_mfma_f32_16x16x32_bf16 v[248:251], v[72:75], v[44:47], v[248:251]
    v_mfma_f32_16x16x32_bf16 v[156:159], v[76:79], v[32:35], v[156:159]
    v_mfma_f32_16x16x32_bf16 v[188:191], v[76:79], v[36:39], v[188:191]
    v_mfma_f32_16x16x32_bf16 v[220:223], v[76:79], v[40:43], v[220:223]
    v_mfma_f32_16x16x32_bf16 v[252:255], v[76:79], v[44:47], v[252:255]
    s_waitcnt vmcnt(0) lgkmcnt(0)
    s_barrier
    v_mfma_f32_16x16x32_bf16 v[128:131], v[96:99], v[80:83], v[128:131]
    ds_read_b64_tr_b16 v[48:49], v27 offset:0
    ds_read_b64_tr_b16 v[50:51], v27 offset:1024
    v_mfma_f32_16x16x32_bf16 v[160:163], v[96:99], v[84:87], v[160:163]
    v_mfma_f32_16x16x32_bf16 v[192:195], v[96:99], v[88:91], v[192:195]
    ds_read_b128 v[32:35], v25 offset:0
    ds_read_b128 v[36:39], v25 offset:2048
    v_mfma_f32_16x16x32_bf16 v[224:227], v[96:99], v[92:95], v[224:227]
    v_mfma_f32_16x16x32_bf16 v[132:135], v[100:103], v[80:83], v[132:135]
    ds_read_b128 v[40:43], v25 offset:4096
    ds_read_b128 v[44:47], v25 offset:6144
    v_mfma_f32_16x16x32_bf16 v[164:167], v[100:103], v[84:87], v[164:167]
    v_mfma_f32_16x16x32_bf16 v[196:199], v[100:103], v[88:91], v[196:199]
    ds_read_b64_tr_b16 v[52:53], v28 offset:0
    ds_read_b64_tr_b16 v[54:55], v28 offset:1024
    v_mfma_f32_16x16x32_bf16 v[228:231], v[100:103], v[92:95], v[228:231]
    v_mfma_f32_16x16x32_bf16 v[136:139], v[104:107], v[80:83], v[136:139]
    ds_read_b64_tr_b16 v[56:57], v29 offset:0
    ds_read_b64_tr_b16 v[58:59], v29 offset:1024
    v_mfma_f32_16x16x32_bf16 v[168:171], v[104:107], v[84:87], v[168:171]
    v_mfma_f32_16x16x32_bf16 v[200:203], v[104:107], v[88:91], v[200:203]
    ds_read_b64_tr_b16 v[60:61], v30 offset:0
    ds_read_b64_tr_b16 v[62:63], v30 offset:1024
    v_mfma_f32_16x16x32_bf16 v[232:235], v[104:107], v[92:95], v[232:235]
    v_mfma_f32_16x16x32_bf16 v[140:143], v[108:111], v[80:83], v[140:143]
    ds_read_b64_tr_b16 v[64:65], v27 offset:128
    ds_read_b64_tr_b16 v[66:67], v27 offset:1152
    v_mfma_f32_16x16x32_bf16 v[172:175], v[108:111], v[84:87], v[172:175]
    v_mfma_f32_16x16x32_bf16 v[204:207], v[108:111], v[88:91], v[204:207]
    ds_read_b64_tr_b16 v[68:69], v28 offset:128
    ds_read_b64_tr_b16 v[70:71], v28 offset:1152
    v_mfma_f32_16x16x32_bf16 v[236:239], v[108:111], v[92:95], v[236:239]
    v_mfma_f32_16x16x32_bf16 v[144:147], v[112:115], v[80:83], v[144:147]
    ds_read_b64_tr_b16 v[72:73], v29 offset:128
    ds_read_b64_tr_b16 v[74:75], v29 offset:1152
    v_mfma_f32_16x16x32_bf16 v[176:179], v[112:115], v[84:87], v[176:179]
    v_mfma_f32_16x16x32_bf16 v[208:211], v[112:115], v[88:91], v[208:211]
    ds_read_b64_tr_b16 v[76:77], v30 offset:128
    ds_read_b64_tr_b16 v[78:79], v30 offset:1152
    v_mfma_f32_16x16x32_bf16 v[240:243], v[112:115], v[92:95], v[240:243]
    v_mfma_f32_16x16x32_bf16 v[148:151], v[116:119], v[80:83], v[148:151]
    v_mfma_f32_16x16x32_bf16 v[180:183], v[116:119], v[84:87], v[180:183]
    v_mfma_f32_16x16x32_bf16 v[212:215], v[116:119], v[88:91], v[212:215]
    v_mfma_f32_16x16x32_bf16 v[244:247], v[116:119], v[92:95], v[244:247]
    v_mfma_f32_16x16x32_bf16 v[152:155], v[120:123], v[80:83], v[152:155]
    v_mfma_f32_16x16x32_bf16 v[184:187], v[120:123], v[84:87], v[184:187]
    v_mfma_f32_16x16x32_bf16 v[216:219], v[120:123], v[88:91], v[216:219]
    v_mfma_f32_16x16x32_bf16 v[248:251], v[120:123], v[92:95], v[248:251]
    v_mfma_f32_16x16x32_bf16 v[156:159], v[124:127], v[80:83], v[156:159]
    v_mfma_f32_16x16x32_bf16 v[188:191], v[124:127], v[84:87], v[188:191]
    v_mfma_f32_16x16x32_bf16 v[220:223], v[124:127], v[88:91], v[220:223]
    v_mfma_f32_16x16x32_bf16 v[252:255], v[124:127], v[92:95], v[252:255]
    s_waitcnt lgkmcnt(0)
    v_mfma_f32_16x16x32_bf16 v[128:131], v[48:51], v[32:35], v[128:131]
    ds_read_b64_tr_b16 v[96:97], v27 offset:8704
    ds_read_b64_tr_b16 v[98:99], v27 offset:9728
    v_mfma_f32_16x16x32_bf16 v[160:163], v[48:51], v[36:39], v[160:163]
    v_mfma_f32_16x16x32_bf16 v[192:195], v[48:51], v[40:43], v[192:195]
    ds_read_b128 v[80:83], v26 offset:0
    ds_read_b128 v[84:87], v26 offset:2048
    v_mfma_f32_16x16x32_bf16 v[224:227], v[48:51], v[44:47], v[224:227]
    buffer_load_dword v2, v3, s[28:31], s40 offen sc1
    v_mfma_f32_16x16x32_bf16 v[132:135], v[52:55], v[32:35], v[132:135]
    ds_read_b128 v[88:91], v26 offset:4096
    ds_read_b128 v[92:95], v26 offset:6144
    v_mfma_f32_16x16x32_bf16 v[164:167], v[52:55], v[36:39], v[164:167]
    v_mfma_f32_16x16x32_bf16 v[196:199], v[52:55], v[40:43], v[196:199]
    ds_read_b64_tr_b16 v[100:101], v28 offset:8704
    ds_read_b64_tr_b16 v[102:103], v28 offset:9728
    v_mfma_f32_16x16x32_bf16 v[228:231], v[52:55], v[44:47], v[228:231]
    v_mfma_f32_16x16x32_bf16 v[136:139], v[56:59], v[32:35], v[136:139]
    ds_read_b64_tr_b16 v[104:105], v29 offset:8704
    ds_read_b64_tr_b16 v[106:107], v29 offset:9728
    v_mfma_f32_16x16x32_bf16 v[168:171], v[56:59], v[36:39], v[168:171]
    v_mfma_f32_16x16x32_bf16 v[200:203], v[56:59], v[40:43], v[200:203]
    ds_read_b64_tr_b16 v[108:109], v30 offset:8704
    ds_read_b64_tr_b16 v[110:111], v30 offset:9728
    v_mfma_f32_16x16x32_bf16 v[232:235], v[56:59], v[44:47], v[232:235]
    v_mfma_f32_16x16x32_bf16 v[140:143], v[60:63], v[32:35], v[140:143]
    ds_read_b64_tr_b16 v[112:113], v27 offset:8832
    ds_read_b64_tr_b16 v[114:115], v27 offset:9856
    v_mfma_f32_16x16x32_bf16 v[172:175], v[60:63], v[36:39], v[172:175]
    v_mfma_f32_16x16x32_bf16 v[204:207], v[60:63], v[40:43], v[204:207]
    ds_read_b64_tr_b16 v[116:117], v28 offset:8832
    ds_read_b64_tr_b16 v[118:119], v28 offset:9856
    v_mfma_f32_16x16x32_bf16 v[236:239], v[60:63], v[44:47], v[236:239]
    v_mfma_f32_16x16x32_bf16 v[144:147], v[64:67], v[32:35], v[144:147]
    ds_read_b64_tr_b16 v[120:121], v29 offset:8832
    ds_read_b64_tr_b16 v[122:123], v29 offset:9856
    v_mfma_f32_16x16x32_bf16 v[176:179], v[64:67], v[36:39], v[176:179]
    v_mfma_f32_16x16x32_bf16 v[208:211], v[64:67], v[40:43], v[208:211]
    ds_read_b64_tr_b16 v[124:125], v30 offset:8832
    ds_read_b64_tr_b16 v[126:127], v30 offset:9856
    v_mfma_f32_16x16x32_bf16 v[240:243], v[64:67], v[44:47], v[240:243]
    v_mfma_f32_16x16x32_bf16 v[148:151], v[68:71], v[32:35], v[148:151]
    v_mfma_f32_16x16x32_bf16 v[180:183], v[68:71], v[36:39], v[180:183]
    v_mfma_f32_16x16x32_bf16 v[212:215], v[68:71], v[40:43], v[212:215]
    v_mfma_f32_16x16x32_bf16 v[244:247], v[68:71], v[44:47], v[244:247]
    v_mfma_f32_16x16x32_bf16 v[152:155], v[72:75], v[32:35], v[152:155]
    v_mfma_f32_16x16x32_bf16 v[184:187], v[72:75], v[36:39], v[184:187]
    v_mfma_f32_16x16x32_bf16 v[216:219], v[72:75], v[40:43], v[216:219]
    v_mfma_f32_16x16x32_bf16 v[248:251], v[72:75], v[44:47], v[248:251]
    v_mfma_f32_16x16x32_bf16 v[156:159], v[76:79], v[32:35], v[156:159]
    v_mfma_f32_16x16x32_bf16 v[188:191], v[76:79], v[36:39], v[188:191]
    v_mfma_f32_16x16x32_bf16 v[220:223], v[76:79], v[40:43], v[220:223]
    v_mfma_f32_16x16x32_bf16 v[252:255], v[76:79], v[44:47], v[252:255]
    s_waitcnt vmcnt(0) lgkmcnt(0)
    s_barrier
    v_cmp_ne_u32 vcc, 1, v2
    v_mfma_f32_16x16x32_bf16 v[128:131], v[96:99], v[80:83], v[128:131]
    s_nop 0
    s_cbranch_vccnz gated_mix__ssm_conv_h3__compressed_kv_cla__prompt_kernel_spin_kv
gated_mix__ssm_conv_h3__compressed_kv_cla__prompt_kernel_spin_kv_ret:
    v_mfma_f32_16x16x32_bf16 v[160:163], v[96:99], v[84:87], v[160:163]
    s_add_u32 s36, s59, 0
    v_mfma_f32_16x16x32_bf16 v[192:195], v[96:99], v[88:91], v[192:195]
    s_add_u32 s37, s59, s47
    s_mov_b32 m0, s37
    v_mfma_f32_16x16x32_bf16 v[224:227], v[96:99], v[92:95], v[224:227]
    buffer_load_dwordx4 v16, s[12:15], s36 offen offset:0 sc1 lds
    v_mfma_f32_16x16x32_bf16 v[132:135], v[100:103], v[80:83], v[132:135]
    v_mfma_f32_16x16x32_bf16 v[164:167], v[100:103], v[84:87], v[164:167]
    v_mfma_f32_16x16x32_bf16 v[196:199], v[100:103], v[88:91], v[196:199]
    v_mfma_f32_16x16x32_bf16 v[228:231], v[100:103], v[92:95], v[228:231]
    buffer_load_dwordx4 v16, s[12:15], s36 offen offset:1024 sc1 lds
    v_mfma_f32_16x16x32_bf16 v[136:139], v[104:107], v[80:83], v[136:139]
    v_mfma_f32_16x16x32_bf16 v[168:171], v[104:107], v[84:87], v[168:171]
    v_mfma_f32_16x16x32_bf16 v[200:203], v[104:107], v[88:91], v[200:203]
    v_mfma_f32_16x16x32_bf16 v[232:235], v[104:107], v[92:95], v[232:235]
    buffer_load_dwordx4 v16, s[12:15], s36 offen offset:2048 sc1 lds
    v_mfma_f32_16x16x32_bf16 v[140:143], v[108:111], v[80:83], v[140:143]
    v_mfma_f32_16x16x32_bf16 v[172:175], v[108:111], v[84:87], v[172:175]
    v_mfma_f32_16x16x32_bf16 v[204:207], v[108:111], v[88:91], v[204:207]
    v_mfma_f32_16x16x32_bf16 v[236:239], v[108:111], v[92:95], v[236:239]
    buffer_load_dwordx4 v16, s[12:15], s36 offen offset:3072 sc1 lds
    v_mfma_f32_16x16x32_bf16 v[144:147], v[112:115], v[80:83], v[144:147]
    v_mfma_f32_16x16x32_bf16 v[176:179], v[112:115], v[84:87], v[176:179]
    v_mfma_f32_16x16x32_bf16 v[208:211], v[112:115], v[88:91], v[208:211]
    v_mfma_f32_16x16x32_bf16 v[240:243], v[112:115], v[92:95], v[240:243]
    s_add_u32 s36, s59, 16384
    v_mfma_f32_16x16x32_bf16 v[148:151], v[116:119], v[80:83], v[148:151]
    s_add_u32 s37, s59, s47
    s_add_u32 m0, s37, 16384
    v_mfma_f32_16x16x32_bf16 v[180:183], v[116:119], v[84:87], v[180:183]
    buffer_load_dwordx4 v16, s[12:15], s36 offen offset:0 sc1 lds
    v_mfma_f32_16x16x32_bf16 v[212:215], v[116:119], v[88:91], v[212:215]
    v_mfma_f32_16x16x32_bf16 v[244:247], v[116:119], v[92:95], v[244:247]
    v_mfma_f32_16x16x32_bf16 v[152:155], v[120:123], v[80:83], v[152:155]
    buffer_load_dwordx4 v16, s[12:15], s36 offen offset:1024 sc1 lds
    v_mfma_f32_16x16x32_bf16 v[184:187], v[120:123], v[84:87], v[184:187]
    v_mfma_f32_16x16x32_bf16 v[216:219], v[120:123], v[88:91], v[216:219]
    v_mfma_f32_16x16x32_bf16 v[248:251], v[120:123], v[92:95], v[248:251]
    buffer_load_dwordx4 v16, s[12:15], s36 offen offset:2048 sc1 lds
    v_mfma_f32_16x16x32_bf16 v[156:159], v[124:127], v[80:83], v[156:159]
    v_mfma_f32_16x16x32_bf16 v[188:191], v[124:127], v[84:87], v[188:191]
    v_mfma_f32_16x16x32_bf16 v[220:223], v[124:127], v[88:91], v[220:223]
    buffer_load_dwordx4 v16, s[12:15], s36 offen offset:3072 sc1 lds
    v_mfma_f32_16x16x32_bf16 v[252:255], v[124:127], v[92:95], v[252:255]
    s_add_u32 s36, s59, 32768
    s_add_u32 s37, s59, s48
    s_mov_b32 m0, s37
    s_nop 0
    buffer_load_dwordx4 v16, s[12:15], s36 offen offset:0 sc1 lds
    buffer_load_dwordx4 v16, s[12:15], s36 offen offset:1024 sc1 lds
    buffer_load_dwordx4 v16, s[12:15], s36 offen offset:2048 sc1 lds
    buffer_load_dwordx4 v16, s[12:15], s36 offen offset:3072 sc1 lds
    v_cvt_pk_bf16_f32 v80, v128, v129
    v_cvt_pk_bf16_f32 v81, v130, v131
    v_cvt_pk_bf16_f32 v82, v132, v133
    v_cvt_pk_bf16_f32 v83, v134, v135
    v_cvt_pk_bf16_f32 v84, v136, v137
    v_cvt_pk_bf16_f32 v85, v138, v139
    v_cvt_pk_bf16_f32 v86, v140, v141
    v_cvt_pk_bf16_f32 v87, v142, v143
    v_cvt_pk_bf16_f32 v88, v144, v145
    v_cvt_pk_bf16_f32 v89, v146, v147
    v_cvt_pk_bf16_f32 v90, v148, v149
    v_cvt_pk_bf16_f32 v91, v150, v151
    v_cvt_pk_bf16_f32 v92, v152, v153
    v_cvt_pk_bf16_f32 v93, v154, v155
    v_cvt_pk_bf16_f32 v94, v156, v157
    v_cvt_pk_bf16_f32 v95, v158, v159
    s_add_u32 s36, s59, 49152
    s_add_u32 s37, s59, s48
    s_add_u32 m0, s37, 16384
    s_nop 0
    buffer_load_dwordx4 v16, s[12:15], s36 offen offset:0 sc1 lds
    buffer_load_dwordx4 v16, s[12:15], s36 offen offset:1024 sc1 lds
    buffer_load_dwordx4 v16, s[12:15], s36 offen offset:2048 sc1 lds
    buffer_load_dwordx4 v16, s[12:15], s36 offen offset:3072 sc1 lds
    v_cvt_pk_bf16_f32 v96, v160, v161
    v_cvt_pk_bf16_f32 v97, v162, v163
    v_cvt_pk_bf16_f32 v98, v164, v165
    v_cvt_pk_bf16_f32 v99, v166, v167
    v_cvt_pk_bf16_f32 v100, v168, v169
    v_cvt_pk_bf16_f32 v101, v170, v171
    v_cvt_pk_bf16_f32 v102, v172, v173
    v_cvt_pk_bf16_f32 v103, v174, v175
    v_cvt_pk_bf16_f32 v104, v176, v177
    v_cvt_pk_bf16_f32 v105, v178, v179
    v_cvt_pk_bf16_f32 v106, v180, v181
    v_cvt_pk_bf16_f32 v107, v182, v183
    v_cvt_pk_bf16_f32 v108, v184, v185
    v_cvt_pk_bf16_f32 v109, v186, v187
    v_cvt_pk_bf16_f32 v110, v188, v189
    v_cvt_pk_bf16_f32 v111, v190, v191
    v_cvt_pk_bf16_f32 v112, v192, v193
    v_cvt_pk_bf16_f32 v113, v194, v195
    v_cvt_pk_bf16_f32 v114, v196, v197
    v_cvt_pk_bf16_f32 v115, v198, v199
    v_cvt_pk_bf16_f32 v116, v200, v201
    v_cvt_pk_bf16_f32 v117, v202, v203
    v_cvt_pk_bf16_f32 v118, v204, v205
    v_cvt_pk_bf16_f32 v119, v206, v207
    v_cvt_pk_bf16_f32 v120, v208, v209
    v_cvt_pk_bf16_f32 v121, v210, v211
    v_cvt_pk_bf16_f32 v122, v212, v213
    v_cvt_pk_bf16_f32 v123, v214, v215
    v_cvt_pk_bf16_f32 v124, v216, v217
    v_cvt_pk_bf16_f32 v125, v218, v219
    v_cvt_pk_bf16_f32 v126, v220, v221
    v_cvt_pk_bf16_f32 v127, v222, v223
    v_cvt_pk_bf16_f32 v128, v224, v225
    v_cvt_pk_bf16_f32 v129, v226, v227
    v_cvt_pk_bf16_f32 v130, v228, v229
    v_cvt_pk_bf16_f32 v131, v230, v231
    v_cvt_pk_bf16_f32 v132, v232, v233
    v_cvt_pk_bf16_f32 v133, v234, v235
    v_cvt_pk_bf16_f32 v134, v236, v237
    v_cvt_pk_bf16_f32 v135, v238, v239
    v_cvt_pk_bf16_f32 v136, v240, v241
    v_cvt_pk_bf16_f32 v137, v242, v243
    v_cvt_pk_bf16_f32 v138, v244, v245
    v_cvt_pk_bf16_f32 v139, v246, v247
    v_cvt_pk_bf16_f32 v140, v248, v249
    v_cvt_pk_bf16_f32 v141, v250, v251
    v_cvt_pk_bf16_f32 v142, v252, v253
    v_cvt_pk_bf16_f32 v143, v254, v255
    v_add_u32 v2, s47, v16
    v_mov_b32 v3, v2
    s_waitcnt vmcnt(8)
    s_barrier
    ds_read_b128 a[128:131], v2 offset:0
    ds_read_b128 a[132:135], v2 offset:1024
    ds_read_b128 a[136:139], v2 offset:2048
    ds_read_b128 a[140:143], v2 offset:3072
    ds_read_b128 a[144:147], v2 offset:4096
    ds_read_b128 a[148:151], v2 offset:5120
    ds_read_b128 a[152:155], v2 offset:6144
    ds_read_b128 a[156:159], v2 offset:7168
    s_add_u32 s36, s59, 65536
    s_add_u32 s37, s59, s51
    s_mov_b32 m0, s37
    s_nop 0
    buffer_load_dwordx4 v16, s[12:15], s36 offen offset:0 sc1 lds
    buffer_load_dwordx4 v16, s[12:15], s36 offen offset:1024 sc1 lds
    buffer_load_dwordx4 v16, s[12:15], s36 offen offset:2048 sc1 lds
    buffer_load_dwordx4 v16, s[12:15], s36 offen offset:3072 sc1 lds
    s_add_u32 s38, s59, 131072
    s_mov_b32 s42, 0x40004000
    s_mov_b32 s39, s47
    s_mov_b32 s45, s48
    s_add_u32 s40, s59, s53
    s_add_u32 s41, s40, 16384
    s_mov_b32 s44, 32768
    s_movk_i32 s49, 16384
    s_movk_i32 s50, 16384
    s_add_u32 s16, s94, 33554432
    s_addc_u32 s17, s95, 0
    s_mov_b32 s18, 16777216
    s_mov_b32 s8, s86
    s_mov_b32 s9, s87
    s_mov_b32 s10, 8388608
    s_mov_b32 s4, s72
    s_mov_b32 s5, s73
    s_mov_b32 s6, 4194304
    s_lshl_b32 s54, s2, 2
    s_add_u32 s54, s54, s32
    s_sub_u32 s46, s54, 512
    s_lshl_b32 s46, s46, 11
    s_cmp_lt_u32 s34, 4
    s_cselect_b32 s46, 0x80000000, s46
    s_lshl_b32 s54, s54, 12
    v_lshlrev_b32 v19, 3, v16
    v_cmp_gt_u32 vcc, 256, v16
    v_mov_b32 v15, 0x80000000
    s_nop 0
gated_mix__ssm_conv_h3__compressed_kv_cla__prompt_kernel_pad8:
    s_cbranch_execz gated_mix__ssm_conv_h3__compressed_kv_cla__prompt_kernel_pad12
    v_cndmask_b32 v19, v15, v19, vcc
    v_bfe_u32 v40, v16, 4, 4
    v_lshrrev_b32 v41, 8, v16
    v_sub_u32 v40, v40, v41
    v_lshl_add_u32 v40, v40, 2, s32
    v_mov_b32 v41, 0xff000000
    v_cmp_gt_i32 vcc, 0, v40
    v_cmp_gt_i32 s[36:37], 1, v40
    s_nop 0
    v_cndmask_b32 v48, 0, v41, vcc
    v_cndmask_b32 v49, 0, v41, s[36:37]
    v_cmp_gt_i32 vcc, 2, v40
    v_cmp_gt_i32 s[36:37], 3, v40
    s_nop 0
    v_cndmask_b32 v50, 0, v41, vcc
    v_cndmask_b32 v51, 0, v41, s[36:37]
    v_cmp_gt_i32 vcc, 16, v40
    v_cmp_gt_i32 s[36:37], 17, v40
    s_nop 0
    v_cndmask_b32 v52, 0, v41, vcc
    v_cndmask_b32 v53, 0, v41, s[36:37]
    v_cmp_gt_i32 vcc, 18, v40
    v_cmp_gt_i32 s[36:37], 19, v40
    s_nop 0
    v_cndmask_b32 v54, 0, v41, vcc
    v_cndmask_b32 v55, 0, v41, s[36:37]
    v_cmp_gt_i32 vcc, 32, v40
    v_cmp_gt_i32 s[36:37], 33, v40
    s_nop 0
    v_cndmask_b32 v56, 0, v41, vcc
    v_cndmask_b32 v57, 0, v41, s[36:37]
    v_cmp_gt_i32 vcc, 34, v40
    v_cmp_gt_i32 s[36:37], 35, v40
    s_nop 0
    v_cndmask_b32 v58, 0, v41, vcc
    v_cndmask_b32 v59, 0, v41, s[36:37]
    v_cmp_gt_i32 vcc, 48, v40
    v_cmp_gt_i32 s[36:37], 49, v40
    s_nop 0
    v_cndmask_b32 v60, 0, v41, vcc
    v_cndmask_b32 v61, 0, v41, s[36:37]
    v_cmp_gt_i32 vcc, 50, v40
    v_cmp_gt_i32 s[36:37], 51, v40
    s_nop 0
    v_cndmask_b32 v62, 0, v41, vcc
    v_cndmask_b32 v63, 0, v41, s[36:37]
    v_mov_b32 v240, 0
    v_mov_b32 v241, 0
    v_mov_b32 v242, 0
    v_mov_b32 v243, 0
    v_mov_b32 v244, 0
    v_mov_b32 v245, 0
    v_mov_b32 v246, 0
    v_mov_b32 v247, 0
    v_mov_b32 v248, 0
    v_mov_b32 v249, 0
    v_mov_b32 v250, 0
    v_mov_b32 v251, 0
    v_mov_b32 v252, 0
    v_mov_b32 v253, 0
    v_mov_b32 v254, 0
    v_mov_b32 v255, 0
    v_mov_b32 v24, 0x3f803f80
    v_mov_b32 v25, 0x3f803f80
    v_mov_b32 v26, 0x3f803f80
    v_mov_b32 v27, 0x3f803f80
    s_waitcnt lgkmcnt(7)
    v_mfma_f32_16x16x32_bf16 v[144:147], a[128:131], v[80:83], 0
    v_mfma_f32_16x16x32_bf16 v[152:155], a[128:131], v[96:99], 0
    s_add_u32 s36, s59, 81920
    s_add_u32 s37, s59, s51
    s_add_u32 m0, s37, 16384
    s_nop 0
    buffer_load_dwordx4 v16, s[12:15], s36 offen offset:0 sc1 lds
    v_mfma_f32_16x16x32_bf16 v[160:163], a[128:131], v[112:115], 0
    v_mfma_f32_16x16x32_bf16 v[168:171], a[128:131], v[128:131], 0
    s_waitcnt lgkmcnt(6)
    buffer_load_dwordx4 v16, s[12:15], s36 offen offset:1024 sc1 lds
    v_mfma_f32_16x16x32_bf16 v[144:147], a[132:135], v[84:87], v[144:147]
    v_mfma_f32_16x16x32_bf16 v[152:155], a[132:135], v[100:103], v[152:155]
    buffer_load_dwordx4 v16, s[12:15], s36 offen offset:2048 sc1 lds
    v_mfma_f32_16x16x32_bf16 v[160:163], a[132:135], v[116:119], v[160:163]
    v_mfma_f32_16x16x32_bf16 v[168:171], a[132:135], v[132:135], v[168:171]
    s_waitcnt lgkmcnt(5)
    buffer_load_dwordx4 v16, s[12:15], s36 offen offset:3072 sc1 lds
    v_mfma_f32_16x16x32_bf16 v[144:147], a[136:139], v[88:91], v[144:147]
    v_mfma_f32_16x16x32_bf16 v[152:155], a[136:139], v[104:107], v[152:155]
    s_add_u32 s36, s59, 98304
    s_add_u32 s37, s59, s52
    s_mov_b32 m0, s37
    s_nop 0
    buffer_load_dwordx4 v16, s[12:15], s36 offen offset:0 sc1 lds
    v_mfma_f32_16x16x32_bf16 v[160:163], a[136:139], v[120:123], v[160:163]
    v_mfma_f32_16x16x32_bf16 v[168:171], a[136:139], v[136:139], v[168:171]
    s_waitcnt lgkmcnt(4)
    buffer_load_dwordx4 v16, s[12:15], s36 offen offset:1024 sc1 lds
    v_mfma_f32_16x16x32_bf16 v[144:147], a[140:143], v[92:95], v[144:147]
    v_mfma_f32_16x16x32_bf16 v[152:155], a[140:143], v[108:111], v[152:155]
    buffer_load_dwordx4 v16, s[12:15], s36 offen offset:2048 sc1 lds
    v_mfma_f32_16x16x32_bf16 v[160:163], a[140:143], v[124:127], v[160:163]
    v_mfma_f32_16x16x32_bf16 v[168:171], a[140:143], v[140:143], v[168:171]
    s_waitcnt lgkmcnt(3)
    buffer_load_dwordx4 v16, s[12:15], s36 offen offset:3072 sc1 lds
    v_mfma_f32_16x16x32_bf16 v[148:151], a[144:147], v[80:83], 0
    v_mfma_f32_16x16x32_bf16 v[156:159], a[144:147], v[96:99], 0
    s_add_u32 s36, s59, 114688
    s_add_u32 s37, s59, s52
    s_add_u32 m0, s37, 16384
    s_nop 0
    buffer_load_dwordx4 v16, s[12:15], s36 offen offset:0 sc1 lds
    v_mfma_f32_16x16x32_bf16 v[164:167], a[144:147], v[112:115], 0
    v_mfma_f32_16x16x32_bf16 v[172:175], a[144:147], v[128:131], 0
    s_waitcnt lgkmcnt(2)
    buffer_load_dwordx4 v16, s[12:15], s36 offen offset:1024 sc1 lds
    v_mfma_f32_16x16x32_bf16 v[148:151], a[148:151], v[84:87], v[148:151]
    v_mfma_f32_16x16x32_bf16 v[156:159], a[148:151], v[100:103], v[156:159]
    buffer_load_dwordx4 v16, s[12:15], s36 offen offset:2048 sc1 lds
    v_mfma_f32_16x16x32_bf16 v[164:167], a[148:151], v[116:119], v[164:167]
    v_mfma_f32_16x16x32_bf16 v[172:175], a[148:151], v[132:135], v[172:175]
    s_waitcnt lgkmcnt(1)
    buffer_load_dwordx4 v16, s[12:15], s36 offen offset:3072 sc1 lds
    v_mfma_f32_16x16x32_bf16 v[148:151], a[152:155], v[88:91], v[148:151]
    v_mfma_f32_16x16x32_bf16 v[156:159], a[152:155], v[104:107], v[156:159]
    s_movk_i32 s47, 12288
    v_lshlrev_b32 v15, 3, v16
    buffer_load_dwordx4 v[28:31], v16, s[28:31], s47 offen sc1
    v_mfma_f32_16x16x32_bf16 v[164:167], a[152:155], v[120:123], v[164:167]
    v_mfma_f32_16x16x32_bf16 v[172:175], a[152:155], v[136:139], v[172:175]
    s_waitcnt lgkmcnt(0)
    buffer_load_dword a200, v15, s[4:7], s54 offen
    v_mfma_f32_16x16x32_bf16 v[148:151], a[156:159], v[92:95], v[148:151]
    v_mfma_f32_16x16x32_bf16 v[156:159], a[156:159], v[108:111], v[156:159]
    v_mfma_f32_16x16x32_bf16 v[164:167], a[156:159], v[124:127], v[164:167]
    v_mfma_f32_16x16x32_bf16 v[172:175], a[156:159], v[140:143], v[172:175]
    ds_read_b128 a[128:131], v2 offset:16384
    ds_read_b128 a[132:135], v2 offset:17408
    ds_read_b128 a[136:139], v2 offset:18432
    ds_read_b128 a[140:143], v2 offset:19456
    ds_read_b128 a[144:147], v2 offset:20480
    ds_read_b128 a[148:151], v2 offset:21504
    ds_read_b128 a[152:155], v2 offset:22528
    ds_read_b128 a[156:159], v2 offset:23552
    ds_read_b128 a[160:163], v2 offset:8192
    ds_read_b128 a[164:167], v2 offset:9216
    ds_read_b128 a[168:171], v2 offset:10240
    ds_read_b128 a[172:175], v2 offset:11264
    s_cmp_lg_u32 s34, 0
    s_nop 3
    s_cbranch_scc1 gated_mix__ssm_conv_h3__compressed_kv_cla__prompt_kernel_nomask0
    v_add_f32 v144, v48, v144
    v_add_f32 v145, v49, v145
    v_add_f32 v146, v50, v146
    v_add_f32 v147, v51, v147
    v_add_f32 v148, v52, v148
    v_add_f32 v149, v53, v149
    v_add_f32 v150, v54, v150
    v_add_f32 v151, v55, v151
gated_mix__ssm_conv_h3__compressed_kv_cla__prompt_kernel_nomask0:
    v_max3_f32 v32, v144, v145, v146
    v_max3_f32 v32, v147, v148, v32
    v_max3_f32 v32, v149, v150, v32
    v_max_f32 v32, v151, v32
    v_max3_f32 v34, v152, v153, v154
    v_max3_f32 v34, v155, v156, v34
    v_max3_f32 v34, v157, v158, v34
    v_max_f32 v34, v159, v34
    v_max3_f32 v36, v160, v161, v162
    v_max3_f32 v36, v163, v164, v36
    v_max3_f32 v36, v165, v166, v36
    v_max_f32 v36, v167, v36
    v_max3_f32 v38, v168, v169, v170
    v_max3_f32 v38, v171, v172, v38
    v_max3_f32 v38, v173, v174, v38
    v_max_f32 v38, v175, v38
    v_mov_b32 v33, v32
    v_mov_b32 v35, v34
    v_mov_b32 v37, v36
    v_mov_b32 v39, v38
    v_permlane16_swap_b32 v32, v33
    v_permlane16_swap_b32 v34, v35
    v_permlane16_swap_b32 v36, v37
    v_permlane16_swap_b32 v38, v39
    v_max_f32 v32, v32, v33
    v_max_f32 v34, v34, v35
    v_max_f32 v36, v36, v37
    v_max_f32 v38, v38, v39
    v_mov_b32 v33, v32
    v_mov_b32 v35, v34
    v_mov_b32 v37, v36
    v_mov_b32 v39, v38
    v_permlane32_swap_b32 v32, v33
    v_permlane32_swap_b32 v34, v35
    v_permlane32_swap_b32 v36, v37
    v_permlane32_swap_b32 v38, v39
    v_max_f32 v32, v32, v33
    v_max_f32 v34, v34, v35
    v_max_f32 v36, v36, v37
    v_max_f32 v38, v38, v39
    v_add_f32 v32, 0x41c00000, v32
    v_sub_f32 v64, 0, v32
    v_sub_f32 v65, 0, v32
    v_sub_f32 v66, 0, v32
    v_sub_f32 v67, 0, v32
    v_sub_f32 v144, v144, v32
    v_sub_f32 v145, v145, v32
    v_sub_f32 v146, v146, v32
    v_sub_f32 v147, v147, v32
    v_sub_f32 v148, v148, v32
    v_sub_f32 v149, v149, v32
    v_sub_f32 v150, v150, v32
    v_sub_f32 v151, v151, v32
    v_add_f32 v34, 0x41c00000, v34
    v_sub_f32 v68, 0, v34
    v_sub_f32 v69, 0, v34
    v_sub_f32 v70, 0, v34
    v_sub_f32 v71, 0, v34
    v_sub_f32 v152, v152, v34
    v_sub_f32 v153, v153, v34
    v_sub_f32 v154, v154, v34
    v_sub_f32 v155, v155, v34
    v_sub_f32 v156, v156, v34
    v_sub_f32 v157, v157, v34
    v_sub_f32 v158, v158, v34
    v_sub_f32 v159, v159, v34
    v_add_f32 v36, 0x41c00000, v36
    v_sub_f32 v72, 0, v36
    v_sub_f32 v73, 0, v36
    v_sub_f32 v74, 0, v36
    v_sub_f32 v75, 0, v36
    v_sub_f32 v160, v160, v36
    v_sub_f32 v161, v161, v36
    v_sub_f32 v162, v162, v36
    v_sub_f32 v163, v163, v36
    v_sub_f32 v164, v164, v36
    v_sub_f32 v165, v165, v36
    v_sub_f32 v166, v166, v36
    v_sub_f32 v167, v167, v36
    v_add_f32 v38, 0x41c00000, v38
    v_sub_f32 v76, 0, v38
    v_sub_f32 v77, 0, v38
    v_sub_f32 v78, 0, v38
    v_sub_f32 v79, 0, v38
    v_sub_f32 v168, v168, v38
    v_sub_f32 v169, v169, v38
    v_sub_f32 v170, v170, v38
    v_sub_f32 v171, v171, v38
    v_sub_f32 v172, v172, v38
    v_sub_f32 v173, v173, v38
    v_sub_f32 v174, v174, v38
    v_sub_f32 v175, v175, v38
    v_exp_f32 v4, v168
    v_exp_f32 v5, v169
    s_nop 0
    v_cvt_pk_bf16_f32 v220, v4, v5
    v_exp_f32 v6, v170
    v_exp_f32 v7, v171
    s_nop 0
    v_cvt_pk_bf16_f32 v221, v6, v7
    v_or_b32 v12, v220, v221
    v_exp_f32 v8, v172
    v_exp_f32 v9, v173
    s_nop 0
    v_cvt_pk_bf16_f32 v222, v8, v9
    v_exp_f32 v10, v174
    v_exp_f32 v11, v175
    s_nop 0
    v_cvt_pk_bf16_f32 v223, v10, v11
    v_or3_b32 v12, v12, v222, v223
    v_exp_f32 v4, v160
    v_exp_f32 v5, v161
    s_nop 0
    v_cvt_pk_bf16_f32 v216, v4, v5
    v_exp_f32 v6, v162
    v_exp_f32 v7, v163
    s_nop 0
    v_cvt_pk_bf16_f32 v217, v6, v7
    v_or3_b32 v12, v12, v216, v217
    v_exp_f32 v8, v164
    v_exp_f32 v9, v165
    s_nop 0
    v_cvt_pk_bf16_f32 v218, v8, v9
    v_exp_f32 v10, v166
    v_exp_f32 v11, v167
    s_nop 0
    v_cvt_pk_bf16_f32 v219, v10, v11
    v_or3_b32 v12, v12, v218, v219
    v_add_u32 v2, s45, v16
    s_waitcnt vmcnt(18) lgkmcnt(0)
    s_barrier
    s_lshl_b32 s35, s34, 1
    s_add_u32 s35, s35, 1
    s_min_u32 s58, s35, 14
    s_cmp_eq_u32 s34, 7
    s_cselect_b32 s58, s58, s35
    s_nop 0
    s_nop 0
    s_nop 0
    s_nop 0
    s_nop 0
    s_nop 0
    s_nop 0
    s_nop 0
    s_nop 0
    s_nop 0
gated_mix__ssm_conv_h3__compressed_kv_cla__prompt_kernel_b4_loop:
    v_mfma_f32_16x16x32_bf16 v[176:179], a[128:131], v[80:83], v[64:67]
    s_cmp_eq_u32 s35, 1
    v_exp_f32 v4, v152
    v_mfma_f32_16x16x32_bf16 v[184:187], a[128:131], v[96:99], v[68:71]
    s_cbranch_scc1 gated_mix__ssm_conv_h3__compressed_kv_cla__prompt_kernel_b4_m0
gated_mix__ssm_conv_h3__compressed_kv_cla__prompt_kernel_b4_m0_ret:
    ds_read_b128 a[176:179], v3 offset:12288
    ds_read_b128 a[180:183], v3 offset:13312
    v_mfma_f32_16x16x32_bf16 v[192:195], a[128:131], v[112:115], v[72:75]
    s_waitcnt vmcnt(18)
    v_exp_f32 v5, v153
    v_mfma_f32_16x16x32_bf16 v[200:203], a[128:131], v[128:131], v[76:79]
    s_barrier
    ds_read_b128 a[184:187], v3 offset:14336
    v_mfma_f32_16x16x32_bf16 v[176:179], a[132:135], v[84:87], v[176:179]
    s_mov_b32 m0, s40
    v_exp_f32 v6, v154
    v_mfma_f32_16x16x32_bf16 v[184:187], a[132:135], v[100:103], v[184:187]
    s_add_u32 s43, s38, s49
    v_exp_f32 v7, v155
    v_mfma_f32_16x16x32_bf16 v[192:195], a[132:135], v[116:119], v[192:195]
    ds_read_b128 a[188:191], v3 offset:15360
    v_cvt_pk_bf16_f32 v212, v4, v5
    v_mfma_f32_16x16x32_bf16 v[200:203], a[132:135], v[132:135], v[200:203]
    ds_read_b128 a[128:131], v2 offset:0
    v_cvt_pk_bf16_f32 v213, v6, v7
    v_mfma_f32_16x16x32_bf16 v[176:179], a[136:139], v[88:91], v[176:179]
    v_exp_f32 v8, v156
    v_mfma_f32_16x16x32_bf16 v[184:187], a[136:139], v[104:107], v[184:187]
    v_exp_f32 v9, v157
    v_mfma_f32_16x16x32_bf16 v[192:195], a[136:139], v[120:123], v[192:195]
    ds_read_b128 a[132:135], v2 offset:1024
    v_or3_b32 v12, v12, v212, v213
    v_mfma_f32_16x16x32_bf16 v[200:203], a[136:139], v[136:139], v[200:203]
    ds_read_b128 a[136:139], v2 offset:2048
    v_cvt_pk_bf16_f32 v214, v8, v9
    v_mfma_f32_16x16x32_bf16 v[176:179], a[140:143], v[92:95], v[176:179]
    v_exp_f32 v10, v158
    v_mfma_f32_16x16x32_bf16 v[184:187], a[140:143], v[108:111], v[184:187]
    v_exp_f32 v11, v159
    v_mfma_f32_16x16x32_bf16 v[192:195], a[140:143], v[124:127], v[192:195]
    v_exp_f32 v4, v144
    v_mfma_f32_16x16x32_bf16 v[200:203], a[140:143], v[140:143], v[200:203]
    s_waitcnt lgkmcnt(11)
    ds_read_b128 a[140:143], v2 offset:3072
    v_cvt_pk_bf16_f32 v215, v10, v11
    v_mfma_f32_16x16x32_bf16 v[180:183], a[144:147], v[80:83], v[64:67]
    v_exp_f32 v5, v145
    v_mfma_f32_16x16x32_bf16 v[188:191], a[144:147], v[96:99], v[68:71]
    v_exp_f32 v6, v146
    v_mfma_f32_16x16x32_bf16 v[196:199], a[144:147], v[112:115], v[72:75]
    v_exp_f32 v7, v147
    v_mfma_f32_16x16x32_bf16 v[204:207], a[144:147], v[128:131], v[76:79]
    ds_read_b128 a[144:147], v2 offset:4096
    v_or3_b32 v12, v12, v214, v215
    v_mfma_f32_16x16x32_bf16 v[180:183], a[148:151], v[84:87], v[180:183]
    buffer_load_dword a200, v19, s[8:11], s46 offen
    v_mfma_f32_16x16x32_bf16 v[188:191], a[148:151], v[100:103], v[188:191]
    v_exp_f32 v8, v148
    v_mfma_f32_16x16x32_bf16 v[196:199], a[148:151], v[116:119], v[196:199]
    v_exp_f32 v9, v149
    v_mfma_f32_16x16x32_bf16 v[204:207], a[148:151], v[132:135], v[204:207]
    ds_read_b128 a[148:151], v2 offset:5120
    v_cvt_pk_bf16_f32 v208, v4, v5
    v_mfma_f32_16x16x32_bf16 v[180:183], a[152:155], v[88:91], v[180:183]
    v_exp_f32 v10, v150
    v_mfma_f32_16x16x32_bf16 v[188:191], a[152:155], v[104:107], v[188:191]
    v_exp_f32 v11, v151
    v_mfma_f32_16x16x32_bf16 v[196:199], a[152:155], v[120:123], v[196:199]
    v_cvt_pk_bf16_f32 v209, v6, v7
    v_or3_b32 v12, v12, v208, v209
    v_mfma_f32_16x16x32_bf16 v[204:207], a[152:155], v[136:139], v[204:207]
    ds_read_b128 a[152:155], v2 offset:6144
    v_cvt_pk_bf16_f32 v210, v8, v9
    v_mfma_f32_16x16x32_bf16 v[180:183], a[156:159], v[92:95], v[180:183]
    v_cvt_pk_bf16_f32 v211, v10, v11
    v_or3_b32 v12, v12, v210, v211
    v_mfma_f32_16x16x32_bf16 v[188:191], a[156:159], v[108:111], v[188:191]
    v_and_b32 v12, s42, v12
    v_cmp_ne_u32 vcc, 0, v12
    v_mfma_f32_16x16x32_bf16 v[196:199], a[156:159], v[124:127], v[196:199]
    s_waitcnt lgkmcnt(11)
    v_mfma_f32_16x16x32_bf16 v[204:207], a[156:159], v[140:143], v[204:207]
    s_cbranch_vccnz gated_mix__ssm_conv_h3__compressed_kv_cla__prompt_kernel_b4_r0
gated_mix__ssm_conv_h3__compressed_kv_cla__prompt_kernel_b4_r0_ret:
    ds_read_b128 a[156:159], v2 offset:7168
    v_mfma_f32_16x16x32_bf16 a[0:3], a[160:163], v[208:211], a[0:3]
    v_mfma_f32_16x16x32_bf16 a[32:35], a[160:163], v[212:215], a[32:35]
    v_mfma_f32_16x16x32_bf16 a[64:67], a[160:163], v[216:219], a[64:67]
    buffer_load_dwordx4 v16, s[12:15], s38 offen offset:0 sc1 lds
    v_mfma_f32_16x16x32_bf16 a[96:99], a[160:163], v[220:223], a[96:99]
    s_cmp_eq_u32 s35, 1
    ds_read_b128 a[160:163], v3 offset:24576
    v_mfma_f32_16x16x32_bf16 a[4:7], a[164:167], v[208:211], a[4:7]
    s_cbranch_scc1 gated_mix__ssm_conv_h3__compressed_kv_cla__prompt_kernel_b4_m1
gated_mix__ssm_conv_h3__compressed_kv_cla__prompt_kernel_b4_m1_ret:
    v_mfma_f32_16x16x32_bf16 a[36:39], a[164:167], v[212:215], a[36:39]
    v_mfma_f32_16x16x32_bf16 a[68:71], a[164:167], v[216:219], a[68:71]
    v_mfma_f32_16x16x32_bf16 a[100:103], a[164:167], v[220:223], a[100:103]
    ds_read_b128 a[164:167], v3 offset:25600
    v_mfma_f32_16x16x32_bf16 a[8:11], a[168:171], v[208:211], a[8:11]
    v_mfma_f32_16x16x32_bf16 a[40:43], a[168:171], v[212:215], a[40:43]
    v_mfma_f32_16x16x32_bf16 a[72:75], a[168:171], v[216:219], a[72:75]
    v_exp_f32 v4, v200
    v_mfma_f32_16x16x32_bf16 a[104:107], a[168:171], v[220:223], a[104:107]
    ds_read_b128 a[168:171], v3 offset:26624
    v_mfma_f32_16x16x32_bf16 a[12:15], a[172:175], v[208:211], a[12:15]
    v_exp_f32 v5, v201
    v_mfma_f32_16x16x32_bf16 a[44:47], a[172:175], v[212:215], a[44:47]
    v_exp_f32 v6, v202
    v_mfma_f32_16x16x32_bf16 a[76:79], a[172:175], v[216:219], a[76:79]
    v_exp_f32 v7, v203
    v_mfma_f32_16x16x32_bf16 a[108:111], a[172:175], v[220:223], a[108:111]
    s_waitcnt lgkmcnt(11)
    ds_read_b128 a[172:175], v3 offset:27648
    v_cvt_pk_bf16_f32 v236, v4, v5
    v_mfma_f32_16x16x32_bf16 a[16:19], a[176:179], v[208:211], a[16:19]
    buffer_load_dwordx4 v16, s[12:15], s38 offen offset:1024 sc1 lds
    v_mfma_f32_16x16x32_bf16 a[48:51], a[176:179], v[212:215], a[48:51]
    v_exp_f32 v8, v204
    v_mfma_f32_16x16x32_bf16 a[80:83], a[176:179], v[216:219], a[80:83]
    v_exp_f32 v9, v205
    v_mfma_f32_16x16x32_bf16 a[112:115], a[176:179], v[220:223], a[112:115]
    ds_read_b128 a[176:179], v3 offset:28672
    v_cvt_pk_bf16_f32 v237, v6, v7
    v_mfma_f32_16x16x32_bf16 a[20:23], a[180:183], v[208:211], a[20:23]
    v_exp_f32 v10, v206
    v_mfma_f32_16x16x32_bf16 a[52:55], a[180:183], v[212:215], a[52:55]
    v_exp_f32 v11, v207
    v_mfma_f32_16x16x32_bf16 a[84:87], a[180:183], v[216:219], a[84:87]
    v_exp_f32 v4, v192
    v_mfma_f32_16x16x32_bf16 a[116:119], a[180:183], v[220:223], a[116:119]
    ds_read_b128 a[180:183], v3 offset:29696
    v_or_b32 v12, v236, v237
    v_mfma_f32_16x16x32_bf16 a[24:27], a[184:187], v[208:211], a[24:27]
    v_exp_f32 v5, v193
    v_mfma_f32_16x16x32_bf16 a[56:59], a[184:187], v[212:215], a[56:59]
    v_exp_f32 v6, v194
    v_mfma_f32_16x16x32_bf16 a[88:91], a[184:187], v[216:219], a[88:91]
    v_exp_f32 v7, v195
    v_mfma_f32_16x16x32_bf16 a[120:123], a[184:187], v[220:223], a[120:123]
    ds_read_b128 a[184:187], v3 offset:30720
    v_cvt_pk_bf16_f32 v238, v8, v9
    v_mfma_f32_16x16x32_bf16 a[28:31], a[188:191], v[208:211], a[28:31]
    v_exp_f32 v8, v196
    v_mfma_f32_16x16x32_bf16 a[60:63], a[188:191], v[212:215], a[60:63]
    v_exp_f32 v9, v197
    v_mfma_f32_16x16x32_bf16 a[92:95], a[188:191], v[216:219], a[92:95]
    buffer_load_dwordx4 v16, s[12:15], s38 offen offset:2048 sc1 lds
    v_mfma_f32_16x16x32_bf16 a[124:127], a[188:191], v[220:223], a[124:127]
    ds_read_b128 a[188:191], v3 offset:31744
    v_cvt_pk_bf16_f32 v239, v10, v11
    v_mfma_f32_16x16x32_bf16 v[240:243], v[24:27], v[208:211], v[240:243]
    v_exp_f32 v10, v198
    v_mfma_f32_16x16x32_bf16 v[244:247], v[24:27], v[212:215], v[244:247]
    v_exp_f32 v11, v199
    v_mfma_f32_16x16x32_bf16 v[248:251], v[24:27], v[216:219], v[248:251]
    v_or3_b32 v12, v12, v238, v239
    v_cvt_pk_bf16_f32 v232, v4, v5
    v_mfma_f32_16x16x32_bf16 v[252:255], v[24:27], v[220:223], v[252:255]
    s_waitcnt lgkmcnt(12)
    v_exp_f32 v4, v184
    v_mfma_f32_16x16x32_bf16 v[144:147], a[128:131], v[80:83], v[64:67]
    v_exp_f32 v5, v185
    v_mfma_f32_16x16x32_bf16 v[152:155], a[128:131], v[96:99], v[68:71]
    v_cvt_pk_bf16_f32 v233, v6, v7
    v_or3_b32 v12, v12, v232, v233
    v_mfma_f32_16x16x32_bf16 v[160:163], a[128:131], v[112:115], v[72:75]
    v_exp_f32 v6, v186
    v_mfma_f32_16x16x32_bf16 v[168:171], a[128:131], v[128:131], v[76:79]
    ds_read_b128 a[128:131], v2 offset:16384
    v_cvt_pk_bf16_f32 v234, v8, v9
    v_mfma_f32_16x16x32_bf16 v[144:147], a[132:135], v[84:87], v[144:147]
    v_exp_f32 v7, v187
    v_mfma_f32_16x16x32_bf16 v[152:155], a[132:135], v[100:103], v[152:155]
    v_exp_f32 v8, v188
    v_mfma_f32_16x16x32_bf16 v[160:163], a[132:135], v[116:119], v[160:163]
    v_exp_f32 v9, v189
    v_mfma_f32_16x16x32_bf16 v[168:171], a[132:135], v[132:135], v[168:171]
    ds_read_b128 a[132:135], v2 offset:17408
    v_cvt_pk_bf16_f32 v235, v10, v11
    v_mfma_f32_16x16x32_bf16 v[144:147], a[136:139], v[88:91], v[144:147]
    v_exp_f32 v10, v190
    v_mfma_f32_16x16x32_bf16 v[152:155], a[136:139], v[104:107], v[152:155]
    buffer_load_dwordx4 v16, s[12:15], s38 offen offset:3072 sc1 lds
    v_mfma_f32_16x16x32_bf16 v[160:163], a[136:139], v[120:123], v[160:163]
    s_mov_b32 m0, s41
    v_exp_f32 v11, v191
    v_mfma_f32_16x16x32_bf16 v[168:171], a[136:139], v[136:139], v[168:171]
    ds_read_b128 a[136:139], v2 offset:18432
    v_or3_b32 v12, v12, v234, v235
    v_mfma_f32_16x16x32_bf16 v[144:147], a[140:143], v[92:95], v[144:147]
    v_cvt_pk_bf16_f32 v228, v4, v5
    v_cvt_pk_bf16_f32 v229, v6, v7
    v_mfma_f32_16x16x32_bf16 v[152:155], a[140:143], v[108:111], v[152:155]
    v_exp_f32 v4, v176
    v_mfma_f32_16x16x32_bf16 v[160:163], a[140:143], v[124:127], v[160:163]
    v_exp_f32 v5, v177
    v_mfma_f32_16x16x32_bf16 v[168:171], a[140:143], v[140:143], v[168:171]
    s_waitcnt lgkmcnt(11)
    ds_read_b128 a[140:143], v2 offset:19456
    v_or3_b32 v12, v12, v228, v229
    v_mfma_f32_16x16x32_bf16 v[148:151], a[144:147], v[80:83], v[64:67]
    v_exp_f32 v6, v178
    v_mfma_f32_16x16x32_bf16 v[156:159], a[144:147], v[96:99], v[68:71]
    v_exp_f32 v7, v179
    v_mfma_f32_16x16x32_bf16 v[164:167], a[144:147], v[112:115], v[72:75]
    v_cvt_pk_bf16_f32 v230, v8, v9
    v_cvt_pk_bf16_f32 v231, v10, v11
    v_mfma_f32_16x16x32_bf16 v[172:175], a[144:147], v[128:131], v[76:79]
    ds_read_b128 a[144:147], v2 offset:20480
    v_or3_b32 v12, v12, v230, v231
    v_mfma_f32_16x16x32_bf16 v[148:151], a[148:151], v[84:87], v[148:151]
    v_exp_f32 v8, v180
    v_mfma_f32_16x16x32_bf16 v[156:159], a[148:151], v[100:103], v[156:159]
    v_exp_f32 v9, v181
    v_mfma_f32_16x16x32_bf16 v[164:167], a[148:151], v[116:119], v[164:167]
    buffer_load_dwordx4 v16, s[12:15], s43 offen offset:0 sc1 lds
    v_mfma_f32_16x16x32_bf16 v[172:175], a[148:151], v[132:135], v[172:175]
    ds_read_b128 a[148:151], v2 offset:21504
    v_cvt_pk_bf16_f32 v224, v4, v5
    v_mfma_f32_16x16x32_bf16 v[148:151], a[152:155], v[88:91], v[148:151]
    v_exp_f32 v10, v182
    v_mfma_f32_16x16x32_bf16 v[156:159], a[152:155], v[104:107], v[156:159]
    v_exp_f32 v11, v183
    v_mfma_f32_16x16x32_bf16 v[164:167], a[152:155], v[120:123], v[164:167]
    v_cvt_pk_bf16_f32 v225, v6, v7
    v_or3_b32 v12, v12, v224, v225
    v_mfma_f32_16x16x32_bf16 v[172:175], a[152:155], v[136:139], v[172:175]
    ds_read_b128 a[152:155], v2 offset:22528
    v_cvt_pk_bf16_f32 v226, v8, v9
    v_mfma_f32_16x16x32_bf16 v[148:151], a[156:159], v[92:95], v[148:151]
    v_cvt_pk_bf16_f32 v227, v10, v11
    v_or3_b32 v12, v12, v226, v227
    v_mfma_f32_16x16x32_bf16 v[156:159], a[156:159], v[108:111], v[156:159]
    v_and_b32 v12, s42, v12
    v_cmp_ne_u32 vcc, 0, v12
    v_mfma_f32_16x16x32_bf16 v[164:167], a[156:159], v[124:127], v[164:167]
    s_waitcnt lgkmcnt(11)
    v_mfma_f32_16x16x32_bf16 v[172:175], a[156:159], v[140:143], v[172:175]
    s_cbranch_vccnz gated_mix__ssm_conv_h3__compressed_kv_cla__prompt_kernel_b4_r1
gated_mix__ssm_conv_h3__compressed_kv_cla__prompt_kernel_b4_r1_ret:
    ds_read_b128 a[156:159], v2 offset:23552
    v_mfma_f32_16x16x32_bf16 a[0:3], a[160:163], v[224:227], a[0:3]
    v_mfma_f32_16x16x32_bf16 a[32:35], a[160:163], v[228:231], a[32:35]
    s_add_u32 s38, s38, s44
    v_mfma_f32_16x16x32_bf16 a[64:67], a[160:163], v[232:235], a[64:67]
    s_add_u32 s40, s39, s59
    v_mfma_f32_16x16x32_bf16 a[96:99], a[160:163], v[236:239], a[96:99]
    s_add_u32 s41, s40, s50
    ds_read_b128 a[160:163], v2 offset:8192
    v_mfma_f32_16x16x32_bf16 a[4:7], a[164:167], v[224:227], a[4:7]
    s_mov_b32 s39, s45
    v_mfma_f32_16x16x32_bf16 a[36:39], a[164:167], v[228:231], a[36:39]
    buffer_load_dwordx4 v16, s[12:15], s43 offen offset:1024 sc1 lds
    v_mfma_f32_16x16x32_bf16 a[68:71], a[164:167], v[232:235], a[68:71]
    s_add_u32 s45, s45, 32768
    v_mfma_f32_16x16x32_bf16 a[100:103], a[164:167], v[236:239], a[100:103]
    s_cmp_eq_u32 s45, 163840
    ds_read_b128 a[164:167], v2 offset:9216
    v_mfma_f32_16x16x32_bf16 a[8:11], a[168:171], v[224:227], a[8:11]
    s_cselect_b32 s45, 0, s45
    v_mfma_f32_16x16x32_bf16 a[40:43], a[168:171], v[228:231], a[40:43]
    s_add_u32 s46, s46, 1048576
    v_exp_f32 v4, v168
    v_mfma_f32_16x16x32_bf16 a[72:75], a[168:171], v[232:235], a[72:75]
    s_sub_u32 s35, s35, 1
    v_exp_f32 v5, v169
    v_mfma_f32_16x16x32_bf16 a[104:107], a[168:171], v[236:239], a[104:107]
    s_sub_u32 s58, s58, 1
    ds_read_b128 a[168:171], v2 offset:10240
    v_mfma_f32_16x16x32_bf16 a[12:15], a[172:175], v[224:227], a[12:15]
    s_cmp_lg_u32 s58, 0
    v_exp_f32 v6, v170
    v_mfma_f32_16x16x32_bf16 a[44:47], a[172:175], v[228:231], a[44:47]
    v_exp_f32 v7, v171
    v_mfma_f32_16x16x32_bf16 a[76:79], a[172:175], v[232:235], a[76:79]
    v_exp_f32 v8, v172
    v_mfma_f32_16x16x32_bf16 a[108:111], a[172:175], v[236:239], a[108:111]
    s_waitcnt lgkmcnt(11)
    ds_read_b128 a[172:175], v2 offset:11264
    v_mfma_f32_16x16x32_bf16 a[16:19], a[176:179], v[224:227], a[16:19]
    v_exp_f32 v9, v173
    v_mfma_f32_16x16x32_bf16 a[48:51], a[176:179], v[228:231], a[48:51]
    v_exp_f32 v10, v174
    v_mfma_f32_16x16x32_bf16 a[80:83], a[176:179], v[232:235], a[80:83]
    v_exp_f32 v11, v175
    v_mfma_f32_16x16x32_bf16 a[112:115], a[176:179], v[236:239], a[112:115]
    buffer_load_dwordx4 v16, s[12:15], s43 offen offset:2048 sc1 lds
    v_mfma_f32_16x16x32_bf16 a[20:23], a[180:183], v[224:227], a[20:23]
    v_cvt_pk_bf16_f32 v220, v4, v5
    v_cvt_pk_bf16_f32 v221, v6, v7
    v_mfma_f32_16x16x32_bf16 a[52:55], a[180:183], v[228:231], a[52:55]
    v_exp_f32 v4, v160
    v_mfma_f32_16x16x32_bf16 a[84:87], a[180:183], v[232:235], a[84:87]
    v_exp_f32 v5, v161
    v_mfma_f32_16x16x32_bf16 a[116:119], a[180:183], v[236:239], a[116:119]
    v_exp_f32 v6, v162
    v_mfma_f32_16x16x32_bf16 a[24:27], a[184:187], v[224:227], a[24:27]
    v_exp_f32 v7, v163
    v_mfma_f32_16x16x32_bf16 a[56:59], a[184:187], v[228:231], a[56:59]
    v_or_b32 v12, v220, v221
    v_cvt_pk_bf16_f32 v222, v8, v9
    v_mfma_f32_16x16x32_bf16 a[88:91], a[184:187], v[232:235], a[88:91]
    v_exp_f32 v8, v164
    v_mfma_f32_16x16x32_bf16 a[120:123], a[184:187], v[236:239], a[120:123]
    v_exp_f32 v9, v165
    v_mfma_f32_16x16x32_bf16 a[28:31], a[188:191], v[224:227], a[28:31]
    v_cvt_pk_bf16_f32 v223, v10, v11
    v_or3_b32 v12, v12, v222, v223
    v_mfma_f32_16x16x32_bf16 a[60:63], a[188:191], v[228:231], a[60:63]
    v_exp_f32 v10, v166
    v_mfma_f32_16x16x32_bf16 a[92:95], a[188:191], v[232:235], a[92:95]
    v_exp_f32 v11, v167
    v_mfma_f32_16x16x32_bf16 a[124:127], a[188:191], v[236:239], a[124:127]
    v_cvt_pk_bf16_f32 v216, v4, v5
    v_cvt_pk_bf16_f32 v217, v6, v7
    v_mfma_f32_16x16x32_bf16 v[240:243], v[24:27], v[224:227], v[240:243]
    v_or3_b32 v12, v12, v216, v217
    v_cvt_pk_bf16_f32 v218, v8, v9
    v_mfma_f32_16x16x32_bf16 v[244:247], v[24:27], v[228:231], v[244:247]
    v_cvt_pk_bf16_f32 v219, v10, v11
    v_or3_b32 v12, v12, v218, v219
    v_mfma_f32_16x16x32_bf16 v[248:251], v[24:27], v[232:235], v[248:251]
    buffer_load_dwordx4 v16, s[12:15], s43 offen offset:3072 sc1 lds
    v_mfma_f32_16x16x32_bf16 v[252:255], v[24:27], v[236:239], v[252:255]
    s_waitcnt lgkmcnt(8)
    v_mov_b32 v3, v2
    v_add_u32 v2, s45, v16
    s_cbranch_scc1 gated_mix__ssm_conv_h3__compressed_kv_cla__prompt_kernel_b4_loop
    s_cmp_lg_u32 s35, 0
    s_cbranch_scc1 gated_mix__ssm_conv_h3__compressed_kv_cla__prompt_kernel_b4_sw
    s_add_u32 s24, s94, 67108864
    s_addc_u32 s25, s95, 0
    s_mov_b32 s26, 8388608
    s_lshl_b32 s46, s2, 2
    s_add_u32 s46, s46, s32
    s_lshl_b32 s46, s46, 13
    s_nop 4
    v_accvgpr_read_b32 v36, a0
    v_accvgpr_read_b32 v37, a1
    v_accvgpr_read_b32 v38, a2
    v_accvgpr_read_b32 v39, a3
    v_accvgpr_read_b32 v40, a4
    v_accvgpr_read_b32 v41, a5
    v_accvgpr_read_b32 v42, a6
    v_accvgpr_read_b32 v43, a7
    v_rcp_f32 v32, v240
    s_nop 0
    v_mul_f32 v36, v36, v32
    v_mul_f32 v37, v37, v32
    v_mul_f32 v38, v38, v32
    v_mul_f32 v39, v39, v32
    v_mul_f32 v40, v40, v32
    v_mul_f32 v41, v41, v32
    v_mul_f32 v42, v42, v32
    v_mul_f32 v43, v43, v32
    v_cvt_pk_bf16_f32 v44, v36, v37
    v_cvt_pk_bf16_f32 v45, v38, v39
    v_cvt_pk_bf16_f32 v46, v40, v41
    v_cvt_pk_bf16_f32 v47, v42, v43
    buffer_store_dwordx4 v[44:47], v16, s[16:19], s60 offen offset:0 sc1
    v_accvgpr_read_b32 v36, a8
    v_accvgpr_read_b32 v37, a9
    v_accvgpr_read_b32 v38, a10
    v_accvgpr_read_b32 v39, a11
gated_mix__ssm_conv_h3__compressed_kv_cla__prompt_kernel_pad9:
    s_cbranch_execz gated_mix__ssm_conv_h3__compressed_kv_cla__prompt_kernel_pad13
    v_accvgpr_read_b32 v40, a12
    v_accvgpr_read_b32 v41, a13
    v_accvgpr_read_b32 v42, a14
    v_accvgpr_read_b32 v43, a15
    v_mul_f32 v36, v36, v32
    v_mul_f32 v37, v37, v32
    v_mul_f32 v38, v38, v32
    v_mul_f32 v39, v39, v32
    v_mul_f32 v40, v40, v32
    v_mul_f32 v41, v41, v32
    v_mul_f32 v42, v42, v32
    v_mul_f32 v43, v43, v32
    v_cvt_pk_bf16_f32 v20, v36, v37
    v_cvt_pk_bf16_f32 v21, v38, v39
    v_cvt_pk_bf16_f32 v22, v40, v41
    v_cvt_pk_bf16_f32 v23, v42, v43
    buffer_store_dwordx4 v[20:23], v16, s[16:19], s60 offen offset:1024 sc1
    v_accvgpr_read_b32 v36, a16
    v_accvgpr_read_b32 v37, a17
    v_accvgpr_read_b32 v38, a18
    v_accvgpr_read_b32 v39, a19
    v_accvgpr_read_b32 v40, a20
    v_accvgpr_read_b32 v41, a21
    v_accvgpr_read_b32 v42, a22
    v_accvgpr_read_b32 v43, a23
    v_mul_f32 v36, v36, v32
    v_mul_f32 v37, v37, v32
    v_mul_f32 v38, v38, v32
    v_mul_f32 v39, v39, v32
    v_mul_f32 v40, v40, v32
    v_mul_f32 v41, v41, v32
    v_mul_f32 v42, v42, v32
    v_mul_f32 v43, v43, v32
    v_cvt_pk_bf16_f32 v44, v36, v37
    v_cvt_pk_bf16_f32 v45, v38, v39
    v_cvt_pk_bf16_f32 v46, v40, v41
    v_cvt_pk_bf16_f32 v47, v42, v43
    buffer_store_dwordx4 v[44:47], v16, s[16:19], s60 offen offset:2048 sc1
    v_accvgpr_read_b32 v36, a24
    v_accvgpr_read_b32 v37, a25
    v_accvgpr_read_b32 v38, a26
    v_accvgpr_read_b32 v39, a27
    v_accvgpr_read_b32 v40, a28
    v_accvgpr_read_b32 v41, a29
    v_accvgpr_read_b32 v42, a30
    v_accvgpr_read_b32 v43, a31
    v_mul_f32 v36, v36, v32
    v_mul_f32 v37, v37, v32
    v_mul_f32 v38, v38, v32
    v_mul_f32 v39, v39, v32
    v_mul_f32 v40, v40, v32
    v_mul_f32 v41, v41, v32
    v_mul_f32 v42, v42, v32
    v_mul_f32 v43, v43, v32
    v_cvt_pk_bf16_f32 v20, v36, v37
    v_cvt_pk_bf16_f32 v21, v38, v39
    v_cvt_pk_bf16_f32 v22, v40, v41
    v_cvt_pk_bf16_f32 v23, v42, v43
    buffer_store_dwordx4 v[20:23], v16, s[16:19], s60 offen offset:3072 sc1
    v_mfma_f32_16x16x32_bf16 v[184:187], a[128:131], v[96:99], v[68:71]
    ds_read_b128 a[176:179], v3 offset:12288
    ds_read_b128 a[180:183], v3 offset:13312
    v_mfma_f32_16x16x32_bf16 v[192:195], a[128:131], v[112:115], v[72:75]
    v_mov_b32 v20, -1
    v_mov_b32 v21, -1
    v_mfma_f32_16x16x32_bf16 v[200:203], a[128:131], v[128:131], v[76:79]
    s_waitcnt vmcnt(16)
    ds_read_b128 a[184:187], v3 offset:14336
    v_mov_b32 v22, -1
    v_mfma_f32_16x16x32_bf16 v[184:187], a[132:135], v[100:103], v[184:187]
    s_barrier
    ds_read_b128 a[188:191], v3 offset:15360
    v_mov_b32 v23, -1
    v_mfma_f32_16x16x32_bf16 v[192:195], a[132:135], v[116:119], v[192:195]
    s_mov_b32 m0, s40
    v_add_f32 v152, v48, v152
    v_add_f32 v153, v49, v153
    v_mfma_f32_16x16x32_bf16 v[200:203], a[132:135], v[132:135], v[200:203]
    s_add_u32 s43, s38, s49
    v_add_f32 v154, v50, v154
    v_add_f32 v155, v51, v155
    v_mfma_f32_16x16x32_bf16 v[184:187], a[136:139], v[104:107], v[184:187]
    v_add_f32 v156, v52, v156
    v_add_f32 v157, v53, v157
    v_mfma_f32_16x16x32_bf16 v[192:195], a[136:139], v[120:123], v[192:195]
    v_add_f32 v158, v54, v158
    v_add_f32 v159, v55, v159
    v_mfma_f32_16x16x32_bf16 v[200:203], a[136:139], v[136:139], v[200:203]
    v_exp_f32 v4, v152
    v_mfma_f32_16x16x32_bf16 v[184:187], a[140:143], v[108:111], v[184:187]
    v_exp_f32 v5, v153
    v_mfma_f32_16x16x32_bf16 v[192:195], a[140:143], v[124:127], v[192:195]
    v_exp_f32 v6, v154
    v_mfma_f32_16x16x32_bf16 v[200:203], a[140:143], v[140:143], v[200:203]
    s_waitcnt lgkmcnt(8)
    v_exp_f32 v7, v155
    v_mfma_f32_16x16x32_bf16 v[188:191], a[144:147], v[96:99], v[68:71]
    v_exp_f32 v8, v156
    v_mfma_f32_16x16x32_bf16 v[196:199], a[144:147], v[112:115], v[72:75]
    buffer_store_dwordx4 v[20:23], v16, s[24:27], s46 offen offset:0 sc1
    v_mfma_f32_16x16x32_bf16 v[204:207], a[144:147], v[128:131], v[76:79]
    v_exp_f32 v9, v157
    v_mfma_f32_16x16x32_bf16 v[188:191], a[148:151], v[100:103], v[188:191]
    v_exp_f32 v10, v158
    v_mfma_f32_16x16x32_bf16 v[196:199], a[148:151], v[116:119], v[196:199]
    v_exp_f32 v11, v159
    v_mfma_f32_16x16x32_bf16 v[204:207], a[148:151], v[132:135], v[204:207]
    v_cvt_pk_bf16_f32 v212, v4, v5
    v_cvt_pk_bf16_f32 v213, v6, v7
    v_mfma_f32_16x16x32_bf16 v[188:191], a[152:155], v[104:107], v[188:191]
    v_or3_b32 v12, v12, v212, v213
    v_cvt_pk_bf16_f32 v214, v8, v9
    v_mfma_f32_16x16x32_bf16 v[196:199], a[152:155], v[120:123], v[196:199]
    v_cvt_pk_bf16_f32 v215, v10, v11
    v_or3_b32 v12, v12, v214, v215
    v_mfma_f32_16x16x32_bf16 v[204:207], a[152:155], v[136:139], v[204:207]
    v_and_b32 v12, s42, v12
    v_cmp_ne_u32 vcc, 0, v12
    v_mfma_f32_16x16x32_bf16 v[188:191], a[156:159], v[108:111], v[188:191]
    buffer_store_dwordx4 v[20:23], v16, s[24:27], s46 offen offset:1024 sc1
    v_mfma_f32_16x16x32_bf16 v[196:199], a[156:159], v[124:127], v[196:199]
    s_waitcnt lgkmcnt(4)
    ds_read_b128 a[128:131], v2 offset:0
    ds_read_b128 a[132:135], v2 offset:1024
    v_mfma_f32_16x16x32_bf16 v[204:207], a[156:159], v[140:143], v[204:207]
    s_cbranch_vccnz gated_mix__ssm_conv_h3__compressed_kv_cla__prompt_kernel_b3_r0
gated_mix__ssm_conv_h3__compressed_kv_cla__prompt_kernel_b3_r0_ret:
    ds_read_b128 a[136:139], v2 offset:2048
    ds_read_b128 a[140:143], v2 offset:3072
    v_mfma_f32_16x16x32_bf16 a[32:35], a[160:163], v[212:215], a[32:35]
    ds_read_b128 a[144:147], v2 offset:4096
    ds_read_b128 a[148:151], v2 offset:5120
    v_mfma_f32_16x16x32_bf16 a[64:67], a[160:163], v[216:219], a[64:67]
    ds_read_b128 a[152:155], v2 offset:6144
    ds_read_b128 a[156:159], v2 offset:7168
    v_mfma_f32_16x16x32_bf16 a[96:99], a[160:163], v[220:223], a[96:99]
    v_exp_f32 v4, v200
    v_mfma_f32_16x16x32_bf16 a[36:39], a[164:167], v[212:215], a[36:39]
    v_exp_f32 v5, v201
    v_mfma_f32_16x16x32_bf16 a[68:71], a[164:167], v[216:219], a[68:71]
    v_exp_f32 v6, v202
    v_mfma_f32_16x16x32_bf16 a[100:103], a[164:167], v[220:223], a[100:103]
    buffer_store_dwordx4 v[20:23], v16, s[24:27], s46 offen offset:2048 sc1
    v_mfma_f32_16x16x32_bf16 a[40:43], a[168:171], v[212:215], a[40:43]
    v_exp_f32 v7, v203
    v_mfma_f32_16x16x32_bf16 a[72:75], a[168:171], v[216:219], a[72:75]
    ds_read_b128 a[160:163], v3 offset:24576
    v_cvt_pk_bf16_f32 v236, v4, v5
    v_mfma_f32_16x16x32_bf16 a[104:107], a[168:171], v[220:223], a[104:107]
    v_exp_f32 v8, v204
    v_mfma_f32_16x16x32_bf16 a[44:47], a[172:175], v[212:215], a[44:47]
    v_exp_f32 v9, v205
    v_mfma_f32_16x16x32_bf16 a[76:79], a[172:175], v[216:219], a[76:79]
    ds_read_b128 a[164:167], v3 offset:25600
    v_cvt_pk_bf16_f32 v237, v6, v7
    v_mfma_f32_16x16x32_bf16 a[108:111], a[172:175], v[220:223], a[108:111]
    s_waitcnt lgkmcnt(10)
    ds_read_b128 a[168:171], v3 offset:26624
    v_or_b32 v12, v236, v237
    v_mfma_f32_16x16x32_bf16 a[48:51], a[176:179], v[212:215], a[48:51]
    v_exp_f32 v10, v206
    v_mfma_f32_16x16x32_bf16 a[80:83], a[176:179], v[216:219], a[80:83]
    buffer_store_dwordx4 v[20:23], v16, s[24:27], s46 offen offset:3072 sc1
    v_mfma_f32_16x16x32_bf16 a[112:115], a[176:179], v[220:223], a[112:115]
    v_exp_f32 v11, v207
    v_mfma_f32_16x16x32_bf16 a[52:55], a[180:183], v[212:215], a[52:55]
    ds_read_b128 a[172:175], v3 offset:27648
    v_cvt_pk_bf16_f32 v238, v8, v9
    v_mfma_f32_16x16x32_bf16 a[84:87], a[180:183], v[216:219], a[84:87]
    v_exp_f32 v4, v192
    v_mfma_f32_16x16x32_bf16 a[116:119], a[180:183], v[220:223], a[116:119]
    v_exp_f32 v5, v193
    v_mfma_f32_16x16x32_bf16 a[56:59], a[184:187], v[212:215], a[56:59]
    ds_read_b128 a[176:179], v3 offset:28672
    v_cvt_pk_bf16_f32 v239, v10, v11
    v_mfma_f32_16x16x32_bf16 a[88:91], a[184:187], v[216:219], a[88:91]
    ds_read_b128 a[180:183], v3 offset:29696
    v_or3_b32 v12, v12, v238, v239
    v_mfma_f32_16x16x32_bf16 a[120:123], a[184:187], v[220:223], a[120:123]
    v_exp_f32 v6, v194
    v_mfma_f32_16x16x32_bf16 a[60:63], a[188:191], v[212:215], a[60:63]
    buffer_load_dwordx4 v16, s[12:15], s38 offen offset:0 sc1 lds
    v_mfma_f32_16x16x32_bf16 a[92:95], a[188:191], v[216:219], a[92:95]
    v_exp_f32 v7, v195
    v_mfma_f32_16x16x32_bf16 a[124:127], a[188:191], v[220:223], a[124:127]
    v_exp_f32 v8, v196
    v_mfma_f32_16x16x32_bf16 v[244:247], v[24:27], v[212:215], v[244:247]
    v_exp_f32 v9, v197
    v_mfma_f32_16x16x32_bf16 v[248:251], v[24:27], v[216:219], v[248:251]
    v_exp_f32 v10, v198
    v_mfma_f32_16x16x32_bf16 v[252:255], v[24:27], v[220:223], v[252:255]
    s_waitcnt lgkmcnt(10)
    v_exp_f32 v11, v199
    v_mfma_f32_16x16x32_bf16 v[152:155], a[128:131], v[96:99], v[68:71]
    v_cvt_pk_bf16_f32 v232, v4, v5
    v_cvt_pk_bf16_f32 v233, v6, v7
    v_mfma_f32_16x16x32_bf16 v[160:163], a[128:131], v[112:115], v[72:75]
    v_or3_b32 v12, v12, v232, v233
    v_cvt_pk_bf16_f32 v234, v8, v9
    v_mfma_f32_16x16x32_bf16 v[168:171], a[128:131], v[128:131], v[76:79]
    buffer_load_dwordx4 v16, s[12:15], s38 offen offset:1024 sc1 lds
    v_mfma_f32_16x16x32_bf16 v[152:155], a[132:135], v[100:103], v[152:155]
    v_cvt_pk_bf16_f32 v235, v10, v11
    v_or3_b32 v12, v12, v234, v235
    v_mfma_f32_16x16x32_bf16 v[160:163], a[132:135], v[116:119], v[160:163]
    v_add_f32 v184, v56, v184
    v_add_f32 v185, v57, v185
    v_mfma_f32_16x16x32_bf16 v[168:171], a[132:135], v[132:135], v[168:171]
    v_add_f32 v186, v58, v186
    v_add_f32 v187, v59, v187
    v_mfma_f32_16x16x32_bf16 v[152:155], a[136:139], v[104:107], v[152:155]
    v_add_f32 v188, v60, v188
    v_add_f32 v189, v61, v189
    v_mfma_f32_16x16x32_bf16 v[160:163], a[136:139], v[120:123], v[160:163]
    v_add_f32 v190, v62, v190
    v_add_f32 v191, v63, v191
    v_mfma_f32_16x16x32_bf16 v[168:171], a[136:139], v[136:139], v[168:171]
    v_exp_f32 v4, v184
    v_mfma_f32_16x16x32_bf16 v[152:155], a[140:143], v[108:111], v[152:155]
    buffer_load_dwordx4 v16, s[12:15], s38 offen offset:2048 sc1 lds
    v_mfma_f32_16x16x32_bf16 v[160:163], a[140:143], v[124:127], v[160:163]
    v_exp_f32 v5, v185
    v_mfma_f32_16x16x32_bf16 v[168:171], a[140:143], v[140:143], v[168:171]
    s_waitcnt lgkmcnt(6)
    v_exp_f32 v6, v186
    v_mfma_f32_16x16x32_bf16 v[156:159], a[144:147], v[96:99], v[68:71]
    v_exp_f32 v7, v187
    v_mfma_f32_16x16x32_bf16 v[164:167], a[144:147], v[112:115], v[72:75]
    v_exp_f32 v8, v188
    v_mfma_f32_16x16x32_bf16 v[172:175], a[144:147], v[128:131], v[76:79]
    v_exp_f32 v9, v189
    v_mfma_f32_16x16x32_bf16 v[156:159], a[148:151], v[100:103], v[156:159]
    v_exp_f32 v10, v190
    v_mfma_f32_16x16x32_bf16 v[164:167], a[148:151], v[116:119], v[164:167]
    v_exp_f32 v11, v191
    v_mfma_f32_16x16x32_bf16 v[172:175], a[148:151], v[132:135], v[172:175]
    buffer_load_dwordx4 v16, s[12:15], s38 offen offset:3072 sc1 lds
    v_mfma_f32_16x16x32_bf16 v[156:159], a[152:155], v[104:107], v[156:159]
    s_mov_b32 m0, s41
    v_cvt_pk_bf16_f32 v228, v4, v5
    v_cvt_pk_bf16_f32 v229, v6, v7
    v_mfma_f32_16x16x32_bf16 v[164:167], a[152:155], v[120:123], v[164:167]
    v_or3_b32 v12, v12, v228, v229
    v_cvt_pk_bf16_f32 v230, v8, v9
    v_mfma_f32_16x16x32_bf16 v[172:175], a[152:155], v[136:139], v[172:175]
    v_cvt_pk_bf16_f32 v231, v10, v11
    v_or3_b32 v12, v12, v230, v231
    v_mfma_f32_16x16x32_bf16 v[156:159], a[156:159], v[108:111], v[156:159]
    v_and_b32 v12, s42, v12
    v_cmp_ne_u32 vcc, 0, v12
    v_mfma_f32_16x16x32_bf16 v[164:167], a[156:159], v[124:127], v[164:167]
    s_waitcnt lgkmcnt(2)
    ds_read_b128 a[184:187], v3 offset:30720
    ds_read_b128 a[188:191], v3 offset:31744
    v_mfma_f32_16x16x32_bf16 v[172:175], a[156:159], v[140:143], v[172:175]
    s_cbranch_vccnz gated_mix__ssm_conv_h3__compressed_kv_cla__prompt_kernel_b3_r1
gated_mix__ssm_conv_h3__compressed_kv_cla__prompt_kernel_b3_r1_ret:
    ds_read_b128 a[128:131], v2 offset:16384
    v_mfma_f32_16x16x32_bf16 a[32:35], a[160:163], v[228:231], a[32:35]
    ds_read_b128 a[132:135], v2 offset:17408
    v_mfma_f32_16x16x32_bf16 a[64:67], a[160:163], v[232:235], a[64:67]
    buffer_load_dwordx4 v16, s[12:15], s43 offen offset:0 sc1 lds
    v_mfma_f32_16x16x32_bf16 a[96:99], a[160:163], v[236:239], a[96:99]
    s_add_u32 s38, s38, s44
    ds_read_b128 a[136:139], v2 offset:18432
    v_mfma_f32_16x16x32_bf16 a[36:39], a[164:167], v[228:231], a[36:39]
    s_add_u32 s40, s39, s59
    ds_read_b128 a[140:143], v2 offset:19456
    v_mfma_f32_16x16x32_bf16 a[68:71], a[164:167], v[232:235], a[68:71]
    s_add_u32 s41, s40, s50
    ds_read_b128 a[144:147], v2 offset:20480
    v_mfma_f32_16x16x32_bf16 a[100:103], a[164:167], v[236:239], a[100:103]
    s_mov_b32 s39, s45
    ds_read_b128 a[148:151], v2 offset:21504
    v_mfma_f32_16x16x32_bf16 a[40:43], a[168:171], v[228:231], a[40:43]
    s_add_u32 s45, s45, 32768
    ds_read_b128 a[152:155], v2 offset:22528
    v_mfma_f32_16x16x32_bf16 a[72:75], a[168:171], v[232:235], a[72:75]
    s_cmp_eq_u32 s45, 163840
    ds_read_b128 a[156:159], v2 offset:23552
    v_mfma_f32_16x16x32_bf16 a[104:107], a[168:171], v[236:239], a[104:107]
    s_cselect_b32 s45, 0, s45
    ds_read_b128 a[160:163], v2 offset:8192
    v_mfma_f32_16x16x32_bf16 a[44:47], a[172:175], v[228:231], a[44:47]
    buffer_load_dwordx4 v16, s[12:15], s43 offen offset:1024 sc1 lds
    v_mfma_f32_16x16x32_bf16 a[76:79], a[172:175], v[232:235], a[76:79]
    ds_read_b128 a[164:167], v2 offset:9216
    v_mfma_f32_16x16x32_bf16 a[108:111], a[172:175], v[236:239], a[108:111]
    s_waitcnt lgkmcnt(10)
    ds_read_b128 a[168:171], v2 offset:10240
    v_mfma_f32_16x16x32_bf16 a[48:51], a[176:179], v[228:231], a[48:51]
    ds_read_b128 a[172:175], v2 offset:11264
    v_mfma_f32_16x16x32_bf16 a[80:83], a[176:179], v[232:235], a[80:83]
    v_exp_f32 v4, v168
    v_mfma_f32_16x16x32_bf16 a[112:115], a[176:179], v[236:239], a[112:115]
    v_exp_f32 v5, v169
    v_mfma_f32_16x16x32_bf16 a[52:55], a[180:183], v[228:231], a[52:55]
    v_exp_f32 v6, v170
    v_mfma_f32_16x16x32_bf16 a[84:87], a[180:183], v[232:235], a[84:87]
    v_exp_f32 v7, v171
    v_mfma_f32_16x16x32_bf16 a[116:119], a[180:183], v[236:239], a[116:119]
    buffer_load_dwordx4 v16, s[12:15], s43 offen offset:2048 sc1 lds
    v_mfma_f32_16x16x32_bf16 a[56:59], a[184:187], v[228:231], a[56:59]
    v_exp_f32 v8, v172
    v_mfma_f32_16x16x32_bf16 a[88:91], a[184:187], v[232:235], a[88:91]
    v_exp_f32 v9, v173
    v_mfma_f32_16x16x32_bf16 a[120:123], a[184:187], v[236:239], a[120:123]
    v_exp_f32 v10, v174
    v_mfma_f32_16x16x32_bf16 a[60:63], a[188:191], v[228:231], a[60:63]
    v_exp_f32 v11, v175
    v_mfma_f32_16x16x32_bf16 a[92:95], a[188:191], v[232:235], a[92:95]
    v_cvt_pk_bf16_f32 v220, v4, v5
    v_cvt_pk_bf16_f32 v221, v6, v7
    v_mfma_f32_16x16x32_bf16 a[124:127], a[188:191], v[236:239], a[124:127]
    v_or_b32 v12, v220, v221
    v_cvt_pk_bf16_f32 v222, v8, v9
    v_mfma_f32_16x16x32_bf16 v[244:247], v[24:27], v[228:231], v[244:247]
    v_cvt_pk_bf16_f32 v223, v10, v11
    v_or3_b32 v12, v12, v222, v223
    v_mfma_f32_16x16x32_bf16 v[248:251], v[24:27], v[232:235], v[248:251]
    buffer_load_dwordx4 v16, s[12:15], s43 offen offset:3072 sc1 lds
    v_mfma_f32_16x16x32_bf16 v[252:255], v[24:27], v[236:239], v[252:255]
    s_waitcnt lgkmcnt(8)
    v_mov_b32 v3, v2
    v_add_u32 v2, s45, v16
    s_nop 4
    v_accvgpr_read_b32 v36, a32
    v_accvgpr_read_b32 v37, a33
    v_accvgpr_read_b32 v38, a34
    v_accvgpr_read_b32 v39, a35
    v_accvgpr_read_b32 v40, a36
    v_accvgpr_read_b32 v41, a37
    v_accvgpr_read_b32 v42, a38
    v_accvgpr_read_b32 v43, a39
    v_rcp_f32 v32, v244
    s_nop 0
    v_mul_f32 v36, v36, v32
    v_mul_f32 v37, v37, v32
    v_mul_f32 v38, v38, v32
    v_mul_f32 v39, v39, v32
    v_mul_f32 v40, v40, v32
    v_mul_f32 v41, v41, v32
    v_mul_f32 v42, v42, v32
    v_mul_f32 v43, v43, v32
    v_cvt_pk_bf16_f32 v44, v36, v37
    v_cvt_pk_bf16_f32 v45, v38, v39
    v_cvt_pk_bf16_f32 v46, v40, v41
    v_cvt_pk_bf16_f32 v47, v42, v43
    buffer_store_dwordx4 v[44:47], v16, s[16:19], s61 offen offset:0 sc1
    v_accvgpr_read_b32 v36, a40
    v_accvgpr_read_b32 v37, a41
    v_accvgpr_read_b32 v38, a42
    v_accvgpr_read_b32 v39, a43
    v_accvgpr_read_b32 v40, a44
    v_accvgpr_read_b32 v41, a45
    v_accvgpr_read_b32 v42, a46
    v_accvgpr_read_b32 v43, a47
    v_mul_f32 v36, v36, v32
    v_mul_f32 v37, v37, v32
    v_mul_f32 v38, v38, v32
    v_mul_f32 v39, v39, v32
    v_mul_f32 v40, v40, v32
    v_mul_f32 v41, v41, v32
    v_mul_f32 v42, v42, v32
    v_mul_f32 v43, v43, v32
    v_cvt_pk_bf16_f32 v20, v36, v37
    v_cvt_pk_bf16_f32 v21, v38, v39
    v_cvt_pk_bf16_f32 v22, v40, v41
    v_cvt_pk_bf16_f32 v23, v42, v43
    buffer_store_dwordx4 v[20:23], v16, s[16:19], s61 offen offset:1024 sc1
    v_accvgpr_read_b32 v36, a48
    v_accvgpr_read_b32 v37, a49
    v_accvgpr_read_b32 v38, a50
    v_accvgpr_read_b32 v39, a51
    v_accvgpr_read_b32 v40, a52
    v_accvgpr_read_b32 v41, a53
    v_accvgpr_read_b32 v42, a54
    v_accvgpr_read_b32 v43, a55
    v_mul_f32 v36, v36, v32
    v_mul_f32 v37, v37, v32
    v_mul_f32 v38, v38, v32
    v_mul_f32 v39, v39, v32
    v_mul_f32 v40, v40, v32
    v_mul_f32 v41, v41, v32
    v_mul_f32 v42, v42, v32
    v_mul_f32 v43, v43, v32
    v_cvt_pk_bf16_f32 v44, v36, v37
    v_cvt_pk_bf16_f32 v45, v38, v39
    v_cvt_pk_bf16_f32 v46, v40, v41
    v_cvt_pk_bf16_f32 v47, v42, v43
    buffer_store_dwordx4 v[44:47], v16, s[16:19], s61 offen offset:2048 sc1
    v_accvgpr_read_b32 v36, a56
    v_accvgpr_read_b32 v37, a57
    v_accvgpr_read_b32 v38, a58
    v_accvgpr_read_b32 v39, a59
    v_accvgpr_read_b32 v40, a60
    v_accvgpr_read_b32 v41, a61
    v_accvgpr_read_b32 v42, a62
    v_accvgpr_read_b32 v43, a63
    v_mul_f32 v36, v36, v32
    v_mul_f32 v37, v37, v32
    v_mul_f32 v38, v38, v32
    v_mul_f32 v39, v39, v32
    v_mul_f32 v40, v40, v32
    v_mul_f32 v41, v41, v32
    v_mul_f32 v42, v42, v32
    v_mul_f32 v43, v43, v32
    v_cvt_pk_bf16_f32 v20, v36, v37
    v_cvt_pk_bf16_f32 v21, v38, v39
    v_cvt_pk_bf16_f32 v22, v40, v41
    v_cvt_pk_bf16_f32 v23, v42, v43
    buffer_store_dwordx4 v[20:23], v16, s[16:19], s61 offen offset:3072 sc1
    s_lshl_b32 s35, s34, 2
    s_sub_u32 s35, 29, s35
    s_sub_u32 s58, s35, 3
    s_cmp_eq_u32 s34, 7
    s_cselect_b32 s58, s35, s58
    s_nop 0
    s_nop 0
    s_nop 0
    s_nop 0
    s_nop 0
    s_nop 0
    s_nop 0
    s_nop 0
    s_nop 0
    s_nop 0
gated_mix__ssm_conv_h3__compressed_kv_cla__prompt_kernel_b2_loop:
    v_mfma_f32_16x16x32_bf16 v[192:195], a[128:131], v[112:115], v[72:75]
    s_cmp_eq_u32 s35, 1
    ds_read_b128 a[176:179], v3 offset:12288
    ds_read_b128 a[180:183], v3 offset:13312
    v_mfma_f32_16x16x32_bf16 v[200:203], a[128:131], v[128:131], v[76:79]
    s_cbranch_scc1 gated_mix__ssm_conv_h3__compressed_kv_cla__prompt_kernel_b2_m0
gated_mix__ssm_conv_h3__compressed_kv_cla__prompt_kernel_b2_m0_ret:
    ds_read_b128 a[184:187], v3 offset:14336
    v_exp_f32 v4, v160
    v_mfma_f32_16x16x32_bf16 v[192:195], a[132:135], v[116:119], v[192:195]
    s_waitcnt vmcnt(16)
    ds_read_b128 a[188:191], v3 offset:15360
    v_exp_f32 v5, v161
    v_mfma_f32_16x16x32_bf16 v[200:203], a[132:135], v[132:135], v[200:203]
    s_barrier
    ds_read_b128 a[128:131], v2 offset:0
    v_exp_f32 v6, v162
    v_mfma_f32_16x16x32_bf16 v[192:195], a[136:139], v[120:123], v[192:195]
    s_mov_b32 m0, s40
    v_exp_f32 v7, v163
    v_mfma_f32_16x16x32_bf16 v[200:203], a[136:139], v[136:139], v[200:203]
    s_add_u32 s43, s38, s49
    ds_read_b128 a[132:135], v2 offset:1024
    v_exp_f32 v8, v164
    v_mfma_f32_16x16x32_bf16 v[192:195], a[140:143], v[124:127], v[192:195]
    ds_read_b128 a[136:139], v2 offset:2048
    v_exp_f32 v9, v165
    v_mfma_f32_16x16x32_bf16 v[200:203], a[140:143], v[140:143], v[200:203]
    s_waitcnt lgkmcnt(11)
    ds_read_b128 a[140:143], v2 offset:3072
    v_exp_f32 v10, v166
    v_mfma_f32_16x16x32_bf16 v[196:199], a[144:147], v[112:115], v[72:75]
    v_exp_f32 v11, v167
    v_mfma_f32_16x16x32_bf16 v[204:207], a[144:147], v[128:131], v[76:79]
    v_cvt_pk_bf16_f32 v216, v4, v5
    v_cvt_pk_bf16_f32 v217, v6, v7
    v_mfma_f32_16x16x32_bf16 v[196:199], a[148:151], v[116:119], v[196:199]
    v_or3_b32 v12, v12, v216, v217
    v_cvt_pk_bf16_f32 v218, v8, v9
    v_mfma_f32_16x16x32_bf16 v[204:207], a[148:151], v[132:135], v[204:207]
    v_cvt_pk_bf16_f32 v219, v10, v11
    v_or3_b32 v12, v12, v218, v219
    v_mfma_f32_16x16x32_bf16 v[196:199], a[152:155], v[120:123], v[196:199]
    v_and_b32 v12, s42, v12
    v_cmp_ne_u32 vcc, 0, v12
    v_mfma_f32_16x16x32_bf16 v[204:207], a[152:155], v[136:139], v[204:207]
    buffer_load_dwordx4 v16, s[12:15], s38 offen offset:0 sc1 lds
    v_mfma_f32_16x16x32_bf16 v[196:199], a[156:159], v[124:127], v[196:199]
    s_waitcnt lgkmcnt(8)
    ds_read_b128 a[144:147], v2 offset:4096
    ds_read_b128 a[148:151], v2 offset:5120
    v_mfma_f32_16x16x32_bf16 v[204:207], a[156:159], v[140:143], v[204:207]
    s_cbranch_vccnz gated_mix__ssm_conv_h3__compressed_kv_cla__prompt_kernel_b2_r0
gated_mix__ssm_conv_h3__compressed_kv_cla__prompt_kernel_b2_r0_ret:
    ds_read_b128 a[152:155], v2 offset:6144
    ds_read_b128 a[156:159], v2 offset:7168
    v_mfma_f32_16x16x32_bf16 a[64:67], a[160:163], v[216:219], a[64:67]
    v_exp_f32 v4, v200
    v_mfma_f32_16x16x32_bf16 a[96:99], a[160:163], v[220:223], a[96:99]
    v_exp_f32 v5, v201
    v_mfma_f32_16x16x32_bf16 a[68:71], a[164:167], v[216:219], a[68:71]
    v_exp_f32 v6, v202
    v_mfma_f32_16x16x32_bf16 a[100:103], a[164:167], v[220:223], a[100:103]
    s_cmp_eq_u32 s35, 1
    ds_read_b128 a[160:163], v3 offset:24576
    ds_read_b128 a[164:167], v3 offset:25600
    v_mfma_f32_16x16x32_bf16 a[72:75], a[168:171], v[216:219], a[72:75]
    s_cbranch_scc1 gated_mix__ssm_conv_h3__compressed_kv_cla__prompt_kernel_b2_m1
gated_mix__ssm_conv_h3__compressed_kv_cla__prompt_kernel_b2_m1_ret:
    v_exp_f32 v7, v203
    v_mfma_f32_16x16x32_bf16 a[104:107], a[168:171], v[220:223], a[104:107]
    buffer_load_dwordx4 v16, s[12:15], s38 offen offset:1024 sc1 lds
    v_mfma_f32_16x16x32_bf16 a[76:79], a[172:175], v[216:219], a[76:79]
    ds_read_b128 a[168:171], v3 offset:26624
    v_cvt_pk_bf16_f32 v236, v4, v5
    v_mfma_f32_16x16x32_bf16 a[108:111], a[172:175], v[220:223], a[108:111]
    s_waitcnt lgkmcnt(11)
    ds_read_b128 a[172:175], v3 offset:27648
    v_cvt_pk_bf16_f32 v237, v6, v7
    v_mfma_f32_16x16x32_bf16 a[80:83], a[176:179], v[216:219], a[80:83]
    v_exp_f32 v8, v204
    v_mfma_f32_16x16x32_bf16 a[112:115], a[176:179], v[220:223], a[112:115]
    v_exp_f32 v9, v205
    v_mfma_f32_16x16x32_bf16 a[84:87], a[180:183], v[216:219], a[84:87]
    ds_read_b128 a[176:179], v3 offset:28672
    v_or_b32 v12, v236, v237
    v_mfma_f32_16x16x32_bf16 a[116:119], a[180:183], v[220:223], a[116:119]
    ds_read_b128 a[180:183], v3 offset:29696
    v_cvt_pk_bf16_f32 v238, v8, v9
    v_mfma_f32_16x16x32_bf16 a[88:91], a[184:187], v[216:219], a[88:91]
    buffer_load_dwordx4 v16, s[12:15], s38 offen offset:2048 sc1 lds
    v_mfma_f32_16x16x32_bf16 a[120:123], a[184:187], v[220:223], a[120:123]
    v_exp_f32 v10, v206
    v_mfma_f32_16x16x32_bf16 a[92:95], a[188:191], v[216:219], a[92:95]
    v_exp_f32 v11, v207
    v_mfma_f32_16x16x32_bf16 a[124:127], a[188:191], v[220:223], a[124:127]
    ds_read_b128 a[184:187], v3 offset:30720
    v_cvt_pk_bf16_f32 v239, v10, v11
    v_mfma_f32_16x16x32_bf16 v[248:251], v[24:27], v[216:219], v[248:251]
    v_exp_f32 v4, v192
    v_mfma_f32_16x16x32_bf16 v[252:255], v[24:27], v[220:223], v[252:255]
    s_waitcnt lgkmcnt(11)
    v_exp_f32 v5, v193
    v_mfma_f32_16x16x32_bf16 v[160:163], a[128:131], v[112:115], v[72:75]
    ds_read_b128 a[188:191], v3 offset:31744
    v_or3_b32 v12, v12, v238, v239
    v_mfma_f32_16x16x32_bf16 v[168:171], a[128:131], v[128:131], v[76:79]
    ds_read_b128 a[128:131], v2 offset:16384
    v_cvt_pk_bf16_f32 v232, v4, v5
    v_mfma_f32_16x16x32_bf16 v[160:163], a[132:135], v[116:119], v[160:163]
    buffer_load_dwordx4 v16, s[12:15], s38 offen offset:3072 sc1 lds
    v_mfma_f32_16x16x32_bf16 v[168:171], a[132:135], v[132:135], v[168:171]
    s_mov_b32 m0, s41
    v_exp_f32 v6, v194
    v_mfma_f32_16x16x32_bf16 v[160:163], a[136:139], v[120:123], v[160:163]
    v_exp_f32 v7, v195
    v_mfma_f32_16x16x32_bf16 v[168:171], a[136:139], v[136:139], v[168:171]
    ds_read_b128 a[132:135], v2 offset:17408
    v_cvt_pk_bf16_f32 v233, v6, v7
    v_mfma_f32_16x16x32_bf16 v[160:163], a[140:143], v[124:127], v[160:163]
    v_exp_f32 v8, v196
    v_mfma_f32_16x16x32_bf16 v[168:171], a[140:143], v[140:143], v[168:171]
    s_waitcnt lgkmcnt(10)
    v_exp_f32 v9, v197
    v_mfma_f32_16x16x32_bf16 v[164:167], a[144:147], v[112:115], v[72:75]
    v_exp_f32 v10, v198
    v_mfma_f32_16x16x32_bf16 v[172:175], a[144:147], v[128:131], v[76:79]
    buffer_load_dwordx4 v16, s[12:15], s43 offen offset:0 sc1 lds
    v_mfma_f32_16x16x32_bf16 v[164:167], a[148:151], v[116:119], v[164:167]
    v_exp_f32 v11, v199
    v_mfma_f32_16x16x32_bf16 v[172:175], a[148:151], v[132:135], v[172:175]
    v_or3_b32 v12, v12, v232, v233
    v_cvt_pk_bf16_f32 v234, v8, v9
    v_mfma_f32_16x16x32_bf16 v[164:167], a[152:155], v[120:123], v[164:167]
    v_cvt_pk_bf16_f32 v235, v10, v11
    v_or3_b32 v12, v12, v234, v235
    v_mfma_f32_16x16x32_bf16 v[172:175], a[152:155], v[136:139], v[172:175]
    s_cmp_eq_u32 s35, 1
    v_and_b32 v12, s42, v12
    v_cmp_ne_u32 vcc, 0, v12
    v_mfma_f32_16x16x32_bf16 v[164:167], a[156:159], v[124:127], v[164:167]
    s_waitcnt lgkmcnt(6)
    ds_read_b128 a[136:139], v2 offset:18432
    ds_read_b128 a[140:143], v2 offset:19456
    v_mfma_f32_16x16x32_bf16 v[172:175], a[156:159], v[140:143], v[172:175]
    s_cbranch_vccnz gated_mix__ssm_conv_h3__compressed_kv_cla__prompt_kernel_b2_r1
gated_mix__ssm_conv_h3__compressed_kv_cla__prompt_kernel_b2_r1_ret:
    ds_read_b128 a[144:147], v2 offset:20480
    ds_read_b128 a[148:151], v2 offset:21504
    v_mfma_f32_16x16x32_bf16 a[64:67], a[160:163], v[232:235], a[64:67]
    s_cbranch_scc1 gated_mix__ssm_conv_h3__compressed_kv_cla__prompt_kernel_b2_m2
gated_mix__ssm_conv_h3__compressed_kv_cla__prompt_kernel_b2_m2_ret:
    ds_read_b128 a[152:155], v2 offset:22528
    ds_read_b128 a[156:159], v2 offset:23552
    v_mfma_f32_16x16x32_bf16 a[96:99], a[160:163], v[236:239], a[96:99]
    buffer_load_dwordx4 v16, s[12:15], s43 offen offset:1024 sc1 lds
    v_mfma_f32_16x16x32_bf16 a[68:71], a[164:167], v[232:235], a[68:71]
    s_add_u32 s38, s38, s44
    v_exp_f32 v4, v168
    v_mfma_f32_16x16x32_bf16 a[100:103], a[164:167], v[236:239], a[100:103]
    s_add_u32 s40, s39, s59
    v_exp_f32 v5, v169
    v_mfma_f32_16x16x32_bf16 a[72:75], a[168:171], v[232:235], a[72:75]
    s_add_u32 s41, s40, s50
    v_exp_f32 v6, v170
    v_mfma_f32_16x16x32_bf16 a[104:107], a[168:171], v[236:239], a[104:107]
    s_mov_b32 s39, s45
    ds_read_b128 a[160:163], v2 offset:8192
    v_cvt_pk_bf16_f32 v220, v4, v5
    v_mfma_f32_16x16x32_bf16 a[76:79], a[172:175], v[232:235], a[76:79]
    s_add_u32 s45, s45, 32768
    v_exp_f32 v7, v171
    v_mfma_f32_16x16x32_bf16 a[108:111], a[172:175], v[236:239], a[108:111]
    s_waitcnt lgkmcnt(9)
    ds_read_b128 a[164:167], v2 offset:9216
    v_cvt_pk_bf16_f32 v221, v6, v7
    v_mfma_f32_16x16x32_bf16 a[80:83], a[176:179], v[232:235], a[80:83]
    buffer_load_dwordx4 v16, s[12:15], s43 offen offset:2048 sc1 lds
    v_mfma_f32_16x16x32_bf16 a[112:115], a[176:179], v[236:239], a[112:115]
    s_cmp_eq_u32 s45, 163840
    ds_read_b128 a[168:171], v2 offset:10240
    v_or_b32 v12, v220, v221
    v_mfma_f32_16x16x32_bf16 a[84:87], a[180:183], v[232:235], a[84:87]
    s_cselect_b32 s45, 0, s45
    v_exp_f32 v8, v172
    v_mfma_f32_16x16x32_bf16 a[116:119], a[180:183], v[236:239], a[116:119]
    s_sub_u32 s35, s35, 1
    v_exp_f32 v9, v173
    v_mfma_f32_16x16x32_bf16 a[88:91], a[184:187], v[232:235], a[88:91]
    s_sub_u32 s58, s58, 1
    v_exp_f32 v10, v174
    v_mfma_f32_16x16x32_bf16 a[120:123], a[184:187], v[236:239], a[120:123]
    s_cmp_lg_u32 s58, 0
    ds_read_b128 a[172:175], v2 offset:11264
    v_cvt_pk_bf16_f32 v222, v8, v9
    v_mfma_f32_16x16x32_bf16 a[92:95], a[188:191], v[232:235], a[92:95]
    v_exp_f32 v11, v175
    v_mfma_f32_16x16x32_bf16 a[124:127], a[188:191], v[236:239], a[124:127]
gated_mix__ssm_conv_h3__compressed_kv_cla__prompt_kernel_pad10:
    s_cbranch_execz gated_mix__ssm_conv_h3__compressed_kv_cla__prompt_kernel_pad14
    v_cvt_pk_bf16_f32 v223, v10, v11
    v_or3_b32 v12, v12, v222, v223
    v_mfma_f32_16x16x32_bf16 v[248:251], v[24:27], v[232:235], v[248:251]
    buffer_load_dwordx4 v16, s[12:15], s43 offen offset:3072 sc1 lds
    v_mfma_f32_16x16x32_bf16 v[252:255], v[24:27], v[236:239], v[252:255]
    s_waitcnt lgkmcnt(8)
    v_mov_b32 v3, v2
    v_add_u32 v2, s45, v16
    s_cbranch_scc1 gated_mix__ssm_conv_h3__compressed_kv_cla__prompt_kernel_b2_loop
    s_cmp_lg_u32 s35, 0
    s_cbranch_scc1 gated_mix__ssm_conv_h3__compressed_kv_cla__prompt_kernel_b2_sw
    s_waitcnt vmcnt(8)
    v_mov_b32 v13, 0
    v_mov_b32 v14, 1
    buffer_store_dword v14, v13, s[28:31], s55 offen sc1
    s_nop 4
    v_accvgpr_read_b32 v36, a64
    v_accvgpr_read_b32 v37, a65
    v_accvgpr_read_b32 v38, a66
    v_accvgpr_read_b32 v39, a67
    v_accvgpr_read_b32 v40, a68
    v_accvgpr_read_b32 v41, a69
    v_accvgpr_read_b32 v42, a70
    v_accvgpr_read_b32 v43, a71
    v_rcp_f32 v32, v248
    s_nop 0
    v_mul_f32 v36, v36, v32
    v_mul_f32 v37, v37, v32
    v_mul_f32 v38, v38, v32
    v_mul_f32 v39, v39, v32
    v_mul_f32 v40, v40, v32
    v_mul_f32 v41, v41, v32
    v_mul_f32 v42, v42, v32
    v_mul_f32 v43, v43, v32
    v_cvt_pk_bf16_f32 v44, v36, v37
    v_cvt_pk_bf16_f32 v45, v38, v39
    v_cvt_pk_bf16_f32 v46, v40, v41
    v_cvt_pk_bf16_f32 v47, v42, v43
    buffer_store_dwordx4 v[44:47], v16, s[16:19], s62 offen offset:0 sc1
    v_accvgpr_read_b32 v36, a72
    v_accvgpr_read_b32 v37, a73
    v_accvgpr_read_b32 v38, a74
    v_accvgpr_read_b32 v39, a75
    v_accvgpr_read_b32 v40, a76
    v_accvgpr_read_b32 v41, a77
    v_accvgpr_read_b32 v42, a78
    v_accvgpr_read_b32 v43, a79
    v_mul_f32 v36, v36, v32
    v_mul_f32 v37, v37, v32
    v_mul_f32 v38, v38, v32
    v_mul_f32 v39, v39, v32
    v_mul_f32 v40, v40, v32
    v_mul_f32 v41, v41, v32
    v_mul_f32 v42, v42, v32
    v_mul_f32 v43, v43, v32
    v_cvt_pk_bf16_f32 v20, v36, v37
    v_cvt_pk_bf16_f32 v21, v38, v39
    v_cvt_pk_bf16_f32 v22, v40, v41
    v_cvt_pk_bf16_f32 v23, v42, v43
    buffer_store_dwordx4 v[20:23], v16, s[16:19], s62 offen offset:1024 sc1
    v_accvgpr_read_b32 v36, a80
    v_accvgpr_read_b32 v37, a81
    v_accvgpr_read_b32 v38, a82
    v_accvgpr_read_b32 v39, a83
    v_accvgpr_read_b32 v40, a84
    v_accvgpr_read_b32 v41, a85
    v_accvgpr_read_b32 v42, a86
    v_accvgpr_read_b32 v43, a87
    v_mul_f32 v36, v36, v32
    v_mul_f32 v37, v37, v32
    v_mul_f32 v38, v38, v32
    v_mul_f32 v39, v39, v32
    v_mul_f32 v40, v40, v32
    v_mul_f32 v41, v41, v32
    v_mul_f32 v42, v42, v32
    v_mul_f32 v43, v43, v32
    v_cvt_pk_bf16_f32 v44, v36, v37
    v_cvt_pk_bf16_f32 v45, v38, v39
    v_cvt_pk_bf16_f32 v46, v40, v41
    v_cvt_pk_bf16_f32 v47, v42, v43
    buffer_store_dwordx4 v[44:47], v16, s[16:19], s62 offen offset:2048 sc1
    v_accvgpr_read_b32 v36, a88
    v_accvgpr_read_b32 v37, a89
    v_accvgpr_read_b32 v38, a90
    v_accvgpr_read_b32 v39, a91
    v_accvgpr_read_b32 v40, a92
    v_accvgpr_read_b32 v41, a93
    v_accvgpr_read_b32 v42, a94
    v_accvgpr_read_b32 v43, a95
    v_mul_f32 v36, v36, v32
    v_mul_f32 v37, v37, v32
    v_mul_f32 v38, v38, v32
    v_mul_f32 v39, v39, v32
    v_mul_f32 v40, v40, v32
    v_mul_f32 v41, v41, v32
    v_mul_f32 v42, v42, v32
    v_mul_f32 v43, v43, v32
    v_cvt_pk_bf16_f32 v20, v36, v37
    v_cvt_pk_bf16_f32 v21, v38, v39
    v_cvt_pk_bf16_f32 v22, v40, v41
    v_cvt_pk_bf16_f32 v23, v42, v43
    buffer_store_dwordx4 v[20:23], v16, s[16:19], s62 offen offset:3072 sc1
    s_mov_b32 m0, s40
    s_add_u32 s43, s38, s49
    s_barrier
    v_and_b32 v12, s42, v12
    v_cmp_ne_u32 vcc, 0, v12
    v_mfma_f32_16x16x32_bf16 v[200:203], a[128:131], v[128:131], v[76:79]
    v_mfma_f32_16x16x32_bf16 v[200:203], a[132:135], v[132:135], v[200:203]
    buffer_load_dwordx4 v16, s[12:15], s38 offen offset:0 sc1 lds
    v_mfma_f32_16x16x32_bf16 v[200:203], a[136:139], v[136:139], v[200:203]
    v_mfma_f32_16x16x32_bf16 v[200:203], a[140:143], v[140:143], v[200:203]
    s_waitcnt lgkmcnt(4)
    buffer_load_dwordx4 v16, s[12:15], s38 offen offset:1024 sc1 lds
    v_mfma_f32_16x16x32_bf16 v[204:207], a[144:147], v[128:131], v[76:79]
    ds_read_b128 a[176:179], v3 offset:12288
    v_mfma_f32_16x16x32_bf16 v[204:207], a[148:151], v[132:135], v[204:207]
    ds_read_b128 a[180:183], v3 offset:13312
    buffer_load_dwordx4 v16, s[12:15], s38 offen offset:2048 sc1 lds
    v_mfma_f32_16x16x32_bf16 v[204:207], a[152:155], v[136:139], v[204:207]
    ds_read_b128 a[184:187], v3 offset:14336
    v_mfma_f32_16x16x32_bf16 v[204:207], a[156:159], v[140:143], v[204:207]
    s_waitcnt lgkmcnt(3)
    ds_read_b128 a[188:191], v3 offset:15360
    buffer_load_dwordx4 v16, s[12:15], s38 offen offset:3072 sc1 lds
    s_mov_b32 m0, s41
    s_cbranch_vccnz gated_mix__ssm_conv_h3__compressed_kv_cla__prompt_kernel_b1_r0
gated_mix__ssm_conv_h3__compressed_kv_cla__prompt_kernel_b1_r0_ret:
    ds_read_b128 a[128:131], v3 offset:24576
    ds_read_b128 a[132:135], v3 offset:25600
    ds_read_b128 a[136:139], v3 offset:26624
    ds_read_b128 a[140:143], v3 offset:27648
    ds_read_b128 a[144:147], v3 offset:28672
    ds_read_b128 a[148:151], v3 offset:29696
    ds_read_b128 a[152:155], v3 offset:30720
    ds_read_b128 a[156:159], v3 offset:31744
    v_mfma_f32_16x16x32_bf16 a[96:99], a[160:163], v[220:223], a[96:99]
    buffer_load_dwordx4 v16, s[12:15], s43 offen offset:0 sc1 lds
    v_mfma_f32_16x16x32_bf16 a[100:103], a[164:167], v[220:223], a[100:103]
    buffer_load_dwordx4 v16, s[12:15], s43 offen offset:1024 sc1 lds
    v_mfma_f32_16x16x32_bf16 a[104:107], a[168:171], v[220:223], a[104:107]
    buffer_load_dwordx4 v16, s[12:15], s43 offen offset:2048 sc1 lds
    v_mfma_f32_16x16x32_bf16 a[108:111], a[172:175], v[220:223], a[108:111]
    s_waitcnt lgkmcnt(8)
    buffer_load_dwordx4 v16, s[12:15], s43 offen offset:3072 sc1 lds
    v_mfma_f32_16x16x32_bf16 a[112:115], a[176:179], v[220:223], a[112:115]
    v_add_f32 v200, v56, v200
    v_add_f32 v201, v57, v201
    v_add_f32 v202, v58, v202
    v_add_f32 v203, v59, v203
    v_add_f32 v204, v60, v204
    v_add_f32 v205, v61, v205
    v_add_f32 v206, v62, v206
    v_add_f32 v207, v63, v207
    v_mfma_f32_16x16x32_bf16 a[116:119], a[180:183], v[220:223], a[116:119]
    v_exp_f32 v4, v200
    v_exp_f32 v5, v201
    s_nop 0
    v_cvt_pk_bf16_f32 v236, v4, v5
    v_mfma_f32_16x16x32_bf16 a[120:123], a[184:187], v[220:223], a[120:123]
    v_exp_f32 v6, v202
    v_exp_f32 v7, v203
    s_nop 0
    v_cvt_pk_bf16_f32 v237, v6, v7
    v_mfma_f32_16x16x32_bf16 a[124:127], a[188:191], v[220:223], a[124:127]
    v_or_b32 v12, v236, v237
    v_exp_f32 v8, v204
    v_exp_f32 v9, v205
    s_nop 0
    v_mfma_f32_16x16x32_bf16 v[252:255], v[24:27], v[220:223], v[252:255]
    s_waitcnt lgkmcnt(4)
    v_cvt_pk_bf16_f32 v238, v8, v9
    v_exp_f32 v10, v206
    v_exp_f32 v11, v207
    s_nop 0
    v_cvt_pk_bf16_f32 v239, v10, v11
    v_or3_b32 v12, v12, v238, v239
    v_and_b32 v12, s42, v12
    v_cmp_ne_u32 vcc, 0, v12
    s_cbranch_vccnz gated_mix__ssm_conv_h3__compressed_kv_cla__prompt_kernel_b1_r1
gated_mix__ssm_conv_h3__compressed_kv_cla__prompt_kernel_b1_r1_ret:
    v_mfma_f32_16x16x32_bf16 a[96:99], a[128:131], v[236:239], a[96:99]
    v_mfma_f32_16x16x32_bf16 a[100:103], a[132:135], v[236:239], a[100:103]
    v_mfma_f32_16x16x32_bf16 a[104:107], a[136:139], v[236:239], a[104:107]
    v_mfma_f32_16x16x32_bf16 a[108:111], a[140:143], v[236:239], a[108:111]
    s_waitcnt lgkmcnt(0)
    v_mfma_f32_16x16x32_bf16 a[112:115], a[144:147], v[236:239], a[112:115]
    v_mfma_f32_16x16x32_bf16 a[116:119], a[148:151], v[236:239], a[116:119]
    v_mfma_f32_16x16x32_bf16 a[120:123], a[152:155], v[236:239], a[120:123]
    v_mfma_f32_16x16x32_bf16 a[124:127], a[156:159], v[236:239], a[124:127]
    v_mfma_f32_16x16x32_bf16 v[252:255], v[24:27], v[236:239], v[252:255]
    s_mov_b32 s20, s74
    s_mov_b32 s21, s75
    s_mov_b32 s22, 2048
    s_lshl_b32 s36, s2, 2
    s_add_u32 s36, s36, s32
    s_lshl_b32 s43, s32, 15
    s_lshl_b32 s44, s36, 12
    s_lshl_b32 s47, s36, 1
    s_mul_i32 s59, s32, 2304
    v_mov_b32 v8, 0
    v_mov_b32 v9, 1
    buffer_load_dwordx2 v[10:11], v8, s[4:7], s44 offen
    buffer_load_ushort v12, v8, s[20:23], s47 offen
    s_nop 4
    v_accvgpr_read_b32 v36, a96
    v_accvgpr_read_b32 v37, a97
    v_accvgpr_read_b32 v38, a98
    v_accvgpr_read_b32 v39, a99
    v_accvgpr_read_b32 v40, a100
    v_accvgpr_read_b32 v41, a101
    v_accvgpr_read_b32 v42, a102
    v_accvgpr_read_b32 v43, a103
    v_rcp_f32 v32, v252
    s_nop 0
    v_mul_f32 v36, v36, v32
    v_mul_f32 v37, v37, v32
    v_mul_f32 v38, v38, v32
    v_mul_f32 v39, v39, v32
    v_mul_f32 v40, v40, v32
    v_mul_f32 v41, v41, v32
    v_mul_f32 v42, v42, v32
    v_mul_f32 v43, v43, v32
    v_cvt_pk_bf16_f32 v44, v36, v37
    v_cvt_pk_bf16_f32 v45, v38, v39
    v_cvt_pk_bf16_f32 v46, v40, v41
    v_cvt_pk_bf16_f32 v47, v42, v43
    buffer_store_dwordx4 v[44:47], v16, s[16:19], s63 offen offset:0 sc1
    v_accvgpr_read_b32 v36, a104
    v_accvgpr_read_b32 v37, a105
    v_accvgpr_read_b32 v38, a106
    v_accvgpr_read_b32 v39, a107
    v_accvgpr_read_b32 v40, a108
    v_accvgpr_read_b32 v41, a109
    v_accvgpr_read_b32 v42, a110
    v_accvgpr_read_b32 v43, a111
    v_mul_f32 v36, v36, v32
    v_mul_f32 v37, v37, v32
    v_mul_f32 v38, v38, v32
    v_mul_f32 v39, v39, v32
    v_mul_f32 v40, v40, v32
    v_mul_f32 v41, v41, v32
    v_mul_f32 v42, v42, v32
    v_mul_f32 v43, v43, v32
    v_cvt_pk_bf16_f32 v20, v36, v37
    v_cvt_pk_bf16_f32 v21, v38, v39
    v_cvt_pk_bf16_f32 v22, v40, v41
    v_cvt_pk_bf16_f32 v23, v42, v43
    buffer_store_dwordx4 v[20:23], v16, s[16:19], s63 offen offset:1024 sc1
    v_accvgpr_read_b32 v36, a112
    v_accvgpr_read_b32 v37, a113
    v_accvgpr_read_b32 v38, a114
    v_accvgpr_read_b32 v39, a115
    v_accvgpr_read_b32 v40, a116
    v_accvgpr_read_b32 v41, a117
    v_accvgpr_read_b32 v42, a118
    v_accvgpr_read_b32 v43, a119
    v_mul_f32 v36, v36, v32
    v_mul_f32 v37, v37, v32
    v_mul_f32 v38, v38, v32
    v_mul_f32 v39, v39, v32
    v_mul_f32 v40, v40, v32
    v_mul_f32 v41, v41, v32
    v_mul_f32 v42, v42, v32
    v_mul_f32 v43, v43, v32
    v_cvt_pk_bf16_f32 v44, v36, v37
    v_cvt_pk_bf16_f32 v45, v38, v39
    v_cvt_pk_bf16_f32 v46, v40, v41
    v_cvt_pk_bf16_f32 v47, v42, v43
    buffer_store_dwordx4 v[44:47], v16, s[16:19], s63 offen offset:2048 sc1
    v_accvgpr_read_b32 v36, a120
    v_accvgpr_read_b32 v37, a121
    v_accvgpr_read_b32 v38, a122
    v_accvgpr_read_b32 v39, a123
    v_accvgpr_read_b32 v40, a124
    v_accvgpr_read_b32 v41, a125
    v_accvgpr_read_b32 v42, a126
    v_accvgpr_read_b32 v43, a127
    v_mul_f32 v36, v36, v32
    v_mul_f32 v37, v37, v32
    v_mul_f32 v38, v38, v32
    v_mul_f32 v39, v39, v32
    v_mul_f32 v40, v40, v32
    v_mul_f32 v41, v41, v32
    v_mul_f32 v42, v42, v32
    v_mul_f32 v43, v43, v32
    v_cvt_pk_bf16_f32 v20, v36, v37
    v_cvt_pk_bf16_f32 v21, v38, v39
    v_cvt_pk_bf16_f32 v22, v40, v41
    v_cvt_pk_bf16_f32 v23, v42, v43
    buffer_store_dwordx4 v[20:23], v16, s[16:19], s63 offen offset:3072 sc1
    v_lshrrev_b32 v232, 4, v16
    v_and_b32 v6, 15, v232
    v_lshrrev_b32 v7, 4, v232
    v_and_b32 v233, 1, v6
    v_cmp_eq_u32 vcc, 1, v233
    v_mov_b32 v234, 4240
    v_lshlrev_b32 v235, 4, v7
    v_cndmask_b32 v234, v234, 8, vcc
    v_lshl_add_u32 v234, v6, 3, v234
    v_add3_u32 v3, v234, v235, s43
    v_and_b32 v236, 3, v6
    v_mul_u32_u24 v236, 4640, v236
    v_lshrrev_b32 v234, 2, v6
    v_lshlrev_b32 v234, 7, v234
    v_sub_u32 v236, v236, v234
    v_add3_u32 v4, v236, v235, s43
    v_add_u32 v4, 8864, v4
    v_mov_b32 v20, 0
    v_mov_b32 v21, 0
    v_mov_b32 v22, 0
    v_mov_b32 v23, 0
    v_and_b32 v234, 7, v232
    v_lshlrev_b32 v234, 4, v234
    v_bfe_u32 v235, v232, 3, 1
    v_mul_u32_u24 v235, 4240, v235
    v_add3_u32 v234, v234, v235, s43
    ds_write_b128 v234, v[20:23]
    v_min_u32 v235, 368, v16
    v_add_u32 v235, s43, v235
    ds_write_b128 v235, v[20:23] offset:12576
    ds_write_b128 v235, v[20:23] offset:17216
    ds_write_b128 v235, v[20:23] offset:21856
    ds_write_b128 v235, v[20:23] offset:26496
    v_lshlrev_b32 v236, 2, v6
    v_sub_u32 v236, 60, v236
    v_lshrrev_b32 v236, 3, v236
    v_sub_u32 v236, v236, v7
    v_lshl_add_u32 v236, v233, 4, v236
    s_waitcnt vmcnt(4)
    v_mov_b32 v234, s43
    ds_write_b64 v234, v[10:11] offset:4360
    v_cmp_eq_u32 vcc, 16, v236
    v_mov_b32 v25, 0
    s_nop 0
    v_cndmask_b32 v24, 0, v12, vcc
    v_cmp_eq_u32 vcc, 0, v236
    v_mov_b32 v27, 0
    s_nop 0
    v_cndmask_b32 v26, 0, v12, vcc
    v_cmp_eq_u32 vcc, 20, v236
    v_mov_b32 v29, 0
    s_nop 0
    v_cndmask_b32 v28, 0, v12, vcc
    v_cmp_eq_u32 vcc, 4, v236
    v_mov_b32 v31, 0
    s_nop 0
    v_cndmask_b32 v30, 0, v12, vcc
    s_waitcnt vmcnt(6) lgkmcnt(0)
    s_barrier
    ds_read_b128 v[96:99], v4 offset:3584
    ds_read_b128 v[64:67], v3 offset:0
    ds_read_b128 v[100:103], v4 offset:3072
    ds_read_b128 v[68:71], v3 offset:512
    ds_read_b128 v[104:107], v4 offset:2560
    ds_read_b128 v[72:75], v3 offset:1024
    ds_read_b128 v[108:111], v4 offset:2048
    ds_read_b128 v[76:79], v3 offset:1536
    ds_read_b128 v[112:115], v4 offset:1536
    ds_read_b128 v[80:83], v3 offset:2048
    ds_read_b128 v[116:119], v4 offset:1024
    ds_read_b128 v[84:87], v3 offset:2560
    ds_read_b128 v[120:123], v4 offset:512
    ds_read_b128 v[88:91], v3 offset:3072
    ds_read_b128 v[124:127], v4 offset:0
    ds_read_b128 v[92:95], v3 offset:3584
    s_waitcnt lgkmcnt(0)
    v_mfma_f32_16x16x32_bf16 v[32:35], v[24:27], v[96:99], 0
    s_and_b32 s45, s2, 1
    s_bfe_u32 s36, s2, 0x10001
    v_mfma_f32_16x16x32_bf16 v[36:39], v[24:27], v[100:103], 0
    s_lshl_b32 s38, s36, 3
    s_bfe_u32 s36, s2, 0x30003
    v_mfma_f32_16x16x32_bf16 v[40:43], v[24:27], v[104:107], 0
    ds_read_b128 v[160:163], v4 offset:3648
    s_add_u32 s38, s38, s36
    s_bfe_u32 s36, s2, 0x10002
    v_mfma_f32_16x16x32_bf16 v[44:47], v[24:27], v[108:111], 0
    s_lshl_b32 s39, s36, 2
    s_lshr_b32 s37, s2, 6
    v_mfma_f32_16x16x32_bf16 v[48:51], v[24:27], v[112:115], 0
    ds_read_b128 v[128:131], v3 offset:64
    s_add_u32 s39, s39, s37
    s_xor_b32 s37, s45, 1
    v_mfma_f32_16x16x32_bf16 v[52:55], v[24:27], v[116:119], 0
    s_lshl_b32 s37, s37, 3
    v_lshlrev_b32 v233, 1, v7
    v_xor_b32 v233, v233, v6
    v_mfma_f32_16x16x32_bf16 v[56:59], v[24:27], v[120:123], 0
    ds_read_b128 v[164:167], v4 offset:3136
    v_xor_b32 v233, s37, v233
    v_mfma_f32_16x16x32_bf16 v[60:63], v[24:27], v[124:127], 0
    v_lshlrev_b32 v233, 4, v233
    v_lshl_add_u32 v192, v7, 11, v233
    v_mfma_f32_16x16x32_bf16 v[32:35], v[64:67], v[96:99], v[32:35]
    ds_read_b128 v[132:135], v3 offset:576
    v_add_u32 v193, 7040, v192
    s_lshl_b32 s40, s45, 22
    s_lshl_b32 s37, s32, 14
    v_mfma_f32_16x16x32_bf16 v[36:39], v[64:67], v[100:103], v[36:39]
    s_add_u32 s40, s40, s37
    s_lshl_b32 s37, s39, 8
    v_mfma_f32_16x16x32_bf16 v[40:43], v[64:67], v[104:107], v[40:43]
    ds_read_b128 v[168:171], v4 offset:2624
    s_add_u32 s40, s40, s37
    s_add_u32 m0, s59, 136192
    v_mfma_f32_16x16x32_bf16 v[44:47], v[64:67], v[108:111], v[44:47]
    buffer_load_dwordx4 v192, s[8:11], s40 offen offset:0 lds
    v_mfma_f32_16x16x32_bf16 v[48:51], v[64:67], v[112:115], v[48:51]
    ds_read_b128 v[136:139], v3 offset:1088
    v_mfma_f32_16x16x32_bf16 v[52:55], v[64:67], v[116:119], v[52:55]
    buffer_load_dwordx4 v193, s[8:11], s40 offen offset:1152 lds
    v_mfma_f32_16x16x32_bf16 v[56:59], v[64:67], v[120:123], v[56:59]
    ds_read_b128 v[172:175], v4 offset:2112
    s_add_u32 s40, s40, 65536
    s_add_u32 m0, s59, 145408
    v_mfma_f32_16x16x32_bf16 v[60:63], v[64:67], v[124:127], v[60:63]
    buffer_load_dwordx4 v192, s[8:11], s40 offen offset:0 lds
    v_mfma_f32_16x16x32_bf16 v[36:39], v[68:71], v[96:99], v[36:39]
    ds_read_b128 v[140:143], v3 offset:1600
    v_mfma_f32_16x16x32_bf16 v[40:43], v[68:71], v[100:103], v[40:43]
    buffer_load_dwordx4 v193, s[8:11], s40 offen offset:1152 lds
    v_mfma_f32_16x16x32_bf16 v[44:47], v[68:71], v[104:107], v[44:47]
    ds_read_b128 v[176:179], v4 offset:1600
    s_add_u32 s40, s40, 65536
    s_add_u32 m0, s59, 154624
    v_mfma_f32_16x16x32_bf16 v[48:51], v[68:71], v[108:111], v[48:51]
    buffer_load_dwordx4 v192, s[8:11], s40 offen offset:0 lds
    v_mfma_f32_16x16x32_bf16 v[52:55], v[68:71], v[112:115], v[52:55]
    ds_read_b128 v[144:147], v3 offset:2112
    v_mfma_f32_16x16x32_bf16 v[56:59], v[68:71], v[116:119], v[56:59]
    buffer_load_dwordx4 v193, s[8:11], s40 offen offset:1152 lds
    v_mfma_f32_16x16x32_bf16 v[60:63], v[68:71], v[120:123], v[60:63]
    ds_read_b128 v[180:183], v4 offset:1088
    s_add_u32 s40, s40, 65536
    s_lshr_b32 s52, s38, 1
    v_mfma_f32_16x16x32_bf16 v[40:43], v[72:75], v[96:99], v[40:43]
    s_lshl_b32 s52, s52, 2
    s_add_u32 s52, s52, s32
    v_mfma_f32_16x16x32_bf16 v[44:47], v[72:75], v[100:103], v[44:47]
    ds_read_b128 v[148:151], v3 offset:2624
    s_lshl_b32 s52, s52, 7
    s_lshl_b32 s37, s45, 6
    v_mfma_f32_16x16x32_bf16 v[48:51], v[72:75], v[104:107], v[48:51]
    s_add_u32 s52, s52, s37
    v_lshlrev_b32 v212, 2, v6
    s_lshl_b32 s41, s38, 2
    v_mfma_f32_16x16x32_bf16 v[52:55], v[72:75], v[108:111], v[52:55]
    ds_read_b128 v[184:187], v4 offset:576
    s_add_u32 s41, s41, s32
    s_lshl_b32 s41, s41, 17
    v_mfma_f32_16x16x32_bf16 v[56:59], v[72:75], v[112:115], v[56:59]
    s_lshl_b32 s37, s45, 16
    s_add_u32 s41, s41, s37
    v_mfma_f32_16x16x32_bf16 v[60:63], v[72:75], v[116:119], v[60:63]
    ds_read_b128 v[152:155], v3 offset:3136
    s_add_u32 s42, s41, 8388608
    v_mfma_f32_16x16x32_bf16 v[44:47], v[76:79], v[96:99], v[44:47]
    buffer_load_dword v213, v212, s[28:31], s52 offen offset:0 sc1
    v_mfma_f32_16x16x32_bf16 v[48:51], v[76:79], v[100:103], v[48:51]
    ds_read_b128 v[188:191], v4 offset:64
    v_mfma_f32_16x16x32_bf16 v[52:55], v[76:79], v[104:107], v[52:55]
    v_mfma_f32_16x16x32_bf16 v[56:59], v[76:79], v[108:111], v[56:59]
    ds_read_b128 v[156:159], v3 offset:3648
    v_mfma_f32_16x16x32_bf16 v[60:63], v[76:79], v[112:115], v[60:63]
    v_mfma_f32_16x16x32_bf16 v[48:51], v[80:83], v[96:99], v[48:51]
    v_mfma_f32_16x16x32_bf16 v[52:55], v[80:83], v[100:103], v[52:55]
    v_mfma_f32_16x16x32_bf16 v[56:59], v[80:83], v[104:107], v[56:59]
    v_mfma_f32_16x16x32_bf16 v[60:63], v[80:83], v[108:111], v[60:63]
    v_mfma_f32_16x16x32_bf16 v[52:55], v[84:87], v[96:99], v[52:55]
    v_mfma_f32_16x16x32_bf16 v[56:59], v[84:87], v[100:103], v[56:59]
    v_mfma_f32_16x16x32_bf16 v[60:63], v[84:87], v[104:107], v[60:63]
    v_mfma_f32_16x16x32_bf16 v[56:59], v[88:91], v[96:99], v[56:59]
    v_mfma_f32_16x16x32_bf16 v[60:63], v[88:91], v[100:103], v[60:63]
    v_mfma_f32_16x16x32_bf16 v[60:63], v[92:95], v[96:99], v[60:63]
    s_waitcnt lgkmcnt(0)
    v_mfma_f32_16x16x32_bf16 v[32:35], v[28:31], v[160:163], v[32:35]
    s_waitcnt vmcnt(7)
    buffer_store_dword v9, v8, s[28:31], s56 offen sc1
    v_mfma_f32_16x16x32_bf16 v[36:39], v[28:31], v[164:167], v[36:39]
    v_mul_u32_u24 v233, 1152, v7
    v_lshrrev_b32 v234, 2, v6
    v_mfma_f32_16x16x32_bf16 v[40:43], v[28:31], v[168:171], v[40:43]
    ds_read_b128 v[96:99], v4 offset:3712
    v_lshl_add_u32 v233, v234, 8, v233
    v_mfma_f32_16x16x32_bf16 v[44:47], v[28:31], v[172:175], v[44:47]
    v_and_b32 v235, 3, v6
    v_lshl_add_u32 v233, v235, 3, v233
    v_mfma_f32_16x16x32_bf16 v[48:51], v[28:31], v[176:179], v[48:51]
    ds_read_b128 v[64:67], v3 offset:128
    v_add_u32 v233, 16384, v233
    v_mfma_f32_16x16x32_bf16 v[52:55], v[28:31], v[180:183], v[52:55]
    v_xor_b32 v236, 0, v234
    v_lshl_add_u32 v194, v236, 5, v233
    v_mfma_f32_16x16x32_bf16 v[56:59], v[28:31], v[184:187], v[56:59]
    ds_read_b128 v[100:103], v4 offset:3200
    v_add_u32 v198, 64512, v194
    v_mfma_f32_16x16x32_bf16 v[60:63], v[28:31], v[188:191], v[60:63]
    v_add_u32 v202, 129024, v194
    v_xor_b32 v236, 1, v234
    v_mfma_f32_16x16x32_bf16 v[32:35], v[128:131], v[160:163], v[32:35]
    ds_read_b128 v[68:71], v3 offset:640
    v_lshl_add_u32 v195, v236, 5, v233
    v_mfma_f32_16x16x32_bf16 v[36:39], v[128:131], v[164:167], v[36:39]
    v_add_u32 v199, 64512, v195
    v_add_u32 v203, 129024, v195
    v_mfma_f32_16x16x32_bf16 v[40:43], v[128:131], v[168:171], v[40:43]
    ds_read_b128 v[104:107], v4 offset:2688
    v_xor_b32 v236, 2, v234
    v_mfma_f32_16x16x32_bf16 v[44:47], v[128:131], v[172:175], v[44:47]
    v_lshl_add_u32 v196, v236, 5, v233
    v_add_u32 v200, 64512, v196
    v_mfma_f32_16x16x32_bf16 v[48:51], v[128:131], v[176:179], v[48:51]
    ds_read_b128 v[72:75], v3 offset:1152
    v_add_u32 v204, 129024, v196
    v_mfma_f32_16x16x32_bf16 v[52:55], v[128:131], v[180:183], v[52:55]
    v_xor_b32 v236, 3, v234
    v_lshl_add_u32 v197, v236, 5, v233
    v_mfma_f32_16x16x32_bf16 v[56:59], v[128:131], v[184:187], v[56:59]
    ds_read_b128 v[108:111], v4 offset:2176
    v_add_u32 v201, 64512, v197
    v_mfma_f32_16x16x32_bf16 v[60:63], v[128:131], v[188:191], v[60:63]
    v_add_u32 v205, 129024, v197
    v_lshlrev_b32 v236, 3, v7
    v_mfma_f32_16x16x32_bf16 v[36:39], v[132:135], v[160:163], v[36:39]
    ds_read_b128 v[76:79], v3 offset:1664
    v_lshl_add_u32 v206, v6, 13, v236
    v_mfma_f32_16x16x32_bf16 v[40:43], v[132:135], v[164:167], v[40:43]
    v_lshl_add_u32 v5, v6, 5, v236
    v_lshrrev_b32 v236, 2, v232
    v_mfma_f32_16x16x32_bf16 v[44:47], v[132:135], v[168:171], v[44:47]
    ds_read_b128 v[112:115], v4 offset:1664
    v_lshlrev_b32 v236, 8, v236
    v_mfma_f32_16x16x32_bf16 v[48:51], v[132:135], v[172:175], v[48:51]
    v_lshl_add_u32 v236, v235, 3, v236
    s_lshl_b32 s37, s32, 5
    v_add_u32 v207, s37, v236
    v_mfma_f32_16x16x32_bf16 v[52:55], v[132:135], v[176:179], v[52:55]
    ds_read_b128 v[80:83], v3 offset:2176
    v_lshlrev_b32 v208, 4, v6
    v_mfma_f32_16x16x32_bf16 v[56:59], v[132:135], v[180:183], v[56:59]
    v_lshlrev_b32 v209, 12, v7
    v_bfe_u32 v236, v232, 3, 1
    v_mfma_f32_16x16x32_bf16 v[60:63], v[132:135], v[184:187], v[60:63]
    ds_read_b128 v[116:119], v4 offset:1152
    v_lshl_add_u32 v209, v236, 11, v209
    v_mfma_f32_16x16x32_bf16 v[40:43], v[136:139], v[160:163], v[40:43]
    v_and_b32 v236, 7, v232
    v_lshl_add_u32 v209, v236, 4, v209
    s_lshl_b32 s48, s38, 6
    s_add_u32 s48, s48, s32
    v_mfma_f32_16x16x32_bf16 v[44:47], v[136:139], v[164:167], v[44:47]
    ds_read_b128 v[84:87], v3 offset:2688
    s_lshl_b32 s50, s48, 2
    s_lshl_b32 s48, s48, 11
    v_mfma_f32_16x16x32_bf16 v[48:51], v[136:139], v[168:171], v[48:51]
    s_lshl_b32 s37, s39, 1
    s_add_u32 s37, s37, s45
    v_mfma_f32_16x16x32_bf16 v[52:55], v[136:139], v[172:175], v[52:55]
    ds_read_b128 v[120:123], v4 offset:640
    s_lshl_b32 s51, s37, 2
    s_lshl_b32 s37, s37, 7
    v_mfma_f32_16x16x32_bf16 v[56:59], v[136:139], v[176:179], v[56:59]
    s_add_u32 s48, s48, s37
    s_add_u32 s49, s48, 2097152
    v_mfma_f32_16x16x32_bf16 v[60:63], v[136:139], v[180:183], v[60:63]
    ds_read_b128 v[88:91], v3 offset:3200
    s_add_u32 s51, s51, s32
    s_lshl_b32 s53, s51, 6
    v_mfma_f32_16x16x32_bf16 v[44:47], v[140:143], v[160:163], v[44:47]
    s_add_u32 s53, s53, 8192
    s_lshl_b32 s51, s51, 16
    v_mfma_f32_16x16x32_bf16 v[48:51], v[140:143], v[164:167], v[48:51]
    ds_read_b128 v[124:127], v4 offset:128
    s_lshl_b32 s37, s38, 7
    s_add_u32 s51, s51, s37
    v_mfma_f32_16x16x32_bf16 v[52:55], v[140:143], v[168:171], v[52:55]
    s_add_u32 s12, s94, 55574528
    s_addc_u32 s13, s95, 0
    s_mov_b32 s14, 4194304
    v_mfma_f32_16x16x32_bf16 v[56:59], v[140:143], v[172:175], v[56:59]
    ds_read_b128 v[92:95], v3 offset:3712
    s_mov_b32 s20, s90
    s_mov_b32 s21, s91
    v_mfma_f32_16x16x32_bf16 v[60:63], v[140:143], v[176:179], v[60:63]
    s_mov_b32 s22, 4194304
    v_mfma_f32_16x16x32_bf16 v[48:51], v[144:147], v[160:163], v[48:51]
    v_mfma_f32_16x16x32_bf16 v[52:55], v[144:147], v[164:167], v[52:55]
    v_mfma_f32_16x16x32_bf16 v[56:59], v[144:147], v[168:171], v[56:59]
    v_mfma_f32_16x16x32_bf16 v[60:63], v[144:147], v[172:175], v[60:63]
    v_mfma_f32_16x16x32_bf16 v[52:55], v[148:151], v[160:163], v[52:55]
    v_mfma_f32_16x16x32_bf16 v[56:59], v[148:151], v[164:167], v[56:59]
    v_mfma_f32_16x16x32_bf16 v[60:63], v[148:151], v[168:171], v[60:63]
    v_mfma_f32_16x16x32_bf16 v[56:59], v[152:155], v[160:163], v[56:59]
    v_mfma_f32_16x16x32_bf16 v[60:63], v[152:155], v[164:167], v[60:63]
    v_mfma_f32_16x16x32_bf16 v[60:63], v[156:159], v[160:163], v[60:63]
    s_waitcnt lgkmcnt(0)
    s_waitcnt vmcnt(1)
    v_cmp_ne_u32 vcc, 1, v213
    s_nop 0
    s_cbranch_vccnz gated_mix__ssm_conv_h3__compressed_kv_cla__prompt_kernel_spin_s
gated_mix__ssm_conv_h3__compressed_kv_cla__prompt_kernel_spin_s_ret:
    v_mfma_f32_16x16x32_bf16 v[32:35], v[64:67], v[96:99], v[32:35]
    buffer_load_dwordx4 a[0:3], v16, s[16:19], s41 offen offset:0 sc1
    v_mfma_f32_16x16x32_bf16 v[36:39], v[64:67], v[100:103], v[36:39]
    buffer_load_dwordx4 a[4:7], v16, s[16:19], s41 offen offset:1024 sc1
    v_mfma_f32_16x16x32_bf16 v[40:43], v[64:67], v[104:107], v[40:43]
    ds_read_b128 v[160:163], v4 offset:3776
    v_mfma_f32_16x16x32_bf16 v[44:47], v[64:67], v[108:111], v[44:47]
    buffer_load_dwordx4 a[8:11], v16, s[16:19], s41 offen offset:2048 sc1
    v_mfma_f32_16x16x32_bf16 v[48:51], v[64:67], v[112:115], v[48:51]
    ds_read_b128 v[128:131], v3 offset:192
    v_mfma_f32_16x16x32_bf16 v[52:55], v[64:67], v[116:119], v[52:55]
    buffer_load_dwordx4 a[12:15], v16, s[16:19], s41 offen offset:3072 sc1
    v_mfma_f32_16x16x32_bf16 v[56:59], v[64:67], v[120:123], v[56:59]
    ds_read_b128 v[164:167], v4 offset:3264
    s_add_u32 s41, s41, 4096
    v_mfma_f32_16x16x32_bf16 v[60:63], v[64:67], v[124:127], v[60:63]
    buffer_load_dwordx4 a[16:19], v16, s[16:19], s41 offen offset:0 sc1
    v_mfma_f32_16x16x32_bf16 v[36:39], v[68:71], v[96:99], v[36:39]
    ds_read_b128 v[132:135], v3 offset:704
    v_mfma_f32_16x16x32_bf16 v[40:43], v[68:71], v[100:103], v[40:43]
    buffer_load_dwordx4 a[20:23], v16, s[16:19], s41 offen offset:1024 sc1
    v_mfma_f32_16x16x32_bf16 v[44:47], v[68:71], v[104:107], v[44:47]
    ds_read_b128 v[168:171], v4 offset:2752
    v_mfma_f32_16x16x32_bf16 v[48:51], v[68:71], v[108:111], v[48:51]
    buffer_load_dwordx4 a[24:27], v16, s[16:19], s41 offen offset:2048 sc1
    v_mfma_f32_16x16x32_bf16 v[52:55], v[68:71], v[112:115], v[52:55]
    ds_read_b128 v[136:139], v3 offset:1216
    v_mfma_f32_16x16x32_bf16 v[56:59], v[68:71], v[116:119], v[56:59]
    buffer_load_dwordx4 a[28:31], v16, s[16:19], s41 offen offset:3072 sc1
    v_mfma_f32_16x16x32_bf16 v[60:63], v[68:71], v[120:123], v[60:63]
gated_mix__ssm_conv_h3__compressed_kv_cla__prompt_kernel_pad11:
    s_cbranch_execz gated_mix__ssm_conv_h3__compressed_kv_cla__prompt_kernel_pad15
    ds_read_b128 v[172:175], v4 offset:2240
    s_add_u32 s41, s41, 4096
    v_mfma_f32_16x16x32_bf16 v[40:43], v[72:75], v[96:99], v[40:43]
    buffer_load_dwordx4 a[32:35], v16, s[16:19], s41 offen offset:0 sc1
    v_mfma_f32_16x16x32_bf16 v[44:47], v[72:75], v[100:103], v[44:47]
    ds_read_b128 v[140:143], v3 offset:1728
    v_mfma_f32_16x16x32_bf16 v[48:51], v[72:75], v[104:107], v[48:51]
    buffer_load_dwordx4 a[36:39], v16, s[16:19], s41 offen offset:1024 sc1
    v_mfma_f32_16x16x32_bf16 v[52:55], v[72:75], v[108:111], v[52:55]
    ds_read_b128 v[176:179], v4 offset:1728
    v_mfma_f32_16x16x32_bf16 v[56:59], v[72:75], v[112:115], v[56:59]
    buffer_load_dwordx4 a[40:43], v16, s[16:19], s41 offen offset:2048 sc1
    v_mfma_f32_16x16x32_bf16 v[60:63], v[72:75], v[116:119], v[60:63]
    ds_read_b128 v[144:147], v3 offset:2240
    v_mfma_f32_16x16x32_bf16 v[44:47], v[76:79], v[96:99], v[44:47]
    buffer_load_dwordx4 a[44:47], v16, s[16:19], s41 offen offset:3072 sc1
    v_mfma_f32_16x16x32_bf16 v[48:51], v[76:79], v[100:103], v[48:51]
    ds_read_b128 v[180:183], v4 offset:1216
    s_add_u32 s41, s41, 4096
    v_mfma_f32_16x16x32_bf16 v[52:55], v[76:79], v[104:107], v[52:55]
    buffer_load_dwordx4 a[48:51], v16, s[16:19], s41 offen offset:0 sc1
    v_mfma_f32_16x16x32_bf16 v[56:59], v[76:79], v[108:111], v[56:59]
    ds_read_b128 v[148:151], v3 offset:2752
    v_mfma_f32_16x16x32_bf16 v[60:63], v[76:79], v[112:115], v[60:63]
    buffer_load_dwordx4 a[52:55], v16, s[16:19], s41 offen offset:1024 sc1
    v_mfma_f32_16x16x32_bf16 v[48:51], v[80:83], v[96:99], v[48:51]
    ds_read_b128 v[184:187], v4 offset:704
    v_mfma_f32_16x16x32_bf16 v[52:55], v[80:83], v[100:103], v[52:55]
    buffer_load_dwordx4 a[56:59], v16, s[16:19], s41 offen offset:2048 sc1
    v_mfma_f32_16x16x32_bf16 v[56:59], v[80:83], v[104:107], v[56:59]
    ds_read_b128 v[152:155], v3 offset:3264
    v_mfma_f32_16x16x32_bf16 v[60:63], v[80:83], v[108:111], v[60:63]
    v_mfma_f32_16x16x32_bf16 v[52:55], v[84:87], v[96:99], v[52:55]
    ds_read_b128 v[188:191], v4 offset:192
    v_mfma_f32_16x16x32_bf16 v[56:59], v[84:87], v[100:103], v[56:59]
    v_mfma_f32_16x16x32_bf16 v[60:63], v[84:87], v[104:107], v[60:63]
    ds_read_b128 v[156:159], v3 offset:3776
    v_mfma_f32_16x16x32_bf16 v[56:59], v[88:91], v[96:99], v[56:59]
    v_mfma_f32_16x16x32_bf16 v[60:63], v[88:91], v[100:103], v[60:63]
    v_mfma_f32_16x16x32_bf16 v[60:63], v[92:95], v[96:99], v[60:63]
    s_waitcnt lgkmcnt(0)
    v_mfma_f32_16x16x32_bf16 v[32:35], v[128:131], v[160:163], v[32:35]
    s_add_u32 s4, s94, 59768832
    s_addc_u32 s5, s95, 0
    s_mov_b32 s6, 8192
    v_mfma_f32_16x16x32_bf16 v[36:39], v[128:131], v[164:167], v[36:39]
    s_mov_b32 s24, s64
    s_mov_b32 s25, s65
    v_mfma_f32_16x16x32_bf16 v[40:43], v[128:131], v[168:171], v[40:43]
    ds_read_b128 v[96:99], v4 offset:3840
    s_mov_b32 s26, 4194304
    s_lshl_b32 s46, s44, 1
    v_mfma_f32_16x16x32_bf16 v[44:47], v[128:131], v[172:175], v[44:47]
    buffer_load_dwordx2 v[216:217], v206, s[24:27], s48 offen offset:0
    v_mfma_f32_16x16x32_bf16 v[48:51], v[128:131], v[176:179], v[48:51]
    ds_read_b128 v[64:67], v3 offset:256
    v_mfma_f32_16x16x32_bf16 v[52:55], v[128:131], v[180:183], v[52:55]
    buffer_load_dwordx2 v[220:221], v206, s[24:27], s48 offen offset:32
    v_mfma_f32_16x16x32_bf16 v[56:59], v[128:131], v[184:187], v[56:59]
    ds_read_b128 v[100:103], v4 offset:3328
    v_mfma_f32_16x16x32_bf16 v[60:63], v[128:131], v[188:191], v[60:63]
    buffer_load_dwordx2 v[224:225], v206, s[24:27], s48 offen offset:64
    v_mfma_f32_16x16x32_bf16 v[36:39], v[132:135], v[160:163], v[36:39]
    ds_read_b128 v[68:71], v3 offset:768
    v_mfma_f32_16x16x32_bf16 v[40:43], v[132:135], v[164:167], v[40:43]
    buffer_load_dwordx2 v[228:229], v206, s[24:27], s48 offen offset:96
    v_mfma_f32_16x16x32_bf16 v[44:47], v[132:135], v[168:171], v[44:47]
    ds_read_b128 v[104:107], v4 offset:2816
    v_mfma_f32_16x16x32_bf16 v[48:51], v[132:135], v[172:175], v[48:51]
    buffer_load_dwordx2 v[218:219], v206, s[24:27], s49 offen offset:0
    v_mfma_f32_16x16x32_bf16 v[52:55], v[132:135], v[176:179], v[52:55]
    ds_read_b128 v[72:75], v3 offset:1280
    v_mfma_f32_16x16x32_bf16 v[56:59], v[132:135], v[180:183], v[56:59]
    buffer_load_dwordx2 v[222:223], v206, s[24:27], s49 offen offset:32
    v_mfma_f32_16x16x32_bf16 v[60:63], v[132:135], v[184:187], v[60:63]
    ds_read_b128 v[108:111], v4 offset:2304
    v_mfma_f32_16x16x32_bf16 v[40:43], v[136:139], v[160:163], v[40:43]
    buffer_load_dwordx2 v[226:227], v206, s[24:27], s49 offen offset:64
    v_mfma_f32_16x16x32_bf16 v[44:47], v[136:139], v[164:167], v[44:47]
    ds_read_b128 v[76:79], v3 offset:1792
    v_mfma_f32_16x16x32_bf16 v[48:51], v[136:139], v[168:171], v[48:51]
    buffer_load_dwordx2 v[230:231], v206, s[24:27], s49 offen offset:96
    v_mfma_f32_16x16x32_bf16 v[52:55], v[136:139], v[172:175], v[52:55]
    ds_read_b128 v[112:115], v4 offset:1792
    v_mfma_f32_16x16x32_bf16 v[56:59], v[136:139], v[176:179], v[56:59]
    buffer_load_dword v210, v208, s[4:7], s50 offen sc1
    v_mfma_f32_16x16x32_bf16 v[60:63], v[136:139], v[180:183], v[60:63]
    ds_read_b128 v[80:83], v3 offset:2304
    s_add_u32 s50, s50, 4096
    v_mfma_f32_16x16x32_bf16 v[44:47], v[140:143], v[160:163], v[44:47]
    buffer_load_dword v211, v208, s[4:7], s50 offen sc1
    v_mfma_f32_16x16x32_bf16 v[48:51], v[140:143], v[164:167], v[48:51]
    ds_read_b128 v[116:119], v4 offset:1280
    v_mfma_f32_16x16x32_bf16 v[52:55], v[140:143], v[168:171], v[52:55]
    v_mfma_f32_16x16x32_bf16 v[56:59], v[140:143], v[172:175], v[56:59]
    ds_read_b128 v[84:87], v3 offset:2816
    v_mfma_f32_16x16x32_bf16 v[60:63], v[140:143], v[176:179], v[60:63]
    v_mfma_f32_16x16x32_bf16 v[48:51], v[144:147], v[160:163], v[48:51]
    ds_read_b128 v[120:123], v4 offset:768
    v_mfma_f32_16x16x32_bf16 v[52:55], v[144:147], v[164:167], v[52:55]
    v_mfma_f32_16x16x32_bf16 v[56:59], v[144:147], v[168:171], v[56:59]
    ds_read_b128 v[88:91], v3 offset:3328
    v_mfma_f32_16x16x32_bf16 v[60:63], v[144:147], v[172:175], v[60:63]
    v_mfma_f32_16x16x32_bf16 v[52:55], v[148:151], v[160:163], v[52:55]
    ds_read_b128 v[124:127], v4 offset:256
    v_mfma_f32_16x16x32_bf16 v[56:59], v[148:151], v[164:167], v[56:59]
    v_mfma_f32_16x16x32_bf16 v[60:63], v[148:151], v[168:171], v[60:63]
    ds_read_b128 v[92:95], v3 offset:3840
    v_mfma_f32_16x16x32_bf16 v[56:59], v[152:155], v[160:163], v[56:59]
    v_mfma_f32_16x16x32_bf16 v[60:63], v[152:155], v[164:167], v[60:63]
    v_mfma_f32_16x16x32_bf16 v[60:63], v[156:159], v[160:163], v[60:63]
    s_waitcnt lgkmcnt(0)
    v_mfma_f32_16x16x32_bf16 v[32:35], v[64:67], v[96:99], v[32:35]
    s_add_u32 s52, s52, 4096
    buffer_load_dword v213, v212, s[28:31], s52 offen offset:0 sc1
    v_mfma_f32_16x16x32_bf16 v[36:39], v[64:67], v[100:103], v[36:39]
    v_mfma_f32_16x16x32_bf16 v[40:43], v[64:67], v[104:107], v[40:43]
    ds_read_b128 v[160:163], v4 offset:3904
    v_mfma_f32_16x16x32_bf16 v[44:47], v[64:67], v[108:111], v[44:47]
    v_mfma_f32_16x16x32_bf16 v[48:51], v[64:67], v[112:115], v[48:51]
    ds_read_b128 v[128:131], v3 offset:320
    v_mfma_f32_16x16x32_bf16 v[52:55], v[64:67], v[116:119], v[52:55]
    v_mfma_f32_16x16x32_bf16 v[56:59], v[64:67], v[120:123], v[56:59]
    ds_read_b128 v[164:167], v4 offset:3392
    v_mfma_f32_16x16x32_bf16 v[60:63], v[64:67], v[124:127], v[60:63]
    v_mfma_f32_16x16x32_bf16 v[36:39], v[68:71], v[96:99], v[36:39]
    ds_read_b128 v[132:135], v3 offset:832
    v_mfma_f32_16x16x32_bf16 v[40:43], v[68:71], v[100:103], v[40:43]
    v_mfma_f32_16x16x32_bf16 v[44:47], v[68:71], v[104:107], v[44:47]
    ds_read_b128 v[168:171], v4 offset:2880
    v_mfma_f32_16x16x32_bf16 v[48:51], v[68:71], v[108:111], v[48:51]
    v_mfma_f32_16x16x32_bf16 v[52:55], v[68:71], v[112:115], v[52:55]
    ds_read_b128 v[136:139], v3 offset:1344
    v_mfma_f32_16x16x32_bf16 v[56:59], v[68:71], v[116:119], v[56:59]
    v_mfma_f32_16x16x32_bf16 v[60:63], v[68:71], v[120:123], v[60:63]
    ds_read_b128 v[172:175], v4 offset:2368
    v_mfma_f32_16x16x32_bf16 v[40:43], v[72:75], v[96:99], v[40:43]
    v_mfma_f32_16x16x32_bf16 v[44:47], v[72:75], v[100:103], v[44:47]
    ds_read_b128 v[140:143], v3 offset:1856
    v_mfma_f32_16x16x32_bf16 v[48:51], v[72:75], v[104:107], v[48:51]
    v_mfma_f32_16x16x32_bf16 v[52:55], v[72:75], v[108:111], v[52:55]
    ds_read_b128 v[176:179], v4 offset:1856
    v_mfma_f32_16x16x32_bf16 v[56:59], v[72:75], v[112:115], v[56:59]
    v_mfma_f32_16x16x32_bf16 v[60:63], v[72:75], v[116:119], v[60:63]
    ds_read_b128 v[144:147], v3 offset:2368
    v_mfma_f32_16x16x32_bf16 v[44:47], v[76:79], v[96:99], v[44:47]
    v_mfma_f32_16x16x32_bf16 v[48:51], v[76:79], v[100:103], v[48:51]
    ds_read_b128 v[180:183], v4 offset:1344
    v_mfma_f32_16x16x32_bf16 v[52:55], v[76:79], v[104:107], v[52:55]
    v_mfma_f32_16x16x32_bf16 v[56:59], v[76:79], v[108:111], v[56:59]
    ds_read_b128 v[148:151], v3 offset:2880
    v_mfma_f32_16x16x32_bf16 v[60:63], v[76:79], v[112:115], v[60:63]
    v_mfma_f32_16x16x32_bf16 v[48:51], v[80:83], v[96:99], v[48:51]
    ds_read_b128 v[184:187], v4 offset:832
    v_mfma_f32_16x16x32_bf16 v[52:55], v[80:83], v[100:103], v[52:55]
    v_mfma_f32_16x16x32_bf16 v[56:59], v[80:83], v[104:107], v[56:59]
    ds_read_b128 v[152:155], v3 offset:3392
    v_mfma_f32_16x16x32_bf16 v[60:63], v[80:83], v[108:111], v[60:63]
    v_mfma_f32_16x16x32_bf16 v[52:55], v[84:87], v[96:99], v[52:55]
    ds_read_b128 v[188:191], v4 offset:320
    v_mfma_f32_16x16x32_bf16 v[56:59], v[84:87], v[100:103], v[56:59]
    v_mfma_f32_16x16x32_bf16 v[60:63], v[84:87], v[104:107], v[60:63]
    ds_read_b128 v[156:159], v3 offset:3904
    v_mfma_f32_16x16x32_bf16 v[56:59], v[88:91], v[96:99], v[56:59]
    v_mfma_f32_16x16x32_bf16 v[60:63], v[88:91], v[100:103], v[60:63]
    v_mfma_f32_16x16x32_bf16 v[60:63], v[92:95], v[96:99], v[60:63]
    s_waitcnt lgkmcnt(0)
    v_mfma_f32_16x16x32_bf16 v[32:35], v[128:131], v[160:163], v[32:35]
    v_mfma_f32_16x16x32_bf16 v[36:39], v[128:131], v[164:167], v[36:39]
    v_mfma_f32_16x16x32_bf16 v[40:43], v[128:131], v[168:171], v[40:43]
    ds_read_b128 v[96:99], v4 offset:3968
    v_mfma_f32_16x16x32_bf16 v[44:47], v[128:131], v[172:175], v[44:47]
    v_mfma_f32_16x16x32_bf16 v[48:51], v[128:131], v[176:179], v[48:51]
    ds_read_b128 v[64:67], v3 offset:384
    v_mfma_f32_16x16x32_bf16 v[52:55], v[128:131], v[180:183], v[52:55]
    v_mfma_f32_16x16x32_bf16 v[56:59], v[128:131], v[184:187], v[56:59]
    ds_read_b128 v[100:103], v4 offset:3456
    v_mfma_f32_16x16x32_bf16 v[60:63], v[128:131], v[188:191], v[60:63]
    v_mfma_f32_16x16x32_bf16 v[36:39], v[132:135], v[160:163], v[36:39]
    ds_read_b128 v[68:71], v3 offset:896
    v_mfma_f32_16x16x32_bf16 v[40:43], v[132:135], v[164:167], v[40:43]
    v_mfma_f32_16x16x32_bf16 v[44:47], v[132:135], v[168:171], v[44:47]
    ds_read_b128 v[104:107], v4 offset:2944
    v_mfma_f32_16x16x32_bf16 v[48:51], v[132:135], v[172:175], v[48:51]
    v_mfma_f32_16x16x32_bf16 v[52:55], v[132:135], v[176:179], v[52:55]
    ds_read_b128 v[72:75], v3 offset:1408
    v_mfma_f32_16x16x32_bf16 v[56:59], v[132:135], v[180:183], v[56:59]
    v_mfma_f32_16x16x32_bf16 v[60:63], v[132:135], v[184:187], v[60:63]
    ds_read_b128 v[108:111], v4 offset:2432
    v_mfma_f32_16x16x32_bf16 v[40:43], v[136:139], v[160:163], v[40:43]
    v_mfma_f32_16x16x32_bf16 v[44:47], v[136:139], v[164:167], v[44:47]
    ds_read_b128 v[76:79], v3 offset:1920
    v_mfma_f32_16x16x32_bf16 v[48:51], v[136:139], v[168:171], v[48:51]
    v_mfma_f32_16x16x32_bf16 v[52:55], v[136:139], v[172:175], v[52:55]
    ds_read_b128 v[112:115], v4 offset:1920
    v_mfma_f32_16x16x32_bf16 v[56:59], v[136:139], v[176:179], v[56:59]
    v_mfma_f32_16x16x32_bf16 v[60:63], v[136:139], v[180:183], v[60:63]
    ds_read_b128 v[80:83], v3 offset:2432
    v_mfma_f32_16x16x32_bf16 v[44:47], v[140:143], v[160:163], v[44:47]
    v_mfma_f32_16x16x32_bf16 v[48:51], v[140:143], v[164:167], v[48:51]
    ds_read_b128 v[116:119], v4 offset:1408
    v_mfma_f32_16x16x32_bf16 v[52:55], v[140:143], v[168:171], v[52:55]
    v_mfma_f32_16x16x32_bf16 v[56:59], v[140:143], v[172:175], v[56:59]
    ds_read_b128 v[84:87], v3 offset:2944
    v_mfma_f32_16x16x32_bf16 v[60:63], v[140:143], v[176:179], v[60:63]
    v_mfma_f32_16x16x32_bf16 v[48:51], v[144:147], v[160:163], v[48:51]
    ds_read_b128 v[120:123], v4 offset:896
    v_mfma_f32_16x16x32_bf16 v[52:55], v[144:147], v[164:167], v[52:55]
    v_mfma_f32_16x16x32_bf16 v[56:59], v[144:147], v[168:171], v[56:59]
    ds_read_b128 v[88:91], v3 offset:3456
    v_mfma_f32_16x16x32_bf16 v[60:63], v[144:147], v[172:175], v[60:63]
    v_mfma_f32_16x16x32_bf16 v[52:55], v[148:151], v[160:163], v[52:55]
    ds_read_b128 v[124:127], v4 offset:384
    v_mfma_f32_16x16x32_bf16 v[56:59], v[148:151], v[164:167], v[56:59]
    v_mfma_f32_16x16x32_bf16 v[60:63], v[148:151], v[168:171], v[60:63]
    ds_read_b128 v[92:95], v3 offset:3968
    v_mfma_f32_16x16x32_bf16 v[56:59], v[152:155], v[160:163], v[56:59]
    v_mfma_f32_16x16x32_bf16 v[60:63], v[152:155], v[164:167], v[60:63]
    v_mfma_f32_16x16x32_bf16 v[60:63], v[156:159], v[160:163], v[60:63]
    s_waitcnt lgkmcnt(0)
    s_waitcnt vmcnt(0)
    v_cmp_ne_u32 vcc, 1, v213
    s_nop 0
    s_cbranch_vccnz gated_mix__ssm_conv_h3__compressed_kv_cla__prompt_kernel_spin_l
gated_mix__ssm_conv_h3__compressed_kv_cla__prompt_kernel_spin_l_ret:
    v_mfma_f32_16x16x32_bf16 v[32:35], v[64:67], v[96:99], v[32:35]
    buffer_load_dwordx4 a[64:67], v16, s[16:19], s42 offen offset:0 sc1
    v_mfma_f32_16x16x32_bf16 v[36:39], v[64:67], v[100:103], v[36:39]
    buffer_load_dwordx4 a[68:71], v16, s[16:19], s42 offen offset:1024 sc1
    v_mfma_f32_16x16x32_bf16 v[40:43], v[64:67], v[104:107], v[40:43]
    ds_read_b128 v[160:163], v4 offset:4032
    v_mfma_f32_16x16x32_bf16 v[44:47], v[64:67], v[108:111], v[44:47]
    buffer_load_dwordx4 a[72:75], v16, s[16:19], s42 offen offset:2048 sc1
    v_mfma_f32_16x16x32_bf16 v[48:51], v[64:67], v[112:115], v[48:51]
    ds_read_b128 v[128:131], v3 offset:448
    v_mfma_f32_16x16x32_bf16 v[52:55], v[64:67], v[116:119], v[52:55]
    buffer_load_dwordx4 a[76:79], v16, s[16:19], s42 offen offset:3072 sc1
    v_mfma_f32_16x16x32_bf16 v[56:59], v[64:67], v[120:123], v[56:59]
    ds_read_b128 v[164:167], v4 offset:3520
    s_add_u32 s42, s42, 4096
    v_mfma_f32_16x16x32_bf16 v[60:63], v[64:67], v[124:127], v[60:63]
    buffer_load_dwordx4 a[80:83], v16, s[16:19], s42 offen offset:0 sc1
    v_mfma_f32_16x16x32_bf16 v[36:39], v[68:71], v[96:99], v[36:39]
    ds_read_b128 v[132:135], v3 offset:960
    v_mfma_f32_16x16x32_bf16 v[40:43], v[68:71], v[100:103], v[40:43]
    buffer_load_dwordx4 a[84:87], v16, s[16:19], s42 offen offset:1024 sc1
    v_mfma_f32_16x16x32_bf16 v[44:47], v[68:71], v[104:107], v[44:47]
    ds_read_b128 v[168:171], v4 offset:3008
    v_mfma_f32_16x16x32_bf16 v[48:51], v[68:71], v[108:111], v[48:51]
    buffer_load_dwordx4 a[88:91], v16, s[16:19], s42 offen offset:2048 sc1
    v_mfma_f32_16x16x32_bf16 v[52:55], v[68:71], v[112:115], v[52:55]
    ds_read_b128 v[136:139], v3 offset:1472
    v_mfma_f32_16x16x32_bf16 v[56:59], v[68:71], v[116:119], v[56:59]
    buffer_load_dwordx4 a[92:95], v16, s[16:19], s42 offen offset:3072 sc1
    v_mfma_f32_16x16x32_bf16 v[60:63], v[68:71], v[120:123], v[60:63]
    ds_read_b128 v[172:175], v4 offset:2496
    s_add_u32 s42, s42, 4096
    v_mfma_f32_16x16x32_bf16 v[40:43], v[72:75], v[96:99], v[40:43]
    buffer_load_dwordx4 a[96:99], v16, s[16:19], s42 offen offset:0 sc1
    v_mfma_f32_16x16x32_bf16 v[44:47], v[72:75], v[100:103], v[44:47]
    ds_read_b128 v[140:143], v3 offset:1984
    v_mfma_f32_16x16x32_bf16 v[48:51], v[72:75], v[104:107], v[48:51]
    buffer_load_dwordx4 a[100:103], v16, s[16:19], s42 offen offset:1024 sc1
    v_mfma_f32_16x16x32_bf16 v[52:55], v[72:75], v[108:111], v[52:55]
    ds_read_b128 v[176:179], v4 offset:1984
    v_mfma_f32_16x16x32_bf16 v[56:59], v[72:75], v[112:115], v[56:59]
    v_mfma_f32_16x16x32_bf16 v[60:63], v[72:75], v[116:119], v[60:63]
    ds_read_b128 v[144:147], v3 offset:2496
    v_mfma_f32_16x16x32_bf16 v[44:47], v[76:79], v[96:99], v[44:47]
    v_mfma_f32_16x16x32_bf16 v[48:51], v[76:79], v[100:103], v[48:51]
    ds_read_b128 v[180:183], v4 offset:1472
    v_mfma_f32_16x16x32_bf16 v[52:55], v[76:79], v[104:107], v[52:55]
    v_mfma_f32_16x16x32_bf16 v[56:59], v[76:79], v[108:111], v[56:59]
    ds_read_b128 v[148:151], v3 offset:3008
    v_mfma_f32_16x16x32_bf16 v[60:63], v[76:79], v[112:115], v[60:63]
    v_mfma_f32_16x16x32_bf16 v[48:51], v[80:83], v[96:99], v[48:51]
    ds_read_b128 v[184:187], v4 offset:960
    v_mfma_f32_16x16x32_bf16 v[52:55], v[80:83], v[100:103], v[52:55]
    v_mfma_f32_16x16x32_bf16 v[56:59], v[80:83], v[104:107], v[56:59]
    ds_read_b128 v[152:155], v3 offset:3520
    v_mfma_f32_16x16x32_bf16 v[60:63], v[80:83], v[108:111], v[60:63]
    v_mfma_f32_16x16x32_bf16 v[52:55], v[84:87], v[96:99], v[52:55]
    ds_read_b128 v[188:191], v4 offset:448
    v_mfma_f32_16x16x32_bf16 v[56:59], v[84:87], v[100:103], v[56:59]
    v_mfma_f32_16x16x32_bf16 v[60:63], v[84:87], v[104:107], v[60:63]
    ds_read_b128 v[156:159], v3 offset:4032
    v_mfma_f32_16x16x32_bf16 v[56:59], v[88:91], v[96:99], v[56:59]
    v_mfma_f32_16x16x32_bf16 v[60:63], v[88:91], v[100:103], v[60:63]
    v_mfma_f32_16x16x32_bf16 v[60:63], v[92:95], v[96:99], v[60:63]
    s_waitcnt lgkmcnt(0)
    s_barrier
    v_mfma_f32_16x16x32_bf16 v[32:35], v[128:131], v[160:163], v[32:35]
    ds_read_b64_tr_b16 a[128:129], v198 offset:55296
    ds_read_b64_tr_b16 a[130:131], v198 offset:59904
    v_mfma_f32_16x16x32_bf16 v[36:39], v[128:131], v[164:167], v[36:39]
    ds_read_b64_tr_b16 a[132:133], v199 offset:55296
    ds_read_b64_tr_b16 a[134:135], v199 offset:59904
    v_mfma_f32_16x16x32_bf16 v[40:43], v[128:131], v[168:171], v[40:43]
    ds_read_b64_tr_b16 a[136:137], v200 offset:55296
    ds_read_b64_tr_b16 a[138:139], v200 offset:59904
    v_mfma_f32_16x16x32_bf16 v[44:47], v[128:131], v[172:175], v[44:47]
    ds_read_b64_tr_b16 a[140:141], v201 offset:55296
    ds_read_b64_tr_b16 a[142:143], v201 offset:59904
    v_mfma_f32_16x16x32_bf16 v[48:51], v[128:131], v[176:179], v[48:51]
    ds_read_b64_tr_b16 a[144:145], v198 offset:55424
    ds_read_b64_tr_b16 a[146:147], v198 offset:60032
    v_mfma_f32_16x16x32_bf16 v[52:55], v[128:131], v[180:183], v[52:55]
    ds_read_b64_tr_b16 a[148:149], v199 offset:55424
    ds_read_b64_tr_b16 a[150:151], v199 offset:60032
    v_mfma_f32_16x16x32_bf16 v[56:59], v[128:131], v[184:187], v[56:59]
    ds_read_b64_tr_b16 a[152:153], v200 offset:55424
    ds_read_b64_tr_b16 a[154:155], v200 offset:60032
    v_mfma_f32_16x16x32_bf16 v[60:63], v[128:131], v[188:191], v[60:63]
    ds_read_b64_tr_b16 a[156:157], v201 offset:55424
    ds_read_b64_tr_b16 a[158:159], v201 offset:60032
    s_add_u32 m0, s59, 16384
    v_mfma_f32_16x16x32_bf16 v[36:39], v[132:135], v[160:163], v[36:39]
    buffer_load_dwordx4 v192, s[8:11], s40 offen offset:0 lds
    v_mfma_f32_16x16x32_bf16 v[40:43], v[132:135], v[164:167], v[40:43]
    buffer_load_dwordx4 v193, s[8:11], s40 offen offset:1152 lds
    v_mfma_f32_16x16x32_bf16 v[44:47], v[132:135], v[168:171], v[44:47]
    s_add_u32 s40, s40, 65536
    s_add_u32 m0, s59, 25600
    v_mov_b32 v64, 0
    v_mov_b32 v65, 0
    v_mfma_f32_16x16x32_bf16 v[48:51], v[132:135], v[172:175], v[48:51]
    buffer_load_dwordx4 v192, s[8:11], s40 offen offset:0 lds
    v_mfma_f32_16x16x32_bf16 v[52:55], v[132:135], v[176:179], v[52:55]
    buffer_load_dwordx4 v193, s[8:11], s40 offen offset:1152 lds
    v_mfma_f32_16x16x32_bf16 v[56:59], v[132:135], v[180:183], v[56:59]
    s_add_u32 s40, s40, 65536
    s_add_u32 m0, s59, 34816
    v_mov_b32 v66, 0
    v_mov_b32 v67, 0
    v_mfma_f32_16x16x32_bf16 v[60:63], v[132:135], v[184:187], v[60:63]
    buffer_load_dwordx4 v192, s[8:11], s40 offen offset:0 lds
    v_mfma_f32_16x16x32_bf16 v[40:43], v[136:139], v[160:163], v[40:43]
    buffer_load_dwordx4 v193, s[8:11], s40 offen offset:1152 lds
    v_mfma_f32_16x16x32_bf16 v[44:47], v[136:139], v[164:167], v[44:47]
    s_add_u32 s40, s40, 65536
    s_add_u32 m0, s59, 44032
    v_mov_b32 v68, 0
    v_mov_b32 v69, 0
    v_mfma_f32_16x16x32_bf16 v[48:51], v[136:139], v[168:171], v[48:51]
    buffer_load_dwordx4 v192, s[8:11], s40 offen offset:0 lds
    v_mfma_f32_16x16x32_bf16 v[52:55], v[136:139], v[172:175], v[52:55]
    buffer_load_dwordx4 v193, s[8:11], s40 offen offset:1152 lds
    v_mfma_f32_16x16x32_bf16 v[56:59], v[136:139], v[176:179], v[56:59]
    s_add_u32 s40, s40, 65536
    s_add_u32 m0, s59, 53248
    v_mov_b32 v70, 0
    v_mov_b32 v71, 0
    v_mfma_f32_16x16x32_bf16 v[60:63], v[136:139], v[180:183], v[60:63]
    buffer_load_dwordx4 v192, s[8:11], s40 offen offset:0 lds
    v_mfma_f32_16x16x32_bf16 v[44:47], v[140:143], v[160:163], v[44:47]
    buffer_load_dwordx4 v193, s[8:11], s40 offen offset:1152 lds
    v_mfma_f32_16x16x32_bf16 v[48:51], v[140:143], v[164:167], v[48:51]
    s_add_u32 s40, s40, 65536
    s_add_u32 m0, s59, 62464
    v_mov_b32 v72, 0
    v_mov_b32 v73, 0
    v_mfma_f32_16x16x32_bf16 v[52:55], v[140:143], v[168:171], v[52:55]
    buffer_load_dwordx4 v192, s[8:11], s40 offen offset:0 lds
    v_mfma_f32_16x16x32_bf16 v[56:59], v[140:143], v[172:175], v[56:59]
    buffer_load_dwordx4 v193, s[8:11], s40 offen offset:1152 lds
    v_mfma_f32_16x16x32_bf16 v[60:63], v[140:143], v[176:179], v[60:63]
    s_add_u32 s40, s40, 65536
    s_add_u32 m0, s59, 71680
    v_mov_b32 v74, 0
    v_mov_b32 v75, 0
    v_mfma_f32_16x16x32_bf16 v[48:51], v[144:147], v[160:163], v[48:51]
    buffer_load_dwordx4 v192, s[8:11], s40 offen offset:0 lds
    v_mfma_f32_16x16x32_bf16 v[52:55], v[144:147], v[164:167], v[52:55]
    buffer_load_dwordx4 v193, s[8:11], s40 offen offset:1152 lds
    v_mfma_f32_16x16x32_bf16 v[56:59], v[144:147], v[168:171], v[56:59]
    s_add_u32 s40, s40, 65536
    s_add_u32 m0, s59, 80896
    v_mov_b32 v76, 0
    v_mov_b32 v77, 0
    v_mfma_f32_16x16x32_bf16 v[60:63], v[144:147], v[172:175], v[60:63]
    buffer_load_dwordx4 v192, s[8:11], s40 offen offset:0 lds
    v_mfma_f32_16x16x32_bf16 v[52:55], v[148:151], v[160:163], v[52:55]
    buffer_load_dwordx4 v193, s[8:11], s40 offen offset:1152 lds
    v_mfma_f32_16x16x32_bf16 v[56:59], v[148:151], v[164:167], v[56:59]
    s_add_u32 s40, s40, 65536
    v_mov_b32 v78, 0
    v_mov_b32 v79, 0
    v_mfma_f32_16x16x32_bf16 v[60:63], v[148:151], v[168:171], v[60:63]
    v_mov_b32 v80, 0
    v_mov_b32 v81, 0
    v_mfma_f32_16x16x32_bf16 v[56:59], v[152:155], v[160:163], v[56:59]
    v_mov_b32 v82, 0
    v_mov_b32 v83, 0
    v_mfma_f32_16x16x32_bf16 v[60:63], v[152:155], v[164:167], v[60:63]
    v_mov_b32 v84, 0
    v_mov_b32 v85, 0
    v_mfma_f32_16x16x32_bf16 v[60:63], v[156:159], v[160:163], v[60:63]
    v_mov_b32 v86, 0
    v_mov_b32 v87, 0
    v_mov_b32 v88, 0
    v_mov_b32 v89, 0
    v_mov_b32 v90, 0
    v_mov_b32 v91, 0
    v_mov_b32 v92, 0
    v_mov_b32 v93, 0
    v_mov_b32 v94, 0
    v_mov_b32 v95, 0
    v_mov_b32 v96, 0
    v_mov_b32 v97, 0
    v_mov_b32 v98, 0
    v_mov_b32 v99, 0
    v_mov_b32 v100, 0
    v_mov_b32 v101, 0
    v_mov_b32 v102, 0
    v_mov_b32 v103, 0
    v_mov_b32 v104, 0
    v_mov_b32 v105, 0
    v_mov_b32 v106, 0
    v_mov_b32 v107, 0
    v_mov_b32 v108, 0
    v_mov_b32 v109, 0
    v_mov_b32 v110, 0
    v_mov_b32 v111, 0
    v_mov_b32 v112, 0
    v_mov_b32 v113, 0
    v_mov_b32 v114, 0
    v_mov_b32 v115, 0
    v_mov_b32 v116, 0
    v_mov_b32 v117, 0
    v_mov_b32 v118, 0
    v_mov_b32 v119, 0
    v_mov_b32 v120, 0
    v_mov_b32 v121, 0
    v_mov_b32 v122, 0
    v_mov_b32 v123, 0
    v_mov_b32 v124, 0
    v_mov_b32 v125, 0
    v_mov_b32 v126, 0
    v_mov_b32 v127, 0
    s_nop 4
    v_cvt_pk_bf16_f32 v32, v32, v33
    v_cvt_pk_bf16_f32 v33, v34, v35
    v_cvt_pk_bf16_f32 v36, v36, v37
    v_cvt_pk_bf16_f32 v37, v38, v39
    v_cvt_pk_bf16_f32 v40, v40, v41
    v_cvt_pk_bf16_f32 v41, v42, v43
    v_cvt_pk_bf16_f32 v44, v44, v45
    v_cvt_pk_bf16_f32 v45, v46, v47
    v_cvt_pk_bf16_f32 v48, v48, v49
    v_cvt_pk_bf16_f32 v49, v50, v51
    v_cvt_pk_bf16_f32 v52, v52, v53
    v_cvt_pk_bf16_f32 v53, v54, v55
    v_cvt_pk_bf16_f32 v56, v56, v57
    v_cvt_pk_bf16_f32 v57, v58, v59
    v_cvt_pk_bf16_f32 v60, v60, v61
    v_cvt_pk_bf16_f32 v61, v62, v63
    buffer_store_dwordx2 v[32:33], v5, s[12:15], s44 offen offset:0 sc1
    buffer_store_dwordx2 v[36:37], v5, s[12:15], s44 offen offset:512 sc1
    buffer_store_dwordx2 v[40:41], v5, s[12:15], s44 offen offset:1024 sc1
    buffer_store_dwordx2 v[44:45], v5, s[12:15], s44 offen offset:1536 sc1
    buffer_store_dwordx2 v[48:49], v5, s[12:15], s44 offen offset:2048 sc1
    buffer_store_dwordx2 v[52:53], v5, s[12:15], s44 offen offset:2560 sc1
    buffer_store_dwordx2 v[56:57], v5, s[12:15], s44 offen offset:3072 sc1
    buffer_store_dwordx2 v[60:61], v5, s[12:15], s44 offen offset:3584 sc1
    s_mov_b32 s35, 0
    s_waitcnt vmcnt(33) lgkmcnt(0)
    s_nop 0
    s_nop 0
    s_nop 0
    s_nop 0
    s_nop 0
    s_nop 0
    s_nop 0
    s_nop 0
    s_nop 0
    s_nop 0
    s_nop 0
    s_nop 0
gated_mix__ssm_conv_h3__compressed_kv_cla__prompt_kernel_oloop:
    v_mfma_f32_16x16x32_bf16 v[64:67], a[128:131], a[0:3], v[64:67]
    ds_read_b64_tr_b16 a[160:161], v202 offset:0
    ds_read_b64_tr_b16 a[162:163], v202 offset:4608
    v_mfma_f32_16x16x32_bf16 v[68:71], a[128:131], a[64:67], v[68:71]
    buffer_load_dwordx4 a[60:63], v16, s[16:19], s41 offen offset:3072 sc1
    v_mfma_f32_16x16x32_bf16 v[72:75], a[132:135], a[0:3], v[72:75]
    s_add_u32 s41, s41, 4096
    ds_read_b64_tr_b16 a[164:165], v203 offset:0
    ds_read_b64_tr_b16 a[166:167], v203 offset:4608
    v_mfma_f32_16x16x32_bf16 v[76:79], a[132:135], a[64:67], v[76:79]
    s_add_u32 m0, s59, 90112
    ds_read_b64_tr_b16 a[168:169], v204 offset:0
    ds_read_b64_tr_b16 a[170:171], v204 offset:4608
    v_mfma_f32_16x16x32_bf16 v[80:83], a[136:139], a[0:3], v[80:83]
    ds_read_b64_tr_b16 a[172:173], v205 offset:0
    ds_read_b64_tr_b16 a[174:175], v205 offset:4608
    v_mfma_f32_16x16x32_bf16 v[84:87], a[136:139], a[64:67], v[84:87]
    buffer_load_dwordx4 v192, s[8:11], s40 offen offset:0 lds
    v_mfma_f32_16x16x32_bf16 v[88:91], a[140:143], a[0:3], v[88:91]
    ds_read_b64_tr_b16 a[176:177], v202 offset:128
    ds_read_b64_tr_b16 a[178:179], v202 offset:4736
    v_mfma_f32_16x16x32_bf16 v[92:95], a[140:143], a[64:67], v[92:95]
    ds_read_b64_tr_b16 a[180:181], v203 offset:128
    ds_read_b64_tr_b16 a[182:183], v203 offset:4736
    v_mfma_f32_16x16x32_bf16 v[96:99], a[144:147], a[0:3], v[96:99]
    ds_read_b64_tr_b16 a[184:185], v204 offset:128
    ds_read_b64_tr_b16 a[186:187], v204 offset:4736
    v_mfma_f32_16x16x32_bf16 v[100:103], a[144:147], a[64:67], v[100:103]
    buffer_load_dwordx4 a[104:107], v16, s[16:19], s42 offen offset:2048 sc1
    v_mfma_f32_16x16x32_bf16 v[104:107], a[148:151], a[0:3], v[104:107]
    ds_read_b64_tr_b16 a[188:189], v205 offset:128
    ds_read_b64_tr_b16 a[190:191], v205 offset:4736
    v_mfma_f32_16x16x32_bf16 v[108:111], a[148:151], a[64:67], v[108:111]
    v_mfma_f32_16x16x32_bf16 v[112:115], a[152:155], a[0:3], v[112:115]
    v_mfma_f32_16x16x32_bf16 v[116:119], a[152:155], a[64:67], v[116:119]
    buffer_load_dwordx4 v193, s[8:11], s40 offen offset:1152 lds
    v_mfma_f32_16x16x32_bf16 v[120:123], a[156:159], a[0:3], v[120:123]
    s_add_u32 s40, s40, 65536
    v_mfma_f32_16x16x32_bf16 v[124:127], a[156:159], a[64:67], v[124:127]
    s_waitcnt vmcnt(24) lgkmcnt(0)
    s_barrier
    v_mfma_f32_16x16x32_bf16 v[64:67], a[160:163], a[4:7], v[64:67]
    ds_read_b64_tr_b16 a[128:129], v202 offset:9216
    ds_read_b64_tr_b16 a[130:131], v202 offset:13824
    v_mfma_f32_16x16x32_bf16 v[68:71], a[160:163], a[68:71], v[68:71]
    buffer_load_dwordx4 a[0:3], v16, s[16:19], s41 offen offset:0 sc1
    v_mfma_f32_16x16x32_bf16 v[72:75], a[164:167], a[4:7], v[72:75]
    ds_read_b64_tr_b16 a[132:133], v203 offset:9216
    ds_read_b64_tr_b16 a[134:135], v203 offset:13824
    v_mfma_f32_16x16x32_bf16 v[76:79], a[164:167], a[68:71], v[76:79]
    s_add_u32 m0, s59, 99328
    ds_read_b64_tr_b16 a[136:137], v204 offset:9216
    ds_read_b64_tr_b16 a[138:139], v204 offset:13824
    v_mfma_f32_16x16x32_bf16 v[80:83], a[168:171], a[4:7], v[80:83]
    ds_read_b64_tr_b16 a[140:141], v205 offset:9216
    ds_read_b64_tr_b16 a[142:143], v205 offset:13824
    v_mfma_f32_16x16x32_bf16 v[84:87], a[168:171], a[68:71], v[84:87]
    buffer_load_dwordx4 v192, s[8:11], s40 offen offset:0 lds
    v_mfma_f32_16x16x32_bf16 v[88:91], a[172:175], a[4:7], v[88:91]
    ds_read_b64_tr_b16 a[144:145], v202 offset:9344
    ds_read_b64_tr_b16 a[146:147], v202 offset:13952
    v_mfma_f32_16x16x32_bf16 v[92:95], a[172:175], a[68:71], v[92:95]
    ds_read_b64_tr_b16 a[148:149], v203 offset:9344
    ds_read_b64_tr_b16 a[150:151], v203 offset:13952
    v_mfma_f32_16x16x32_bf16 v[96:99], a[176:179], a[4:7], v[96:99]
    ds_read_b64_tr_b16 a[152:153], v204 offset:9344
    ds_read_b64_tr_b16 a[154:155], v204 offset:13952
    v_mfma_f32_16x16x32_bf16 v[100:103], a[176:179], a[68:71], v[100:103]
    buffer_load_dwordx4 a[108:111], v16, s[16:19], s42 offen offset:3072 sc1
    v_mfma_f32_16x16x32_bf16 v[104:107], a[180:183], a[4:7], v[104:107]
    s_add_u32 s42, s42, 4096
    ds_read_b64_tr_b16 a[156:157], v205 offset:9344
    ds_read_b64_tr_b16 a[158:159], v205 offset:13952
    v_mfma_f32_16x16x32_bf16 v[108:111], a[180:183], a[68:71], v[108:111]
    v_mfma_f32_16x16x32_bf16 v[112:115], a[184:187], a[4:7], v[112:115]
    v_mfma_f32_16x16x32_bf16 v[116:119], a[184:187], a[68:71], v[116:119]
    buffer_load_dwordx4 v193, s[8:11], s40 offen offset:1152 lds
    v_mfma_f32_16x16x32_bf16 v[120:123], a[188:191], a[4:7], v[120:123]
    s_add_u32 s40, s40, 65536
    v_mfma_f32_16x16x32_bf16 v[124:127], a[188:191], a[68:71], v[124:127]
    s_waitcnt lgkmcnt(0)
    v_mfma_f32_16x16x32_bf16 v[64:67], a[128:131], a[8:11], v[64:67]
gated_mix__ssm_conv_h3__compressed_kv_cla__prompt_kernel_pad12:
    s_cbranch_execz gated_mix__ssm_conv_h3__compressed_kv_cla__prompt_kernel_pad16
    ds_read_b64_tr_b16 a[160:161], v194 offset:0
    ds_read_b64_tr_b16 a[162:163], v194 offset:4608
    v_mfma_f32_16x16x32_bf16 v[68:71], a[128:131], a[72:75], v[68:71]
    buffer_load_dwordx4 a[4:7], v16, s[16:19], s41 offen offset:1024 sc1
    v_mfma_f32_16x16x32_bf16 v[72:75], a[132:135], a[8:11], v[72:75]
    ds_read_b64_tr_b16 a[164:165], v195 offset:0
    ds_read_b64_tr_b16 a[166:167], v195 offset:4608
    v_mfma_f32_16x16x32_bf16 v[76:79], a[132:135], a[72:75], v[76:79]
    s_add_u32 m0, s59, 108544
    ds_read_b64_tr_b16 a[168:169], v196 offset:0
    ds_read_b64_tr_b16 a[170:171], v196 offset:4608
    v_mfma_f32_16x16x32_bf16 v[80:83], a[136:139], a[8:11], v[80:83]
    ds_read_b64_tr_b16 a[172:173], v197 offset:0
    ds_read_b64_tr_b16 a[174:175], v197 offset:4608
    v_mfma_f32_16x16x32_bf16 v[84:87], a[136:139], a[72:75], v[84:87]
    buffer_load_dwordx4 v192, s[8:11], s40 offen offset:0 lds
    v_mfma_f32_16x16x32_bf16 v[88:91], a[140:143], a[8:11], v[88:91]
    ds_read_b64_tr_b16 a[176:177], v194 offset:128
    ds_read_b64_tr_b16 a[178:179], v194 offset:4736
    v_mfma_f32_16x16x32_bf16 v[92:95], a[140:143], a[72:75], v[92:95]
    ds_read_b64_tr_b16 a[180:181], v195 offset:128
    ds_read_b64_tr_b16 a[182:183], v195 offset:4736
    v_mfma_f32_16x16x32_bf16 v[96:99], a[144:147], a[8:11], v[96:99]
    ds_read_b64_tr_b16 a[184:185], v196 offset:128
    ds_read_b64_tr_b16 a[186:187], v196 offset:4736
    v_mfma_f32_16x16x32_bf16 v[100:103], a[144:147], a[72:75], v[100:103]
    buffer_load_dwordx4 a[112:115], v16, s[16:19], s42 offen offset:0 sc1
    v_mfma_f32_16x16x32_bf16 v[104:107], a[148:151], a[8:11], v[104:107]
    ds_read_b64_tr_b16 a[188:189], v197 offset:128
    ds_read_b64_tr_b16 a[190:191], v197 offset:4736
    v_mfma_f32_16x16x32_bf16 v[108:111], a[148:151], a[72:75], v[108:111]
    v_mfma_f32_16x16x32_bf16 v[112:115], a[152:155], a[8:11], v[112:115]
    v_mfma_f32_16x16x32_bf16 v[116:119], a[152:155], a[72:75], v[116:119]
    buffer_load_dwordx4 v193, s[8:11], s40 offen offset:1152 lds
    v_mfma_f32_16x16x32_bf16 v[120:123], a[156:159], a[8:11], v[120:123]
    s_add_u32 s40, s40, 65536
    v_mfma_f32_16x16x32_bf16 v[124:127], a[156:159], a[72:75], v[124:127]
    s_waitcnt vmcnt(24) lgkmcnt(0)
    s_barrier
    v_mfma_f32_16x16x32_bf16 v[64:67], a[160:163], a[12:15], v[64:67]
    ds_read_b64_tr_b16 a[128:129], v194 offset:9216
    ds_read_b64_tr_b16 a[130:131], v194 offset:13824
    v_mfma_f32_16x16x32_bf16 v[68:71], a[160:163], a[76:79], v[68:71]
    buffer_load_dwordx4 a[8:11], v16, s[16:19], s41 offen offset:2048 sc1
    v_mfma_f32_16x16x32_bf16 v[72:75], a[164:167], a[12:15], v[72:75]
    ds_read_b64_tr_b16 a[132:133], v195 offset:9216
    ds_read_b64_tr_b16 a[134:135], v195 offset:13824
    v_mfma_f32_16x16x32_bf16 v[76:79], a[164:167], a[76:79], v[76:79]
    s_add_u32 m0, s59, 117760
    ds_read_b64_tr_b16 a[136:137], v196 offset:9216
    ds_read_b64_tr_b16 a[138:139], v196 offset:13824
    v_mfma_f32_16x16x32_bf16 v[80:83], a[168:171], a[12:15], v[80:83]
    ds_read_b64_tr_b16 a[140:141], v197 offset:9216
    ds_read_b64_tr_b16 a[142:143], v197 offset:13824
    v_mfma_f32_16x16x32_bf16 v[84:87], a[168:171], a[76:79], v[84:87]
    buffer_load_dwordx4 v192, s[8:11], s40 offen offset:0 lds
    v_mfma_f32_16x16x32_bf16 v[88:91], a[172:175], a[12:15], v[88:91]
    ds_read_b64_tr_b16 a[144:145], v194 offset:9344
    ds_read_b64_tr_b16 a[146:147], v194 offset:13952
    v_mfma_f32_16x16x32_bf16 v[92:95], a[172:175], a[76:79], v[92:95]
    ds_read_b64_tr_b16 a[148:149], v195 offset:9344
    ds_read_b64_tr_b16 a[150:151], v195 offset:13952
    v_mfma_f32_16x16x32_bf16 v[96:99], a[176:179], a[12:15], v[96:99]
    ds_read_b64_tr_b16 a[152:153], v196 offset:9344
    ds_read_b64_tr_b16 a[154:155], v196 offset:13952
    v_mfma_f32_16x16x32_bf16 v[100:103], a[176:179], a[76:79], v[100:103]
    buffer_load_dwordx4 a[116:119], v16, s[16:19], s42 offen offset:1024 sc1
    v_mfma_f32_16x16x32_bf16 v[104:107], a[180:183], a[12:15], v[104:107]
    ds_read_b64_tr_b16 a[156:157], v197 offset:9344
    ds_read_b64_tr_b16 a[158:159], v197 offset:13952
    v_mfma_f32_16x16x32_bf16 v[108:111], a[180:183], a[76:79], v[108:111]
    v_mfma_f32_16x16x32_bf16 v[112:115], a[184:187], a[12:15], v[112:115]
    v_mfma_f32_16x16x32_bf16 v[116:119], a[184:187], a[76:79], v[116:119]
    buffer_load_dwordx4 v193, s[8:11], s40 offen offset:1152 lds
    v_mfma_f32_16x16x32_bf16 v[120:123], a[188:191], a[12:15], v[120:123]
    s_add_u32 s40, s40, 65536
    v_mfma_f32_16x16x32_bf16 v[124:127], a[188:191], a[76:79], v[124:127]
    s_waitcnt lgkmcnt(0)
    v_mfma_f32_16x16x32_bf16 v[64:67], a[128:131], a[16:19], v[64:67]
    ds_read_b64_tr_b16 a[160:161], v194 offset:18432
    ds_read_b64_tr_b16 a[162:163], v194 offset:23040
    v_mfma_f32_16x16x32_bf16 v[68:71], a[128:131], a[80:83], v[68:71]
    buffer_load_dwordx4 a[12:15], v16, s[16:19], s41 offen offset:3072 sc1
    v_mfma_f32_16x16x32_bf16 v[72:75], a[132:135], a[16:19], v[72:75]
    s_add_u32 s41, s41, 4096
    ds_read_b64_tr_b16 a[164:165], v195 offset:18432
    ds_read_b64_tr_b16 a[166:167], v195 offset:23040
    v_mfma_f32_16x16x32_bf16 v[76:79], a[132:135], a[80:83], v[76:79]
    s_add_u32 m0, s59, 126976
    ds_read_b64_tr_b16 a[168:169], v196 offset:18432
    ds_read_b64_tr_b16 a[170:171], v196 offset:23040
    v_mfma_f32_16x16x32_bf16 v[80:83], a[136:139], a[16:19], v[80:83]
    ds_read_b64_tr_b16 a[172:173], v197 offset:18432
    ds_read_b64_tr_b16 a[174:175], v197 offset:23040
    v_mfma_f32_16x16x32_bf16 v[84:87], a[136:139], a[80:83], v[84:87]
    buffer_load_dwordx4 v192, s[8:11], s40 offen offset:0 lds
    v_mfma_f32_16x16x32_bf16 v[88:91], a[140:143], a[16:19], v[88:91]
    ds_read_b64_tr_b16 a[176:177], v194 offset:18560
    ds_read_b64_tr_b16 a[178:179], v194 offset:23168
    v_mfma_f32_16x16x32_bf16 v[92:95], a[140:143], a[80:83], v[92:95]
    ds_read_b64_tr_b16 a[180:181], v195 offset:18560
    ds_read_b64_tr_b16 a[182:183], v195 offset:23168
    v_mfma_f32_16x16x32_bf16 v[96:99], a[144:147], a[16:19], v[96:99]
    ds_read_b64_tr_b16 a[184:185], v196 offset:18560
    ds_read_b64_tr_b16 a[186:187], v196 offset:23168
    v_mfma_f32_16x16x32_bf16 v[100:103], a[144:147], a[80:83], v[100:103]
    buffer_load_dwordx4 a[120:123], v16, s[16:19], s42 offen offset:2048 sc1
    v_mfma_f32_16x16x32_bf16 v[104:107], a[148:151], a[16:19], v[104:107]
    ds_read_b64_tr_b16 a[188:189], v197 offset:18560
    ds_read_b64_tr_b16 a[190:191], v197 offset:23168
    v_mfma_f32_16x16x32_bf16 v[108:111], a[148:151], a[80:83], v[108:111]
    v_mfma_f32_16x16x32_bf16 v[112:115], a[152:155], a[16:19], v[112:115]
    v_mfma_f32_16x16x32_bf16 v[116:119], a[152:155], a[80:83], v[116:119]
    buffer_load_dwordx4 v193, s[8:11], s40 offen offset:1152 lds
    v_mfma_f32_16x16x32_bf16 v[120:123], a[156:159], a[16:19], v[120:123]
    s_add_u32 s40, s40, 65536
    v_mfma_f32_16x16x32_bf16 v[124:127], a[156:159], a[80:83], v[124:127]
    s_waitcnt vmcnt(24) lgkmcnt(0)
    s_barrier
    v_mfma_f32_16x16x32_bf16 v[64:67], a[160:163], a[20:23], v[64:67]
    ds_read_b64_tr_b16 a[128:129], v194 offset:27648
    ds_read_b64_tr_b16 a[130:131], v194 offset:32256
    v_mfma_f32_16x16x32_bf16 v[68:71], a[160:163], a[84:87], v[68:71]
    buffer_load_dwordx4 a[16:19], v16, s[16:19], s41 offen offset:0 sc1
    v_mfma_f32_16x16x32_bf16 v[72:75], a[164:167], a[20:23], v[72:75]
    ds_read_b64_tr_b16 a[132:133], v195 offset:27648
    ds_read_b64_tr_b16 a[134:135], v195 offset:32256
    v_mfma_f32_16x16x32_bf16 v[76:79], a[164:167], a[84:87], v[76:79]
    s_add_u32 m0, s59, 136192
    ds_read_b64_tr_b16 a[136:137], v196 offset:27648
    ds_read_b64_tr_b16 a[138:139], v196 offset:32256
    v_mfma_f32_16x16x32_bf16 v[80:83], a[168:171], a[20:23], v[80:83]
    ds_read_b64_tr_b16 a[140:141], v197 offset:27648
    ds_read_b64_tr_b16 a[142:143], v197 offset:32256
    v_mfma_f32_16x16x32_bf16 v[84:87], a[168:171], a[84:87], v[84:87]
    buffer_load_dwordx4 v192, s[8:11], s40 offen offset:0 lds
    v_mfma_f32_16x16x32_bf16 v[88:91], a[172:175], a[20:23], v[88:91]
    ds_read_b64_tr_b16 a[144:145], v194 offset:27776
    ds_read_b64_tr_b16 a[146:147], v194 offset:32384
    v_mfma_f32_16x16x32_bf16 v[92:95], a[172:175], a[84:87], v[92:95]
    ds_read_b64_tr_b16 a[148:149], v195 offset:27776
    ds_read_b64_tr_b16 a[150:151], v195 offset:32384
    v_mfma_f32_16x16x32_bf16 v[96:99], a[176:179], a[20:23], v[96:99]
    ds_read_b64_tr_b16 a[152:153], v196 offset:27776
    ds_read_b64_tr_b16 a[154:155], v196 offset:32384
    v_mfma_f32_16x16x32_bf16 v[100:103], a[176:179], a[84:87], v[100:103]
    buffer_load_dwordx4 a[124:127], v16, s[16:19], s42 offen offset:3072 sc1
    v_mfma_f32_16x16x32_bf16 v[104:107], a[180:183], a[20:23], v[104:107]
    s_add_u32 s42, s42, 4096
    ds_read_b64_tr_b16 a[156:157], v197 offset:27776
    ds_read_b64_tr_b16 a[158:159], v197 offset:32384
    v_mfma_f32_16x16x32_bf16 v[108:111], a[180:183], a[84:87], v[108:111]
    s_cmp_lg_u32 s35, 0
    v_mfma_f32_16x16x32_bf16 v[112:115], a[184:187], a[20:23], v[112:115]
    s_cbranch_scc1 gated_mix__ssm_conv_h3__compressed_kv_cla__prompt_kernel_hook
gated_mix__ssm_conv_h3__compressed_kv_cla__prompt_kernel_hook_ret:
    v_mfma_f32_16x16x32_bf16 v[116:119], a[184:187], a[84:87], v[116:119]
    buffer_load_dwordx4 v193, s[8:11], s40 offen offset:1152 lds
    v_mfma_f32_16x16x32_bf16 v[120:123], a[188:191], a[20:23], v[120:123]
    s_add_u32 s40, s40, 65536
    v_mfma_f32_16x16x32_bf16 v[124:127], a[188:191], a[84:87], v[124:127]
    s_waitcnt lgkmcnt(0)
    v_mfma_f32_16x16x32_bf16 v[64:67], a[128:131], a[24:27], v[64:67]
    ds_read_b64_tr_b16 a[160:161], v194 offset:36864
    ds_read_b64_tr_b16 a[162:163], v194 offset:41472
    v_mfma_f32_16x16x32_bf16 v[68:71], a[128:131], a[88:91], v[68:71]
    buffer_load_dwordx4 a[20:23], v16, s[16:19], s41 offen offset:1024 sc1
    v_mfma_f32_16x16x32_bf16 v[72:75], a[132:135], a[24:27], v[72:75]
    ds_read_b64_tr_b16 a[164:165], v195 offset:36864
    ds_read_b64_tr_b16 a[166:167], v195 offset:41472
    v_mfma_f32_16x16x32_bf16 v[76:79], a[132:135], a[88:91], v[76:79]
    s_add_u32 m0, s59, 145408
    ds_read_b64_tr_b16 a[168:169], v196 offset:36864
    ds_read_b64_tr_b16 a[170:171], v196 offset:41472
    v_mfma_f32_16x16x32_bf16 v[80:83], a[136:139], a[24:27], v[80:83]
    ds_read_b64_tr_b16 a[172:173], v197 offset:36864
    ds_read_b64_tr_b16 a[174:175], v197 offset:41472
    v_mfma_f32_16x16x32_bf16 v[84:87], a[136:139], a[88:91], v[84:87]
    buffer_load_dwordx4 v192, s[8:11], s40 offen offset:0 lds
    v_mfma_f32_16x16x32_bf16 v[88:91], a[140:143], a[24:27], v[88:91]
    ds_read_b64_tr_b16 a[176:177], v194 offset:36992
    ds_read_b64_tr_b16 a[178:179], v194 offset:41600
    v_mfma_f32_16x16x32_bf16 v[92:95], a[140:143], a[88:91], v[92:95]
    ds_read_b64_tr_b16 a[180:181], v195 offset:36992
    ds_read_b64_tr_b16 a[182:183], v195 offset:41600
    v_mfma_f32_16x16x32_bf16 v[96:99], a[144:147], a[24:27], v[96:99]
    ds_read_b64_tr_b16 a[184:185], v196 offset:36992
    ds_read_b64_tr_b16 a[186:187], v196 offset:41600
    v_mfma_f32_16x16x32_bf16 v[100:103], a[144:147], a[88:91], v[100:103]
    buffer_load_dwordx4 a[64:67], v16, s[16:19], s42 offen offset:0 sc1
    v_mfma_f32_16x16x32_bf16 v[104:107], a[148:151], a[24:27], v[104:107]
    ds_read_b64_tr_b16 a[188:189], v197 offset:36992
    ds_read_b64_tr_b16 a[190:191], v197 offset:41600
    v_mfma_f32_16x16x32_bf16 v[108:111], a[148:151], a[88:91], v[108:111]
    v_mfma_f32_16x16x32_bf16 v[112:115], a[152:155], a[24:27], v[112:115]
    v_mfma_f32_16x16x32_bf16 v[116:119], a[152:155], a[88:91], v[116:119]
    buffer_load_dwordx4 v193, s[8:11], s40 offen offset:1152 lds
    v_mfma_f32_16x16x32_bf16 v[120:123], a[156:159], a[24:27], v[120:123]
    s_add_u32 s40, s40, 65536
    v_mfma_f32_16x16x32_bf16 v[124:127], a[156:159], a[88:91], v[124:127]
    s_waitcnt vmcnt(24) lgkmcnt(0)
    s_barrier
    v_mfma_f32_16x16x32_bf16 v[64:67], a[160:163], a[28:31], v[64:67]
    ds_read_b64_tr_b16 a[128:129], v194 offset:46080
    ds_read_b64_tr_b16 a[130:131], v194 offset:50688
    v_mfma_f32_16x16x32_bf16 v[68:71], a[160:163], a[92:95], v[68:71]
    buffer_load_dwordx4 a[24:27], v16, s[16:19], s41 offen offset:2048 sc1
    v_mfma_f32_16x16x32_bf16 v[72:75], a[164:167], a[28:31], v[72:75]
    ds_read_b64_tr_b16 a[132:133], v195 offset:46080
    ds_read_b64_tr_b16 a[134:135], v195 offset:50688
    v_mfma_f32_16x16x32_bf16 v[76:79], a[164:167], a[92:95], v[76:79]
    s_add_u32 m0, s59, 154624
    ds_read_b64_tr_b16 a[136:137], v196 offset:46080
    ds_read_b64_tr_b16 a[138:139], v196 offset:50688
    v_mfma_f32_16x16x32_bf16 v[80:83], a[168:171], a[28:31], v[80:83]
    ds_read_b64_tr_b16 a[140:141], v197 offset:46080
    ds_read_b64_tr_b16 a[142:143], v197 offset:50688
    v_mfma_f32_16x16x32_bf16 v[84:87], a[168:171], a[92:95], v[84:87]
    buffer_load_dwordx4 v192, s[8:11], s40 offen offset:0 lds
    v_mfma_f32_16x16x32_bf16 v[88:91], a[172:175], a[28:31], v[88:91]
    ds_read_b64_tr_b16 a[144:145], v194 offset:46208
    ds_read_b64_tr_b16 a[146:147], v194 offset:50816
    v_mfma_f32_16x16x32_bf16 v[92:95], a[172:175], a[92:95], v[92:95]
    ds_read_b64_tr_b16 a[148:149], v195 offset:46208
    ds_read_b64_tr_b16 a[150:151], v195 offset:50816
    v_mfma_f32_16x16x32_bf16 v[96:99], a[176:179], a[28:31], v[96:99]
    ds_read_b64_tr_b16 a[152:153], v196 offset:46208
    ds_read_b64_tr_b16 a[154:155], v196 offset:50816
    v_mfma_f32_16x16x32_bf16 v[100:103], a[176:179], a[92:95], v[100:103]
    buffer_load_dwordx4 a[68:71], v16, s[16:19], s42 offen offset:1024 sc1
    v_mfma_f32_16x16x32_bf16 v[104:107], a[180:183], a[28:31], v[104:107]
    ds_read_b64_tr_b16 a[156:157], v197 offset:46208
    ds_read_b64_tr_b16 a[158:159], v197 offset:50816
    v_mfma_f32_16x16x32_bf16 v[108:111], a[180:183], a[92:95], v[108:111]
    v_mfma_f32_16x16x32_bf16 v[112:115], a[184:187], a[28:31], v[112:115]
    v_mfma_f32_16x16x32_bf16 v[116:119], a[184:187], a[92:95], v[116:119]
    buffer_load_dwordx4 v193, s[8:11], s40 offen offset:1152 lds
    v_mfma_f32_16x16x32_bf16 v[120:123], a[188:191], a[28:31], v[120:123]
    s_add_u32 s40, s40, 65536
    v_mfma_f32_16x16x32_bf16 v[124:127], a[188:191], a[92:95], v[124:127]
    s_waitcnt lgkmcnt(0)
    v_mfma_f32_16x16x32_bf16 v[64:67], a[128:131], a[32:35], v[64:67]
    ds_read_b64_tr_b16 a[160:161], v194 offset:55296
    ds_read_b64_tr_b16 a[162:163], v194 offset:59904
    v_mfma_f32_16x16x32_bf16 v[68:71], a[128:131], a[96:99], v[68:71]
    buffer_load_dwordx4 a[28:31], v16, s[16:19], s41 offen offset:3072 sc1
    v_mfma_f32_16x16x32_bf16 v[72:75], a[132:135], a[32:35], v[72:75]
    s_add_u32 s41, s41, 4096
    ds_read_b64_tr_b16 a[164:165], v195 offset:55296
    ds_read_b64_tr_b16 a[166:167], v195 offset:59904
    v_mfma_f32_16x16x32_bf16 v[76:79], a[132:135], a[96:99], v[76:79]
    s_add_u32 m0, s59, 16384
    ds_read_b64_tr_b16 a[168:169], v196 offset:55296
    ds_read_b64_tr_b16 a[170:171], v196 offset:59904
    v_mfma_f32_16x16x32_bf16 v[80:83], a[136:139], a[32:35], v[80:83]
    ds_read_b64_tr_b16 a[172:173], v197 offset:55296
    ds_read_b64_tr_b16 a[174:175], v197 offset:59904
    v_mfma_f32_16x16x32_bf16 v[84:87], a[136:139], a[96:99], v[84:87]
    buffer_load_dwordx4 v192, s[8:11], s40 offen offset:0 lds
    v_mfma_f32_16x16x32_bf16 v[88:91], a[140:143], a[32:35], v[88:91]
    ds_read_b64_tr_b16 a[176:177], v194 offset:55424
    ds_read_b64_tr_b16 a[178:179], v194 offset:60032
    v_mfma_f32_16x16x32_bf16 v[92:95], a[140:143], a[96:99], v[92:95]
    ds_read_b64_tr_b16 a[180:181], v195 offset:55424
    ds_read_b64_tr_b16 a[182:183], v195 offset:60032
    v_mfma_f32_16x16x32_bf16 v[96:99], a[144:147], a[32:35], v[96:99]
    ds_read_b64_tr_b16 a[184:185], v196 offset:55424
    ds_read_b64_tr_b16 a[186:187], v196 offset:60032
    v_mfma_f32_16x16x32_bf16 v[100:103], a[144:147], a[96:99], v[100:103]
    buffer_load_dwordx4 a[72:75], v16, s[16:19], s42 offen offset:2048 sc1
    v_mfma_f32_16x16x32_bf16 v[104:107], a[148:151], a[32:35], v[104:107]
    ds_read_b64_tr_b16 a[188:189], v197 offset:55424
    ds_read_b64_tr_b16 a[190:191], v197 offset:60032
    v_mfma_f32_16x16x32_bf16 v[108:111], a[148:151], a[96:99], v[108:111]
    v_mfma_f32_16x16x32_bf16 v[112:115], a[152:155], a[32:35], v[112:115]
    v_mfma_f32_16x16x32_bf16 v[116:119], a[152:155], a[96:99], v[116:119]
    buffer_load_dwordx4 v193, s[8:11], s40 offen offset:1152 lds
    v_mfma_f32_16x16x32_bf16 v[120:123], a[156:159], a[32:35], v[120:123]
    s_add_u32 s40, s40, 65536
    v_mfma_f32_16x16x32_bf16 v[124:127], a[156:159], a[96:99], v[124:127]
    s_waitcnt vmcnt(24) lgkmcnt(0)
    s_barrier
    v_mfma_f32_16x16x32_bf16 v[64:67], a[160:163], a[36:39], v[64:67]
    ds_read_b64_tr_b16 a[128:129], v198 offset:0
    ds_read_b64_tr_b16 a[130:131], v198 offset:4608
    v_mfma_f32_16x16x32_bf16 v[68:71], a[160:163], a[100:103], v[68:71]
    buffer_load_dwordx4 a[32:35], v16, s[16:19], s41 offen offset:0 sc1
    v_mfma_f32_16x16x32_bf16 v[72:75], a[164:167], a[36:39], v[72:75]
    ds_read_b64_tr_b16 a[132:133], v199 offset:0
    ds_read_b64_tr_b16 a[134:135], v199 offset:4608
    v_mfma_f32_16x16x32_bf16 v[76:79], a[164:167], a[100:103], v[76:79]
    s_add_u32 m0, s59, 25600
    ds_read_b64_tr_b16 a[136:137], v200 offset:0
    ds_read_b64_tr_b16 a[138:139], v200 offset:4608
    v_mfma_f32_16x16x32_bf16 v[80:83], a[168:171], a[36:39], v[80:83]
    ds_read_b64_tr_b16 a[140:141], v201 offset:0
    ds_read_b64_tr_b16 a[142:143], v201 offset:4608
    v_mfma_f32_16x16x32_bf16 v[84:87], a[168:171], a[100:103], v[84:87]
    buffer_load_dwordx4 v192, s[8:11], s40 offen offset:0 lds
    v_mfma_f32_16x16x32_bf16 v[88:91], a[172:175], a[36:39], v[88:91]
    ds_read_b64_tr_b16 a[144:145], v198 offset:128
    ds_read_b64_tr_b16 a[146:147], v198 offset:4736
    v_mfma_f32_16x16x32_bf16 v[92:95], a[172:175], a[100:103], v[92:95]
    ds_read_b64_tr_b16 a[148:149], v199 offset:128
    ds_read_b64_tr_b16 a[150:151], v199 offset:4736
    v_mfma_f32_16x16x32_bf16 v[96:99], a[176:179], a[36:39], v[96:99]
    ds_read_b64_tr_b16 a[152:153], v200 offset:128
    ds_read_b64_tr_b16 a[154:155], v200 offset:4736
    v_mfma_f32_16x16x32_bf16 v[100:103], a[176:179], a[100:103], v[100:103]
    buffer_load_dwordx4 a[76:79], v16, s[16:19], s42 offen offset:3072 sc1
    v_mfma_f32_16x16x32_bf16 v[104:107], a[180:183], a[36:39], v[104:107]
    s_add_u32 s42, s42, 4096
    ds_read_b64_tr_b16 a[156:157], v201 offset:128
    ds_read_b64_tr_b16 a[158:159], v201 offset:4736
    v_mfma_f32_16x16x32_bf16 v[108:111], a[180:183], a[100:103], v[108:111]
    v_mfma_f32_16x16x32_bf16 v[112:115], a[184:187], a[36:39], v[112:115]
    v_mfma_f32_16x16x32_bf16 v[116:119], a[184:187], a[100:103], v[116:119]
    buffer_load_dwordx4 v193, s[8:11], s40 offen offset:1152 lds
    v_mfma_f32_16x16x32_bf16 v[120:123], a[188:191], a[36:39], v[120:123]
    s_add_u32 s40, s40, 65536
    v_mfma_f32_16x16x32_bf16 v[124:127], a[188:191], a[100:103], v[124:127]
    s_waitcnt lgkmcnt(0)
    v_mfma_f32_16x16x32_bf16 v[64:67], a[128:131], a[40:43], v[64:67]
    ds_read_b64_tr_b16 a[160:161], v198 offset:9216
    ds_read_b64_tr_b16 a[162:163], v198 offset:13824
    v_mfma_f32_16x16x32_bf16 v[68:71], a[128:131], a[104:107], v[68:71]
    buffer_load_dwordx4 a[36:39], v16, s[16:19], s41 offen offset:1024 sc1
    v_mfma_f32_16x16x32_bf16 v[72:75], a[132:135], a[40:43], v[72:75]
    ds_read_b64_tr_b16 a[164:165], v199 offset:9216
    ds_read_b64_tr_b16 a[166:167], v199 offset:13824
    v_mfma_f32_16x16x32_bf16 v[76:79], a[132:135], a[104:107], v[76:79]
    s_add_u32 m0, s59, 34816
    ds_read_b64_tr_b16 a[168:169], v200 offset:9216
    ds_read_b64_tr_b16 a[170:171], v200 offset:13824
    v_mfma_f32_16x16x32_bf16 v[80:83], a[136:139], a[40:43], v[80:83]
    ds_read_b64_tr_b16 a[172:173], v201 offset:9216
    ds_read_b64_tr_b16 a[174:175], v201 offset:13824
    v_mfma_f32_16x16x32_bf16 v[84:87], a[136:139], a[104:107], v[84:87]
    buffer_load_dwordx4 v192, s[8:11], s40 offen offset:0 lds
    v_mfma_f32_16x16x32_bf16 v[88:91], a[140:143], a[40:43], v[88:91]
    ds_read_b64_tr_b16 a[176:177], v198 offset:9344
    ds_read_b64_tr_b16 a[178:179], v198 offset:13952
    v_mfma_f32_16x16x32_bf16 v[92:95], a[140:143], a[104:107], v[92:95]
    ds_read_b64_tr_b16 a[180:181], v199 offset:9344
    ds_read_b64_tr_b16 a[182:183], v199 offset:13952
    v_mfma_f32_16x16x32_bf16 v[96:99], a[144:147], a[40:43], v[96:99]
    ds_read_b64_tr_b16 a[184:185], v200 offset:9344
    ds_read_b64_tr_b16 a[186:187], v200 offset:13952
    v_mfma_f32_16x16x32_bf16 v[100:103], a[144:147], a[104:107], v[100:103]
    buffer_load_dwordx4 a[80:83], v16, s[16:19], s42 offen offset:0 sc1
    v_mfma_f32_16x16x32_bf16 v[104:107], a[148:151], a[40:43], v[104:107]
    ds_read_b64_tr_b16 a[188:189], v201 offset:9344
    ds_read_b64_tr_b16 a[190:191], v201 offset:13952
    v_mfma_f32_16x16x32_bf16 v[108:111], a[148:151], a[104:107], v[108:111]
    v_mfma_f32_16x16x32_bf16 v[112:115], a[152:155], a[40:43], v[112:115]
    v_mfma_f32_16x16x32_bf16 v[116:119], a[152:155], a[104:107], v[116:119]
    buffer_load_dwordx4 v193, s[8:11], s40 offen offset:1152 lds
    v_mfma_f32_16x16x32_bf16 v[120:123], a[156:159], a[40:43], v[120:123]
    s_add_u32 s40, s40, 65536
    v_mfma_f32_16x16x32_bf16 v[124:127], a[156:159], a[104:107], v[124:127]
    s_waitcnt vmcnt(24) lgkmcnt(0)
    s_barrier
    v_mfma_f32_16x16x32_bf16 v[64:67], a[160:163], a[44:47], v[64:67]
    ds_read_b64_tr_b16 a[128:129], v198 offset:18432
    ds_read_b64_tr_b16 a[130:131], v198 offset:23040
    v_mfma_f32_16x16x32_bf16 v[68:71], a[160:163], a[108:111], v[68:71]
    buffer_load_dwordx4 a[40:43], v16, s[16:19], s41 offen offset:2048 sc1
    v_mfma_f32_16x16x32_bf16 v[72:75], a[164:167], a[44:47], v[72:75]
    ds_read_b64_tr_b16 a[132:133], v199 offset:18432
    ds_read_b64_tr_b16 a[134:135], v199 offset:23040
    v_mfma_f32_16x16x32_bf16 v[76:79], a[164:167], a[108:111], v[76:79]
    s_add_u32 m0, s59, 44032
    ds_read_b64_tr_b16 a[136:137], v200 offset:18432
    ds_read_b64_tr_b16 a[138:139], v200 offset:23040
    v_mfma_f32_16x16x32_bf16 v[80:83], a[168:171], a[44:47], v[80:83]
    ds_read_b64_tr_b16 a[140:141], v201 offset:18432
    ds_read_b64_tr_b16 a[142:143], v201 offset:23040
    v_mfma_f32_16x16x32_bf16 v[84:87], a[168:171], a[108:111], v[84:87]
    buffer_load_dwordx4 v192, s[8:11], s40 offen offset:0 lds
    v_mfma_f32_16x16x32_bf16 v[88:91], a[172:175], a[44:47], v[88:91]
    ds_read_b64_tr_b16 a[144:145], v198 offset:18560
    ds_read_b64_tr_b16 a[146:147], v198 offset:23168
    v_mfma_f32_16x16x32_bf16 v[92:95], a[172:175], a[108:111], v[92:95]
    ds_read_b64_tr_b16 a[148:149], v199 offset:18560
    ds_read_b64_tr_b16 a[150:151], v199 offset:23168
    v_mfma_f32_16x16x32_bf16 v[96:99], a[176:179], a[44:47], v[96:99]
    ds_read_b64_tr_b16 a[152:153], v200 offset:18560
    ds_read_b64_tr_b16 a[154:155], v200 offset:23168
    v_mfma_f32_16x16x32_bf16 v[100:103], a[176:179], a[108:111], v[100:103]
    buffer_load_dwordx4 a[84:87], v16, s[16:19], s42 offen offset:1024 sc1
    v_mfma_f32_16x16x32_bf16 v[104:107], a[180:183], a[44:47], v[104:107]
    ds_read_b64_tr_b16 a[156:157], v201 offset:18560
    ds_read_b64_tr_b16 a[158:159], v201 offset:23168
    v_mfma_f32_16x16x32_bf16 v[108:111], a[180:183], a[108:111], v[108:111]
    v_mfma_f32_16x16x32_bf16 v[112:115], a[184:187], a[44:47], v[112:115]
    v_mfma_f32_16x16x32_bf16 v[116:119], a[184:187], a[108:111], v[116:119]
    buffer_load_dwordx4 v193, s[8:11], s40 offen offset:1152 lds
    v_mfma_f32_16x16x32_bf16 v[120:123], a[188:191], a[44:47], v[120:123]
    s_add_u32 s40, s40, 65536
    v_mfma_f32_16x16x32_bf16 v[124:127], a[188:191], a[108:111], v[124:127]
    s_waitcnt lgkmcnt(0)
    v_mfma_f32_16x16x32_bf16 v[64:67], a[128:131], a[48:51], v[64:67]
    ds_read_b64_tr_b16 a[160:161], v198 offset:27648
    ds_read_b64_tr_b16 a[162:163], v198 offset:32256
    v_mfma_f32_16x16x32_bf16 v[68:71], a[128:131], a[112:115], v[68:71]
    buffer_load_dwordx4 a[44:47], v16, s[16:19], s41 offen offset:3072 sc1
    v_mfma_f32_16x16x32_bf16 v[72:75], a[132:135], a[48:51], v[72:75]
    s_add_u32 s41, s41, 4096
    ds_read_b64_tr_b16 a[164:165], v199 offset:27648
    ds_read_b64_tr_b16 a[166:167], v199 offset:32256
    v_mfma_f32_16x16x32_bf16 v[76:79], a[132:135], a[112:115], v[76:79]
    s_add_u32 m0, s59, 53248
    ds_read_b64_tr_b16 a[168:169], v200 offset:27648
    ds_read_b64_tr_b16 a[170:171], v200 offset:32256
    v_mfma_f32_16x16x32_bf16 v[80:83], a[136:139], a[48:51], v[80:83]
    ds_read_b64_tr_b16 a[172:173], v201 offset:27648
    ds_read_b64_tr_b16 a[174:175], v201 offset:32256
    v_mfma_f32_16x16x32_bf16 v[84:87], a[136:139], a[112:115], v[84:87]
    buffer_load_dwordx4 v192, s[8:11], s40 offen offset:0 lds
    v_mfma_f32_16x16x32_bf16 v[88:91], a[140:143], a[48:51], v[88:91]
    ds_read_b64_tr_b16 a[176:177], v198 offset:27776
    ds_read_b64_tr_b16 a[178:179], v198 offset:32384
    v_mfma_f32_16x16x32_bf16 v[92:95], a[140:143], a[112:115], v[92:95]
    ds_read_b64_tr_b16 a[180:181], v199 offset:27776
    ds_read_b64_tr_b16 a[182:183], v199 offset:32384
    v_mfma_f32_16x16x32_bf16 v[96:99], a[144:147], a[48:51], v[96:99]
    ds_read_b64_tr_b16 a[184:185], v200 offset:27776
    ds_read_b64_tr_b16 a[186:187], v200 offset:32384
    v_mfma_f32_16x16x32_bf16 v[100:103], a[144:147], a[112:115], v[100:103]
    buffer_load_dwordx4 a[88:91], v16, s[16:19], s42 offen offset:2048 sc1
    v_mfma_f32_16x16x32_bf16 v[104:107], a[148:151], a[48:51], v[104:107]
    ds_read_b64_tr_b16 a[188:189], v201 offset:27776
    ds_read_b64_tr_b16 a[190:191], v201 offset:32384
    v_mfma_f32_16x16x32_bf16 v[108:111], a[148:151], a[112:115], v[108:111]
    v_mfma_f32_16x16x32_bf16 v[112:115], a[152:155], a[48:51], v[112:115]
    v_mfma_f32_16x16x32_bf16 v[116:119], a[152:155], a[112:115], v[116:119]
    buffer_load_dwordx4 v193, s[8:11], s40 offen offset:1152 lds
    v_mfma_f32_16x16x32_bf16 v[120:123], a[156:159], a[48:51], v[120:123]
    s_add_u32 s40, s40, 65536
    v_mfma_f32_16x16x32_bf16 v[124:127], a[156:159], a[112:115], v[124:127]
    s_waitcnt vmcnt(24) lgkmcnt(0)
    s_barrier
    v_mfma_f32_16x16x32_bf16 v[64:67], a[160:163], a[52:55], v[64:67]
    ds_read_b64_tr_b16 a[128:129], v198 offset:36864
    ds_read_b64_tr_b16 a[130:131], v198 offset:41472
    v_mfma_f32_16x16x32_bf16 v[68:71], a[160:163], a[116:119], v[68:71]
    buffer_load_dwordx4 a[48:51], v16, s[16:19], s41 offen offset:0 sc1
    v_mfma_f32_16x16x32_bf16 v[72:75], a[164:167], a[52:55], v[72:75]
    ds_read_b64_tr_b16 a[132:133], v199 offset:36864
    ds_read_b64_tr_b16 a[134:135], v199 offset:41472
    v_mfma_f32_16x16x32_bf16 v[76:79], a[164:167], a[116:119], v[76:79]
    s_add_u32 m0, s59, 62464
    ds_read_b64_tr_b16 a[136:137], v200 offset:36864
    ds_read_b64_tr_b16 a[138:139], v200 offset:41472
    v_mfma_f32_16x16x32_bf16 v[80:83], a[168:171], a[52:55], v[80:83]
    ds_read_b64_tr_b16 a[140:141], v201 offset:36864
    ds_read_b64_tr_b16 a[142:143], v201 offset:41472
    v_mfma_f32_16x16x32_bf16 v[84:87], a[168:171], a[116:119], v[84:87]
    buffer_load_dwordx4 v192, s[8:11], s40 offen offset:0 lds
    v_mfma_f32_16x16x32_bf16 v[88:91], a[172:175], a[52:55], v[88:91]
    ds_read_b64_tr_b16 a[144:145], v198 offset:36992
    ds_read_b64_tr_b16 a[146:147], v198 offset:41600
    v_mfma_f32_16x16x32_bf16 v[92:95], a[172:175], a[116:119], v[92:95]
    ds_read_b64_tr_b16 a[148:149], v199 offset:36992
    ds_read_b64_tr_b16 a[150:151], v199 offset:41600
    v_mfma_f32_16x16x32_bf16 v[96:99], a[176:179], a[52:55], v[96:99]
    ds_read_b64_tr_b16 a[152:153], v200 offset:36992
    ds_read_b64_tr_b16 a[154:155], v200 offset:41600
    v_mfma_f32_16x16x32_bf16 v[100:103], a[176:179], a[116:119], v[100:103]
    buffer_load_dwordx4 a[92:95], v16, s[16:19], s42 offen offset:3072 sc1
    v_mfma_f32_16x16x32_bf16 v[104:107], a[180:183], a[52:55], v[104:107]
    s_add_u32 s42, s42, 4096
    ds_read_b64_tr_b16 a[156:157], v201 offset:36992
    ds_read_b64_tr_b16 a[158:159], v201 offset:41600
    v_mfma_f32_16x16x32_bf16 v[108:111], a[180:183], a[116:119], v[108:111]
    v_mfma_f32_16x16x32_bf16 v[112:115], a[184:187], a[52:55], v[112:115]
    v_mfma_f32_16x16x32_bf16 v[116:119], a[184:187], a[116:119], v[116:119]
    buffer_load_dwordx4 v193, s[8:11], s40 offen offset:1152 lds
    v_mfma_f32_16x16x32_bf16 v[120:123], a[188:191], a[52:55], v[120:123]
    s_add_u32 s40, s40, 65536
    v_mfma_f32_16x16x32_bf16 v[124:127], a[188:191], a[116:119], v[124:127]
    s_waitcnt lgkmcnt(0)
    v_mfma_f32_16x16x32_bf16 v[64:67], a[128:131], a[56:59], v[64:67]
    ds_read_b64_tr_b16 a[160:161], v198 offset:46080
    ds_read_b64_tr_b16 a[162:163], v198 offset:50688
    v_mfma_f32_16x16x32_bf16 v[68:71], a[128:131], a[120:123], v[68:71]
    buffer_load_dwordx4 a[52:55], v16, s[16:19], s41 offen offset:1024 sc1
    v_mfma_f32_16x16x32_bf16 v[72:75], a[132:135], a[56:59], v[72:75]
    ds_read_b64_tr_b16 a[164:165], v199 offset:46080
    ds_read_b64_tr_b16 a[166:167], v199 offset:50688
    v_mfma_f32_16x16x32_bf16 v[76:79], a[132:135], a[120:123], v[76:79]
    s_add_u32 m0, s59, 71680
    ds_read_b64_tr_b16 a[168:169], v200 offset:46080
    ds_read_b64_tr_b16 a[170:171], v200 offset:50688
    v_mfma_f32_16x16x32_bf16 v[80:83], a[136:139], a[56:59], v[80:83]
    ds_read_b64_tr_b16 a[172:173], v201 offset:46080
    ds_read_b64_tr_b16 a[174:175], v201 offset:50688
    v_mfma_f32_16x16x32_bf16 v[84:87], a[136:139], a[120:123], v[84:87]
    buffer_load_dwordx4 v192, s[8:11], s40 offen offset:0 lds
    v_mfma_f32_16x16x32_bf16 v[88:91], a[140:143], a[56:59], v[88:91]
    ds_read_b64_tr_b16 a[176:177], v198 offset:46208
    ds_read_b64_tr_b16 a[178:179], v198 offset:50816
    v_mfma_f32_16x16x32_bf16 v[92:95], a[140:143], a[120:123], v[92:95]
    ds_read_b64_tr_b16 a[180:181], v199 offset:46208
    ds_read_b64_tr_b16 a[182:183], v199 offset:50816
    v_mfma_f32_16x16x32_bf16 v[96:99], a[144:147], a[56:59], v[96:99]
    ds_read_b64_tr_b16 a[184:185], v200 offset:46208
    ds_read_b64_tr_b16 a[186:187], v200 offset:50816
    v_mfma_f32_16x16x32_bf16 v[100:103], a[144:147], a[120:123], v[100:103]
    buffer_load_dwordx4 a[96:99], v16, s[16:19], s42 offen offset:0 sc1
    v_mfma_f32_16x16x32_bf16 v[104:107], a[148:151], a[56:59], v[104:107]
    ds_read_b64_tr_b16 a[188:189], v201 offset:46208
    ds_read_b64_tr_b16 a[190:191], v201 offset:50816
    v_mfma_f32_16x16x32_bf16 v[108:111], a[148:151], a[120:123], v[108:111]
    v_mfma_f32_16x16x32_bf16 v[112:115], a[152:155], a[56:59], v[112:115]
    v_mfma_f32_16x16x32_bf16 v[116:119], a[152:155], a[120:123], v[116:119]
    buffer_load_dwordx4 v193, s[8:11], s40 offen offset:1152 lds
    v_mfma_f32_16x16x32_bf16 v[120:123], a[156:159], a[56:59], v[120:123]
    s_add_u32 s40, s40, 65536
    v_mfma_f32_16x16x32_bf16 v[124:127], a[156:159], a[120:123], v[124:127]
    s_waitcnt vmcnt(24) lgkmcnt(0)
    s_barrier
    v_mfma_f32_16x16x32_bf16 v[64:67], a[160:163], a[60:63], v[64:67]
gated_mix__ssm_conv_h3__compressed_kv_cla__prompt_kernel_pad13:
    s_cbranch_execz gated_mix__ssm_conv_h3__compressed_kv_cla__prompt_kernel_pad17
    ds_read_b64_tr_b16 a[128:129], v198 offset:55296
    ds_read_b64_tr_b16 a[130:131], v198 offset:59904
    v_mfma_f32_16x16x32_bf16 v[68:71], a[160:163], a[124:127], v[68:71]
    buffer_load_dwordx4 a[56:59], v16, s[16:19], s41 offen offset:2048 sc1
    v_mfma_f32_16x16x32_bf16 v[72:75], a[164:167], a[60:63], v[72:75]
    ds_read_b64_tr_b16 a[132:133], v199 offset:55296
    ds_read_b64_tr_b16 a[134:135], v199 offset:59904
    v_mfma_f32_16x16x32_bf16 v[76:79], a[164:167], a[124:127], v[76:79]
    s_add_u32 m0, s59, 80896
    ds_read_b64_tr_b16 a[136:137], v200 offset:55296
    ds_read_b64_tr_b16 a[138:139], v200 offset:59904
    v_mfma_f32_16x16x32_bf16 v[80:83], a[168:171], a[60:63], v[80:83]
    ds_read_b64_tr_b16 a[140:141], v201 offset:55296
    ds_read_b64_tr_b16 a[142:143], v201 offset:59904
    v_mfma_f32_16x16x32_bf16 v[84:87], a[168:171], a[124:127], v[84:87]
    buffer_load_dwordx4 v192, s[8:11], s40 offen offset:0 lds
    v_mfma_f32_16x16x32_bf16 v[88:91], a[172:175], a[60:63], v[88:91]
    ds_read_b64_tr_b16 a[144:145], v198 offset:55424
    ds_read_b64_tr_b16 a[146:147], v198 offset:60032
    v_mfma_f32_16x16x32_bf16 v[92:95], a[172:175], a[124:127], v[92:95]
    ds_read_b64_tr_b16 a[148:149], v199 offset:55424
    ds_read_b64_tr_b16 a[150:151], v199 offset:60032
    v_mfma_f32_16x16x32_bf16 v[96:99], a[176:179], a[60:63], v[96:99]
    ds_read_b64_tr_b16 a[152:153], v200 offset:55424
    ds_read_b64_tr_b16 a[154:155], v200 offset:60032
    v_mfma_f32_16x16x32_bf16 v[100:103], a[176:179], a[124:127], v[100:103]
    buffer_load_dwordx4 a[100:103], v16, s[16:19], s42 offen offset:1024 sc1
    v_mfma_f32_16x16x32_bf16 v[104:107], a[180:183], a[60:63], v[104:107]
    ds_read_b64_tr_b16 a[156:157], v201 offset:55424
    ds_read_b64_tr_b16 a[158:159], v201 offset:60032
    v_mfma_f32_16x16x32_bf16 v[108:111], a[180:183], a[124:127], v[108:111]
    s_add_u32 s35, s35, 1
    v_mfma_f32_16x16x32_bf16 v[112:115], a[184:187], a[60:63], v[112:115]
    v_mfma_f32_16x16x32_bf16 v[116:119], a[184:187], a[124:127], v[116:119]
    buffer_load_dwordx4 v193, s[8:11], s40 offen offset:1152 lds
    v_mfma_f32_16x16x32_bf16 v[120:123], a[188:191], a[60:63], v[120:123]
    s_add_u32 s40, s40, 65536
    v_mfma_f32_16x16x32_bf16 v[124:127], a[188:191], a[124:127], v[124:127]
    s_waitcnt lgkmcnt(0)
    s_cmp_lg_u32 s35, 3
    s_cbranch_scc1 gated_mix__ssm_conv_h3__compressed_kv_cla__prompt_kernel_oloop
    s_waitcnt vmcnt(41)
    v_cmp_ne_u32 vcc, 1, v213
    s_nop 0
    s_cbranch_vccnz gated_mix__ssm_conv_h3__compressed_kv_cla__prompt_kernel_spin_y
gated_mix__ssm_conv_h3__compressed_kv_cla__prompt_kernel_spin_y_ret:
    v_mfma_f32_16x16x32_bf16 v[64:67], a[128:131], a[0:3], v[64:67]
    ds_read_b64_tr_b16 a[160:161], v202 offset:0
    ds_read_b64_tr_b16 a[162:163], v202 offset:4608
    v_mfma_f32_16x16x32_bf16 v[68:71], a[128:131], a[64:67], v[68:71]
    s_lshl_b32 s37, s32, 12
    s_add_u32 m0, s37, 0
    s_add_u32 s36, s51, 0
    buffer_load_dwordx4 v209, s[12:15], s36 offen sc1 lds
    v_mfma_f32_16x16x32_bf16 v[72:75], a[132:135], a[0:3], v[72:75]
    ds_read_b64_tr_b16 a[164:165], v203 offset:0
    ds_read_b64_tr_b16 a[166:167], v203 offset:4608
    v_mfma_f32_16x16x32_bf16 v[76:79], a[132:135], a[64:67], v[76:79]
    ds_read_b64_tr_b16 a[168:169], v204 offset:0
    ds_read_b64_tr_b16 a[170:171], v204 offset:4608
    v_mfma_f32_16x16x32_bf16 v[80:83], a[136:139], a[0:3], v[80:83]
    ds_read_b64_tr_b16 a[172:173], v205 offset:0
    ds_read_b64_tr_b16 a[174:175], v205 offset:4608
    v_mfma_f32_16x16x32_bf16 v[84:87], a[136:139], a[64:67], v[84:87]
    s_add_u32 m0, s37, 1024
    s_add_u32 s36, s51, 16384
    buffer_load_dwordx4 v209, s[12:15], s36 offen sc1 lds
    v_mfma_f32_16x16x32_bf16 v[88:91], a[140:143], a[0:3], v[88:91]
    s_add_u32 m0, s37, 2048
    s_add_u32 s36, s51, 32768
    buffer_load_dwordx4 v209, s[12:15], s36 offen sc1 lds
    v_mfma_f32_16x16x32_bf16 v[92:95], a[140:143], a[64:67], v[92:95]
    s_waitcnt vmcnt(31) lgkmcnt(0)
    s_barrier
    v_mfma_f32_16x16x32_bf16 v[64:67], a[160:163], a[4:7], v[64:67]
    ds_read_b64_tr_b16 a[128:129], v202 offset:9216
    ds_read_b64_tr_b16 a[130:131], v202 offset:13824
    v_mfma_f32_16x16x32_bf16 v[68:71], a[160:163], a[68:71], v[68:71]
    s_add_u32 m0, s37, 3072
    s_add_u32 s36, s51, 49152
    buffer_load_dwordx4 v209, s[12:15], s36 offen sc1 lds
    v_mfma_f32_16x16x32_bf16 v[72:75], a[164:167], a[4:7], v[72:75]
    ds_read_b64_tr_b16 a[132:133], v203 offset:9216
    ds_read_b64_tr_b16 a[134:135], v203 offset:13824
    v_mfma_f32_16x16x32_bf16 v[76:79], a[164:167], a[68:71], v[76:79]
    ds_read_b64_tr_b16 a[136:137], v204 offset:9216
    ds_read_b64_tr_b16 a[138:139], v204 offset:13824
    v_mfma_f32_16x16x32_bf16 v[80:83], a[168:171], a[4:7], v[80:83]
    ds_read_b64_tr_b16 a[140:141], v205 offset:9216
    ds_read_b64_tr_b16 a[142:143], v205 offset:13824
    v_mfma_f32_16x16x32_bf16 v[84:87], a[168:171], a[68:71], v[84:87]
    buffer_load_dwordx4 a[60:63], v16, s[16:19], s41 offen offset:3072 sc1
    v_mfma_f32_16x16x32_bf16 v[88:91], a[172:175], a[4:7], v[88:91]
    s_add_u32 s41, s41, 4096
    s_add_u32 m0, s59, 90112
    v_mfma_f32_16x16x32_bf16 v[92:95], a[172:175], a[68:71], v[92:95]
    s_waitcnt lgkmcnt(0)
    v_mfma_f32_16x16x32_bf16 v[64:67], a[128:131], a[8:11], v[64:67]
    ds_read_b64_tr_b16 a[160:161], v194 offset:0
    ds_read_b64_tr_b16 a[162:163], v194 offset:4608
    v_mfma_f32_16x16x32_bf16 v[68:71], a[128:131], a[72:75], v[68:71]
    buffer_load_dwordx4 v192, s[8:11], s40 offen offset:0 lds
    v_mfma_f32_16x16x32_bf16 v[72:75], a[132:135], a[8:11], v[72:75]
    ds_read_b64_tr_b16 a[164:165], v195 offset:0
    ds_read_b64_tr_b16 a[166:167], v195 offset:4608
    v_mfma_f32_16x16x32_bf16 v[76:79], a[132:135], a[72:75], v[76:79]
    ds_read_b64_tr_b16 a[168:169], v196 offset:0
    ds_read_b64_tr_b16 a[170:171], v196 offset:4608
    v_mfma_f32_16x16x32_bf16 v[80:83], a[136:139], a[8:11], v[80:83]
    ds_read_b64_tr_b16 a[172:173], v197 offset:0
    ds_read_b64_tr_b16 a[174:175], v197 offset:4608
    v_mfma_f32_16x16x32_bf16 v[84:87], a[136:139], a[72:75], v[84:87]
    buffer_load_dwordx4 v193, s[8:11], s40 offen offset:1152 lds
    v_mfma_f32_16x16x32_bf16 v[88:91], a[140:143], a[8:11], v[88:91]
    s_add_u32 s40, s40, 65536
    buffer_load_dwordx4 a[104:107], v16, s[16:19], s42 offen offset:2048 sc1
    v_mfma_f32_16x16x32_bf16 v[92:95], a[140:143], a[72:75], v[92:95]
    s_waitcnt vmcnt(28) lgkmcnt(0)
    s_barrier
    v_mfma_f32_16x16x32_bf16 v[64:67], a[160:163], a[12:15], v[64:67]
    ds_read_b64_tr_b16 a[128:129], v194 offset:9216
    ds_read_b64_tr_b16 a[130:131], v194 offset:13824
    v_mfma_f32_16x16x32_bf16 v[68:71], a[160:163], a[76:79], v[68:71]
    s_add_u32 m0, s59, 99328
    v_mfma_f32_16x16x32_bf16 v[72:75], a[164:167], a[12:15], v[72:75]
    ds_read_b64_tr_b16 a[132:133], v195 offset:9216
    ds_read_b64_tr_b16 a[134:135], v195 offset:13824
    v_mfma_f32_16x16x32_bf16 v[76:79], a[164:167], a[76:79], v[76:79]
    ds_read_b64_tr_b16 a[136:137], v196 offset:9216
    ds_read_b64_tr_b16 a[138:139], v196 offset:13824
    v_mfma_f32_16x16x32_bf16 v[80:83], a[168:171], a[12:15], v[80:83]
    ds_read_b64_tr_b16 a[140:141], v197 offset:9216
    ds_read_b64_tr_b16 a[142:143], v197 offset:13824
    v_mfma_f32_16x16x32_bf16 v[84:87], a[168:171], a[76:79], v[84:87]
    buffer_load_dwordx4 v192, s[8:11], s40 offen offset:0 lds
    v_mfma_f32_16x16x32_bf16 v[88:91], a[172:175], a[12:15], v[88:91]
    buffer_load_dwordx4 v193, s[8:11], s40 offen offset:1152 lds
    v_mfma_f32_16x16x32_bf16 v[92:95], a[172:175], a[76:79], v[92:95]
    s_waitcnt lgkmcnt(0)
    v_mfma_f32_16x16x32_bf16 v[64:67], a[128:131], a[16:19], v[64:67]
    ds_read_b64_tr_b16 a[160:161], v194 offset:18432
    ds_read_b64_tr_b16 a[162:163], v194 offset:23040
    v_mfma_f32_16x16x32_bf16 v[68:71], a[128:131], a[80:83], v[68:71]
    s_add_u32 s40, s40, 65536
    buffer_load_dwordx4 a[108:111], v16, s[16:19], s42 offen offset:3072 sc1
    v_mfma_f32_16x16x32_bf16 v[72:75], a[132:135], a[16:19], v[72:75]
    ds_read_b64_tr_b16 a[164:165], v195 offset:18432
    ds_read_b64_tr_b16 a[166:167], v195 offset:23040
    v_mfma_f32_16x16x32_bf16 v[76:79], a[132:135], a[80:83], v[76:79]
    ds_read_b64_tr_b16 a[168:169], v196 offset:18432
    ds_read_b64_tr_b16 a[170:171], v196 offset:23040
    v_mfma_f32_16x16x32_bf16 v[80:83], a[136:139], a[16:19], v[80:83]
    ds_read_b64_tr_b16 a[172:173], v197 offset:18432
    ds_read_b64_tr_b16 a[174:175], v197 offset:23040
    v_mfma_f32_16x16x32_bf16 v[84:87], a[136:139], a[80:83], v[84:87]
    s_add_u32 s42, s42, 4096
    s_add_u32 m0, s59, 108544
    v_mfma_f32_16x16x32_bf16 v[88:91], a[140:143], a[16:19], v[88:91]
    buffer_load_dwordx4 v192, s[8:11], s40 offen offset:0 lds
    v_mfma_f32_16x16x32_bf16 v[92:95], a[140:143], a[80:83], v[92:95]
    s_waitcnt vmcnt(24) lgkmcnt(0)
    s_barrier
    v_mfma_f32_16x16x32_bf16 v[64:67], a[160:163], a[20:23], v[64:67]
    ds_read_b64_tr_b16 a[128:129], v194 offset:27648
    ds_read_b64_tr_b16 a[130:131], v194 offset:32256
    v_mfma_f32_16x16x32_bf16 v[68:71], a[160:163], a[84:87], v[68:71]
    buffer_load_dwordx4 v193, s[8:11], s40 offen offset:1152 lds
    v_mfma_f32_16x16x32_bf16 v[72:75], a[164:167], a[20:23], v[72:75]
    ds_read_b64_tr_b16 a[132:133], v195 offset:27648
    ds_read_b64_tr_b16 a[134:135], v195 offset:32256
    v_mfma_f32_16x16x32_bf16 v[76:79], a[164:167], a[84:87], v[76:79]
    ds_read_b64_tr_b16 a[136:137], v196 offset:27648
    ds_read_b64_tr_b16 a[138:139], v196 offset:32256
    v_mfma_f32_16x16x32_bf16 v[80:83], a[168:171], a[20:23], v[80:83]
    ds_read_b64_tr_b16 a[140:141], v197 offset:27648
    ds_read_b64_tr_b16 a[142:143], v197 offset:32256
    v_mfma_f32_16x16x32_bf16 v[84:87], a[168:171], a[84:87], v[84:87]
    s_add_u32 s40, s40, 65536
    buffer_load_dwordx4 a[112:115], v16, s[16:19], s42 offen offset:0 sc1
    v_mfma_f32_16x16x32_bf16 v[88:91], a[172:175], a[20:23], v[88:91]
    s_add_u32 m0, s59, 117760
    v_mfma_f32_16x16x32_bf16 v[92:95], a[172:175], a[84:87], v[92:95]
    s_waitcnt lgkmcnt(0)
    v_mfma_f32_16x16x32_bf16 v[64:67], a[128:131], a[24:27], v[64:67]
    ds_read_b64_tr_b16 a[160:161], v194 offset:36864
    ds_read_b64_tr_b16 a[162:163], v194 offset:41472
    v_mfma_f32_16x16x32_bf16 v[68:71], a[128:131], a[88:91], v[68:71]
    buffer_load_dwordx4 v192, s[8:11], s40 offen offset:0 lds
    v_mfma_f32_16x16x32_bf16 v[72:75], a[132:135], a[24:27], v[72:75]
    ds_read_b64_tr_b16 a[164:165], v195 offset:36864
    ds_read_b64_tr_b16 a[166:167], v195 offset:41472
    v_mfma_f32_16x16x32_bf16 v[76:79], a[132:135], a[88:91], v[76:79]
    ds_read_b64_tr_b16 a[168:169], v196 offset:36864
    ds_read_b64_tr_b16 a[170:171], v196 offset:41472
    v_mfma_f32_16x16x32_bf16 v[80:83], a[136:139], a[24:27], v[80:83]
    ds_read_b64_tr_b16 a[172:173], v197 offset:36864
    ds_read_b64_tr_b16 a[174:175], v197 offset:41472
    v_mfma_f32_16x16x32_bf16 v[84:87], a[136:139], a[88:91], v[84:87]
    buffer_load_dwordx4 v193, s[8:11], s40 offen offset:1152 lds
    v_mfma_f32_16x16x32_bf16 v[88:91], a[140:143], a[24:27], v[88:91]
    s_add_u32 s40, s40, 65536
    buffer_load_dwordx4 a[116:119], v16, s[16:19], s42 offen offset:1024 sc1
    v_mfma_f32_16x16x32_bf16 v[92:95], a[140:143], a[88:91], v[92:95]
    s_waitcnt vmcnt(21) lgkmcnt(0)
    s_barrier
    v_mfma_f32_16x16x32_bf16 v[64:67], a[160:163], a[28:31], v[64:67]
    ds_read_b64_tr_b16 a[128:129], v194 offset:46080
    ds_read_b64_tr_b16 a[130:131], v194 offset:50688
    v_mfma_f32_16x16x32_bf16 v[68:71], a[160:163], a[92:95], v[68:71]
    s_add_u32 m0, s59, 126976
    v_mfma_f32_16x16x32_bf16 v[72:75], a[164:167], a[28:31], v[72:75]
    ds_read_b64_tr_b16 a[132:133], v195 offset:46080
    ds_read_b64_tr_b16 a[134:135], v195 offset:50688
    v_mfma_f32_16x16x32_bf16 v[76:79], a[164:167], a[92:95], v[76:79]
    ds_read_b64_tr_b16 a[136:137], v196 offset:46080
    ds_read_b64_tr_b16 a[138:139], v196 offset:50688
    v_mfma_f32_16x16x32_bf16 v[80:83], a[168:171], a[28:31], v[80:83]
    ds_read_b64_tr_b16 a[140:141], v197 offset:46080
    ds_read_b64_tr_b16 a[142:143], v197 offset:50688
    v_mfma_f32_16x16x32_bf16 v[84:87], a[168:171], a[92:95], v[84:87]
    buffer_load_dwordx4 v192, s[8:11], s40 offen offset:0 lds
    v_mfma_f32_16x16x32_bf16 v[88:91], a[172:175], a[28:31], v[88:91]
    buffer_load_dwordx4 v193, s[8:11], s40 offen offset:1152 lds
    v_mfma_f32_16x16x32_bf16 v[92:95], a[172:175], a[92:95], v[92:95]
    s_waitcnt lgkmcnt(0)
    v_mfma_f32_16x16x32_bf16 v[64:67], a[128:131], a[32:35], v[64:67]
    ds_read_b64_tr_b16 a[160:161], v194 offset:55296
    ds_read_b64_tr_b16 a[162:163], v194 offset:59904
    v_mfma_f32_16x16x32_bf16 v[68:71], a[128:131], a[96:99], v[68:71]
    s_add_u32 s40, s40, 65536
    buffer_load_dwordx4 a[120:123], v16, s[16:19], s42 offen offset:2048 sc1
    v_mfma_f32_16x16x32_bf16 v[72:75], a[132:135], a[32:35], v[72:75]
    ds_read_b64_tr_b16 a[164:165], v195 offset:55296
    ds_read_b64_tr_b16 a[166:167], v195 offset:59904
    v_mfma_f32_16x16x32_bf16 v[76:79], a[132:135], a[96:99], v[76:79]
    ds_read_b64_tr_b16 a[168:169], v196 offset:55296
    ds_read_b64_tr_b16 a[170:171], v196 offset:59904
    v_mfma_f32_16x16x32_bf16 v[80:83], a[136:139], a[32:35], v[80:83]
    ds_read_b64_tr_b16 a[172:173], v197 offset:55296
    ds_read_b64_tr_b16 a[174:175], v197 offset:59904
    v_mfma_f32_16x16x32_bf16 v[84:87], a[136:139], a[96:99], v[84:87]
    buffer_load_dwordx4 a[124:127], v16, s[16:19], s42 offen offset:3072 sc1
    v_mfma_f32_16x16x32_bf16 v[88:91], a[140:143], a[32:35], v[88:91]
    s_add_u32 s42, s42, 4096
    s_add_u32 s16, s94, 67108864
    s_addc_u32 s17, s95, 0
    s_mov_b32 s18, 8388608
    v_mfma_f32_16x16x32_bf16 v[92:95], a[140:143], a[96:99], v[92:95]
    s_waitcnt vmcnt(13) lgkmcnt(0)
    s_barrier
    v_mfma_f32_16x16x32_bf16 v[64:67], a[160:163], a[36:39], v[64:67]
    ds_read_b64_tr_b16 a[128:129], v198 offset:0
    ds_read_b64_tr_b16 a[130:131], v198 offset:4608
    v_mfma_f32_16x16x32_bf16 v[68:71], a[160:163], a[100:103], v[68:71]
    v_mfma_f32_16x16x32_bf16 v[72:75], a[164:167], a[36:39], v[72:75]
    ds_read_b64_tr_b16 a[132:133], v199 offset:0
    ds_read_b64_tr_b16 a[134:135], v199 offset:4608
    v_mfma_f32_16x16x32_bf16 v[76:79], a[164:167], a[100:103], v[76:79]
    ds_read_b64_tr_b16 a[136:137], v200 offset:0
    ds_read_b64_tr_b16 a[138:139], v200 offset:4608
    v_mfma_f32_16x16x32_bf16 v[80:83], a[168:171], a[36:39], v[80:83]
    ds_read_b64_tr_b16 a[140:141], v201 offset:0
    ds_read_b64_tr_b16 a[142:143], v201 offset:4608
    v_mfma_f32_16x16x32_bf16 v[84:87], a[168:171], a[100:103], v[84:87]
    v_mfma_f32_16x16x32_bf16 v[88:91], a[172:175], a[36:39], v[88:91]
    v_mfma_f32_16x16x32_bf16 v[92:95], a[172:175], a[100:103], v[92:95]
    s_waitcnt lgkmcnt(0)
    v_mfma_f32_16x16x32_bf16 v[64:67], a[128:131], a[40:43], v[64:67]
    ds_read_b64_tr_b16 a[160:161], v198 offset:9216
    ds_read_b64_tr_b16 a[162:163], v198 offset:13824
    v_mfma_f32_16x16x32_bf16 v[68:71], a[128:131], a[104:107], v[68:71]
    v_mfma_f32_16x16x32_bf16 v[72:75], a[132:135], a[40:43], v[72:75]
    ds_read_b64_tr_b16 a[164:165], v199 offset:9216
    ds_read_b64_tr_b16 a[166:167], v199 offset:13824
    v_mfma_f32_16x16x32_bf16 v[76:79], a[132:135], a[104:107], v[76:79]
    ds_read_b64_tr_b16 a[168:169], v200 offset:9216
    ds_read_b64_tr_b16 a[170:171], v200 offset:13824
    v_mfma_f32_16x16x32_bf16 v[80:83], a[136:139], a[40:43], v[80:83]
    ds_read_b64_tr_b16 a[172:173], v201 offset:9216
    ds_read_b64_tr_b16 a[174:175], v201 offset:13824
    v_mfma_f32_16x16x32_bf16 v[84:87], a[136:139], a[104:107], v[84:87]
    s_mov_b32 s37, 0xffff0000
    v_mfma_f32_16x16x32_bf16 v[88:91], a[140:143], a[40:43], v[88:91]
    v_mfma_f32_16x16x32_bf16 v[92:95], a[140:143], a[104:107], v[92:95]
    s_waitcnt vmcnt(7) lgkmcnt(0)
    s_barrier
    v_mfma_f32_16x16x32_bf16 v[64:67], a[160:163], a[44:47], v[64:67]
    ds_read_b64_tr_b16 a[128:129], v198 offset:18432
    ds_read_b64_tr_b16 a[130:131], v198 offset:23040
    v_mfma_f32_16x16x32_bf16 v[68:71], a[160:163], a[108:111], v[68:71]
    ds_read_b64_tr_b16 v[160:161], v207 offset:0
    ds_read_b64_tr_b16 v[164:165], v207 offset:4096
    ds_read_b64_tr_b16 v[168:169], v207 offset:8192
    v_mfma_f32_16x16x32_bf16 v[72:75], a[164:167], a[44:47], v[72:75]
    ds_read_b64_tr_b16 a[132:133], v199 offset:18432
    ds_read_b64_tr_b16 a[134:135], v199 offset:23040
    v_mfma_f32_16x16x32_bf16 v[76:79], a[164:167], a[108:111], v[76:79]
    ds_read_b64_tr_b16 a[136:137], v200 offset:18432
    ds_read_b64_tr_b16 a[138:139], v200 offset:23040
    v_mfma_f32_16x16x32_bf16 v[80:83], a[168:171], a[44:47], v[80:83]
    ds_read_b64_tr_b16 a[140:141], v201 offset:18432
    ds_read_b64_tr_b16 a[142:143], v201 offset:23040
    v_mfma_f32_16x16x32_bf16 v[84:87], a[168:171], a[108:111], v[84:87]
    ds_read_b64_tr_b16 v[172:173], v207 offset:12288
    ds_read_b64_tr_b16 v[162:163], v207 offset:128
    ds_read_b64_tr_b16 v[166:167], v207 offset:4224
    v_mfma_f32_16x16x32_bf16 v[88:91], a[172:175], a[44:47], v[88:91]
    ds_read_b64_tr_b16 v[170:171], v207 offset:8320
    ds_read_b64_tr_b16 v[174:175], v207 offset:12416
    v_mfma_f32_16x16x32_bf16 v[92:95], a[172:175], a[108:111], v[92:95]
    s_waitcnt lgkmcnt(0)
    v_mfma_f32_16x16x32_bf16 v[64:67], a[128:131], a[48:51], v[64:67]
    ds_read_b64_tr_b16 a[160:161], v198 offset:27648
    ds_read_b64_tr_b16 a[162:163], v198 offset:32256
    v_mfma_f32_16x16x32_bf16 v[68:71], a[128:131], a[112:115], v[68:71]
    v_lshlrev_b32 v176, 16, v216
    v_lshlrev_b32 v177, 16, v160
    v_mfma_f32_16x16x32_bf16 v[72:75], a[132:135], a[48:51], v[72:75]
    ds_read_b64_tr_b16 a[164:165], v199 offset:27648
    ds_read_b64_tr_b16 a[166:167], v199 offset:32256
    v_mfma_f32_16x16x32_bf16 v[76:79], a[132:135], a[112:115], v[76:79]
    ds_read_b64_tr_b16 a[168:169], v200 offset:27648
    ds_read_b64_tr_b16 a[170:171], v200 offset:32256
    v_mfma_f32_16x16x32_bf16 v[80:83], a[136:139], a[48:51], v[80:83]
    ds_read_b64_tr_b16 a[172:173], v201 offset:27648
    ds_read_b64_tr_b16 a[174:175], v201 offset:32256
    v_mfma_f32_16x16x32_bf16 v[84:87], a[136:139], a[112:115], v[84:87]
    v_mul_f32 v176, v176, v177
    v_mul_f32 v32, v210, v176
    v_mfma_f32_16x16x32_bf16 v[88:91], a[140:143], a[48:51], v[88:91]
    v_and_b32 v176, s37, v216
    v_and_b32 v177, s37, v160
    v_mfma_f32_16x16x32_bf16 v[92:95], a[140:143], a[112:115], v[92:95]
    s_waitcnt vmcnt(1) lgkmcnt(0)
    s_barrier
    v_mfma_f32_16x16x32_bf16 v[64:67], a[160:163], a[52:55], v[64:67]
    ds_read_b64_tr_b16 a[128:129], v198 offset:36864
    ds_read_b64_tr_b16 a[130:131], v198 offset:41472
    v_mfma_f32_16x16x32_bf16 v[68:71], a[160:163], a[116:119], v[68:71]
    v_mul_f32 v176, v176, v177
    v_mul_f32 v33, v210, v176
    v_mfma_f32_16x16x32_bf16 v[72:75], a[164:167], a[52:55], v[72:75]
    ds_read_b64_tr_b16 a[132:133], v199 offset:36864
    ds_read_b64_tr_b16 a[134:135], v199 offset:41472
    v_mfma_f32_16x16x32_bf16 v[76:79], a[164:167], a[116:119], v[76:79]
    ds_read_b64_tr_b16 a[136:137], v200 offset:36864
    ds_read_b64_tr_b16 a[138:139], v200 offset:41472
    v_mfma_f32_16x16x32_bf16 v[80:83], a[168:171], a[52:55], v[80:83]
    ds_read_b64_tr_b16 a[140:141], v201 offset:36864
    ds_read_b64_tr_b16 a[142:143], v201 offset:41472
    v_mfma_f32_16x16x32_bf16 v[84:87], a[168:171], a[116:119], v[84:87]
    v_lshlrev_b32 v176, 16, v217
    v_lshlrev_b32 v177, 16, v161
    v_mfma_f32_16x16x32_bf16 v[88:91], a[172:175], a[52:55], v[88:91]
    v_mul_f32 v176, v176, v177
    v_mul_f32 v34, v210, v176
    v_mfma_f32_16x16x32_bf16 v[92:95], a[172:175], a[116:119], v[92:95]
    s_waitcnt lgkmcnt(0)
    v_mfma_f32_16x16x32_bf16 v[64:67], a[128:131], a[56:59], v[64:67]
    ds_read_b64_tr_b16 a[160:161], v198 offset:46080
    ds_read_b64_tr_b16 a[162:163], v198 offset:50688
    v_mfma_f32_16x16x32_bf16 v[68:71], a[128:131], a[120:123], v[68:71]
    v_and_b32 v176, s37, v217
    v_and_b32 v177, s37, v161
    v_mfma_f32_16x16x32_bf16 v[72:75], a[132:135], a[56:59], v[72:75]
    ds_read_b64_tr_b16 a[164:165], v199 offset:46080
    ds_read_b64_tr_b16 a[166:167], v199 offset:50688
    v_mfma_f32_16x16x32_bf16 v[76:79], a[132:135], a[120:123], v[76:79]
    ds_read_b64_tr_b16 a[168:169], v200 offset:46080
    ds_read_b64_tr_b16 a[170:171], v200 offset:50688
    v_mfma_f32_16x16x32_bf16 v[80:83], a[136:139], a[56:59], v[80:83]
    ds_read_b64_tr_b16 a[172:173], v201 offset:46080
    ds_read_b64_tr_b16 a[174:175], v201 offset:50688
    v_mfma_f32_16x16x32_bf16 v[84:87], a[136:139], a[120:123], v[84:87]
    v_mul_f32 v176, v176, v177
    v_mul_f32 v35, v210, v176
    v_mfma_f32_16x16x32_bf16 v[88:91], a[140:143], a[56:59], v[88:91]
    v_lshlrev_b32 v176, 16, v218
    v_lshlrev_b32 v177, 16, v162
    v_mfma_f32_16x16x32_bf16 v[92:95], a[140:143], a[120:123], v[92:95]
    s_waitcnt vmcnt(0) lgkmcnt(0)
    v_mfma_f32_16x16x32_bf16 v[64:67], a[160:163], a[60:63], v[64:67]
    v_mfma_f32_16x16x32_bf16 v[68:71], a[160:163], a[124:127], v[68:71]
    v_mul_f32 v176, v176, v177
    v_mul_f32 v36, v211, v176
    v_mfma_f32_16x16x32_bf16 v[72:75], a[164:167], a[60:63], v[72:75]
    v_mfma_f32_16x16x32_bf16 v[76:79], a[164:167], a[124:127], v[76:79]
    v_mfma_f32_16x16x32_bf16 v[80:83], a[168:171], a[60:63], v[80:83]
    v_mfma_f32_16x16x32_bf16 v[84:87], a[168:171], a[124:127], v[84:87]
    v_and_b32 v176, s37, v218
    v_and_b32 v177, s37, v162
    v_mfma_f32_16x16x32_bf16 v[88:91], a[172:175], a[60:63], v[88:91]
    v_mul_f32 v176, v176, v177
    v_mul_f32 v37, v211, v176
    v_mfma_f32_16x16x32_bf16 v[92:95], a[172:175], a[124:127], v[92:95]
    s_waitcnt lgkmcnt(0)
    v_mfma_f32_16x16x32_bf16 v[96:99], a[144:147], a[0:3], v[96:99]
    ds_read_b64_tr_b16 a[176:177], v202 offset:128
    ds_read_b64_tr_b16 a[178:179], v202 offset:4736
    v_mfma_f32_16x16x32_bf16 v[100:103], a[144:147], a[64:67], v[100:103]
    v_mfma_f32_16x16x32_bf16 v[104:107], a[148:151], a[0:3], v[104:107]
    ds_read_b64_tr_b16 a[180:181], v203 offset:128
    ds_read_b64_tr_b16 a[182:183], v203 offset:4736
    v_mfma_f32_16x16x32_bf16 v[108:111], a[148:151], a[64:67], v[108:111]
    ds_read_b64_tr_b16 a[184:185], v204 offset:128
    ds_read_b64_tr_b16 a[186:187], v204 offset:4736
    v_mfma_f32_16x16x32_bf16 v[112:115], a[152:155], a[0:3], v[112:115]
    ds_read_b64_tr_b16 a[188:189], v205 offset:128
    ds_read_b64_tr_b16 a[190:191], v205 offset:4736
    v_mfma_f32_16x16x32_bf16 v[116:119], a[152:155], a[64:67], v[116:119]
    v_cvt_pk_bf16_f32 v64, v64, v65
    v_cvt_pk_bf16_f32 v65, v66, v67
    v_mfma_f32_16x16x32_bf16 v[120:123], a[156:159], a[0:3], v[120:123]
    v_cvt_pk_bf16_f32 v66, v68, v69
    v_cvt_pk_bf16_f32 v67, v70, v71
    v_mfma_f32_16x16x32_bf16 v[124:127], a[156:159], a[64:67], v[124:127]
    s_waitcnt lgkmcnt(0)
    v_cvt_pk_bf16_f32 v68, v72, v73
    v_cvt_pk_bf16_f32 v69, v74, v75
    v_mfma_f32_16x16x32_bf16 v[96:99], a[176:179], a[4:7], v[96:99]
    ds_read_b64_tr_b16 a[144:145], v202 offset:9344
    ds_read_b64_tr_b16 a[146:147], v202 offset:13952
    v_mfma_f32_16x16x32_bf16 v[100:103], a[176:179], a[68:71], v[100:103]
    buffer_store_dwordx4 v[64:67], v16, s[16:19], s46 offen offset:0 sc1
    v_mfma_f32_16x16x32_bf16 v[104:107], a[180:183], a[4:7], v[104:107]
    ds_read_b64_tr_b16 a[148:149], v203 offset:9344
    ds_read_b64_tr_b16 a[150:151], v203 offset:13952
    v_mfma_f32_16x16x32_bf16 v[108:111], a[180:183], a[68:71], v[108:111]
    ds_read_b64_tr_b16 a[152:153], v204 offset:9344
    ds_read_b64_tr_b16 a[154:155], v204 offset:13952
    v_mfma_f32_16x16x32_bf16 v[112:115], a[184:187], a[4:7], v[112:115]
    ds_read_b64_tr_b16 a[156:157], v205 offset:9344
    ds_read_b64_tr_b16 a[158:159], v205 offset:13952
    v_mfma_f32_16x16x32_bf16 v[116:119], a[184:187], a[68:71], v[116:119]
    v_cvt_pk_bf16_f32 v70, v76, v77
    v_cvt_pk_bf16_f32 v71, v78, v79
    v_mfma_f32_16x16x32_bf16 v[120:123], a[188:191], a[4:7], v[120:123]
    v_cvt_pk_bf16_f32 v72, v80, v81
    v_cvt_pk_bf16_f32 v73, v82, v83
    v_mfma_f32_16x16x32_bf16 v[124:127], a[188:191], a[68:71], v[124:127]
    s_waitcnt lgkmcnt(0)
    v_cvt_pk_bf16_f32 v74, v84, v85
    v_cvt_pk_bf16_f32 v75, v86, v87
    v_mfma_f32_16x16x32_bf16 v[96:99], a[144:147], a[8:11], v[96:99]
    ds_read_b64_tr_b16 a[176:177], v194 offset:128
    ds_read_b64_tr_b16 a[178:179], v194 offset:4736
    v_mfma_f32_16x16x32_bf16 v[100:103], a[144:147], a[72:75], v[100:103]
    buffer_store_dwordx4 v[68:71], v16, s[16:19], s46 offen offset:1024 sc1
    v_mfma_f32_16x16x32_bf16 v[104:107], a[148:151], a[8:11], v[104:107]
    ds_read_b64_tr_b16 a[180:181], v195 offset:128
    ds_read_b64_tr_b16 a[182:183], v195 offset:4736
    v_mfma_f32_16x16x32_bf16 v[108:111], a[148:151], a[72:75], v[108:111]
    ds_read_b64_tr_b16 a[184:185], v196 offset:128
    ds_read_b64_tr_b16 a[186:187], v196 offset:4736
    v_mfma_f32_16x16x32_bf16 v[112:115], a[152:155], a[8:11], v[112:115]
    ds_read_b64_tr_b16 a[188:189], v197 offset:128
    ds_read_b64_tr_b16 a[190:191], v197 offset:4736
    v_mfma_f32_16x16x32_bf16 v[116:119], a[152:155], a[72:75], v[116:119]
    v_cvt_pk_bf16_f32 v76, v88, v89
    v_cvt_pk_bf16_f32 v77, v90, v91
    v_mfma_f32_16x16x32_bf16 v[120:123], a[156:159], a[8:11], v[120:123]
    v_cvt_pk_bf16_f32 v78, v92, v93
    v_cvt_pk_bf16_f32 v79, v94, v95
    v_mfma_f32_16x16x32_bf16 v[124:127], a[156:159], a[72:75], v[124:127]
    s_waitcnt lgkmcnt(0)
    v_lshlrev_b32 v176, 16, v219
    v_lshlrev_b32 v177, 16, v163
    v_mfma_f32_16x16x32_bf16 v[96:99], a[176:179], a[12:15], v[96:99]
    ds_read_b64_tr_b16 a[144:145], v194 offset:9344
    ds_read_b64_tr_b16 a[146:147], v194 offset:13952
    v_mfma_f32_16x16x32_bf16 v[100:103], a[176:179], a[76:79], v[100:103]
    buffer_store_dwordx4 v[72:75], v16, s[16:19], s46 offen offset:2048 sc1
    v_mfma_f32_16x16x32_bf16 v[104:107], a[180:183], a[12:15], v[104:107]
    ds_read_b64_tr_b16 a[148:149], v195 offset:9344
    ds_read_b64_tr_b16 a[150:151], v195 offset:13952
    v_mfma_f32_16x16x32_bf16 v[108:111], a[180:183], a[76:79], v[108:111]
    ds_read_b64_tr_b16 a[152:153], v196 offset:9344
    ds_read_b64_tr_b16 a[154:155], v196 offset:13952
    v_mfma_f32_16x16x32_bf16 v[112:115], a[184:187], a[12:15], v[112:115]
    ds_read_b64_tr_b16 a[156:157], v197 offset:9344
    ds_read_b64_tr_b16 a[158:159], v197 offset:13952
    v_mfma_f32_16x16x32_bf16 v[116:119], a[184:187], a[76:79], v[116:119]
    v_mul_f32 v176, v176, v177
    v_mul_f32 v38, v211, v176
    v_mfma_f32_16x16x32_bf16 v[120:123], a[188:191], a[12:15], v[120:123]
    v_and_b32 v176, s37, v219
    v_and_b32 v177, s37, v163
    v_mfma_f32_16x16x32_bf16 v[124:127], a[188:191], a[76:79], v[124:127]
    s_waitcnt lgkmcnt(0)
    v_mul_f32 v176, v176, v177
    v_mul_f32 v39, v211, v176
    v_mfma_f32_16x16x32_bf16 v[96:99], a[144:147], a[16:19], v[96:99]
    ds_read_b64_tr_b16 a[176:177], v194 offset:18560
    ds_read_b64_tr_b16 a[178:179], v194 offset:23168
    v_mfma_f32_16x16x32_bf16 v[100:103], a[144:147], a[80:83], v[100:103]
    buffer_store_dwordx4 v[76:79], v16, s[16:19], s46 offen offset:3072 sc1
    v_mfma_f32_16x16x32_bf16 v[104:107], a[148:151], a[16:19], v[104:107]
    ds_read_b64_tr_b16 a[180:181], v195 offset:18560
    ds_read_b64_tr_b16 a[182:183], v195 offset:23168
    v_mfma_f32_16x16x32_bf16 v[108:111], a[148:151], a[80:83], v[108:111]
    ds_read_b64_tr_b16 a[184:185], v196 offset:18560
    ds_read_b64_tr_b16 a[186:187], v196 offset:23168
    v_mfma_f32_16x16x32_bf16 v[112:115], a[152:155], a[16:19], v[112:115]
    ds_read_b64_tr_b16 a[188:189], v197 offset:18560
    ds_read_b64_tr_b16 a[190:191], v197 offset:23168
    v_mfma_f32_16x16x32_bf16 v[116:119], a[152:155], a[80:83], v[116:119]
    v_lshlrev_b32 v176, 16, v220
    v_lshlrev_b32 v177, 16, v164
    v_mfma_f32_16x16x32_bf16 v[120:123], a[156:159], a[16:19], v[120:123]
    v_mul_f32 v176, v176, v177
    v_mul_f32 v40, v210, v176
    v_mfma_f32_16x16x32_bf16 v[124:127], a[156:159], a[80:83], v[124:127]
    s_waitcnt lgkmcnt(0)
    v_and_b32 v176, s37, v220
    v_and_b32 v177, s37, v164
    v_mfma_f32_16x16x32_bf16 v[96:99], a[176:179], a[20:23], v[96:99]
    ds_read_b64_tr_b16 a[144:145], v194 offset:27776
    ds_read_b64_tr_b16 a[146:147], v194 offset:32384
    v_mfma_f32_16x16x32_bf16 v[100:103], a[176:179], a[84:87], v[100:103]
    v_mul_f32 v176, v176, v177
    v_mul_f32 v41, v210, v176
    v_mfma_f32_16x16x32_bf16 v[104:107], a[180:183], a[20:23], v[104:107]
    ds_read_b64_tr_b16 a[148:149], v195 offset:27776
    ds_read_b64_tr_b16 a[150:151], v195 offset:32384
    v_mfma_f32_16x16x32_bf16 v[108:111], a[180:183], a[84:87], v[108:111]
    ds_read_b64_tr_b16 a[152:153], v196 offset:27776
    ds_read_b64_tr_b16 a[154:155], v196 offset:32384
    v_mfma_f32_16x16x32_bf16 v[112:115], a[184:187], a[20:23], v[112:115]
    ds_read_b64_tr_b16 a[156:157], v197 offset:27776
    ds_read_b64_tr_b16 a[158:159], v197 offset:32384
    v_mfma_f32_16x16x32_bf16 v[116:119], a[184:187], a[84:87], v[116:119]
    v_lshlrev_b32 v176, 16, v221
    v_lshlrev_b32 v177, 16, v165
    v_mfma_f32_16x16x32_bf16 v[120:123], a[188:191], a[20:23], v[120:123]
    v_mul_f32 v176, v176, v177
    v_mul_f32 v42, v210, v176
    v_mfma_f32_16x16x32_bf16 v[124:127], a[188:191], a[84:87], v[124:127]
    s_waitcnt lgkmcnt(0)
    v_and_b32 v176, s37, v221
    v_and_b32 v177, s37, v165
    v_mfma_f32_16x16x32_bf16 v[96:99], a[144:147], a[24:27], v[96:99]
    ds_read_b64_tr_b16 a[176:177], v194 offset:36992
    ds_read_b64_tr_b16 a[178:179], v194 offset:41600
    v_mfma_f32_16x16x32_bf16 v[100:103], a[144:147], a[88:91], v[100:103]
    v_mul_f32 v176, v176, v177
    v_mul_f32 v43, v210, v176
    v_mfma_f32_16x16x32_bf16 v[104:107], a[148:151], a[24:27], v[104:107]
    ds_read_b64_tr_b16 a[180:181], v195 offset:36992
    ds_read_b64_tr_b16 a[182:183], v195 offset:41600
    v_mfma_f32_16x16x32_bf16 v[108:111], a[148:151], a[88:91], v[108:111]
    ds_read_b64_tr_b16 a[184:185], v196 offset:36992
    ds_read_b64_tr_b16 a[186:187], v196 offset:41600
    v_mfma_f32_16x16x32_bf16 v[112:115], a[152:155], a[24:27], v[112:115]
    ds_read_b64_tr_b16 a[188:189], v197 offset:36992
    ds_read_b64_tr_b16 a[190:191], v197 offset:41600
    v_mfma_f32_16x16x32_bf16 v[116:119], a[152:155], a[88:91], v[116:119]
    v_lshlrev_b32 v176, 16, v222
    v_lshlrev_b32 v177, 16, v166
    v_mfma_f32_16x16x32_bf16 v[120:123], a[156:159], a[24:27], v[120:123]
gated_mix__ssm_conv_h3__compressed_kv_cla__prompt_kernel_pad14:
    s_cbranch_execz gated_mix__ssm_conv_h3__compressed_kv_cla__prompt_kernel_pad18
    v_mul_f32 v176, v176, v177
    v_mul_f32 v44, v211, v176
    v_mfma_f32_16x16x32_bf16 v[124:127], a[156:159], a[88:91], v[124:127]
    s_waitcnt lgkmcnt(0)
    v_and_b32 v176, s37, v222
    v_and_b32 v177, s37, v166
    v_mfma_f32_16x16x32_bf16 v[96:99], a[176:179], a[28:31], v[96:99]
    ds_read_b64_tr_b16 a[144:145], v194 offset:46208
    ds_read_b64_tr_b16 a[146:147], v194 offset:50816
    v_mfma_f32_16x16x32_bf16 v[100:103], a[176:179], a[92:95], v[100:103]
    v_mul_f32 v176, v176, v177
    v_mul_f32 v45, v211, v176
    v_mfma_f32_16x16x32_bf16 v[104:107], a[180:183], a[28:31], v[104:107]
    ds_read_b64_tr_b16 a[148:149], v195 offset:46208
    ds_read_b64_tr_b16 a[150:151], v195 offset:50816
    v_mfma_f32_16x16x32_bf16 v[108:111], a[180:183], a[92:95], v[108:111]
    ds_read_b64_tr_b16 a[152:153], v196 offset:46208
    ds_read_b64_tr_b16 a[154:155], v196 offset:50816
    v_mfma_f32_16x16x32_bf16 v[112:115], a[184:187], a[28:31], v[112:115]
    ds_read_b64_tr_b16 a[156:157], v197 offset:46208
    ds_read_b64_tr_b16 a[158:159], v197 offset:50816
    v_mfma_f32_16x16x32_bf16 v[116:119], a[184:187], a[92:95], v[116:119]
    v_lshlrev_b32 v176, 16, v223
    v_lshlrev_b32 v177, 16, v167
    v_mfma_f32_16x16x32_bf16 v[120:123], a[188:191], a[28:31], v[120:123]
    v_mul_f32 v176, v176, v177
    v_mul_f32 v46, v211, v176
    v_mfma_f32_16x16x32_bf16 v[124:127], a[188:191], a[92:95], v[124:127]
    s_waitcnt lgkmcnt(0)
    v_and_b32 v176, s37, v223
    v_and_b32 v177, s37, v167
    v_mfma_f32_16x16x32_bf16 v[96:99], a[144:147], a[32:35], v[96:99]
    ds_read_b64_tr_b16 a[176:177], v194 offset:55424
    ds_read_b64_tr_b16 a[178:179], v194 offset:60032
    v_mfma_f32_16x16x32_bf16 v[100:103], a[144:147], a[96:99], v[100:103]
    v_mul_f32 v176, v176, v177
    v_mul_f32 v47, v211, v176
    v_mfma_f32_16x16x32_bf16 v[104:107], a[148:151], a[32:35], v[104:107]
    ds_read_b64_tr_b16 a[180:181], v195 offset:55424
    ds_read_b64_tr_b16 a[182:183], v195 offset:60032
    v_mfma_f32_16x16x32_bf16 v[108:111], a[148:151], a[96:99], v[108:111]
    ds_read_b64_tr_b16 a[184:185], v196 offset:55424
    ds_read_b64_tr_b16 a[186:187], v196 offset:60032
    v_mfma_f32_16x16x32_bf16 v[112:115], a[152:155], a[32:35], v[112:115]
    ds_read_b64_tr_b16 a[188:189], v197 offset:55424
    ds_read_b64_tr_b16 a[190:191], v197 offset:60032
    v_mfma_f32_16x16x32_bf16 v[116:119], a[152:155], a[96:99], v[116:119]
    v_lshlrev_b32 v176, 16, v224
    v_lshlrev_b32 v177, 16, v168
    v_mfma_f32_16x16x32_bf16 v[120:123], a[156:159], a[32:35], v[120:123]
    v_mul_f32 v176, v176, v177
    v_mul_f32 v48, v210, v176
    v_mfma_f32_16x16x32_bf16 v[124:127], a[156:159], a[96:99], v[124:127]
    s_waitcnt lgkmcnt(0)
    v_and_b32 v176, s37, v224
    v_and_b32 v177, s37, v168
    v_mfma_f32_16x16x32_bf16 v[96:99], a[176:179], a[36:39], v[96:99]
    ds_read_b64_tr_b16 a[144:145], v198 offset:128
    ds_read_b64_tr_b16 a[146:147], v198 offset:4736
    v_mfma_f32_16x16x32_bf16 v[100:103], a[176:179], a[100:103], v[100:103]
    v_mul_f32 v176, v176, v177
    v_mul_f32 v49, v210, v176
    v_mfma_f32_16x16x32_bf16 v[104:107], a[180:183], a[36:39], v[104:107]
    ds_read_b64_tr_b16 a[148:149], v199 offset:128
    ds_read_b64_tr_b16 a[150:151], v199 offset:4736
    v_mfma_f32_16x16x32_bf16 v[108:111], a[180:183], a[100:103], v[108:111]
    ds_read_b64_tr_b16 a[152:153], v200 offset:128
    ds_read_b64_tr_b16 a[154:155], v200 offset:4736
    v_mfma_f32_16x16x32_bf16 v[112:115], a[184:187], a[36:39], v[112:115]
    ds_read_b64_tr_b16 a[156:157], v201 offset:128
    ds_read_b64_tr_b16 a[158:159], v201 offset:4736
    v_mfma_f32_16x16x32_bf16 v[116:119], a[184:187], a[100:103], v[116:119]
    s_xor_b32 s46, s46, 32768
    v_lshlrev_b32 v176, 16, v225
    v_lshlrev_b32 v177, 16, v169
    v_mfma_f32_16x16x32_bf16 v[120:123], a[188:191], a[36:39], v[120:123]
    v_mul_f32 v176, v176, v177
    v_mul_f32 v50, v210, v176
    v_mfma_f32_16x16x32_bf16 v[124:127], a[188:191], a[100:103], v[124:127]
    s_waitcnt lgkmcnt(0)
    v_and_b32 v176, s37, v225
    v_and_b32 v177, s37, v169
    v_mfma_f32_16x16x32_bf16 v[96:99], a[144:147], a[40:43], v[96:99]
    ds_read_b64_tr_b16 a[176:177], v198 offset:9344
    ds_read_b64_tr_b16 a[178:179], v198 offset:13952
    v_mfma_f32_16x16x32_bf16 v[100:103], a[144:147], a[104:107], v[100:103]
    buffer_load_dwordx4 v[128:131], v16, s[16:19], s46 offen offset:0 sc1
    v_mfma_f32_16x16x32_bf16 v[104:107], a[148:151], a[40:43], v[104:107]
    ds_read_b64_tr_b16 a[180:181], v199 offset:9344
    ds_read_b64_tr_b16 a[182:183], v199 offset:13952
    v_mfma_f32_16x16x32_bf16 v[108:111], a[148:151], a[104:107], v[108:111]
    ds_read_b64_tr_b16 a[184:185], v200 offset:9344
    ds_read_b64_tr_b16 a[186:187], v200 offset:13952
    v_mfma_f32_16x16x32_bf16 v[112:115], a[152:155], a[40:43], v[112:115]
    ds_read_b64_tr_b16 a[188:189], v201 offset:9344
    ds_read_b64_tr_b16 a[190:191], v201 offset:13952
    v_mfma_f32_16x16x32_bf16 v[116:119], a[152:155], a[104:107], v[116:119]
    v_mul_f32 v176, v176, v177
    v_mul_f32 v51, v210, v176
    v_mfma_f32_16x16x32_bf16 v[120:123], a[156:159], a[40:43], v[120:123]
    buffer_load_dwordx4 v[132:135], v16, s[16:19], s46 offen offset:1024 sc1
    v_mfma_f32_16x16x32_bf16 v[124:127], a[156:159], a[104:107], v[124:127]
    s_waitcnt lgkmcnt(0)
    v_lshlrev_b32 v176, 16, v226
    v_lshlrev_b32 v177, 16, v170
    v_mfma_f32_16x16x32_bf16 v[96:99], a[176:179], a[44:47], v[96:99]
    ds_read_b64_tr_b16 a[144:145], v198 offset:18560
    ds_read_b64_tr_b16 a[146:147], v198 offset:23168
    v_mfma_f32_16x16x32_bf16 v[100:103], a[176:179], a[108:111], v[100:103]
    buffer_load_dwordx4 v[136:139], v16, s[16:19], s46 offen offset:2048 sc1
    v_mfma_f32_16x16x32_bf16 v[104:107], a[180:183], a[44:47], v[104:107]
    ds_read_b64_tr_b16 a[148:149], v199 offset:18560
    ds_read_b64_tr_b16 a[150:151], v199 offset:23168
    v_mfma_f32_16x16x32_bf16 v[108:111], a[180:183], a[108:111], v[108:111]
    ds_read_b64_tr_b16 a[152:153], v200 offset:18560
    ds_read_b64_tr_b16 a[154:155], v200 offset:23168
    v_mfma_f32_16x16x32_bf16 v[112:115], a[184:187], a[44:47], v[112:115]
    ds_read_b64_tr_b16 a[156:157], v201 offset:18560
    ds_read_b64_tr_b16 a[158:159], v201 offset:23168
    v_mfma_f32_16x16x32_bf16 v[116:119], a[184:187], a[108:111], v[116:119]
    v_mul_f32 v176, v176, v177
    v_mul_f32 v52, v211, v176
    v_mfma_f32_16x16x32_bf16 v[120:123], a[188:191], a[44:47], v[120:123]
    buffer_load_dwordx4 v[140:143], v16, s[16:19], s46 offen offset:3072 sc1
    v_mfma_f32_16x16x32_bf16 v[124:127], a[188:191], a[108:111], v[124:127]
    s_waitcnt lgkmcnt(0)
    v_and_b32 v176, s37, v226
    v_and_b32 v177, s37, v170
    v_mfma_f32_16x16x32_bf16 v[96:99], a[144:147], a[48:51], v[96:99]
    ds_read_b64_tr_b16 a[176:177], v198 offset:27776
    ds_read_b64_tr_b16 a[178:179], v198 offset:32384
    v_mfma_f32_16x16x32_bf16 v[100:103], a[144:147], a[112:115], v[100:103]
    v_mul_f32 v176, v176, v177
    v_mul_f32 v53, v211, v176
    v_mfma_f32_16x16x32_bf16 v[104:107], a[148:151], a[48:51], v[104:107]
    ds_read_b64_tr_b16 a[180:181], v199 offset:27776
    ds_read_b64_tr_b16 a[182:183], v199 offset:32384
    v_mfma_f32_16x16x32_bf16 v[108:111], a[148:151], a[112:115], v[108:111]
    ds_read_b64_tr_b16 a[184:185], v200 offset:27776
    ds_read_b64_tr_b16 a[186:187], v200 offset:32384
    v_mfma_f32_16x16x32_bf16 v[112:115], a[152:155], a[48:51], v[112:115]
    ds_read_b64_tr_b16 a[188:189], v201 offset:27776
    ds_read_b64_tr_b16 a[190:191], v201 offset:32384
    v_mfma_f32_16x16x32_bf16 v[116:119], a[152:155], a[112:115], v[116:119]
    v_lshlrev_b32 v176, 16, v227
    v_lshlrev_b32 v177, 16, v171
    v_mfma_f32_16x16x32_bf16 v[120:123], a[156:159], a[48:51], v[120:123]
    v_mul_f32 v176, v176, v177
    v_mul_f32 v54, v211, v176
    v_mfma_f32_16x16x32_bf16 v[124:127], a[156:159], a[112:115], v[124:127]
    s_waitcnt lgkmcnt(0)
    v_and_b32 v176, s37, v227
    v_and_b32 v177, s37, v171
    v_mfma_f32_16x16x32_bf16 v[96:99], a[176:179], a[52:55], v[96:99]
    ds_read_b64_tr_b16 a[144:145], v198 offset:36992
    ds_read_b64_tr_b16 a[146:147], v198 offset:41600
    v_mfma_f32_16x16x32_bf16 v[100:103], a[176:179], a[116:119], v[100:103]
    v_mul_f32 v176, v176, v177
    v_mul_f32 v55, v211, v176
    v_mfma_f32_16x16x32_bf16 v[104:107], a[180:183], a[52:55], v[104:107]
    ds_read_b64_tr_b16 a[148:149], v199 offset:36992
    ds_read_b64_tr_b16 a[150:151], v199 offset:41600
    v_mfma_f32_16x16x32_bf16 v[108:111], a[180:183], a[116:119], v[108:111]
    ds_read_b64_tr_b16 a[152:153], v200 offset:36992
    ds_read_b64_tr_b16 a[154:155], v200 offset:41600
    v_mfma_f32_16x16x32_bf16 v[112:115], a[184:187], a[52:55], v[112:115]
    ds_read_b64_tr_b16 a[156:157], v201 offset:36992
    ds_read_b64_tr_b16 a[158:159], v201 offset:41600
    v_mfma_f32_16x16x32_bf16 v[116:119], a[184:187], a[116:119], v[116:119]
    v_lshlrev_b32 v176, 16, v228
    v_lshlrev_b32 v177, 16, v172
    v_mfma_f32_16x16x32_bf16 v[120:123], a[188:191], a[52:55], v[120:123]
    v_mul_f32 v176, v176, v177
    v_mul_f32 v56, v210, v176
    v_mfma_f32_16x16x32_bf16 v[124:127], a[188:191], a[116:119], v[124:127]
    s_waitcnt lgkmcnt(0)
    v_and_b32 v176, s37, v228
    v_and_b32 v177, s37, v172
    v_mfma_f32_16x16x32_bf16 v[96:99], a[144:147], a[56:59], v[96:99]
    ds_read_b64_tr_b16 a[176:177], v198 offset:46208
    ds_read_b64_tr_b16 a[178:179], v198 offset:50816
    v_mfma_f32_16x16x32_bf16 v[100:103], a[144:147], a[120:123], v[100:103]
    v_mul_f32 v176, v176, v177
    v_mul_f32 v57, v210, v176
    v_mfma_f32_16x16x32_bf16 v[104:107], a[148:151], a[56:59], v[104:107]
    ds_read_b64_tr_b16 a[180:181], v199 offset:46208
    ds_read_b64_tr_b16 a[182:183], v199 offset:50816
    v_mfma_f32_16x16x32_bf16 v[108:111], a[148:151], a[120:123], v[108:111]
    ds_read_b64_tr_b16 a[184:185], v200 offset:46208
    ds_read_b64_tr_b16 a[186:187], v200 offset:50816
    v_mfma_f32_16x16x32_bf16 v[112:115], a[152:155], a[56:59], v[112:115]
    ds_read_b64_tr_b16 a[188:189], v201 offset:46208
    ds_read_b64_tr_b16 a[190:191], v201 offset:50816
    v_mfma_f32_16x16x32_bf16 v[116:119], a[152:155], a[120:123], v[116:119]
    v_lshlrev_b32 v176, 16, v229
    v_lshlrev_b32 v177, 16, v173
    v_mfma_f32_16x16x32_bf16 v[120:123], a[156:159], a[56:59], v[120:123]
    v_mul_f32 v176, v176, v177
    v_mul_f32 v58, v210, v176
    v_mfma_f32_16x16x32_bf16 v[124:127], a[156:159], a[120:123], v[124:127]
    s_waitcnt lgkmcnt(0)
    v_and_b32 v176, s37, v229
    v_and_b32 v177, s37, v173
    v_mfma_f32_16x16x32_bf16 v[96:99], a[176:179], a[60:63], v[96:99]
    v_mfma_f32_16x16x32_bf16 v[100:103], a[176:179], a[124:127], v[100:103]
    v_mul_f32 v176, v176, v177
    v_mul_f32 v59, v210, v176
    v_mfma_f32_16x16x32_bf16 v[104:107], a[180:183], a[60:63], v[104:107]
    v_mfma_f32_16x16x32_bf16 v[108:111], a[180:183], a[124:127], v[108:111]
    v_mfma_f32_16x16x32_bf16 v[112:115], a[184:187], a[60:63], v[112:115]
    v_mfma_f32_16x16x32_bf16 v[116:119], a[184:187], a[124:127], v[116:119]
    v_lshlrev_b32 v176, 16, v230
    v_lshlrev_b32 v177, 16, v174
    v_mfma_f32_16x16x32_bf16 v[120:123], a[188:191], a[60:63], v[120:123]
    v_mul_f32 v176, v176, v177
    v_mul_f32 v60, v211, v176
    v_mfma_f32_16x16x32_bf16 v[124:127], a[188:191], a[124:127], v[124:127]
    s_waitcnt lgkmcnt(0)
    v_and_b32 v176, s37, v230
    v_and_b32 v177, s37, v174
    v_mul_f32 v176, v176, v177
    v_mul_f32 v61, v211, v176
    v_lshlrev_b32 v176, 16, v231
    v_lshlrev_b32 v177, 16, v175
    v_mul_f32 v176, v176, v177
    v_mul_f32 v62, v211, v176
    v_and_b32 v176, s37, v231
    v_and_b32 v177, s37, v175
    v_mul_f32 v176, v176, v177
    v_mul_f32 v63, v211, v176
    v_sub_f32 v210, 1.0, v210
    v_sub_f32 v211, 1.0, v211
    v_bfe_u32 v176, v16, 8, 1
    v_mad_u32_u24 v206, v176, 24, v206
    s_waitcnt vmcnt(0)
    v_max3_u32 v178, v128, v129, v130
    v_max3_u32 v178, v178, v131, v132
    v_max3_u32 v178, v178, v133, v134
    v_max3_u32 v178, v178, v135, v136
    v_max3_u32 v178, v178, v137, v138
    v_max3_u32 v178, v178, v139, v140
    v_max3_u32 v178, v178, v141, v142
    v_max_u32 v178, v178, v143
    v_cmp_eq_u32 vcc, -1, v178
    s_nop 0
    s_cbranch_vccnz gated_mix__ssm_conv_h3__compressed_kv_cla__prompt_kernel_spin_x
gated_mix__ssm_conv_h3__compressed_kv_cla__prompt_kernel_spin_x_ret:
    v_lshlrev_b32 v176, 16, v128
    v_add_f32 v96, v96, v176
    v_and_b32 v177, s37, v128
    v_add_f32 v97, v97, v177
    v_lshlrev_b32 v178, 16, v129
    v_add_f32 v98, v98, v178
    v_and_b32 v179, s37, v129
    v_add_f32 v99, v99, v179
    v_fma_f32 v96, v96, v210, v32
    v_fma_f32 v97, v97, v210, v33
    v_fma_f32 v98, v98, v210, v34
    v_fma_f32 v99, v99, v210, v35
    v_cvt_pk_bf16_f32 v180, v96, v97
    v_cvt_pk_bf16_f32 v181, v98, v99
    v_lshlrev_b32 v176, 16, v132
    v_add_f32 v104, v104, v176
    v_and_b32 v177, s37, v132
    v_add_f32 v105, v105, v177
    v_lshlrev_b32 v178, 16, v133
    v_add_f32 v106, v106, v178
    v_and_b32 v179, s37, v133
    v_add_f32 v107, v107, v179
    v_fma_f32 v104, v104, v210, v40
    v_fma_f32 v105, v105, v210, v41
    v_fma_f32 v106, v106, v210, v42
    v_fma_f32 v107, v107, v210, v43
    v_cvt_pk_bf16_f32 v182, v104, v105
    v_cvt_pk_bf16_f32 v183, v106, v107
    s_nop 0
    v_permlane16_swap_b32 v180, v182
    v_permlane16_swap_b32 v181, v183
    buffer_store_dwordx4 v[180:183], v206, s[20:23], s48 offen offset:0
    v_lshlrev_b32 v176, 16, v136
    v_add_f32 v112, v112, v176
    v_and_b32 v177, s37, v136
    v_add_f32 v113, v113, v177
    v_lshlrev_b32 v178, 16, v137
    v_add_f32 v114, v114, v178
    v_and_b32 v179, s37, v137
    v_add_f32 v115, v115, v179
    v_fma_f32 v112, v112, v210, v48
    v_fma_f32 v113, v113, v210, v49
    v_fma_f32 v114, v114, v210, v50
    v_fma_f32 v115, v115, v210, v51
    v_cvt_pk_bf16_f32 v184, v112, v113
    v_cvt_pk_bf16_f32 v185, v114, v115
    v_lshlrev_b32 v176, 16, v140
    v_add_f32 v120, v120, v176
    v_and_b32 v177, s37, v140
    v_add_f32 v121, v121, v177
    v_lshlrev_b32 v178, 16, v141
    v_add_f32 v122, v122, v178
    v_and_b32 v179, s37, v141
    v_add_f32 v123, v123, v179
    v_fma_f32 v120, v120, v210, v56
    v_fma_f32 v121, v121, v210, v57
    v_fma_f32 v122, v122, v210, v58
    v_fma_f32 v123, v123, v210, v59
    v_cvt_pk_bf16_f32 v186, v120, v121
    v_cvt_pk_bf16_f32 v187, v122, v123
    s_nop 0
    v_permlane16_swap_b32 v184, v186
    v_permlane16_swap_b32 v185, v187
    buffer_store_dwordx4 v[184:187], v206, s[20:23], s48 offen offset:64
    v_lshlrev_b32 v176, 16, v130
    v_add_f32 v100, v100, v176
    v_and_b32 v177, s37, v130
    v_add_f32 v101, v101, v177
    v_lshlrev_b32 v178, 16, v131
    v_add_f32 v102, v102, v178
    v_and_b32 v179, s37, v131
    v_add_f32 v103, v103, v179
    v_fma_f32 v100, v100, v211, v36
    v_fma_f32 v101, v101, v211, v37
    v_fma_f32 v102, v102, v211, v38
    v_fma_f32 v103, v103, v211, v39
    v_cvt_pk_bf16_f32 v180, v100, v101
    v_cvt_pk_bf16_f32 v181, v102, v103
    v_lshlrev_b32 v176, 16, v134
    v_add_f32 v108, v108, v176
    v_and_b32 v177, s37, v134
    v_add_f32 v109, v109, v177
    v_lshlrev_b32 v178, 16, v135
    v_add_f32 v110, v110, v178
    v_and_b32 v179, s37, v135
    v_add_f32 v111, v111, v179
    v_fma_f32 v108, v108, v211, v44
    v_fma_f32 v109, v109, v211, v45
    v_fma_f32 v110, v110, v211, v46
    v_fma_f32 v111, v111, v211, v47
    v_cvt_pk_bf16_f32 v182, v108, v109
    v_cvt_pk_bf16_f32 v183, v110, v111
    s_nop 0
    v_permlane16_swap_b32 v180, v182
    v_permlane16_swap_b32 v181, v183
    buffer_store_dwordx4 v[180:183], v206, s[20:23], s49 offen offset:0
    v_lshlrev_b32 v176, 16, v138
    v_add_f32 v116, v116, v176
    v_and_b32 v177, s37, v138
    v_add_f32 v117, v117, v177
    v_lshlrev_b32 v178, 16, v139
    v_add_f32 v118, v118, v178
    v_and_b32 v179, s37, v139
    v_add_f32 v119, v119, v179
    v_fma_f32 v116, v116, v211, v52
    v_fma_f32 v117, v117, v211, v53
    v_fma_f32 v118, v118, v211, v54
    v_fma_f32 v119, v119, v211, v55
    v_cvt_pk_bf16_f32 v184, v116, v117
    v_cvt_pk_bf16_f32 v185, v118, v119
    v_lshlrev_b32 v176, 16, v142
    v_add_f32 v124, v124, v176
    v_and_b32 v177, s37, v142
    v_add_f32 v125, v125, v177
    v_lshlrev_b32 v178, 16, v143
    v_add_f32 v126, v126, v178
    v_and_b32 v179, s37, v143
    v_add_f32 v127, v127, v179
    v_fma_f32 v124, v124, v211, v60
    v_fma_f32 v125, v125, v211, v61
    v_fma_f32 v126, v126, v211, v62
    v_fma_f32 v127, v127, v211, v63
    v_cvt_pk_bf16_f32 v186, v124, v125
    v_cvt_pk_bf16_f32 v187, v126, v127
    s_nop 0
    v_permlane16_swap_b32 v184, v186
    v_permlane16_swap_b32 v185, v187
    buffer_store_dwordx4 v[184:187], v206, s[20:23], s49 offen offset:64
gated_mix__ssm_conv_h3__compressed_kv_cla__prompt_kernel_end:
    s_endpgm
gated_mix__ssm_conv_h3__compressed_kv_cla__prompt_kernel_wb:
    v_bfe_u32 v3, v16, 1, 8
    s_branch gated_mix__ssm_conv_h3__compressed_kv_cla__prompt_kernel_wbs
gated_mix__ssm_conv_h3__compressed_kv_cla__prompt_kernel_wbs_ret:
    v_bfe_u32 v3, v16, 2, 5
    buffer_wbl2 sc1
    s_waitcnt vmcnt(0)
    s_branch gated_mix__ssm_conv_h3__compressed_kv_cla__prompt_kernel_wb_ret
gated_mix__ssm_conv_h3__compressed_kv_cla__prompt_kernel_wbs:
    s_mov_b32 s54, 0
gated_mix__ssm_conv_h3__compressed_kv_cla__prompt_kernel_wbs_again:
    s_sleep 2
    buffer_load_dword v9, v3, s[76:79], 0 offen sc1
    s_waitcnt vmcnt(0)
    v_and_b32 v11, v10, v9
    v_lshrrev_b32 v12, 4, v9
    v_and_b32 v12, v10, v12
    v_sad_u8 v11, v11, 0, 0
    v_sad_u8 v11, v12, 0, v11
    v_cmp_ne_u32 vcc, 8, v11
    s_add_u32 s54, s54, 1
    s_cmp_gt_u32 s54, 0x40000
    s_cbranch_scc1 gated_mix__ssm_conv_h3__compressed_kv_cla__prompt_kernel_wbs_ret
    s_cbranch_vccnz gated_mix__ssm_conv_h3__compressed_kv_cla__prompt_kernel_wbs_again
    s_branch gated_mix__ssm_conv_h3__compressed_kv_cla__prompt_kernel_wbs_ret
gated_mix__ssm_conv_h3__compressed_kv_cla__prompt_kernel_spin_kv:
    s_mov_b32 s54, 0
gated_mix__ssm_conv_h3__compressed_kv_cla__prompt_kernel_spin_kv_again:
    s_sleep 2
    buffer_load_dword v2, v3, s[28:31], s40 offen sc1
    s_waitcnt vmcnt(0)
    v_cmp_ne_u32 vcc, 1, v2
    s_add_u32 s54, s54, 1
    s_cmp_gt_u32 s54, 0x40000
    s_cbranch_scc1 gated_mix__ssm_conv_h3__compressed_kv_cla__prompt_kernel_spin_kv_ret
    s_cbranch_vccnz gated_mix__ssm_conv_h3__compressed_kv_cla__prompt_kernel_spin_kv_again
    s_branch gated_mix__ssm_conv_h3__compressed_kv_cla__prompt_kernel_spin_kv_ret
gated_mix__ssm_conv_h3__compressed_kv_cla__prompt_kernel_b4_sw:
gated_mix__ssm_conv_h3__compressed_kv_cla__prompt_kernel_pad15:
    s_cbranch_execz gated_mix__ssm_conv_h3__compressed_kv_cla__prompt_kernel_pad19
    s_waitcnt vmcnt(8)
    v_and_b32 v17, v28, v29
    v_and_b32 v18, v30, v31
    v_and_b32 v17, v17, v18
    v_cmp_ne_u32 vcc, 1, v17
    s_mov_b32 s58, s35
    s_cbranch_vccnz gated_mix__ssm_conv_h3__compressed_kv_cla__prompt_kernel_b4_sw_spin
gated_mix__ssm_conv_h3__compressed_kv_cla__prompt_kernel_b4_sw_spin_ret:
    s_lshl_b32 s36, s2, 2
    s_cmp_eq_u32 s32, 0
    s_cbranch_scc1 gated_mix__ssm_conv_h3__compressed_kv_cla__prompt_kernel_b4_sw_h
    s_add_u32 s12, s94, 50331648
    s_addc_u32 s13, s95, 0
    s_mov_b32 s14, 4718592
    s_mov_b32 s15, 0x00020000
    s_mul_i32 s38, s36, 4608
    s_movk_i32 s44, 4608
    s_mov_b32 s49, -2
    s_movk_i32 s50, 4640
    s_lshl_b32 s37, s32, 2
    s_sub_u32 s37, 10, s37
    s_add_u32 s38, s38, s37
    s_mul_i32 s59, s32, 9280
    s_add_u32 s59, s59, 4294966496
    s_cmp_eq_u32 s32, 3
    s_cbranch_scc0 gated_mix__ssm_conv_h3__compressed_kv_cla__prompt_kernel_b4_sw_go
    s_mov_b32 s14, 0
    s_mov_b32 s38, 2
    s_movk_i32 s59, 27648
    s_mov_b32 s50, 0
    s_branch gated_mix__ssm_conv_h3__compressed_kv_cla__prompt_kernel_b4_sw_go
gated_mix__ssm_conv_h3__compressed_kv_cla__prompt_kernel_b4_sw_h:
gated_mix__ssm_conv_h3__compressed_kv_cla__prompt_kernel_pad16:
    s_cbranch_execz gated_mix__ssm_conv_h3__compressed_kv_cla__prompt_kernel_pad20
    s_mov_b32 s12, s72
    s_mov_b32 s13, s73
    s_mov_b32 s14, 4194304
    s_mov_b32 s15, 0x00020000
    s_lshl_b32 s38, s36, 12
    s_movk_i32 s44, 4096
    s_mov_b32 s49, 8
    s_movk_i32 s50, 4240
    s_movk_i32 s59, 128
gated_mix__ssm_conv_h3__compressed_kv_cla__prompt_kernel_b4_sw_go:
    s_mov_b32 s40, s59
    s_add_u32 s41, s59, s50
    s_branch gated_mix__ssm_conv_h3__compressed_kv_cla__prompt_kernel_b4_loop
gated_mix__ssm_conv_h3__compressed_kv_cla__prompt_kernel_b4_sw_spin:
    s_mov_b32 s54, 0
gated_mix__ssm_conv_h3__compressed_kv_cla__prompt_kernel_b4_sw_spin_again:
    s_sleep 2
    buffer_load_dwordx4 v[28:31], v16, s[28:31], s47 offen sc1
    s_waitcnt vmcnt(0)
    v_and_b32 v17, v28, v29
    v_and_b32 v18, v30, v31
    v_and_b32 v17, v17, v18
    v_cmp_ne_u32 vcc, 1, v17
    s_add_u32 s54, s54, 1
    s_cmp_gt_u32 s54, 0x40000
    s_cbranch_scc1 gated_mix__ssm_conv_h3__compressed_kv_cla__prompt_kernel_b4_sw_spin_ret
    s_cbranch_vccnz gated_mix__ssm_conv_h3__compressed_kv_cla__prompt_kernel_b4_sw_spin_again
    s_branch gated_mix__ssm_conv_h3__compressed_kv_cla__prompt_kernel_b4_sw_spin_ret
gated_mix__ssm_conv_h3__compressed_kv_cla__prompt_kernel_b2_sw:
gated_mix__ssm_conv_h3__compressed_kv_cla__prompt_kernel_pad17:
    s_cbranch_execz gated_mix__ssm_conv_h3__compressed_kv_cla__prompt_kernel_pad21
    s_waitcnt vmcnt(8)
    v_and_b32 v17, v28, v29
    v_and_b32 v18, v30, v31
    v_and_b32 v17, v17, v18
    v_cmp_ne_u32 vcc, 1, v17
    s_mov_b32 s58, s35
    s_cbranch_vccnz gated_mix__ssm_conv_h3__compressed_kv_cla__prompt_kernel_b2_sw_spin
gated_mix__ssm_conv_h3__compressed_kv_cla__prompt_kernel_b2_sw_spin_ret:
    v_mov_b32 v13, 0
    v_mov_b32 v14, 1
    buffer_store_dword v14, v13, s[28:31], s55 offen sc1
    s_lshl_b32 s36, s2, 2
    s_cmp_eq_u32 s32, 0
    s_cbranch_scc1 gated_mix__ssm_conv_h3__compressed_kv_cla__prompt_kernel_b2_sw_h
    s_add_u32 s12, s94, 50331648
    s_addc_u32 s13, s95, 0
    s_mov_b32 s14, 4718592
    s_mov_b32 s15, 0x00020000
    s_mul_i32 s38, s36, 4608
    s_movk_i32 s44, 4608
    s_mov_b32 s49, -2
    s_movk_i32 s50, 4640
    s_lshl_b32 s37, s32, 2
    s_sub_u32 s37, 10, s37
    s_add_u32 s38, s38, s37
    s_mul_i32 s59, s32, 9280
    s_add_u32 s59, s59, 4294966496
    s_cmp_eq_u32 s32, 3
    s_cbranch_scc0 gated_mix__ssm_conv_h3__compressed_kv_cla__prompt_kernel_b2_sw_go
    s_mov_b32 s14, 0
    s_mov_b32 s38, 2
    s_movk_i32 s59, 27648
    s_mov_b32 s50, 0
    s_branch gated_mix__ssm_conv_h3__compressed_kv_cla__prompt_kernel_b2_sw_go
gated_mix__ssm_conv_h3__compressed_kv_cla__prompt_kernel_b2_sw_h:
gated_mix__ssm_conv_h3__compressed_kv_cla__prompt_kernel_pad18:
    s_cbranch_execz gated_mix__ssm_conv_h3__compressed_kv_cla__prompt_kernel_pad22
    s_mov_b32 s12, s72
    s_mov_b32 s13, s73
    s_mov_b32 s14, 4194304
    s_mov_b32 s15, 0x00020000
    s_lshl_b32 s38, s36, 12
    s_movk_i32 s44, 4096
    s_mov_b32 s49, 8
    s_movk_i32 s50, 4240
    s_movk_i32 s59, 128
gated_mix__ssm_conv_h3__compressed_kv_cla__prompt_kernel_b2_sw_go:
    s_mov_b32 s40, s59
    s_add_u32 s41, s59, s50
    s_branch gated_mix__ssm_conv_h3__compressed_kv_cla__prompt_kernel_b2_loop
gated_mix__ssm_conv_h3__compressed_kv_cla__prompt_kernel_b2_sw_spin:
    s_mov_b32 s54, 0
gated_mix__ssm_conv_h3__compressed_kv_cla__prompt_kernel_b2_sw_spin_again:
    s_sleep 2
    buffer_load_dwordx4 v[28:31], v16, s[28:31], s47 offen sc1
    s_waitcnt vmcnt(0)
    v_and_b32 v17, v28, v29
    v_and_b32 v18, v30, v31
    v_and_b32 v17, v17, v18
    v_cmp_ne_u32 vcc, 1, v17
    s_add_u32 s54, s54, 1
    s_cmp_gt_u32 s54, 0x40000
    s_cbranch_scc1 gated_mix__ssm_conv_h3__compressed_kv_cla__prompt_kernel_b2_sw_spin_ret
    s_cbranch_vccnz gated_mix__ssm_conv_h3__compressed_kv_cla__prompt_kernel_b2_sw_spin_again
    s_branch gated_mix__ssm_conv_h3__compressed_kv_cla__prompt_kernel_b2_sw_spin_ret
gated_mix__ssm_conv_h3__compressed_kv_cla__prompt_kernel_b4_m0:
gated_mix__ssm_conv_h3__compressed_kv_cla__prompt_kernel_pad19:
    s_cbranch_execz gated_mix__ssm_conv_h3__compressed_kv_cla__prompt_kernel_pad23
    s_nop 7
    v_add_f32 v144, v48, v144
    v_add_f32 v145, v49, v145
    v_add_f32 v146, v50, v146
    v_add_f32 v147, v51, v147
    v_add_f32 v148, v52, v148
    v_add_f32 v149, v53, v149
    v_add_f32 v150, v54, v150
    v_add_f32 v151, v55, v151
    s_branch gated_mix__ssm_conv_h3__compressed_kv_cla__prompt_kernel_b4_m0_ret
gated_mix__ssm_conv_h3__compressed_kv_cla__prompt_kernel_b4_m1:
gated_mix__ssm_conv_h3__compressed_kv_cla__prompt_kernel_pad20:
    s_cbranch_execz gated_mix__ssm_conv_h3__compressed_kv_cla__prompt_kernel_pad24
    s_nop 7
    v_add_f32 v176, v56, v176
    v_add_f32 v177, v57, v177
    v_add_f32 v178, v58, v178
    v_add_f32 v179, v59, v179
    v_add_f32 v180, v60, v180
    v_add_f32 v181, v61, v181
    v_add_f32 v182, v62, v182
    v_add_f32 v183, v63, v183
    s_branch gated_mix__ssm_conv_h3__compressed_kv_cla__prompt_kernel_b4_m1_ret
gated_mix__ssm_conv_h3__compressed_kv_cla__prompt_kernel_b2_m0:
gated_mix__ssm_conv_h3__compressed_kv_cla__prompt_kernel_pad21:
    s_cbranch_execz gated_mix__ssm_conv_h3__compressed_kv_cla__prompt_kernel_pad25
    s_nop 7
    v_add_f32 v160, v48, v160
    v_add_f32 v161, v49, v161
    v_add_f32 v162, v50, v162
    v_add_f32 v163, v51, v163
    v_add_f32 v164, v52, v164
    v_add_f32 v165, v53, v165
    v_add_f32 v166, v54, v166
    v_add_f32 v167, v55, v167
    s_branch gated_mix__ssm_conv_h3__compressed_kv_cla__prompt_kernel_b2_m0_ret
gated_mix__ssm_conv_h3__compressed_kv_cla__prompt_kernel_b2_m1:
gated_mix__ssm_conv_h3__compressed_kv_cla__prompt_kernel_pad22:
    s_cbranch_execz gated_mix__ssm_conv_h3__compressed_kv_cla__prompt_kernel_body
    s_nop 7
    v_add_f32 v192, v56, v192
    v_add_f32 v193, v57, v193
    v_add_f32 v194, v58, v194
    v_add_f32 v195, v59, v195
    v_add_f32 v196, v60, v196
    v_add_f32 v197, v61, v197
    v_add_f32 v198, v62, v198
    v_add_f32 v199, v63, v199
    s_branch gated_mix__ssm_conv_h3__compressed_kv_cla__prompt_kernel_b2_m1_ret
gated_mix__ssm_conv_h3__compressed_kv_cla__prompt_kernel_b2_m2:
gated_mix__ssm_conv_h3__compressed_kv_cla__prompt_kernel_pad23:
    s_cbranch_execz gated_mix__ssm_conv_h3__compressed_kv_cla__prompt_kernel_body
    s_nop 7
    v_add_f32 v168, v48, v168
    v_add_f32 v169, v49, v169
    v_add_f32 v170, v50, v170
    v_add_f32 v171, v51, v171
    v_add_f32 v172, v52, v172
    v_add_f32 v173, v53, v173
    v_add_f32 v174, v54, v174
    v_add_f32 v175, v55, v175
    s_branch gated_mix__ssm_conv_h3__compressed_kv_cla__prompt_kernel_b2_m2_ret
gated_mix__ssm_conv_h3__compressed_kv_cla__prompt_kernel_spin_s:
    s_mov_b32 s54, 0
gated_mix__ssm_conv_h3__compressed_kv_cla__prompt_kernel_spin_s_again:
    s_sleep 2
    buffer_load_dword v213, v212, s[28:31], s52 offen offset:0 sc1
    s_waitcnt vmcnt(0)
    v_cmp_ne_u32 vcc, 1, v213
    s_add_u32 s54, s54, 1
    s_cmp_gt_u32 s54, 0x40000
    s_cbranch_scc1 gated_mix__ssm_conv_h3__compressed_kv_cla__prompt_kernel_spin_s_ret
    s_cbranch_vccnz gated_mix__ssm_conv_h3__compressed_kv_cla__prompt_kernel_spin_s_again
    s_branch gated_mix__ssm_conv_h3__compressed_kv_cla__prompt_kernel_spin_s_ret
gated_mix__ssm_conv_h3__compressed_kv_cla__prompt_kernel_spin_l:
    s_mov_b32 s54, 0
gated_mix__ssm_conv_h3__compressed_kv_cla__prompt_kernel_spin_l_again:
    s_sleep 2
    buffer_load_dword v213, v212, s[28:31], s52 offen offset:0 sc1
    s_waitcnt vmcnt(0)
    v_cmp_ne_u32 vcc, 1, v213
    s_add_u32 s54, s54, 1
    s_cmp_gt_u32 s54, 0x40000
    s_cbranch_scc1 gated_mix__ssm_conv_h3__compressed_kv_cla__prompt_kernel_spin_l_ret
    s_cbranch_vccnz gated_mix__ssm_conv_h3__compressed_kv_cla__prompt_kernel_spin_l_again
    s_branch gated_mix__ssm_conv_h3__compressed_kv_cla__prompt_kernel_spin_l_ret
gated_mix__ssm_conv_h3__compressed_kv_cla__prompt_kernel_hook:
gated_mix__ssm_conv_h3__compressed_kv_cla__prompt_kernel_pad24:
    s_cbranch_execz gated_mix__ssm_conv_h3__compressed_kv_cla__prompt_kernel_body
    s_cmp_eq_u32 s35, 2
    s_cbranch_scc1 gated_mix__ssm_conv_h3__compressed_kv_cla__prompt_kernel_ypoll
    buffer_store_dword v9, v8, s[28:31], s57 offen sc1
    s_branch gated_mix__ssm_conv_h3__compressed_kv_cla__prompt_kernel_hook_ret
gated_mix__ssm_conv_h3__compressed_kv_cla__prompt_kernel_ypoll:
gated_mix__ssm_conv_h3__compressed_kv_cla__prompt_kernel_pad25:
    s_cbranch_execz gated_mix__ssm_conv_h3__compressed_kv_cla__prompt_kernel_body
    s_xor_b32 s36, s57, 16
    v_add_u32 v212, s53, v212
    v_mov_b32 v214, s36
    v_cmp_gt_u32 vcc, 256, v16
    s_mov_b32 s53, 0
    s_nop 0
    v_cndmask_b32 v212, v214, v212, vcc
    buffer_load_dword v213, v212, s[28:31], s53 offen sc1
    s_branch gated_mix__ssm_conv_h3__compressed_kv_cla__prompt_kernel_hook_ret
gated_mix__ssm_conv_h3__compressed_kv_cla__prompt_kernel_spin_y:
    s_mov_b32 s54, 0
gated_mix__ssm_conv_h3__compressed_kv_cla__prompt_kernel_spin_y_again:
    s_sleep 2
    buffer_load_dword v213, v212, s[28:31], s53 offen sc1
    s_waitcnt vmcnt(0)
    v_cmp_ne_u32 vcc, 1, v213
    s_add_u32 s54, s54, 1
    s_cmp_gt_u32 s54, 0x40000
    s_cbranch_scc1 gated_mix__ssm_conv_h3__compressed_kv_cla__prompt_kernel_spin_y_ret
    s_cbranch_vccnz gated_mix__ssm_conv_h3__compressed_kv_cla__prompt_kernel_spin_y_again
    s_branch gated_mix__ssm_conv_h3__compressed_kv_cla__prompt_kernel_spin_y_ret
gated_mix__ssm_conv_h3__compressed_kv_cla__prompt_kernel_spin_x:
    s_mov_b32 s54, 0
gated_mix__ssm_conv_h3__compressed_kv_cla__prompt_kernel_spin_x_again:
    s_sleep 2
    buffer_load_dwordx4 v[128:131], v16, s[16:19], s46 offen offset:0 sc1
    buffer_load_dwordx4 v[132:135], v16, s[16:19], s46 offen offset:1024 sc1
    buffer_load_dwordx4 v[136:139], v16, s[16:19], s46 offen offset:2048 sc1
    buffer_load_dwordx4 v[140:143], v16, s[16:19], s46 offen offset:3072 sc1
    s_waitcnt vmcnt(0)
    v_max3_u32 v178, v128, v129, v130
    v_max3_u32 v178, v178, v131, v132
    v_max3_u32 v178, v178, v133, v134
    v_max3_u32 v178, v178, v135, v136
    v_max3_u32 v178, v178, v137, v138
    v_max3_u32 v178, v178, v139, v140
    v_max3_u32 v178, v178, v141, v142
    v_max_u32 v178, v178, v143
    v_cmp_eq_u32 vcc, -1, v178
    s_add_u32 s54, s54, 1
    s_cmp_gt_u32 s54, 0x40000
    s_cbranch_scc1 gated_mix__ssm_conv_h3__compressed_kv_cla__prompt_kernel_spin_x_ret
    s_cbranch_vccnz gated_mix__ssm_conv_h3__compressed_kv_cla__prompt_kernel_spin_x_again
    s_branch gated_mix__ssm_conv_h3__compressed_kv_cla__prompt_kernel_spin_x_ret
gated_mix__ssm_conv_h3__compressed_kv_cla__prompt_kernel_hotend:
gated_mix__ssm_conv_h3__compressed_kv_cla__prompt_kernel_b4_r0:
    s_nop 7
    v_max3_f32 v32, v144, v145, v146
    v_max3_f32 v32, v147, v148, v32
    v_max3_f32 v32, v149, v150, v32
    v_max_f32 v32, v151, v32
    v_mov_b32 v33, v32
    s_nop 1
    v_permlane16_swap_b32 v32, v33
    s_nop 1
    v_max_f32 v32, v32, v33
    v_mov_b32 v33, v32
    s_nop 1
    v_permlane32_swap_b32 v32, v33
    s_nop 1
    v_max_f32 v32, v32, v33
    v_add_f32 v32, 0x41c00000, v32
    v_max_f32 v32, 0, v32
    v_exp_f32 v34, -v32
    v_sub_f32 v64, v64, v32
    v_sub_f32 v65, v65, v32
    v_sub_f32 v66, v66, v32
    v_sub_f32 v67, v67, v32
    v_sub_f32 v144, v144, v32
    v_sub_f32 v145, v145, v32
    v_sub_f32 v146, v146, v32
    v_sub_f32 v147, v147, v32
    v_sub_f32 v148, v148, v32
    v_sub_f32 v149, v149, v32
    v_sub_f32 v150, v150, v32
    v_sub_f32 v151, v151, v32
    v_sub_f32 v176, v176, v32
    v_sub_f32 v177, v177, v32
    v_sub_f32 v178, v178, v32
    v_sub_f32 v179, v179, v32
    v_sub_f32 v180, v180, v32
    v_sub_f32 v181, v181, v32
    v_sub_f32 v182, v182, v32
    v_sub_f32 v183, v183, v32
    v_mul_f32 v240, v240, v34
    v_mul_f32 v241, v241, v34
    v_mul_f32 v242, v242, v34
    v_mul_f32 v243, v243, v34
    v_accvgpr_read_b32 v33, a0
    v_mul_f32 v33, v33, v34
    v_accvgpr_write_b32 a0, v33
    v_accvgpr_read_b32 v33, a1
    v_mul_f32 v33, v33, v34
    v_accvgpr_write_b32 a1, v33
    v_accvgpr_read_b32 v33, a2
    v_mul_f32 v33, v33, v34
    v_accvgpr_write_b32 a2, v33
    v_accvgpr_read_b32 v33, a3
    v_mul_f32 v33, v33, v34
    v_accvgpr_write_b32 a3, v33
    v_accvgpr_read_b32 v33, a4
    v_mul_f32 v33, v33, v34
    v_accvgpr_write_b32 a4, v33
    v_accvgpr_read_b32 v33, a5
    v_mul_f32 v33, v33, v34
    v_accvgpr_write_b32 a5, v33
    v_accvgpr_read_b32 v33, a6
    v_mul_f32 v33, v33, v34
    v_accvgpr_write_b32 a6, v33
    v_accvgpr_read_b32 v33, a7
    v_mul_f32 v33, v33, v34
    v_accvgpr_write_b32 a7, v33
    v_accvgpr_read_b32 v33, a8
    v_mul_f32 v33, v33, v34
    v_accvgpr_write_b32 a8, v33
    v_accvgpr_read_b32 v33, a9
    v_mul_f32 v33, v33, v34
    v_accvgpr_write_b32 a9, v33
    v_accvgpr_read_b32 v33, a10
    v_mul_f32 v33, v33, v34
    v_accvgpr_write_b32 a10, v33
    v_accvgpr_read_b32 v33, a11
    v_mul_f32 v33, v33, v34
    v_accvgpr_write_b32 a11, v33
    v_accvgpr_read_b32 v33, a12
    v_mul_f32 v33, v33, v34
    v_accvgpr_write_b32 a12, v33
    v_accvgpr_read_b32 v33, a13
    v_mul_f32 v33, v33, v34
    v_accvgpr_write_b32 a13, v33
    v_accvgpr_read_b32 v33, a14
    v_mul_f32 v33, v33, v34
    v_accvgpr_write_b32 a14, v33
    v_accvgpr_read_b32 v33, a15
    v_mul_f32 v33, v33, v34
    v_accvgpr_write_b32 a15, v33
    v_accvgpr_read_b32 v33, a16
    v_mul_f32 v33, v33, v34
    v_accvgpr_write_b32 a16, v33
    v_accvgpr_read_b32 v33, a17
    v_mul_f32 v33, v33, v34
    v_accvgpr_write_b32 a17, v33
    v_accvgpr_read_b32 v33, a18
    v_mul_f32 v33, v33, v34
    v_accvgpr_write_b32 a18, v33
    v_accvgpr_read_b32 v33, a19
    v_mul_f32 v33, v33, v34
    v_accvgpr_write_b32 a19, v33
    v_accvgpr_read_b32 v33, a20
    v_mul_f32 v33, v33, v34
    v_accvgpr_write_b32 a20, v33
    v_accvgpr_read_b32 v33, a21
    v_mul_f32 v33, v33, v34
    v_accvgpr_write_b32 a21, v33
    v_accvgpr_read_b32 v33, a22
    v_mul_f32 v33, v33, v34
    v_accvgpr_write_b32 a22, v33
    v_accvgpr_read_b32 v33, a23
    v_mul_f32 v33, v33, v34
    v_accvgpr_write_b32 a23, v33
    v_accvgpr_read_b32 v33, a24
    v_mul_f32 v33, v33, v34
    v_accvgpr_write_b32 a24, v33
    v_accvgpr_read_b32 v33, a25
    v_mul_f32 v33, v33, v34
    v_accvgpr_write_b32 a25, v33
    v_accvgpr_read_b32 v33, a26
    v_mul_f32 v33, v33, v34
    v_accvgpr_write_b32 a26, v33
    v_accvgpr_read_b32 v33, a27
    v_mul_f32 v33, v33, v34
    v_accvgpr_write_b32 a27, v33
    v_accvgpr_read_b32 v33, a28
    v_mul_f32 v33, v33, v34
    v_accvgpr_write_b32 a28, v33
    v_accvgpr_read_b32 v33, a29
    v_mul_f32 v33, v33, v34
    v_accvgpr_write_b32 a29, v33
    v_accvgpr_read_b32 v33, a30
    v_mul_f32 v33, v33, v34
    v_accvgpr_write_b32 a30, v33
    v_accvgpr_read_b32 v33, a31
    v_mul_f32 v33, v33, v34
    v_accvgpr_write_b32 a31, v33
    v_exp_f32 v36, v144
    v_exp_f32 v37, v145
    s_nop 0
    v_cvt_pk_bf16_f32 v208, v36, v37
    v_exp_f32 v36, v146
    v_exp_f32 v37, v147
    s_nop 0
    v_cvt_pk_bf16_f32 v209, v36, v37
    v_exp_f32 v36, v148
    v_exp_f32 v37, v149
    s_nop 0
    v_cvt_pk_bf16_f32 v210, v36, v37
    v_exp_f32 v36, v150
    v_exp_f32 v37, v151
    s_nop 0
    v_cvt_pk_bf16_f32 v211, v36, v37
    v_max3_f32 v32, v152, v153, v154
    v_max3_f32 v32, v155, v156, v32
    v_max3_f32 v32, v157, v158, v32
    v_max_f32 v32, v159, v32
    v_mov_b32 v33, v32
    s_nop 1
    v_permlane16_swap_b32 v32, v33
    s_nop 1
    v_max_f32 v32, v32, v33
    v_mov_b32 v33, v32
    s_nop 1
    v_permlane32_swap_b32 v32, v33
    s_nop 1
    v_max_f32 v32, v32, v33
    v_add_f32 v32, 0x41c00000, v32
    v_max_f32 v32, 0, v32
    v_exp_f32 v34, -v32
    v_sub_f32 v68, v68, v32
    v_sub_f32 v69, v69, v32
    v_sub_f32 v70, v70, v32
    v_sub_f32 v71, v71, v32
    v_sub_f32 v152, v152, v32
    v_sub_f32 v153, v153, v32
    v_sub_f32 v154, v154, v32
    v_sub_f32 v155, v155, v32
    v_sub_f32 v156, v156, v32
    v_sub_f32 v157, v157, v32
    v_sub_f32 v158, v158, v32
    v_sub_f32 v159, v159, v32
    v_sub_f32 v184, v184, v32
    v_sub_f32 v185, v185, v32
    v_sub_f32 v186, v186, v32
    v_sub_f32 v187, v187, v32
    v_sub_f32 v188, v188, v32
    v_sub_f32 v189, v189, v32
    v_sub_f32 v190, v190, v32
    v_sub_f32 v191, v191, v32
    v_mul_f32 v244, v244, v34
    v_mul_f32 v245, v245, v34
    v_mul_f32 v246, v246, v34
    v_mul_f32 v247, v247, v34
    v_accvgpr_read_b32 v33, a32
    v_mul_f32 v33, v33, v34
    v_accvgpr_write_b32 a32, v33
    v_accvgpr_read_b32 v33, a33
    v_mul_f32 v33, v33, v34
    v_accvgpr_write_b32 a33, v33
    v_accvgpr_read_b32 v33, a34
    v_mul_f32 v33, v33, v34
    v_accvgpr_write_b32 a34, v33
    v_accvgpr_read_b32 v33, a35
    v_mul_f32 v33, v33, v34
    v_accvgpr_write_b32 a35, v33
    v_accvgpr_read_b32 v33, a36
    v_mul_f32 v33, v33, v34
    v_accvgpr_write_b32 a36, v33
    v_accvgpr_read_b32 v33, a37
    v_mul_f32 v33, v33, v34
    v_accvgpr_write_b32 a37, v33
    v_accvgpr_read_b32 v33, a38
    v_mul_f32 v33, v33, v34
    v_accvgpr_write_b32 a38, v33
    v_accvgpr_read_b32 v33, a39
    v_mul_f32 v33, v33, v34
    v_accvgpr_write_b32 a39, v33
    v_accvgpr_read_b32 v33, a40
    v_mul_f32 v33, v33, v34
    v_accvgpr_write_b32 a40, v33
    v_accvgpr_read_b32 v33, a41
    v_mul_f32 v33, v33, v34
    v_accvgpr_write_b32 a41, v33
    v_accvgpr_read_b32 v33, a42
    v_mul_f32 v33, v33, v34
    v_accvgpr_write_b32 a42, v33
    v_accvgpr_read_b32 v33, a43
    v_mul_f32 v33, v33, v34
    v_accvgpr_write_b32 a43, v33
    v_accvgpr_read_b32 v33, a44
    v_mul_f32 v33, v33, v34
    v_accvgpr_write_b32 a44, v33
    v_accvgpr_read_b32 v33, a45
    v_mul_f32 v33, v33, v34
    v_accvgpr_write_b32 a45, v33
    v_accvgpr_read_b32 v33, a46
    v_mul_f32 v33, v33, v34
    v_accvgpr_write_b32 a46, v33
    v_accvgpr_read_b32 v33, a47
    v_mul_f32 v33, v33, v34
    v_accvgpr_write_b32 a47, v33
    v_accvgpr_read_b32 v33, a48
    v_mul_f32 v33, v33, v34
    v_accvgpr_write_b32 a48, v33
    v_accvgpr_read_b32 v33, a49
    v_mul_f32 v33, v33, v34
    v_accvgpr_write_b32 a49, v33
    v_accvgpr_read_b32 v33, a50
    v_mul_f32 v33, v33, v34
    v_accvgpr_write_b32 a50, v33
    v_accvgpr_read_b32 v33, a51
    v_mul_f32 v33, v33, v34
    v_accvgpr_write_b32 a51, v33
    v_accvgpr_read_b32 v33, a52
    v_mul_f32 v33, v33, v34
    v_accvgpr_write_b32 a52, v33
    v_accvgpr_read_b32 v33, a53
    v_mul_f32 v33, v33, v34
    v_accvgpr_write_b32 a53, v33
    v_accvgpr_read_b32 v33, a54
    v_mul_f32 v33, v33, v34
    v_accvgpr_write_b32 a54, v33
    v_accvgpr_read_b32 v33, a55
    v_mul_f32 v33, v33, v34
    v_accvgpr_write_b32 a55, v33
    v_accvgpr_read_b32 v33, a56
    v_mul_f32 v33, v33, v34
    v_accvgpr_write_b32 a56, v33
    v_accvgpr_read_b32 v33, a57
    v_mul_f32 v33, v33, v34
    v_accvgpr_write_b32 a57, v33
    v_accvgpr_read_b32 v33, a58
    v_mul_f32 v33, v33, v34
    v_accvgpr_write_b32 a58, v33
    v_accvgpr_read_b32 v33, a59
    v_mul_f32 v33, v33, v34
    v_accvgpr_write_b32 a59, v33
    v_accvgpr_read_b32 v33, a60
    v_mul_f32 v33, v33, v34
    v_accvgpr_write_b32 a60, v33
    v_accvgpr_read_b32 v33, a61
    v_mul_f32 v33, v33, v34
    v_accvgpr_write_b32 a61, v33
    v_accvgpr_read_b32 v33, a62
    v_mul_f32 v33, v33, v34
    v_accvgpr_write_b32 a62, v33
    v_accvgpr_read_b32 v33, a63
    v_mul_f32 v33, v33, v34
    v_accvgpr_write_b32 a63, v33
    v_exp_f32 v36, v152
    v_exp_f32 v37, v153
    s_nop 0
    v_cvt_pk_bf16_f32 v212, v36, v37
    v_exp_f32 v36, v154
    v_exp_f32 v37, v155
    s_nop 0
    v_cvt_pk_bf16_f32 v213, v36, v37
    v_exp_f32 v36, v156
    v_exp_f32 v37, v157
    s_nop 0
    v_cvt_pk_bf16_f32 v214, v36, v37
    v_exp_f32 v36, v158
    v_exp_f32 v37, v159
    s_nop 0
    v_cvt_pk_bf16_f32 v215, v36, v37
    v_max3_f32 v32, v160, v161, v162
    v_max3_f32 v32, v163, v164, v32
    v_max3_f32 v32, v165, v166, v32
    v_max_f32 v32, v167, v32
    v_mov_b32 v33, v32
    s_nop 1
    v_permlane16_swap_b32 v32, v33
    s_nop 1
    v_max_f32 v32, v32, v33
    v_mov_b32 v33, v32
    s_nop 1
    v_permlane32_swap_b32 v32, v33
    s_nop 1
    v_max_f32 v32, v32, v33
    v_add_f32 v32, 0x41c00000, v32
    v_max_f32 v32, 0, v32
    v_exp_f32 v34, -v32
    v_sub_f32 v72, v72, v32
    v_sub_f32 v73, v73, v32
    v_sub_f32 v74, v74, v32
    v_sub_f32 v75, v75, v32
    v_sub_f32 v160, v160, v32
    v_sub_f32 v161, v161, v32
    v_sub_f32 v162, v162, v32
    v_sub_f32 v163, v163, v32
    v_sub_f32 v164, v164, v32
    v_sub_f32 v165, v165, v32
    v_sub_f32 v166, v166, v32
    v_sub_f32 v167, v167, v32
    v_sub_f32 v192, v192, v32
    v_sub_f32 v193, v193, v32
    v_sub_f32 v194, v194, v32
    v_sub_f32 v195, v195, v32
    v_sub_f32 v196, v196, v32
    v_sub_f32 v197, v197, v32
    v_sub_f32 v198, v198, v32
    v_sub_f32 v199, v199, v32
    v_mul_f32 v248, v248, v34
    v_mul_f32 v249, v249, v34
    v_mul_f32 v250, v250, v34
    v_mul_f32 v251, v251, v34
    v_accvgpr_read_b32 v33, a64
    v_mul_f32 v33, v33, v34
    v_accvgpr_write_b32 a64, v33
    v_accvgpr_read_b32 v33, a65
    v_mul_f32 v33, v33, v34
    v_accvgpr_write_b32 a65, v33
    v_accvgpr_read_b32 v33, a66
    v_mul_f32 v33, v33, v34
    v_accvgpr_write_b32 a66, v33
    v_accvgpr_read_b32 v33, a67
    v_mul_f32 v33, v33, v34
    v_accvgpr_write_b32 a67, v33
    v_accvgpr_read_b32 v33, a68
    v_mul_f32 v33, v33, v34
    v_accvgpr_write_b32 a68, v33
    v_accvgpr_read_b32 v33, a69
    v_mul_f32 v33, v33, v34
    v_accvgpr_write_b32 a69, v33
    v_accvgpr_read_b32 v33, a70
    v_mul_f32 v33, v33, v34
    v_accvgpr_write_b32 a70, v33
    v_accvgpr_read_b32 v33, a71
    v_mul_f32 v33, v33, v34
    v_accvgpr_write_b32 a71, v33
    v_accvgpr_read_b32 v33, a72
    v_mul_f32 v33, v33, v34
    v_accvgpr_write_b32 a72, v33
    v_accvgpr_read_b32 v33, a73
    v_mul_f32 v33, v33, v34
    v_accvgpr_write_b32 a73, v33
    v_accvgpr_read_b32 v33, a74
    v_mul_f32 v33, v33, v34
    v_accvgpr_write_b32 a74, v33
    v_accvgpr_read_b32 v33, a75
    v_mul_f32 v33, v33, v34
    v_accvgpr_write_b32 a75, v33
    v_accvgpr_read_b32 v33, a76
    v_mul_f32 v33, v33, v34
    v_accvgpr_write_b32 a76, v33
    v_accvgpr_read_b32 v33, a77
    v_mul_f32 v33, v33, v34
    v_accvgpr_write_b32 a77, v33
    v_accvgpr_read_b32 v33, a78
    v_mul_f32 v33, v33, v34
    v_accvgpr_write_b32 a78, v33
    v_accvgpr_read_b32 v33, a79
    v_mul_f32 v33, v33, v34
    v_accvgpr_write_b32 a79, v33
    v_accvgpr_read_b32 v33, a80
    v_mul_f32 v33, v33, v34
    v_accvgpr_write_b32 a80, v33
    v_accvgpr_read_b32 v33, a81
    v_mul_f32 v33, v33, v34
    v_accvgpr_write_b32 a81, v33
    v_accvgpr_read_b32 v33, a82
    v_mul_f32 v33, v33, v34
    v_accvgpr_write_b32 a82, v33
    v_accvgpr_read_b32 v33, a83
    v_mul_f32 v33, v33, v34
    v_accvgpr_write_b32 a83, v33
    v_accvgpr_read_b32 v33, a84
    v_mul_f32 v33, v33, v34
    v_accvgpr_write_b32 a84, v33
    v_accvgpr_read_b32 v33, a85
    v_mul_f32 v33, v33, v34
    v_accvgpr_write_b32 a85, v33
    v_accvgpr_read_b32 v33, a86
    v_mul_f32 v33, v33, v34
    v_accvgpr_write_b32 a86, v33
    v_accvgpr_read_b32 v33, a87
    v_mul_f32 v33, v33, v34
    v_accvgpr_write_b32 a87, v33
    v_accvgpr_read_b32 v33, a88
    v_mul_f32 v33, v33, v34
    v_accvgpr_write_b32 a88, v33
    v_accvgpr_read_b32 v33, a89
    v_mul_f32 v33, v33, v34
    v_accvgpr_write_b32 a89, v33
    v_accvgpr_read_b32 v33, a90
    v_mul_f32 v33, v33, v34
    v_accvgpr_write_b32 a90, v33
    v_accvgpr_read_b32 v33, a91
    v_mul_f32 v33, v33, v34
    v_accvgpr_write_b32 a91, v33
    v_accvgpr_read_b32 v33, a92
    v_mul_f32 v33, v33, v34
    v_accvgpr_write_b32 a92, v33
    v_accvgpr_read_b32 v33, a93
    v_mul_f32 v33, v33, v34
    v_accvgpr_write_b32 a93, v33
    v_accvgpr_read_b32 v33, a94
    v_mul_f32 v33, v33, v34
    v_accvgpr_write_b32 a94, v33
    v_accvgpr_read_b32 v33, a95
    v_mul_f32 v33, v33, v34
    v_accvgpr_write_b32 a95, v33
    v_exp_f32 v36, v160
    v_exp_f32 v37, v161
    s_nop 0
    v_cvt_pk_bf16_f32 v216, v36, v37
    v_exp_f32 v36, v162
    v_exp_f32 v37, v163
    s_nop 0
    v_cvt_pk_bf16_f32 v217, v36, v37
    v_exp_f32 v36, v164
    v_exp_f32 v37, v165
    s_nop 0
    v_cvt_pk_bf16_f32 v218, v36, v37
    v_exp_f32 v36, v166
    v_exp_f32 v37, v167
    s_nop 0
    v_cvt_pk_bf16_f32 v219, v36, v37
    v_max3_f32 v32, v168, v169, v170
    v_max3_f32 v32, v171, v172, v32
    v_max3_f32 v32, v173, v174, v32
    v_max_f32 v32, v175, v32
    v_mov_b32 v33, v32
    s_nop 1
    v_permlane16_swap_b32 v32, v33
    s_nop 1
    v_max_f32 v32, v32, v33
    v_mov_b32 v33, v32
    s_nop 1
    v_permlane32_swap_b32 v32, v33
    s_nop 1
    v_max_f32 v32, v32, v33
    v_add_f32 v32, 0x41c00000, v32
    v_max_f32 v32, 0, v32
    v_exp_f32 v34, -v32
    v_sub_f32 v76, v76, v32
    v_sub_f32 v77, v77, v32
    v_sub_f32 v78, v78, v32
    v_sub_f32 v79, v79, v32
    v_sub_f32 v168, v168, v32
    v_sub_f32 v169, v169, v32
    v_sub_f32 v170, v170, v32
    v_sub_f32 v171, v171, v32
    v_sub_f32 v172, v172, v32
    v_sub_f32 v173, v173, v32
    v_sub_f32 v174, v174, v32
    v_sub_f32 v175, v175, v32
    v_sub_f32 v200, v200, v32
    v_sub_f32 v201, v201, v32
    v_sub_f32 v202, v202, v32
    v_sub_f32 v203, v203, v32
    v_sub_f32 v204, v204, v32
    v_sub_f32 v205, v205, v32
    v_sub_f32 v206, v206, v32
    v_sub_f32 v207, v207, v32
    v_mul_f32 v252, v252, v34
    v_mul_f32 v253, v253, v34
    v_mul_f32 v254, v254, v34
    v_mul_f32 v255, v255, v34
    v_accvgpr_read_b32 v33, a96
    v_mul_f32 v33, v33, v34
    v_accvgpr_write_b32 a96, v33
    v_accvgpr_read_b32 v33, a97
    v_mul_f32 v33, v33, v34
    v_accvgpr_write_b32 a97, v33
    v_accvgpr_read_b32 v33, a98
    v_mul_f32 v33, v33, v34
    v_accvgpr_write_b32 a98, v33
    v_accvgpr_read_b32 v33, a99
    v_mul_f32 v33, v33, v34
    v_accvgpr_write_b32 a99, v33
    v_accvgpr_read_b32 v33, a100
    v_mul_f32 v33, v33, v34
    v_accvgpr_write_b32 a100, v33
    v_accvgpr_read_b32 v33, a101
    v_mul_f32 v33, v33, v34
    v_accvgpr_write_b32 a101, v33
    v_accvgpr_read_b32 v33, a102
    v_mul_f32 v33, v33, v34
    v_accvgpr_write_b32 a102, v33
    v_accvgpr_read_b32 v33, a103
    v_mul_f32 v33, v33, v34
    v_accvgpr_write_b32 a103, v33
    v_accvgpr_read_b32 v33, a104
    v_mul_f32 v33, v33, v34
    v_accvgpr_write_b32 a104, v33
    v_accvgpr_read_b32 v33, a105
    v_mul_f32 v33, v33, v34
    v_accvgpr_write_b32 a105, v33
    v_accvgpr_read_b32 v33, a106
    v_mul_f32 v33, v33, v34
    v_accvgpr_write_b32 a106, v33
    v_accvgpr_read_b32 v33, a107
    v_mul_f32 v33, v33, v34
    v_accvgpr_write_b32 a107, v33
    v_accvgpr_read_b32 v33, a108
    v_mul_f32 v33, v33, v34
    v_accvgpr_write_b32 a108, v33
    v_accvgpr_read_b32 v33, a109
    v_mul_f32 v33, v33, v34
    v_accvgpr_write_b32 a109, v33
    v_accvgpr_read_b32 v33, a110
    v_mul_f32 v33, v33, v34
    v_accvgpr_write_b32 a110, v33
    v_accvgpr_read_b32 v33, a111
    v_mul_f32 v33, v33, v34
    v_accvgpr_write_b32 a111, v33
    v_accvgpr_read_b32 v33, a112
    v_mul_f32 v33, v33, v34
    v_accvgpr_write_b32 a112, v33
    v_accvgpr_read_b32 v33, a113
    v_mul_f32 v33, v33, v34
    v_accvgpr_write_b32 a113, v33
    v_accvgpr_read_b32 v33, a114
    v_mul_f32 v33, v33, v34
    v_accvgpr_write_b32 a114, v33
    v_accvgpr_read_b32 v33, a115
    v_mul_f32 v33, v33, v34
    v_accvgpr_write_b32 a115, v33
    v_accvgpr_read_b32 v33, a116
    v_mul_f32 v33, v33, v34
    v_accvgpr_write_b32 a116, v33
    v_accvgpr_read_b32 v33, a117
    v_mul_f32 v33, v33, v34
    v_accvgpr_write_b32 a117, v33
    v_accvgpr_read_b32 v33, a118
    v_mul_f32 v33, v33, v34
    v_accvgpr_write_b32 a118, v33
    v_accvgpr_read_b32 v33, a119
    v_mul_f32 v33, v33, v34
    v_accvgpr_write_b32 a119, v33
    v_accvgpr_read_b32 v33, a120
    v_mul_f32 v33, v33, v34
    v_accvgpr_write_b32 a120, v33
    v_accvgpr_read_b32 v33, a121
    v_mul_f32 v33, v33, v34
    v_accvgpr_write_b32 a121, v33
    v_accvgpr_read_b32 v33, a122
    v_mul_f32 v33, v33, v34
    v_accvgpr_write_b32 a122, v33
    v_accvgpr_read_b32 v33, a123
    v_mul_f32 v33, v33, v34
    v_accvgpr_write_b32 a123, v33
    v_accvgpr_read_b32 v33, a124
    v_mul_f32 v33, v33, v34
    v_accvgpr_write_b32 a124, v33
    v_accvgpr_read_b32 v33, a125
    v_mul_f32 v33, v33, v34
    v_accvgpr_write_b32 a125, v33
    v_accvgpr_read_b32 v33, a126
    v_mul_f32 v33, v33, v34
    v_accvgpr_write_b32 a126, v33
    v_accvgpr_read_b32 v33, a127
    v_mul_f32 v33, v33, v34
    v_accvgpr_write_b32 a127, v33
    v_exp_f32 v36, v168
    v_exp_f32 v37, v169
    s_nop 0
    v_cvt_pk_bf16_f32 v220, v36, v37
    v_exp_f32 v36, v170
    v_exp_f32 v37, v171
    s_nop 0
    v_cvt_pk_bf16_f32 v221, v36, v37
    v_exp_f32 v36, v172
    v_exp_f32 v37, v173
    s_nop 0
    v_cvt_pk_bf16_f32 v222, v36, v37
    v_exp_f32 v36, v174
    v_exp_f32 v37, v175
    s_nop 0
    v_cvt_pk_bf16_f32 v223, v36, v37
    s_nop 1
    s_branch gated_mix__ssm_conv_h3__compressed_kv_cla__prompt_kernel_b4_r0_ret
gated_mix__ssm_conv_h3__compressed_kv_cla__prompt_kernel_b4_r1:
    s_nop 7
    v_max3_f32 v32, v176, v177, v178
    v_max3_f32 v32, v179, v180, v32
    v_max3_f32 v32, v181, v182, v32
    v_max_f32 v32, v183, v32
    v_mov_b32 v33, v32
    s_nop 1
    v_permlane16_swap_b32 v32, v33
    s_nop 1
    v_max_f32 v32, v32, v33
    v_mov_b32 v33, v32
    s_nop 1
    v_permlane32_swap_b32 v32, v33
    s_nop 1
    v_max_f32 v32, v32, v33
    v_add_f32 v32, 0x41c00000, v32
    v_max_f32 v32, 0, v32
    v_exp_f32 v34, -v32
    v_sub_f32 v64, v64, v32
    v_sub_f32 v65, v65, v32
    v_sub_f32 v66, v66, v32
    v_sub_f32 v67, v67, v32
    v_sub_f32 v176, v176, v32
    v_sub_f32 v177, v177, v32
    v_sub_f32 v178, v178, v32
    v_sub_f32 v179, v179, v32
    v_sub_f32 v180, v180, v32
    v_sub_f32 v181, v181, v32
    v_sub_f32 v182, v182, v32
    v_sub_f32 v183, v183, v32
    v_sub_f32 v144, v144, v32
    v_sub_f32 v145, v145, v32
    v_sub_f32 v146, v146, v32
    v_sub_f32 v147, v147, v32
    v_sub_f32 v148, v148, v32
    v_sub_f32 v149, v149, v32
    v_sub_f32 v150, v150, v32
    v_sub_f32 v151, v151, v32
    v_mul_f32 v240, v240, v34
    v_mul_f32 v241, v241, v34
    v_mul_f32 v242, v242, v34
    v_mul_f32 v243, v243, v34
    v_accvgpr_read_b32 v33, a0
    v_mul_f32 v33, v33, v34
    v_accvgpr_write_b32 a0, v33
    v_accvgpr_read_b32 v33, a1
    v_mul_f32 v33, v33, v34
    v_accvgpr_write_b32 a1, v33
    v_accvgpr_read_b32 v33, a2
    v_mul_f32 v33, v33, v34
    v_accvgpr_write_b32 a2, v33
    v_accvgpr_read_b32 v33, a3
    v_mul_f32 v33, v33, v34
    v_accvgpr_write_b32 a3, v33
    v_accvgpr_read_b32 v33, a4
    v_mul_f32 v33, v33, v34
    v_accvgpr_write_b32 a4, v33
    v_accvgpr_read_b32 v33, a5
    v_mul_f32 v33, v33, v34
    v_accvgpr_write_b32 a5, v33
    v_accvgpr_read_b32 v33, a6
    v_mul_f32 v33, v33, v34
    v_accvgpr_write_b32 a6, v33
    v_accvgpr_read_b32 v33, a7
    v_mul_f32 v33, v33, v34
    v_accvgpr_write_b32 a7, v33
    v_accvgpr_read_b32 v33, a8
    v_mul_f32 v33, v33, v34
    v_accvgpr_write_b32 a8, v33
    v_accvgpr_read_b32 v33, a9
    v_mul_f32 v33, v33, v34
    v_accvgpr_write_b32 a9, v33
    v_accvgpr_read_b32 v33, a10
    v_mul_f32 v33, v33, v34
    v_accvgpr_write_b32 a10, v33
    v_accvgpr_read_b32 v33, a11
    v_mul_f32 v33, v33, v34
    v_accvgpr_write_b32 a11, v33
    v_accvgpr_read_b32 v33, a12
    v_mul_f32 v33, v33, v34
    v_accvgpr_write_b32 a12, v33
    v_accvgpr_read_b32 v33, a13
    v_mul_f32 v33, v33, v34
    v_accvgpr_write_b32 a13, v33
    v_accvgpr_read_b32 v33, a14
    v_mul_f32 v33, v33, v34
    v_accvgpr_write_b32 a14, v33
    v_accvgpr_read_b32 v33, a15
    v_mul_f32 v33, v33, v34
    v_accvgpr_write_b32 a15, v33
    v_accvgpr_read_b32 v33, a16
    v_mul_f32 v33, v33, v34
    v_accvgpr_write_b32 a16, v33
    v_accvgpr_read_b32 v33, a17
    v_mul_f32 v33, v33, v34
    v_accvgpr_write_b32 a17, v33
    v_accvgpr_read_b32 v33, a18
    v_mul_f32 v33, v33, v34
    v_accvgpr_write_b32 a18, v33
    v_accvgpr_read_b32 v33, a19
    v_mul_f32 v33, v33, v34
    v_accvgpr_write_b32 a19, v33
    v_accvgpr_read_b32 v33, a20
    v_mul_f32 v33, v33, v34
    v_accvgpr_write_b32 a20, v33
    v_accvgpr_read_b32 v33, a21
    v_mul_f32 v33, v33, v34
    v_accvgpr_write_b32 a21, v33
    v_accvgpr_read_b32 v33, a22
    v_mul_f32 v33, v33, v34
    v_accvgpr_write_b32 a22, v33
    v_accvgpr_read_b32 v33, a23
    v_mul_f32 v33, v33, v34
    v_accvgpr_write_b32 a23, v33
    v_accvgpr_read_b32 v33, a24
    v_mul_f32 v33, v33, v34
    v_accvgpr_write_b32 a24, v33
    v_accvgpr_read_b32 v33, a25
    v_mul_f32 v33, v33, v34
    v_accvgpr_write_b32 a25, v33
    v_accvgpr_read_b32 v33, a26
    v_mul_f32 v33, v33, v34
    v_accvgpr_write_b32 a26, v33
    v_accvgpr_read_b32 v33, a27
    v_mul_f32 v33, v33, v34
    v_accvgpr_write_b32 a27, v33
    v_accvgpr_read_b32 v33, a28
    v_mul_f32 v33, v33, v34
    v_accvgpr_write_b32 a28, v33
    v_accvgpr_read_b32 v33, a29
    v_mul_f32 v33, v33, v34
    v_accvgpr_write_b32 a29, v33
    v_accvgpr_read_b32 v33, a30
    v_mul_f32 v33, v33, v34
    v_accvgpr_write_b32 a30, v33
    v_accvgpr_read_b32 v33, a31
    v_mul_f32 v33, v33, v34
    v_accvgpr_write_b32 a31, v33
    v_exp_f32 v36, v176
    v_exp_f32 v37, v177
    s_nop 0
    v_cvt_pk_bf16_f32 v224, v36, v37
    v_exp_f32 v36, v178
    v_exp_f32 v37, v179
    s_nop 0
    v_cvt_pk_bf16_f32 v225, v36, v37
    v_exp_f32 v36, v180
    v_exp_f32 v37, v181
    s_nop 0
    v_cvt_pk_bf16_f32 v226, v36, v37
    v_exp_f32 v36, v182
    v_exp_f32 v37, v183
    s_nop 0
    v_cvt_pk_bf16_f32 v227, v36, v37
    v_max3_f32 v32, v184, v185, v186
    v_max3_f32 v32, v187, v188, v32
    v_max3_f32 v32, v189, v190, v32
    v_max_f32 v32, v191, v32
    v_mov_b32 v33, v32
    s_nop 1
    v_permlane16_swap_b32 v32, v33
    s_nop 1
    v_max_f32 v32, v32, v33
    v_mov_b32 v33, v32
    s_nop 1
    v_permlane32_swap_b32 v32, v33
    s_nop 1
    v_max_f32 v32, v32, v33
    v_add_f32 v32, 0x41c00000, v32
    v_max_f32 v32, 0, v32
    v_exp_f32 v34, -v32
    v_sub_f32 v68, v68, v32
    v_sub_f32 v69, v69, v32
    v_sub_f32 v70, v70, v32
    v_sub_f32 v71, v71, v32
    v_sub_f32 v184, v184, v32
    v_sub_f32 v185, v185, v32
    v_sub_f32 v186, v186, v32
    v_sub_f32 v187, v187, v32
    v_sub_f32 v188, v188, v32
    v_sub_f32 v189, v189, v32
    v_sub_f32 v190, v190, v32
    v_sub_f32 v191, v191, v32
    v_sub_f32 v152, v152, v32
    v_sub_f32 v153, v153, v32
    v_sub_f32 v154, v154, v32
    v_sub_f32 v155, v155, v32
    v_sub_f32 v156, v156, v32
    v_sub_f32 v157, v157, v32
    v_sub_f32 v158, v158, v32
    v_sub_f32 v159, v159, v32
    v_mul_f32 v244, v244, v34
    v_mul_f32 v245, v245, v34
    v_mul_f32 v246, v246, v34
    v_mul_f32 v247, v247, v34
    v_accvgpr_read_b32 v33, a32
    v_mul_f32 v33, v33, v34
    v_accvgpr_write_b32 a32, v33
    v_accvgpr_read_b32 v33, a33
    v_mul_f32 v33, v33, v34
    v_accvgpr_write_b32 a33, v33
    v_accvgpr_read_b32 v33, a34
    v_mul_f32 v33, v33, v34
    v_accvgpr_write_b32 a34, v33
    v_accvgpr_read_b32 v33, a35
    v_mul_f32 v33, v33, v34
    v_accvgpr_write_b32 a35, v33
    v_accvgpr_read_b32 v33, a36
    v_mul_f32 v33, v33, v34
    v_accvgpr_write_b32 a36, v33
    v_accvgpr_read_b32 v33, a37
    v_mul_f32 v33, v33, v34
    v_accvgpr_write_b32 a37, v33
    v_accvgpr_read_b32 v33, a38
    v_mul_f32 v33, v33, v34
    v_accvgpr_write_b32 a38, v33
    v_accvgpr_read_b32 v33, a39
    v_mul_f32 v33, v33, v34
    v_accvgpr_write_b32 a39, v33
    v_accvgpr_read_b32 v33, a40
    v_mul_f32 v33, v33, v34
    v_accvgpr_write_b32 a40, v33
    v_accvgpr_read_b32 v33, a41
    v_mul_f32 v33, v33, v34
    v_accvgpr_write_b32 a41, v33
    v_accvgpr_read_b32 v33, a42
    v_mul_f32 v33, v33, v34
    v_accvgpr_write_b32 a42, v33
    v_accvgpr_read_b32 v33, a43
    v_mul_f32 v33, v33, v34
    v_accvgpr_write_b32 a43, v33
    v_accvgpr_read_b32 v33, a44
    v_mul_f32 v33, v33, v34
    v_accvgpr_write_b32 a44, v33
    v_accvgpr_read_b32 v33, a45
    v_mul_f32 v33, v33, v34
    v_accvgpr_write_b32 a45, v33
    v_accvgpr_read_b32 v33, a46
    v_mul_f32 v33, v33, v34
    v_accvgpr_write_b32 a46, v33
    v_accvgpr_read_b32 v33, a47
    v_mul_f32 v33, v33, v34
    v_accvgpr_write_b32 a47, v33
    v_accvgpr_read_b32 v33, a48
    v_mul_f32 v33, v33, v34
    v_accvgpr_write_b32 a48, v33
    v_accvgpr_read_b32 v33, a49
    v_mul_f32 v33, v33, v34
    v_accvgpr_write_b32 a49, v33
    v_accvgpr_read_b32 v33, a50
    v_mul_f32 v33, v33, v34
    v_accvgpr_write_b32 a50, v33
    v_accvgpr_read_b32 v33, a51
    v_mul_f32 v33, v33, v34
    v_accvgpr_write_b32 a51, v33
    v_accvgpr_read_b32 v33, a52
    v_mul_f32 v33, v33, v34
    v_accvgpr_write_b32 a52, v33
    v_accvgpr_read_b32 v33, a53
    v_mul_f32 v33, v33, v34
    v_accvgpr_write_b32 a53, v33
    v_accvgpr_read_b32 v33, a54
    v_mul_f32 v33, v33, v34
    v_accvgpr_write_b32 a54, v33
    v_accvgpr_read_b32 v33, a55
    v_mul_f32 v33, v33, v34
    v_accvgpr_write_b32 a55, v33
    v_accvgpr_read_b32 v33, a56
    v_mul_f32 v33, v33, v34
    v_accvgpr_write_b32 a56, v33
    v_accvgpr_read_b32 v33, a57
    v_mul_f32 v33, v33, v34
    v_accvgpr_write_b32 a57, v33
    v_accvgpr_read_b32 v33, a58
    v_mul_f32 v33, v33, v34
    v_accvgpr_write_b32 a58, v33
    v_accvgpr_read_b32 v33, a59
    v_mul_f32 v33, v33, v34
    v_accvgpr_write_b32 a59, v33
    v_accvgpr_read_b32 v33, a60
    v_mul_f32 v33, v33, v34
    v_accvgpr_write_b32 a60, v33
    v_accvgpr_read_b32 v33, a61
    v_mul_f32 v33, v33, v34
    v_accvgpr_write_b32 a61, v33
    v_accvgpr_read_b32 v33, a62
    v_mul_f32 v33, v33, v34
    v_accvgpr_write_b32 a62, v33
    v_accvgpr_read_b32 v33, a63
    v_mul_f32 v33, v33, v34
    v_accvgpr_write_b32 a63, v33
    v_exp_f32 v36, v184
    v_exp_f32 v37, v185
    s_nop 0
    v_cvt_pk_bf16_f32 v228, v36, v37
    v_exp_f32 v36, v186
    v_exp_f32 v37, v187
    s_nop 0
    v_cvt_pk_bf16_f32 v229, v36, v37
    v_exp_f32 v36, v188
    v_exp_f32 v37, v189
    s_nop 0
    v_cvt_pk_bf16_f32 v230, v36, v37
    v_exp_f32 v36, v190
    v_exp_f32 v37, v191
    s_nop 0
    v_cvt_pk_bf16_f32 v231, v36, v37
    v_max3_f32 v32, v192, v193, v194
    v_max3_f32 v32, v195, v196, v32
    v_max3_f32 v32, v197, v198, v32
    v_max_f32 v32, v199, v32
    v_mov_b32 v33, v32
    s_nop 1
    v_permlane16_swap_b32 v32, v33
    s_nop 1
    v_max_f32 v32, v32, v33
    v_mov_b32 v33, v32
    s_nop 1
    v_permlane32_swap_b32 v32, v33
    s_nop 1
    v_max_f32 v32, v32, v33
    v_add_f32 v32, 0x41c00000, v32
    v_max_f32 v32, 0, v32
    v_exp_f32 v34, -v32
    v_sub_f32 v72, v72, v32
    v_sub_f32 v73, v73, v32
    v_sub_f32 v74, v74, v32
    v_sub_f32 v75, v75, v32
    v_sub_f32 v192, v192, v32
    v_sub_f32 v193, v193, v32
    v_sub_f32 v194, v194, v32
    v_sub_f32 v195, v195, v32
    v_sub_f32 v196, v196, v32
    v_sub_f32 v197, v197, v32
    v_sub_f32 v198, v198, v32
    v_sub_f32 v199, v199, v32
    v_sub_f32 v160, v160, v32
    v_sub_f32 v161, v161, v32
    v_sub_f32 v162, v162, v32
    v_sub_f32 v163, v163, v32
    v_sub_f32 v164, v164, v32
    v_sub_f32 v165, v165, v32
    v_sub_f32 v166, v166, v32
    v_sub_f32 v167, v167, v32
    v_mul_f32 v248, v248, v34
    v_mul_f32 v249, v249, v34
    v_mul_f32 v250, v250, v34
    v_mul_f32 v251, v251, v34
    v_accvgpr_read_b32 v33, a64
    v_mul_f32 v33, v33, v34
    v_accvgpr_write_b32 a64, v33
    v_accvgpr_read_b32 v33, a65
    v_mul_f32 v33, v33, v34
    v_accvgpr_write_b32 a65, v33
    v_accvgpr_read_b32 v33, a66
    v_mul_f32 v33, v33, v34
    v_accvgpr_write_b32 a66, v33
    v_accvgpr_read_b32 v33, a67
    v_mul_f32 v33, v33, v34
    v_accvgpr_write_b32 a67, v33
    v_accvgpr_read_b32 v33, a68
    v_mul_f32 v33, v33, v34
    v_accvgpr_write_b32 a68, v33
    v_accvgpr_read_b32 v33, a69
    v_mul_f32 v33, v33, v34
    v_accvgpr_write_b32 a69, v33
    v_accvgpr_read_b32 v33, a70
    v_mul_f32 v33, v33, v34
    v_accvgpr_write_b32 a70, v33
    v_accvgpr_read_b32 v33, a71
    v_mul_f32 v33, v33, v34
    v_accvgpr_write_b32 a71, v33
    v_accvgpr_read_b32 v33, a72
    v_mul_f32 v33, v33, v34
    v_accvgpr_write_b32 a72, v33
    v_accvgpr_read_b32 v33, a73
    v_mul_f32 v33, v33, v34
    v_accvgpr_write_b32 a73, v33
    v_accvgpr_read_b32 v33, a74
    v_mul_f32 v33, v33, v34
    v_accvgpr_write_b32 a74, v33
    v_accvgpr_read_b32 v33, a75
    v_mul_f32 v33, v33, v34
    v_accvgpr_write_b32 a75, v33
    v_accvgpr_read_b32 v33, a76
    v_mul_f32 v33, v33, v34
    v_accvgpr_write_b32 a76, v33
    v_accvgpr_read_b32 v33, a77
    v_mul_f32 v33, v33, v34
    v_accvgpr_write_b32 a77, v33
    v_accvgpr_read_b32 v33, a78
    v_mul_f32 v33, v33, v34
    v_accvgpr_write_b32 a78, v33
    v_accvgpr_read_b32 v33, a79
    v_mul_f32 v33, v33, v34
    v_accvgpr_write_b32 a79, v33
    v_accvgpr_read_b32 v33, a80
    v_mul_f32 v33, v33, v34
    v_accvgpr_write_b32 a80, v33
    v_accvgpr_read_b32 v33, a81
    v_mul_f32 v33, v33, v34
    v_accvgpr_write_b32 a81, v33
    v_accvgpr_read_b32 v33, a82
    v_mul_f32 v33, v33, v34
    v_accvgpr_write_b32 a82, v33
    v_accvgpr_read_b32 v33, a83
    v_mul_f32 v33, v33, v34
    v_accvgpr_write_b32 a83, v33
    v_accvgpr_read_b32 v33, a84
    v_mul_f32 v33, v33, v34
    v_accvgpr_write_b32 a84, v33
    v_accvgpr_read_b32 v33, a85
    v_mul_f32 v33, v33, v34
    v_accvgpr_write_b32 a85, v33
    v_accvgpr_read_b32 v33, a86
    v_mul_f32 v33, v33, v34
    v_accvgpr_write_b32 a86, v33
    v_accvgpr_read_b32 v33, a87
    v_mul_f32 v33, v33, v34
    v_accvgpr_write_b32 a87, v33
    v_accvgpr_read_b32 v33, a88
    v_mul_f32 v33, v33, v34
    v_accvgpr_write_b32 a88, v33
    v_accvgpr_read_b32 v33, a89
    v_mul_f32 v33, v33, v34
    v_accvgpr_write_b32 a89, v33
    v_accvgpr_read_b32 v33, a90
    v_mul_f32 v33, v33, v34
    v_accvgpr_write_b32 a90, v33
    v_accvgpr_read_b32 v33, a91
    v_mul_f32 v33, v33, v34
    v_accvgpr_write_b32 a91, v33
    v_accvgpr_read_b32 v33, a92
    v_mul_f32 v33, v33, v34
    v_accvgpr_write_b32 a92, v33
    v_accvgpr_read_b32 v33, a93
    v_mul_f32 v33, v33, v34
    v_accvgpr_write_b32 a93, v33
    v_accvgpr_read_b32 v33, a94
    v_mul_f32 v33, v33, v34
    v_accvgpr_write_b32 a94, v33
    v_accvgpr_read_b32 v33, a95
    v_mul_f32 v33, v33, v34
    v_accvgpr_write_b32 a95, v33
    v_exp_f32 v36, v192
    v_exp_f32 v37, v193
    s_nop 0
    v_cvt_pk_bf16_f32 v232, v36, v37
    v_exp_f32 v36, v194
    v_exp_f32 v37, v195
    s_nop 0
    v_cvt_pk_bf16_f32 v233, v36, v37
    v_exp_f32 v36, v196
    v_exp_f32 v37, v197
    s_nop 0
    v_cvt_pk_bf16_f32 v234, v36, v37
    v_exp_f32 v36, v198
    v_exp_f32 v37, v199
    s_nop 0
    v_cvt_pk_bf16_f32 v235, v36, v37
    v_max3_f32 v32, v200, v201, v202
    v_max3_f32 v32, v203, v204, v32
    v_max3_f32 v32, v205, v206, v32
    v_max_f32 v32, v207, v32
    v_mov_b32 v33, v32
    s_nop 1
    v_permlane16_swap_b32 v32, v33
    s_nop 1
    v_max_f32 v32, v32, v33
    v_mov_b32 v33, v32
    s_nop 1
    v_permlane32_swap_b32 v32, v33
    s_nop 1
    v_max_f32 v32, v32, v33
    v_add_f32 v32, 0x41c00000, v32
    v_max_f32 v32, 0, v32
    v_exp_f32 v34, -v32
    v_sub_f32 v76, v76, v32
    v_sub_f32 v77, v77, v32
    v_sub_f32 v78, v78, v32
    v_sub_f32 v79, v79, v32
    v_sub_f32 v200, v200, v32
    v_sub_f32 v201, v201, v32
    v_sub_f32 v202, v202, v32
    v_sub_f32 v203, v203, v32
    v_sub_f32 v204, v204, v32
    v_sub_f32 v205, v205, v32
    v_sub_f32 v206, v206, v32
    v_sub_f32 v207, v207, v32
    v_sub_f32 v168, v168, v32
    v_sub_f32 v169, v169, v32
    v_sub_f32 v170, v170, v32
    v_sub_f32 v171, v171, v32
    v_sub_f32 v172, v172, v32
    v_sub_f32 v173, v173, v32
    v_sub_f32 v174, v174, v32
    v_sub_f32 v175, v175, v32
    v_mul_f32 v252, v252, v34
    v_mul_f32 v253, v253, v34
    v_mul_f32 v254, v254, v34
    v_mul_f32 v255, v255, v34
    v_accvgpr_read_b32 v33, a96
    v_mul_f32 v33, v33, v34
    v_accvgpr_write_b32 a96, v33
    v_accvgpr_read_b32 v33, a97
    v_mul_f32 v33, v33, v34
    v_accvgpr_write_b32 a97, v33
    v_accvgpr_read_b32 v33, a98
    v_mul_f32 v33, v33, v34
    v_accvgpr_write_b32 a98, v33
    v_accvgpr_read_b32 v33, a99
    v_mul_f32 v33, v33, v34
    v_accvgpr_write_b32 a99, v33
    v_accvgpr_read_b32 v33, a100
    v_mul_f32 v33, v33, v34
    v_accvgpr_write_b32 a100, v33
    v_accvgpr_read_b32 v33, a101
    v_mul_f32 v33, v33, v34
    v_accvgpr_write_b32 a101, v33
    v_accvgpr_read_b32 v33, a102
    v_mul_f32 v33, v33, v34
    v_accvgpr_write_b32 a102, v33
    v_accvgpr_read_b32 v33, a103
    v_mul_f32 v33, v33, v34
    v_accvgpr_write_b32 a103, v33
    v_accvgpr_read_b32 v33, a104
    v_mul_f32 v33, v33, v34
    v_accvgpr_write_b32 a104, v33
    v_accvgpr_read_b32 v33, a105
    v_mul_f32 v33, v33, v34
    v_accvgpr_write_b32 a105, v33
    v_accvgpr_read_b32 v33, a106
    v_mul_f32 v33, v33, v34
    v_accvgpr_write_b32 a106, v33
    v_accvgpr_read_b32 v33, a107
    v_mul_f32 v33, v33, v34
    v_accvgpr_write_b32 a107, v33
    v_accvgpr_read_b32 v33, a108
    v_mul_f32 v33, v33, v34
    v_accvgpr_write_b32 a108, v33
    v_accvgpr_read_b32 v33, a109
    v_mul_f32 v33, v33, v34
    v_accvgpr_write_b32 a109, v33
    v_accvgpr_read_b32 v33, a110
    v_mul_f32 v33, v33, v34
    v_accvgpr_write_b32 a110, v33
    v_accvgpr_read_b32 v33, a111
    v_mul_f32 v33, v33, v34
    v_accvgpr_write_b32 a111, v33
    v_accvgpr_read_b32 v33, a112
    v_mul_f32 v33, v33, v34
    v_accvgpr_write_b32 a112, v33
    v_accvgpr_read_b32 v33, a113
    v_mul_f32 v33, v33, v34
    v_accvgpr_write_b32 a113, v33
    v_accvgpr_read_b32 v33, a114
    v_mul_f32 v33, v33, v34
    v_accvgpr_write_b32 a114, v33
    v_accvgpr_read_b32 v33, a115
    v_mul_f32 v33, v33, v34
    v_accvgpr_write_b32 a115, v33
    v_accvgpr_read_b32 v33, a116
    v_mul_f32 v33, v33, v34
    v_accvgpr_write_b32 a116, v33
    v_accvgpr_read_b32 v33, a117
    v_mul_f32 v33, v33, v34
    v_accvgpr_write_b32 a117, v33
    v_accvgpr_read_b32 v33, a118
    v_mul_f32 v33, v33, v34
    v_accvgpr_write_b32 a118, v33
    v_accvgpr_read_b32 v33, a119
    v_mul_f32 v33, v33, v34
    v_accvgpr_write_b32 a119, v33
    v_accvgpr_read_b32 v33, a120
    v_mul_f32 v33, v33, v34
    v_accvgpr_write_b32 a120, v33
    v_accvgpr_read_b32 v33, a121
    v_mul_f32 v33, v33, v34
    v_accvgpr_write_b32 a121, v33
    v_accvgpr_read_b32 v33, a122
    v_mul_f32 v33, v33, v34
    v_accvgpr_write_b32 a122, v33
    v_accvgpr_read_b32 v33, a123
    v_mul_f32 v33, v33, v34
    v_accvgpr_write_b32 a123, v33
    v_accvgpr_read_b32 v33, a124
    v_mul_f32 v33, v33, v34
    v_accvgpr_write_b32 a124, v33
    v_accvgpr_read_b32 v33, a125
    v_mul_f32 v33, v33, v34
    v_accvgpr_write_b32 a125, v33
    v_accvgpr_read_b32 v33, a126
    v_mul_f32 v33, v33, v34
    v_accvgpr_write_b32 a126, v33
    v_accvgpr_read_b32 v33, a127
    v_mul_f32 v33, v33, v34
    v_accvgpr_write_b32 a127, v33
    v_exp_f32 v36, v200
    v_exp_f32 v37, v201
    s_nop 0
    v_cvt_pk_bf16_f32 v236, v36, v37
    v_exp_f32 v36, v202
    v_exp_f32 v37, v203
    s_nop 0
    v_cvt_pk_bf16_f32 v237, v36, v37
    v_exp_f32 v36, v204
    v_exp_f32 v37, v205
    s_nop 0
    v_cvt_pk_bf16_f32 v238, v36, v37
    v_exp_f32 v36, v206
    v_exp_f32 v37, v207
    s_nop 0
    v_cvt_pk_bf16_f32 v239, v36, v37
    s_nop 1
    s_branch gated_mix__ssm_conv_h3__compressed_kv_cla__prompt_kernel_b4_r1_ret
gated_mix__ssm_conv_h3__compressed_kv_cla__prompt_kernel_b3_r0:
    s_nop 7
    v_max3_f32 v32, v152, v153, v154
    v_max3_f32 v32, v155, v156, v32
    v_max3_f32 v32, v157, v158, v32
    v_max_f32 v32, v159, v32
    v_mov_b32 v33, v32
    s_nop 1
    v_permlane16_swap_b32 v32, v33
    s_nop 1
    v_max_f32 v32, v32, v33
    v_mov_b32 v33, v32
    s_nop 1
    v_permlane32_swap_b32 v32, v33
    s_nop 1
    v_max_f32 v32, v32, v33
    v_add_f32 v32, 0x41c00000, v32
    v_max_f32 v32, 0, v32
    v_exp_f32 v34, -v32
    v_sub_f32 v68, v68, v32
    v_sub_f32 v69, v69, v32
    v_sub_f32 v70, v70, v32
    v_sub_f32 v71, v71, v32
    v_sub_f32 v152, v152, v32
    v_sub_f32 v153, v153, v32
    v_sub_f32 v154, v154, v32
    v_sub_f32 v155, v155, v32
    v_sub_f32 v156, v156, v32
    v_sub_f32 v157, v157, v32
    v_sub_f32 v158, v158, v32
    v_sub_f32 v159, v159, v32
    v_sub_f32 v184, v184, v32
    v_sub_f32 v185, v185, v32
    v_sub_f32 v186, v186, v32
    v_sub_f32 v187, v187, v32
    v_sub_f32 v188, v188, v32
    v_sub_f32 v189, v189, v32
    v_sub_f32 v190, v190, v32
    v_sub_f32 v191, v191, v32
    v_mul_f32 v244, v244, v34
    v_mul_f32 v245, v245, v34
    v_mul_f32 v246, v246, v34
    v_mul_f32 v247, v247, v34
    v_accvgpr_read_b32 v33, a32
    v_mul_f32 v33, v33, v34
    v_accvgpr_write_b32 a32, v33
    v_accvgpr_read_b32 v33, a33
    v_mul_f32 v33, v33, v34
    v_accvgpr_write_b32 a33, v33
    v_accvgpr_read_b32 v33, a34
    v_mul_f32 v33, v33, v34
    v_accvgpr_write_b32 a34, v33
    v_accvgpr_read_b32 v33, a35
    v_mul_f32 v33, v33, v34
    v_accvgpr_write_b32 a35, v33
    v_accvgpr_read_b32 v33, a36
    v_mul_f32 v33, v33, v34
    v_accvgpr_write_b32 a36, v33
    v_accvgpr_read_b32 v33, a37
    v_mul_f32 v33, v33, v34
    v_accvgpr_write_b32 a37, v33
    v_accvgpr_read_b32 v33, a38
    v_mul_f32 v33, v33, v34
    v_accvgpr_write_b32 a38, v33
    v_accvgpr_read_b32 v33, a39
    v_mul_f32 v33, v33, v34
    v_accvgpr_write_b32 a39, v33
    v_accvgpr_read_b32 v33, a40
    v_mul_f32 v33, v33, v34
    v_accvgpr_write_b32 a40, v33
    v_accvgpr_read_b32 v33, a41
    v_mul_f32 v33, v33, v34
    v_accvgpr_write_b32 a41, v33
    v_accvgpr_read_b32 v33, a42
    v_mul_f32 v33, v33, v34
    v_accvgpr_write_b32 a42, v33
    v_accvgpr_read_b32 v33, a43
    v_mul_f32 v33, v33, v34
    v_accvgpr_write_b32 a43, v33
    v_accvgpr_read_b32 v33, a44
    v_mul_f32 v33, v33, v34
    v_accvgpr_write_b32 a44, v33
    v_accvgpr_read_b32 v33, a45
    v_mul_f32 v33, v33, v34
    v_accvgpr_write_b32 a45, v33
    v_accvgpr_read_b32 v33, a46
    v_mul_f32 v33, v33, v34
    v_accvgpr_write_b32 a46, v33
    v_accvgpr_read_b32 v33, a47
    v_mul_f32 v33, v33, v34
    v_accvgpr_write_b32 a47, v33
    v_accvgpr_read_b32 v33, a48
    v_mul_f32 v33, v33, v34
    v_accvgpr_write_b32 a48, v33
    v_accvgpr_read_b32 v33, a49
    v_mul_f32 v33, v33, v34
    v_accvgpr_write_b32 a49, v33
    v_accvgpr_read_b32 v33, a50
    v_mul_f32 v33, v33, v34
    v_accvgpr_write_b32 a50, v33
    v_accvgpr_read_b32 v33, a51
    v_mul_f32 v33, v33, v34
    v_accvgpr_write_b32 a51, v33
    v_accvgpr_read_b32 v33, a52
    v_mul_f32 v33, v33, v34
    v_accvgpr_write_b32 a52, v33
    v_accvgpr_read_b32 v33, a53
    v_mul_f32 v33, v33, v34
    v_accvgpr_write_b32 a53, v33
    v_accvgpr_read_b32 v33, a54
    v_mul_f32 v33, v33, v34
    v_accvgpr_write_b32 a54, v33
    v_accvgpr_read_b32 v33, a55
    v_mul_f32 v33, v33, v34
    v_accvgpr_write_b32 a55, v33
    v_accvgpr_read_b32 v33, a56
    v_mul_f32 v33, v33, v34
    v_accvgpr_write_b32 a56, v33
    v_accvgpr_read_b32 v33, a57
    v_mul_f32 v33, v33, v34
    v_accvgpr_write_b32 a57, v33
    v_accvgpr_read_b32 v33, a58
    v_mul_f32 v33, v33, v34
    v_accvgpr_write_b32 a58, v33
    v_accvgpr_read_b32 v33, a59
    v_mul_f32 v33, v33, v34
    v_accvgpr_write_b32 a59, v33
    v_accvgpr_read_b32 v33, a60
    v_mul_f32 v33, v33, v34
    v_accvgpr_write_b32 a60, v33
    v_accvgpr_read_b32 v33, a61
    v_mul_f32 v33, v33, v34
    v_accvgpr_write_b32 a61, v33
    v_accvgpr_read_b32 v33, a62
    v_mul_f32 v33, v33, v34
    v_accvgpr_write_b32 a62, v33
    v_accvgpr_read_b32 v33, a63
    v_mul_f32 v33, v33, v34
    v_accvgpr_write_b32 a63, v33
    v_exp_f32 v36, v152
    v_exp_f32 v37, v153
    s_nop 0
    v_cvt_pk_bf16_f32 v212, v36, v37
    v_exp_f32 v36, v154
    v_exp_f32 v37, v155
    s_nop 0
    v_cvt_pk_bf16_f32 v213, v36, v37
    v_exp_f32 v36, v156
    v_exp_f32 v37, v157
    s_nop 0
    v_cvt_pk_bf16_f32 v214, v36, v37
    v_exp_f32 v36, v158
    v_exp_f32 v37, v159
    s_nop 0
    v_cvt_pk_bf16_f32 v215, v36, v37
    v_max3_f32 v32, v160, v161, v162
    v_max3_f32 v32, v163, v164, v32
    v_max3_f32 v32, v165, v166, v32
    v_max_f32 v32, v167, v32
    v_mov_b32 v33, v32
    s_nop 1
    v_permlane16_swap_b32 v32, v33
    s_nop 1
    v_max_f32 v32, v32, v33
    v_mov_b32 v33, v32
    s_nop 1
    v_permlane32_swap_b32 v32, v33
    s_nop 1
    v_max_f32 v32, v32, v33
    v_add_f32 v32, 0x41c00000, v32
    v_max_f32 v32, 0, v32
    v_exp_f32 v34, -v32
    v_sub_f32 v72, v72, v32
    v_sub_f32 v73, v73, v32
    v_sub_f32 v74, v74, v32
    v_sub_f32 v75, v75, v32
    v_sub_f32 v160, v160, v32
    v_sub_f32 v161, v161, v32
    v_sub_f32 v162, v162, v32
    v_sub_f32 v163, v163, v32
    v_sub_f32 v164, v164, v32
    v_sub_f32 v165, v165, v32
    v_sub_f32 v166, v166, v32
    v_sub_f32 v167, v167, v32
    v_sub_f32 v192, v192, v32
    v_sub_f32 v193, v193, v32
    v_sub_f32 v194, v194, v32
    v_sub_f32 v195, v195, v32
    v_sub_f32 v196, v196, v32
    v_sub_f32 v197, v197, v32
    v_sub_f32 v198, v198, v32
    v_sub_f32 v199, v199, v32
    v_mul_f32 v248, v248, v34
    v_mul_f32 v249, v249, v34
    v_mul_f32 v250, v250, v34
    v_mul_f32 v251, v251, v34
    v_accvgpr_read_b32 v33, a64
    v_mul_f32 v33, v33, v34
    v_accvgpr_write_b32 a64, v33
    v_accvgpr_read_b32 v33, a65
    v_mul_f32 v33, v33, v34
    v_accvgpr_write_b32 a65, v33
    v_accvgpr_read_b32 v33, a66
    v_mul_f32 v33, v33, v34
    v_accvgpr_write_b32 a66, v33
    v_accvgpr_read_b32 v33, a67
    v_mul_f32 v33, v33, v34
    v_accvgpr_write_b32 a67, v33
    v_accvgpr_read_b32 v33, a68
    v_mul_f32 v33, v33, v34
    v_accvgpr_write_b32 a68, v33
    v_accvgpr_read_b32 v33, a69
    v_mul_f32 v33, v33, v34
    v_accvgpr_write_b32 a69, v33
    v_accvgpr_read_b32 v33, a70
    v_mul_f32 v33, v33, v34
    v_accvgpr_write_b32 a70, v33
    v_accvgpr_read_b32 v33, a71
    v_mul_f32 v33, v33, v34
    v_accvgpr_write_b32 a71, v33
    v_accvgpr_read_b32 v33, a72
    v_mul_f32 v33, v33, v34
    v_accvgpr_write_b32 a72, v33
    v_accvgpr_read_b32 v33, a73
    v_mul_f32 v33, v33, v34
    v_accvgpr_write_b32 a73, v33
    v_accvgpr_read_b32 v33, a74
    v_mul_f32 v33, v33, v34
    v_accvgpr_write_b32 a74, v33
    v_accvgpr_read_b32 v33, a75
    v_mul_f32 v33, v33, v34
    v_accvgpr_write_b32 a75, v33
    v_accvgpr_read_b32 v33, a76
    v_mul_f32 v33, v33, v34
    v_accvgpr_write_b32 a76, v33
    v_accvgpr_read_b32 v33, a77
    v_mul_f32 v33, v33, v34
    v_accvgpr_write_b32 a77, v33
    v_accvgpr_read_b32 v33, a78
    v_mul_f32 v33, v33, v34
    v_accvgpr_write_b32 a78, v33
    v_accvgpr_read_b32 v33, a79
    v_mul_f32 v33, v33, v34
    v_accvgpr_write_b32 a79, v33
    v_accvgpr_read_b32 v33, a80
    v_mul_f32 v33, v33, v34
    v_accvgpr_write_b32 a80, v33
    v_accvgpr_read_b32 v33, a81
    v_mul_f32 v33, v33, v34
    v_accvgpr_write_b32 a81, v33
    v_accvgpr_read_b32 v33, a82
    v_mul_f32 v33, v33, v34
    v_accvgpr_write_b32 a82, v33
    v_accvgpr_read_b32 v33, a83
    v_mul_f32 v33, v33, v34
    v_accvgpr_write_b32 a83, v33
    v_accvgpr_read_b32 v33, a84
    v_mul_f32 v33, v33, v34
    v_accvgpr_write_b32 a84, v33
    v_accvgpr_read_b32 v33, a85
    v_mul_f32 v33, v33, v34
    v_accvgpr_write_b32 a85, v33
    v_accvgpr_read_b32 v33, a86
    v_mul_f32 v33, v33, v34
    v_accvgpr_write_b32 a86, v33
    v_accvgpr_read_b32 v33, a87
    v_mul_f32 v33, v33, v34
    v_accvgpr_write_b32 a87, v33
    v_accvgpr_read_b32 v33, a88
    v_mul_f32 v33, v33, v34
    v_accvgpr_write_b32 a88, v33
    v_accvgpr_read_b32 v33, a89
    v_mul_f32 v33, v33, v34
    v_accvgpr_write_b32 a89, v33
    v_accvgpr_read_b32 v33, a90
    v_mul_f32 v33, v33, v34
    v_accvgpr_write_b32 a90, v33
    v_accvgpr_read_b32 v33, a91
    v_mul_f32 v33, v33, v34
    v_accvgpr_write_b32 a91, v33
    v_accvgpr_read_b32 v33, a92
    v_mul_f32 v33, v33, v34
    v_accvgpr_write_b32 a92, v33
    v_accvgpr_read_b32 v33, a93
    v_mul_f32 v33, v33, v34
    v_accvgpr_write_b32 a93, v33
    v_accvgpr_read_b32 v33, a94
    v_mul_f32 v33, v33, v34
    v_accvgpr_write_b32 a94, v33
    v_accvgpr_read_b32 v33, a95
    v_mul_f32 v33, v33, v34
    v_accvgpr_write_b32 a95, v33
    v_exp_f32 v36, v160
    v_exp_f32 v37, v161
    s_nop 0
    v_cvt_pk_bf16_f32 v216, v36, v37
    v_exp_f32 v36, v162
    v_exp_f32 v37, v163
    s_nop 0
    v_cvt_pk_bf16_f32 v217, v36, v37
    v_exp_f32 v36, v164
    v_exp_f32 v37, v165
    s_nop 0
    v_cvt_pk_bf16_f32 v218, v36, v37
    v_exp_f32 v36, v166
    v_exp_f32 v37, v167
    s_nop 0
    v_cvt_pk_bf16_f32 v219, v36, v37
    v_max3_f32 v32, v168, v169, v170
    v_max3_f32 v32, v171, v172, v32
    v_max3_f32 v32, v173, v174, v32
    v_max_f32 v32, v175, v32
    v_mov_b32 v33, v32
    s_nop 1
    v_permlane16_swap_b32 v32, v33
    s_nop 1
    v_max_f32 v32, v32, v33
    v_mov_b32 v33, v32
    s_nop 1
    v_permlane32_swap_b32 v32, v33
    s_nop 1
    v_max_f32 v32, v32, v33
    v_add_f32 v32, 0x41c00000, v32
    v_max_f32 v32, 0, v32
    v_exp_f32 v34, -v32
    v_sub_f32 v76, v76, v32
    v_sub_f32 v77, v77, v32
    v_sub_f32 v78, v78, v32
    v_sub_f32 v79, v79, v32
    v_sub_f32 v168, v168, v32
    v_sub_f32 v169, v169, v32
    v_sub_f32 v170, v170, v32
    v_sub_f32 v171, v171, v32
    v_sub_f32 v172, v172, v32
    v_sub_f32 v173, v173, v32
    v_sub_f32 v174, v174, v32
    v_sub_f32 v175, v175, v32
    v_sub_f32 v200, v200, v32
    v_sub_f32 v201, v201, v32
    v_sub_f32 v202, v202, v32
    v_sub_f32 v203, v203, v32
    v_sub_f32 v204, v204, v32
    v_sub_f32 v205, v205, v32
    v_sub_f32 v206, v206, v32
    v_sub_f32 v207, v207, v32
    v_mul_f32 v252, v252, v34
    v_mul_f32 v253, v253, v34
    v_mul_f32 v254, v254, v34
    v_mul_f32 v255, v255, v34
    v_accvgpr_read_b32 v33, a96
    v_mul_f32 v33, v33, v34
    v_accvgpr_write_b32 a96, v33
    v_accvgpr_read_b32 v33, a97
    v_mul_f32 v33, v33, v34
    v_accvgpr_write_b32 a97, v33
    v_accvgpr_read_b32 v33, a98
    v_mul_f32 v33, v33, v34
    v_accvgpr_write_b32 a98, v33
    v_accvgpr_read_b32 v33, a99
    v_mul_f32 v33, v33, v34
    v_accvgpr_write_b32 a99, v33
    v_accvgpr_read_b32 v33, a100
    v_mul_f32 v33, v33, v34
    v_accvgpr_write_b32 a100, v33
    v_accvgpr_read_b32 v33, a101
    v_mul_f32 v33, v33, v34
    v_accvgpr_write_b32 a101, v33
    v_accvgpr_read_b32 v33, a102
    v_mul_f32 v33, v33, v34
    v_accvgpr_write_b32 a102, v33
    v_accvgpr_read_b32 v33, a103
    v_mul_f32 v33, v33, v34
    v_accvgpr_write_b32 a103, v33
    v_accvgpr_read_b32 v33, a104
    v_mul_f32 v33, v33, v34
    v_accvgpr_write_b32 a104, v33
    v_accvgpr_read_b32 v33, a105
    v_mul_f32 v33, v33, v34
    v_accvgpr_write_b32 a105, v33
    v_accvgpr_read_b32 v33, a106
    v_mul_f32 v33, v33, v34
    v_accvgpr_write_b32 a106, v33
    v_accvgpr_read_b32 v33, a107
    v_mul_f32 v33, v33, v34
    v_accvgpr_write_b32 a107, v33
    v_accvgpr_read_b32 v33, a108
    v_mul_f32 v33, v33, v34
    v_accvgpr_write_b32 a108, v33
    v_accvgpr_read_b32 v33, a109
    v_mul_f32 v33, v33, v34
    v_accvgpr_write_b32 a109, v33
    v_accvgpr_read_b32 v33, a110
    v_mul_f32 v33, v33, v34
    v_accvgpr_write_b32 a110, v33
    v_accvgpr_read_b32 v33, a111
    v_mul_f32 v33, v33, v34
    v_accvgpr_write_b32 a111, v33
    v_accvgpr_read_b32 v33, a112
    v_mul_f32 v33, v33, v34
    v_accvgpr_write_b32 a112, v33
    v_accvgpr_read_b32 v33, a113
    v_mul_f32 v33, v33, v34
    v_accvgpr_write_b32 a113, v33
    v_accvgpr_read_b32 v33, a114
    v_mul_f32 v33, v33, v34
    v_accvgpr_write_b32 a114, v33
    v_accvgpr_read_b32 v33, a115
    v_mul_f32 v33, v33, v34
    v_accvgpr_write_b32 a115, v33
    v_accvgpr_read_b32 v33, a116
    v_mul_f32 v33, v33, v34
    v_accvgpr_write_b32 a116, v33
    v_accvgpr_read_b32 v33, a117
    v_mul_f32 v33, v33, v34
    v_accvgpr_write_b32 a117, v33
    v_accvgpr_read_b32 v33, a118
    v_mul_f32 v33, v33, v34
    v_accvgpr_write_b32 a118, v33
    v_accvgpr_read_b32 v33, a119
    v_mul_f32 v33, v33, v34
    v_accvgpr_write_b32 a119, v33
    v_accvgpr_read_b32 v33, a120
    v_mul_f32 v33, v33, v34
    v_accvgpr_write_b32 a120, v33
    v_accvgpr_read_b32 v33, a121
    v_mul_f32 v33, v33, v34
    v_accvgpr_write_b32 a121, v33
    v_accvgpr_read_b32 v33, a122
    v_mul_f32 v33, v33, v34
    v_accvgpr_write_b32 a122, v33
    v_accvgpr_read_b32 v33, a123
    v_mul_f32 v33, v33, v34
    v_accvgpr_write_b32 a123, v33
    v_accvgpr_read_b32 v33, a124
    v_mul_f32 v33, v33, v34
    v_accvgpr_write_b32 a124, v33
    v_accvgpr_read_b32 v33, a125
    v_mul_f32 v33, v33, v34
    v_accvgpr_write_b32 a125, v33
    v_accvgpr_read_b32 v33, a126
    v_mul_f32 v33, v33, v34
    v_accvgpr_write_b32 a126, v33
    v_accvgpr_read_b32 v33, a127
    v_mul_f32 v33, v33, v34
    v_accvgpr_write_b32 a127, v33
    v_exp_f32 v36, v168
    v_exp_f32 v37, v169
    s_nop 0
    v_cvt_pk_bf16_f32 v220, v36, v37
    v_exp_f32 v36, v170
    v_exp_f32 v37, v171
    s_nop 0
    v_cvt_pk_bf16_f32 v221, v36, v37
    v_exp_f32 v36, v172
    v_exp_f32 v37, v173
    s_nop 0
    v_cvt_pk_bf16_f32 v222, v36, v37
    v_exp_f32 v36, v174
    v_exp_f32 v37, v175
    s_nop 0
    v_cvt_pk_bf16_f32 v223, v36, v37
    s_nop 1
    s_branch gated_mix__ssm_conv_h3__compressed_kv_cla__prompt_kernel_b3_r0_ret
gated_mix__ssm_conv_h3__compressed_kv_cla__prompt_kernel_b3_r1:
    s_nop 7
    v_max3_f32 v32, v184, v185, v186
    v_max3_f32 v32, v187, v188, v32
    v_max3_f32 v32, v189, v190, v32
    v_max_f32 v32, v191, v32
    v_mov_b32 v33, v32
    s_nop 1
    v_permlane16_swap_b32 v32, v33
    s_nop 1
    v_max_f32 v32, v32, v33
    v_mov_b32 v33, v32
    s_nop 1
    v_permlane32_swap_b32 v32, v33
    s_nop 1
    v_max_f32 v32, v32, v33
    v_add_f32 v32, 0x41c00000, v32
    v_max_f32 v32, 0, v32
    v_exp_f32 v34, -v32
    v_sub_f32 v68, v68, v32
    v_sub_f32 v69, v69, v32
    v_sub_f32 v70, v70, v32
    v_sub_f32 v71, v71, v32
    v_sub_f32 v184, v184, v32
    v_sub_f32 v185, v185, v32
    v_sub_f32 v186, v186, v32
    v_sub_f32 v187, v187, v32
    v_sub_f32 v188, v188, v32
    v_sub_f32 v189, v189, v32
    v_sub_f32 v190, v190, v32
    v_sub_f32 v191, v191, v32
    v_sub_f32 v152, v152, v32
    v_sub_f32 v153, v153, v32
    v_sub_f32 v154, v154, v32
    v_sub_f32 v155, v155, v32
    v_sub_f32 v156, v156, v32
    v_sub_f32 v157, v157, v32
    v_sub_f32 v158, v158, v32
    v_sub_f32 v159, v159, v32
    v_mul_f32 v244, v244, v34
    v_mul_f32 v245, v245, v34
    v_mul_f32 v246, v246, v34
    v_mul_f32 v247, v247, v34
    v_accvgpr_read_b32 v33, a32
    v_mul_f32 v33, v33, v34
    v_accvgpr_write_b32 a32, v33
    v_accvgpr_read_b32 v33, a33
    v_mul_f32 v33, v33, v34
    v_accvgpr_write_b32 a33, v33
    v_accvgpr_read_b32 v33, a34
    v_mul_f32 v33, v33, v34
    v_accvgpr_write_b32 a34, v33
    v_accvgpr_read_b32 v33, a35
    v_mul_f32 v33, v33, v34
    v_accvgpr_write_b32 a35, v33
    v_accvgpr_read_b32 v33, a36
    v_mul_f32 v33, v33, v34
    v_accvgpr_write_b32 a36, v33
    v_accvgpr_read_b32 v33, a37
    v_mul_f32 v33, v33, v34
    v_accvgpr_write_b32 a37, v33
    v_accvgpr_read_b32 v33, a38
    v_mul_f32 v33, v33, v34
    v_accvgpr_write_b32 a38, v33
    v_accvgpr_read_b32 v33, a39
    v_mul_f32 v33, v33, v34
    v_accvgpr_write_b32 a39, v33
    v_accvgpr_read_b32 v33, a40
    v_mul_f32 v33, v33, v34
    v_accvgpr_write_b32 a40, v33
    v_accvgpr_read_b32 v33, a41
    v_mul_f32 v33, v33, v34
    v_accvgpr_write_b32 a41, v33
    v_accvgpr_read_b32 v33, a42
    v_mul_f32 v33, v33, v34
    v_accvgpr_write_b32 a42, v33
    v_accvgpr_read_b32 v33, a43
    v_mul_f32 v33, v33, v34
    v_accvgpr_write_b32 a43, v33
    v_accvgpr_read_b32 v33, a44
    v_mul_f32 v33, v33, v34
    v_accvgpr_write_b32 a44, v33
    v_accvgpr_read_b32 v33, a45
    v_mul_f32 v33, v33, v34
    v_accvgpr_write_b32 a45, v33
    v_accvgpr_read_b32 v33, a46
    v_mul_f32 v33, v33, v34
    v_accvgpr_write_b32 a46, v33
    v_accvgpr_read_b32 v33, a47
    v_mul_f32 v33, v33, v34
    v_accvgpr_write_b32 a47, v33
    v_accvgpr_read_b32 v33, a48
    v_mul_f32 v33, v33, v34
    v_accvgpr_write_b32 a48, v33
    v_accvgpr_read_b32 v33, a49
    v_mul_f32 v33, v33, v34
    v_accvgpr_write_b32 a49, v33
    v_accvgpr_read_b32 v33, a50
    v_mul_f32 v33, v33, v34
    v_accvgpr_write_b32 a50, v33
    v_accvgpr_read_b32 v33, a51
    v_mul_f32 v33, v33, v34
    v_accvgpr_write_b32 a51, v33
    v_accvgpr_read_b32 v33, a52
    v_mul_f32 v33, v33, v34
    v_accvgpr_write_b32 a52, v33
    v_accvgpr_read_b32 v33, a53
    v_mul_f32 v33, v33, v34
    v_accvgpr_write_b32 a53, v33
    v_accvgpr_read_b32 v33, a54
    v_mul_f32 v33, v33, v34
    v_accvgpr_write_b32 a54, v33
    v_accvgpr_read_b32 v33, a55
    v_mul_f32 v33, v33, v34
    v_accvgpr_write_b32 a55, v33
    v_accvgpr_read_b32 v33, a56
    v_mul_f32 v33, v33, v34
    v_accvgpr_write_b32 a56, v33
    v_accvgpr_read_b32 v33, a57
    v_mul_f32 v33, v33, v34
    v_accvgpr_write_b32 a57, v33
    v_accvgpr_read_b32 v33, a58
    v_mul_f32 v33, v33, v34
    v_accvgpr_write_b32 a58, v33
    v_accvgpr_read_b32 v33, a59
    v_mul_f32 v33, v33, v34
    v_accvgpr_write_b32 a59, v33
    v_accvgpr_read_b32 v33, a60
    v_mul_f32 v33, v33, v34
    v_accvgpr_write_b32 a60, v33
    v_accvgpr_read_b32 v33, a61
    v_mul_f32 v33, v33, v34
    v_accvgpr_write_b32 a61, v33
    v_accvgpr_read_b32 v33, a62
    v_mul_f32 v33, v33, v34
    v_accvgpr_write_b32 a62, v33
    v_accvgpr_read_b32 v33, a63
    v_mul_f32 v33, v33, v34
    v_accvgpr_write_b32 a63, v33
    v_exp_f32 v36, v184
    v_exp_f32 v37, v185
    s_nop 0
    v_cvt_pk_bf16_f32 v228, v36, v37
    v_exp_f32 v36, v186
    v_exp_f32 v37, v187
    s_nop 0
    v_cvt_pk_bf16_f32 v229, v36, v37
    v_exp_f32 v36, v188
    v_exp_f32 v37, v189
    s_nop 0
    v_cvt_pk_bf16_f32 v230, v36, v37
    v_exp_f32 v36, v190
    v_exp_f32 v37, v191
    s_nop 0
    v_cvt_pk_bf16_f32 v231, v36, v37
    v_max3_f32 v32, v192, v193, v194
    v_max3_f32 v32, v195, v196, v32
    v_max3_f32 v32, v197, v198, v32
    v_max_f32 v32, v199, v32
    v_mov_b32 v33, v32
    s_nop 1
    v_permlane16_swap_b32 v32, v33
    s_nop 1
    v_max_f32 v32, v32, v33
    v_mov_b32 v33, v32
    s_nop 1
    v_permlane32_swap_b32 v32, v33
    s_nop 1
    v_max_f32 v32, v32, v33
    v_add_f32 v32, 0x41c00000, v32
    v_max_f32 v32, 0, v32
    v_exp_f32 v34, -v32
    v_sub_f32 v72, v72, v32
    v_sub_f32 v73, v73, v32
    v_sub_f32 v74, v74, v32
    v_sub_f32 v75, v75, v32
    v_sub_f32 v192, v192, v32
    v_sub_f32 v193, v193, v32
    v_sub_f32 v194, v194, v32
    v_sub_f32 v195, v195, v32
    v_sub_f32 v196, v196, v32
    v_sub_f32 v197, v197, v32
    v_sub_f32 v198, v198, v32
    v_sub_f32 v199, v199, v32
    v_sub_f32 v160, v160, v32
    v_sub_f32 v161, v161, v32
    v_sub_f32 v162, v162, v32
    v_sub_f32 v163, v163, v32
    v_sub_f32 v164, v164, v32
    v_sub_f32 v165, v165, v32
    v_sub_f32 v166, v166, v32
    v_sub_f32 v167, v167, v32
    v_mul_f32 v248, v248, v34
    v_mul_f32 v249, v249, v34
    v_mul_f32 v250, v250, v34
    v_mul_f32 v251, v251, v34
    v_accvgpr_read_b32 v33, a64
    v_mul_f32 v33, v33, v34
    v_accvgpr_write_b32 a64, v33
    v_accvgpr_read_b32 v33, a65
    v_mul_f32 v33, v33, v34
    v_accvgpr_write_b32 a65, v33
    v_accvgpr_read_b32 v33, a66
    v_mul_f32 v33, v33, v34
    v_accvgpr_write_b32 a66, v33
    v_accvgpr_read_b32 v33, a67
    v_mul_f32 v33, v33, v34
    v_accvgpr_write_b32 a67, v33
    v_accvgpr_read_b32 v33, a68
    v_mul_f32 v33, v33, v34
    v_accvgpr_write_b32 a68, v33
    v_accvgpr_read_b32 v33, a69
    v_mul_f32 v33, v33, v34
    v_accvgpr_write_b32 a69, v33
    v_accvgpr_read_b32 v33, a70
    v_mul_f32 v33, v33, v34
    v_accvgpr_write_b32 a70, v33
    v_accvgpr_read_b32 v33, a71
    v_mul_f32 v33, v33, v34
    v_accvgpr_write_b32 a71, v33
    v_accvgpr_read_b32 v33, a72
    v_mul_f32 v33, v33, v34
    v_accvgpr_write_b32 a72, v33
    v_accvgpr_read_b32 v33, a73
    v_mul_f32 v33, v33, v34
    v_accvgpr_write_b32 a73, v33
    v_accvgpr_read_b32 v33, a74
    v_mul_f32 v33, v33, v34
    v_accvgpr_write_b32 a74, v33
    v_accvgpr_read_b32 v33, a75
    v_mul_f32 v33, v33, v34
    v_accvgpr_write_b32 a75, v33
    v_accvgpr_read_b32 v33, a76
    v_mul_f32 v33, v33, v34
    v_accvgpr_write_b32 a76, v33
    v_accvgpr_read_b32 v33, a77
    v_mul_f32 v33, v33, v34
    v_accvgpr_write_b32 a77, v33
    v_accvgpr_read_b32 v33, a78
    v_mul_f32 v33, v33, v34
    v_accvgpr_write_b32 a78, v33
    v_accvgpr_read_b32 v33, a79
    v_mul_f32 v33, v33, v34
    v_accvgpr_write_b32 a79, v33
    v_accvgpr_read_b32 v33, a80
    v_mul_f32 v33, v33, v34
    v_accvgpr_write_b32 a80, v33
    v_accvgpr_read_b32 v33, a81
    v_mul_f32 v33, v33, v34
    v_accvgpr_write_b32 a81, v33
    v_accvgpr_read_b32 v33, a82
    v_mul_f32 v33, v33, v34
    v_accvgpr_write_b32 a82, v33
    v_accvgpr_read_b32 v33, a83
    v_mul_f32 v33, v33, v34
    v_accvgpr_write_b32 a83, v33
    v_accvgpr_read_b32 v33, a84
    v_mul_f32 v33, v33, v34
    v_accvgpr_write_b32 a84, v33
    v_accvgpr_read_b32 v33, a85
    v_mul_f32 v33, v33, v34
    v_accvgpr_write_b32 a85, v33
    v_accvgpr_read_b32 v33, a86
    v_mul_f32 v33, v33, v34
    v_accvgpr_write_b32 a86, v33
    v_accvgpr_read_b32 v33, a87
    v_mul_f32 v33, v33, v34
    v_accvgpr_write_b32 a87, v33
    v_accvgpr_read_b32 v33, a88
    v_mul_f32 v33, v33, v34
    v_accvgpr_write_b32 a88, v33
    v_accvgpr_read_b32 v33, a89
    v_mul_f32 v33, v33, v34
    v_accvgpr_write_b32 a89, v33
    v_accvgpr_read_b32 v33, a90
    v_mul_f32 v33, v33, v34
    v_accvgpr_write_b32 a90, v33
    v_accvgpr_read_b32 v33, a91
    v_mul_f32 v33, v33, v34
    v_accvgpr_write_b32 a91, v33
    v_accvgpr_read_b32 v33, a92
    v_mul_f32 v33, v33, v34
    v_accvgpr_write_b32 a92, v33
    v_accvgpr_read_b32 v33, a93
    v_mul_f32 v33, v33, v34
    v_accvgpr_write_b32 a93, v33
    v_accvgpr_read_b32 v33, a94
    v_mul_f32 v33, v33, v34
    v_accvgpr_write_b32 a94, v33
    v_accvgpr_read_b32 v33, a95
    v_mul_f32 v33, v33, v34
    v_accvgpr_write_b32 a95, v33
    v_exp_f32 v36, v192
    v_exp_f32 v37, v193
    s_nop 0
    v_cvt_pk_bf16_f32 v232, v36, v37
    v_exp_f32 v36, v194
    v_exp_f32 v37, v195
    s_nop 0
    v_cvt_pk_bf16_f32 v233, v36, v37
    v_exp_f32 v36, v196
    v_exp_f32 v37, v197
    s_nop 0
    v_cvt_pk_bf16_f32 v234, v36, v37
    v_exp_f32 v36, v198
    v_exp_f32 v37, v199
    s_nop 0
    v_cvt_pk_bf16_f32 v235, v36, v37
    v_max3_f32 v32, v200, v201, v202
    v_max3_f32 v32, v203, v204, v32
    v_max3_f32 v32, v205, v206, v32
    v_max_f32 v32, v207, v32
    v_mov_b32 v33, v32
    s_nop 1
    v_permlane16_swap_b32 v32, v33
    s_nop 1
    v_max_f32 v32, v32, v33
    v_mov_b32 v33, v32
    s_nop 1
    v_permlane32_swap_b32 v32, v33
    s_nop 1
    v_max_f32 v32, v32, v33
    v_add_f32 v32, 0x41c00000, v32
    v_max_f32 v32, 0, v32
    v_exp_f32 v34, -v32
    v_sub_f32 v76, v76, v32
    v_sub_f32 v77, v77, v32
    v_sub_f32 v78, v78, v32
    v_sub_f32 v79, v79, v32
    v_sub_f32 v200, v200, v32
    v_sub_f32 v201, v201, v32
    v_sub_f32 v202, v202, v32
    v_sub_f32 v203, v203, v32
    v_sub_f32 v204, v204, v32
    v_sub_f32 v205, v205, v32
    v_sub_f32 v206, v206, v32
    v_sub_f32 v207, v207, v32
    v_sub_f32 v168, v168, v32
    v_sub_f32 v169, v169, v32
    v_sub_f32 v170, v170, v32
    v_sub_f32 v171, v171, v32
    v_sub_f32 v172, v172, v32
    v_sub_f32 v173, v173, v32
    v_sub_f32 v174, v174, v32
    v_sub_f32 v175, v175, v32
    v_mul_f32 v252, v252, v34
    v_mul_f32 v253, v253, v34
    v_mul_f32 v254, v254, v34
    v_mul_f32 v255, v255, v34
    v_accvgpr_read_b32 v33, a96
    v_mul_f32 v33, v33, v34
    v_accvgpr_write_b32 a96, v33
    v_accvgpr_read_b32 v33, a97
    v_mul_f32 v33, v33, v34
    v_accvgpr_write_b32 a97, v33
    v_accvgpr_read_b32 v33, a98
    v_mul_f32 v33, v33, v34
    v_accvgpr_write_b32 a98, v33
    v_accvgpr_read_b32 v33, a99
    v_mul_f32 v33, v33, v34
    v_accvgpr_write_b32 a99, v33
    v_accvgpr_read_b32 v33, a100
    v_mul_f32 v33, v33, v34
    v_accvgpr_write_b32 a100, v33
    v_accvgpr_read_b32 v33, a101
    v_mul_f32 v33, v33, v34
    v_accvgpr_write_b32 a101, v33
    v_accvgpr_read_b32 v33, a102
    v_mul_f32 v33, v33, v34
    v_accvgpr_write_b32 a102, v33
    v_accvgpr_read_b32 v33, a103
    v_mul_f32 v33, v33, v34
    v_accvgpr_write_b32 a103, v33
    v_accvgpr_read_b32 v33, a104
    v_mul_f32 v33, v33, v34
    v_accvgpr_write_b32 a104, v33
    v_accvgpr_read_b32 v33, a105
    v_mul_f32 v33, v33, v34
    v_accvgpr_write_b32 a105, v33
    v_accvgpr_read_b32 v33, a106
    v_mul_f32 v33, v33, v34
    v_accvgpr_write_b32 a106, v33
    v_accvgpr_read_b32 v33, a107
    v_mul_f32 v33, v33, v34
    v_accvgpr_write_b32 a107, v33
    v_accvgpr_read_b32 v33, a108
    v_mul_f32 v33, v33, v34
    v_accvgpr_write_b32 a108, v33
    v_accvgpr_read_b32 v33, a109
    v_mul_f32 v33, v33, v34
    v_accvgpr_write_b32 a109, v33
    v_accvgpr_read_b32 v33, a110
    v_mul_f32 v33, v33, v34
    v_accvgpr_write_b32 a110, v33
    v_accvgpr_read_b32 v33, a111
    v_mul_f32 v33, v33, v34
    v_accvgpr_write_b32 a111, v33
    v_accvgpr_read_b32 v33, a112
    v_mul_f32 v33, v33, v34
    v_accvgpr_write_b32 a112, v33
    v_accvgpr_read_b32 v33, a113
    v_mul_f32 v33, v33, v34
    v_accvgpr_write_b32 a113, v33
    v_accvgpr_read_b32 v33, a114
    v_mul_f32 v33, v33, v34
    v_accvgpr_write_b32 a114, v33
    v_accvgpr_read_b32 v33, a115
    v_mul_f32 v33, v33, v34
    v_accvgpr_write_b32 a115, v33
    v_accvgpr_read_b32 v33, a116
    v_mul_f32 v33, v33, v34
    v_accvgpr_write_b32 a116, v33
    v_accvgpr_read_b32 v33, a117
    v_mul_f32 v33, v33, v34
    v_accvgpr_write_b32 a117, v33
    v_accvgpr_read_b32 v33, a118
    v_mul_f32 v33, v33, v34
    v_accvgpr_write_b32 a118, v33
    v_accvgpr_read_b32 v33, a119
    v_mul_f32 v33, v33, v34
    v_accvgpr_write_b32 a119, v33
    v_accvgpr_read_b32 v33, a120
    v_mul_f32 v33, v33, v34
    v_accvgpr_write_b32 a120, v33
    v_accvgpr_read_b32 v33, a121
    v_mul_f32 v33, v33, v34
    v_accvgpr_write_b32 a121, v33
    v_accvgpr_read_b32 v33, a122
    v_mul_f32 v33, v33, v34
    v_accvgpr_write_b32 a122, v33
    v_accvgpr_read_b32 v33, a123
    v_mul_f32 v33, v33, v34
    v_accvgpr_write_b32 a123, v33
    v_accvgpr_read_b32 v33, a124
    v_mul_f32 v33, v33, v34
    v_accvgpr_write_b32 a124, v33
    v_accvgpr_read_b32 v33, a125
    v_mul_f32 v33, v33, v34
    v_accvgpr_write_b32 a125, v33
    v_accvgpr_read_b32 v33, a126
    v_mul_f32 v33, v33, v34
    v_accvgpr_write_b32 a126, v33
    v_accvgpr_read_b32 v33, a127
    v_mul_f32 v33, v33, v34
    v_accvgpr_write_b32 a127, v33
    v_exp_f32 v36, v200
    v_exp_f32 v37, v201
    s_nop 0
    v_cvt_pk_bf16_f32 v236, v36, v37
    v_exp_f32 v36, v202
    v_exp_f32 v37, v203
    s_nop 0
    v_cvt_pk_bf16_f32 v237, v36, v37
    v_exp_f32 v36, v204
    v_exp_f32 v37, v205
    s_nop 0
    v_cvt_pk_bf16_f32 v238, v36, v37
    v_exp_f32 v36, v206
    v_exp_f32 v37, v207
    s_nop 0
    v_cvt_pk_bf16_f32 v239, v36, v37
    s_nop 1
    s_branch gated_mix__ssm_conv_h3__compressed_kv_cla__prompt_kernel_b3_r1_ret
gated_mix__ssm_conv_h3__compressed_kv_cla__prompt_kernel_b2_r0:
    s_nop 7
    v_max3_f32 v32, v160, v161, v162
    v_max3_f32 v32, v163, v164, v32
    v_max3_f32 v32, v165, v166, v32
    v_max_f32 v32, v167, v32
    v_mov_b32 v33, v32
    s_nop 1
    v_permlane16_swap_b32 v32, v33
    s_nop 1
    v_max_f32 v32, v32, v33
    v_mov_b32 v33, v32
    s_nop 1
    v_permlane32_swap_b32 v32, v33
    s_nop 1
    v_max_f32 v32, v32, v33
    v_add_f32 v32, 0x41c00000, v32
    v_max_f32 v32, 0, v32
    v_exp_f32 v34, -v32
    v_sub_f32 v72, v72, v32
    v_sub_f32 v73, v73, v32
    v_sub_f32 v74, v74, v32
    v_sub_f32 v75, v75, v32
    v_sub_f32 v160, v160, v32
    v_sub_f32 v161, v161, v32
    v_sub_f32 v162, v162, v32
    v_sub_f32 v163, v163, v32
    v_sub_f32 v164, v164, v32
    v_sub_f32 v165, v165, v32
    v_sub_f32 v166, v166, v32
    v_sub_f32 v167, v167, v32
    v_sub_f32 v192, v192, v32
    v_sub_f32 v193, v193, v32
    v_sub_f32 v194, v194, v32
    v_sub_f32 v195, v195, v32
    v_sub_f32 v196, v196, v32
    v_sub_f32 v197, v197, v32
    v_sub_f32 v198, v198, v32
    v_sub_f32 v199, v199, v32
    v_mul_f32 v248, v248, v34
    v_mul_f32 v249, v249, v34
    v_mul_f32 v250, v250, v34
    v_mul_f32 v251, v251, v34
    v_accvgpr_read_b32 v33, a64
    v_mul_f32 v33, v33, v34
    v_accvgpr_write_b32 a64, v33
    v_accvgpr_read_b32 v33, a65
    v_mul_f32 v33, v33, v34
    v_accvgpr_write_b32 a65, v33
    v_accvgpr_read_b32 v33, a66
    v_mul_f32 v33, v33, v34
    v_accvgpr_write_b32 a66, v33
    v_accvgpr_read_b32 v33, a67
    v_mul_f32 v33, v33, v34
    v_accvgpr_write_b32 a67, v33
    v_accvgpr_read_b32 v33, a68
    v_mul_f32 v33, v33, v34
    v_accvgpr_write_b32 a68, v33
    v_accvgpr_read_b32 v33, a69
    v_mul_f32 v33, v33, v34
    v_accvgpr_write_b32 a69, v33
    v_accvgpr_read_b32 v33, a70
    v_mul_f32 v33, v33, v34
    v_accvgpr_write_b32 a70, v33
    v_accvgpr_read_b32 v33, a71
    v_mul_f32 v33, v33, v34
    v_accvgpr_write_b32 a71, v33
    v_accvgpr_read_b32 v33, a72
    v_mul_f32 v33, v33, v34
    v_accvgpr_write_b32 a72, v33
    v_accvgpr_read_b32 v33, a73
    v_mul_f32 v33, v33, v34
    v_accvgpr_write_b32 a73, v33
    v_accvgpr_read_b32 v33, a74
    v_mul_f32 v33, v33, v34
    v_accvgpr_write_b32 a74, v33
    v_accvgpr_read_b32 v33, a75
    v_mul_f32 v33, v33, v34
    v_accvgpr_write_b32 a75, v33
    v_accvgpr_read_b32 v33, a76
    v_mul_f32 v33, v33, v34
    v_accvgpr_write_b32 a76, v33
    v_accvgpr_read_b32 v33, a77
    v_mul_f32 v33, v33, v34
    v_accvgpr_write_b32 a77, v33
    v_accvgpr_read_b32 v33, a78
    v_mul_f32 v33, v33, v34
    v_accvgpr_write_b32 a78, v33
    v_accvgpr_read_b32 v33, a79
    v_mul_f32 v33, v33, v34
    v_accvgpr_write_b32 a79, v33
    v_accvgpr_read_b32 v33, a80
    v_mul_f32 v33, v33, v34
    v_accvgpr_write_b32 a80, v33
    v_accvgpr_read_b32 v33, a81
    v_mul_f32 v33, v33, v34
    v_accvgpr_write_b32 a81, v33
    v_accvgpr_read_b32 v33, a82
    v_mul_f32 v33, v33, v34
    v_accvgpr_write_b32 a82, v33
    v_accvgpr_read_b32 v33, a83
    v_mul_f32 v33, v33, v34
    v_accvgpr_write_b32 a83, v33
    v_accvgpr_read_b32 v33, a84
    v_mul_f32 v33, v33, v34
    v_accvgpr_write_b32 a84, v33
    v_accvgpr_read_b32 v33, a85
    v_mul_f32 v33, v33, v34
    v_accvgpr_write_b32 a85, v33
    v_accvgpr_read_b32 v33, a86
    v_mul_f32 v33, v33, v34
    v_accvgpr_write_b32 a86, v33
    v_accvgpr_read_b32 v33, a87
    v_mul_f32 v33, v33, v34
    v_accvgpr_write_b32 a87, v33
    v_accvgpr_read_b32 v33, a88
    v_mul_f32 v33, v33, v34
    v_accvgpr_write_b32 a88, v33
    v_accvgpr_read_b32 v33, a89
    v_mul_f32 v33, v33, v34
    v_accvgpr_write_b32 a89, v33
    v_accvgpr_read_b32 v33, a90
    v_mul_f32 v33, v33, v34
    v_accvgpr_write_b32 a90, v33
    v_accvgpr_read_b32 v33, a91
    v_mul_f32 v33, v33, v34
    v_accvgpr_write_b32 a91, v33
    v_accvgpr_read_b32 v33, a92
    v_mul_f32 v33, v33, v34
    v_accvgpr_write_b32 a92, v33
    v_accvgpr_read_b32 v33, a93
    v_mul_f32 v33, v33, v34
    v_accvgpr_write_b32 a93, v33
    v_accvgpr_read_b32 v33, a94
    v_mul_f32 v33, v33, v34
    v_accvgpr_write_b32 a94, v33
    v_accvgpr_read_b32 v33, a95
    v_mul_f32 v33, v33, v34
    v_accvgpr_write_b32 a95, v33
    v_exp_f32 v36, v160
    v_exp_f32 v37, v161
    s_nop 0
    v_cvt_pk_bf16_f32 v216, v36, v37
    v_exp_f32 v36, v162
    v_exp_f32 v37, v163
    s_nop 0
    v_cvt_pk_bf16_f32 v217, v36, v37
    v_exp_f32 v36, v164
    v_exp_f32 v37, v165
    s_nop 0
    v_cvt_pk_bf16_f32 v218, v36, v37
    v_exp_f32 v36, v166
    v_exp_f32 v37, v167
    s_nop 0
    v_cvt_pk_bf16_f32 v219, v36, v37
    v_max3_f32 v32, v168, v169, v170
    v_max3_f32 v32, v171, v172, v32
    v_max3_f32 v32, v173, v174, v32
    v_max_f32 v32, v175, v32
    v_mov_b32 v33, v32
    s_nop 1
    v_permlane16_swap_b32 v32, v33
    s_nop 1
    v_max_f32 v32, v32, v33
    v_mov_b32 v33, v32
    s_nop 1
    v_permlane32_swap_b32 v32, v33
    s_nop 1
    v_max_f32 v32, v32, v33
    v_add_f32 v32, 0x41c00000, v32
    v_max_f32 v32, 0, v32
    v_exp_f32 v34, -v32
    v_sub_f32 v76, v76, v32
    v_sub_f32 v77, v77, v32
    v_sub_f32 v78, v78, v32
    v_sub_f32 v79, v79, v32
    v_sub_f32 v168, v168, v32
    v_sub_f32 v169, v169, v32
    v_sub_f32 v170, v170, v32
    v_sub_f32 v171, v171, v32
    v_sub_f32 v172, v172, v32
    v_sub_f32 v173, v173, v32
    v_sub_f32 v174, v174, v32
    v_sub_f32 v175, v175, v32
    v_sub_f32 v200, v200, v32
    v_sub_f32 v201, v201, v32
    v_sub_f32 v202, v202, v32
    v_sub_f32 v203, v203, v32
    v_sub_f32 v204, v204, v32
    v_sub_f32 v205, v205, v32
    v_sub_f32 v206, v206, v32
    v_sub_f32 v207, v207, v32
    v_mul_f32 v252, v252, v34
    v_mul_f32 v253, v253, v34
    v_mul_f32 v254, v254, v34
    v_mul_f32 v255, v255, v34
    v_accvgpr_read_b32 v33, a96
    v_mul_f32 v33, v33, v34
    v_accvgpr_write_b32 a96, v33
    v_accvgpr_read_b32 v33, a97
    v_mul_f32 v33, v33, v34
    v_accvgpr_write_b32 a97, v33
    v_accvgpr_read_b32 v33, a98
    v_mul_f32 v33, v33, v34
    v_accvgpr_write_b32 a98, v33
    v_accvgpr_read_b32 v33, a99
    v_mul_f32 v33, v33, v34
    v_accvgpr_write_b32 a99, v33
    v_accvgpr_read_b32 v33, a100
    v_mul_f32 v33, v33, v34
    v_accvgpr_write_b32 a100, v33
    v_accvgpr_read_b32 v33, a101
    v_mul_f32 v33, v33, v34
    v_accvgpr_write_b32 a101, v33
    v_accvgpr_read_b32 v33, a102
    v_mul_f32 v33, v33, v34
    v_accvgpr_write_b32 a102, v33
    v_accvgpr_read_b32 v33, a103
    v_mul_f32 v33, v33, v34
    v_accvgpr_write_b32 a103, v33
    v_accvgpr_read_b32 v33, a104
    v_mul_f32 v33, v33, v34
    v_accvgpr_write_b32 a104, v33
    v_accvgpr_read_b32 v33, a105
    v_mul_f32 v33, v33, v34
    v_accvgpr_write_b32 a105, v33
    v_accvgpr_read_b32 v33, a106
    v_mul_f32 v33, v33, v34
    v_accvgpr_write_b32 a106, v33
    v_accvgpr_read_b32 v33, a107
    v_mul_f32 v33, v33, v34
    v_accvgpr_write_b32 a107, v33
    v_accvgpr_read_b32 v33, a108
    v_mul_f32 v33, v33, v34
    v_accvgpr_write_b32 a108, v33
    v_accvgpr_read_b32 v33, a109
    v_mul_f32 v33, v33, v34
    v_accvgpr_write_b32 a109, v33
    v_accvgpr_read_b32 v33, a110
    v_mul_f32 v33, v33, v34
    v_accvgpr_write_b32 a110, v33
    v_accvgpr_read_b32 v33, a111
    v_mul_f32 v33, v33, v34
    v_accvgpr_write_b32 a111, v33
    v_accvgpr_read_b32 v33, a112
    v_mul_f32 v33, v33, v34
    v_accvgpr_write_b32 a112, v33
    v_accvgpr_read_b32 v33, a113
    v_mul_f32 v33, v33, v34
    v_accvgpr_write_b32 a113, v33
    v_accvgpr_read_b32 v33, a114
    v_mul_f32 v33, v33, v34
    v_accvgpr_write_b32 a114, v33
    v_accvgpr_read_b32 v33, a115
    v_mul_f32 v33, v33, v34
    v_accvgpr_write_b32 a115, v33
    v_accvgpr_read_b32 v33, a116
    v_mul_f32 v33, v33, v34
    v_accvgpr_write_b32 a116, v33
    v_accvgpr_read_b32 v33, a117
    v_mul_f32 v33, v33, v34
    v_accvgpr_write_b32 a117, v33
    v_accvgpr_read_b32 v33, a118
    v_mul_f32 v33, v33, v34
    v_accvgpr_write_b32 a118, v33
    v_accvgpr_read_b32 v33, a119
    v_mul_f32 v33, v33, v34
    v_accvgpr_write_b32 a119, v33
    v_accvgpr_read_b32 v33, a120
    v_mul_f32 v33, v33, v34
    v_accvgpr_write_b32 a120, v33
    v_accvgpr_read_b32 v33, a121
    v_mul_f32 v33, v33, v34
    v_accvgpr_write_b32 a121, v33
    v_accvgpr_read_b32 v33, a122
    v_mul_f32 v33, v33, v34
    v_accvgpr_write_b32 a122, v33
    v_accvgpr_read_b32 v33, a123
    v_mul_f32 v33, v33, v34
    v_accvgpr_write_b32 a123, v33
    v_accvgpr_read_b32 v33, a124
    v_mul_f32 v33, v33, v34
    v_accvgpr_write_b32 a124, v33
    v_accvgpr_read_b32 v33, a125
    v_mul_f32 v33, v33, v34
    v_accvgpr_write_b32 a125, v33
    v_accvgpr_read_b32 v33, a126
    v_mul_f32 v33, v33, v34
    v_accvgpr_write_b32 a126, v33
    v_accvgpr_read_b32 v33, a127
    v_mul_f32 v33, v33, v34
    v_accvgpr_write_b32 a127, v33
    v_exp_f32 v36, v168
    v_exp_f32 v37, v169
    s_nop 0
    v_cvt_pk_bf16_f32 v220, v36, v37
    v_exp_f32 v36, v170
    v_exp_f32 v37, v171
    s_nop 0
    v_cvt_pk_bf16_f32 v221, v36, v37
    v_exp_f32 v36, v172
    v_exp_f32 v37, v173
    s_nop 0
    v_cvt_pk_bf16_f32 v222, v36, v37
    v_exp_f32 v36, v174
    v_exp_f32 v37, v175
    s_nop 0
    v_cvt_pk_bf16_f32 v223, v36, v37
    s_nop 1
    s_branch gated_mix__ssm_conv_h3__compressed_kv_cla__prompt_kernel_b2_r0_ret
gated_mix__ssm_conv_h3__compressed_kv_cla__prompt_kernel_b2_r1:
    s_nop 7
    v_max3_f32 v32, v192, v193, v194
    v_max3_f32 v32, v195, v196, v32
    v_max3_f32 v32, v197, v198, v32
    v_max_f32 v32, v199, v32
    v_mov_b32 v33, v32
    s_nop 1
    v_permlane16_swap_b32 v32, v33
    s_nop 1
    v_max_f32 v32, v32, v33
    v_mov_b32 v33, v32
    s_nop 1
    v_permlane32_swap_b32 v32, v33
    s_nop 1
    v_max_f32 v32, v32, v33
    v_add_f32 v32, 0x41c00000, v32
    v_max_f32 v32, 0, v32
    v_exp_f32 v34, -v32
    v_sub_f32 v72, v72, v32
    v_sub_f32 v73, v73, v32
    v_sub_f32 v74, v74, v32
    v_sub_f32 v75, v75, v32
    v_sub_f32 v192, v192, v32
    v_sub_f32 v193, v193, v32
    v_sub_f32 v194, v194, v32
    v_sub_f32 v195, v195, v32
    v_sub_f32 v196, v196, v32
    v_sub_f32 v197, v197, v32
    v_sub_f32 v198, v198, v32
    v_sub_f32 v199, v199, v32
    v_sub_f32 v160, v160, v32
    v_sub_f32 v161, v161, v32
    v_sub_f32 v162, v162, v32
    v_sub_f32 v163, v163, v32
    v_sub_f32 v164, v164, v32
    v_sub_f32 v165, v165, v32
    v_sub_f32 v166, v166, v32
    v_sub_f32 v167, v167, v32
    v_mul_f32 v248, v248, v34
    v_mul_f32 v249, v249, v34
    v_mul_f32 v250, v250, v34
    v_mul_f32 v251, v251, v34
    v_accvgpr_read_b32 v33, a64
    v_mul_f32 v33, v33, v34
    v_accvgpr_write_b32 a64, v33
    v_accvgpr_read_b32 v33, a65
    v_mul_f32 v33, v33, v34
    v_accvgpr_write_b32 a65, v33
    v_accvgpr_read_b32 v33, a66
    v_mul_f32 v33, v33, v34
    v_accvgpr_write_b32 a66, v33
    v_accvgpr_read_b32 v33, a67
    v_mul_f32 v33, v33, v34
    v_accvgpr_write_b32 a67, v33
    v_accvgpr_read_b32 v33, a68
    v_mul_f32 v33, v33, v34
    v_accvgpr_write_b32 a68, v33
    v_accvgpr_read_b32 v33, a69
    v_mul_f32 v33, v33, v34
    v_accvgpr_write_b32 a69, v33
    v_accvgpr_read_b32 v33, a70
    v_mul_f32 v33, v33, v34
    v_accvgpr_write_b32 a70, v33
    v_accvgpr_read_b32 v33, a71
    v_mul_f32 v33, v33, v34
    v_accvgpr_write_b32 a71, v33
    v_accvgpr_read_b32 v33, a72
    v_mul_f32 v33, v33, v34
    v_accvgpr_write_b32 a72, v33
    v_accvgpr_read_b32 v33, a73
    v_mul_f32 v33, v33, v34
    v_accvgpr_write_b32 a73, v33
    v_accvgpr_read_b32 v33, a74
    v_mul_f32 v33, v33, v34
    v_accvgpr_write_b32 a74, v33
    v_accvgpr_read_b32 v33, a75
    v_mul_f32 v33, v33, v34
    v_accvgpr_write_b32 a75, v33
    v_accvgpr_read_b32 v33, a76
    v_mul_f32 v33, v33, v34
    v_accvgpr_write_b32 a76, v33
    v_accvgpr_read_b32 v33, a77
    v_mul_f32 v33, v33, v34
    v_accvgpr_write_b32 a77, v33
    v_accvgpr_read_b32 v33, a78
    v_mul_f32 v33, v33, v34
    v_accvgpr_write_b32 a78, v33
    v_accvgpr_read_b32 v33, a79
    v_mul_f32 v33, v33, v34
    v_accvgpr_write_b32 a79, v33
    v_accvgpr_read_b32 v33, a80
    v_mul_f32 v33, v33, v34
    v_accvgpr_write_b32 a80, v33
    v_accvgpr_read_b32 v33, a81
    v_mul_f32 v33, v33, v34
    v_accvgpr_write_b32 a81, v33
    v_accvgpr_read_b32 v33, a82
    v_mul_f32 v33, v33, v34
    v_accvgpr_write_b32 a82, v33
    v_accvgpr_read_b32 v33, a83
    v_mul_f32 v33, v33, v34
    v_accvgpr_write_b32 a83, v33
    v_accvgpr_read_b32 v33, a84
    v_mul_f32 v33, v33, v34
    v_accvgpr_write_b32 a84, v33
    v_accvgpr_read_b32 v33, a85
    v_mul_f32 v33, v33, v34
    v_accvgpr_write_b32 a85, v33
    v_accvgpr_read_b32 v33, a86
    v_mul_f32 v33, v33, v34
    v_accvgpr_write_b32 a86, v33
    v_accvgpr_read_b32 v33, a87
    v_mul_f32 v33, v33, v34
    v_accvgpr_write_b32 a87, v33
    v_accvgpr_read_b32 v33, a88
    v_mul_f32 v33, v33, v34
    v_accvgpr_write_b32 a88, v33
    v_accvgpr_read_b32 v33, a89
    v_mul_f32 v33, v33, v34
    v_accvgpr_write_b32 a89, v33
    v_accvgpr_read_b32 v33, a90
    v_mul_f32 v33, v33, v34
    v_accvgpr_write_b32 a90, v33
    v_accvgpr_read_b32 v33, a91
    v_mul_f32 v33, v33, v34
    v_accvgpr_write_b32 a91, v33
    v_accvgpr_read_b32 v33, a92
    v_mul_f32 v33, v33, v34
    v_accvgpr_write_b32 a92, v33
    v_accvgpr_read_b32 v33, a93
    v_mul_f32 v33, v33, v34
    v_accvgpr_write_b32 a93, v33
    v_accvgpr_read_b32 v33, a94
    v_mul_f32 v33, v33, v34
    v_accvgpr_write_b32 a94, v33
    v_accvgpr_read_b32 v33, a95
    v_mul_f32 v33, v33, v34
    v_accvgpr_write_b32 a95, v33
    v_exp_f32 v36, v192
    v_exp_f32 v37, v193
    s_nop 0
    v_cvt_pk_bf16_f32 v232, v36, v37
    v_exp_f32 v36, v194
    v_exp_f32 v37, v195
    s_nop 0
    v_cvt_pk_bf16_f32 v233, v36, v37
    v_exp_f32 v36, v196
    v_exp_f32 v37, v197
    s_nop 0
    v_cvt_pk_bf16_f32 v234, v36, v37
    v_exp_f32 v36, v198
    v_exp_f32 v37, v199
    s_nop 0
    v_cvt_pk_bf16_f32 v235, v36, v37
    v_max3_f32 v32, v200, v201, v202
    v_max3_f32 v32, v203, v204, v32
    v_max3_f32 v32, v205, v206, v32
    v_max_f32 v32, v207, v32
    v_mov_b32 v33, v32
    s_nop 1
    v_permlane16_swap_b32 v32, v33
    s_nop 1
    v_max_f32 v32, v32, v33
    v_mov_b32 v33, v32
    s_nop 1
    v_permlane32_swap_b32 v32, v33
    s_nop 1
    v_max_f32 v32, v32, v33
    v_add_f32 v32, 0x41c00000, v32
    v_max_f32 v32, 0, v32
    v_exp_f32 v34, -v32
    v_sub_f32 v76, v76, v32
    v_sub_f32 v77, v77, v32
    v_sub_f32 v78, v78, v32
    v_sub_f32 v79, v79, v32
    v_sub_f32 v200, v200, v32
    v_sub_f32 v201, v201, v32
    v_sub_f32 v202, v202, v32
    v_sub_f32 v203, v203, v32
    v_sub_f32 v204, v204, v32
    v_sub_f32 v205, v205, v32
    v_sub_f32 v206, v206, v32
    v_sub_f32 v207, v207, v32
    v_sub_f32 v168, v168, v32
    v_sub_f32 v169, v169, v32
    v_sub_f32 v170, v170, v32
    v_sub_f32 v171, v171, v32
    v_sub_f32 v172, v172, v32
    v_sub_f32 v173, v173, v32
    v_sub_f32 v174, v174, v32
    v_sub_f32 v175, v175, v32
    v_mul_f32 v252, v252, v34
    v_mul_f32 v253, v253, v34
    v_mul_f32 v254, v254, v34
    v_mul_f32 v255, v255, v34
    v_accvgpr_read_b32 v33, a96
    v_mul_f32 v33, v33, v34
    v_accvgpr_write_b32 a96, v33
    v_accvgpr_read_b32 v33, a97
    v_mul_f32 v33, v33, v34
    v_accvgpr_write_b32 a97, v33
    v_accvgpr_read_b32 v33, a98
    v_mul_f32 v33, v33, v34
    v_accvgpr_write_b32 a98, v33
    v_accvgpr_read_b32 v33, a99
    v_mul_f32 v33, v33, v34
    v_accvgpr_write_b32 a99, v33
    v_accvgpr_read_b32 v33, a100
    v_mul_f32 v33, v33, v34
    v_accvgpr_write_b32 a100, v33
    v_accvgpr_read_b32 v33, a101
    v_mul_f32 v33, v33, v34
    v_accvgpr_write_b32 a101, v33
    v_accvgpr_read_b32 v33, a102
    v_mul_f32 v33, v33, v34
    v_accvgpr_write_b32 a102, v33
    v_accvgpr_read_b32 v33, a103
    v_mul_f32 v33, v33, v34
    v_accvgpr_write_b32 a103, v33
    v_accvgpr_read_b32 v33, a104
    v_mul_f32 v33, v33, v34
    v_accvgpr_write_b32 a104, v33
    v_accvgpr_read_b32 v33, a105
    v_mul_f32 v33, v33, v34
    v_accvgpr_write_b32 a105, v33
    v_accvgpr_read_b32 v33, a106
    v_mul_f32 v33, v33, v34
    v_accvgpr_write_b32 a106, v33
    v_accvgpr_read_b32 v33, a107
    v_mul_f32 v33, v33, v34
    v_accvgpr_write_b32 a107, v33
    v_accvgpr_read_b32 v33, a108
    v_mul_f32 v33, v33, v34
    v_accvgpr_write_b32 a108, v33
    v_accvgpr_read_b32 v33, a109
    v_mul_f32 v33, v33, v34
    v_accvgpr_write_b32 a109, v33
    v_accvgpr_read_b32 v33, a110
    v_mul_f32 v33, v33, v34
    v_accvgpr_write_b32 a110, v33
    v_accvgpr_read_b32 v33, a111
    v_mul_f32 v33, v33, v34
    v_accvgpr_write_b32 a111, v33
    v_accvgpr_read_b32 v33, a112
    v_mul_f32 v33, v33, v34
    v_accvgpr_write_b32 a112, v33
    v_accvgpr_read_b32 v33, a113
    v_mul_f32 v33, v33, v34
    v_accvgpr_write_b32 a113, v33
    v_accvgpr_read_b32 v33, a114
    v_mul_f32 v33, v33, v34
    v_accvgpr_write_b32 a114, v33
    v_accvgpr_read_b32 v33, a115
    v_mul_f32 v33, v33, v34
    v_accvgpr_write_b32 a115, v33
    v_accvgpr_read_b32 v33, a116
    v_mul_f32 v33, v33, v34
    v_accvgpr_write_b32 a116, v33
    v_accvgpr_read_b32 v33, a117
    v_mul_f32 v33, v33, v34
    v_accvgpr_write_b32 a117, v33
    v_accvgpr_read_b32 v33, a118
    v_mul_f32 v33, v33, v34
    v_accvgpr_write_b32 a118, v33
    v_accvgpr_read_b32 v33, a119
    v_mul_f32 v33, v33, v34
    v_accvgpr_write_b32 a119, v33
    v_accvgpr_read_b32 v33, a120
    v_mul_f32 v33, v33, v34
    v_accvgpr_write_b32 a120, v33
    v_accvgpr_read_b32 v33, a121
    v_mul_f32 v33, v33, v34
    v_accvgpr_write_b32 a121, v33
    v_accvgpr_read_b32 v33, a122
    v_mul_f32 v33, v33, v34
    v_accvgpr_write_b32 a122, v33
    v_accvgpr_read_b32 v33, a123
    v_mul_f32 v33, v33, v34
    v_accvgpr_write_b32 a123, v33
    v_accvgpr_read_b32 v33, a124
    v_mul_f32 v33, v33, v34
    v_accvgpr_write_b32 a124, v33
    v_accvgpr_read_b32 v33, a125
    v_mul_f32 v33, v33, v34
    v_accvgpr_write_b32 a125, v33
    v_accvgpr_read_b32 v33, a126
    v_mul_f32 v33, v33, v34
    v_accvgpr_write_b32 a126, v33
    v_accvgpr_read_b32 v33, a127
    v_mul_f32 v33, v33, v34
    v_accvgpr_write_b32 a127, v33
    v_exp_f32 v36, v200
    v_exp_f32 v37, v201
    s_nop 0
    v_cvt_pk_bf16_f32 v236, v36, v37
    v_exp_f32 v36, v202
    v_exp_f32 v37, v203
    s_nop 0
    v_cvt_pk_bf16_f32 v237, v36, v37
    v_exp_f32 v36, v204
    v_exp_f32 v37, v205
    s_nop 0
    v_cvt_pk_bf16_f32 v238, v36, v37
    v_exp_f32 v36, v206
    v_exp_f32 v37, v207
    s_nop 0
    v_cvt_pk_bf16_f32 v239, v36, v37
    s_nop 1
    s_branch gated_mix__ssm_conv_h3__compressed_kv_cla__prompt_kernel_b2_r1_ret
gated_mix__ssm_conv_h3__compressed_kv_cla__prompt_kernel_b1_r0:
    s_nop 7
    v_max3_f32 v32, v168, v169, v170
    v_max3_f32 v32, v171, v172, v32
    v_max3_f32 v32, v173, v174, v32
    v_max_f32 v32, v175, v32
    v_mov_b32 v33, v32
    s_nop 1
    v_permlane16_swap_b32 v32, v33
    s_nop 1
    v_max_f32 v32, v32, v33
    v_mov_b32 v33, v32
    s_nop 1
    v_permlane32_swap_b32 v32, v33
    s_nop 1
    v_max_f32 v32, v32, v33
    v_add_f32 v32, 0x41c00000, v32
    v_max_f32 v32, 0, v32
    v_exp_f32 v34, -v32
    v_sub_f32 v76, v76, v32
    v_sub_f32 v77, v77, v32
    v_sub_f32 v78, v78, v32
    v_sub_f32 v79, v79, v32
    v_sub_f32 v168, v168, v32
    v_sub_f32 v169, v169, v32
    v_sub_f32 v170, v170, v32
    v_sub_f32 v171, v171, v32
    v_sub_f32 v172, v172, v32
    v_sub_f32 v173, v173, v32
    v_sub_f32 v174, v174, v32
    v_sub_f32 v175, v175, v32
    v_sub_f32 v200, v200, v32
    v_sub_f32 v201, v201, v32
    v_sub_f32 v202, v202, v32
    v_sub_f32 v203, v203, v32
    v_sub_f32 v204, v204, v32
    v_sub_f32 v205, v205, v32
    v_sub_f32 v206, v206, v32
    v_sub_f32 v207, v207, v32
    v_mul_f32 v252, v252, v34
    v_mul_f32 v253, v253, v34
    v_mul_f32 v254, v254, v34
    v_mul_f32 v255, v255, v34
    v_accvgpr_read_b32 v33, a96
    v_mul_f32 v33, v33, v34
    v_accvgpr_write_b32 a96, v33
    v_accvgpr_read_b32 v33, a97
    v_mul_f32 v33, v33, v34
    v_accvgpr_write_b32 a97, v33
    v_accvgpr_read_b32 v33, a98
    v_mul_f32 v33, v33, v34
    v_accvgpr_write_b32 a98, v33
    v_accvgpr_read_b32 v33, a99
    v_mul_f32 v33, v33, v34
    v_accvgpr_write_b32 a99, v33
    v_accvgpr_read_b32 v33, a100
    v_mul_f32 v33, v33, v34
    v_accvgpr_write_b32 a100, v33
    v_accvgpr_read_b32 v33, a101
    v_mul_f32 v33, v33, v34
    v_accvgpr_write_b32 a101, v33
    v_accvgpr_read_b32 v33, a102
    v_mul_f32 v33, v33, v34
    v_accvgpr_write_b32 a102, v33
    v_accvgpr_read_b32 v33, a103
    v_mul_f32 v33, v33, v34
    v_accvgpr_write_b32 a103, v33
    v_accvgpr_read_b32 v33, a104
    v_mul_f32 v33, v33, v34
    v_accvgpr_write_b32 a104, v33
    v_accvgpr_read_b32 v33, a105
    v_mul_f32 v33, v33, v34
    v_accvgpr_write_b32 a105, v33
    v_accvgpr_read_b32 v33, a106
    v_mul_f32 v33, v33, v34
    v_accvgpr_write_b32 a106, v33
    v_accvgpr_read_b32 v33, a107
    v_mul_f32 v33, v33, v34
    v_accvgpr_write_b32 a107, v33
    v_accvgpr_read_b32 v33, a108
    v_mul_f32 v33, v33, v34
    v_accvgpr_write_b32 a108, v33
    v_accvgpr_read_b32 v33, a109
    v_mul_f32 v33, v33, v34
    v_accvgpr_write_b32 a109, v33
    v_accvgpr_read_b32 v33, a110
    v_mul_f32 v33, v33, v34
    v_accvgpr_write_b32 a110, v33
    v_accvgpr_read_b32 v33, a111
    v_mul_f32 v33, v33, v34
    v_accvgpr_write_b32 a111, v33
    v_accvgpr_read_b32 v33, a112
    v_mul_f32 v33, v33, v34
    v_accvgpr_write_b32 a112, v33
    v_accvgpr_read_b32 v33, a113
    v_mul_f32 v33, v33, v34
    v_accvgpr_write_b32 a113, v33
    v_accvgpr_read_b32 v33, a114
    v_mul_f32 v33, v33, v34
    v_accvgpr_write_b32 a114, v33
    v_accvgpr_read_b32 v33, a115
    v_mul_f32 v33, v33, v34
    v_accvgpr_write_b32 a115, v33
    v_accvgpr_read_b32 v33, a116
    v_mul_f32 v33, v33, v34
    v_accvgpr_write_b32 a116, v33
    v_accvgpr_read_b32 v33, a117
    v_mul_f32 v33, v33, v34
    v_accvgpr_write_b32 a117, v33
    v_accvgpr_read_b32 v33, a118
    v_mul_f32 v33, v33, v34
    v_accvgpr_write_b32 a118, v33
    v_accvgpr_read_b32 v33, a119
    v_mul_f32 v33, v33, v34
    v_accvgpr_write_b32 a119, v33
    v_accvgpr_read_b32 v33, a120
    v_mul_f32 v33, v33, v34
    v_accvgpr_write_b32 a120, v33
    v_accvgpr_read_b32 v33, a121
    v_mul_f32 v33, v33, v34
    v_accvgpr_write_b32 a121, v33
    v_accvgpr_read_b32 v33, a122
    v_mul_f32 v33, v33, v34
    v_accvgpr_write_b32 a122, v33
    v_accvgpr_read_b32 v33, a123
    v_mul_f32 v33, v33, v34
    v_accvgpr_write_b32 a123, v33
    v_accvgpr_read_b32 v33, a124
    v_mul_f32 v33, v33, v34
    v_accvgpr_write_b32 a124, v33
    v_accvgpr_read_b32 v33, a125
    v_mul_f32 v33, v33, v34
    v_accvgpr_write_b32 a125, v33
    v_accvgpr_read_b32 v33, a126
    v_mul_f32 v33, v33, v34
    v_accvgpr_write_b32 a126, v33
    v_accvgpr_read_b32 v33, a127
    v_mul_f32 v33, v33, v34
    v_accvgpr_write_b32 a127, v33
    v_exp_f32 v36, v168
    v_exp_f32 v37, v169
    s_nop 0
    v_cvt_pk_bf16_f32 v220, v36, v37
    v_exp_f32 v36, v170
    v_exp_f32 v37, v171
    s_nop 0
    v_cvt_pk_bf16_f32 v221, v36, v37
    v_exp_f32 v36, v172
    v_exp_f32 v37, v173
    s_nop 0
    v_cvt_pk_bf16_f32 v222, v36, v37
    v_exp_f32 v36, v174
    v_exp_f32 v37, v175
    s_nop 0
    v_cvt_pk_bf16_f32 v223, v36, v37
    s_nop 1
    s_branch gated_mix__ssm_conv_h3__compressed_kv_cla__prompt_kernel_b1_r0_ret
gated_mix__ssm_conv_h3__compressed_kv_cla__prompt_kernel_b1_r1:
    s_nop 7
    v_max3_f32 v32, v200, v201, v202
    v_max3_f32 v32, v203, v204, v32
    v_max3_f32 v32, v205, v206, v32
    v_max_f32 v32, v207, v32
    v_mov_b32 v33, v32
    s_nop 1
    v_permlane16_swap_b32 v32, v33
    s_nop 1
    v_max_f32 v32, v32, v33
    v_mov_b32 v33, v32
    s_nop 1
    v_permlane32_swap_b32 v32, v33
    s_nop 1
    v_max_f32 v32, v32, v33
    v_add_f32 v32, 0x41c00000, v32
    v_max_f32 v32, 0, v32
    v_exp_f32 v34, -v32
    v_sub_f32 v76, v76, v32
    v_sub_f32 v77, v77, v32
    v_sub_f32 v78, v78, v32
    v_sub_f32 v79, v79, v32
    v_sub_f32 v200, v200, v32
    v_sub_f32 v201, v201, v32
    v_sub_f32 v202, v202, v32
    v_sub_f32 v203, v203, v32
    v_sub_f32 v204, v204, v32
    v_sub_f32 v205, v205, v32
    v_sub_f32 v206, v206, v32
    v_sub_f32 v207, v207, v32
    v_mul_f32 v252, v252, v34
    v_mul_f32 v253, v253, v34
    v_mul_f32 v254, v254, v34
    v_mul_f32 v255, v255, v34
    v_accvgpr_read_b32 v33, a96
    v_mul_f32 v33, v33, v34
    v_accvgpr_write_b32 a96, v33
    v_accvgpr_read_b32 v33, a97
    v_mul_f32 v33, v33, v34
    v_accvgpr_write_b32 a97, v33
    v_accvgpr_read_b32 v33, a98
    v_mul_f32 v33, v33, v34
    v_accvgpr_write_b32 a98, v33
    v_accvgpr_read_b32 v33, a99
    v_mul_f32 v33, v33, v34
    v_accvgpr_write_b32 a99, v33
    v_accvgpr_read_b32 v33, a100
    v_mul_f32 v33, v33, v34
    v_accvgpr_write_b32 a100, v33
    v_accvgpr_read_b32 v33, a101
    v_mul_f32 v33, v33, v34
    v_accvgpr_write_b32 a101, v33
    v_accvgpr_read_b32 v33, a102
    v_mul_f32 v33, v33, v34
    v_accvgpr_write_b32 a102, v33
    v_accvgpr_read_b32 v33, a103
    v_mul_f32 v33, v33, v34
    v_accvgpr_write_b32 a103, v33
    v_accvgpr_read_b32 v33, a104
    v_mul_f32 v33, v33, v34
    v_accvgpr_write_b32 a104, v33
    v_accvgpr_read_b32 v33, a105
    v_mul_f32 v33, v33, v34
    v_accvgpr_write_b32 a105, v33
    v_accvgpr_read_b32 v33, a106
    v_mul_f32 v33, v33, v34
    v_accvgpr_write_b32 a106, v33
    v_accvgpr_read_b32 v33, a107
    v_mul_f32 v33, v33, v34
    v_accvgpr_write_b32 a107, v33
    v_accvgpr_read_b32 v33, a108
    v_mul_f32 v33, v33, v34
    v_accvgpr_write_b32 a108, v33
    v_accvgpr_read_b32 v33, a109
    v_mul_f32 v33, v33, v34
    v_accvgpr_write_b32 a109, v33
    v_accvgpr_read_b32 v33, a110
    v_mul_f32 v33, v33, v34
    v_accvgpr_write_b32 a110, v33
    v_accvgpr_read_b32 v33, a111
    v_mul_f32 v33, v33, v34
    v_accvgpr_write_b32 a111, v33
    v_accvgpr_read_b32 v33, a112
    v_mul_f32 v33, v33, v34
    v_accvgpr_write_b32 a112, v33
    v_accvgpr_read_b32 v33, a113
    v_mul_f32 v33, v33, v34
    v_accvgpr_write_b32 a113, v33
    v_accvgpr_read_b32 v33, a114
    v_mul_f32 v33, v33, v34
    v_accvgpr_write_b32 a114, v33
    v_accvgpr_read_b32 v33, a115
    v_mul_f32 v33, v33, v34
    v_accvgpr_write_b32 a115, v33
    v_accvgpr_read_b32 v33, a116
    v_mul_f32 v33, v33, v34
    v_accvgpr_write_b32 a116, v33
    v_accvgpr_read_b32 v33, a117
    v_mul_f32 v33, v33, v34
    v_accvgpr_write_b32 a117, v33
    v_accvgpr_read_b32 v33, a118
    v_mul_f32 v33, v33, v34
    v_accvgpr_write_b32 a118, v33
    v_accvgpr_read_b32 v33, a119
    v_mul_f32 v33, v33, v34
    v_accvgpr_write_b32 a119, v33
    v_accvgpr_read_b32 v33, a120
    v_mul_f32 v33, v33, v34
    v_accvgpr_write_b32 a120, v33
    v_accvgpr_read_b32 v33, a121
    v_mul_f32 v33, v33, v34
    v_accvgpr_write_b32 a121, v33
    v_accvgpr_read_b32 v33, a122
    v_mul_f32 v33, v33, v34
    v_accvgpr_write_b32 a122, v33
    v_accvgpr_read_b32 v33, a123
    v_mul_f32 v33, v33, v34
    v_accvgpr_write_b32 a123, v33
    v_accvgpr_read_b32 v33, a124
    v_mul_f32 v33, v33, v34
    v_accvgpr_write_b32 a124, v33
    v_accvgpr_read_b32 v33, a125
    v_mul_f32 v33, v33, v34
    v_accvgpr_write_b32 a125, v33
    v_accvgpr_read_b32 v33, a126
    v_mul_f32 v33, v33, v34
    v_accvgpr_write_b32 a126, v33
    v_accvgpr_read_b32 v33, a127
    v_mul_f32 v33, v33, v34
    v_accvgpr_write_b32 a127, v33
    v_exp_f32 v36, v200
    v_exp_f32 v37, v201
    s_nop 0
    v_cvt_pk_bf16_f32 v236, v36, v37
    v_exp_f32 v36, v202
    v_exp_f32 v37, v203
    s_nop 0
    v_cvt_pk_bf16_f32 v237, v36, v37
    v_exp_f32 v36, v204
    v_exp_f32 v37, v205
    s_nop 0
    v_cvt_pk_bf16_f32 v238, v36, v37
    v_exp_f32 v36, v206
    v_exp_f32 v37, v207
    s_nop 0
    v_cvt_pk_bf16_f32 v239, v36, v37
    s_nop 1
    s_branch gated_mix__ssm_conv_h3__compressed_kv_cla__prompt_kernel_b1_r1_ret

.section .rodata,"a"
.p2align 6
.amdhsa_kernel gated_mix__ssm_conv_h3__compressed_kv_cla__prompt_kernel
  .amdhsa_next_free_vgpr 512
  .amdhsa_next_free_sgpr 102
  .amdhsa_accum_offset 256
  .amdhsa_group_segment_fixed_size 0
  .amdhsa_kernarg_size 128
  .amdhsa_user_sgpr_count 2
  .amdhsa_user_sgpr_kernarg_segment_ptr 1
  .amdhsa_system_sgpr_workgroup_id_x 1
  .amdhsa_float_denorm_mode_32 3
.end_amdhsa_kernel
```

```asm
; @launch grid=(256,1,1) block=(256,1,1) lds=163840
.amdgcn_target "amdgcn-amd-amdhsa--gfx950"
.text
.globl gated_mix__ssm_conv_h3__compressed_kv_cla__prompt_kernel
.p2align 8
.type gated_mix__ssm_conv_h3__compressed_kv_cla__prompt_kernel,@function
gated_mix__ssm_conv_h3__compressed_kv_cla__prompt_kernel:
    s_cmp_ge_u32 s2, 256
    s_cbranch_scc1 gated_mix__ssm_conv_h3__compressed_kv_cla__prompt_kernel_end
    s_load_dwordx16 s[64:79], s[0:1], 0
    s_load_dwordx16 s[80:95], s[0:1], 64
    s_getpc_b64 s[4:5]
gated_mix__ssm_conv_h3__compressed_kv_cla__prompt_kernel_pc:
    v_lshlrev_b32 v242, 7, v0
    v_add_u32 v243, 0x8000, v242
    v_min_u32 v243, gated_mix__ssm_conv_h3__compressed_kv_cla__prompt_kernel_hotend-gated_mix__ssm_conv_h3__compressed_kv_cla__prompt_kernel_pc, v243
    global_load_dword v255, v242, s[4:5]
    global_load_dword v255, v243, s[4:5]
    v_add_u32 v244, 0x10000, v242
    v_min_u32 v244, gated_mix__ssm_conv_h3__compressed_kv_cla__prompt_kernel_hotend-gated_mix__ssm_conv_h3__compressed_kv_cla__prompt_kernel_pc, v244
    global_load_dword v255, v244, s[4:5]
    v_lshrrev_b32 v242, 6, v0
    v_and_b32 v240, 63, v0
    v_readfirstlane_b32 s32, v242
    v_lshlrev_b32 v16, 4, v240
    s_and_b32 s36, s2, 7
    s_lshl_b32 s36, s36, 2
    s_bfe_u32 s33, s2, 0x20003
    s_add_u32 s33, s33, s36
    s_lshr_b32 s34, s2, 5
    v_lshrrev_b32 v242, 3, v240
    v_and_b32 v247, 7, v240
    v_lshrrev_b32 v245, 4, v240
    v_xor_b32 v243, v245, v247
    v_lshlrev_b32 v243, 4, v243
    v_xor_b32 v244, 64, v243
    v_lshl_add_u32 v2, v242, 10, v243
    v_lshl_add_u32 v3, v242, 10, v244
    v_add_u32 v3, 7168, v3
    v_add_u32 v4, 14336, v2
    v_add_u32 v5, 14336, v3
    v_and_b32 v246, 15, v240
    v_lshlrev_b32 v247, 1, v245
    v_xor_b32 v247, v247, v246
    v_lshlrev_b32 v247, 4, v247
    v_lshl_add_u32 v21, v245, 13, v247
    s_and_b32 s36, s32, 1
    s_lshl_b32 s36, s36, 7
    v_xor_b32 v6, s36, v21
    v_add_u32 v7, 31744, v6
    s_lshl_b32 s38, s34, 18
    s_lshl_b32 s36, s32, 16
    s_add_u32 s38, s38, s36
    s_lshl_b32 s39, s33, 8
    s_add_u32 s39, s39, s36
    s_lshl_b32 s42, s32, 13
    s_lshl_b32 s43, s32, 12
    s_add_u32 s43, s43, 98304
    s_waitcnt lgkmcnt(0)
    s_mov_b32 s4, s78
    s_mov_b32 s5, s79
    s_mov_b32 s6, 2097152
    s_mov_b32 s7, 0x00020000
    s_mov_b32 s8, s82
    s_mov_b32 s9, s83
    s_mov_b32 s10, 4194304
    s_mov_b32 s11, 0x00020000
    s_mov_b32 s12, s84
    s_mov_b32 s13, s85
    s_mov_b32 s14, 4194304
    s_mov_b32 s15, 0x00020000
    s_add_u32 s35, s2, s34
    s_and_b32 s35, s35, 7
    s_lshl_b32 s58, s35, 19
    s_lshl_b32 s35, s35, 7
    s_add_u32 s59, s38, 32768
    s_add_u32 s36, s35, 0
    s_and_b32 s36, s36, 1023
    s_add_u32 s36, s36, s38
    s_add_u32 m0, s42, 0
    s_nop 0
    buffer_load_dwordx4 v2, s[4:7], s36 offen offset:0 lds
    buffer_load_dwordx4 v3, s[4:7], s36 offen offset:1024 lds
    buffer_load_dwordx4 v4, s[4:7], s36 offen offset:2048 lds
    buffer_load_dwordx4 v5, s[4:7], s36 offen offset:3072 lds
    s_add_u32 s36, s35, 0
    s_and_b32 s36, s36, 1023
    s_add_u32 s36, s36, s59
    s_add_u32 m0, s42, 4096
    s_nop 0
    buffer_load_dwordx4 v2, s[4:7], s36 offen offset:0 lds
    buffer_load_dwordx4 v3, s[4:7], s36 offen offset:1024 lds
    buffer_load_dwordx4 v4, s[4:7], s36 offen offset:2048 lds
    buffer_load_dwordx4 v5, s[4:7], s36 offen offset:3072 lds
    s_add_u32 s37, s58, 0
    s_and_b32 s37, s37, 4194303
    s_add_u32 s37, s37, s39
    s_add_u32 m0, s43, 0
    s_nop 0
    buffer_load_dwordx4 v6, s[8:11], s37 offen offset:0 lds
    buffer_load_dwordx4 v7, s[8:11], s37 offen offset:1024 lds
    s_add_u32 m0, s43, 2048
    s_nop 0
    buffer_load_dwordx4 v6, s[12:15], s37 offen offset:0 lds
    buffer_load_dwordx4 v7, s[12:15], s37 offen offset:1024 lds
    s_add_u32 s37, s58, 262144
    s_and_b32 s37, s37, 4194303
    s_add_u32 s37, s37, s39
    s_add_u32 m0, s43, 16384
    s_nop 0
    buffer_load_dwordx4 v6, s[8:11], s37 offen offset:0 lds
    buffer_load_dwordx4 v7, s[8:11], s37 offen offset:1024 lds
    s_add_u32 m0, s43, 18432
    s_nop 0
    buffer_load_dwordx4 v6, s[12:15], s37 offen offset:0 lds
    buffer_load_dwordx4 v7, s[12:15], s37 offen offset:1024 lds
    s_add_u32 s36, s35, 128
    s_and_b32 s36, s36, 1023
    s_add_u32 s36, s36, s38
    s_add_u32 m0, s42, 32768
    s_nop 0
    buffer_load_dwordx4 v2, s[4:7], s36 offen offset:0 lds
    buffer_load_dwordx4 v3, s[4:7], s36 offen offset:1024 lds
    buffer_load_dwordx4 v4, s[4:7], s36 offen offset:2048 lds
    buffer_load_dwordx4 v5, s[4:7], s36 offen offset:3072 lds
    v_lshrrev_b32 v247, 1, v246
    v_xor_b32 v247, v245, v247
    v_lshlrev_b32 v247, 4, v247
    v_lshl_add_u32 v247, v246, 7, v247
    s_lshr_b32 s36, s32, 1
    s_lshl_b32 s36, s36, 14
    v_add_u32 v8, s36, v247
    v_xor_b32 v9, 64, v8
    v_add_u32 v14, 65536, v8
    v_add_u32 v15, 65536, v9
    v_add_u32 v23, s42, v247
    v_xor_b32 v24, 64, v23
    v_add_u32 v25, 65536, v23
    v_add_u32 v26, 65536, v24
    v_lshrrev_b32 v247, 2, v246
    v_and_b32 v248, 3, v246
    v_lshlrev_b32 v248, 3, v248
    v_lshl_add_u32 v248, v247, 8, v248
    v_add_u32 v248, 98304, v248
    v_lshl_add_u32 v249, v245, 12, v248
    v_mul_u32_u24 v250, 2176, v245
    v_add_u32 v250, v250, v248
    v_xor_b32 v248, s32, v245
    v_and_b32 v248, 1, v248
    v_lshl_add_u32 v249, v248, 7, v249
    v_xor_b32 v248, 0, v247
    v_lshl_add_u32 v10, v248, 5, v249
    v_lshl_add_u32 v27, v248, 5, v250
    v_xor_b32 v248, 1, v247
    v_lshl_add_u32 v11, v248, 5, v249
    v_lshl_add_u32 v28, v248, 5, v250
    v_xor_b32 v248, 2, v247
    v_lshl_add_u32 v12, v248, 5, v249
    v_lshl_add_u32 v29, v248, 5, v250
    v_xor_b32 v248, 3, v247
    v_lshl_add_u32 v13, v248, 5, v249
    v_lshl_add_u32 v30, v248, 5, v250
    v_lshl_add_u32 v17, v242, 13, v243
    v_lshl_add_u32 v18, v242, 13, v244
    v_add_u32 v18, 64512, v18
    v_add_u32 v19, 129024, v17
    v_add_u32 v20, 129024, v18
    v_add_u32 v22, 31744, v21
    s_lshl_b32 s54, s2, 2
    s_add_u32 s54, s54, s32
    v_lshlrev_b32 v254, 7, v240
    s_lshl_b32 s46, s54, 13
    s_mov_b32 s20, s80
    s_mov_b32 s21, s81
    s_mov_b32 s22, 8388608
    s_mov_b32 s23, 0x00020000
    s_mov_b32 s24, s64
    s_mov_b32 s25, s65
    s_mov_b32 s26, 4194304
    s_mov_b32 s27, 0x00020000
    s_add_u32 s28, s94, 60817408
    s_addc_u32 s29, s95, 0
    s_mov_b32 s30, 16384
    s_mov_b32 s31, 0x00020000
    s_mov_b32 s49, s39
    s_mul_i32 s50, s32, 2176
    s_add_u32 s50, s50, 98304
    s_lshl_b32 s44, s34, 7
    s_add_u32 s44, s44, s32
    s_lshl_b32 s44, s44, 11
    s_lshl_b32 s37, s34, 1
    s_sub_u32 s45, 15, s37
    s_lshl_b32 s45, s45, 18
    s_add_u32 s45, s45, s44
    s_lshl_b32 s57, s54, 2
    s_add_u32 s57, s57, 8192
    s_lshl_b32 s36, s32, 5
    s_add_u32 s36, s36, s33
    s_lshl_b32 s36, s36, 2
    s_lshl_b32 s37, s34, 9
    s_add_u32 s55, s36, s37
    s_sub_u32 s56, 7680, s37
    s_add_u32 s56, s56, s36
    s_lshl_b32 s36, s34, 3
    s_add_u32 s36, s36, 0
    s_add_u32 s36, s36, s32
    s_lshl_b32 s36, s36, 5
    s_add_u32 s36, s36, s33
    s_lshl_b32 s60, s36, 12
    s_lshl_b32 s36, s34, 3
    s_add_u32 s36, s36, 4
    s_add_u32 s36, s36, s32
    s_lshl_b32 s36, s36, 5
    s_add_u32 s36, s36, s33
    s_lshl_b32 s61, s36, 12
    s_lshl_b32 s36, s34, 3
    s_sub_u32 s36, 120, s36
    s_add_u32 s36, s36, s32
    s_lshl_b32 s36, s36, 5
    s_add_u32 s36, s36, s33
    s_lshl_b32 s62, s36, 12
    s_lshl_b32 s36, s34, 3
    s_sub_u32 s36, 124, s36
    s_add_u32 s36, s36, s32
    s_lshl_b32 s36, s36, 5
    s_add_u32 s36, s36, s33
    s_lshl_b32 s63, s36, 12
    s_lshr_b32 s36, s2, 4
    s_lshl_b32 s36, s36, 4
    s_lshl_b32 s37, s32, 2
    s_add_u32 s36, s36, s37
    s_and_b32 s37, s2, 15
    s_lshl_b32 s37, s37, 6
    v_add_u32 v247, s36, v245
    v_lshl_add_u32 v248, v246, 2, s37
    v_lshlrev_b32 v0, 14, v247
    v_lshl_add_u32 v0, v248, 1, v0
    v_subrev_u32 v1, 6144, v0
    v_lshlrev_b32 v232, 3, v248
    v_lshlrev_b32 v233, 4, v240
    v_mul_u32_u24 v234, 4608, v248
    v_lshlrev_b32 v247, 4, v247
    v_sub_u32 v247, 4080, v247
    v_add_u32 v234, v234, v247
    v_add_u32 v235, s37, v240
    v_mul_u32_u24 v235, 4608, v235
    s_movk_i32 s47, 4096
    s_movk_i32 s48, 8192
    s_movk_i32 s51, 12288
    s_mov_b32 s52, 0xffff0000
    s_lshr_b32 s37, s2, 4
    s_or_b32 s37, s37, s32
    s_cmp_eq_u32 s37, 0
    s_cselect_b32 s53, s47, 0x80000000
    s_lshl_b32 s36, s33, 13
    s_add_u32 s40, s44, s36
    s_add_u32 s41, s45, s36
    s_waitcnt vmcnt(20)
    s_mov_b64 exec, 0
    s_cmp_eq_u32 s32, 0
    s_cbranch_scc1 gated_mix__ssm_conv_h3__compressed_kv_cla__prompt_kernel_pad0
    s_cmp_eq_u32 s32, 1
    s_cbranch_scc1 gated_mix__ssm_conv_h3__compressed_kv_cla__prompt_kernel_pad1
    s_cmp_eq_u32 s32, 2
    s_cbranch_scc1 gated_mix__ssm_conv_h3__compressed_kv_cla__prompt_kernel_pad2
    s_cmp_eq_u32 s32, 3
    s_cbranch_scc1 gated_mix__ssm_conv_h3__compressed_kv_cla__prompt_kernel_pad3
    s_branch gated_mix__ssm_conv_h3__compressed_kv_cla__prompt_kernel_body
.p2align 12
gated_mix__ssm_conv_h3__compressed_kv_cla__prompt_kernel_body:
    s_mov_b64 exec, -1
    s_waitcnt vmcnt(8)
    s_barrier
    ds_read_b64_tr_b16 v[64:65], v10 offset:0
    ds_read_b64_tr_b16 v[66:67], v10 offset:1024
    ds_read_b64_tr_b16 v[68:69], v11 offset:0
    ds_read_b64_tr_b16 v[70:71], v11 offset:1024
    ds_read_b128 v[32:35], v8 offset:0
    ds_read_b64_tr_b16 v[72:73], v12 offset:0
    ds_read_b64_tr_b16 v[74:75], v12 offset:1024
    ds_read_b128 v[36:39], v8 offset:2048
    ds_read_b64_tr_b16 v[76:77], v13 offset:0
    ds_read_b64_tr_b16 v[78:79], v13 offset:1024
    ds_read_b128 v[40:43], v8 offset:4096
    ds_read_b64_tr_b16 v[80:81], v10 offset:2048
    ds_read_b64_tr_b16 v[82:83], v10 offset:3072
    ds_read_b128 v[44:47], v8 offset:6144
    ds_read_b64_tr_b16 v[84:85], v11 offset:2048
    ds_read_b64_tr_b16 v[86:87], v11 offset:3072
    ds_read_b128 v[48:51], v8 offset:8192
    ds_read_b64_tr_b16 v[88:89], v12 offset:2048
    ds_read_b64_tr_b16 v[90:91], v12 offset:3072
    ds_read_b128 v[52:55], v8 offset:10240
    ds_read_b64_tr_b16 v[92:93], v13 offset:2048
    ds_read_b64_tr_b16 v[94:95], v13 offset:3072
    ds_read_b128 v[56:59], v8 offset:12288
    ds_read_b128 v[60:63], v8 offset:14336
    s_waitcnt vmcnt(4) lgkmcnt(0)
    s_barrier
    v_mfma_f32_16x16x32_bf16 a[0:3], v[64:67], v[32:35], 0
    ds_read_b64_tr_b16 v[128:129], v10 offset:16384
    v_mfma_f32_16x16x32_bf16 a[4:7], v[64:67], v[36:39], 0
    s_add_u32 s36, s35, 128
    s_and_b32 s36, s36, 1023
    s_add_u32 s36, s36, s59
    v_mfma_f32_16x16x32_bf16 a[8:11], v[64:67], v[40:43], 0
    s_add_u32 m0, s42, 36864
    ds_read_b64_tr_b16 v[130:131], v10 offset:17408
    v_mfma_f32_16x16x32_bf16 a[12:15], v[64:67], v[44:47], 0
    buffer_load_dwordx4 v2, s[4:7], s36 offen offset:0 lds
    v_mfma_f32_16x16x32_bf16 a[16:19], v[64:67], v[48:51], 0
    ds_read_b64_tr_b16 v[132:133], v11 offset:16384
    v_mfma_f32_16x16x32_bf16 a[20:23], v[64:67], v[52:55], 0
    v_mfma_f32_16x16x32_bf16 a[24:27], v[64:67], v[56:59], 0
    ds_read_b64_tr_b16 v[134:135], v11 offset:17408
    v_mfma_f32_16x16x32_bf16 a[28:31], v[64:67], v[60:63], 0
    buffer_load_dwordx4 v3, s[4:7], s36 offen offset:1024 lds
    v_mfma_f32_16x16x32_bf16 a[32:35], v[68:71], v[32:35], 0
    ds_read_b128 v[96:99], v9 offset:0
    v_mfma_f32_16x16x32_bf16 a[36:39], v[68:71], v[36:39], 0
    v_mfma_f32_16x16x32_bf16 a[40:43], v[68:71], v[40:43], 0
    ds_read_b64_tr_b16 v[136:137], v12 offset:16384
    v_mfma_f32_16x16x32_bf16 a[44:47], v[68:71], v[44:47], 0
    buffer_load_dwordx4 v4, s[4:7], s36 offen offset:2048 lds
    v_mfma_f32_16x16x32_bf16 a[48:51], v[68:71], v[48:51], 0
    ds_read_b64_tr_b16 v[138:139], v12 offset:17408
    v_mfma_f32_16x16x32_bf16 a[52:55], v[68:71], v[52:55], 0
    v_mfma_f32_16x16x32_bf16 a[56:59], v[68:71], v[56:59], 0
    ds_read_b128 v[100:103], v9 offset:2048
    v_mfma_f32_16x16x32_bf16 a[60:63], v[68:71], v[60:63], 0
    buffer_load_dwordx4 v5, s[4:7], s36 offen offset:3072 lds
    v_mfma_f32_16x16x32_bf16 a[64:67], v[72:75], v[32:35], 0
    ds_read_b64_tr_b16 v[140:141], v13 offset:16384
    v_mfma_f32_16x16x32_bf16 a[68:71], v[72:75], v[36:39], 0
    s_add_u32 s37, s58, 524288
    s_and_b32 s37, s37, 4194303
    s_add_u32 s37, s37, s39
    v_mfma_f32_16x16x32_bf16 a[72:75], v[72:75], v[40:43], 0
    s_add_u32 m0, s43, 32768
    ds_read_b64_tr_b16 v[142:143], v13 offset:17408
    v_mfma_f32_16x16x32_bf16 a[76:79], v[72:75], v[44:47], 0
    buffer_load_dwordx4 v6, s[8:11], s37 offen offset:0 lds
    v_mfma_f32_16x16x32_bf16 a[80:83], v[72:75], v[48:51], 0
    ds_read_b128 v[104:107], v9 offset:4096
    v_mfma_f32_16x16x32_bf16 a[84:87], v[72:75], v[52:55], 0
    v_mfma_f32_16x16x32_bf16 a[88:91], v[72:75], v[56:59], 0
    ds_read_b64_tr_b16 v[144:145], v10 offset:18432
    v_mfma_f32_16x16x32_bf16 a[92:95], v[72:75], v[60:63], 0
    buffer_load_dwordx4 v7, s[8:11], s37 offen offset:1024 lds
    v_mfma_f32_16x16x32_bf16 a[96:99], v[76:79], v[32:35], 0
    ds_read_b64_tr_b16 v[146:147], v10 offset:19456
    v_mfma_f32_16x16x32_bf16 a[100:103], v[76:79], v[36:39], 0
    v_mfma_f32_16x16x32_bf16 a[104:107], v[76:79], v[40:43], 0
    s_add_u32 m0, s43, 34816
    ds_read_b128 v[108:111], v9 offset:6144
    v_mfma_f32_16x16x32_bf16 a[108:111], v[76:79], v[44:47], 0
    buffer_load_dwordx4 v6, s[12:15], s37 offen offset:0 lds
    v_mfma_f32_16x16x32_bf16 a[112:115], v[76:79], v[48:51], 0
    ds_read_b64_tr_b16 v[148:149], v11 offset:18432
    v_mfma_f32_16x16x32_bf16 a[116:119], v[76:79], v[52:55], 0
    v_mfma_f32_16x16x32_bf16 a[120:123], v[76:79], v[56:59], 0
    ds_read_b64_tr_b16 v[150:151], v11 offset:19456
    v_mfma_f32_16x16x32_bf16 a[124:127], v[76:79], v[60:63], 0
    buffer_load_dwordx4 v7, s[12:15], s37 offen offset:1024 lds
    v_mfma_f32_16x16x32_bf16 a[128:131], v[32:35], v[80:83], 0
    ds_read_b128 v[112:115], v9 offset:8192
    v_mfma_f32_16x16x32_bf16 a[132:135], v[36:39], v[80:83], 0
    s_add_u32 s37, s58, 786432
    s_and_b32 s37, s37, 4194303
    s_add_u32 s37, s37, s39
    v_mfma_f32_16x16x32_bf16 a[136:139], v[40:43], v[80:83], 0
    s_add_u32 m0, s43, 49152
    ds_read_b64_tr_b16 v[152:153], v12 offset:18432
    v_mfma_f32_16x16x32_bf16 a[140:143], v[44:47], v[80:83], 0
    buffer_load_dwordx4 v6, s[8:11], s37 offen offset:0 lds
    v_mfma_f32_16x16x32_bf16 a[144:147], v[48:51], v[80:83], 0
    ds_read_b64_tr_b16 v[154:155], v12 offset:19456
    v_mfma_f32_16x16x32_bf16 a[148:151], v[52:55], v[80:83], 0
    v_mfma_f32_16x16x32_bf16 a[152:155], v[56:59], v[80:83], 0
    ds_read_b128 v[116:119], v9 offset:10240
    v_mfma_f32_16x16x32_bf16 a[156:159], v[60:63], v[80:83], 0
    buffer_load_dwordx4 v7, s[8:11], s37 offen offset:1024 lds
    v_mfma_f32_16x16x32_bf16 a[160:163], v[32:35], v[84:87], 0
    ds_read_b64_tr_b16 v[156:157], v13 offset:18432
    v_mfma_f32_16x16x32_bf16 a[164:167], v[36:39], v[84:87], 0
    v_mfma_f32_16x16x32_bf16 a[168:171], v[40:43], v[84:87], 0
    s_add_u32 m0, s43, 51200
    ds_read_b64_tr_b16 v[158:159], v13 offset:19456
    v_mfma_f32_16x16x32_bf16 a[172:175], v[44:47], v[84:87], 0
    buffer_load_dwordx4 v6, s[12:15], s37 offen offset:0 lds
    v_mfma_f32_16x16x32_bf16 a[176:179], v[48:51], v[84:87], 0
    ds_read_b128 v[120:123], v9 offset:12288
    v_mfma_f32_16x16x32_bf16 a[180:183], v[52:55], v[84:87], 0
    v_mfma_f32_16x16x32_bf16 a[184:187], v[56:59], v[84:87], 0
    ds_read_b128 v[124:127], v9 offset:14336
    v_mfma_f32_16x16x32_bf16 a[188:191], v[60:63], v[84:87], 0
    buffer_load_dwordx4 v7, s[12:15], s37 offen offset:1024 lds
    v_mfma_f32_16x16x32_bf16 a[192:195], v[32:35], v[88:91], 0
    v_mfma_f32_16x16x32_bf16 a[196:199], v[36:39], v[88:91], 0
    v_mfma_f32_16x16x32_bf16 a[200:203], v[40:43], v[88:91], 0
    v_mfma_f32_16x16x32_bf16 a[204:207], v[44:47], v[88:91], 0
    v_mfma_f32_16x16x32_bf16 a[208:211], v[48:51], v[88:91], 0
    v_mfma_f32_16x16x32_bf16 a[212:215], v[52:55], v[88:91], 0
    v_mfma_f32_16x16x32_bf16 a[216:219], v[56:59], v[88:91], 0
    v_mfma_f32_16x16x32_bf16 a[220:223], v[60:63], v[88:91], 0
    v_mfma_f32_16x16x32_bf16 a[224:227], v[32:35], v[92:95], 0
    v_mfma_f32_16x16x32_bf16 a[228:231], v[36:39], v[92:95], 0
    v_mfma_f32_16x16x32_bf16 a[232:235], v[40:43], v[92:95], 0
    v_mfma_f32_16x16x32_bf16 a[236:239], v[44:47], v[92:95], 0
    v_mfma_f32_16x16x32_bf16 a[240:243], v[48:51], v[92:95], 0
    v_mfma_f32_16x16x32_bf16 a[244:247], v[52:55], v[92:95], 0
    v_mfma_f32_16x16x32_bf16 a[248:251], v[56:59], v[92:95], 0
    v_mfma_f32_16x16x32_bf16 a[252:255], v[60:63], v[92:95], 0
    s_waitcnt vmcnt(4) lgkmcnt(0)
    s_barrier
    v_mfma_f32_16x16x32_bf16 a[0:3], v[128:131], v[96:99], a[0:3]
    ds_read_b64_tr_b16 v[64:65], v10 offset:32768
    v_mfma_f32_16x16x32_bf16 a[4:7], v[128:131], v[100:103], a[4:7]
    s_add_u32 s36, s35, 256
    s_and_b32 s36, s36, 1023
    s_add_u32 s36, s36, s38
    v_mfma_f32_16x16x32_bf16 a[8:11], v[128:131], v[104:107], a[8:11]
    s_add_u32 m0, s42, 65536
    ds_read_b64_tr_b16 v[66:67], v10 offset:33792
    v_mfma_f32_16x16x32_bf16 a[12:15], v[128:131], v[108:111], a[12:15]
    buffer_load_dwordx4 v2, s[4:7], s36 offen offset:0 lds
    v_mfma_f32_16x16x32_bf16 a[16:19], v[128:131], v[112:115], a[16:19]
    ds_read_b64_tr_b16 v[68:69], v11 offset:32768
    v_mfma_f32_16x16x32_bf16 a[20:23], v[128:131], v[116:119], a[20:23]
    v_mfma_f32_16x16x32_bf16 a[24:27], v[128:131], v[120:123], a[24:27]
    ds_read_b64_tr_b16 v[70:71], v11 offset:33792
    v_mfma_f32_16x16x32_bf16 a[28:31], v[128:131], v[124:127], a[28:31]
    buffer_load_dwordx4 v3, s[4:7], s36 offen offset:1024 lds
    v_mfma_f32_16x16x32_bf16 a[32:35], v[132:135], v[96:99], a[32:35]
    ds_read_b128 v[32:35], v8 offset:32768
    v_mfma_f32_16x16x32_bf16 a[36:39], v[132:135], v[100:103], a[36:39]
    v_mfma_f32_16x16x32_bf16 a[40:43], v[132:135], v[104:107], a[40:43]
    ds_read_b64_tr_b16 v[72:73], v12 offset:32768
    v_mfma_f32_16x16x32_bf16 a[44:47], v[132:135], v[108:111], a[44:47]
    buffer_load_dwordx4 v4, s[4:7], s36 offen offset:2048 lds
    v_mfma_f32_16x16x32_bf16 a[48:51], v[132:135], v[112:115], a[48:51]
    ds_read_b64_tr_b16 v[74:75], v12 offset:33792
    v_mfma_f32_16x16x32_bf16 a[52:55], v[132:135], v[116:119], a[52:55]
    v_mfma_f32_16x16x32_bf16 a[56:59], v[132:135], v[120:123], a[56:59]
    ds_read_b128 v[36:39], v8 offset:34816
    v_mfma_f32_16x16x32_bf16 a[60:63], v[132:135], v[124:127], a[60:63]
    buffer_load_dwordx4 v5, s[4:7], s36 offen offset:3072 lds
    v_mfma_f32_16x16x32_bf16 a[64:67], v[136:139], v[96:99], a[64:67]
    ds_read_b64_tr_b16 v[76:77], v13 offset:32768
    v_mfma_f32_16x16x32_bf16 a[68:71], v[136:139], v[100:103], a[68:71]
    s_add_u32 s36, s35, 256
    s_and_b32 s36, s36, 1023
    s_add_u32 s36, s36, s59
    v_mfma_f32_16x16x32_bf16 a[72:75], v[136:139], v[104:107], a[72:75]
    s_add_u32 m0, s42, 69632
    ds_read_b64_tr_b16 v[78:79], v13 offset:33792
    v_mfma_f32_16x16x32_bf16 a[76:79], v[136:139], v[108:111], a[76:79]
    buffer_load_dwordx4 v2, s[4:7], s36 offen offset:0 lds
    v_mfma_f32_16x16x32_bf16 a[80:83], v[136:139], v[112:115], a[80:83]
    ds_read_b128 v[40:43], v8 offset:36864
    v_mfma_f32_16x16x32_bf16 a[84:87], v[136:139], v[116:119], a[84:87]
    v_mfma_f32_16x16x32_bf16 a[88:91], v[136:139], v[120:123], a[88:91]
    ds_read_b64_tr_b16 v[80:81], v10 offset:34816
    v_mfma_f32_16x16x32_bf16 a[92:95], v[136:139], v[124:127], a[92:95]
    buffer_load_dwordx4 v3, s[4:7], s36 offen offset:1024 lds
    v_mfma_f32_16x16x32_bf16 a[96:99], v[140:143], v[96:99], a[96:99]
    ds_read_b64_tr_b16 v[82:83], v10 offset:35840
    v_mfma_f32_16x16x32_bf16 a[100:103], v[140:143], v[100:103], a[100:103]
    v_mfma_f32_16x16x32_bf16 a[104:107], v[140:143], v[104:107], a[104:107]
    ds_read_b128 v[44:47], v8 offset:38912
    v_mfma_f32_16x16x32_bf16 a[108:111], v[140:143], v[108:111], a[108:111]
    buffer_load_dwordx4 v4, s[4:7], s36 offen offset:2048 lds
    v_mfma_f32_16x16x32_bf16 a[112:115], v[140:143], v[112:115], a[112:115]
    ds_read_b64_tr_b16 v[84:85], v11 offset:34816
    v_mfma_f32_16x16x32_bf16 a[116:119], v[140:143], v[116:119], a[116:119]
    v_mfma_f32_16x16x32_bf16 a[120:123], v[140:143], v[120:123], a[120:123]
    ds_read_b64_tr_b16 v[86:87], v11 offset:35840
    v_mfma_f32_16x16x32_bf16 a[124:127], v[140:143], v[124:127], a[124:127]
    buffer_load_dwordx4 v5, s[4:7], s36 offen offset:3072 lds
    v_mfma_f32_16x16x32_bf16 a[128:131], v[96:99], v[144:147], a[128:131]
    ds_read_b128 v[48:51], v8 offset:40960
    v_mfma_f32_16x16x32_bf16 a[132:135], v[100:103], v[144:147], a[132:135]
    s_add_u32 s37, s58, 1048576
    s_and_b32 s37, s37, 4194303
    s_add_u32 s37, s37, s39
    v_mfma_f32_16x16x32_bf16 a[136:139], v[104:107], v[144:147], a[136:139]
    s_add_u32 m0, s43, 0
    ds_read_b64_tr_b16 v[88:89], v12 offset:34816
    v_mfma_f32_16x16x32_bf16 a[140:143], v[108:111], v[144:147], a[140:143]
    buffer_load_dwordx4 v6, s[8:11], s37 offen offset:0 lds
    v_mfma_f32_16x16x32_bf16 a[144:147], v[112:115], v[144:147], a[144:147]
    ds_read_b64_tr_b16 v[90:91], v12 offset:35840
    v_mfma_f32_16x16x32_bf16 a[148:151], v[116:119], v[144:147], a[148:151]
    v_mfma_f32_16x16x32_bf16 a[152:155], v[120:123], v[144:147], a[152:155]
    ds_read_b128 v[52:55], v8 offset:43008
    v_mfma_f32_16x16x32_bf16 a[156:159], v[124:127], v[144:147], a[156:159]
    buffer_load_dwordx4 v7, s[8:11], s37 offen offset:1024 lds
    v_mfma_f32_16x16x32_bf16 a[160:163], v[96:99], v[148:151], a[160:163]
    s_lshl_b32 s3, s33, 3
    ds_read_b64_tr_b16 v[92:93], v13 offset:34816
    v_mfma_f32_16x16x32_bf16 a[164:167], v[100:103], v[148:151], a[164:167]
    s_add_u32 s3, s3, s34
    v_mfma_f32_16x16x32_bf16 a[168:171], v[104:107], v[148:151], a[168:171]
    s_add_u32 m0, s43, 2048
    ds_read_b64_tr_b16 v[94:95], v13 offset:35840
    v_mfma_f32_16x16x32_bf16 a[172:175], v[108:111], v[148:151], a[172:175]
    buffer_load_dwordx4 v6, s[12:15], s37 offen offset:0 lds
    v_mfma_f32_16x16x32_bf16 a[176:179], v[112:115], v[148:151], a[176:179]
    s_lshl_b32 s3, s3, 2
    ds_read_b128 v[56:59], v8 offset:45056
    v_mfma_f32_16x16x32_bf16 a[180:183], v[116:119], v[148:151], a[180:183]
    s_add_u32 s3, s3, 12288
    v_mfma_f32_16x16x32_bf16 a[184:187], v[120:123], v[148:151], a[184:187]
    ds_read_b128 v[60:63], v8 offset:47104
    v_mov_b32 v241, 0
    v_mfma_f32_16x16x32_bf16 a[188:191], v[124:127], v[148:151], a[188:191]
    buffer_load_dwordx4 v7, s[12:15], s37 offen offset:1024 lds
    v_mfma_f32_16x16x32_bf16 a[192:195], v[96:99], v[152:155], a[192:195]
    s_mov_b32 s16, s66
    v_mfma_f32_16x16x32_bf16 a[196:199], v[100:103], v[152:155], a[196:199]
    s_mov_b32 s17, s67
    v_mfma_f32_16x16x32_bf16 a[200:203], v[104:107], v[152:155], a[200:203]
    s_mov_b32 s18, 4194304
    v_mfma_f32_16x16x32_bf16 a[204:207], v[108:111], v[152:155], a[204:207]
    v_mfma_f32_16x16x32_bf16 a[208:211], v[112:115], v[152:155], a[208:211]
    s_mov_b32 s19, 0x00020000
    v_mfma_f32_16x16x32_bf16 a[212:215], v[116:119], v[152:155], a[212:215]
    s_mov_b32 s76, s68
    v_mfma_f32_16x16x32_bf16 a[216:219], v[120:123], v[152:155], a[216:219]
    s_mov_b32 s77, s69
    v_mfma_f32_16x16x32_bf16 a[220:223], v[124:127], v[152:155], a[220:223]
    v_mfma_f32_16x16x32_bf16 a[224:227], v[96:99], v[156:159], a[224:227]
    s_mov_b32 s78, 4194304
    v_mfma_f32_16x16x32_bf16 a[228:231], v[100:103], v[156:159], a[228:231]
    s_mov_b32 s79, 0x00020000
    v_mfma_f32_16x16x32_bf16 a[232:235], v[104:107], v[156:159], a[232:235]
    v_mfma_f32_16x16x32_bf16 a[236:239], v[108:111], v[156:159], a[236:239]
    v_mfma_f32_16x16x32_bf16 a[240:243], v[112:115], v[156:159], a[240:243]
    v_mfma_f32_16x16x32_bf16 a[244:247], v[116:119], v[156:159], a[244:247]
    v_mfma_f32_16x16x32_bf16 a[248:251], v[120:123], v[156:159], a[248:251]
    v_mfma_f32_16x16x32_bf16 a[252:255], v[124:127], v[156:159], a[252:255]
    s_waitcnt vmcnt(12) lgkmcnt(0)
    s_barrier
    v_mfma_f32_16x16x32_bf16 a[0:3], v[64:67], v[32:35], a[0:3]
    ds_read_b64_tr_b16 v[128:129], v10 offset:49152
    v_mfma_f32_16x16x32_bf16 a[4:7], v[64:67], v[36:39], a[4:7]
    s_add_u32 s36, s35, 384
    s_and_b32 s36, s36, 1023
    s_add_u32 s36, s36, s38
    v_mfma_f32_16x16x32_bf16 a[8:11], v[64:67], v[40:43], a[8:11]
    s_add_u32 m0, s42, 0
    ds_read_b64_tr_b16 v[130:131], v10 offset:50176
    v_mfma_f32_16x16x32_bf16 a[12:15], v[64:67], v[44:47], a[12:15]
    buffer_load_dwordx4 v2, s[4:7], s36 offen offset:0 lds
    v_mfma_f32_16x16x32_bf16 a[16:19], v[64:67], v[48:51], a[16:19]
    ds_read_b64_tr_b16 v[132:133], v11 offset:49152
    v_mfma_f32_16x16x32_bf16 a[20:23], v[64:67], v[52:55], a[20:23]
    v_mfma_f32_16x16x32_bf16 a[24:27], v[64:67], v[56:59], a[24:27]
    ds_read_b64_tr_b16 v[134:135], v11 offset:50176
    v_mfma_f32_16x16x32_bf16 a[28:31], v[64:67], v[60:63], a[28:31]
    buffer_load_dwordx4 v3, s[4:7], s36 offen offset:1024 lds
    v_mfma_f32_16x16x32_bf16 a[32:35], v[68:71], v[32:35], a[32:35]
    ds_read_b128 v[96:99], v9 offset:32768
    v_mfma_f32_16x16x32_bf16 a[36:39], v[68:71], v[36:39], a[36:39]
    v_mfma_f32_16x16x32_bf16 a[40:43], v[68:71], v[40:43], a[40:43]
    ds_read_b64_tr_b16 v[136:137], v12 offset:49152
    v_mfma_f32_16x16x32_bf16 a[44:47], v[68:71], v[44:47], a[44:47]
    buffer_load_dwordx4 v4, s[4:7], s36 offen offset:2048 lds
    v_mfma_f32_16x16x32_bf16 a[48:51], v[68:71], v[48:51], a[48:51]
    ds_read_b64_tr_b16 v[138:139], v12 offset:50176
    v_mfma_f32_16x16x32_bf16 a[52:55], v[68:71], v[52:55], a[52:55]
    v_mfma_f32_16x16x32_bf16 a[56:59], v[68:71], v[56:59], a[56:59]
    ds_read_b128 v[100:103], v9 offset:34816
    v_mfma_f32_16x16x32_bf16 a[60:63], v[68:71], v[60:63], a[60:63]
    buffer_load_dwordx4 v5, s[4:7], s36 offen offset:3072 lds
    v_mfma_f32_16x16x32_bf16 a[64:67], v[72:75], v[32:35], a[64:67]
    ds_read_b64_tr_b16 v[140:141], v13 offset:49152
    v_mfma_f32_16x16x32_bf16 a[68:71], v[72:75], v[36:39], a[68:71]
    s_add_u32 s37, s58, 1310720
    s_and_b32 s37, s37, 4194303
    s_add_u32 s37, s37, s39
    v_mfma_f32_16x16x32_bf16 a[72:75], v[72:75], v[40:43], a[72:75]
    s_add_u32 m0, s43, 16384
    ds_read_b64_tr_b16 v[142:143], v13 offset:50176
    v_mfma_f32_16x16x32_bf16 a[76:79], v[72:75], v[44:47], a[76:79]
    buffer_load_dwordx4 v6, s[8:11], s37 offen offset:0 lds
    v_mfma_f32_16x16x32_bf16 a[80:83], v[72:75], v[48:51], a[80:83]
    ds_read_b128 v[104:107], v9 offset:36864
    v_mfma_f32_16x16x32_bf16 a[84:87], v[72:75], v[52:55], a[84:87]
    v_mfma_f32_16x16x32_bf16 a[88:91], v[72:75], v[56:59], a[88:91]
    ds_read_b64_tr_b16 v[144:145], v10 offset:51200
    v_mfma_f32_16x16x32_bf16 a[92:95], v[72:75], v[60:63], a[92:95]
    buffer_load_dwordx4 v7, s[8:11], s37 offen offset:1024 lds
    v_mfma_f32_16x16x32_bf16 a[96:99], v[76:79], v[32:35], a[96:99]
    ds_read_b64_tr_b16 v[146:147], v10 offset:52224
    v_mfma_f32_16x16x32_bf16 a[100:103], v[76:79], v[36:39], a[100:103]
    v_mfma_f32_16x16x32_bf16 a[104:107], v[76:79], v[40:43], a[104:107]
    s_add_u32 m0, s43, 18432
    ds_read_b128 v[108:111], v9 offset:38912
    v_mfma_f32_16x16x32_bf16 a[108:111], v[76:79], v[44:47], a[108:111]
    buffer_load_dwordx4 v6, s[12:15], s37 offen offset:0 lds
    v_mfma_f32_16x16x32_bf16 a[112:115], v[76:79], v[48:51], a[112:115]
    ds_read_b64_tr_b16 v[148:149], v11 offset:51200
    v_mfma_f32_16x16x32_bf16 a[116:119], v[76:79], v[52:55], a[116:119]
    v_mfma_f32_16x16x32_bf16 a[120:123], v[76:79], v[56:59], a[120:123]
    ds_read_b64_tr_b16 v[150:151], v11 offset:52224
    v_mfma_f32_16x16x32_bf16 a[124:127], v[76:79], v[60:63], a[124:127]
    buffer_load_dwordx4 v7, s[12:15], s37 offen offset:1024 lds
    v_mfma_f32_16x16x32_bf16 a[128:131], v[32:35], v[80:83], a[128:131]
    ds_read_b128 v[112:115], v9 offset:40960
    v_mfma_f32_16x16x32_bf16 a[132:135], v[36:39], v[80:83], a[132:135]
    s_add_u32 s36, s35, 384
    s_and_b32 s36, s36, 1023
    s_add_u32 s36, s36, s59
    v_mfma_f32_16x16x32_bf16 a[136:139], v[40:43], v[80:83], a[136:139]
    s_add_u32 m0, s42, 4096
    ds_read_b64_tr_b16 v[152:153], v12 offset:51200
    v_mfma_f32_16x16x32_bf16 a[140:143], v[44:47], v[80:83], a[140:143]
    buffer_load_dwordx4 v2, s[4:7], s36 offen offset:0 lds
    v_mfma_f32_16x16x32_bf16 a[144:147], v[48:51], v[80:83], a[144:147]
    ds_read_b64_tr_b16 v[154:155], v12 offset:52224
    v_mfma_f32_16x16x32_bf16 a[148:151], v[52:55], v[80:83], a[148:151]
    v_mfma_f32_16x16x32_bf16 a[152:155], v[56:59], v[80:83], a[152:155]
    ds_read_b128 v[116:119], v9 offset:43008
    v_mfma_f32_16x16x32_bf16 a[156:159], v[60:63], v[80:83], a[156:159]
    buffer_load_dwordx4 v3, s[4:7], s36 offen offset:1024 lds
    v_mfma_f32_16x16x32_bf16 a[160:163], v[32:35], v[84:87], a[160:163]
    ds_read_b64_tr_b16 v[156:157], v13 offset:51200
    v_mfma_f32_16x16x32_bf16 a[164:167], v[36:39], v[84:87], a[164:167]
    v_mfma_f32_16x16x32_bf16 a[168:171], v[40:43], v[84:87], a[168:171]
    ds_read_b64_tr_b16 v[158:159], v13 offset:52224
    v_mfma_f32_16x16x32_bf16 a[172:175], v[44:47], v[84:87], a[172:175]
    buffer_load_dwordx4 v4, s[4:7], s36 offen offset:2048 lds
    v_mfma_f32_16x16x32_bf16 a[176:179], v[48:51], v[84:87], a[176:179]
    ds_read_b128 v[120:123], v9 offset:45056
    v_mfma_f32_16x16x32_bf16 a[180:183], v[52:55], v[84:87], a[180:183]
    v_mfma_f32_16x16x32_bf16 a[184:187], v[56:59], v[84:87], a[184:187]
    ds_read_b128 v[124:127], v9 offset:47104
    v_mfma_f32_16x16x32_bf16 a[188:191], v[60:63], v[84:87], a[188:191]
    buffer_load_dwordx4 v5, s[4:7], s36 offen offset:3072 lds
    v_mfma_f32_16x16x32_bf16 a[192:195], v[32:35], v[88:91], a[192:195]
    v_mfma_f32_16x16x32_bf16 a[196:199], v[36:39], v[88:91], a[196:199]
    v_mfma_f32_16x16x32_bf16 a[200:203], v[40:43], v[88:91], a[200:203]
    v_mfma_f32_16x16x32_bf16 a[204:207], v[44:47], v[88:91], a[204:207]
    v_mfma_f32_16x16x32_bf16 a[208:211], v[48:51], v[88:91], a[208:211]
    v_mfma_f32_16x16x32_bf16 a[212:215], v[52:55], v[88:91], a[212:215]
    v_mfma_f32_16x16x32_bf16 a[216:219], v[56:59], v[88:91], a[216:219]
    v_mfma_f32_16x16x32_bf16 a[220:223], v[60:63], v[88:91], a[220:223]
    v_mfma_f32_16x16x32_bf16 a[224:227], v[32:35], v[92:95], a[224:227]
    v_mfma_f32_16x16x32_bf16 a[228:231], v[36:39], v[92:95], a[228:231]
    v_mfma_f32_16x16x32_bf16 a[232:235], v[40:43], v[92:95], a[232:235]
    v_mfma_f32_16x16x32_bf16 a[236:239], v[44:47], v[92:95], a[236:239]
    v_mfma_f32_16x16x32_bf16 a[240:243], v[48:51], v[92:95], a[240:243]
    v_mfma_f32_16x16x32_bf16 a[244:247], v[52:55], v[92:95], a[244:247]
    v_mfma_f32_16x16x32_bf16 a[248:251], v[56:59], v[92:95], a[248:251]
    v_mfma_f32_16x16x32_bf16 a[252:255], v[60:63], v[92:95], a[252:255]
    s_waitcnt vmcnt(12) lgkmcnt(0)
    s_barrier
    v_mfma_f32_16x16x32_bf16 a[0:3], v[128:131], v[96:99], a[0:3]
    ds_read_b64_tr_b16 v[64:65], v10 offset:0
    v_mfma_f32_16x16x32_bf16 a[4:7], v[128:131], v[100:103], a[4:7]
    s_add_u32 s37, s58, 1572864
    s_and_b32 s37, s37, 4194303
    s_add_u32 s37, s37, s39
    v_mfma_f32_16x16x32_bf16 a[8:11], v[128:131], v[104:107], a[8:11]
    s_add_u32 m0, s43, 32768
    ds_read_b64_tr_b16 v[66:67], v10 offset:1024
    v_mfma_f32_16x16x32_bf16 a[12:15], v[128:131], v[108:111], a[12:15]
    buffer_load_dwordx4 v6, s[8:11], s37 offen offset:0 lds
    v_mfma_f32_16x16x32_bf16 a[16:19], v[128:131], v[112:115], a[16:19]
    ds_read_b64_tr_b16 v[68:69], v11 offset:0
    v_mfma_f32_16x16x32_bf16 a[20:23], v[128:131], v[116:119], a[20:23]
    v_mfma_f32_16x16x32_bf16 a[24:27], v[128:131], v[120:123], a[24:27]
    ds_read_b64_tr_b16 v[70:71], v11 offset:1024
    v_mfma_f32_16x16x32_bf16 a[28:31], v[128:131], v[124:127], a[28:31]
    buffer_load_dwordx4 v7, s[8:11], s37 offen offset:1024 lds
    v_mfma_f32_16x16x32_bf16 a[32:35], v[132:135], v[96:99], a[32:35]
    ds_read_b128 v[32:35], v14 offset:0
    v_mfma_f32_16x16x32_bf16 a[36:39], v[132:135], v[100:103], a[36:39]
    v_mfma_f32_16x16x32_bf16 a[40:43], v[132:135], v[104:107], a[40:43]
    s_add_u32 m0, s43, 34816
    ds_read_b64_tr_b16 v[72:73], v12 offset:0
    v_mfma_f32_16x16x32_bf16 a[44:47], v[132:135], v[108:111], a[44:47]
    buffer_load_dwordx4 v6, s[12:15], s37 offen offset:0 lds
    v_mfma_f32_16x16x32_bf16 a[48:51], v[132:135], v[112:115], a[48:51]
    ds_read_b64_tr_b16 v[74:75], v12 offset:1024
    v_mfma_f32_16x16x32_bf16 a[52:55], v[132:135], v[116:119], a[52:55]
    v_mfma_f32_16x16x32_bf16 a[56:59], v[132:135], v[120:123], a[56:59]
    ds_read_b128 v[36:39], v14 offset:2048
    v_mfma_f32_16x16x32_bf16 a[60:63], v[132:135], v[124:127], a[60:63]
    buffer_load_dwordx4 v7, s[12:15], s37 offen offset:1024 lds
    v_mfma_f32_16x16x32_bf16 a[64:67], v[136:139], v[96:99], a[64:67]
    ds_read_b64_tr_b16 v[76:77], v13 offset:0
    v_mfma_f32_16x16x32_bf16 a[68:71], v[136:139], v[100:103], a[68:71]
    s_add_u32 s36, s35, 512
    s_and_b32 s36, s36, 1023
    s_add_u32 s36, s36, s38
    v_mfma_f32_16x16x32_bf16 a[72:75], v[136:139], v[104:107], a[72:75]
    s_add_u32 m0, s42, 32768
    ds_read_b64_tr_b16 v[78:79], v13 offset:1024
    v_mfma_f32_16x16x32_bf16 a[76:79], v[136:139], v[108:111], a[76:79]
    buffer_load_dwordx4 v2, s[4:7], s36 offen offset:0 lds
    v_mfma_f32_16x16x32_bf16 a[80:83], v[136:139], v[112:115], a[80:83]
    ds_read_b128 v[40:43], v14 offset:4096
    v_mfma_f32_16x16x32_bf16 a[84:87], v[136:139], v[116:119], a[84:87]
    v_mfma_f32_16x16x32_bf16 a[88:91], v[136:139], v[120:123], a[88:91]
    ds_read_b64_tr_b16 v[80:81], v10 offset:2048
    v_mfma_f32_16x16x32_bf16 a[92:95], v[136:139], v[124:127], a[92:95]
    buffer_load_dwordx4 v3, s[4:7], s36 offen offset:1024 lds
    v_mfma_f32_16x16x32_bf16 a[96:99], v[140:143], v[96:99], a[96:99]
    ds_read_b64_tr_b16 v[82:83], v10 offset:3072
    v_mfma_f32_16x16x32_bf16 a[100:103], v[140:143], v[100:103], a[100:103]
    v_mfma_f32_16x16x32_bf16 a[104:107], v[140:143], v[104:107], a[104:107]
    ds_read_b128 v[44:47], v14 offset:6144
    v_mfma_f32_16x16x32_bf16 a[108:111], v[140:143], v[108:111], a[108:111]
    buffer_load_dwordx4 v4, s[4:7], s36 offen offset:2048 lds
    v_mfma_f32_16x16x32_bf16 a[112:115], v[140:143], v[112:115], a[112:115]
    ds_read_b64_tr_b16 v[84:85], v11 offset:2048
    v_mfma_f32_16x16x32_bf16 a[116:119], v[140:143], v[116:119], a[116:119]
    v_mfma_f32_16x16x32_bf16 a[120:123], v[140:143], v[120:123], a[120:123]
    ds_read_b64_tr_b16 v[86:87], v11 offset:3072
    v_mfma_f32_16x16x32_bf16 a[124:127], v[140:143], v[124:127], a[124:127]
    buffer_load_dwordx4 v5, s[4:7], s36 offen offset:3072 lds
    v_mfma_f32_16x16x32_bf16 a[128:131], v[96:99], v[144:147], a[128:131]
    ds_read_b128 v[48:51], v14 offset:8192
    v_mfma_f32_16x16x32_bf16 a[132:135], v[100:103], v[144:147], a[132:135]
    s_add_u32 s37, s58, 1835008
    s_and_b32 s37, s37, 4194303
    s_add_u32 s37, s37, s39
    v_mfma_f32_16x16x32_bf16 a[136:139], v[104:107], v[144:147], a[136:139]
    s_add_u32 m0, s43, 49152
    ds_read_b64_tr_b16 v[88:89], v12 offset:2048
    v_mfma_f32_16x16x32_bf16 a[140:143], v[108:111], v[144:147], a[140:143]
    buffer_load_dwordx4 v6, s[8:11], s37 offen offset:0 lds
    v_mfma_f32_16x16x32_bf16 a[144:147], v[112:115], v[144:147], a[144:147]
    ds_read_b64_tr_b16 v[90:91], v12 offset:3072
    v_mfma_f32_16x16x32_bf16 a[148:151], v[116:119], v[144:147], a[148:151]
    v_mfma_f32_16x16x32_bf16 a[152:155], v[120:123], v[144:147], a[152:155]
    ds_read_b128 v[52:55], v14 offset:10240
    v_mfma_f32_16x16x32_bf16 a[156:159], v[124:127], v[144:147], a[156:159]
    buffer_load_dwordx4 v7, s[8:11], s37 offen offset:1024 lds
    v_mfma_f32_16x16x32_bf16 a[160:163], v[96:99], v[148:151], a[160:163]
    ds_read_b64_tr_b16 v[92:93], v13 offset:2048
    v_mfma_f32_16x16x32_bf16 a[164:167], v[100:103], v[148:151], a[164:167]
    v_mfma_f32_16x16x32_bf16 a[168:171], v[104:107], v[148:151], a[168:171]
    s_add_u32 m0, s43, 51200
    ds_read_b64_tr_b16 v[94:95], v13 offset:3072
    v_mfma_f32_16x16x32_bf16 a[172:175], v[108:111], v[148:151], a[172:175]
    buffer_load_dwordx4 v6, s[12:15], s37 offen offset:0 lds
    v_mfma_f32_16x16x32_bf16 a[176:179], v[112:115], v[148:151], a[176:179]
    ds_read_b128 v[56:59], v14 offset:12288
    v_mfma_f32_16x16x32_bf16 a[180:183], v[116:119], v[148:151], a[180:183]
    v_mfma_f32_16x16x32_bf16 a[184:187], v[120:123], v[148:151], a[184:187]
    ds_read_b128 v[60:63], v14 offset:14336
    v_mfma_f32_16x16x32_bf16 a[188:191], v[124:127], v[148:151], a[188:191]
    buffer_load_dwordx4 v7, s[12:15], s37 offen offset:1024 lds
    v_mfma_f32_16x16x32_bf16 a[192:195], v[96:99], v[152:155], a[192:195]
    v_mfma_f32_16x16x32_bf16 a[196:199], v[100:103], v[152:155], a[196:199]
    v_mfma_f32_16x16x32_bf16 a[200:203], v[104:107], v[152:155], a[200:203]
    v_mfma_f32_16x16x32_bf16 a[204:207], v[108:111], v[152:155], a[204:207]
    v_mfma_f32_16x16x32_bf16 a[208:211], v[112:115], v[152:155], a[208:211]
    v_mfma_f32_16x16x32_bf16 a[212:215], v[116:119], v[152:155], a[212:215]
    v_mfma_f32_16x16x32_bf16 a[216:219], v[120:123], v[152:155], a[216:219]
    v_mfma_f32_16x16x32_bf16 a[220:223], v[124:127], v[152:155], a[220:223]
    v_mfma_f32_16x16x32_bf16 a[224:227], v[96:99], v[156:159], a[224:227]
    v_mfma_f32_16x16x32_bf16 a[228:231], v[100:103], v[156:159], a[228:231]
    v_mfma_f32_16x16x32_bf16 a[232:235], v[104:107], v[156:159], a[232:235]
    v_mfma_f32_16x16x32_bf16 a[236:239], v[108:111], v[156:159], a[236:239]
    v_mfma_f32_16x16x32_bf16 a[240:243], v[112:115], v[156:159], a[240:243]
    v_mfma_f32_16x16x32_bf16 a[244:247], v[116:119], v[156:159], a[244:247]
    v_mfma_f32_16x16x32_bf16 a[248:251], v[120:123], v[156:159], a[248:251]
    v_mfma_f32_16x16x32_bf16 a[252:255], v[124:127], v[156:159], a[252:255]
    s_waitcnt vmcnt(16) lgkmcnt(0)
    s_barrier
    v_mfma_f32_16x16x32_bf16 a[0:3], v[64:67], v[32:35], a[0:3]
    ds_read_b64_tr_b16 v[128:129], v10 offset:16384
    v_mfma_f32_16x16x32_bf16 a[4:7], v[64:67], v[36:39], a[4:7]
    s_add_u32 s36, s35, 512
    s_and_b32 s36, s36, 1023
    s_add_u32 s36, s36, s59
    v_mfma_f32_16x16x32_bf16 a[8:11], v[64:67], v[40:43], a[8:11]
    s_add_u32 m0, s42, 36864
    ds_read_b64_tr_b16 v[130:131], v10 offset:17408
    v_mfma_f32_16x16x32_bf16 a[12:15], v[64:67], v[44:47], a[12:15]
    buffer_load_dwordx4 v2, s[4:7], s36 offen offset:0 lds
    v_mfma_f32_16x16x32_bf16 a[16:19], v[64:67], v[48:51], a[16:19]
    ds_read_b64_tr_b16 v[132:133], v11 offset:16384
    v_mfma_f32_16x16x32_bf16 a[20:23], v[64:67], v[52:55], a[20:23]
    v_mfma_f32_16x16x32_bf16 a[24:27], v[64:67], v[56:59], a[24:27]
    ds_read_b64_tr_b16 v[134:135], v11 offset:17408
    v_mfma_f32_16x16x32_bf16 a[28:31], v[64:67], v[60:63], a[28:31]
    buffer_load_dwordx4 v3, s[4:7], s36 offen offset:1024 lds
    v_mfma_f32_16x16x32_bf16 a[32:35], v[68:71], v[32:35], a[32:35]
    ds_read_b128 v[96:99], v15 offset:0
    v_mfma_f32_16x16x32_bf16 a[36:39], v[68:71], v[36:39], a[36:39]
    v_mfma_f32_16x16x32_bf16 a[40:43], v[68:71], v[40:43], a[40:43]
    ds_read_b64_tr_b16 v[136:137], v12 offset:16384
    v_mfma_f32_16x16x32_bf16 a[44:47], v[68:71], v[44:47], a[44:47]
    buffer_load_dwordx4 v4, s[4:7], s36 offen offset:2048 lds
    v_mfma_f32_16x16x32_bf16 a[48:51], v[68:71], v[48:51], a[48:51]
gated_mix__ssm_conv_h3__compressed_kv_cla__prompt_kernel_pad0:
    s_cbranch_execz gated_mix__ssm_conv_h3__compressed_kv_cla__prompt_kernel_pad4
    ds_read_b64_tr_b16 v[138:139], v12 offset:17408
    v_mfma_f32_16x16x32_bf16 a[52:55], v[68:71], v[52:55], a[52:55]
    v_mfma_f32_16x16x32_bf16 a[56:59], v[68:71], v[56:59], a[56:59]
    ds_read_b128 v[100:103], v15 offset:2048
    v_mfma_f32_16x16x32_bf16 a[60:63], v[68:71], v[60:63], a[60:63]
    buffer_load_dwordx4 v5, s[4:7], s36 offen offset:3072 lds
    v_mfma_f32_16x16x32_bf16 a[64:67], v[72:75], v[32:35], a[64:67]
    ds_read_b64_tr_b16 v[140:141], v13 offset:16384
    v_mfma_f32_16x16x32_bf16 a[68:71], v[72:75], v[36:39], a[68:71]
    s_add_u32 s37, s58, 2097152
    s_and_b32 s37, s37, 4194303
    s_add_u32 s37, s37, s39
    v_mfma_f32_16x16x32_bf16 a[72:75], v[72:75], v[40:43], a[72:75]
    s_add_u32 m0, s43, 0
    ds_read_b64_tr_b16 v[142:143], v13 offset:17408
    v_mfma_f32_16x16x32_bf16 a[76:79], v[72:75], v[44:47], a[76:79]
    buffer_load_dwordx4 v6, s[8:11], s37 offen offset:0 lds
    v_mfma_f32_16x16x32_bf16 a[80:83], v[72:75], v[48:51], a[80:83]
    ds_read_b128 v[104:107], v15 offset:4096
    v_mfma_f32_16x16x32_bf16 a[84:87], v[72:75], v[52:55], a[84:87]
    v_mfma_f32_16x16x32_bf16 a[88:91], v[72:75], v[56:59], a[88:91]
    ds_read_b64_tr_b16 v[144:145], v10 offset:18432
    v_mfma_f32_16x16x32_bf16 a[92:95], v[72:75], v[60:63], a[92:95]
    buffer_load_dwordx4 v7, s[8:11], s37 offen offset:1024 lds
    v_mfma_f32_16x16x32_bf16 a[96:99], v[76:79], v[32:35], a[96:99]
    ds_read_b64_tr_b16 v[146:147], v10 offset:19456
    v_mfma_f32_16x16x32_bf16 a[100:103], v[76:79], v[36:39], a[100:103]
    v_mfma_f32_16x16x32_bf16 a[104:107], v[76:79], v[40:43], a[104:107]
    s_add_u32 m0, s43, 2048
    ds_read_b128 v[108:111], v15 offset:6144
    v_mfma_f32_16x16x32_bf16 a[108:111], v[76:79], v[44:47], a[108:111]
    buffer_load_dwordx4 v6, s[12:15], s37 offen offset:0 lds
    v_mfma_f32_16x16x32_bf16 a[112:115], v[76:79], v[48:51], a[112:115]
    ds_read_b64_tr_b16 v[148:149], v11 offset:18432
    v_mfma_f32_16x16x32_bf16 a[116:119], v[76:79], v[52:55], a[116:119]
    v_mfma_f32_16x16x32_bf16 a[120:123], v[76:79], v[56:59], a[120:123]
    ds_read_b64_tr_b16 v[150:151], v11 offset:19456
    v_mfma_f32_16x16x32_bf16 a[124:127], v[76:79], v[60:63], a[124:127]
    buffer_load_dwordx4 v7, s[12:15], s37 offen offset:1024 lds
    v_mfma_f32_16x16x32_bf16 a[128:131], v[32:35], v[80:83], a[128:131]
    ds_read_b128 v[112:115], v15 offset:8192
    v_mfma_f32_16x16x32_bf16 a[132:135], v[36:39], v[80:83], a[132:135]
    buffer_load_dwordx2 v[160:161], v1, s[16:19], 0 offen offset:0
    v_mfma_f32_16x16x32_bf16 a[136:139], v[40:43], v[80:83], a[136:139]
    ds_read_b64_tr_b16 v[152:153], v12 offset:18432
    v_mfma_f32_16x16x32_bf16 a[140:143], v[44:47], v[80:83], a[140:143]
    buffer_load_dwordx2 v[162:163], v1, s[16:19], 0 offen offset:2048
    v_mfma_f32_16x16x32_bf16 a[144:147], v[48:51], v[80:83], a[144:147]
    ds_read_b64_tr_b16 v[154:155], v12 offset:19456
    v_mfma_f32_16x16x32_bf16 a[148:151], v[52:55], v[80:83], a[148:151]
    buffer_load_dwordx2 v[164:165], v1, s[16:19], s47 offen offset:0
    v_mfma_f32_16x16x32_bf16 a[152:155], v[56:59], v[80:83], a[152:155]
    ds_read_b128 v[116:119], v15 offset:10240
    v_mfma_f32_16x16x32_bf16 a[156:159], v[60:63], v[80:83], a[156:159]
    buffer_load_dwordx2 v[166:167], v0, s[16:19], 0 offen offset:0
    v_mfma_f32_16x16x32_bf16 a[160:163], v[32:35], v[84:87], a[160:163]
    ds_read_b64_tr_b16 v[156:157], v13 offset:18432
    v_mfma_f32_16x16x32_bf16 a[164:167], v[36:39], v[84:87], a[164:167]
    buffer_load_dwordx2 v[168:169], v0, s[16:19], 0 offen offset:2048
    v_mfma_f32_16x16x32_bf16 a[168:171], v[40:43], v[84:87], a[168:171]
    ds_read_b64_tr_b16 v[158:159], v13 offset:19456
    v_mfma_f32_16x16x32_bf16 a[172:175], v[44:47], v[84:87], a[172:175]
    buffer_load_dwordx2 v[170:171], v0, s[16:19], s47 offen offset:0
    v_mfma_f32_16x16x32_bf16 a[176:179], v[48:51], v[84:87], a[176:179]
    ds_read_b128 v[120:123], v15 offset:12288
    v_mfma_f32_16x16x32_bf16 a[180:183], v[52:55], v[84:87], a[180:183]
    buffer_load_dwordx2 v[172:173], v0, s[16:19], s47 offen offset:2048
    v_mfma_f32_16x16x32_bf16 a[184:187], v[56:59], v[84:87], a[184:187]
    ds_read_b128 v[124:127], v15 offset:14336
    v_mfma_f32_16x16x32_bf16 a[188:191], v[60:63], v[84:87], a[188:191]
    buffer_load_dwordx2 v[174:175], v0, s[16:19], s48 offen offset:0
    v_mfma_f32_16x16x32_bf16 a[192:195], v[32:35], v[88:91], a[192:195]
    buffer_load_dwordx2 v[176:177], v0, s[16:19], s48 offen offset:2048
    v_mfma_f32_16x16x32_bf16 a[196:199], v[36:39], v[88:91], a[196:199]
    buffer_load_dwordx2 v[178:179], v0, s[16:19], s51 offen offset:0
    v_mfma_f32_16x16x32_bf16 a[200:203], v[40:43], v[88:91], a[200:203]
    buffer_load_dwordx2 v[180:181], v0, s[16:19], s51 offen offset:2048
    v_mfma_f32_16x16x32_bf16 a[204:207], v[44:47], v[88:91], a[204:207]
    buffer_load_dwordx2 v[182:183], v0, s[76:79], 0 offen offset:0
    v_mfma_f32_16x16x32_bf16 a[208:211], v[48:51], v[88:91], a[208:211]
    buffer_load_dwordx2 v[184:185], v0, s[76:79], 0 offen offset:2048
    v_mfma_f32_16x16x32_bf16 a[212:215], v[52:55], v[88:91], a[212:215]
    buffer_load_dwordx2 v[186:187], v0, s[76:79], s47 offen offset:0
    v_mfma_f32_16x16x32_bf16 a[216:219], v[56:59], v[88:91], a[216:219]
    buffer_load_dwordx2 v[188:189], v0, s[76:79], s47 offen offset:2048
    v_mfma_f32_16x16x32_bf16 a[220:223], v[60:63], v[88:91], a[220:223]
    buffer_load_dwordx2 v[190:191], v0, s[76:79], s48 offen offset:0
    v_mfma_f32_16x16x32_bf16 a[224:227], v[32:35], v[92:95], a[224:227]
    buffer_load_dwordx2 v[192:193], v0, s[76:79], s48 offen offset:2048
    v_mfma_f32_16x16x32_bf16 a[228:231], v[36:39], v[92:95], a[228:231]
    buffer_load_dwordx2 v[194:195], v0, s[76:79], s51 offen offset:0
    v_mfma_f32_16x16x32_bf16 a[232:235], v[40:43], v[92:95], a[232:235]
    buffer_load_dwordx2 v[196:197], v0, s[76:79], s51 offen offset:2048
    v_mfma_f32_16x16x32_bf16 a[236:239], v[44:47], v[92:95], a[236:239]
    v_mfma_f32_16x16x32_bf16 a[240:243], v[48:51], v[92:95], a[240:243]
    v_mfma_f32_16x16x32_bf16 a[244:247], v[52:55], v[92:95], a[244:247]
    v_mfma_f32_16x16x32_bf16 a[248:251], v[56:59], v[92:95], a[248:251]
    v_mfma_f32_16x16x32_bf16 a[252:255], v[60:63], v[92:95], a[252:255]
    s_waitcnt vmcnt(35) lgkmcnt(0)
    s_barrier
    v_mfma_f32_16x16x32_bf16 a[0:3], v[128:131], v[96:99], a[0:3]
    s_mov_b32 s16, s88
    ds_read_b64_tr_b16 v[64:65], v10 offset:32768
    v_mfma_f32_16x16x32_bf16 a[4:7], v[128:131], v[100:103], a[4:7]
    s_add_u32 s36, s35, 640
    s_and_b32 s36, s36, 1023
    s_add_u32 s36, s36, s38
    v_mfma_f32_16x16x32_bf16 a[8:11], v[128:131], v[104:107], a[8:11]
    s_add_u32 m0, s42, 65536
    ds_read_b64_tr_b16 v[66:67], v10 offset:33792
    v_mfma_f32_16x16x32_bf16 a[12:15], v[128:131], v[108:111], a[12:15]
    buffer_load_dwordx4 v2, s[4:7], s36 offen offset:0 lds
    v_mfma_f32_16x16x32_bf16 a[16:19], v[128:131], v[112:115], a[16:19]
    s_mov_b32 s17, s89
    ds_read_b64_tr_b16 v[68:69], v11 offset:32768
    v_mfma_f32_16x16x32_bf16 a[20:23], v[128:131], v[116:119], a[20:23]
    s_mov_b32 s18, 2048
    v_mfma_f32_16x16x32_bf16 a[24:27], v[128:131], v[120:123], a[24:27]
    s_mov_b32 s76, s70
    ds_read_b64_tr_b16 v[70:71], v11 offset:33792
    v_mfma_f32_16x16x32_bf16 a[28:31], v[128:131], v[124:127], a[28:31]
    buffer_load_dwordx4 v3, s[4:7], s36 offen offset:1024 lds
    v_mfma_f32_16x16x32_bf16 a[32:35], v[132:135], v[96:99], a[32:35]
    s_mov_b32 s77, s71
    ds_read_b128 v[32:35], v8 offset:0
    v_mfma_f32_16x16x32_bf16 a[36:39], v[132:135], v[100:103], a[36:39]
    s_mov_b32 s78, 8192
    v_mfma_f32_16x16x32_bf16 a[40:43], v[132:135], v[104:107], a[40:43]
    ds_read_b64_tr_b16 v[72:73], v12 offset:32768
    v_mfma_f32_16x16x32_bf16 a[44:47], v[132:135], v[108:111], a[44:47]
    buffer_load_dwordx4 v4, s[4:7], s36 offen offset:2048 lds
    v_mfma_f32_16x16x32_bf16 a[48:51], v[132:135], v[112:115], a[48:51]
    ds_read_b64_tr_b16 v[74:75], v12 offset:33792
    v_mfma_f32_16x16x32_bf16 a[52:55], v[132:135], v[116:119], a[52:55]
    v_mfma_f32_16x16x32_bf16 a[56:59], v[132:135], v[120:123], a[56:59]
    ds_read_b128 v[36:39], v8 offset:2048
    v_mfma_f32_16x16x32_bf16 a[60:63], v[132:135], v[124:127], a[60:63]
    buffer_load_dwordx4 v5, s[4:7], s36 offen offset:3072 lds
    v_mfma_f32_16x16x32_bf16 a[64:67], v[136:139], v[96:99], a[64:67]
    ds_read_b64_tr_b16 v[76:77], v13 offset:32768
    v_mfma_f32_16x16x32_bf16 a[68:71], v[136:139], v[100:103], a[68:71]
    s_add_u32 s37, s58, 2359296
    s_and_b32 s37, s37, 4194303
    s_add_u32 s37, s37, s39
    v_mfma_f32_16x16x32_bf16 a[72:75], v[136:139], v[104:107], a[72:75]
    s_add_u32 m0, s43, 16384
    ds_read_b64_tr_b16 v[78:79], v13 offset:33792
    v_mfma_f32_16x16x32_bf16 a[76:79], v[136:139], v[108:111], a[76:79]
    buffer_load_dwordx4 v6, s[8:11], s37 offen offset:0 lds
    v_mfma_f32_16x16x32_bf16 a[80:83], v[136:139], v[112:115], a[80:83]
    ds_read_b128 v[40:43], v8 offset:4096
    v_mfma_f32_16x16x32_bf16 a[84:87], v[136:139], v[116:119], a[84:87]
    v_mfma_f32_16x16x32_bf16 a[88:91], v[136:139], v[120:123], a[88:91]
    ds_read_b64_tr_b16 v[80:81], v10 offset:34816
    v_mfma_f32_16x16x32_bf16 a[92:95], v[136:139], v[124:127], a[92:95]
    buffer_load_dwordx4 v7, s[8:11], s37 offen offset:1024 lds
    v_mfma_f32_16x16x32_bf16 a[96:99], v[140:143], v[96:99], a[96:99]
    ds_read_b64_tr_b16 v[82:83], v10 offset:35840
    v_mfma_f32_16x16x32_bf16 a[100:103], v[140:143], v[100:103], a[100:103]
    v_mfma_f32_16x16x32_bf16 a[104:107], v[140:143], v[104:107], a[104:107]
    s_add_u32 m0, s43, 18432
    ds_read_b128 v[44:47], v8 offset:6144
    v_mfma_f32_16x16x32_bf16 a[108:111], v[140:143], v[108:111], a[108:111]
    buffer_load_dwordx4 v6, s[12:15], s37 offen offset:0 lds
    v_mfma_f32_16x16x32_bf16 a[112:115], v[140:143], v[112:115], a[112:115]
    ds_read_b64_tr_b16 v[84:85], v11 offset:34816
    v_mfma_f32_16x16x32_bf16 a[116:119], v[140:143], v[116:119], a[116:119]
    v_mfma_f32_16x16x32_bf16 a[120:123], v[140:143], v[120:123], a[120:123]
    ds_read_b64_tr_b16 v[86:87], v11 offset:35840
    v_mfma_f32_16x16x32_bf16 a[124:127], v[140:143], v[124:127], a[124:127]
    buffer_load_dwordx4 v7, s[12:15], s37 offen offset:1024 lds
    v_mfma_f32_16x16x32_bf16 a[128:131], v[96:99], v[144:147], a[128:131]
    ds_read_b128 v[48:51], v8 offset:8192
    v_mfma_f32_16x16x32_bf16 a[132:135], v[100:103], v[144:147], a[132:135]
    v_mfma_f32_16x16x32_bf16 a[136:139], v[104:107], v[144:147], a[136:139]
    ds_read_b64_tr_b16 v[88:89], v12 offset:34816
    v_mfma_f32_16x16x32_bf16 a[140:143], v[108:111], v[144:147], a[140:143]
    v_mfma_f32_16x16x32_bf16 a[144:147], v[112:115], v[144:147], a[144:147]
    ds_read_b64_tr_b16 v[90:91], v12 offset:35840
    v_mfma_f32_16x16x32_bf16 a[148:151], v[116:119], v[144:147], a[148:151]
    v_mfma_f32_16x16x32_bf16 a[152:155], v[120:123], v[144:147], a[152:155]
    ds_read_b128 v[52:55], v8 offset:10240
    v_mfma_f32_16x16x32_bf16 a[156:159], v[124:127], v[144:147], a[156:159]
    v_mfma_f32_16x16x32_bf16 a[160:163], v[96:99], v[148:151], a[160:163]
    ds_read_b64_tr_b16 v[92:93], v13 offset:34816
    v_mfma_f32_16x16x32_bf16 a[164:167], v[100:103], v[148:151], a[164:167]
    v_mfma_f32_16x16x32_bf16 a[168:171], v[104:107], v[148:151], a[168:171]
    ds_read_b64_tr_b16 v[94:95], v13 offset:35840
    v_mfma_f32_16x16x32_bf16 a[172:175], v[108:111], v[148:151], a[172:175]
    v_mfma_f32_16x16x32_bf16 a[176:179], v[112:115], v[148:151], a[176:179]
    ds_read_b128 v[56:59], v8 offset:12288
    v_mfma_f32_16x16x32_bf16 a[180:183], v[116:119], v[148:151], a[180:183]
    v_mfma_f32_16x16x32_bf16 a[184:187], v[120:123], v[148:151], a[184:187]
    ds_read_b128 v[60:63], v8 offset:14336
    v_mfma_f32_16x16x32_bf16 a[188:191], v[124:127], v[148:151], a[188:191]
    v_mfma_f32_16x16x32_bf16 a[192:195], v[96:99], v[152:155], a[192:195]
    v_mfma_f32_16x16x32_bf16 a[196:199], v[100:103], v[152:155], a[196:199]
    v_mfma_f32_16x16x32_bf16 a[200:203], v[104:107], v[152:155], a[200:203]
    v_mfma_f32_16x16x32_bf16 a[204:207], v[108:111], v[152:155], a[204:207]
    v_mfma_f32_16x16x32_bf16 a[208:211], v[112:115], v[152:155], a[208:211]
    v_mfma_f32_16x16x32_bf16 a[212:215], v[116:119], v[152:155], a[212:215]
    v_mfma_f32_16x16x32_bf16 a[216:219], v[120:123], v[152:155], a[216:219]
    v_mfma_f32_16x16x32_bf16 a[220:223], v[124:127], v[152:155], a[220:223]
    v_mfma_f32_16x16x32_bf16 a[224:227], v[96:99], v[156:159], a[224:227]
    v_mfma_f32_16x16x32_bf16 a[228:231], v[100:103], v[156:159], a[228:231]
    v_mfma_f32_16x16x32_bf16 a[232:235], v[104:107], v[156:159], a[232:235]
    v_mfma_f32_16x16x32_bf16 a[236:239], v[108:111], v[156:159], a[236:239]
    v_mfma_f32_16x16x32_bf16 a[240:243], v[112:115], v[156:159], a[240:243]
    v_mfma_f32_16x16x32_bf16 a[244:247], v[116:119], v[156:159], a[244:247]
    v_mfma_f32_16x16x32_bf16 a[248:251], v[120:123], v[156:159], a[248:251]
    v_mfma_f32_16x16x32_bf16 a[252:255], v[124:127], v[156:159], a[252:255]
    s_waitcnt vmcnt(35) lgkmcnt(0)
    s_barrier
    v_mfma_f32_16x16x32_bf16 a[0:3], v[64:67], v[32:35], a[0:3]
    ds_read_b64_tr_b16 v[128:129], v10 offset:49152
    v_mfma_f32_16x16x32_bf16 a[4:7], v[64:67], v[36:39], a[4:7]
    s_add_u32 s36, s35, 640
    s_and_b32 s36, s36, 1023
    s_add_u32 s36, s36, s59
    v_mfma_f32_16x16x32_bf16 a[8:11], v[64:67], v[40:43], a[8:11]
    s_add_u32 m0, s42, 69632
    ds_read_b64_tr_b16 v[130:131], v10 offset:50176
    v_mfma_f32_16x16x32_bf16 a[12:15], v[64:67], v[44:47], a[12:15]
    buffer_load_dwordx4 v2, s[4:7], s36 offen offset:0 lds
    v_mfma_f32_16x16x32_bf16 a[16:19], v[64:67], v[48:51], a[16:19]
    ds_read_b64_tr_b16 v[132:133], v11 offset:49152
    v_mfma_f32_16x16x32_bf16 a[20:23], v[64:67], v[52:55], a[20:23]
    v_mfma_f32_16x16x32_bf16 a[24:27], v[64:67], v[56:59], a[24:27]
    ds_read_b64_tr_b16 v[134:135], v11 offset:50176
    v_mfma_f32_16x16x32_bf16 a[28:31], v[64:67], v[60:63], a[28:31]
    buffer_load_dwordx4 v3, s[4:7], s36 offen offset:1024 lds
    v_mfma_f32_16x16x32_bf16 a[32:35], v[68:71], v[32:35], a[32:35]
    ds_read_b128 v[96:99], v9 offset:0
    v_mfma_f32_16x16x32_bf16 a[36:39], v[68:71], v[36:39], a[36:39]
    v_mfma_f32_16x16x32_bf16 a[40:43], v[68:71], v[40:43], a[40:43]
    ds_read_b64_tr_b16 v[136:137], v12 offset:49152
    v_mfma_f32_16x16x32_bf16 a[44:47], v[68:71], v[44:47], a[44:47]
    buffer_load_dwordx4 v4, s[4:7], s36 offen offset:2048 lds
    v_mfma_f32_16x16x32_bf16 a[48:51], v[68:71], v[48:51], a[48:51]
    ds_read_b64_tr_b16 v[138:139], v12 offset:50176
    v_mfma_f32_16x16x32_bf16 a[52:55], v[68:71], v[52:55], a[52:55]
    v_mfma_f32_16x16x32_bf16 a[56:59], v[68:71], v[56:59], a[56:59]
    ds_read_b128 v[100:103], v9 offset:2048
    v_mfma_f32_16x16x32_bf16 a[60:63], v[68:71], v[60:63], a[60:63]
    buffer_load_dwordx4 v5, s[4:7], s36 offen offset:3072 lds
    v_mfma_f32_16x16x32_bf16 a[64:67], v[72:75], v[32:35], a[64:67]
    ds_read_b64_tr_b16 v[140:141], v13 offset:49152
    v_mfma_f32_16x16x32_bf16 a[68:71], v[72:75], v[36:39], a[68:71]
    s_add_u32 s37, s58, 2621440
    s_and_b32 s37, s37, 4194303
    s_add_u32 s37, s37, s39
    v_mfma_f32_16x16x32_bf16 a[72:75], v[72:75], v[40:43], a[72:75]
    s_add_u32 m0, s43, 32768
    ds_read_b64_tr_b16 v[142:143], v13 offset:50176
    v_mfma_f32_16x16x32_bf16 a[76:79], v[72:75], v[44:47], a[76:79]
    buffer_load_dwordx4 v6, s[8:11], s37 offen offset:0 lds
    v_mfma_f32_16x16x32_bf16 a[80:83], v[72:75], v[48:51], a[80:83]
    ds_read_b128 v[104:107], v9 offset:4096
    v_mfma_f32_16x16x32_bf16 a[84:87], v[72:75], v[52:55], a[84:87]
    v_mfma_f32_16x16x32_bf16 a[88:91], v[72:75], v[56:59], a[88:91]
    ds_read_b64_tr_b16 v[144:145], v10 offset:51200
    v_mfma_f32_16x16x32_bf16 a[92:95], v[72:75], v[60:63], a[92:95]
    buffer_load_dwordx4 v7, s[8:11], s37 offen offset:1024 lds
    v_mfma_f32_16x16x32_bf16 a[96:99], v[76:79], v[32:35], a[96:99]
    ds_read_b64_tr_b16 v[146:147], v10 offset:52224
    v_mfma_f32_16x16x32_bf16 a[100:103], v[76:79], v[36:39], a[100:103]
    v_mfma_f32_16x16x32_bf16 a[104:107], v[76:79], v[40:43], a[104:107]
    s_add_u32 m0, s43, 34816
    ds_read_b128 v[108:111], v9 offset:6144
    v_mfma_f32_16x16x32_bf16 a[108:111], v[76:79], v[44:47], a[108:111]
    buffer_load_dwordx4 v6, s[12:15], s37 offen offset:0 lds
    v_mfma_f32_16x16x32_bf16 a[112:115], v[76:79], v[48:51], a[112:115]
    ds_read_b64_tr_b16 v[148:149], v11 offset:51200
    v_mfma_f32_16x16x32_bf16 a[116:119], v[76:79], v[52:55], a[116:119]
    v_mfma_f32_16x16x32_bf16 a[120:123], v[76:79], v[56:59], a[120:123]
    ds_read_b64_tr_b16 v[150:151], v11 offset:52224
    v_mfma_f32_16x16x32_bf16 a[124:127], v[76:79], v[60:63], a[124:127]
    buffer_load_dwordx4 v7, s[12:15], s37 offen offset:1024 lds
    v_mfma_f32_16x16x32_bf16 a[128:131], v[32:35], v[80:83], a[128:131]
    ds_read_b128 v[112:115], v9 offset:8192
    v_mfma_f32_16x16x32_bf16 a[132:135], v[36:39], v[80:83], a[132:135]
    v_mfma_f32_16x16x32_bf16 a[136:139], v[40:43], v[80:83], a[136:139]
    ds_read_b64_tr_b16 v[152:153], v12 offset:51200
    v_mfma_f32_16x16x32_bf16 a[140:143], v[44:47], v[80:83], a[140:143]
    v_mfma_f32_16x16x32_bf16 a[144:147], v[48:51], v[80:83], a[144:147]
    ds_read_b64_tr_b16 v[154:155], v12 offset:52224
    v_mfma_f32_16x16x32_bf16 a[148:151], v[52:55], v[80:83], a[148:151]
    v_mfma_f32_16x16x32_bf16 a[152:155], v[56:59], v[80:83], a[152:155]
    ds_read_b128 v[116:119], v9 offset:10240
    v_mfma_f32_16x16x32_bf16 a[156:159], v[60:63], v[80:83], a[156:159]
    v_mfma_f32_16x16x32_bf16 a[160:163], v[32:35], v[84:87], a[160:163]
    ds_read_b64_tr_b16 v[156:157], v13 offset:51200
    v_mfma_f32_16x16x32_bf16 a[164:167], v[36:39], v[84:87], a[164:167]
    v_mfma_f32_16x16x32_bf16 a[168:171], v[40:43], v[84:87], a[168:171]
    ds_read_b64_tr_b16 v[158:159], v13 offset:52224
    v_mfma_f32_16x16x32_bf16 a[172:175], v[44:47], v[84:87], a[172:175]
    v_mfma_f32_16x16x32_bf16 a[176:179], v[48:51], v[84:87], a[176:179]
    ds_read_b128 v[120:123], v9 offset:12288
    v_mfma_f32_16x16x32_bf16 a[180:183], v[52:55], v[84:87], a[180:183]
    v_mfma_f32_16x16x32_bf16 a[184:187], v[56:59], v[84:87], a[184:187]
    ds_read_b128 v[124:127], v9 offset:14336
    v_mfma_f32_16x16x32_bf16 a[188:191], v[60:63], v[84:87], a[188:191]
    v_mfma_f32_16x16x32_bf16 a[192:195], v[32:35], v[88:91], a[192:195]
    v_mfma_f32_16x16x32_bf16 a[196:199], v[36:39], v[88:91], a[196:199]
    v_mfma_f32_16x16x32_bf16 a[200:203], v[40:43], v[88:91], a[200:203]
    v_mfma_f32_16x16x32_bf16 a[204:207], v[44:47], v[88:91], a[204:207]
    v_mfma_f32_16x16x32_bf16 a[208:211], v[48:51], v[88:91], a[208:211]
    v_mfma_f32_16x16x32_bf16 a[212:215], v[52:55], v[88:91], a[212:215]
    v_mfma_f32_16x16x32_bf16 a[216:219], v[56:59], v[88:91], a[216:219]
    v_mfma_f32_16x16x32_bf16 a[220:223], v[60:63], v[88:91], a[220:223]
    v_mfma_f32_16x16x32_bf16 a[224:227], v[32:35], v[92:95], a[224:227]
    v_mfma_f32_16x16x32_bf16 a[228:231], v[36:39], v[92:95], a[228:231]
    v_mfma_f32_16x16x32_bf16 a[232:235], v[40:43], v[92:95], a[232:235]
    v_mfma_f32_16x16x32_bf16 a[236:239], v[44:47], v[92:95], a[236:239]
    v_mfma_f32_16x16x32_bf16 a[240:243], v[48:51], v[92:95], a[240:243]
    v_mfma_f32_16x16x32_bf16 a[244:247], v[52:55], v[92:95], a[244:247]
    v_mfma_f32_16x16x32_bf16 a[248:251], v[56:59], v[92:95], a[248:251]
    v_mfma_f32_16x16x32_bf16 a[252:255], v[60:63], v[92:95], a[252:255]
    s_waitcnt vmcnt(35) lgkmcnt(0)
    s_barrier
    v_mfma_f32_16x16x32_bf16 a[0:3], v[128:131], v[96:99], a[0:3]
    ds_read_b64_tr_b16 v[64:65], v10 offset:0
    v_mfma_f32_16x16x32_bf16 a[4:7], v[128:131], v[100:103], a[4:7]
    s_add_u32 s36, s35, 768
    s_and_b32 s36, s36, 1023
    s_add_u32 s36, s36, s38
    v_mfma_f32_16x16x32_bf16 a[8:11], v[128:131], v[104:107], a[8:11]
    s_add_u32 m0, s42, 0
    ds_read_b64_tr_b16 v[66:67], v10 offset:1024
    v_mfma_f32_16x16x32_bf16 a[12:15], v[128:131], v[108:111], a[12:15]
    buffer_load_dwordx4 v2, s[4:7], s36 offen offset:0 lds
    v_mfma_f32_16x16x32_bf16 a[16:19], v[128:131], v[112:115], a[16:19]
    ds_read_b64_tr_b16 v[68:69], v11 offset:0
    v_mfma_f32_16x16x32_bf16 a[20:23], v[128:131], v[116:119], a[20:23]
    v_mfma_f32_16x16x32_bf16 a[24:27], v[128:131], v[120:123], a[24:27]
    ds_read_b64_tr_b16 v[70:71], v11 offset:1024
    v_mfma_f32_16x16x32_bf16 a[28:31], v[128:131], v[124:127], a[28:31]
    buffer_load_dwordx4 v3, s[4:7], s36 offen offset:1024 lds
    v_mfma_f32_16x16x32_bf16 a[32:35], v[132:135], v[96:99], a[32:35]
    ds_read_b128 v[32:35], v8 offset:32768
    v_mfma_f32_16x16x32_bf16 a[36:39], v[132:135], v[100:103], a[36:39]
    v_mfma_f32_16x16x32_bf16 a[40:43], v[132:135], v[104:107], a[40:43]
    ds_read_b64_tr_b16 v[72:73], v12 offset:0
    v_mfma_f32_16x16x32_bf16 a[44:47], v[132:135], v[108:111], a[44:47]
    buffer_load_dwordx4 v4, s[4:7], s36 offen offset:2048 lds
    v_mfma_f32_16x16x32_bf16 a[48:51], v[132:135], v[112:115], a[48:51]
    ds_read_b64_tr_b16 v[74:75], v12 offset:1024
    v_mfma_f32_16x16x32_bf16 a[52:55], v[132:135], v[116:119], a[52:55]
    v_mfma_f32_16x16x32_bf16 a[56:59], v[132:135], v[120:123], a[56:59]
    ds_read_b128 v[36:39], v8 offset:34816
    v_mfma_f32_16x16x32_bf16 a[60:63], v[132:135], v[124:127], a[60:63]
    buffer_load_dwordx4 v5, s[4:7], s36 offen offset:3072 lds
    v_mfma_f32_16x16x32_bf16 a[64:67], v[136:139], v[96:99], a[64:67]
    ds_read_b64_tr_b16 v[76:77], v13 offset:0
    v_mfma_f32_16x16x32_bf16 a[68:71], v[136:139], v[100:103], a[68:71]
    s_add_u32 s37, s58, 2883584
    s_and_b32 s37, s37, 4194303
    s_add_u32 s37, s37, s39
    v_mfma_f32_16x16x32_bf16 a[72:75], v[136:139], v[104:107], a[72:75]
    s_add_u32 m0, s43, 49152
    ds_read_b64_tr_b16 v[78:79], v13 offset:1024
    v_mfma_f32_16x16x32_bf16 a[76:79], v[136:139], v[108:111], a[76:79]
    buffer_load_dwordx4 v6, s[8:11], s37 offen offset:0 lds
    v_mfma_f32_16x16x32_bf16 a[80:83], v[136:139], v[112:115], a[80:83]
    ds_read_b128 v[40:43], v8 offset:36864
    v_mfma_f32_16x16x32_bf16 a[84:87], v[136:139], v[116:119], a[84:87]
    v_mfma_f32_16x16x32_bf16 a[88:91], v[136:139], v[120:123], a[88:91]
    ds_read_b64_tr_b16 v[80:81], v10 offset:2048
    v_mfma_f32_16x16x32_bf16 a[92:95], v[136:139], v[124:127], a[92:95]
    buffer_load_dwordx4 v7, s[8:11], s37 offen offset:1024 lds
    v_mfma_f32_16x16x32_bf16 a[96:99], v[140:143], v[96:99], a[96:99]
    ds_read_b64_tr_b16 v[82:83], v10 offset:3072
    v_mfma_f32_16x16x32_bf16 a[100:103], v[140:143], v[100:103], a[100:103]
    v_mfma_f32_16x16x32_bf16 a[104:107], v[140:143], v[104:107], a[104:107]
    s_add_u32 m0, s43, 51200
    ds_read_b128 v[44:47], v8 offset:38912
    v_mfma_f32_16x16x32_bf16 a[108:111], v[140:143], v[108:111], a[108:111]
    buffer_load_dwordx4 v6, s[12:15], s37 offen offset:0 lds
    v_mfma_f32_16x16x32_bf16 a[112:115], v[140:143], v[112:115], a[112:115]
    ds_read_b64_tr_b16 v[84:85], v11 offset:2048
    v_mfma_f32_16x16x32_bf16 a[116:119], v[140:143], v[116:119], a[116:119]
    v_mfma_f32_16x16x32_bf16 a[120:123], v[140:143], v[120:123], a[120:123]
    ds_read_b64_tr_b16 v[86:87], v11 offset:3072
    v_mfma_f32_16x16x32_bf16 a[124:127], v[140:143], v[124:127], a[124:127]
    buffer_load_dwordx4 v7, s[12:15], s37 offen offset:1024 lds
    v_mfma_f32_16x16x32_bf16 a[128:131], v[96:99], v[144:147], a[128:131]
    ds_read_b128 v[48:51], v8 offset:40960
    v_mfma_f32_16x16x32_bf16 a[132:135], v[100:103], v[144:147], a[132:135]
    buffer_load_dwordx4 v[206:209], v233, s[24:27], s40 offen offset:0
    v_mfma_f32_16x16x32_bf16 a[136:139], v[104:107], v[144:147], a[136:139]
    ds_read_b64_tr_b16 v[88:89], v12 offset:2048
    v_mfma_f32_16x16x32_bf16 a[140:143], v[108:111], v[144:147], a[140:143]
    buffer_load_dwordx4 v[210:213], v233, s[24:27], s40 offen offset:1024
    v_mfma_f32_16x16x32_bf16 a[144:147], v[112:115], v[144:147], a[144:147]
    ds_read_b64_tr_b16 v[90:91], v12 offset:3072
    v_mfma_f32_16x16x32_bf16 a[148:151], v[116:119], v[144:147], a[148:151]
    buffer_load_dwordx4 v[214:217], v233, s[24:27], s41 offen offset:0
    v_mfma_f32_16x16x32_bf16 a[152:155], v[120:123], v[144:147], a[152:155]
    ds_read_b128 v[52:55], v8 offset:43008
    v_mfma_f32_16x16x32_bf16 a[156:159], v[124:127], v[144:147], a[156:159]
    buffer_load_dwordx4 v[218:221], v233, s[24:27], s41 offen offset:1024
    v_mfma_f32_16x16x32_bf16 a[160:163], v[96:99], v[148:151], a[160:163]
    ds_read_b64_tr_b16 v[92:93], v13 offset:2048
    v_mfma_f32_16x16x32_bf16 a[164:167], v[100:103], v[148:151], a[164:167]
    buffer_load_dwordx4 v[222:225], v233, s[16:19], 0 offen offset:0
    v_mfma_f32_16x16x32_bf16 a[168:171], v[104:107], v[148:151], a[168:171]
    ds_read_b64_tr_b16 v[94:95], v13 offset:3072
    v_mfma_f32_16x16x32_bf16 a[172:175], v[108:111], v[148:151], a[172:175]
    buffer_load_dwordx4 v[226:229], v233, s[16:19], 0 offen offset:1024
    v_mfma_f32_16x16x32_bf16 a[176:179], v[112:115], v[148:151], a[176:179]
    ds_read_b128 v[56:59], v8 offset:45056
    v_mfma_f32_16x16x32_bf16 a[180:183], v[116:119], v[148:151], a[180:183]
    buffer_load_dwordx4 v[198:201], v232, s[76:79], 0 offen offset:0
    v_mfma_f32_16x16x32_bf16 a[184:187], v[120:123], v[148:151], a[184:187]
    ds_read_b128 v[60:63], v8 offset:47104
    v_mfma_f32_16x16x32_bf16 a[188:191], v[124:127], v[148:151], a[188:191]
    buffer_load_dwordx4 v[202:205], v232, s[76:79], 0 offen offset:16
    v_mfma_f32_16x16x32_bf16 a[192:195], v[96:99], v[152:155], a[192:195]
    buffer_store_dword v241, v241, s[28:31], s55 offen sc1
    v_mfma_f32_16x16x32_bf16 a[196:199], v[100:103], v[152:155], a[196:199]
    buffer_store_dword v241, v241, s[28:31], s56 offen sc1
    v_mfma_f32_16x16x32_bf16 a[200:203], v[104:107], v[152:155], a[200:203]
    buffer_store_dword v241, v241, s[28:31], s57 offen sc1
    v_mfma_f32_16x16x32_bf16 a[204:207], v[108:111], v[152:155], a[204:207]
    buffer_store_dword v241, v241, s[28:31], s3 offen sc1
    v_mfma_f32_16x16x32_bf16 a[208:211], v[112:115], v[152:155], a[208:211]
    v_mfma_f32_16x16x32_bf16 a[212:215], v[116:119], v[152:155], a[212:215]
    v_mfma_f32_16x16x32_bf16 a[216:219], v[120:123], v[152:155], a[216:219]
    v_mfma_f32_16x16x32_bf16 a[220:223], v[124:127], v[152:155], a[220:223]
    v_mfma_f32_16x16x32_bf16 a[224:227], v[96:99], v[156:159], a[224:227]
    v_mfma_f32_16x16x32_bf16 a[228:231], v[100:103], v[156:159], a[228:231]
    v_mfma_f32_16x16x32_bf16 a[232:235], v[104:107], v[156:159], a[232:235]
    v_mfma_f32_16x16x32_bf16 a[236:239], v[108:111], v[156:159], a[236:239]
    v_mfma_f32_16x16x32_bf16 a[240:243], v[112:115], v[156:159], a[240:243]
    v_mfma_f32_16x16x32_bf16 a[244:247], v[116:119], v[156:159], a[244:247]
    v_mfma_f32_16x16x32_bf16 a[248:251], v[120:123], v[156:159], a[248:251]
    v_mfma_f32_16x16x32_bf16 a[252:255], v[124:127], v[156:159], a[252:255]
    s_waitcnt vmcnt(28) lgkmcnt(0)
    s_barrier
    v_mfma_f32_16x16x32_bf16 a[0:3], v[64:67], v[32:35], a[0:3]
    ds_read_b64_tr_b16 v[128:129], v10 offset:16384
    v_mfma_f32_16x16x32_bf16 a[4:7], v[64:67], v[36:39], a[4:7]
    s_add_u32 s36, s35, 768
    s_and_b32 s36, s36, 1023
    s_add_u32 s36, s36, s59
    v_mfma_f32_16x16x32_bf16 a[8:11], v[64:67], v[40:43], a[8:11]
    s_add_u32 m0, s42, 4096
    ds_read_b64_tr_b16 v[130:131], v10 offset:17408
    v_mfma_f32_16x16x32_bf16 a[12:15], v[64:67], v[44:47], a[12:15]
    buffer_load_dwordx4 v2, s[4:7], s36 offen offset:0 lds
    v_mfma_f32_16x16x32_bf16 a[16:19], v[64:67], v[48:51], a[16:19]
    ds_read_b64_tr_b16 v[132:133], v11 offset:16384
    v_mfma_f32_16x16x32_bf16 a[20:23], v[64:67], v[52:55], a[20:23]
    v_mfma_f32_16x16x32_bf16 a[24:27], v[64:67], v[56:59], a[24:27]
    ds_read_b64_tr_b16 v[134:135], v11 offset:17408
    v_mfma_f32_16x16x32_bf16 a[28:31], v[64:67], v[60:63], a[28:31]
    buffer_load_dwordx4 v3, s[4:7], s36 offen offset:1024 lds
    v_mfma_f32_16x16x32_bf16 a[32:35], v[68:71], v[32:35], a[32:35]
    ds_read_b128 v[96:99], v9 offset:32768
    v_mfma_f32_16x16x32_bf16 a[36:39], v[68:71], v[36:39], a[36:39]
    v_mfma_f32_16x16x32_bf16 a[40:43], v[68:71], v[40:43], a[40:43]
    ds_read_b64_tr_b16 v[136:137], v12 offset:16384
    v_mfma_f32_16x16x32_bf16 a[44:47], v[68:71], v[44:47], a[44:47]
    buffer_load_dwordx4 v4, s[4:7], s36 offen offset:2048 lds
    v_mfma_f32_16x16x32_bf16 a[48:51], v[68:71], v[48:51], a[48:51]
    ds_read_b64_tr_b16 v[138:139], v12 offset:17408
    v_mfma_f32_16x16x32_bf16 a[52:55], v[68:71], v[52:55], a[52:55]
    v_mfma_f32_16x16x32_bf16 a[56:59], v[68:71], v[56:59], a[56:59]
    ds_read_b128 v[100:103], v9 offset:34816
    v_mfma_f32_16x16x32_bf16 a[60:63], v[68:71], v[60:63], a[60:63]
    buffer_load_dwordx4 v5, s[4:7], s36 offen offset:3072 lds
    v_mfma_f32_16x16x32_bf16 a[64:67], v[72:75], v[32:35], a[64:67]
    ds_read_b64_tr_b16 v[140:141], v13 offset:16384
    v_mfma_f32_16x16x32_bf16 a[68:71], v[72:75], v[36:39], a[68:71]
    s_add_u32 s37, s58, 3145728
    s_and_b32 s37, s37, 4194303
    s_add_u32 s37, s37, s39
    v_mfma_f32_16x16x32_bf16 a[72:75], v[72:75], v[40:43], a[72:75]
    s_add_u32 m0, s43, 0
    ds_read_b64_tr_b16 v[142:143], v13 offset:17408
    v_mfma_f32_16x16x32_bf16 a[76:79], v[72:75], v[44:47], a[76:79]
    buffer_load_dwordx4 v6, s[8:11], s37 offen offset:0 lds
    v_mfma_f32_16x16x32_bf16 a[80:83], v[72:75], v[48:51], a[80:83]
    ds_read_b128 v[104:107], v9 offset:36864
    v_mfma_f32_16x16x32_bf16 a[84:87], v[72:75], v[52:55], a[84:87]
    v_mfma_f32_16x16x32_bf16 a[88:91], v[72:75], v[56:59], a[88:91]
    ds_read_b64_tr_b16 v[144:145], v10 offset:18432
    v_mfma_f32_16x16x32_bf16 a[92:95], v[72:75], v[60:63], a[92:95]
    buffer_load_dwordx4 v7, s[8:11], s37 offen offset:1024 lds
    v_mfma_f32_16x16x32_bf16 a[96:99], v[76:79], v[32:35], a[96:99]
    ds_read_b64_tr_b16 v[146:147], v10 offset:19456
    v_mfma_f32_16x16x32_bf16 a[100:103], v[76:79], v[36:39], a[100:103]
    v_mfma_f32_16x16x32_bf16 a[104:107], v[76:79], v[40:43], a[104:107]
    s_add_u32 m0, s43, 2048
    ds_read_b128 v[108:111], v9 offset:38912
    v_mfma_f32_16x16x32_bf16 a[108:111], v[76:79], v[44:47], a[108:111]
    buffer_load_dwordx4 v6, s[12:15], s37 offen offset:0 lds
    v_mfma_f32_16x16x32_bf16 a[112:115], v[76:79], v[48:51], a[112:115]
    ds_read_b64_tr_b16 v[148:149], v11 offset:18432
    v_mfma_f32_16x16x32_bf16 a[116:119], v[76:79], v[52:55], a[116:119]
    v_mfma_f32_16x16x32_bf16 a[120:123], v[76:79], v[56:59], a[120:123]
    ds_read_b64_tr_b16 v[150:151], v11 offset:19456
    v_mfma_f32_16x16x32_bf16 a[124:127], v[76:79], v[60:63], a[124:127]
    buffer_load_dwordx4 v7, s[12:15], s37 offen offset:1024 lds
    v_mfma_f32_16x16x32_bf16 a[128:131], v[32:35], v[80:83], a[128:131]
    ds_read_b128 v[112:115], v9 offset:40960
    v_mfma_f32_16x16x32_bf16 a[132:135], v[36:39], v[80:83], a[132:135]
    v_mfma_f32_16x16x32_bf16 a[136:139], v[40:43], v[80:83], a[136:139]
    ds_read_b64_tr_b16 v[152:153], v12 offset:18432
    v_mfma_f32_16x16x32_bf16 a[140:143], v[44:47], v[80:83], a[140:143]
    v_mfma_f32_16x16x32_bf16 a[144:147], v[48:51], v[80:83], a[144:147]
    ds_read_b64_tr_b16 v[154:155], v12 offset:19456
    v_mfma_f32_16x16x32_bf16 a[148:151], v[52:55], v[80:83], a[148:151]
    v_mfma_f32_16x16x32_bf16 a[152:155], v[56:59], v[80:83], a[152:155]
    ds_read_b128 v[116:119], v9 offset:43008
    v_mfma_f32_16x16x32_bf16 a[156:159], v[60:63], v[80:83], a[156:159]
    v_mfma_f32_16x16x32_bf16 a[160:163], v[32:35], v[84:87], a[160:163]
    ds_read_b64_tr_b16 v[156:157], v13 offset:18432
    v_mfma_f32_16x16x32_bf16 a[164:167], v[36:39], v[84:87], a[164:167]
    v_mfma_f32_16x16x32_bf16 a[168:171], v[40:43], v[84:87], a[168:171]
    ds_read_b64_tr_b16 v[158:159], v13 offset:19456
    v_mfma_f32_16x16x32_bf16 a[172:175], v[44:47], v[84:87], a[172:175]
    v_mfma_f32_16x16x32_bf16 a[176:179], v[48:51], v[84:87], a[176:179]
    ds_read_b128 v[120:123], v9 offset:45056
    v_mfma_f32_16x16x32_bf16 a[180:183], v[52:55], v[84:87], a[180:183]
gated_mix__ssm_conv_h3__compressed_kv_cla__prompt_kernel_pad1:
    s_cbranch_execz gated_mix__ssm_conv_h3__compressed_kv_cla__prompt_kernel_pad5
    v_mfma_f32_16x16x32_bf16 a[184:187], v[56:59], v[84:87], a[184:187]
    ds_read_b128 v[124:127], v9 offset:47104
    v_mfma_f32_16x16x32_bf16 a[188:191], v[60:63], v[84:87], a[188:191]
    v_mfma_f32_16x16x32_bf16 a[192:195], v[32:35], v[88:91], a[192:195]
    v_mfma_f32_16x16x32_bf16 a[196:199], v[36:39], v[88:91], a[196:199]
    v_mfma_f32_16x16x32_bf16 a[200:203], v[40:43], v[88:91], a[200:203]
    v_mfma_f32_16x16x32_bf16 a[204:207], v[44:47], v[88:91], a[204:207]
    v_mfma_f32_16x16x32_bf16 a[208:211], v[48:51], v[88:91], a[208:211]
    v_mfma_f32_16x16x32_bf16 a[212:215], v[52:55], v[88:91], a[212:215]
    v_mfma_f32_16x16x32_bf16 a[216:219], v[56:59], v[88:91], a[216:219]
    v_mfma_f32_16x16x32_bf16 a[220:223], v[60:63], v[88:91], a[220:223]
    v_mfma_f32_16x16x32_bf16 a[224:227], v[32:35], v[92:95], a[224:227]
    v_mfma_f32_16x16x32_bf16 a[228:231], v[36:39], v[92:95], a[228:231]
    v_mfma_f32_16x16x32_bf16 a[232:235], v[40:43], v[92:95], a[232:235]
    v_mfma_f32_16x16x32_bf16 a[236:239], v[44:47], v[92:95], a[236:239]
    v_mfma_f32_16x16x32_bf16 a[240:243], v[48:51], v[92:95], a[240:243]
    v_mfma_f32_16x16x32_bf16 a[244:247], v[52:55], v[92:95], a[244:247]
    v_mfma_f32_16x16x32_bf16 a[248:251], v[56:59], v[92:95], a[248:251]
    v_mfma_f32_16x16x32_bf16 a[252:255], v[60:63], v[92:95], a[252:255]
    s_waitcnt vmcnt(28) lgkmcnt(0)
    s_barrier
    v_mfma_f32_16x16x32_bf16 a[0:3], v[128:131], v[96:99], a[0:3]
    s_mov_b32 s76, s92
    ds_read_b64_tr_b16 v[64:65], v10 offset:32768
    v_mfma_f32_16x16x32_bf16 a[4:7], v[128:131], v[100:103], a[4:7]
    s_add_u32 s36, s35, 896
    s_and_b32 s36, s36, 1023
    s_add_u32 s36, s36, s38
    v_mfma_f32_16x16x32_bf16 a[8:11], v[128:131], v[104:107], a[8:11]
    s_add_u32 m0, s42, 32768
    ds_read_b64_tr_b16 v[66:67], v10 offset:33792
    v_mfma_f32_16x16x32_bf16 a[12:15], v[128:131], v[108:111], a[12:15]
    buffer_load_dwordx4 v2, s[4:7], s36 offen offset:0 lds
    v_mfma_f32_16x16x32_bf16 a[16:19], v[128:131], v[112:115], a[16:19]
    s_mov_b32 s77, s93
    ds_read_b64_tr_b16 v[68:69], v11 offset:32768
    v_mfma_f32_16x16x32_bf16 a[20:23], v[128:131], v[116:119], a[20:23]
    s_mov_b32 s78, 256
    v_mfma_f32_16x16x32_bf16 a[24:27], v[128:131], v[120:123], a[24:27]
    s_mov_b32 s79, 0x00020000
    ds_read_b64_tr_b16 v[70:71], v11 offset:33792
    v_mfma_f32_16x16x32_bf16 a[28:31], v[128:131], v[124:127], a[28:31]
    buffer_load_dwordx4 v3, s[4:7], s36 offen offset:1024 lds
    v_mfma_f32_16x16x32_bf16 a[32:35], v[132:135], v[96:99], a[32:35]
    s_getreg_b32 s88, hwreg(HW_REG_XCC_ID, 0, 3)
    ds_read_b128 v[32:35], v14 offset:0
    v_mfma_f32_16x16x32_bf16 a[36:39], v[132:135], v[100:103], a[36:39]
    s_lshl_b32 s88, s88, 2
    v_mfma_f32_16x16x32_bf16 a[40:43], v[132:135], v[104:107], a[40:43]
    s_lshl_b32 s88, 1, s88
    ds_read_b64_tr_b16 v[72:73], v12 offset:32768
    v_mfma_f32_16x16x32_bf16 a[44:47], v[132:135], v[108:111], a[44:47]
    buffer_load_dwordx4 v4, s[4:7], s36 offen offset:2048 lds
    v_mfma_f32_16x16x32_bf16 a[48:51], v[132:135], v[112:115], a[48:51]
    ds_read_b64_tr_b16 v[74:75], v12 offset:33792
    v_or_b32 v242, s32, v16
    v_mfma_f32_16x16x32_bf16 a[52:55], v[132:135], v[116:119], a[52:55]
    v_mov_b32 v243, 0x80000000
    v_cmp_eq_u32 vcc, 0, v242
    v_mfma_f32_16x16x32_bf16 a[56:59], v[132:135], v[120:123], a[56:59]
    ds_read_b128 v[36:39], v14 offset:2048
    v_mov_b32 v241, s88
    v_mfma_f32_16x16x32_bf16 a[60:63], v[132:135], v[124:127], a[60:63]
    buffer_load_dwordx4 v5, s[4:7], s36 offen offset:3072 lds
    v_mfma_f32_16x16x32_bf16 a[64:67], v[136:139], v[96:99], a[64:67]
    s_lshl_b32 s88, s33, 3
    ds_read_b64_tr_b16 v[76:77], v13 offset:32768
    v_mfma_f32_16x16x32_bf16 a[68:71], v[136:139], v[100:103], a[68:71]
    s_add_u32 s37, s58, 3407872
    s_and_b32 s37, s37, 4194303
    s_add_u32 s37, s37, s39
    v_mfma_f32_16x16x32_bf16 a[72:75], v[136:139], v[104:107], a[72:75]
    s_add_u32 m0, s43, 16384
    ds_read_b64_tr_b16 v[78:79], v13 offset:33792
    v_cndmask_b32 v242, v243, v242, vcc
    v_mfma_f32_16x16x32_bf16 a[76:79], v[136:139], v[108:111], a[76:79]
    buffer_load_dwordx4 v6, s[8:11], s37 offen offset:0 lds
    v_mfma_f32_16x16x32_bf16 a[80:83], v[136:139], v[112:115], a[80:83]
    ds_read_b128 v[40:43], v14 offset:4096
    v_mfma_f32_16x16x32_bf16 a[84:87], v[136:139], v[116:119], a[84:87]
    v_mfma_f32_16x16x32_bf16 a[88:91], v[136:139], v[120:123], a[88:91]
    ds_read_b64_tr_b16 v[80:81], v10 offset:34816
    v_mfma_f32_16x16x32_bf16 a[92:95], v[136:139], v[124:127], a[92:95]
    buffer_load_dwordx4 v7, s[8:11], s37 offen offset:1024 lds
    v_mfma_f32_16x16x32_bf16 a[96:99], v[140:143], v[96:99], a[96:99]
    ds_read_b64_tr_b16 v[82:83], v10 offset:35840
    v_mfma_f32_16x16x32_bf16 a[100:103], v[140:143], v[100:103], a[100:103]
    v_mfma_f32_16x16x32_bf16 a[104:107], v[140:143], v[104:107], a[104:107]
    s_add_u32 m0, s43, 18432
    ds_read_b128 v[44:47], v14 offset:6144
    v_mfma_f32_16x16x32_bf16 a[108:111], v[140:143], v[108:111], a[108:111]
    buffer_load_dwordx4 v6, s[12:15], s37 offen offset:0 lds
    v_mfma_f32_16x16x32_bf16 a[112:115], v[140:143], v[112:115], a[112:115]
    ds_read_b64_tr_b16 v[84:85], v11 offset:34816
    v_mfma_f32_16x16x32_bf16 a[116:119], v[140:143], v[116:119], a[116:119]
    v_mfma_f32_16x16x32_bf16 a[120:123], v[140:143], v[120:123], a[120:123]
    ds_read_b64_tr_b16 v[86:87], v11 offset:35840
    v_mfma_f32_16x16x32_bf16 a[124:127], v[140:143], v[124:127], a[124:127]
    buffer_load_dwordx4 v7, s[12:15], s37 offen offset:1024 lds
    v_mfma_f32_16x16x32_bf16 a[128:131], v[96:99], v[144:147], a[128:131]
    ds_read_b128 v[48:51], v14 offset:8192
    v_mfma_f32_16x16x32_bf16 a[132:135], v[100:103], v[144:147], a[132:135]
    v_mfma_f32_16x16x32_bf16 a[136:139], v[104:107], v[144:147], a[136:139]
    ds_read_b64_tr_b16 v[88:89], v12 offset:34816
    v_mfma_f32_16x16x32_bf16 a[140:143], v[108:111], v[144:147], a[140:143]
    v_mfma_f32_16x16x32_bf16 a[144:147], v[112:115], v[144:147], a[144:147]
    ds_read_b64_tr_b16 v[90:91], v12 offset:35840
    v_mfma_f32_16x16x32_bf16 a[148:151], v[116:119], v[144:147], a[148:151]
    v_mfma_f32_16x16x32_bf16 a[152:155], v[120:123], v[144:147], a[152:155]
    ds_read_b128 v[52:55], v14 offset:10240
    v_mfma_f32_16x16x32_bf16 a[156:159], v[124:127], v[144:147], a[156:159]
    v_mfma_f32_16x16x32_bf16 a[160:163], v[96:99], v[148:151], a[160:163]
    ds_read_b64_tr_b16 v[92:93], v13 offset:34816
    v_mfma_f32_16x16x32_bf16 a[164:167], v[100:103], v[148:151], a[164:167]
    v_mfma_f32_16x16x32_bf16 a[168:171], v[104:107], v[148:151], a[168:171]
    ds_read_b64_tr_b16 v[94:95], v13 offset:35840
    v_mfma_f32_16x16x32_bf16 a[172:175], v[108:111], v[148:151], a[172:175]
    v_mfma_f32_16x16x32_bf16 a[176:179], v[112:115], v[148:151], a[176:179]
    ds_read_b128 v[56:59], v14 offset:12288
    v_mfma_f32_16x16x32_bf16 a[180:183], v[116:119], v[148:151], a[180:183]
    v_mfma_f32_16x16x32_bf16 a[184:187], v[120:123], v[148:151], a[184:187]
    ds_read_b128 v[60:63], v14 offset:14336
    v_mfma_f32_16x16x32_bf16 a[188:191], v[124:127], v[148:151], a[188:191]
    v_mfma_f32_16x16x32_bf16 a[192:195], v[96:99], v[152:155], a[192:195]
    v_mfma_f32_16x16x32_bf16 a[196:199], v[100:103], v[152:155], a[196:199]
    v_mfma_f32_16x16x32_bf16 a[200:203], v[104:107], v[152:155], a[200:203]
    v_mfma_f32_16x16x32_bf16 a[204:207], v[108:111], v[152:155], a[204:207]
    v_mfma_f32_16x16x32_bf16 a[208:211], v[112:115], v[152:155], a[208:211]
    v_mfma_f32_16x16x32_bf16 a[212:215], v[116:119], v[152:155], a[212:215]
    v_mfma_f32_16x16x32_bf16 a[216:219], v[120:123], v[152:155], a[216:219]
    v_mfma_f32_16x16x32_bf16 a[220:223], v[124:127], v[152:155], a[220:223]
    v_mfma_f32_16x16x32_bf16 a[224:227], v[96:99], v[156:159], a[224:227]
    v_mfma_f32_16x16x32_bf16 a[228:231], v[100:103], v[156:159], a[228:231]
    v_mfma_f32_16x16x32_bf16 a[232:235], v[104:107], v[156:159], a[232:235]
    v_mfma_f32_16x16x32_bf16 a[236:239], v[108:111], v[156:159], a[236:239]
    v_mfma_f32_16x16x32_bf16 a[240:243], v[112:115], v[156:159], a[240:243]
    v_mfma_f32_16x16x32_bf16 a[244:247], v[116:119], v[156:159], a[244:247]
    v_mfma_f32_16x16x32_bf16 a[248:251], v[120:123], v[156:159], a[248:251]
    v_mfma_f32_16x16x32_bf16 a[252:255], v[124:127], v[156:159], a[252:255]
    s_waitcnt vmcnt(16) lgkmcnt(0)
    s_barrier
    v_mfma_f32_16x16x32_bf16 a[0:3], v[64:67], v[32:35], a[0:3]
    ds_read_b64_tr_b16 v[128:129], v10 offset:49152
    v_lshlrev_b32 v240, 16, v222
    v_mfma_f32_16x16x32_bf16 a[4:7], v[64:67], v[36:39], a[4:7]
    s_add_u32 s36, s35, 896
    s_and_b32 s36, s36, 1023
    s_add_u32 s36, s36, s59
    v_lshlrev_b32 v238, 16, v206
    v_lshlrev_b32 v239, 16, v214
    v_mfma_f32_16x16x32_bf16 a[8:11], v[64:67], v[40:43], a[8:11]
    s_add_u32 m0, s42, 36864
    ds_read_b64_tr_b16 v[130:131], v10 offset:50176
    v_mul_f32 v236, v238, v240
    v_mfma_f32_16x16x32_bf16 a[12:15], v[64:67], v[44:47], a[12:15]
    buffer_load_dwordx4 v2, s[4:7], s36 offen offset:0 lds
    v_mfma_f32_16x16x32_bf16 a[16:19], v[64:67], v[48:51], a[16:19]
    ds_read_b64_tr_b16 v[132:133], v11 offset:49152
    v_mul_f32 v237, v239, v240
    v_mfma_f32_16x16x32_bf16 a[20:23], v[64:67], v[52:55], a[20:23]
    v_and_b32 v240, s52, v222
    v_and_b32 v238, s52, v206
    v_mfma_f32_16x16x32_bf16 a[24:27], v[64:67], v[56:59], a[24:27]
    ds_read_b64_tr_b16 v[134:135], v11 offset:50176
    v_and_b32 v239, s52, v214
    v_mfma_f32_16x16x32_bf16 a[28:31], v[64:67], v[60:63], a[28:31]
    buffer_load_dwordx4 v3, s[4:7], s36 offen offset:1024 lds
    v_mfma_f32_16x16x32_bf16 a[32:35], v[68:71], v[32:35], a[32:35]
    ds_read_b128 v[96:99], v15 offset:0
    v_fmac_f32 v236, v238, v240
    v_mfma_f32_16x16x32_bf16 a[36:39], v[68:71], v[36:39], a[36:39]
    v_fmac_f32 v237, v239, v240
    v_lshlrev_b32 v240, 16, v223
    v_mfma_f32_16x16x32_bf16 a[40:43], v[68:71], v[40:43], a[40:43]
    ds_read_b64_tr_b16 v[136:137], v12 offset:49152
    v_lshlrev_b32 v238, 16, v207
    v_mfma_f32_16x16x32_bf16 a[44:47], v[68:71], v[44:47], a[44:47]
    buffer_load_dwordx4 v4, s[4:7], s36 offen offset:2048 lds
    v_mfma_f32_16x16x32_bf16 a[48:51], v[68:71], v[48:51], a[48:51]
    ds_read_b64_tr_b16 v[138:139], v12 offset:50176
    v_lshlrev_b32 v239, 16, v215
    v_mfma_f32_16x16x32_bf16 a[52:55], v[68:71], v[52:55], a[52:55]
    v_fmac_f32 v236, v238, v240
    v_fmac_f32 v237, v239, v240
    v_mfma_f32_16x16x32_bf16 a[56:59], v[68:71], v[56:59], a[56:59]
    ds_read_b128 v[100:103], v15 offset:2048
    v_and_b32 v240, s52, v223
    v_mfma_f32_16x16x32_bf16 a[60:63], v[68:71], v[60:63], a[60:63]
    buffer_load_dwordx4 v5, s[4:7], s36 offen offset:3072 lds
    v_mfma_f32_16x16x32_bf16 a[64:67], v[72:75], v[32:35], a[64:67]
    ds_read_b64_tr_b16 v[140:141], v13 offset:49152
    v_and_b32 v238, s52, v207
    v_mfma_f32_16x16x32_bf16 a[68:71], v[72:75], v[36:39], a[68:71]
    s_add_u32 s37, s58, 3670016
    s_and_b32 s37, s37, 4194303
    s_add_u32 s37, s37, s39
    v_and_b32 v239, s52, v215
    v_fmac_f32 v236, v238, v240
    v_mfma_f32_16x16x32_bf16 a[72:75], v[72:75], v[40:43], a[72:75]
    s_add_u32 m0, s43, 32768
    ds_read_b64_tr_b16 v[142:143], v13 offset:50176
    v_fmac_f32 v237, v239, v240
    v_mfma_f32_16x16x32_bf16 a[76:79], v[72:75], v[44:47], a[76:79]
    buffer_load_dwordx4 v6, s[8:11], s37 offen offset:0 lds
    v_mfma_f32_16x16x32_bf16 a[80:83], v[72:75], v[48:51], a[80:83]
    ds_read_b128 v[104:107], v15 offset:4096
    v_lshlrev_b32 v240, 16, v224
    v_mfma_f32_16x16x32_bf16 a[84:87], v[72:75], v[52:55], a[84:87]
    v_lshlrev_b32 v238, 16, v208
    v_lshlrev_b32 v239, 16, v216
    v_mfma_f32_16x16x32_bf16 a[88:91], v[72:75], v[56:59], a[88:91]
    ds_read_b64_tr_b16 v[144:145], v10 offset:51200
    v_fmac_f32 v236, v238, v240
    v_mfma_f32_16x16x32_bf16 a[92:95], v[72:75], v[60:63], a[92:95]
    buffer_load_dwordx4 v7, s[8:11], s37 offen offset:1024 lds
    v_mfma_f32_16x16x32_bf16 a[96:99], v[76:79], v[32:35], a[96:99]
    ds_read_b64_tr_b16 v[146:147], v10 offset:52224
    v_fmac_f32 v237, v239, v240
    v_mfma_f32_16x16x32_bf16 a[100:103], v[76:79], v[36:39], a[100:103]
    v_and_b32 v240, s52, v224
    v_and_b32 v238, s52, v208
    v_mfma_f32_16x16x32_bf16 a[104:107], v[76:79], v[40:43], a[104:107]
    s_add_u32 m0, s43, 34816
    ds_read_b128 v[108:111], v15 offset:6144
    v_and_b32 v239, s52, v216
    v_mfma_f32_16x16x32_bf16 a[108:111], v[76:79], v[44:47], a[108:111]
    buffer_load_dwordx4 v6, s[12:15], s37 offen offset:0 lds
    v_mfma_f32_16x16x32_bf16 a[112:115], v[76:79], v[48:51], a[112:115]
    ds_read_b64_tr_b16 v[148:149], v11 offset:51200
    v_fmac_f32 v236, v238, v240
    v_mfma_f32_16x16x32_bf16 a[116:119], v[76:79], v[52:55], a[116:119]
    v_fmac_f32 v237, v239, v240
    v_lshlrev_b32 v240, 16, v225
    v_mfma_f32_16x16x32_bf16 a[120:123], v[76:79], v[56:59], a[120:123]
    ds_read_b64_tr_b16 v[150:151], v11 offset:52224
    v_lshlrev_b32 v238, 16, v209
    v_mfma_f32_16x16x32_bf16 a[124:127], v[76:79], v[60:63], a[124:127]
    buffer_load_dwordx4 v7, s[12:15], s37 offen offset:1024 lds
    v_mfma_f32_16x16x32_bf16 a[128:131], v[32:35], v[80:83], a[128:131]
    ds_read_b128 v[112:115], v15 offset:8192
    v_lshlrev_b32 v239, 16, v217
    v_mfma_f32_16x16x32_bf16 a[132:135], v[36:39], v[80:83], a[132:135]
    buffer_load_dword v31, v254, s[20:23], s46 offen
    v_mfma_f32_16x16x32_bf16 a[136:139], v[40:43], v[80:83], a[136:139]
    ds_read_b64_tr_b16 v[152:153], v12 offset:51200
    v_fmac_f32 v236, v238, v240
    v_mfma_f32_16x16x32_bf16 a[140:143], v[44:47], v[80:83], a[140:143]
    buffer_atomic_add v241, v242, s[76:79], s88 offen sc1
    v_mfma_f32_16x16x32_bf16 a[144:147], v[48:51], v[80:83], a[144:147]
    ds_read_b64_tr_b16 v[154:155], v12 offset:52224
    v_fmac_f32 v237, v239, v240
    v_mfma_f32_16x16x32_bf16 a[148:151], v[52:55], v[80:83], a[148:151]
    v_and_b32 v240, s52, v225
    v_and_b32 v238, s52, v209
    v_mfma_f32_16x16x32_bf16 a[152:155], v[56:59], v[80:83], a[152:155]
    ds_read_b128 v[116:119], v15 offset:10240
    v_and_b32 v239, s52, v217
    v_mfma_f32_16x16x32_bf16 a[156:159], v[60:63], v[80:83], a[156:159]
    v_mfma_f32_16x16x32_bf16 a[160:163], v[32:35], v[84:87], a[160:163]
    ds_read_b64_tr_b16 v[156:157], v13 offset:51200
    v_fmac_f32 v236, v238, v240
    v_mfma_f32_16x16x32_bf16 a[164:167], v[36:39], v[84:87], a[164:167]
    v_fmac_f32 v237, v239, v240
    v_lshlrev_b32 v240, 16, v226
    v_mfma_f32_16x16x32_bf16 a[168:171], v[40:43], v[84:87], a[168:171]
    ds_read_b64_tr_b16 v[158:159], v13 offset:52224
    v_lshlrev_b32 v238, 16, v210
    v_mfma_f32_16x16x32_bf16 a[172:175], v[44:47], v[84:87], a[172:175]
    v_mfma_f32_16x16x32_bf16 a[176:179], v[48:51], v[84:87], a[176:179]
    ds_read_b128 v[120:123], v15 offset:12288
    v_lshlrev_b32 v239, 16, v218
    v_mfma_f32_16x16x32_bf16 a[180:183], v[52:55], v[84:87], a[180:183]
    v_fmac_f32 v236, v238, v240
    v_fmac_f32 v237, v239, v240
    v_mfma_f32_16x16x32_bf16 a[184:187], v[56:59], v[84:87], a[184:187]
    ds_read_b128 v[124:127], v15 offset:14336
    v_and_b32 v240, s52, v226
    v_mfma_f32_16x16x32_bf16 a[188:191], v[60:63], v[84:87], a[188:191]
    v_mfma_f32_16x16x32_bf16 a[192:195], v[32:35], v[88:91], a[192:195]
    v_and_b32 v238, s52, v210
    v_and_b32 v239, s52, v218
    v_mfma_f32_16x16x32_bf16 a[196:199], v[36:39], v[88:91], a[196:199]
    v_fmac_f32 v236, v238, v240
    v_fmac_f32 v237, v239, v240
    v_mfma_f32_16x16x32_bf16 a[200:203], v[40:43], v[88:91], a[200:203]
    v_lshlrev_b32 v240, 16, v227
    v_lshlrev_b32 v238, 16, v211
    v_mfma_f32_16x16x32_bf16 a[204:207], v[44:47], v[88:91], a[204:207]
    v_mfma_f32_16x16x32_bf16 a[208:211], v[48:51], v[88:91], a[208:211]
    v_lshlrev_b32 v239, 16, v219
    v_fmac_f32 v236, v238, v240
    v_mfma_f32_16x16x32_bf16 a[212:215], v[52:55], v[88:91], a[212:215]
    v_fmac_f32 v237, v239, v240
    v_and_b32 v240, s52, v227
    v_mfma_f32_16x16x32_bf16 a[216:219], v[56:59], v[88:91], a[216:219]
    v_and_b32 v238, s52, v211
    v_and_b32 v239, s52, v219
    v_mfma_f32_16x16x32_bf16 a[220:223], v[60:63], v[88:91], a[220:223]
    v_mfma_f32_16x16x32_bf16 a[224:227], v[32:35], v[92:95], a[224:227]
    v_fmac_f32 v236, v238, v240
    v_fmac_f32 v237, v239, v240
    v_mfma_f32_16x16x32_bf16 a[228:231], v[36:39], v[92:95], a[228:231]
    v_lshlrev_b32 v240, 16, v228
    v_lshlrev_b32 v238, 16, v212
    v_mfma_f32_16x16x32_bf16 a[232:235], v[40:43], v[92:95], a[232:235]
    v_lshlrev_b32 v239, 16, v220
    v_fmac_f32 v236, v238, v240
    v_mfma_f32_16x16x32_bf16 a[236:239], v[44:47], v[92:95], a[236:239]
    v_mfma_f32_16x16x32_bf16 a[240:243], v[48:51], v[92:95], a[240:243]
    v_fmac_f32 v237, v239, v240
    v_and_b32 v240, s52, v228
    v_mfma_f32_16x16x32_bf16 a[244:247], v[52:55], v[92:95], a[244:247]
    v_and_b32 v238, s52, v212
    v_and_b32 v239, s52, v220
    v_mfma_f32_16x16x32_bf16 a[248:251], v[56:59], v[92:95], a[248:251]
    v_fmac_f32 v236, v238, v240
    v_fmac_f32 v237, v239, v240
    v_mfma_f32_16x16x32_bf16 a[252:255], v[60:63], v[92:95], a[252:255]
    s_waitcnt vmcnt(18) lgkmcnt(0)
    s_barrier
    v_lshlrev_b32 v240, 16, v229
    v_lshlrev_b32 v238, 16, v213
    v_mfma_f32_16x16x32_bf16 a[0:3], v[128:131], v[96:99], a[0:3]
    ds_read_b64_tr_b16 v[64:65], v10 offset:0
    v_lshlrev_b32 v239, 16, v221
    v_mfma_f32_16x16x32_bf16 a[4:7], v[128:131], v[100:103], a[4:7]
    s_add_u32 s36, s44, 0
    v_fmac_f32 v236, v238, v240
    v_fmac_f32 v237, v239, v240
    v_mfma_f32_16x16x32_bf16 a[8:11], v[128:131], v[104:107], a[8:11]
    s_add_u32 m0, s42, 65536
    ds_read_b64_tr_b16 v[66:67], v10 offset:1024
    v_and_b32 v240, s52, v229
    v_mfma_f32_16x16x32_bf16 a[12:15], v[128:131], v[108:111], a[12:15]
    buffer_load_dwordx4 v17, s[24:27], s36 offen offset:0 lds
    v_mfma_f32_16x16x32_bf16 a[16:19], v[128:131], v[112:115], a[16:19]
    ds_read_b64_tr_b16 v[68:69], v11 offset:0
    v_and_b32 v238, s52, v213
    v_mfma_f32_16x16x32_bf16 a[20:23], v[128:131], v[116:119], a[20:23]
    v_and_b32 v239, s52, v221
    v_fmac_f32 v236, v238, v240
    v_mfma_f32_16x16x32_bf16 a[24:27], v[128:131], v[120:123], a[24:27]
    ds_read_b64_tr_b16 v[70:71], v11 offset:1024
    v_fmac_f32 v237, v239, v240
    v_mfma_f32_16x16x32_bf16 a[28:31], v[128:131], v[124:127], a[28:31]
    buffer_load_dwordx4 v18, s[24:27], s36 offen offset:1024 lds
    v_mfma_f32_16x16x32_bf16 a[32:35], v[132:135], v[96:99], a[32:35]
    ds_read_b128 v[32:35], v8 offset:0
    v_add_f32_dpp v236, v236, v236 quad_perm:[1,0,3,2] row_mask:0xf bank_mask:0xf
    v_mfma_f32_16x16x32_bf16 a[36:39], v[132:135], v[100:103], a[36:39]
    v_add_f32_dpp v237, v237, v237 quad_perm:[1,0,3,2] row_mask:0xf bank_mask:0xf
    v_mfma_f32_16x16x32_bf16 a[40:43], v[132:135], v[104:107], a[40:43]
    ds_read_b64_tr_b16 v[72:73], v12 offset:0
    v_mfma_f32_16x16x32_bf16 a[44:47], v[132:135], v[108:111], a[44:47]
    buffer_load_dwordx4 v19, s[24:27], s36 offen offset:2048 lds
    v_mfma_f32_16x16x32_bf16 a[48:51], v[132:135], v[112:115], a[48:51]
    ds_read_b64_tr_b16 v[74:75], v12 offset:1024
    v_add_f32_dpp v236, v236, v236 quad_perm:[2,3,0,1] row_mask:0xf bank_mask:0xf
    v_mfma_f32_16x16x32_bf16 a[52:55], v[132:135], v[116:119], a[52:55]
    v_add_f32_dpp v237, v237, v237 quad_perm:[2,3,0,1] row_mask:0xf bank_mask:0xf
    v_mfma_f32_16x16x32_bf16 a[56:59], v[132:135], v[120:123], a[56:59]
    ds_read_b128 v[36:39], v8 offset:2048
    v_mfma_f32_16x16x32_bf16 a[60:63], v[132:135], v[124:127], a[60:63]
    buffer_load_dwordx4 v20, s[24:27], s36 offen offset:3072 lds
    v_mfma_f32_16x16x32_bf16 a[64:67], v[136:139], v[96:99], a[64:67]
    ds_read_b64_tr_b16 v[76:77], v13 offset:0
    v_add_f32_dpp v236, v236, v236 row_half_mirror row_mask:0xf bank_mask:0xf
    v_mfma_f32_16x16x32_bf16 a[68:71], v[136:139], v[100:103], a[68:71]
    s_add_u32 s37, s58, 3932160
    s_and_b32 s37, s37, 4194303
    s_add_u32 s37, s37, s39
    v_add_f32_dpp v237, v237, v237 row_half_mirror row_mask:0xf bank_mask:0xf
    v_mfma_f32_16x16x32_bf16 a[72:75], v[136:139], v[104:107], a[72:75]
    s_add_u32 m0, s43, 49152
    ds_read_b64_tr_b16 v[78:79], v13 offset:1024
    v_mfma_f32_16x16x32_bf16 a[76:79], v[136:139], v[108:111], a[76:79]
    buffer_load_dwordx4 v6, s[8:11], s37 offen offset:0 lds
    v_mfma_f32_16x16x32_bf16 a[80:83], v[136:139], v[112:115], a[80:83]
    ds_read_b128 v[40:43], v8 offset:4096
    v_add_f32_dpp v236, v236, v236 row_mirror row_mask:0xf bank_mask:0xf
    v_mfma_f32_16x16x32_bf16 a[84:87], v[136:139], v[116:119], a[84:87]
    v_add_f32_dpp v237, v237, v237 row_mirror row_mask:0xf bank_mask:0xf
    v_mov_b32 v238, v236
    v_mfma_f32_16x16x32_bf16 a[88:91], v[136:139], v[120:123], a[88:91]
    ds_read_b64_tr_b16 v[80:81], v10 offset:2048
    v_mov_b32 v239, v237
    v_mfma_f32_16x16x32_bf16 a[92:95], v[136:139], v[124:127], a[92:95]
    buffer_load_dwordx4 v7, s[8:11], s37 offen offset:1024 lds
    v_mfma_f32_16x16x32_bf16 a[96:99], v[140:143], v[96:99], a[96:99]
    ds_read_b64_tr_b16 v[82:83], v10 offset:3072
    v_permlane16_swap_b32 v236, v238
    v_mfma_f32_16x16x32_bf16 a[100:103], v[140:143], v[100:103], a[100:103]
    v_permlane16_swap_b32 v237, v239
    v_mfma_f32_16x16x32_bf16 a[104:107], v[140:143], v[104:107], a[104:107]
    s_add_u32 m0, s43, 51200
    ds_read_b128 v[44:47], v8 offset:6144
    v_add_f32 v236, v236, v238
    v_mfma_f32_16x16x32_bf16 a[108:111], v[140:143], v[108:111], a[108:111]
    buffer_load_dwordx4 v6, s[12:15], s37 offen offset:0 lds
    v_mfma_f32_16x16x32_bf16 a[112:115], v[140:143], v[112:115], a[112:115]
    ds_read_b64_tr_b16 v[84:85], v11 offset:2048
    v_add_f32 v237, v237, v239
    v_mfma_f32_16x16x32_bf16 a[116:119], v[140:143], v[116:119], a[116:119]
    v_mov_b32 v238, v236
    v_mov_b32 v239, v237
    v_mfma_f32_16x16x32_bf16 a[120:123], v[140:143], v[120:123], a[120:123]
    ds_read_b64_tr_b16 v[86:87], v11 offset:3072
    v_mfma_f32_16x16x32_bf16 a[124:127], v[140:143], v[124:127], a[124:127]
    buffer_load_dwordx4 v7, s[12:15], s37 offen offset:1024 lds
    v_mfma_f32_16x16x32_bf16 a[128:131], v[96:99], v[144:147], a[128:131]
    ds_read_b128 v[48:51], v8 offset:8192
    v_permlane32_swap_b32 v236, v238
    v_mfma_f32_16x16x32_bf16 a[132:135], v[100:103], v[144:147], a[132:135]
    v_permlane32_swap_b32 v237, v239
    v_mfma_f32_16x16x32_bf16 a[136:139], v[104:107], v[144:147], a[136:139]
    ds_read_b64_tr_b16 v[88:89], v12 offset:2048
    v_add_f32 v236, v236, v238
    v_mfma_f32_16x16x32_bf16 a[140:143], v[108:111], v[144:147], a[140:143]
    v_mfma_f32_16x16x32_bf16 a[144:147], v[112:115], v[144:147], a[144:147]
    ds_read_b64_tr_b16 v[90:91], v12 offset:3072
    v_add_f32 v237, v237, v239
    v_mfma_f32_16x16x32_bf16 a[148:151], v[116:119], v[144:147], a[148:151]
    v_mul_f32 v236, 0xbfb8aa3b, v236
    v_mul_f32 v237, 0xbfb8aa3b, v237
    v_mfma_f32_16x16x32_bf16 a[152:155], v[120:123], v[144:147], a[152:155]
    ds_read_b128 v[52:55], v8 offset:10240
    v_exp_f32 v236, v236
    v_mfma_f32_16x16x32_bf16 a[156:159], v[124:127], v[144:147], a[156:159]
    v_mfma_f32_16x16x32_bf16 a[160:163], v[96:99], v[148:151], a[160:163]
    ds_read_b64_tr_b16 v[92:93], v13 offset:2048
    v_exp_f32 v237, v237
    v_mfma_f32_16x16x32_bf16 a[164:167], v[100:103], v[148:151], a[164:167]
    v_mov_b32 v238, 0
    v_add_f32 v236, 1.0, v236
    v_mfma_f32_16x16x32_bf16 a[168:171], v[104:107], v[148:151], a[168:171]
    ds_read_b64_tr_b16 v[94:95], v13 offset:3072
    v_add_f32 v237, 1.0, v237
    v_mfma_f32_16x16x32_bf16 a[172:175], v[108:111], v[148:151], a[172:175]
    v_mfma_f32_16x16x32_bf16 a[176:179], v[112:115], v[148:151], a[176:179]
    ds_read_b128 v[56:59], v8 offset:12288
    v_rcp_f32 v236, v236
    v_mfma_f32_16x16x32_bf16 a[180:183], v[116:119], v[148:151], a[180:183]
    v_rcp_f32 v237, v237
    v_mfma_f32_16x16x32_bf16 a[184:187], v[120:123], v[148:151], a[184:187]
    s_add_u32 s16, s94, 59768832
    s_addc_u32 s17, s95, 0
    ds_read_b128 v[60:63], v8 offset:14336
    v_mfma_f32_16x16x32_bf16 a[188:191], v[124:127], v[148:151], a[188:191]
    v_mfma_f32_16x16x32_bf16 a[192:195], v[96:99], v[152:155], a[192:195]
    s_mov_b32 s18, 8192
    v_mfma_f32_16x16x32_bf16 a[196:199], v[100:103], v[152:155], a[196:199]
    s_lshr_b32 s40, s40, 9
    v_mfma_f32_16x16x32_bf16 a[200:203], v[104:107], v[152:155], a[200:203]
    s_lshr_b32 s41, s41, 9
    v_mfma_f32_16x16x32_bf16 a[204:207], v[108:111], v[152:155], a[204:207]
    buffer_store_dword v236, v238, s[16:19], s40 offen sc1
    v_mfma_f32_16x16x32_bf16 a[208:211], v[112:115], v[152:155], a[208:211]
    v_mfma_f32_16x16x32_bf16 a[212:215], v[116:119], v[152:155], a[212:215]
    v_mfma_f32_16x16x32_bf16 a[216:219], v[120:123], v[152:155], a[216:219]
    v_mfma_f32_16x16x32_bf16 a[220:223], v[124:127], v[152:155], a[220:223]
    buffer_store_dword v237, v238, s[16:19], s41 offen sc1
    v_mfma_f32_16x16x32_bf16 a[224:227], v[96:99], v[156:159], a[224:227]
    s_add_u32 s16, s94, 50331648
    s_addc_u32 s17, s95, 0
    v_mfma_f32_16x16x32_bf16 a[228:231], v[100:103], v[156:159], a[228:231]
    s_mov_b32 s18, 4718592
    v_mfma_f32_16x16x32_bf16 a[232:235], v[104:107], v[156:159], a[232:235]
    v_mfma_f32_16x16x32_bf16 a[236:239], v[108:111], v[156:159], a[236:239]
    v_mfma_f32_16x16x32_bf16 a[240:243], v[112:115], v[156:159], a[240:243]
    v_mfma_f32_16x16x32_bf16 a[244:247], v[116:119], v[156:159], a[244:247]
    v_mfma_f32_16x16x32_bf16 a[248:251], v[120:123], v[156:159], a[248:251]
    v_mfma_f32_16x16x32_bf16 a[252:255], v[124:127], v[156:159], a[252:255]
    s_waitcnt vmcnt(20) lgkmcnt(0)
    s_barrier
    v_mfma_f32_16x16x32_bf16 a[0:3], v[64:67], v[32:35], a[0:3]
    ds_read_b64_tr_b16 v[128:129], v10 offset:16384
    v_lshlrev_b32 v206, 16, v160
    v_mfma_f32_16x16x32_bf16 a[4:7], v[64:67], v[36:39], a[4:7]
    s_add_u32 s36, s45, 0
    v_lshlrev_b32 v207, 16, v162
    v_lshlrev_b32 v208, 16, v164
    v_mfma_f32_16x16x32_bf16 a[8:11], v[64:67], v[40:43], a[8:11]
    s_add_u32 m0, s42, 69632
    ds_read_b64_tr_b16 v[130:131], v10 offset:17408
    v_lshlrev_b32 v209, 16, v166
    v_mfma_f32_16x16x32_bf16 a[12:15], v[64:67], v[44:47], a[12:15]
    buffer_load_dwordx4 v17, s[24:27], s36 offen offset:0 lds
    v_mfma_f32_16x16x32_bf16 a[16:19], v[64:67], v[48:51], a[16:19]
    ds_read_b64_tr_b16 v[132:133], v11 offset:16384
    v_lshlrev_b32 v210, 16, v168
    v_mfma_f32_16x16x32_bf16 a[20:23], v[64:67], v[52:55], a[20:23]
    v_lshlrev_b32 v211, 16, v170
    v_lshlrev_b32 v212, 16, v172
    v_mfma_f32_16x16x32_bf16 a[24:27], v[64:67], v[56:59], a[24:27]
    ds_read_b64_tr_b16 v[134:135], v11 offset:17408
    v_lshlrev_b32 v213, 16, v174
    v_mfma_f32_16x16x32_bf16 a[28:31], v[64:67], v[60:63], a[28:31]
    buffer_load_dwordx4 v18, s[24:27], s36 offen offset:1024 lds
    v_mfma_f32_16x16x32_bf16 a[32:35], v[68:71], v[32:35], a[32:35]
    ds_read_b128 v[96:99], v9 offset:0
    v_lshlrev_b32 v214, 16, v176
    v_mfma_f32_16x16x32_bf16 a[36:39], v[68:71], v[36:39], a[36:39]
    v_lshlrev_b32 v215, 16, v178
    v_lshlrev_b32 v216, 16, v180
    v_mfma_f32_16x16x32_bf16 a[40:43], v[68:71], v[40:43], a[40:43]
    ds_read_b64_tr_b16 v[136:137], v12 offset:16384
    v_lshlrev_b32 v217, 16, v198
    v_mfma_f32_16x16x32_bf16 a[44:47], v[68:71], v[44:47], a[44:47]
    buffer_load_dwordx4 v19, s[24:27], s36 offen offset:2048 lds
    v_mfma_f32_16x16x32_bf16 a[48:51], v[68:71], v[48:51], a[48:51]
    ds_read_b64_tr_b16 v[138:139], v12 offset:17408
    v_and_b32 v218, s52, v198
    v_mfma_f32_16x16x32_bf16 a[52:55], v[68:71], v[52:55], a[52:55]
    v_lshlrev_b32 v219, 16, v199
    v_and_b32 v220, s52, v199
    v_mfma_f32_16x16x32_bf16 a[56:59], v[68:71], v[56:59], a[56:59]
    ds_read_b128 v[100:103], v9 offset:2048
    v_mul_f32 v221, v209, v217
    v_mfma_f32_16x16x32_bf16 a[60:63], v[68:71], v[60:63], a[60:63]
    buffer_load_dwordx4 v20, s[24:27], s36 offen offset:3072 lds
    v_mfma_f32_16x16x32_bf16 a[64:67], v[72:75], v[32:35], a[64:67]
    ds_read_b64_tr_b16 v[140:141], v13 offset:16384
    v_mul_f32 v222, v210, v217
    v_mfma_f32_16x16x32_bf16 a[68:71], v[72:75], v[36:39], a[68:71]
    s_add_u32 s37, s49, 0
    v_mul_f32 v223, v211, v217
    v_mul_f32 v224, v212, v217
    v_mfma_f32_16x16x32_bf16 a[72:75], v[72:75], v[40:43], a[72:75]
    s_add_u32 m0, s50, 0
    ds_read_b64_tr_b16 v[142:143], v13 offset:17408
    v_mul_f32 v225, v213, v217
    v_mfma_f32_16x16x32_bf16 a[76:79], v[72:75], v[44:47], a[76:79]
    buffer_load_dwordx4 v21, s[20:23], s37 offen offset:0 lds
    v_mfma_f32_16x16x32_bf16 a[80:83], v[72:75], v[48:51], a[80:83]
    ds_read_b128 v[104:107], v9 offset:4096
    v_mul_f32 v226, v214, v217
    v_mfma_f32_16x16x32_bf16 a[84:87], v[72:75], v[52:55], a[84:87]
    v_mul_f32 v227, v215, v217
    v_mul_f32 v228, v216, v217
    v_mfma_f32_16x16x32_bf16 a[88:91], v[72:75], v[56:59], a[88:91]
    ds_read_b64_tr_b16 v[144:145], v10 offset:18432
    v_fmac_f32 v221, v208, v218
    v_mfma_f32_16x16x32_bf16 a[92:95], v[72:75], v[60:63], a[92:95]
    buffer_load_dwordx4 v22, s[20:23], s37 offen offset:1024 lds
    v_mfma_f32_16x16x32_bf16 a[96:99], v[76:79], v[32:35], a[96:99]
    ds_read_b64_tr_b16 v[146:147], v10 offset:19456
    v_fmac_f32 v222, v209, v218
    v_mfma_f32_16x16x32_bf16 a[100:103], v[76:79], v[36:39], a[100:103]
    v_fmac_f32 v223, v210, v218
    v_fmac_f32 v224, v211, v218
    v_mfma_f32_16x16x32_bf16 a[104:107], v[76:79], v[40:43], a[104:107]
    ds_read_b128 v[108:111], v9 offset:6144
    v_fmac_f32 v225, v212, v218
    v_mfma_f32_16x16x32_bf16 a[108:111], v[76:79], v[44:47], a[108:111]
    v_mfma_f32_16x16x32_bf16 a[112:115], v[76:79], v[48:51], a[112:115]
    ds_read_b64_tr_b16 v[148:149], v11 offset:18432
    v_fmac_f32 v226, v213, v218
    v_mfma_f32_16x16x32_bf16 a[116:119], v[76:79], v[52:55], a[116:119]
    v_fmac_f32 v227, v214, v218
    v_fmac_f32 v228, v215, v218
    v_mfma_f32_16x16x32_bf16 a[120:123], v[76:79], v[56:59], a[120:123]
    ds_read_b64_tr_b16 v[150:151], v11 offset:19456
    v_fmac_f32 v221, v207, v219
    v_mfma_f32_16x16x32_bf16 a[124:127], v[76:79], v[60:63], a[124:127]
    v_mfma_f32_16x16x32_bf16 a[128:131], v[32:35], v[80:83], a[128:131]
    ds_read_b128 v[112:115], v9 offset:8192
    v_fmac_f32 v222, v208, v219
    v_mfma_f32_16x16x32_bf16 a[132:135], v[36:39], v[80:83], a[132:135]
    v_fmac_f32 v223, v209, v219
    v_fmac_f32 v224, v210, v219
    v_mfma_f32_16x16x32_bf16 a[136:139], v[40:43], v[80:83], a[136:139]
    ds_read_b64_tr_b16 v[152:153], v12 offset:18432
    v_fmac_f32 v225, v211, v219
    v_mfma_f32_16x16x32_bf16 a[140:143], v[44:47], v[80:83], a[140:143]
    v_mfma_f32_16x16x32_bf16 a[144:147], v[48:51], v[80:83], a[144:147]
    ds_read_b64_tr_b16 v[154:155], v12 offset:19456
    v_fmac_f32 v226, v212, v219
    v_mfma_f32_16x16x32_bf16 a[148:151], v[52:55], v[80:83], a[148:151]
    v_fmac_f32 v227, v213, v219
    v_fmac_f32 v228, v214, v219
    v_mfma_f32_16x16x32_bf16 a[152:155], v[56:59], v[80:83], a[152:155]
    ds_read_b128 v[116:119], v9 offset:10240
    v_fmac_f32 v221, v206, v220
    v_mfma_f32_16x16x32_bf16 a[156:159], v[60:63], v[80:83], a[156:159]
    v_mfma_f32_16x16x32_bf16 a[160:163], v[32:35], v[84:87], a[160:163]
    ds_read_b64_tr_b16 v[156:157], v13 offset:18432
    v_fmac_f32 v222, v207, v220
    v_mfma_f32_16x16x32_bf16 a[164:167], v[36:39], v[84:87], a[164:167]
    v_fmac_f32 v223, v208, v220
    v_fmac_f32 v224, v209, v220
    v_mfma_f32_16x16x32_bf16 a[168:171], v[40:43], v[84:87], a[168:171]
    ds_read_b64_tr_b16 v[158:159], v13 offset:19456
    v_fmac_f32 v225, v210, v220
    v_mfma_f32_16x16x32_bf16 a[172:175], v[44:47], v[84:87], a[172:175]
    v_mfma_f32_16x16x32_bf16 a[176:179], v[48:51], v[84:87], a[176:179]
    ds_read_b128 v[120:123], v9 offset:12288
    v_fmac_f32 v226, v211, v220
    v_mfma_f32_16x16x32_bf16 a[180:183], v[52:55], v[84:87], a[180:183]
gated_mix__ssm_conv_h3__compressed_kv_cla__prompt_kernel_pad2:
    s_cbranch_execz gated_mix__ssm_conv_h3__compressed_kv_cla__prompt_kernel_pad6
    v_fmac_f32 v227, v212, v220
    v_fmac_f32 v228, v213, v220
    v_mfma_f32_16x16x32_bf16 a[184:187], v[56:59], v[84:87], a[184:187]
    ds_read_b128 v[124:127], v9 offset:14336
    v_lshlrev_b32 v206, 16, v182
    v_mfma_f32_16x16x32_bf16 a[188:191], v[60:63], v[84:87], a[188:191]
    v_mfma_f32_16x16x32_bf16 a[192:195], v[32:35], v[88:91], a[192:195]
    v_lshlrev_b32 v207, 16, v184
    v_lshlrev_b32 v208, 16, v186
    v_mfma_f32_16x16x32_bf16 a[196:199], v[36:39], v[88:91], a[196:199]
    v_lshlrev_b32 v209, 16, v188
    v_lshlrev_b32 v210, 16, v190
    v_mfma_f32_16x16x32_bf16 a[200:203], v[40:43], v[88:91], a[200:203]
    v_lshlrev_b32 v211, 16, v192
    v_lshlrev_b32 v212, 16, v194
    v_mfma_f32_16x16x32_bf16 a[204:207], v[44:47], v[88:91], a[204:207]
    v_mfma_f32_16x16x32_bf16 a[208:211], v[48:51], v[88:91], a[208:211]
    v_lshlrev_b32 v213, 16, v196
    v_mul_f32 v221, v221, v206
    v_mfma_f32_16x16x32_bf16 a[212:215], v[52:55], v[88:91], a[212:215]
    v_mul_f32 v222, v222, v207
    v_mul_f32 v223, v223, v208
    v_mfma_f32_16x16x32_bf16 a[216:219], v[56:59], v[88:91], a[216:219]
    v_mul_f32 v224, v224, v209
    v_mul_f32 v225, v225, v210
    v_mfma_f32_16x16x32_bf16 a[220:223], v[60:63], v[88:91], a[220:223]
    v_mfma_f32_16x16x32_bf16 a[224:227], v[32:35], v[92:95], a[224:227]
    v_mul_f32 v226, v226, v211
    v_mul_f32 v227, v227, v212
    v_mfma_f32_16x16x32_bf16 a[228:231], v[36:39], v[92:95], a[228:231]
    v_mul_f32 v228, v228, v213
    v_cvt_pk_bf16_f32 v244, v228, v227
    v_mfma_f32_16x16x32_bf16 a[232:235], v[40:43], v[92:95], a[232:235]
    v_cvt_pk_bf16_f32 v245, v226, v225
    v_cvt_pk_bf16_f32 v246, v224, v223
    v_mfma_f32_16x16x32_bf16 a[236:239], v[44:47], v[92:95], a[236:239]
    v_mfma_f32_16x16x32_bf16 a[240:243], v[48:51], v[92:95], a[240:243]
    v_cvt_pk_bf16_f32 v247, v222, v221
    v_and_b32 v206, s52, v160
    v_mfma_f32_16x16x32_bf16 a[244:247], v[52:55], v[92:95], a[244:247]
    v_and_b32 v207, s52, v162
    v_and_b32 v208, s52, v164
    v_mfma_f32_16x16x32_bf16 a[248:251], v[56:59], v[92:95], a[248:251]
    v_and_b32 v209, s52, v166
    v_and_b32 v210, s52, v168
    v_mfma_f32_16x16x32_bf16 a[252:255], v[60:63], v[92:95], a[252:255]
    s_waitcnt vmcnt(18) lgkmcnt(0)
    s_barrier
    v_and_b32 v211, s52, v170
    v_and_b32 v212, s52, v172
    v_mfma_f32_16x16x32_bf16 a[0:3], v[128:131], v[96:99], a[0:3]
    ds_read_b64_tr_b16 v[64:65], v10 offset:32768
    v_and_b32 v213, s52, v174
    v_mfma_f32_16x16x32_bf16 a[4:7], v[128:131], v[100:103], a[4:7]
    s_add_u32 s36, s44, 128
    v_and_b32 v214, s52, v176
    v_and_b32 v215, s52, v178
    v_mfma_f32_16x16x32_bf16 a[8:11], v[128:131], v[104:107], a[8:11]
    s_add_u32 m0, s42, 0
    ds_read_b64_tr_b16 v[66:67], v10 offset:33792
    v_and_b32 v216, s52, v180
    v_mfma_f32_16x16x32_bf16 a[12:15], v[128:131], v[108:111], a[12:15]
    buffer_load_dwordx4 v17, s[24:27], s36 offen offset:0 lds
    v_mfma_f32_16x16x32_bf16 a[16:19], v[128:131], v[112:115], a[16:19]
    ds_read_b64_tr_b16 v[68:69], v11 offset:32768
    v_lshlrev_b32 v217, 16, v200
    v_mfma_f32_16x16x32_bf16 a[20:23], v[128:131], v[116:119], a[20:23]
    v_and_b32 v218, s52, v200
    v_lshlrev_b32 v219, 16, v201
    v_mfma_f32_16x16x32_bf16 a[24:27], v[128:131], v[120:123], a[24:27]
    ds_read_b64_tr_b16 v[70:71], v11 offset:33792
    v_and_b32 v220, s52, v201
    v_mfma_f32_16x16x32_bf16 a[28:31], v[128:131], v[124:127], a[28:31]
    buffer_load_dwordx4 v18, s[24:27], s36 offen offset:1024 lds
    v_mfma_f32_16x16x32_bf16 a[32:35], v[132:135], v[96:99], a[32:35]
    ds_read_b128 v[32:35], v8 offset:32768
    v_mul_f32 v221, v209, v217
    v_mfma_f32_16x16x32_bf16 a[36:39], v[132:135], v[100:103], a[36:39]
    v_mul_f32 v222, v210, v217
    v_mul_f32 v223, v211, v217
    v_mfma_f32_16x16x32_bf16 a[40:43], v[132:135], v[104:107], a[40:43]
    ds_read_b64_tr_b16 v[72:73], v12 offset:32768
    v_mul_f32 v224, v212, v217
    v_mfma_f32_16x16x32_bf16 a[44:47], v[132:135], v[108:111], a[44:47]
    buffer_load_dwordx4 v19, s[24:27], s36 offen offset:2048 lds
    v_mfma_f32_16x16x32_bf16 a[48:51], v[132:135], v[112:115], a[48:51]
    ds_read_b64_tr_b16 v[74:75], v12 offset:33792
    v_mul_f32 v225, v213, v217
    v_mfma_f32_16x16x32_bf16 a[52:55], v[132:135], v[116:119], a[52:55]
    v_mul_f32 v226, v214, v217
    v_mul_f32 v227, v215, v217
    v_mfma_f32_16x16x32_bf16 a[56:59], v[132:135], v[120:123], a[56:59]
    ds_read_b128 v[36:39], v8 offset:34816
    v_mul_f32 v228, v216, v217
    v_mfma_f32_16x16x32_bf16 a[60:63], v[132:135], v[124:127], a[60:63]
    buffer_load_dwordx4 v20, s[24:27], s36 offen offset:3072 lds
    v_mfma_f32_16x16x32_bf16 a[64:67], v[136:139], v[96:99], a[64:67]
    ds_read_b64_tr_b16 v[76:77], v13 offset:32768
    v_fmac_f32 v221, v208, v218
    v_mfma_f32_16x16x32_bf16 a[68:71], v[136:139], v[100:103], a[68:71]
    s_add_u32 s37, s49, 262144
    v_fmac_f32 v222, v209, v218
    v_fmac_f32 v223, v210, v218
    v_mfma_f32_16x16x32_bf16 a[72:75], v[136:139], v[104:107], a[72:75]
    s_add_u32 m0, s50, 8704
    ds_read_b64_tr_b16 v[78:79], v13 offset:33792
    v_fmac_f32 v224, v211, v218
    v_mfma_f32_16x16x32_bf16 a[76:79], v[136:139], v[108:111], a[76:79]
    buffer_load_dwordx4 v21, s[20:23], s37 offen offset:0 lds
    v_mfma_f32_16x16x32_bf16 a[80:83], v[136:139], v[112:115], a[80:83]
    ds_read_b128 v[40:43], v8 offset:36864
    v_fmac_f32 v225, v212, v218
    v_mfma_f32_16x16x32_bf16 a[84:87], v[136:139], v[116:119], a[84:87]
    v_fmac_f32 v226, v213, v218
    v_fmac_f32 v227, v214, v218
    v_mfma_f32_16x16x32_bf16 a[88:91], v[136:139], v[120:123], a[88:91]
    ds_read_b64_tr_b16 v[80:81], v10 offset:34816
    v_fmac_f32 v228, v215, v218
    v_mfma_f32_16x16x32_bf16 a[92:95], v[136:139], v[124:127], a[92:95]
    buffer_load_dwordx4 v22, s[20:23], s37 offen offset:1024 lds
    v_mfma_f32_16x16x32_bf16 a[96:99], v[140:143], v[96:99], a[96:99]
    ds_read_b64_tr_b16 v[82:83], v10 offset:35840
    v_fmac_f32 v221, v207, v219
    v_mfma_f32_16x16x32_bf16 a[100:103], v[140:143], v[100:103], a[100:103]
    s_add_u32 s37, s49, 524288
    v_fmac_f32 v222, v208, v219
    v_fmac_f32 v223, v209, v219
    v_mfma_f32_16x16x32_bf16 a[104:107], v[140:143], v[104:107], a[104:107]
    s_add_u32 m0, s50, 17408
    ds_read_b128 v[44:47], v8 offset:38912
    v_fmac_f32 v224, v210, v219
    v_mfma_f32_16x16x32_bf16 a[108:111], v[140:143], v[108:111], a[108:111]
    buffer_load_dwordx4 v21, s[20:23], s37 offen offset:0 lds
    v_mfma_f32_16x16x32_bf16 a[112:115], v[140:143], v[112:115], a[112:115]
    ds_read_b64_tr_b16 v[84:85], v11 offset:34816
    v_fmac_f32 v225, v211, v219
    v_mfma_f32_16x16x32_bf16 a[116:119], v[140:143], v[116:119], a[116:119]
    v_fmac_f32 v226, v212, v219
    v_fmac_f32 v227, v213, v219
    v_mfma_f32_16x16x32_bf16 a[120:123], v[140:143], v[120:123], a[120:123]
    ds_read_b64_tr_b16 v[86:87], v11 offset:35840
    v_fmac_f32 v228, v214, v219
    v_mfma_f32_16x16x32_bf16 a[124:127], v[140:143], v[124:127], a[124:127]
    buffer_load_dwordx4 v22, s[20:23], s37 offen offset:1024 lds
    v_mfma_f32_16x16x32_bf16 a[128:131], v[96:99], v[144:147], a[128:131]
    ds_read_b128 v[48:51], v8 offset:40960
    v_fmac_f32 v221, v206, v220
    v_mfma_f32_16x16x32_bf16 a[132:135], v[100:103], v[144:147], a[132:135]
    v_fmac_f32 v222, v207, v220
    v_fmac_f32 v223, v208, v220
    v_mfma_f32_16x16x32_bf16 a[136:139], v[104:107], v[144:147], a[136:139]
    ds_read_b64_tr_b16 v[88:89], v12 offset:34816
    v_fmac_f32 v224, v209, v220
    v_mfma_f32_16x16x32_bf16 a[140:143], v[108:111], v[144:147], a[140:143]
    buffer_store_dwordx4 v[244:247], v234, s[16:19], 0 offen sc1
    v_mfma_f32_16x16x32_bf16 a[144:147], v[112:115], v[144:147], a[144:147]
    s_movk_i32 s54, 4608
    ds_read_b64_tr_b16 v[90:91], v12 offset:35840
    v_fmac_f32 v225, v210, v220
    v_mfma_f32_16x16x32_bf16 a[148:151], v[116:119], v[144:147], a[148:151]
    v_fmac_f32 v226, v211, v220
    v_fmac_f32 v227, v212, v220
    v_mfma_f32_16x16x32_bf16 a[152:155], v[120:123], v[144:147], a[152:155]
    ds_read_b128 v[52:55], v8 offset:43008
    v_fmac_f32 v228, v213, v220
    v_mfma_f32_16x16x32_bf16 a[156:159], v[124:127], v[144:147], a[156:159]
    v_mfma_f32_16x16x32_bf16 a[160:163], v[96:99], v[148:151], a[160:163]
    ds_read_b64_tr_b16 v[92:93], v13 offset:34816
    v_and_b32 v206, s52, v182
    v_mfma_f32_16x16x32_bf16 a[164:167], v[100:103], v[148:151], a[164:167]
    v_and_b32 v207, s52, v184
    v_and_b32 v208, s52, v186
    v_mfma_f32_16x16x32_bf16 a[168:171], v[104:107], v[148:151], a[168:171]
    ds_read_b64_tr_b16 v[94:95], v13 offset:35840
    v_and_b32 v209, s52, v188
    v_mfma_f32_16x16x32_bf16 a[172:175], v[108:111], v[148:151], a[172:175]
    v_mfma_f32_16x16x32_bf16 a[176:179], v[112:115], v[148:151], a[176:179]
    ds_read_b128 v[56:59], v8 offset:45056
    v_and_b32 v210, s52, v190
    v_mfma_f32_16x16x32_bf16 a[180:183], v[116:119], v[148:151], a[180:183]
    v_and_b32 v211, s52, v192
    v_and_b32 v212, s52, v194
    v_mfma_f32_16x16x32_bf16 a[184:187], v[120:123], v[148:151], a[184:187]
    ds_read_b128 v[60:63], v8 offset:47104
    v_and_b32 v213, s52, v196
    v_mfma_f32_16x16x32_bf16 a[188:191], v[124:127], v[148:151], a[188:191]
    v_mfma_f32_16x16x32_bf16 a[192:195], v[96:99], v[152:155], a[192:195]
    v_mul_f32 v221, v221, v206
    v_mul_f32 v222, v222, v207
    v_mfma_f32_16x16x32_bf16 a[196:199], v[100:103], v[152:155], a[196:199]
    v_mul_f32 v223, v223, v208
    v_mul_f32 v224, v224, v209
    v_mfma_f32_16x16x32_bf16 a[200:203], v[104:107], v[152:155], a[200:203]
    v_mul_f32 v225, v225, v210
    v_mul_f32 v226, v226, v211
    v_mfma_f32_16x16x32_bf16 a[204:207], v[108:111], v[152:155], a[204:207]
    v_mfma_f32_16x16x32_bf16 a[208:211], v[112:115], v[152:155], a[208:211]
    v_mul_f32 v227, v227, v212
    v_mul_f32 v228, v228, v213
    v_mfma_f32_16x16x32_bf16 a[212:215], v[116:119], v[152:155], a[212:215]
    v_cvt_pk_bf16_f32 v248, v228, v227
    v_cvt_pk_bf16_f32 v249, v226, v225
    v_mfma_f32_16x16x32_bf16 a[216:219], v[120:123], v[152:155], a[216:219]
    v_cvt_pk_bf16_f32 v250, v224, v223
    v_cvt_pk_bf16_f32 v251, v222, v221
    v_mfma_f32_16x16x32_bf16 a[220:223], v[124:127], v[152:155], a[220:223]
    buffer_store_dwordx4 v[248:251], v234, s[16:19], s54 offen sc1
    v_mfma_f32_16x16x32_bf16 a[224:227], v[96:99], v[156:159], a[224:227]
    s_movk_i32 s54, 9216
    v_lshlrev_b32 v206, 16, v161
    v_lshlrev_b32 v207, 16, v163
    v_mfma_f32_16x16x32_bf16 a[228:231], v[100:103], v[156:159], a[228:231]
    v_lshlrev_b32 v208, 16, v165
    v_lshlrev_b32 v209, 16, v167
    v_mfma_f32_16x16x32_bf16 a[232:235], v[104:107], v[156:159], a[232:235]
    v_lshlrev_b32 v210, 16, v169
    v_lshlrev_b32 v211, 16, v171
    v_mfma_f32_16x16x32_bf16 a[236:239], v[108:111], v[156:159], a[236:239]
    v_mfma_f32_16x16x32_bf16 a[240:243], v[112:115], v[156:159], a[240:243]
    v_lshlrev_b32 v212, 16, v173
    v_lshlrev_b32 v213, 16, v175
    v_mfma_f32_16x16x32_bf16 a[244:247], v[116:119], v[156:159], a[244:247]
    v_lshlrev_b32 v214, 16, v177
    v_lshlrev_b32 v215, 16, v179
    v_mfma_f32_16x16x32_bf16 a[248:251], v[120:123], v[156:159], a[248:251]
    v_lshlrev_b32 v216, 16, v181
    v_lshlrev_b32 v217, 16, v202
    v_mfma_f32_16x16x32_bf16 a[252:255], v[124:127], v[156:159], a[252:255]
    s_waitcnt vmcnt(18) lgkmcnt(0)
    s_barrier
    v_and_b32 v218, s52, v202
    v_lshlrev_b32 v219, 16, v203
    v_mfma_f32_16x16x32_bf16 a[0:3], v[64:67], v[32:35], a[0:3]
    ds_read_b64_tr_b16 v[128:129], v10 offset:49152
    v_and_b32 v220, s52, v203
    v_mfma_f32_16x16x32_bf16 a[4:7], v[64:67], v[36:39], a[4:7]
    s_add_u32 s36, s45, 128
    v_mul_f32 v221, v209, v217
    v_mul_f32 v222, v210, v217
    v_mfma_f32_16x16x32_bf16 a[8:11], v[64:67], v[40:43], a[8:11]
    s_add_u32 m0, s42, 4096
    ds_read_b64_tr_b16 v[130:131], v10 offset:50176
    v_mul_f32 v223, v211, v217
    v_mfma_f32_16x16x32_bf16 a[12:15], v[64:67], v[44:47], a[12:15]
    buffer_load_dwordx4 v17, s[24:27], s36 offen offset:0 lds
    v_mfma_f32_16x16x32_bf16 a[16:19], v[64:67], v[48:51], a[16:19]
    ds_read_b64_tr_b16 v[132:133], v11 offset:49152
    v_mul_f32 v224, v212, v217
    v_mfma_f32_16x16x32_bf16 a[20:23], v[64:67], v[52:55], a[20:23]
    v_mul_f32 v225, v213, v217
    v_mul_f32 v226, v214, v217
    v_mfma_f32_16x16x32_bf16 a[24:27], v[64:67], v[56:59], a[24:27]
    ds_read_b64_tr_b16 v[134:135], v11 offset:50176
    v_mul_f32 v227, v215, v217
    v_mfma_f32_16x16x32_bf16 a[28:31], v[64:67], v[60:63], a[28:31]
    buffer_load_dwordx4 v18, s[24:27], s36 offen offset:1024 lds
    v_mfma_f32_16x16x32_bf16 a[32:35], v[68:71], v[32:35], a[32:35]
    ds_read_b128 v[96:99], v9 offset:32768
    v_mul_f32 v228, v216, v217
    v_mfma_f32_16x16x32_bf16 a[36:39], v[68:71], v[36:39], a[36:39]
    v_fmac_f32 v221, v208, v218
    v_fmac_f32 v222, v209, v218
    v_mfma_f32_16x16x32_bf16 a[40:43], v[68:71], v[40:43], a[40:43]
    ds_read_b64_tr_b16 v[136:137], v12 offset:49152
    v_fmac_f32 v223, v210, v218
    v_mfma_f32_16x16x32_bf16 a[44:47], v[68:71], v[44:47], a[44:47]
    buffer_load_dwordx4 v19, s[24:27], s36 offen offset:2048 lds
    v_mfma_f32_16x16x32_bf16 a[48:51], v[68:71], v[48:51], a[48:51]
    ds_read_b64_tr_b16 v[138:139], v12 offset:50176
    v_fmac_f32 v224, v211, v218
    v_mfma_f32_16x16x32_bf16 a[52:55], v[68:71], v[52:55], a[52:55]
    v_fmac_f32 v225, v212, v218
    v_fmac_f32 v226, v213, v218
    v_mfma_f32_16x16x32_bf16 a[56:59], v[68:71], v[56:59], a[56:59]
    ds_read_b128 v[100:103], v9 offset:34816
    v_fmac_f32 v227, v214, v218
    v_mfma_f32_16x16x32_bf16 a[60:63], v[68:71], v[60:63], a[60:63]
    buffer_load_dwordx4 v20, s[24:27], s36 offen offset:3072 lds
    v_mfma_f32_16x16x32_bf16 a[64:67], v[72:75], v[32:35], a[64:67]
    ds_read_b64_tr_b16 v[140:141], v13 offset:49152
    v_fmac_f32 v228, v215, v218
    v_mfma_f32_16x16x32_bf16 a[68:71], v[72:75], v[36:39], a[68:71]
    s_add_u32 s37, s49, 786432
    v_fmac_f32 v221, v207, v219
    v_fmac_f32 v222, v208, v219
    v_mfma_f32_16x16x32_bf16 a[72:75], v[72:75], v[40:43], a[72:75]
    s_add_u32 m0, s50, 26112
    ds_read_b64_tr_b16 v[142:143], v13 offset:50176
    v_fmac_f32 v223, v209, v219
    v_mfma_f32_16x16x32_bf16 a[76:79], v[72:75], v[44:47], a[76:79]
    buffer_load_dwordx4 v21, s[20:23], s37 offen offset:0 lds
    v_mfma_f32_16x16x32_bf16 a[80:83], v[72:75], v[48:51], a[80:83]
    ds_read_b128 v[104:107], v9 offset:36864
    v_fmac_f32 v224, v210, v219
    v_mfma_f32_16x16x32_bf16 a[84:87], v[72:75], v[52:55], a[84:87]
    v_fmac_f32 v225, v211, v219
    v_fmac_f32 v226, v212, v219
    v_mfma_f32_16x16x32_bf16 a[88:91], v[72:75], v[56:59], a[88:91]
    ds_read_b64_tr_b16 v[144:145], v10 offset:51200
    v_fmac_f32 v227, v213, v219
    v_mfma_f32_16x16x32_bf16 a[92:95], v[72:75], v[60:63], a[92:95]
    buffer_load_dwordx4 v22, s[20:23], s37 offen offset:1024 lds
    v_mfma_f32_16x16x32_bf16 a[96:99], v[76:79], v[32:35], a[96:99]
    ds_read_b64_tr_b16 v[146:147], v10 offset:52224
    v_fmac_f32 v228, v214, v219
    v_mfma_f32_16x16x32_bf16 a[100:103], v[76:79], v[36:39], a[100:103]
    s_add_u32 s37, s49, 1048576
    v_fmac_f32 v221, v206, v220
    v_fmac_f32 v222, v207, v220
    v_mfma_f32_16x16x32_bf16 a[104:107], v[76:79], v[40:43], a[104:107]
    s_add_u32 m0, s50, 34816
    ds_read_b128 v[108:111], v9 offset:38912
    v_fmac_f32 v223, v208, v220
    v_mfma_f32_16x16x32_bf16 a[108:111], v[76:79], v[44:47], a[108:111]
    buffer_load_dwordx4 v21, s[20:23], s37 offen offset:0 lds
    v_mfma_f32_16x16x32_bf16 a[112:115], v[76:79], v[48:51], a[112:115]
    ds_read_b64_tr_b16 v[148:149], v11 offset:51200
    v_fmac_f32 v224, v209, v220
    v_mfma_f32_16x16x32_bf16 a[116:119], v[76:79], v[52:55], a[116:119]
    v_fmac_f32 v225, v210, v220
    v_fmac_f32 v226, v211, v220
    v_mfma_f32_16x16x32_bf16 a[120:123], v[76:79], v[56:59], a[120:123]
    ds_read_b64_tr_b16 v[150:151], v11 offset:52224
    v_fmac_f32 v227, v212, v220
    v_mfma_f32_16x16x32_bf16 a[124:127], v[76:79], v[60:63], a[124:127]
    buffer_load_dwordx4 v22, s[20:23], s37 offen offset:1024 lds
    v_mfma_f32_16x16x32_bf16 a[128:131], v[32:35], v[80:83], a[128:131]
    ds_read_b128 v[112:115], v9 offset:40960
    v_fmac_f32 v228, v213, v220
    v_mfma_f32_16x16x32_bf16 a[132:135], v[36:39], v[80:83], a[132:135]
    v_lshlrev_b32 v206, 16, v183
    v_lshlrev_b32 v207, 16, v185
    v_mfma_f32_16x16x32_bf16 a[136:139], v[40:43], v[80:83], a[136:139]
    ds_read_b64_tr_b16 v[152:153], v12 offset:51200
    v_lshlrev_b32 v208, 16, v187
    v_mfma_f32_16x16x32_bf16 a[140:143], v[44:47], v[80:83], a[140:143]
    v_mfma_f32_16x16x32_bf16 a[144:147], v[48:51], v[80:83], a[144:147]
    ds_read_b64_tr_b16 v[154:155], v12 offset:52224
    v_lshlrev_b32 v209, 16, v189
    v_mfma_f32_16x16x32_bf16 a[148:151], v[52:55], v[80:83], a[148:151]
    v_lshlrev_b32 v210, 16, v191
    v_lshlrev_b32 v211, 16, v193
    v_mfma_f32_16x16x32_bf16 a[152:155], v[56:59], v[80:83], a[152:155]
    ds_read_b128 v[116:119], v9 offset:43008
    v_lshlrev_b32 v212, 16, v195
    v_mfma_f32_16x16x32_bf16 a[156:159], v[60:63], v[80:83], a[156:159]
    v_mfma_f32_16x16x32_bf16 a[160:163], v[32:35], v[84:87], a[160:163]
    ds_read_b64_tr_b16 v[156:157], v13 offset:51200
    v_lshlrev_b32 v213, 16, v197
    v_mfma_f32_16x16x32_bf16 a[164:167], v[36:39], v[84:87], a[164:167]
    v_mul_f32 v221, v221, v206
    v_mul_f32 v222, v222, v207
    v_mfma_f32_16x16x32_bf16 a[168:171], v[40:43], v[84:87], a[168:171]
    ds_read_b64_tr_b16 v[158:159], v13 offset:52224
    v_mul_f32 v223, v223, v208
    v_mfma_f32_16x16x32_bf16 a[172:175], v[44:47], v[84:87], a[172:175]
    v_mfma_f32_16x16x32_bf16 a[176:179], v[48:51], v[84:87], a[176:179]
    ds_read_b128 v[120:123], v9 offset:45056
    v_mul_f32 v224, v224, v209
    v_mfma_f32_16x16x32_bf16 a[180:183], v[52:55], v[84:87], a[180:183]
    v_mul_f32 v225, v225, v210
    v_mul_f32 v226, v226, v211
    v_mfma_f32_16x16x32_bf16 a[184:187], v[56:59], v[84:87], a[184:187]
    ds_read_b128 v[124:127], v9 offset:47104
    v_mul_f32 v227, v227, v212
    v_mfma_f32_16x16x32_bf16 a[188:191], v[60:63], v[84:87], a[188:191]
    v_mfma_f32_16x16x32_bf16 a[192:195], v[32:35], v[88:91], a[192:195]
    v_mul_f32 v228, v228, v213
    v_cvt_pk_bf16_f32 v244, v228, v227
    v_mfma_f32_16x16x32_bf16 a[196:199], v[36:39], v[88:91], a[196:199]
    v_cvt_pk_bf16_f32 v245, v226, v225
    v_cvt_pk_bf16_f32 v246, v224, v223
    v_mfma_f32_16x16x32_bf16 a[200:203], v[40:43], v[88:91], a[200:203]
    v_cvt_pk_bf16_f32 v247, v222, v221
    v_and_b32 v206, s52, v161
    v_mfma_f32_16x16x32_bf16 a[204:207], v[44:47], v[88:91], a[204:207]
    buffer_store_dwordx4 v[244:247], v234, s[16:19], s54 offen sc1
    v_mfma_f32_16x16x32_bf16 a[208:211], v[48:51], v[88:91], a[208:211]
    s_movk_i32 s54, 13824
    v_and_b32 v207, s52, v163
    v_and_b32 v208, s52, v165
    v_mfma_f32_16x16x32_bf16 a[212:215], v[52:55], v[88:91], a[212:215]
    v_and_b32 v209, s52, v167
    v_and_b32 v210, s52, v169
    v_mfma_f32_16x16x32_bf16 a[216:219], v[56:59], v[88:91], a[216:219]
    v_and_b32 v211, s52, v171
    v_and_b32 v212, s52, v173
    v_mfma_f32_16x16x32_bf16 a[220:223], v[60:63], v[88:91], a[220:223]
    v_mfma_f32_16x16x32_bf16 a[224:227], v[32:35], v[92:95], a[224:227]
    v_and_b32 v213, s52, v175
    v_and_b32 v214, s52, v177
    v_mfma_f32_16x16x32_bf16 a[228:231], v[36:39], v[92:95], a[228:231]
    v_and_b32 v215, s52, v179
    v_and_b32 v216, s52, v181
    v_mfma_f32_16x16x32_bf16 a[232:235], v[40:43], v[92:95], a[232:235]
    v_lshlrev_b32 v217, 16, v204
    v_and_b32 v218, s52, v204
    v_mfma_f32_16x16x32_bf16 a[236:239], v[44:47], v[92:95], a[236:239]
    v_mfma_f32_16x16x32_bf16 a[240:243], v[48:51], v[92:95], a[240:243]
    v_lshlrev_b32 v219, 16, v205
    v_and_b32 v220, s52, v205
    v_mfma_f32_16x16x32_bf16 a[244:247], v[52:55], v[92:95], a[244:247]
    v_mul_f32 v221, v209, v217
    v_mul_f32 v222, v210, v217
    v_mfma_f32_16x16x32_bf16 a[248:251], v[56:59], v[92:95], a[248:251]
    v_mul_f32 v223, v211, v217
    v_mul_f32 v224, v212, v217
    v_mfma_f32_16x16x32_bf16 a[252:255], v[60:63], v[92:95], a[252:255]
    s_waitcnt vmcnt(19) lgkmcnt(0)
    s_barrier
    v_mul_f32 v225, v213, v217
    v_mul_f32 v226, v214, v217
    v_mfma_f32_16x16x32_bf16 a[0:3], v[128:131], v[96:99], a[0:3]
    ds_read_b64_tr_b16 v[48:49], v27 offset:0
    v_mul_f32 v227, v215, v217
    v_mfma_f32_16x16x32_bf16 a[4:7], v[128:131], v[100:103], a[4:7]
    s_add_u32 s36, s44, 256
    v_mul_f32 v228, v216, v217
    v_fmac_f32 v221, v208, v218
    v_mfma_f32_16x16x32_bf16 a[8:11], v[128:131], v[104:107], a[8:11]
    s_add_u32 m0, s42, 32768
    ds_read_b64_tr_b16 v[50:51], v27 offset:1024
    v_fmac_f32 v222, v209, v218
    v_mfma_f32_16x16x32_bf16 a[12:15], v[128:131], v[108:111], a[12:15]
    buffer_load_dwordx4 v17, s[24:27], s36 offen offset:0 lds
    v_mfma_f32_16x16x32_bf16 a[16:19], v[128:131], v[112:115], a[16:19]
    ds_read_b128 v[32:35], v25 offset:0
    v_fmac_f32 v223, v210, v218
    v_mfma_f32_16x16x32_bf16 a[20:23], v[128:131], v[116:119], a[20:23]
    v_fmac_f32 v224, v211, v218
    v_fmac_f32 v225, v212, v218
    v_mfma_f32_16x16x32_bf16 a[24:27], v[128:131], v[120:123], a[24:27]
    ds_read_b128 v[36:39], v25 offset:2048
    v_fmac_f32 v226, v213, v218
    v_mfma_f32_16x16x32_bf16 a[28:31], v[128:131], v[124:127], a[28:31]
    buffer_load_dwordx4 v18, s[24:27], s36 offen offset:1024 lds
    v_mfma_f32_16x16x32_bf16 a[32:35], v[132:135], v[96:99], a[32:35]
    ds_read_b128 v[40:43], v25 offset:4096
    v_fmac_f32 v227, v214, v218
    v_mfma_f32_16x16x32_bf16 a[36:39], v[132:135], v[100:103], a[36:39]
    v_fmac_f32 v228, v215, v218
    v_fmac_f32 v221, v207, v219
    v_mfma_f32_16x16x32_bf16 a[40:43], v[132:135], v[104:107], a[40:43]
    ds_read_b128 v[44:47], v25 offset:6144
    v_fmac_f32 v222, v208, v219
    v_mfma_f32_16x16x32_bf16 a[44:47], v[132:135], v[108:111], a[44:47]
    buffer_load_dwordx4 v19, s[24:27], s36 offen offset:2048 lds
    v_mfma_f32_16x16x32_bf16 a[48:51], v[132:135], v[112:115], a[48:51]
    ds_read_b64_tr_b16 v[52:53], v28 offset:0
    v_fmac_f32 v223, v209, v219
    v_mfma_f32_16x16x32_bf16 a[52:55], v[132:135], v[116:119], a[52:55]
    v_fmac_f32 v224, v210, v219
    v_fmac_f32 v225, v211, v219
    v_mfma_f32_16x16x32_bf16 a[56:59], v[132:135], v[120:123], a[56:59]
    ds_read_b64_tr_b16 v[54:55], v28 offset:1024
    v_fmac_f32 v226, v212, v219
    v_mfma_f32_16x16x32_bf16 a[60:63], v[132:135], v[124:127], a[60:63]
    buffer_load_dwordx4 v20, s[24:27], s36 offen offset:3072 lds
    v_mfma_f32_16x16x32_bf16 a[64:67], v[136:139], v[96:99], a[64:67]
    ds_read_b64_tr_b16 v[56:57], v29 offset:0
    v_fmac_f32 v227, v213, v219
    v_mfma_f32_16x16x32_bf16 a[68:71], v[136:139], v[100:103], a[68:71]
    v_fmac_f32 v228, v214, v219
    v_fmac_f32 v221, v206, v220
    v_mfma_f32_16x16x32_bf16 a[72:75], v[136:139], v[104:107], a[72:75]
    ds_read_b64_tr_b16 v[58:59], v29 offset:1024
    v_fmac_f32 v222, v207, v220
    v_mfma_f32_16x16x32_bf16 a[76:79], v[136:139], v[108:111], a[76:79]
    v_mfma_f32_16x16x32_bf16 a[80:83], v[136:139], v[112:115], a[80:83]
    ds_read_b64_tr_b16 v[60:61], v30 offset:0
    v_fmac_f32 v223, v208, v220
    v_mfma_f32_16x16x32_bf16 a[84:87], v[136:139], v[116:119], a[84:87]
    v_fmac_f32 v224, v209, v220
    v_fmac_f32 v225, v210, v220
    v_mfma_f32_16x16x32_bf16 a[88:91], v[136:139], v[120:123], a[88:91]
    ds_read_b64_tr_b16 v[62:63], v30 offset:1024
    v_fmac_f32 v226, v211, v220
    v_mfma_f32_16x16x32_bf16 a[92:95], v[136:139], v[124:127], a[92:95]
    v_mfma_f32_16x16x32_bf16 a[96:99], v[140:143], v[96:99], a[96:99]
    ds_read_b64_tr_b16 v[64:65], v27 offset:128
    v_fmac_f32 v227, v212, v220
    v_mfma_f32_16x16x32_bf16 a[100:103], v[140:143], v[100:103], a[100:103]
    v_fmac_f32 v228, v213, v220
    v_and_b32 v206, s52, v183
    v_mfma_f32_16x16x32_bf16 a[104:107], v[140:143], v[104:107], a[104:107]
    ds_read_b64_tr_b16 v[66:67], v27 offset:1152
    v_and_b32 v207, s52, v185
    v_mfma_f32_16x16x32_bf16 a[108:111], v[140:143], v[108:111], a[108:111]
    v_mfma_f32_16x16x32_bf16 a[112:115], v[140:143], v[112:115], a[112:115]
    ds_read_b64_tr_b16 v[68:69], v28 offset:128
    v_and_b32 v208, s52, v187
    v_mfma_f32_16x16x32_bf16 a[116:119], v[140:143], v[116:119], a[116:119]
    v_and_b32 v209, s52, v189
    v_and_b32 v210, s52, v191
    v_mfma_f32_16x16x32_bf16 a[120:123], v[140:143], v[120:123], a[120:123]
    ds_read_b64_tr_b16 v[70:71], v28 offset:1152
    v_and_b32 v211, s52, v193
    v_mfma_f32_16x16x32_bf16 a[124:127], v[140:143], v[124:127], a[124:127]
    v_mfma_f32_16x16x32_bf16 a[128:131], v[96:99], v[144:147], a[128:131]
    ds_read_b64_tr_b16 v[72:73], v29 offset:128
    v_and_b32 v212, s52, v195
    v_mfma_f32_16x16x32_bf16 a[132:135], v[100:103], v[144:147], a[132:135]
    v_and_b32 v213, s52, v197
    v_mul_f32 v221, v221, v206
    v_mfma_f32_16x16x32_bf16 a[136:139], v[104:107], v[144:147], a[136:139]
    ds_read_b64_tr_b16 v[74:75], v29 offset:1152
    v_mul_f32 v222, v222, v207
    v_mfma_f32_16x16x32_bf16 a[140:143], v[108:111], v[144:147], a[140:143]
    v_mfma_f32_16x16x32_bf16 a[144:147], v[112:115], v[144:147], a[144:147]
    ds_read_b64_tr_b16 v[76:77], v30 offset:128
    v_mul_f32 v223, v223, v208
    v_mfma_f32_16x16x32_bf16 a[148:151], v[116:119], v[144:147], a[148:151]
    v_mul_f32 v224, v224, v209
    v_mul_f32 v225, v225, v210
    v_mfma_f32_16x16x32_bf16 a[152:155], v[120:123], v[144:147], a[152:155]
    ds_read_b64_tr_b16 v[78:79], v30 offset:1152
    v_mul_f32 v226, v226, v211
    v_mfma_f32_16x16x32_bf16 a[156:159], v[124:127], v[144:147], a[156:159]
    v_mfma_f32_16x16x32_bf16 a[160:163], v[96:99], v[148:151], a[160:163]
    v_mul_f32 v227, v227, v212
    v_mul_f32 v228, v228, v213
    v_mfma_f32_16x16x32_bf16 a[164:167], v[100:103], v[148:151], a[164:167]
    v_cvt_pk_bf16_f32 v248, v228, v227
    v_cvt_pk_bf16_f32 v249, v226, v225
    v_mfma_f32_16x16x32_bf16 a[168:171], v[104:107], v[148:151], a[168:171]
    v_cvt_pk_bf16_f32 v250, v224, v223
    v_cvt_pk_bf16_f32 v251, v222, v221
    v_mfma_f32_16x16x32_bf16 a[172:175], v[108:111], v[148:151], a[172:175]
    buffer_store_dwordx4 v[248:251], v234, s[16:19], s54 offen sc1
    v_mfma_f32_16x16x32_bf16 a[176:179], v[112:115], v[148:151], a[176:179]
    v_mov_b32 v160, 0
    v_mov_b32 v161, 0
    v_mfma_f32_16x16x32_bf16 a[180:183], v[116:119], v[148:151], a[180:183]
    v_mov_b32 v162, 0
    v_mov_b32 v163, 0
    v_mfma_f32_16x16x32_bf16 a[184:187], v[120:123], v[148:151], a[184:187]
    v_mfma_f32_16x16x32_bf16 a[188:191], v[124:127], v[148:151], a[188:191]
    buffer_store_dwordx4 v[160:163], v235, s[16:19], s53 offen sc1
    v_mfma_f32_16x16x32_bf16 a[192:195], v[96:99], v[152:155], a[192:195]
    v_mfma_f32_16x16x32_bf16 a[196:199], v[100:103], v[152:155], a[196:199]
    v_mfma_f32_16x16x32_bf16 a[200:203], v[104:107], v[152:155], a[200:203]
    v_mfma_f32_16x16x32_bf16 a[204:207], v[108:111], v[152:155], a[204:207]
    v_mfma_f32_16x16x32_bf16 a[208:211], v[112:115], v[152:155], a[208:211]
    v_mfma_f32_16x16x32_bf16 a[212:215], v[116:119], v[152:155], a[212:215]
    v_mfma_f32_16x16x32_bf16 a[216:219], v[120:123], v[152:155], a[216:219]
    v_mfma_f32_16x16x32_bf16 a[220:223], v[124:127], v[152:155], a[220:223]
    v_mfma_f32_16x16x32_bf16 a[224:227], v[96:99], v[156:159], a[224:227]
    v_mfma_f32_16x16x32_bf16 a[228:231], v[100:103], v[156:159], a[228:231]
    v_mfma_f32_16x16x32_bf16 a[232:235], v[104:107], v[156:159], a[232:235]
    v_mfma_f32_16x16x32_bf16 a[236:239], v[108:111], v[156:159], a[236:239]
    v_mfma_f32_16x16x32_bf16 a[240:243], v[112:115], v[156:159], a[240:243]
    v_mfma_f32_16x16x32_bf16 a[244:247], v[116:119], v[156:159], a[244:247]
    v_mfma_f32_16x16x32_bf16 a[248:251], v[120:123], v[156:159], a[248:251]
    v_mfma_f32_16x16x32_bf16 a[252:255], v[124:127], v[156:159], a[252:255]
    s_waitcnt vmcnt(19) lgkmcnt(0)
    s_barrier
    v_mfma_f32_16x16x32_bf16 v[128:131], v[48:51], v[32:35], 0
    s_lshl_b32 s38, s33, 6
    ds_read_b64_tr_b16 v[96:97], v27 offset:8704
    ds_read_b64_tr_b16 v[98:99], v27 offset:9728
    v_mfma_f32_16x16x32_bf16 v[160:163], v[48:51], v[36:39], 0
    s_add_u32 s36, s45, 256
    v_mfma_f32_16x16x32_bf16 v[192:195], v[48:51], v[40:43], 0
    s_add_u32 m0, s42, 36864
    ds_read_b128 v[80:83], v26 offset:0
    ds_read_b128 v[84:87], v26 offset:2048
    v_mfma_f32_16x16x32_bf16 v[224:227], v[48:51], v[44:47], 0
    buffer_load_dwordx4 v17, s[24:27], s36 offen offset:0 lds
    v_mfma_f32_16x16x32_bf16 v[132:135], v[52:55], v[32:35], 0
    s_lshl_b32 s54, s34, 3
    ds_read_b128 v[88:91], v26 offset:4096
    ds_read_b128 v[92:95], v26 offset:6144
    v_mfma_f32_16x16x32_bf16 v[164:167], v[52:55], v[36:39], 0
    s_add_u32 s38, s38, s54
    v_accvgpr_read_b32 v4, a132
    v_accvgpr_read_b32 v5, a133
    v_mfma_f32_16x16x32_bf16 v[196:199], v[52:55], v[40:43], 0
    s_lshr_b32 s54, s32, 1
    ds_read_b64_tr_b16 v[100:101], v28 offset:8704
    ds_read_b64_tr_b16 v[102:103], v28 offset:9728
    v_mfma_f32_16x16x32_bf16 v[228:231], v[52:55], v[44:47], 0
    buffer_load_dwordx4 v18, s[24:27], s36 offen offset:1024 lds
    v_mfma_f32_16x16x32_bf16 v[136:139], v[56:59], v[32:35], 0
    s_lshl_b32 s54, s54, 2
    ds_read_b64_tr_b16 v[104:105], v29 offset:8704
    ds_read_b64_tr_b16 v[106:107], v29 offset:9728
    v_mfma_f32_16x16x32_bf16 v[168:171], v[56:59], v[36:39], 0
    s_add_u32 s38, s38, s54
    v_accvgpr_read_b32 v6, a134
    v_accvgpr_read_b32 v7, a135
    v_mfma_f32_16x16x32_bf16 v[200:203], v[56:59], v[40:43], 0
    s_lshl_b32 s38, s38, 14
    ds_read_b64_tr_b16 v[108:109], v30 offset:8704
    ds_read_b64_tr_b16 v[110:111], v30 offset:9728
    v_mfma_f32_16x16x32_bf16 v[232:235], v[56:59], v[44:47], 0
    v_mfma_f32_16x16x32_bf16 v[140:143], v[60:63], v[32:35], 0
    s_and_b32 s54, s32, 1
    ds_read_b64_tr_b16 v[112:113], v27 offset:8832
    ds_read_b64_tr_b16 v[114:115], v27 offset:9856
    v_mfma_f32_16x16x32_bf16 v[172:175], v[60:63], v[36:39], 0
    s_lshl_b32 s54, s54, 11
    v_accvgpr_read_b32 v0, a128
    v_accvgpr_read_b32 v1, a129
    v_mfma_f32_16x16x32_bf16 v[204:207], v[60:63], v[40:43], 0
    s_add_u32 s41, s38, s54
    ds_read_b64_tr_b16 v[116:117], v28 offset:8832
    ds_read_b64_tr_b16 v[118:119], v28 offset:9856
    v_mfma_f32_16x16x32_bf16 v[236:239], v[60:63], v[44:47], 0
    buffer_load_dwordx4 v19, s[24:27], s36 offen offset:2048 lds
    v_mfma_f32_16x16x32_bf16 v[144:147], v[64:67], v[32:35], 0
    s_add_u32 s38, s41, s54
    ds_read_b64_tr_b16 v[120:121], v29 offset:8832
    ds_read_b64_tr_b16 v[122:123], v29 offset:9856
    v_mfma_f32_16x16x32_bf16 v[176:179], v[64:67], v[36:39], 0
    s_add_u32 s38, s38, 8192
    v_accvgpr_read_b32 v2, a130
    v_accvgpr_read_b32 v3, a131
    v_mfma_f32_16x16x32_bf16 v[208:211], v[64:67], v[40:43], 0
    s_mov_b32 s40, 0x3e0293ee
    ds_read_b64_tr_b16 v[124:125], v30 offset:8832
    ds_read_b64_tr_b16 v[126:127], v30 offset:9856
    v_mfma_f32_16x16x32_bf16 v[240:243], v[64:67], v[44:47], 0
    s_mov_b32 s16, s94
    v_cvt_pk_bf16_f32 v0, v0, v1
    v_cvt_pk_bf16_f32 v1, v2, v3
    v_mfma_f32_16x16x32_bf16 v[148:151], v[68:71], v[32:35], 0
    s_mov_b32 s17, s95
    v_cvt_pk_bf16_f32 v2, v4, v5
    v_cvt_pk_bf16_f32 v3, v6, v7
    v_mfma_f32_16x16x32_bf16 v[180:183], v[68:71], v[36:39], 0
gated_mix__ssm_conv_h3__compressed_kv_cla__prompt_kernel_pad3:
    s_cbranch_execz gated_mix__ssm_conv_h3__compressed_kv_cla__prompt_kernel_pad7
    buffer_load_dwordx4 v20, s[24:27], s36 offen offset:3072 lds
    v_mfma_f32_16x16x32_bf16 v[212:215], v[68:71], v[40:43], 0
    s_add_u32 s37, s49, 1310720
    v_accvgpr_read_b32 v12, a32
    v_accvgpr_read_b32 v13, a33
    v_mfma_f32_16x16x32_bf16 v[244:247], v[68:71], v[44:47], 0
    s_add_u32 m0, s50, 43520
    v_accvgpr_read_b32 v14, a34
    v_accvgpr_read_b32 v15, a35
    v_mfma_f32_16x16x32_bf16 v[152:155], v[72:75], v[32:35], 0
    buffer_load_dwordx4 v21, s[20:23], s37 offen offset:0 lds
    v_mfma_f32_16x16x32_bf16 v[184:187], v[72:75], v[36:39], 0
    s_mov_b32 s18, 33554432
    v_accvgpr_read_b32 v8, a0
    v_accvgpr_read_b32 v9, a1
    v_mfma_f32_16x16x32_bf16 v[216:219], v[72:75], v[40:43], 0
    v_accvgpr_read_b32 v10, a2
    v_accvgpr_read_b32 v11, a3
    v_mfma_f32_16x16x32_bf16 v[248:251], v[72:75], v[44:47], 0
    buffer_store_dwordx4 v[0:3], v16, s[16:19], s38 offen offset:0
    v_mfma_f32_16x16x32_bf16 v[156:159], v[76:79], v[32:35], 0
    v_mul_f32 v8, s40, v8
    v_mul_f32 v9, s40, v9
    v_mfma_f32_16x16x32_bf16 v[188:191], v[76:79], v[36:39], 0
    v_mul_f32 v10, s40, v10
    v_mul_f32 v11, s40, v11
    v_mfma_f32_16x16x32_bf16 v[220:223], v[76:79], v[40:43], 0
    buffer_load_dwordx4 v22, s[20:23], s37 offen offset:1024 lds
    v_mfma_f32_16x16x32_bf16 v[252:255], v[76:79], v[44:47], 0
    s_waitcnt vmcnt(16) lgkmcnt(0)
    s_barrier
    v_mul_f32 v12, s40, v12
    v_mul_f32 v13, s40, v13
    v_mfma_f32_16x16x32_bf16 v[128:131], v[96:99], v[80:83], v[128:131]
    ds_read_b64_tr_b16 v[48:49], v27 offset:17408
    ds_read_b64_tr_b16 v[50:51], v27 offset:18432
    v_mfma_f32_16x16x32_bf16 v[160:163], v[96:99], v[84:87], v[160:163]
    s_add_u32 s36, s44, 384
    v_mul_f32 v14, s40, v14
    v_mul_f32 v15, s40, v15
    v_mfma_f32_16x16x32_bf16 v[192:195], v[96:99], v[88:91], v[192:195]
    s_add_u32 m0, s42, 65536
    ds_read_b128 v[32:35], v23 offset:0
    ds_read_b128 v[36:39], v23 offset:2048
    v_mfma_f32_16x16x32_bf16 v[224:227], v[96:99], v[92:95], v[224:227]
    buffer_load_dwordx4 v17, s[24:27], s36 offen offset:0 lds
    v_mfma_f32_16x16x32_bf16 v[132:135], v[100:103], v[80:83], v[132:135]
    ds_read_b128 v[40:43], v23 offset:4096
    ds_read_b128 v[44:47], v23 offset:6144
    v_mfma_f32_16x16x32_bf16 v[164:167], v[100:103], v[84:87], v[164:167]
    v_cvt_pk_bf16_f32 v8, v8, v9
    v_cvt_pk_bf16_f32 v9, v10, v11
    v_mfma_f32_16x16x32_bf16 v[196:199], v[100:103], v[88:91], v[196:199]
    ds_read_b64_tr_b16 v[52:53], v28 offset:17408
    ds_read_b64_tr_b16 v[54:55], v28 offset:18432
    v_mfma_f32_16x16x32_bf16 v[228:231], v[100:103], v[92:95], v[228:231]
    buffer_load_dwordx4 v18, s[24:27], s36 offen offset:1024 lds
    v_mfma_f32_16x16x32_bf16 v[136:139], v[104:107], v[80:83], v[136:139]
    ds_read_b64_tr_b16 v[56:57], v29 offset:17408
    ds_read_b64_tr_b16 v[58:59], v29 offset:18432
    v_mfma_f32_16x16x32_bf16 v[168:171], v[104:107], v[84:87], v[168:171]
    v_cvt_pk_bf16_f32 v10, v12, v13
    v_cvt_pk_bf16_f32 v11, v14, v15
    v_mfma_f32_16x16x32_bf16 v[200:203], v[104:107], v[88:91], v[200:203]
    ds_read_b64_tr_b16 v[60:61], v30 offset:17408
    ds_read_b64_tr_b16 v[62:63], v30 offset:18432
    v_mfma_f32_16x16x32_bf16 v[232:235], v[104:107], v[92:95], v[232:235]
    buffer_store_dwordx4 v[8:11], v16, s[16:19], s41 offen offset:0
    v_mfma_f32_16x16x32_bf16 v[140:143], v[108:111], v[80:83], v[140:143]
    ds_read_b64_tr_b16 v[64:65], v27 offset:17536
    ds_read_b64_tr_b16 v[66:67], v27 offset:18560
    v_mfma_f32_16x16x32_bf16 v[172:175], v[108:111], v[84:87], v[172:175]
    v_accvgpr_read_b32 v4, a164
    v_accvgpr_read_b32 v5, a165
    v_mfma_f32_16x16x32_bf16 v[204:207], v[108:111], v[88:91], v[204:207]
    ds_read_b64_tr_b16 v[68:69], v28 offset:17536
    ds_read_b64_tr_b16 v[70:71], v28 offset:18560
    v_mfma_f32_16x16x32_bf16 v[236:239], v[108:111], v[92:95], v[236:239]
    buffer_load_dwordx4 v19, s[24:27], s36 offen offset:2048 lds
    v_mfma_f32_16x16x32_bf16 v[144:147], v[112:115], v[80:83], v[144:147]
    ds_read_b64_tr_b16 v[72:73], v29 offset:17536
    ds_read_b64_tr_b16 v[74:75], v29 offset:18560
    v_mfma_f32_16x16x32_bf16 v[176:179], v[112:115], v[84:87], v[176:179]
    v_accvgpr_read_b32 v6, a166
    v_accvgpr_read_b32 v7, a167
    v_mfma_f32_16x16x32_bf16 v[208:211], v[112:115], v[88:91], v[208:211]
    ds_read_b64_tr_b16 v[76:77], v30 offset:17536
    ds_read_b64_tr_b16 v[78:79], v30 offset:18560
    v_mfma_f32_16x16x32_bf16 v[240:243], v[112:115], v[92:95], v[240:243]
    v_accvgpr_read_b32 v0, a160
    v_accvgpr_read_b32 v1, a161
    v_mfma_f32_16x16x32_bf16 v[148:151], v[116:119], v[80:83], v[148:151]
    v_accvgpr_read_b32 v2, a162
    v_accvgpr_read_b32 v3, a163
    v_mfma_f32_16x16x32_bf16 v[180:183], v[116:119], v[84:87], v[180:183]
    buffer_load_dwordx4 v20, s[24:27], s36 offen offset:3072 lds
    v_mfma_f32_16x16x32_bf16 v[212:215], v[116:119], v[88:91], v[212:215]
    s_add_u32 s37, s49, 1572864
    v_cvt_pk_bf16_f32 v0, v0, v1
    v_cvt_pk_bf16_f32 v1, v2, v3
    v_mfma_f32_16x16x32_bf16 v[244:247], v[116:119], v[92:95], v[244:247]
    s_add_u32 m0, s50, 0
    v_cvt_pk_bf16_f32 v2, v4, v5
    v_cvt_pk_bf16_f32 v3, v6, v7
    v_mfma_f32_16x16x32_bf16 v[152:155], v[120:123], v[80:83], v[152:155]
    buffer_load_dwordx4 v21, s[20:23], s37 offen offset:0 lds
    v_mfma_f32_16x16x32_bf16 v[184:187], v[120:123], v[84:87], v[184:187]
    v_accvgpr_read_b32 v12, a96
    v_accvgpr_read_b32 v13, a97
    v_mfma_f32_16x16x32_bf16 v[216:219], v[120:123], v[88:91], v[216:219]
    v_accvgpr_read_b32 v14, a98
    v_accvgpr_read_b32 v15, a99
    v_mfma_f32_16x16x32_bf16 v[248:251], v[120:123], v[92:95], v[248:251]
    buffer_store_dwordx4 v[0:3], v16, s[16:19], s38 offen offset:1024
    v_mfma_f32_16x16x32_bf16 v[156:159], v[124:127], v[80:83], v[156:159]
    v_accvgpr_read_b32 v8, a64
    v_accvgpr_read_b32 v9, a65
    v_mfma_f32_16x16x32_bf16 v[188:191], v[124:127], v[84:87], v[188:191]
    v_accvgpr_read_b32 v10, a66
    v_accvgpr_read_b32 v11, a67
    v_mfma_f32_16x16x32_bf16 v[220:223], v[124:127], v[88:91], v[220:223]
    buffer_load_dwordx4 v22, s[20:23], s37 offen offset:1024 lds
    v_mfma_f32_16x16x32_bf16 v[252:255], v[124:127], v[92:95], v[252:255]
    s_waitcnt lgkmcnt(0)
    v_mul_f32 v8, s40, v8
    v_mul_f32 v9, s40, v9
    v_mfma_f32_16x16x32_bf16 v[128:131], v[48:51], v[32:35], v[128:131]
    ds_read_b64_tr_b16 v[96:97], v27 offset:26112
    ds_read_b64_tr_b16 v[98:99], v27 offset:27136
    v_mfma_f32_16x16x32_bf16 v[160:163], v[48:51], v[36:39], v[160:163]
    s_add_u32 s36, s45, 384
    v_mul_f32 v10, s40, v10
    v_mul_f32 v11, s40, v11
    v_mfma_f32_16x16x32_bf16 v[192:195], v[48:51], v[40:43], v[192:195]
    s_add_u32 m0, s42, 69632
    ds_read_b128 v[80:83], v24 offset:0
    ds_read_b128 v[84:87], v24 offset:2048
    v_mfma_f32_16x16x32_bf16 v[224:227], v[48:51], v[44:47], v[224:227]
    buffer_load_dwordx4 v17, s[24:27], s36 offen offset:0 lds
    v_mfma_f32_16x16x32_bf16 v[132:135], v[52:55], v[32:35], v[132:135]
    ds_read_b128 v[88:91], v24 offset:4096
    ds_read_b128 v[92:95], v24 offset:6144
    v_mfma_f32_16x16x32_bf16 v[164:167], v[52:55], v[36:39], v[164:167]
    v_mul_f32 v12, s40, v12
    v_mul_f32 v13, s40, v13
    v_mfma_f32_16x16x32_bf16 v[196:199], v[52:55], v[40:43], v[196:199]
    ds_read_b64_tr_b16 v[100:101], v28 offset:26112
    ds_read_b64_tr_b16 v[102:103], v28 offset:27136
    v_mfma_f32_16x16x32_bf16 v[228:231], v[52:55], v[44:47], v[228:231]
    buffer_load_dwordx4 v18, s[24:27], s36 offen offset:1024 lds
    v_mfma_f32_16x16x32_bf16 v[136:139], v[56:59], v[32:35], v[136:139]
    ds_read_b64_tr_b16 v[104:105], v29 offset:26112
    ds_read_b64_tr_b16 v[106:107], v29 offset:27136
    v_mfma_f32_16x16x32_bf16 v[168:171], v[56:59], v[36:39], v[168:171]
    v_mul_f32 v14, s40, v14
    v_mul_f32 v15, s40, v15
    v_mfma_f32_16x16x32_bf16 v[200:203], v[56:59], v[40:43], v[200:203]
    ds_read_b64_tr_b16 v[108:109], v30 offset:26112
    ds_read_b64_tr_b16 v[110:111], v30 offset:27136
    v_mfma_f32_16x16x32_bf16 v[232:235], v[56:59], v[44:47], v[232:235]
    v_mfma_f32_16x16x32_bf16 v[140:143], v[60:63], v[32:35], v[140:143]
    ds_read_b64_tr_b16 v[112:113], v27 offset:26240
    ds_read_b64_tr_b16 v[114:115], v27 offset:27264
    v_mfma_f32_16x16x32_bf16 v[172:175], v[60:63], v[36:39], v[172:175]
    v_cvt_pk_bf16_f32 v8, v8, v9
    v_cvt_pk_bf16_f32 v9, v10, v11
    v_mfma_f32_16x16x32_bf16 v[204:207], v[60:63], v[40:43], v[204:207]
    ds_read_b64_tr_b16 v[116:117], v28 offset:26240
    ds_read_b64_tr_b16 v[118:119], v28 offset:27264
    v_mfma_f32_16x16x32_bf16 v[236:239], v[60:63], v[44:47], v[236:239]
    buffer_load_dwordx4 v19, s[24:27], s36 offen offset:2048 lds
    v_mfma_f32_16x16x32_bf16 v[144:147], v[64:67], v[32:35], v[144:147]
    ds_read_b64_tr_b16 v[120:121], v29 offset:26240
    ds_read_b64_tr_b16 v[122:123], v29 offset:27264
    v_mfma_f32_16x16x32_bf16 v[176:179], v[64:67], v[36:39], v[176:179]
    v_cvt_pk_bf16_f32 v10, v12, v13
    v_cvt_pk_bf16_f32 v11, v14, v15
    v_mfma_f32_16x16x32_bf16 v[208:211], v[64:67], v[40:43], v[208:211]
    ds_read_b64_tr_b16 v[124:125], v30 offset:26240
    ds_read_b64_tr_b16 v[126:127], v30 offset:27264
    v_mfma_f32_16x16x32_bf16 v[240:243], v[64:67], v[44:47], v[240:243]
    v_accvgpr_read_b32 v4, a196
    v_accvgpr_read_b32 v5, a197
    v_mfma_f32_16x16x32_bf16 v[148:151], v[68:71], v[32:35], v[148:151]
    v_accvgpr_read_b32 v6, a198
    v_accvgpr_read_b32 v7, a199
    v_mfma_f32_16x16x32_bf16 v[180:183], v[68:71], v[36:39], v[180:183]
    buffer_load_dwordx4 v20, s[24:27], s36 offen offset:3072 lds
    v_mfma_f32_16x16x32_bf16 v[212:215], v[68:71], v[40:43], v[212:215]
    s_add_u32 s37, s49, 1835008
    v_accvgpr_read_b32 v0, a192
    v_accvgpr_read_b32 v1, a193
    v_mfma_f32_16x16x32_bf16 v[244:247], v[68:71], v[44:47], v[244:247]
    s_add_u32 m0, s50, 8704
    v_accvgpr_read_b32 v2, a194
    v_accvgpr_read_b32 v3, a195
    v_mfma_f32_16x16x32_bf16 v[152:155], v[72:75], v[32:35], v[152:155]
    buffer_load_dwordx4 v21, s[20:23], s37 offen offset:0 lds
    v_mfma_f32_16x16x32_bf16 v[184:187], v[72:75], v[36:39], v[184:187]
    v_cvt_pk_bf16_f32 v0, v0, v1
    v_cvt_pk_bf16_f32 v1, v2, v3
    v_mfma_f32_16x16x32_bf16 v[216:219], v[72:75], v[40:43], v[216:219]
    v_cvt_pk_bf16_f32 v2, v4, v5
    v_cvt_pk_bf16_f32 v3, v6, v7
    v_mfma_f32_16x16x32_bf16 v[248:251], v[72:75], v[44:47], v[248:251]
    buffer_store_dwordx4 v[8:11], v16, s[16:19], s41 offen offset:1024
    v_mfma_f32_16x16x32_bf16 v[156:159], v[76:79], v[32:35], v[156:159]
    s_add_u32 s41, s41, 4096
    v_accvgpr_read_b32 v12, a36
    v_accvgpr_read_b32 v13, a37
    v_mfma_f32_16x16x32_bf16 v[188:191], v[76:79], v[36:39], v[188:191]
    v_accvgpr_read_b32 v14, a38
    v_accvgpr_read_b32 v15, a39
    v_mfma_f32_16x16x32_bf16 v[220:223], v[76:79], v[40:43], v[220:223]
    buffer_load_dwordx4 v22, s[20:23], s37 offen offset:1024 lds
    v_mfma_f32_16x16x32_bf16 v[252:255], v[76:79], v[44:47], v[252:255]
    s_waitcnt vmcnt(15) lgkmcnt(0)
    s_barrier
    v_accvgpr_read_b32 v8, a4
    v_accvgpr_read_b32 v9, a5
    v_mfma_f32_16x16x32_bf16 v[128:131], v[96:99], v[80:83], v[128:131]
    ds_read_b64_tr_b16 v[48:49], v27 offset:34816
    ds_read_b64_tr_b16 v[50:51], v27 offset:35840
    v_mfma_f32_16x16x32_bf16 v[160:163], v[96:99], v[84:87], v[160:163]
    s_add_u32 s36, s44, 512
    v_accvgpr_read_b32 v10, a6
    v_accvgpr_read_b32 v11, a7
    v_mfma_f32_16x16x32_bf16 v[192:195], v[96:99], v[88:91], v[192:195]
    s_add_u32 m0, s42, 0
    ds_read_b128 v[32:35], v23 offset:32768
    ds_read_b128 v[36:39], v23 offset:34816
    v_mfma_f32_16x16x32_bf16 v[224:227], v[96:99], v[92:95], v[224:227]
    buffer_load_dwordx4 v17, s[24:27], s36 offen offset:0 lds
    v_mfma_f32_16x16x32_bf16 v[132:135], v[100:103], v[80:83], v[132:135]
    ds_read_b128 v[40:43], v23 offset:36864
    ds_read_b128 v[44:47], v23 offset:38912
    v_mfma_f32_16x16x32_bf16 v[164:167], v[100:103], v[84:87], v[164:167]
    v_mul_f32 v8, s40, v8
    v_mul_f32 v9, s40, v9
    v_mfma_f32_16x16x32_bf16 v[196:199], v[100:103], v[88:91], v[196:199]
    ds_read_b64_tr_b16 v[52:53], v28 offset:34816
    ds_read_b64_tr_b16 v[54:55], v28 offset:35840
    v_mfma_f32_16x16x32_bf16 v[228:231], v[100:103], v[92:95], v[228:231]
    buffer_load_dwordx4 v18, s[24:27], s36 offen offset:1024 lds
    v_mfma_f32_16x16x32_bf16 v[136:139], v[104:107], v[80:83], v[136:139]
    ds_read_b64_tr_b16 v[56:57], v29 offset:34816
    ds_read_b64_tr_b16 v[58:59], v29 offset:35840
    v_mfma_f32_16x16x32_bf16 v[168:171], v[104:107], v[84:87], v[168:171]
    v_mul_f32 v10, s40, v10
    v_mul_f32 v11, s40, v11
    v_mfma_f32_16x16x32_bf16 v[200:203], v[104:107], v[88:91], v[200:203]
    ds_read_b64_tr_b16 v[60:61], v30 offset:34816
    ds_read_b64_tr_b16 v[62:63], v30 offset:35840
    v_mfma_f32_16x16x32_bf16 v[232:235], v[104:107], v[92:95], v[232:235]
    buffer_store_dwordx4 v[0:3], v16, s[16:19], s38 offen offset:2048
    v_mfma_f32_16x16x32_bf16 v[140:143], v[108:111], v[80:83], v[140:143]
    ds_read_b64_tr_b16 v[64:65], v27 offset:34944
    ds_read_b64_tr_b16 v[66:67], v27 offset:35968
    v_mfma_f32_16x16x32_bf16 v[172:175], v[108:111], v[84:87], v[172:175]
    v_mul_f32 v12, s40, v12
    v_mul_f32 v13, s40, v13
    v_mfma_f32_16x16x32_bf16 v[204:207], v[108:111], v[88:91], v[204:207]
    ds_read_b64_tr_b16 v[68:69], v28 offset:34944
    ds_read_b64_tr_b16 v[70:71], v28 offset:35968
    v_mfma_f32_16x16x32_bf16 v[236:239], v[108:111], v[92:95], v[236:239]
    buffer_load_dwordx4 v19, s[24:27], s36 offen offset:2048 lds
    v_mfma_f32_16x16x32_bf16 v[144:147], v[112:115], v[80:83], v[144:147]
    ds_read_b64_tr_b16 v[72:73], v29 offset:34944
    ds_read_b64_tr_b16 v[74:75], v29 offset:35968
    v_mfma_f32_16x16x32_bf16 v[176:179], v[112:115], v[84:87], v[176:179]
    v_mul_f32 v14, s40, v14
    v_mul_f32 v15, s40, v15
    v_mfma_f32_16x16x32_bf16 v[208:211], v[112:115], v[88:91], v[208:211]
    ds_read_b64_tr_b16 v[76:77], v30 offset:34944
    ds_read_b64_tr_b16 v[78:79], v30 offset:35968
    v_mfma_f32_16x16x32_bf16 v[240:243], v[112:115], v[92:95], v[240:243]
    v_cvt_pk_bf16_f32 v8, v8, v9
    v_cvt_pk_bf16_f32 v9, v10, v11
    v_mfma_f32_16x16x32_bf16 v[148:151], v[116:119], v[80:83], v[148:151]
    v_cvt_pk_bf16_f32 v10, v12, v13
    v_cvt_pk_bf16_f32 v11, v14, v15
    v_mfma_f32_16x16x32_bf16 v[180:183], v[116:119], v[84:87], v[180:183]
    buffer_load_dwordx4 v20, s[24:27], s36 offen offset:3072 lds
    v_mfma_f32_16x16x32_bf16 v[212:215], v[116:119], v[88:91], v[212:215]
    s_add_u32 s37, s49, 2097152
    v_accvgpr_read_b32 v4, a228
    v_accvgpr_read_b32 v5, a229
    v_mfma_f32_16x16x32_bf16 v[244:247], v[116:119], v[92:95], v[244:247]
    s_add_u32 m0, s50, 17408
    v_accvgpr_read_b32 v6, a230
    v_accvgpr_read_b32 v7, a231
    v_mfma_f32_16x16x32_bf16 v[152:155], v[120:123], v[80:83], v[152:155]
    buffer_load_dwordx4 v21, s[20:23], s37 offen offset:0 lds
    v_mfma_f32_16x16x32_bf16 v[184:187], v[120:123], v[84:87], v[184:187]
    v_accvgpr_read_b32 v0, a224
    v_accvgpr_read_b32 v1, a225
    v_mfma_f32_16x16x32_bf16 v[216:219], v[120:123], v[88:91], v[216:219]
    v_accvgpr_read_b32 v2, a226
    v_accvgpr_read_b32 v3, a227
    v_mfma_f32_16x16x32_bf16 v[248:251], v[120:123], v[92:95], v[248:251]
    buffer_store_dwordx4 v[8:11], v16, s[16:19], s41 offen offset:0
    v_mfma_f32_16x16x32_bf16 v[156:159], v[124:127], v[80:83], v[156:159]
    v_cvt_pk_bf16_f32 v0, v0, v1
    v_cvt_pk_bf16_f32 v1, v2, v3
    v_mfma_f32_16x16x32_bf16 v[188:191], v[124:127], v[84:87], v[188:191]
    v_cvt_pk_bf16_f32 v2, v4, v5
    v_cvt_pk_bf16_f32 v3, v6, v7
    v_mfma_f32_16x16x32_bf16 v[220:223], v[124:127], v[88:91], v[220:223]
    buffer_load_dwordx4 v22, s[20:23], s37 offen offset:1024 lds
    v_mfma_f32_16x16x32_bf16 v[252:255], v[124:127], v[92:95], v[252:255]
    s_waitcnt lgkmcnt(0)
    v_accvgpr_read_b32 v12, a100
    v_accvgpr_read_b32 v13, a101
    v_mfma_f32_16x16x32_bf16 v[128:131], v[48:51], v[32:35], v[128:131]
    ds_read_b64_tr_b16 v[96:97], v27 offset:43520
    ds_read_b64_tr_b16 v[98:99], v27 offset:44544
    v_mfma_f32_16x16x32_bf16 v[160:163], v[48:51], v[36:39], v[160:163]
    s_add_u32 s36, s45, 512
    v_accvgpr_read_b32 v14, a102
    v_accvgpr_read_b32 v15, a103
    v_mfma_f32_16x16x32_bf16 v[192:195], v[48:51], v[40:43], v[192:195]
    s_add_u32 m0, s42, 4096
    ds_read_b128 v[80:83], v24 offset:32768
    ds_read_b128 v[84:87], v24 offset:34816
    v_mfma_f32_16x16x32_bf16 v[224:227], v[48:51], v[44:47], v[224:227]
    buffer_load_dwordx4 v17, s[24:27], s36 offen offset:0 lds
    v_mfma_f32_16x16x32_bf16 v[132:135], v[52:55], v[32:35], v[132:135]
    ds_read_b128 v[88:91], v24 offset:36864
    ds_read_b128 v[92:95], v24 offset:38912
    v_mfma_f32_16x16x32_bf16 v[164:167], v[52:55], v[36:39], v[164:167]
    v_accvgpr_read_b32 v8, a68
    v_accvgpr_read_b32 v9, a69
    v_mfma_f32_16x16x32_bf16 v[196:199], v[52:55], v[40:43], v[196:199]
    ds_read_b64_tr_b16 v[100:101], v28 offset:43520
    ds_read_b64_tr_b16 v[102:103], v28 offset:44544
    v_mfma_f32_16x16x32_bf16 v[228:231], v[52:55], v[44:47], v[228:231]
    buffer_load_dwordx4 v18, s[24:27], s36 offen offset:1024 lds
    v_mfma_f32_16x16x32_bf16 v[136:139], v[56:59], v[32:35], v[136:139]
    ds_read_b64_tr_b16 v[104:105], v29 offset:43520
    ds_read_b64_tr_b16 v[106:107], v29 offset:44544
    v_mfma_f32_16x16x32_bf16 v[168:171], v[56:59], v[36:39], v[168:171]
    v_accvgpr_read_b32 v10, a70
    v_accvgpr_read_b32 v11, a71
    v_mfma_f32_16x16x32_bf16 v[200:203], v[56:59], v[40:43], v[200:203]
    ds_read_b64_tr_b16 v[108:109], v30 offset:43520
    ds_read_b64_tr_b16 v[110:111], v30 offset:44544
    v_mfma_f32_16x16x32_bf16 v[232:235], v[56:59], v[44:47], v[232:235]
    buffer_store_dwordx4 v[0:3], v16, s[16:19], s38 offen offset:3072
    v_mfma_f32_16x16x32_bf16 v[140:143], v[60:63], v[32:35], v[140:143]
    s_add_u32 s38, s38, 16384
    ds_read_b64_tr_b16 v[112:113], v27 offset:43648
    ds_read_b64_tr_b16 v[114:115], v27 offset:44672
    v_mfma_f32_16x16x32_bf16 v[172:175], v[60:63], v[36:39], v[172:175]
    v_mul_f32 v8, s40, v8
    v_mul_f32 v9, s40, v9
    v_mfma_f32_16x16x32_bf16 v[204:207], v[60:63], v[40:43], v[204:207]
    ds_read_b64_tr_b16 v[116:117], v28 offset:43648
    ds_read_b64_tr_b16 v[118:119], v28 offset:44672
    v_mfma_f32_16x16x32_bf16 v[236:239], v[60:63], v[44:47], v[236:239]
    buffer_load_dwordx4 v19, s[24:27], s36 offen offset:2048 lds
    v_mfma_f32_16x16x32_bf16 v[144:147], v[64:67], v[32:35], v[144:147]
    ds_read_b64_tr_b16 v[120:121], v29 offset:43648
    ds_read_b64_tr_b16 v[122:123], v29 offset:44672
    v_mfma_f32_16x16x32_bf16 v[176:179], v[64:67], v[36:39], v[176:179]
    v_mul_f32 v10, s40, v10
    v_mul_f32 v11, s40, v11
    v_mfma_f32_16x16x32_bf16 v[208:211], v[64:67], v[40:43], v[208:211]
    ds_read_b64_tr_b16 v[124:125], v30 offset:43648
    ds_read_b64_tr_b16 v[126:127], v30 offset:44672
    v_mfma_f32_16x16x32_bf16 v[240:243], v[64:67], v[44:47], v[240:243]
    v_mul_f32 v12, s40, v12
    v_mul_f32 v13, s40, v13
    v_mfma_f32_16x16x32_bf16 v[148:151], v[68:71], v[32:35], v[148:151]
    v_mul_f32 v14, s40, v14
    v_mul_f32 v15, s40, v15
    v_mfma_f32_16x16x32_bf16 v[180:183], v[68:71], v[36:39], v[180:183]
    buffer_load_dwordx4 v20, s[24:27], s36 offen offset:3072 lds
    v_mfma_f32_16x16x32_bf16 v[212:215], v[68:71], v[40:43], v[212:215]
    s_add_u32 s37, s49, 2359296
    v_cvt_pk_bf16_f32 v8, v8, v9
    v_cvt_pk_bf16_f32 v9, v10, v11
    v_mfma_f32_16x16x32_bf16 v[244:247], v[68:71], v[44:47], v[244:247]
    s_add_u32 m0, s50, 26112
    v_cvt_pk_bf16_f32 v10, v12, v13
    v_cvt_pk_bf16_f32 v11, v14, v15
    v_mfma_f32_16x16x32_bf16 v[152:155], v[72:75], v[32:35], v[152:155]
    buffer_load_dwordx4 v21, s[20:23], s37 offen offset:0 lds
    v_mfma_f32_16x16x32_bf16 v[184:187], v[72:75], v[36:39], v[184:187]
    v_accvgpr_read_b32 v4, a140
    v_accvgpr_read_b32 v5, a141
    v_mfma_f32_16x16x32_bf16 v[216:219], v[72:75], v[40:43], v[216:219]
    v_accvgpr_read_b32 v6, a142
    v_accvgpr_read_b32 v7, a143
    v_mfma_f32_16x16x32_bf16 v[248:251], v[72:75], v[44:47], v[248:251]
    buffer_store_dwordx4 v[8:11], v16, s[16:19], s41 offen offset:1024
    v_mfma_f32_16x16x32_bf16 v[156:159], v[76:79], v[32:35], v[156:159]
    s_add_u32 s41, s41, 12288
    v_accvgpr_read_b32 v0, a136
    v_accvgpr_read_b32 v1, a137
    v_mfma_f32_16x16x32_bf16 v[188:191], v[76:79], v[36:39], v[188:191]
    v_accvgpr_read_b32 v2, a138
    v_accvgpr_read_b32 v3, a139
    v_mfma_f32_16x16x32_bf16 v[220:223], v[76:79], v[40:43], v[220:223]
    buffer_load_dwordx4 v22, s[20:23], s37 offen offset:1024 lds
    v_mfma_f32_16x16x32_bf16 v[252:255], v[76:79], v[44:47], v[252:255]
    s_waitcnt vmcnt(16) lgkmcnt(0)
    s_barrier
    v_cvt_pk_bf16_f32 v0, v0, v1
    v_cvt_pk_bf16_f32 v1, v2, v3
    v_mfma_f32_16x16x32_bf16 v[128:131], v[96:99], v[80:83], v[128:131]
    ds_read_b64_tr_b16 v[48:49], v27 offset:0
    ds_read_b64_tr_b16 v[50:51], v27 offset:1024
    v_mfma_f32_16x16x32_bf16 v[160:163], v[96:99], v[84:87], v[160:163]
    s_add_u32 s36, s44, 640
    v_cvt_pk_bf16_f32 v2, v4, v5
    v_cvt_pk_bf16_f32 v3, v6, v7
    v_mfma_f32_16x16x32_bf16 v[192:195], v[96:99], v[88:91], v[192:195]
    s_add_u32 m0, s42, 32768
    ds_read_b128 v[32:35], v25 offset:0
    ds_read_b128 v[36:39], v25 offset:2048
    v_mfma_f32_16x16x32_bf16 v[224:227], v[96:99], v[92:95], v[224:227]
    buffer_load_dwordx4 v17, s[24:27], s36 offen offset:0 lds
    v_mfma_f32_16x16x32_bf16 v[132:135], v[100:103], v[80:83], v[132:135]
    ds_read_b128 v[40:43], v25 offset:4096
    ds_read_b128 v[44:47], v25 offset:6144
    v_mfma_f32_16x16x32_bf16 v[164:167], v[100:103], v[84:87], v[164:167]
    v_accvgpr_read_b32 v12, a40
    v_accvgpr_read_b32 v13, a41
    v_mfma_f32_16x16x32_bf16 v[196:199], v[100:103], v[88:91], v[196:199]
    ds_read_b64_tr_b16 v[52:53], v28 offset:0
    ds_read_b64_tr_b16 v[54:55], v28 offset:1024
    v_mfma_f32_16x16x32_bf16 v[228:231], v[100:103], v[92:95], v[228:231]
    buffer_load_dwordx4 v18, s[24:27], s36 offen offset:1024 lds
    v_mfma_f32_16x16x32_bf16 v[136:139], v[104:107], v[80:83], v[136:139]
    ds_read_b64_tr_b16 v[56:57], v29 offset:0
    ds_read_b64_tr_b16 v[58:59], v29 offset:1024
    v_mfma_f32_16x16x32_bf16 v[168:171], v[104:107], v[84:87], v[168:171]
    v_accvgpr_read_b32 v14, a42
    v_accvgpr_read_b32 v15, a43
    v_mfma_f32_16x16x32_bf16 v[200:203], v[104:107], v[88:91], v[200:203]
    ds_read_b64_tr_b16 v[60:61], v30 offset:0
    ds_read_b64_tr_b16 v[62:63], v30 offset:1024
    v_mfma_f32_16x16x32_bf16 v[232:235], v[104:107], v[92:95], v[232:235]
    buffer_store_dwordx4 v[0:3], v16, s[16:19], s38 offen offset:0
    v_mfma_f32_16x16x32_bf16 v[140:143], v[108:111], v[80:83], v[140:143]
    ds_read_b64_tr_b16 v[64:65], v27 offset:128
    ds_read_b64_tr_b16 v[66:67], v27 offset:1152
    v_mfma_f32_16x16x32_bf16 v[172:175], v[108:111], v[84:87], v[172:175]
    v_accvgpr_read_b32 v8, a8
    v_accvgpr_read_b32 v9, a9
    v_mfma_f32_16x16x32_bf16 v[204:207], v[108:111], v[88:91], v[204:207]
    ds_read_b64_tr_b16 v[68:69], v28 offset:128
    ds_read_b64_tr_b16 v[70:71], v28 offset:1152
    v_mfma_f32_16x16x32_bf16 v[236:239], v[108:111], v[92:95], v[236:239]
    buffer_load_dwordx4 v19, s[24:27], s36 offen offset:2048 lds
    v_mfma_f32_16x16x32_bf16 v[144:147], v[112:115], v[80:83], v[144:147]
    ds_read_b64_tr_b16 v[72:73], v29 offset:128
    ds_read_b64_tr_b16 v[74:75], v29 offset:1152
    v_mfma_f32_16x16x32_bf16 v[176:179], v[112:115], v[84:87], v[176:179]
    v_accvgpr_read_b32 v10, a10
    v_accvgpr_read_b32 v11, a11
    v_mfma_f32_16x16x32_bf16 v[208:211], v[112:115], v[88:91], v[208:211]
    ds_read_b64_tr_b16 v[76:77], v30 offset:128
    ds_read_b64_tr_b16 v[78:79], v30 offset:1152
    v_mfma_f32_16x16x32_bf16 v[240:243], v[112:115], v[92:95], v[240:243]
    v_mul_f32 v8, s40, v8
    v_mul_f32 v9, s40, v9
    v_mfma_f32_16x16x32_bf16 v[148:151], v[116:119], v[80:83], v[148:151]
    v_mul_f32 v10, s40, v10
    v_mul_f32 v11, s40, v11
    v_mfma_f32_16x16x32_bf16 v[180:183], v[116:119], v[84:87], v[180:183]
    buffer_load_dwordx4 v20, s[24:27], s36 offen offset:3072 lds
    v_mfma_f32_16x16x32_bf16 v[212:215], v[116:119], v[88:91], v[212:215]
    s_add_u32 s37, s49, 2621440
    v_mul_f32 v12, s40, v12
    v_mul_f32 v13, s40, v13
    v_mfma_f32_16x16x32_bf16 v[244:247], v[116:119], v[92:95], v[244:247]
    s_add_u32 m0, s50, 34816
    v_mul_f32 v14, s40, v14
    v_mul_f32 v15, s40, v15
    v_mfma_f32_16x16x32_bf16 v[152:155], v[120:123], v[80:83], v[152:155]
    buffer_load_dwordx4 v21, s[20:23], s37 offen offset:0 lds
    v_mfma_f32_16x16x32_bf16 v[184:187], v[120:123], v[84:87], v[184:187]
    v_cvt_pk_bf16_f32 v8, v8, v9
    v_cvt_pk_bf16_f32 v9, v10, v11
    v_mfma_f32_16x16x32_bf16 v[216:219], v[120:123], v[88:91], v[216:219]
    v_cvt_pk_bf16_f32 v10, v12, v13
    v_cvt_pk_bf16_f32 v11, v14, v15
    v_mfma_f32_16x16x32_bf16 v[248:251], v[120:123], v[92:95], v[248:251]
    buffer_store_dwordx4 v[8:11], v16, s[16:19], s41 offen offset:0
    v_mfma_f32_16x16x32_bf16 v[156:159], v[124:127], v[80:83], v[156:159]
    v_accvgpr_read_b32 v4, a172
    v_accvgpr_read_b32 v5, a173
    v_mfma_f32_16x16x32_bf16 v[188:191], v[124:127], v[84:87], v[188:191]
    v_accvgpr_read_b32 v6, a174
    v_accvgpr_read_b32 v7, a175
    v_mfma_f32_16x16x32_bf16 v[220:223], v[124:127], v[88:91], v[220:223]
    buffer_load_dwordx4 v22, s[20:23], s37 offen offset:1024 lds
    v_mfma_f32_16x16x32_bf16 v[252:255], v[124:127], v[92:95], v[252:255]
    s_waitcnt lgkmcnt(0)
    v_accvgpr_read_b32 v0, a168
    v_accvgpr_read_b32 v1, a169
    v_mfma_f32_16x16x32_bf16 v[128:131], v[48:51], v[32:35], v[128:131]
    ds_read_b64_tr_b16 v[96:97], v27 offset:8704
    ds_read_b64_tr_b16 v[98:99], v27 offset:9728
    v_mfma_f32_16x16x32_bf16 v[160:163], v[48:51], v[36:39], v[160:163]
    s_add_u32 s36, s45, 640
    v_accvgpr_read_b32 v2, a170
    v_accvgpr_read_b32 v3, a171
    v_mfma_f32_16x16x32_bf16 v[192:195], v[48:51], v[40:43], v[192:195]
    s_add_u32 m0, s42, 36864
    ds_read_b128 v[80:83], v26 offset:0
    ds_read_b128 v[84:87], v26 offset:2048
    v_mfma_f32_16x16x32_bf16 v[224:227], v[48:51], v[44:47], v[224:227]
    buffer_load_dwordx4 v17, s[24:27], s36 offen offset:0 lds
    v_mfma_f32_16x16x32_bf16 v[132:135], v[52:55], v[32:35], v[132:135]
    ds_read_b128 v[88:91], v26 offset:4096
    ds_read_b128 v[92:95], v26 offset:6144
    v_mfma_f32_16x16x32_bf16 v[164:167], v[52:55], v[36:39], v[164:167]
    v_cvt_pk_bf16_f32 v0, v0, v1
    v_cvt_pk_bf16_f32 v1, v2, v3
    v_mfma_f32_16x16x32_bf16 v[196:199], v[52:55], v[40:43], v[196:199]
    ds_read_b64_tr_b16 v[100:101], v28 offset:8704
    ds_read_b64_tr_b16 v[102:103], v28 offset:9728
    v_mfma_f32_16x16x32_bf16 v[228:231], v[52:55], v[44:47], v[228:231]
    buffer_load_dwordx4 v18, s[24:27], s36 offen offset:1024 lds
    v_mfma_f32_16x16x32_bf16 v[136:139], v[56:59], v[32:35], v[136:139]
    ds_read_b64_tr_b16 v[104:105], v29 offset:8704
    ds_read_b64_tr_b16 v[106:107], v29 offset:9728
    v_mfma_f32_16x16x32_bf16 v[168:171], v[56:59], v[36:39], v[168:171]
    v_cvt_pk_bf16_f32 v2, v4, v5
    v_cvt_pk_bf16_f32 v3, v6, v7
    v_mfma_f32_16x16x32_bf16 v[200:203], v[56:59], v[40:43], v[200:203]
    ds_read_b64_tr_b16 v[108:109], v30 offset:8704
    ds_read_b64_tr_b16 v[110:111], v30 offset:9728
    v_mfma_f32_16x16x32_bf16 v[232:235], v[56:59], v[44:47], v[232:235]
gated_mix__ssm_conv_h3__compressed_kv_cla__prompt_kernel_pad4:
    s_cbranch_execz gated_mix__ssm_conv_h3__compressed_kv_cla__prompt_kernel_pad8
    buffer_store_dwordx4 v[0:3], v16, s[16:19], s38 offen offset:1024
    v_mfma_f32_16x16x32_bf16 v[140:143], v[60:63], v[32:35], v[140:143]
    ds_read_b64_tr_b16 v[112:113], v27 offset:8832
    ds_read_b64_tr_b16 v[114:115], v27 offset:9856
    v_mfma_f32_16x16x32_bf16 v[172:175], v[60:63], v[36:39], v[172:175]
    v_accvgpr_read_b32 v12, a104
    v_accvgpr_read_b32 v13, a105
    v_mfma_f32_16x16x32_bf16 v[204:207], v[60:63], v[40:43], v[204:207]
    ds_read_b64_tr_b16 v[116:117], v28 offset:8832
    ds_read_b64_tr_b16 v[118:119], v28 offset:9856
    v_mfma_f32_16x16x32_bf16 v[236:239], v[60:63], v[44:47], v[236:239]
    buffer_load_dwordx4 v19, s[24:27], s36 offen offset:2048 lds
    v_mfma_f32_16x16x32_bf16 v[144:147], v[64:67], v[32:35], v[144:147]
    ds_read_b64_tr_b16 v[120:121], v29 offset:8832
    ds_read_b64_tr_b16 v[122:123], v29 offset:9856
    v_mfma_f32_16x16x32_bf16 v[176:179], v[64:67], v[36:39], v[176:179]
    v_accvgpr_read_b32 v14, a106
    v_accvgpr_read_b32 v15, a107
    v_mfma_f32_16x16x32_bf16 v[208:211], v[64:67], v[40:43], v[208:211]
    ds_read_b64_tr_b16 v[124:125], v30 offset:8832
    ds_read_b64_tr_b16 v[126:127], v30 offset:9856
    v_mfma_f32_16x16x32_bf16 v[240:243], v[64:67], v[44:47], v[240:243]
    v_accvgpr_read_b32 v8, a72
    v_accvgpr_read_b32 v9, a73
    v_mfma_f32_16x16x32_bf16 v[148:151], v[68:71], v[32:35], v[148:151]
    v_accvgpr_read_b32 v10, a74
    v_accvgpr_read_b32 v11, a75
    v_mfma_f32_16x16x32_bf16 v[180:183], v[68:71], v[36:39], v[180:183]
    buffer_load_dwordx4 v20, s[24:27], s36 offen offset:3072 lds
    v_mfma_f32_16x16x32_bf16 v[212:215], v[68:71], v[40:43], v[212:215]
    s_add_u32 s37, s49, 2883584
    v_mul_f32 v8, s40, v8
    v_mul_f32 v9, s40, v9
    v_mfma_f32_16x16x32_bf16 v[244:247], v[68:71], v[44:47], v[244:247]
    s_add_u32 m0, s50, 43520
    v_mul_f32 v10, s40, v10
    v_mul_f32 v11, s40, v11
    v_mfma_f32_16x16x32_bf16 v[152:155], v[72:75], v[32:35], v[152:155]
    buffer_load_dwordx4 v21, s[20:23], s37 offen offset:0 lds
    v_mfma_f32_16x16x32_bf16 v[184:187], v[72:75], v[36:39], v[184:187]
    v_mul_f32 v12, s40, v12
    v_mul_f32 v13, s40, v13
    v_mfma_f32_16x16x32_bf16 v[216:219], v[72:75], v[40:43], v[216:219]
    v_mul_f32 v14, s40, v14
    v_mul_f32 v15, s40, v15
    v_mfma_f32_16x16x32_bf16 v[248:251], v[72:75], v[44:47], v[248:251]
    v_mfma_f32_16x16x32_bf16 v[156:159], v[76:79], v[32:35], v[156:159]
    v_cvt_pk_bf16_f32 v8, v8, v9
    v_cvt_pk_bf16_f32 v9, v10, v11
    v_mfma_f32_16x16x32_bf16 v[188:191], v[76:79], v[36:39], v[188:191]
    v_cvt_pk_bf16_f32 v10, v12, v13
    v_cvt_pk_bf16_f32 v11, v14, v15
    v_mfma_f32_16x16x32_bf16 v[220:223], v[76:79], v[40:43], v[220:223]
    buffer_load_dwordx4 v22, s[20:23], s37 offen offset:1024 lds
    v_mfma_f32_16x16x32_bf16 v[252:255], v[76:79], v[44:47], v[252:255]
    s_waitcnt vmcnt(15) lgkmcnt(0)
    s_barrier
    v_accvgpr_read_b32 v4, a204
    v_accvgpr_read_b32 v5, a205
    v_mfma_f32_16x16x32_bf16 v[128:131], v[96:99], v[80:83], v[128:131]
    ds_read_b64_tr_b16 v[48:49], v27 offset:17408
    ds_read_b64_tr_b16 v[50:51], v27 offset:18432
    v_mfma_f32_16x16x32_bf16 v[160:163], v[96:99], v[84:87], v[160:163]
    s_add_u32 s36, s44, 768
    v_accvgpr_read_b32 v6, a206
    v_accvgpr_read_b32 v7, a207
    v_mfma_f32_16x16x32_bf16 v[192:195], v[96:99], v[88:91], v[192:195]
    s_add_u32 m0, s42, 65536
    ds_read_b128 v[32:35], v23 offset:0
    ds_read_b128 v[36:39], v23 offset:2048
    v_mfma_f32_16x16x32_bf16 v[224:227], v[96:99], v[92:95], v[224:227]
    buffer_load_dwordx4 v17, s[24:27], s36 offen offset:0 lds
    v_mfma_f32_16x16x32_bf16 v[132:135], v[100:103], v[80:83], v[132:135]
    ds_read_b128 v[40:43], v23 offset:4096
    ds_read_b128 v[44:47], v23 offset:6144
    v_mfma_f32_16x16x32_bf16 v[164:167], v[100:103], v[84:87], v[164:167]
    v_accvgpr_read_b32 v0, a200
    v_accvgpr_read_b32 v1, a201
    v_mfma_f32_16x16x32_bf16 v[196:199], v[100:103], v[88:91], v[196:199]
    ds_read_b64_tr_b16 v[52:53], v28 offset:17408
    ds_read_b64_tr_b16 v[54:55], v28 offset:18432
    v_mfma_f32_16x16x32_bf16 v[228:231], v[100:103], v[92:95], v[228:231]
    buffer_load_dwordx4 v18, s[24:27], s36 offen offset:1024 lds
    v_mfma_f32_16x16x32_bf16 v[136:139], v[104:107], v[80:83], v[136:139]
    ds_read_b64_tr_b16 v[56:57], v29 offset:17408
    ds_read_b64_tr_b16 v[58:59], v29 offset:18432
    v_mfma_f32_16x16x32_bf16 v[168:171], v[104:107], v[84:87], v[168:171]
    v_accvgpr_read_b32 v2, a202
    v_accvgpr_read_b32 v3, a203
    v_mfma_f32_16x16x32_bf16 v[200:203], v[104:107], v[88:91], v[200:203]
    ds_read_b64_tr_b16 v[60:61], v30 offset:17408
    ds_read_b64_tr_b16 v[62:63], v30 offset:18432
    v_mfma_f32_16x16x32_bf16 v[232:235], v[104:107], v[92:95], v[232:235]
    buffer_store_dwordx4 v[8:11], v16, s[16:19], s41 offen offset:1024
    v_mfma_f32_16x16x32_bf16 v[140:143], v[108:111], v[80:83], v[140:143]
    s_add_u32 s41, s41, 4096
    ds_read_b64_tr_b16 v[64:65], v27 offset:17536
    ds_read_b64_tr_b16 v[66:67], v27 offset:18560
    v_mfma_f32_16x16x32_bf16 v[172:175], v[108:111], v[84:87], v[172:175]
    v_cvt_pk_bf16_f32 v0, v0, v1
    v_cvt_pk_bf16_f32 v1, v2, v3
    v_mfma_f32_16x16x32_bf16 v[204:207], v[108:111], v[88:91], v[204:207]
    ds_read_b64_tr_b16 v[68:69], v28 offset:17536
    ds_read_b64_tr_b16 v[70:71], v28 offset:18560
    v_mfma_f32_16x16x32_bf16 v[236:239], v[108:111], v[92:95], v[236:239]
    buffer_load_dwordx4 v19, s[24:27], s36 offen offset:2048 lds
    v_mfma_f32_16x16x32_bf16 v[144:147], v[112:115], v[80:83], v[144:147]
    ds_read_b64_tr_b16 v[72:73], v29 offset:17536
    ds_read_b64_tr_b16 v[74:75], v29 offset:18560
    v_mfma_f32_16x16x32_bf16 v[176:179], v[112:115], v[84:87], v[176:179]
    v_cvt_pk_bf16_f32 v2, v4, v5
    v_cvt_pk_bf16_f32 v3, v6, v7
    v_mfma_f32_16x16x32_bf16 v[208:211], v[112:115], v[88:91], v[208:211]
    ds_read_b64_tr_b16 v[76:77], v30 offset:17536
    ds_read_b64_tr_b16 v[78:79], v30 offset:18560
    v_mfma_f32_16x16x32_bf16 v[240:243], v[112:115], v[92:95], v[240:243]
    v_accvgpr_read_b32 v12, a44
    v_accvgpr_read_b32 v13, a45
    v_mfma_f32_16x16x32_bf16 v[148:151], v[116:119], v[80:83], v[148:151]
    v_accvgpr_read_b32 v14, a46
    v_accvgpr_read_b32 v15, a47
    v_mfma_f32_16x16x32_bf16 v[180:183], v[116:119], v[84:87], v[180:183]
    buffer_load_dwordx4 v20, s[24:27], s36 offen offset:3072 lds
    v_mfma_f32_16x16x32_bf16 v[212:215], v[116:119], v[88:91], v[212:215]
    s_add_u32 s37, s49, 3145728
    v_accvgpr_read_b32 v8, a12
    v_accvgpr_read_b32 v9, a13
    v_mfma_f32_16x16x32_bf16 v[244:247], v[116:119], v[92:95], v[244:247]
    s_add_u32 m0, s50, 0
    v_accvgpr_read_b32 v10, a14
    v_accvgpr_read_b32 v11, a15
    v_mfma_f32_16x16x32_bf16 v[152:155], v[120:123], v[80:83], v[152:155]
    buffer_load_dwordx4 v21, s[20:23], s37 offen offset:0 lds
    v_mfma_f32_16x16x32_bf16 v[184:187], v[120:123], v[84:87], v[184:187]
    v_mul_f32 v8, s40, v8
    v_mul_f32 v9, s40, v9
    v_mfma_f32_16x16x32_bf16 v[216:219], v[120:123], v[88:91], v[216:219]
    v_mul_f32 v10, s40, v10
    v_mul_f32 v11, s40, v11
    v_mfma_f32_16x16x32_bf16 v[248:251], v[120:123], v[92:95], v[248:251]
    buffer_store_dwordx4 v[0:3], v16, s[16:19], s38 offen offset:2048
    v_mfma_f32_16x16x32_bf16 v[156:159], v[124:127], v[80:83], v[156:159]
    v_mul_f32 v12, s40, v12
    v_mul_f32 v13, s40, v13
    v_mfma_f32_16x16x32_bf16 v[188:191], v[124:127], v[84:87], v[188:191]
    v_mul_f32 v14, s40, v14
    v_mul_f32 v15, s40, v15
    v_mfma_f32_16x16x32_bf16 v[220:223], v[124:127], v[88:91], v[220:223]
    buffer_load_dwordx4 v22, s[20:23], s37 offen offset:1024 lds
    v_mfma_f32_16x16x32_bf16 v[252:255], v[124:127], v[92:95], v[252:255]
    s_waitcnt lgkmcnt(0)
    v_cvt_pk_bf16_f32 v8, v8, v9
    v_cvt_pk_bf16_f32 v9, v10, v11
    v_mfma_f32_16x16x32_bf16 v[128:131], v[48:51], v[32:35], v[128:131]
    ds_read_b64_tr_b16 v[96:97], v27 offset:26112
    ds_read_b64_tr_b16 v[98:99], v27 offset:27136
    v_mfma_f32_16x16x32_bf16 v[160:163], v[48:51], v[36:39], v[160:163]
    s_add_u32 s36, s45, 768
    v_cvt_pk_bf16_f32 v10, v12, v13
    v_cvt_pk_bf16_f32 v11, v14, v15
    v_mfma_f32_16x16x32_bf16 v[192:195], v[48:51], v[40:43], v[192:195]
    s_add_u32 m0, s42, 69632
    ds_read_b128 v[80:83], v24 offset:0
    ds_read_b128 v[84:87], v24 offset:2048
    v_mfma_f32_16x16x32_bf16 v[224:227], v[48:51], v[44:47], v[224:227]
    buffer_load_dwordx4 v17, s[24:27], s36 offen offset:0 lds
    v_mfma_f32_16x16x32_bf16 v[132:135], v[52:55], v[32:35], v[132:135]
    ds_read_b128 v[88:91], v24 offset:4096
    ds_read_b128 v[92:95], v24 offset:6144
    v_mfma_f32_16x16x32_bf16 v[164:167], v[52:55], v[36:39], v[164:167]
    v_accvgpr_read_b32 v4, a236
    v_accvgpr_read_b32 v5, a237
    v_mfma_f32_16x16x32_bf16 v[196:199], v[52:55], v[40:43], v[196:199]
    ds_read_b64_tr_b16 v[100:101], v28 offset:26112
    ds_read_b64_tr_b16 v[102:103], v28 offset:27136
    v_mfma_f32_16x16x32_bf16 v[228:231], v[52:55], v[44:47], v[228:231]
    buffer_load_dwordx4 v18, s[24:27], s36 offen offset:1024 lds
    v_mfma_f32_16x16x32_bf16 v[136:139], v[56:59], v[32:35], v[136:139]
    ds_read_b64_tr_b16 v[104:105], v29 offset:26112
    ds_read_b64_tr_b16 v[106:107], v29 offset:27136
    v_mfma_f32_16x16x32_bf16 v[168:171], v[56:59], v[36:39], v[168:171]
    v_accvgpr_read_b32 v6, a238
    v_accvgpr_read_b32 v7, a239
    v_mfma_f32_16x16x32_bf16 v[200:203], v[56:59], v[40:43], v[200:203]
    ds_read_b64_tr_b16 v[108:109], v30 offset:26112
    ds_read_b64_tr_b16 v[110:111], v30 offset:27136
    v_mfma_f32_16x16x32_bf16 v[232:235], v[56:59], v[44:47], v[232:235]
    buffer_store_dwordx4 v[8:11], v16, s[16:19], s41 offen offset:0
    v_mfma_f32_16x16x32_bf16 v[140:143], v[60:63], v[32:35], v[140:143]
    ds_read_b64_tr_b16 v[112:113], v27 offset:26240
    ds_read_b64_tr_b16 v[114:115], v27 offset:27264
    v_mfma_f32_16x16x32_bf16 v[172:175], v[60:63], v[36:39], v[172:175]
    v_accvgpr_read_b32 v0, a232
    v_accvgpr_read_b32 v1, a233
    v_mfma_f32_16x16x32_bf16 v[204:207], v[60:63], v[40:43], v[204:207]
    ds_read_b64_tr_b16 v[116:117], v28 offset:26240
    ds_read_b64_tr_b16 v[118:119], v28 offset:27264
    v_mfma_f32_16x16x32_bf16 v[236:239], v[60:63], v[44:47], v[236:239]
    buffer_load_dwordx4 v19, s[24:27], s36 offen offset:2048 lds
    v_mfma_f32_16x16x32_bf16 v[144:147], v[64:67], v[32:35], v[144:147]
    ds_read_b64_tr_b16 v[120:121], v29 offset:26240
    ds_read_b64_tr_b16 v[122:123], v29 offset:27264
    v_mfma_f32_16x16x32_bf16 v[176:179], v[64:67], v[36:39], v[176:179]
    v_accvgpr_read_b32 v2, a234
    v_accvgpr_read_b32 v3, a235
    v_mfma_f32_16x16x32_bf16 v[208:211], v[64:67], v[40:43], v[208:211]
    ds_read_b64_tr_b16 v[124:125], v30 offset:26240
    ds_read_b64_tr_b16 v[126:127], v30 offset:27264
    v_mfma_f32_16x16x32_bf16 v[240:243], v[64:67], v[44:47], v[240:243]
    v_cvt_pk_bf16_f32 v0, v0, v1
    v_cvt_pk_bf16_f32 v1, v2, v3
    v_mfma_f32_16x16x32_bf16 v[148:151], v[68:71], v[32:35], v[148:151]
    v_cvt_pk_bf16_f32 v2, v4, v5
    v_cvt_pk_bf16_f32 v3, v6, v7
    v_mfma_f32_16x16x32_bf16 v[180:183], v[68:71], v[36:39], v[180:183]
    buffer_load_dwordx4 v20, s[24:27], s36 offen offset:3072 lds
    v_mfma_f32_16x16x32_bf16 v[212:215], v[68:71], v[40:43], v[212:215]
    s_add_u32 s37, s49, 3407872
    v_accvgpr_read_b32 v12, a108
    v_accvgpr_read_b32 v13, a109
    v_mfma_f32_16x16x32_bf16 v[244:247], v[68:71], v[44:47], v[244:247]
    s_add_u32 m0, s50, 8704
    v_accvgpr_read_b32 v14, a110
    v_accvgpr_read_b32 v15, a111
    v_mfma_f32_16x16x32_bf16 v[152:155], v[72:75], v[32:35], v[152:155]
    buffer_load_dwordx4 v21, s[20:23], s37 offen offset:0 lds
    v_mfma_f32_16x16x32_bf16 v[184:187], v[72:75], v[36:39], v[184:187]
    v_accvgpr_read_b32 v8, a76
    v_accvgpr_read_b32 v9, a77
    v_mfma_f32_16x16x32_bf16 v[216:219], v[72:75], v[40:43], v[216:219]
    v_accvgpr_read_b32 v10, a78
    v_accvgpr_read_b32 v11, a79
    v_mfma_f32_16x16x32_bf16 v[248:251], v[72:75], v[44:47], v[248:251]
    buffer_store_dwordx4 v[0:3], v16, s[16:19], s38 offen offset:3072
    v_mfma_f32_16x16x32_bf16 v[156:159], v[76:79], v[32:35], v[156:159]
    s_add_u32 s38, s38, 16384
    v_mul_f32 v8, s40, v8
    v_mul_f32 v9, s40, v9
    v_mfma_f32_16x16x32_bf16 v[188:191], v[76:79], v[36:39], v[188:191]
    v_mul_f32 v10, s40, v10
    v_mul_f32 v11, s40, v11
    v_mfma_f32_16x16x32_bf16 v[220:223], v[76:79], v[40:43], v[220:223]
    buffer_load_dwordx4 v22, s[20:23], s37 offen offset:1024 lds
    v_mfma_f32_16x16x32_bf16 v[252:255], v[76:79], v[44:47], v[252:255]
    s_waitcnt vmcnt(16) lgkmcnt(0)
    s_barrier
    v_mul_f32 v12, s40, v12
    v_mul_f32 v13, s40, v13
    v_mfma_f32_16x16x32_bf16 v[128:131], v[96:99], v[80:83], v[128:131]
    ds_read_b64_tr_b16 v[48:49], v27 offset:34816
    ds_read_b64_tr_b16 v[50:51], v27 offset:35840
    v_mfma_f32_16x16x32_bf16 v[160:163], v[96:99], v[84:87], v[160:163]
    s_add_u32 s36, s44, 896
    v_mul_f32 v14, s40, v14
    v_mul_f32 v15, s40, v15
    v_mfma_f32_16x16x32_bf16 v[192:195], v[96:99], v[88:91], v[192:195]
    s_add_u32 m0, s42, 0
    ds_read_b128 v[32:35], v23 offset:32768
    ds_read_b128 v[36:39], v23 offset:34816
    v_mfma_f32_16x16x32_bf16 v[224:227], v[96:99], v[92:95], v[224:227]
    buffer_load_dwordx4 v17, s[24:27], s36 offen offset:0 lds
    v_mfma_f32_16x16x32_bf16 v[132:135], v[100:103], v[80:83], v[132:135]
    ds_read_b128 v[40:43], v23 offset:36864
    ds_read_b128 v[44:47], v23 offset:38912
    v_mfma_f32_16x16x32_bf16 v[164:167], v[100:103], v[84:87], v[164:167]
    v_cvt_pk_bf16_f32 v8, v8, v9
    v_cvt_pk_bf16_f32 v9, v10, v11
    v_mfma_f32_16x16x32_bf16 v[196:199], v[100:103], v[88:91], v[196:199]
    ds_read_b64_tr_b16 v[52:53], v28 offset:34816
    ds_read_b64_tr_b16 v[54:55], v28 offset:35840
    v_mfma_f32_16x16x32_bf16 v[228:231], v[100:103], v[92:95], v[228:231]
    buffer_load_dwordx4 v18, s[24:27], s36 offen offset:1024 lds
    v_mfma_f32_16x16x32_bf16 v[136:139], v[104:107], v[80:83], v[136:139]
    ds_read_b64_tr_b16 v[56:57], v29 offset:34816
    ds_read_b64_tr_b16 v[58:59], v29 offset:35840
    v_mfma_f32_16x16x32_bf16 v[168:171], v[104:107], v[84:87], v[168:171]
    v_cvt_pk_bf16_f32 v10, v12, v13
    v_cvt_pk_bf16_f32 v11, v14, v15
    v_mfma_f32_16x16x32_bf16 v[200:203], v[104:107], v[88:91], v[200:203]
    ds_read_b64_tr_b16 v[60:61], v30 offset:34816
    ds_read_b64_tr_b16 v[62:63], v30 offset:35840
    v_mfma_f32_16x16x32_bf16 v[232:235], v[104:107], v[92:95], v[232:235]
    buffer_store_dwordx4 v[8:11], v16, s[16:19], s41 offen offset:1024
    v_mfma_f32_16x16x32_bf16 v[140:143], v[108:111], v[80:83], v[140:143]
    s_add_u32 s41, s41, 12288
    ds_read_b64_tr_b16 v[64:65], v27 offset:34944
    ds_read_b64_tr_b16 v[66:67], v27 offset:35968
    v_mfma_f32_16x16x32_bf16 v[172:175], v[108:111], v[84:87], v[172:175]
    v_accvgpr_read_b32 v4, a148
    v_accvgpr_read_b32 v5, a149
    v_mfma_f32_16x16x32_bf16 v[204:207], v[108:111], v[88:91], v[204:207]
    ds_read_b64_tr_b16 v[68:69], v28 offset:34944
    ds_read_b64_tr_b16 v[70:71], v28 offset:35968
    v_mfma_f32_16x16x32_bf16 v[236:239], v[108:111], v[92:95], v[236:239]
    buffer_load_dwordx4 v19, s[24:27], s36 offen offset:2048 lds
    v_mfma_f32_16x16x32_bf16 v[144:147], v[112:115], v[80:83], v[144:147]
    ds_read_b64_tr_b16 v[72:73], v29 offset:34944
    ds_read_b64_tr_b16 v[74:75], v29 offset:35968
    v_mfma_f32_16x16x32_bf16 v[176:179], v[112:115], v[84:87], v[176:179]
    v_accvgpr_read_b32 v6, a150
    v_accvgpr_read_b32 v7, a151
    v_mfma_f32_16x16x32_bf16 v[208:211], v[112:115], v[88:91], v[208:211]
    ds_read_b64_tr_b16 v[76:77], v30 offset:34944
    ds_read_b64_tr_b16 v[78:79], v30 offset:35968
    v_mfma_f32_16x16x32_bf16 v[240:243], v[112:115], v[92:95], v[240:243]
    v_accvgpr_read_b32 v0, a144
    v_accvgpr_read_b32 v1, a145
    v_mfma_f32_16x16x32_bf16 v[148:151], v[116:119], v[80:83], v[148:151]
    v_accvgpr_read_b32 v2, a146
    v_accvgpr_read_b32 v3, a147
    v_mfma_f32_16x16x32_bf16 v[180:183], v[116:119], v[84:87], v[180:183]
    buffer_load_dwordx4 v20, s[24:27], s36 offen offset:3072 lds
    v_mfma_f32_16x16x32_bf16 v[212:215], v[116:119], v[88:91], v[212:215]
    s_add_u32 s37, s49, 3670016
    v_cvt_pk_bf16_f32 v0, v0, v1
    v_cvt_pk_bf16_f32 v1, v2, v3
    v_mfma_f32_16x16x32_bf16 v[244:247], v[116:119], v[92:95], v[244:247]
    s_add_u32 m0, s50, 17408
    v_cvt_pk_bf16_f32 v2, v4, v5
    v_cvt_pk_bf16_f32 v3, v6, v7
    v_mfma_f32_16x16x32_bf16 v[152:155], v[120:123], v[80:83], v[152:155]
    buffer_load_dwordx4 v21, s[20:23], s37 offen offset:0 lds
    v_mfma_f32_16x16x32_bf16 v[184:187], v[120:123], v[84:87], v[184:187]
    v_accvgpr_read_b32 v12, a48
    v_accvgpr_read_b32 v13, a49
    v_mfma_f32_16x16x32_bf16 v[216:219], v[120:123], v[88:91], v[216:219]
    v_accvgpr_read_b32 v14, a50
    v_accvgpr_read_b32 v15, a51
    v_mfma_f32_16x16x32_bf16 v[248:251], v[120:123], v[92:95], v[248:251]
    buffer_store_dwordx4 v[0:3], v16, s[16:19], s38 offen offset:0
    v_mfma_f32_16x16x32_bf16 v[156:159], v[124:127], v[80:83], v[156:159]
    v_accvgpr_read_b32 v8, a16
    v_accvgpr_read_b32 v9, a17
    v_mfma_f32_16x16x32_bf16 v[188:191], v[124:127], v[84:87], v[188:191]
    v_accvgpr_read_b32 v10, a18
    v_accvgpr_read_b32 v11, a19
    v_mfma_f32_16x16x32_bf16 v[220:223], v[124:127], v[88:91], v[220:223]
    buffer_load_dwordx4 v22, s[20:23], s37 offen offset:1024 lds
    v_mfma_f32_16x16x32_bf16 v[252:255], v[124:127], v[92:95], v[252:255]
    s_waitcnt lgkmcnt(0)
    v_mul_f32 v8, s40, v8
    v_mul_f32 v9, s40, v9
    v_mfma_f32_16x16x32_bf16 v[128:131], v[48:51], v[32:35], v[128:131]
    ds_read_b64_tr_b16 v[96:97], v27 offset:43520
    ds_read_b64_tr_b16 v[98:99], v27 offset:44544
    v_mfma_f32_16x16x32_bf16 v[160:163], v[48:51], v[36:39], v[160:163]
    s_add_u32 s36, s45, 896
    v_mul_f32 v10, s40, v10
    v_mul_f32 v11, s40, v11
    v_mfma_f32_16x16x32_bf16 v[192:195], v[48:51], v[40:43], v[192:195]
    s_add_u32 m0, s42, 4096
    ds_read_b128 v[80:83], v24 offset:32768
    ds_read_b128 v[84:87], v24 offset:34816
    v_mfma_f32_16x16x32_bf16 v[224:227], v[48:51], v[44:47], v[224:227]
    buffer_load_dwordx4 v17, s[24:27], s36 offen offset:0 lds
    v_mfma_f32_16x16x32_bf16 v[132:135], v[52:55], v[32:35], v[132:135]
    ds_read_b128 v[88:91], v24 offset:36864
    ds_read_b128 v[92:95], v24 offset:38912
    v_mfma_f32_16x16x32_bf16 v[164:167], v[52:55], v[36:39], v[164:167]
    v_mul_f32 v12, s40, v12
    v_mul_f32 v13, s40, v13
    v_mfma_f32_16x16x32_bf16 v[196:199], v[52:55], v[40:43], v[196:199]
    ds_read_b64_tr_b16 v[100:101], v28 offset:43520
    ds_read_b64_tr_b16 v[102:103], v28 offset:44544
    v_mfma_f32_16x16x32_bf16 v[228:231], v[52:55], v[44:47], v[228:231]
    buffer_load_dwordx4 v18, s[24:27], s36 offen offset:1024 lds
    v_mfma_f32_16x16x32_bf16 v[136:139], v[56:59], v[32:35], v[136:139]
    ds_read_b64_tr_b16 v[104:105], v29 offset:43520
    ds_read_b64_tr_b16 v[106:107], v29 offset:44544
    v_mfma_f32_16x16x32_bf16 v[168:171], v[56:59], v[36:39], v[168:171]
    v_mul_f32 v14, s40, v14
    v_mul_f32 v15, s40, v15
    v_mfma_f32_16x16x32_bf16 v[200:203], v[56:59], v[40:43], v[200:203]
    ds_read_b64_tr_b16 v[108:109], v30 offset:43520
    ds_read_b64_tr_b16 v[110:111], v30 offset:44544
    v_mfma_f32_16x16x32_bf16 v[232:235], v[56:59], v[44:47], v[232:235]
    v_mfma_f32_16x16x32_bf16 v[140:143], v[60:63], v[32:35], v[140:143]
    ds_read_b64_tr_b16 v[112:113], v27 offset:43648
    ds_read_b64_tr_b16 v[114:115], v27 offset:44672
    v_mfma_f32_16x16x32_bf16 v[172:175], v[60:63], v[36:39], v[172:175]
    v_cvt_pk_bf16_f32 v8, v8, v9
    v_cvt_pk_bf16_f32 v9, v10, v11
    v_mfma_f32_16x16x32_bf16 v[204:207], v[60:63], v[40:43], v[204:207]
    ds_read_b64_tr_b16 v[116:117], v28 offset:43648
    ds_read_b64_tr_b16 v[118:119], v28 offset:44672
    v_mfma_f32_16x16x32_bf16 v[236:239], v[60:63], v[44:47], v[236:239]
    buffer_load_dwordx4 v19, s[24:27], s36 offen offset:2048 lds
    v_mfma_f32_16x16x32_bf16 v[144:147], v[64:67], v[32:35], v[144:147]
    ds_read_b64_tr_b16 v[120:121], v29 offset:43648
    ds_read_b64_tr_b16 v[122:123], v29 offset:44672
    v_mfma_f32_16x16x32_bf16 v[176:179], v[64:67], v[36:39], v[176:179]
    v_cvt_pk_bf16_f32 v10, v12, v13
    v_cvt_pk_bf16_f32 v11, v14, v15
    v_mfma_f32_16x16x32_bf16 v[208:211], v[64:67], v[40:43], v[208:211]
    ds_read_b64_tr_b16 v[124:125], v30 offset:43648
    ds_read_b64_tr_b16 v[126:127], v30 offset:44672
    v_mfma_f32_16x16x32_bf16 v[240:243], v[64:67], v[44:47], v[240:243]
    v_accvgpr_read_b32 v4, a180
    v_accvgpr_read_b32 v5, a181
    v_mfma_f32_16x16x32_bf16 v[148:151], v[68:71], v[32:35], v[148:151]
    v_accvgpr_read_b32 v6, a182
    v_accvgpr_read_b32 v7, a183
    v_mfma_f32_16x16x32_bf16 v[180:183], v[68:71], v[36:39], v[180:183]
    buffer_load_dwordx4 v20, s[24:27], s36 offen offset:3072 lds
    v_mfma_f32_16x16x32_bf16 v[212:215], v[68:71], v[40:43], v[212:215]
    s_add_u32 s37, s49, 3932160
    v_accvgpr_read_b32 v0, a176
    v_accvgpr_read_b32 v1, a177
    v_mfma_f32_16x16x32_bf16 v[244:247], v[68:71], v[44:47], v[244:247]
    s_add_u32 m0, s50, 26112
    v_accvgpr_read_b32 v2, a178
    v_accvgpr_read_b32 v3, a179
    v_mfma_f32_16x16x32_bf16 v[152:155], v[72:75], v[32:35], v[152:155]
    buffer_load_dwordx4 v21, s[20:23], s37 offen offset:0 lds
    v_mfma_f32_16x16x32_bf16 v[184:187], v[72:75], v[36:39], v[184:187]
    v_cvt_pk_bf16_f32 v0, v0, v1
    v_cvt_pk_bf16_f32 v1, v2, v3
    v_mfma_f32_16x16x32_bf16 v[216:219], v[72:75], v[40:43], v[216:219]
    v_cvt_pk_bf16_f32 v2, v4, v5
    v_cvt_pk_bf16_f32 v3, v6, v7
    v_mfma_f32_16x16x32_bf16 v[248:251], v[72:75], v[44:47], v[248:251]
    buffer_store_dwordx4 v[8:11], v16, s[16:19], s41 offen offset:0
    v_mfma_f32_16x16x32_bf16 v[156:159], v[76:79], v[32:35], v[156:159]
    v_accvgpr_read_b32 v12, a112
    v_accvgpr_read_b32 v13, a113
    v_mfma_f32_16x16x32_bf16 v[188:191], v[76:79], v[36:39], v[188:191]
    v_accvgpr_read_b32 v14, a114
    v_accvgpr_read_b32 v15, a115
    v_mfma_f32_16x16x32_bf16 v[220:223], v[76:79], v[40:43], v[220:223]
    buffer_load_dwordx4 v22, s[20:23], s37 offen offset:1024 lds
    v_mfma_f32_16x16x32_bf16 v[252:255], v[76:79], v[44:47], v[252:255]
    s_waitcnt vmcnt(15) lgkmcnt(0)
    s_barrier
    v_accvgpr_read_b32 v8, a80
    v_accvgpr_read_b32 v9, a81
    v_mfma_f32_16x16x32_bf16 v[128:131], v[96:99], v[80:83], v[128:131]
    ds_read_b64_tr_b16 v[48:49], v27 offset:0
    ds_read_b64_tr_b16 v[50:51], v27 offset:1024
    v_mfma_f32_16x16x32_bf16 v[160:163], v[96:99], v[84:87], v[160:163]
    s_add_u32 s36, s44, 1024
    v_accvgpr_read_b32 v10, a82
    v_accvgpr_read_b32 v11, a83
    v_mfma_f32_16x16x32_bf16 v[192:195], v[96:99], v[88:91], v[192:195]
    s_add_u32 m0, s42, 32768
    ds_read_b128 v[32:35], v25 offset:0
    ds_read_b128 v[36:39], v25 offset:2048
    v_mfma_f32_16x16x32_bf16 v[224:227], v[96:99], v[92:95], v[224:227]
    buffer_load_dwordx4 v17, s[24:27], s36 offen offset:0 lds
    v_mfma_f32_16x16x32_bf16 v[132:135], v[100:103], v[80:83], v[132:135]
    ds_read_b128 v[40:43], v25 offset:4096
    ds_read_b128 v[44:47], v25 offset:6144
    v_mfma_f32_16x16x32_bf16 v[164:167], v[100:103], v[84:87], v[164:167]
    v_mul_f32 v8, s40, v8
    v_mul_f32 v9, s40, v9
    v_mfma_f32_16x16x32_bf16 v[196:199], v[100:103], v[88:91], v[196:199]
    ds_read_b64_tr_b16 v[52:53], v28 offset:0
    ds_read_b64_tr_b16 v[54:55], v28 offset:1024
    v_mfma_f32_16x16x32_bf16 v[228:231], v[100:103], v[92:95], v[228:231]
    buffer_load_dwordx4 v18, s[24:27], s36 offen offset:1024 lds
    v_mfma_f32_16x16x32_bf16 v[136:139], v[104:107], v[80:83], v[136:139]
    ds_read_b64_tr_b16 v[56:57], v29 offset:0
    ds_read_b64_tr_b16 v[58:59], v29 offset:1024
    v_mfma_f32_16x16x32_bf16 v[168:171], v[104:107], v[84:87], v[168:171]
    v_mul_f32 v10, s40, v10
    v_mul_f32 v11, s40, v11
    v_mfma_f32_16x16x32_bf16 v[200:203], v[104:107], v[88:91], v[200:203]
    ds_read_b64_tr_b16 v[60:61], v30 offset:0
    ds_read_b64_tr_b16 v[62:63], v30 offset:1024
    v_mfma_f32_16x16x32_bf16 v[232:235], v[104:107], v[92:95], v[232:235]
    buffer_store_dwordx4 v[0:3], v16, s[16:19], s38 offen offset:1024
    v_mfma_f32_16x16x32_bf16 v[140:143], v[108:111], v[80:83], v[140:143]
    ds_read_b64_tr_b16 v[64:65], v27 offset:128
    ds_read_b64_tr_b16 v[66:67], v27 offset:1152
    v_mfma_f32_16x16x32_bf16 v[172:175], v[108:111], v[84:87], v[172:175]
    v_mul_f32 v12, s40, v12
    v_mul_f32 v13, s40, v13
    v_mfma_f32_16x16x32_bf16 v[204:207], v[108:111], v[88:91], v[204:207]
    ds_read_b64_tr_b16 v[68:69], v28 offset:128
    ds_read_b64_tr_b16 v[70:71], v28 offset:1152
    v_mfma_f32_16x16x32_bf16 v[236:239], v[108:111], v[92:95], v[236:239]
    buffer_load_dwordx4 v19, s[24:27], s36 offen offset:2048 lds
    v_mfma_f32_16x16x32_bf16 v[144:147], v[112:115], v[80:83], v[144:147]
    ds_read_b64_tr_b16 v[72:73], v29 offset:128
    ds_read_b64_tr_b16 v[74:75], v29 offset:1152
    v_mfma_f32_16x16x32_bf16 v[176:179], v[112:115], v[84:87], v[176:179]
    v_mul_f32 v14, s40, v14
    v_mul_f32 v15, s40, v15
    v_mfma_f32_16x16x32_bf16 v[208:211], v[112:115], v[88:91], v[208:211]
    ds_read_b64_tr_b16 v[76:77], v30 offset:128
    ds_read_b64_tr_b16 v[78:79], v30 offset:1152
    v_mfma_f32_16x16x32_bf16 v[240:243], v[112:115], v[92:95], v[240:243]
    v_cvt_pk_bf16_f32 v8, v8, v9
    v_cvt_pk_bf16_f32 v9, v10, v11
    v_mfma_f32_16x16x32_bf16 v[148:151], v[116:119], v[80:83], v[148:151]
    v_cvt_pk_bf16_f32 v10, v12, v13
    v_cvt_pk_bf16_f32 v11, v14, v15
    v_mfma_f32_16x16x32_bf16 v[180:183], v[116:119], v[84:87], v[180:183]
    buffer_load_dwordx4 v20, s[24:27], s36 offen offset:3072 lds
    v_mfma_f32_16x16x32_bf16 v[212:215], v[116:119], v[88:91], v[212:215]
    s_add_u32 s37, s49, 4194304
    v_accvgpr_read_b32 v4, a212
    v_accvgpr_read_b32 v5, a213
    v_mfma_f32_16x16x32_bf16 v[244:247], v[116:119], v[92:95], v[244:247]
    s_add_u32 m0, s50, 34816
    v_accvgpr_read_b32 v6, a214
    v_accvgpr_read_b32 v7, a215
    v_mfma_f32_16x16x32_bf16 v[152:155], v[120:123], v[80:83], v[152:155]
    buffer_load_dwordx4 v21, s[20:23], s37 offen offset:0 lds
    v_mfma_f32_16x16x32_bf16 v[184:187], v[120:123], v[84:87], v[184:187]
    v_accvgpr_read_b32 v0, a208
    v_accvgpr_read_b32 v1, a209
    v_mfma_f32_16x16x32_bf16 v[216:219], v[120:123], v[88:91], v[216:219]
    v_accvgpr_read_b32 v2, a210
    v_accvgpr_read_b32 v3, a211
    v_mfma_f32_16x16x32_bf16 v[248:251], v[120:123], v[92:95], v[248:251]
    buffer_store_dwordx4 v[8:11], v16, s[16:19], s41 offen offset:1024
    v_mfma_f32_16x16x32_bf16 v[156:159], v[124:127], v[80:83], v[156:159]
    s_add_u32 s41, s41, 4096
    v_cvt_pk_bf16_f32 v0, v0, v1
    v_cvt_pk_bf16_f32 v1, v2, v3
    v_mfma_f32_16x16x32_bf16 v[188:191], v[124:127], v[84:87], v[188:191]
    v_cvt_pk_bf16_f32 v2, v4, v5
    v_cvt_pk_bf16_f32 v3, v6, v7
    v_mfma_f32_16x16x32_bf16 v[220:223], v[124:127], v[88:91], v[220:223]
    buffer_load_dwordx4 v22, s[20:23], s37 offen offset:1024 lds
    v_mfma_f32_16x16x32_bf16 v[252:255], v[124:127], v[92:95], v[252:255]
    s_waitcnt lgkmcnt(0)
    v_accvgpr_read_b32 v12, a52
    v_accvgpr_read_b32 v13, a53
    v_mfma_f32_16x16x32_bf16 v[128:131], v[48:51], v[32:35], v[128:131]
    ds_read_b64_tr_b16 v[96:97], v27 offset:8704
    ds_read_b64_tr_b16 v[98:99], v27 offset:9728
    v_mfma_f32_16x16x32_bf16 v[160:163], v[48:51], v[36:39], v[160:163]
    s_add_u32 s36, s45, 1024
    v_accvgpr_read_b32 v14, a54
    v_accvgpr_read_b32 v15, a55
    v_mfma_f32_16x16x32_bf16 v[192:195], v[48:51], v[40:43], v[192:195]
gated_mix__ssm_conv_h3__compressed_kv_cla__prompt_kernel_pad5:
    s_cbranch_execz gated_mix__ssm_conv_h3__compressed_kv_cla__prompt_kernel_pad9
    s_add_u32 m0, s42, 36864
    ds_read_b128 v[80:83], v26 offset:0
    ds_read_b128 v[84:87], v26 offset:2048
    v_mfma_f32_16x16x32_bf16 v[224:227], v[48:51], v[44:47], v[224:227]
    buffer_load_dwordx4 v17, s[24:27], s36 offen offset:0 lds
    v_mfma_f32_16x16x32_bf16 v[132:135], v[52:55], v[32:35], v[132:135]
    ds_read_b128 v[88:91], v26 offset:4096
    ds_read_b128 v[92:95], v26 offset:6144
    v_mfma_f32_16x16x32_bf16 v[164:167], v[52:55], v[36:39], v[164:167]
    v_accvgpr_read_b32 v8, a20
    v_accvgpr_read_b32 v9, a21
    v_mfma_f32_16x16x32_bf16 v[196:199], v[52:55], v[40:43], v[196:199]
    ds_read_b64_tr_b16 v[100:101], v28 offset:8704
    ds_read_b64_tr_b16 v[102:103], v28 offset:9728
    v_mfma_f32_16x16x32_bf16 v[228:231], v[52:55], v[44:47], v[228:231]
    buffer_load_dwordx4 v18, s[24:27], s36 offen offset:1024 lds
    v_mfma_f32_16x16x32_bf16 v[136:139], v[56:59], v[32:35], v[136:139]
    ds_read_b64_tr_b16 v[104:105], v29 offset:8704
    ds_read_b64_tr_b16 v[106:107], v29 offset:9728
    v_mfma_f32_16x16x32_bf16 v[168:171], v[56:59], v[36:39], v[168:171]
    v_accvgpr_read_b32 v10, a22
    v_accvgpr_read_b32 v11, a23
    v_mfma_f32_16x16x32_bf16 v[200:203], v[56:59], v[40:43], v[200:203]
    ds_read_b64_tr_b16 v[108:109], v30 offset:8704
    ds_read_b64_tr_b16 v[110:111], v30 offset:9728
    v_mfma_f32_16x16x32_bf16 v[232:235], v[56:59], v[44:47], v[232:235]
    buffer_store_dwordx4 v[0:3], v16, s[16:19], s38 offen offset:2048
    v_mfma_f32_16x16x32_bf16 v[140:143], v[60:63], v[32:35], v[140:143]
    ds_read_b64_tr_b16 v[112:113], v27 offset:8832
    ds_read_b64_tr_b16 v[114:115], v27 offset:9856
    v_mfma_f32_16x16x32_bf16 v[172:175], v[60:63], v[36:39], v[172:175]
    v_mul_f32 v8, s40, v8
    v_mul_f32 v9, s40, v9
    v_mfma_f32_16x16x32_bf16 v[204:207], v[60:63], v[40:43], v[204:207]
    ds_read_b64_tr_b16 v[116:117], v28 offset:8832
    ds_read_b64_tr_b16 v[118:119], v28 offset:9856
    v_mfma_f32_16x16x32_bf16 v[236:239], v[60:63], v[44:47], v[236:239]
    buffer_load_dwordx4 v19, s[24:27], s36 offen offset:2048 lds
    v_mfma_f32_16x16x32_bf16 v[144:147], v[64:67], v[32:35], v[144:147]
    ds_read_b64_tr_b16 v[120:121], v29 offset:8832
    ds_read_b64_tr_b16 v[122:123], v29 offset:9856
    v_mfma_f32_16x16x32_bf16 v[176:179], v[64:67], v[36:39], v[176:179]
    v_mul_f32 v10, s40, v10
    v_mul_f32 v11, s40, v11
    v_mfma_f32_16x16x32_bf16 v[208:211], v[64:67], v[40:43], v[208:211]
    ds_read_b64_tr_b16 v[124:125], v30 offset:8832
    ds_read_b64_tr_b16 v[126:127], v30 offset:9856
    v_mfma_f32_16x16x32_bf16 v[240:243], v[64:67], v[44:47], v[240:243]
    v_mul_f32 v12, s40, v12
    v_mul_f32 v13, s40, v13
    v_mfma_f32_16x16x32_bf16 v[148:151], v[68:71], v[32:35], v[148:151]
    v_mul_f32 v14, s40, v14
    v_mul_f32 v15, s40, v15
    v_mfma_f32_16x16x32_bf16 v[180:183], v[68:71], v[36:39], v[180:183]
    buffer_load_dwordx4 v20, s[24:27], s36 offen offset:3072 lds
    v_mfma_f32_16x16x32_bf16 v[212:215], v[68:71], v[40:43], v[212:215]
    s_add_u32 s37, s49, 4456448
    v_cvt_pk_bf16_f32 v8, v8, v9
    v_cvt_pk_bf16_f32 v9, v10, v11
    v_mfma_f32_16x16x32_bf16 v[244:247], v[68:71], v[44:47], v[244:247]
    s_add_u32 m0, s50, 43520
    v_cvt_pk_bf16_f32 v10, v12, v13
    v_cvt_pk_bf16_f32 v11, v14, v15
    v_mfma_f32_16x16x32_bf16 v[152:155], v[72:75], v[32:35], v[152:155]
    buffer_load_dwordx4 v21, s[20:23], s37 offen offset:0 lds
    v_mfma_f32_16x16x32_bf16 v[184:187], v[72:75], v[36:39], v[184:187]
    v_accvgpr_read_b32 v4, a244
    v_accvgpr_read_b32 v5, a245
    v_mfma_f32_16x16x32_bf16 v[216:219], v[72:75], v[40:43], v[216:219]
    v_accvgpr_read_b32 v6, a246
    v_accvgpr_read_b32 v7, a247
    v_mfma_f32_16x16x32_bf16 v[248:251], v[72:75], v[44:47], v[248:251]
    buffer_store_dwordx4 v[8:11], v16, s[16:19], s41 offen offset:0
    v_mfma_f32_16x16x32_bf16 v[156:159], v[76:79], v[32:35], v[156:159]
    v_accvgpr_read_b32 v0, a240
    v_accvgpr_read_b32 v1, a241
    v_mfma_f32_16x16x32_bf16 v[188:191], v[76:79], v[36:39], v[188:191]
    v_accvgpr_read_b32 v2, a242
    v_accvgpr_read_b32 v3, a243
    v_mfma_f32_16x16x32_bf16 v[220:223], v[76:79], v[40:43], v[220:223]
    buffer_load_dwordx4 v22, s[20:23], s37 offen offset:1024 lds
    v_mfma_f32_16x16x32_bf16 v[252:255], v[76:79], v[44:47], v[252:255]
    s_waitcnt vmcnt(16) lgkmcnt(0)
    s_barrier
    v_cvt_pk_bf16_f32 v0, v0, v1
    v_cvt_pk_bf16_f32 v1, v2, v3
    v_mfma_f32_16x16x32_bf16 v[128:131], v[96:99], v[80:83], v[128:131]
    ds_read_b64_tr_b16 v[48:49], v27 offset:17408
    ds_read_b64_tr_b16 v[50:51], v27 offset:18432
    v_mfma_f32_16x16x32_bf16 v[160:163], v[96:99], v[84:87], v[160:163]
    s_add_u32 s36, s44, 1152
    v_cvt_pk_bf16_f32 v2, v4, v5
    v_cvt_pk_bf16_f32 v3, v6, v7
    v_mfma_f32_16x16x32_bf16 v[192:195], v[96:99], v[88:91], v[192:195]
    s_add_u32 m0, s42, 65536
    ds_read_b128 v[32:35], v23 offset:0
    ds_read_b128 v[36:39], v23 offset:2048
    v_mfma_f32_16x16x32_bf16 v[224:227], v[96:99], v[92:95], v[224:227]
    buffer_load_dwordx4 v17, s[24:27], s36 offen offset:0 lds
    v_mfma_f32_16x16x32_bf16 v[132:135], v[100:103], v[80:83], v[132:135]
    ds_read_b128 v[40:43], v23 offset:4096
    ds_read_b128 v[44:47], v23 offset:6144
    v_mfma_f32_16x16x32_bf16 v[164:167], v[100:103], v[84:87], v[164:167]
    v_accvgpr_read_b32 v12, a116
    v_accvgpr_read_b32 v13, a117
    v_mfma_f32_16x16x32_bf16 v[196:199], v[100:103], v[88:91], v[196:199]
    ds_read_b64_tr_b16 v[52:53], v28 offset:17408
    ds_read_b64_tr_b16 v[54:55], v28 offset:18432
    v_mfma_f32_16x16x32_bf16 v[228:231], v[100:103], v[92:95], v[228:231]
    buffer_load_dwordx4 v18, s[24:27], s36 offen offset:1024 lds
    v_mfma_f32_16x16x32_bf16 v[136:139], v[104:107], v[80:83], v[136:139]
    ds_read_b64_tr_b16 v[56:57], v29 offset:17408
    ds_read_b64_tr_b16 v[58:59], v29 offset:18432
    v_mfma_f32_16x16x32_bf16 v[168:171], v[104:107], v[84:87], v[168:171]
    v_accvgpr_read_b32 v14, a118
    v_accvgpr_read_b32 v15, a119
    v_mfma_f32_16x16x32_bf16 v[200:203], v[104:107], v[88:91], v[200:203]
    ds_read_b64_tr_b16 v[60:61], v30 offset:17408
    ds_read_b64_tr_b16 v[62:63], v30 offset:18432
    v_mfma_f32_16x16x32_bf16 v[232:235], v[104:107], v[92:95], v[232:235]
    buffer_store_dwordx4 v[0:3], v16, s[16:19], s38 offen offset:3072
    v_mfma_f32_16x16x32_bf16 v[140:143], v[108:111], v[80:83], v[140:143]
    s_add_u32 s38, s38, 16384
    ds_read_b64_tr_b16 v[64:65], v27 offset:17536
    ds_read_b64_tr_b16 v[66:67], v27 offset:18560
    v_mfma_f32_16x16x32_bf16 v[172:175], v[108:111], v[84:87], v[172:175]
    v_accvgpr_read_b32 v8, a84
    v_accvgpr_read_b32 v9, a85
    v_mfma_f32_16x16x32_bf16 v[204:207], v[108:111], v[88:91], v[204:207]
    ds_read_b64_tr_b16 v[68:69], v28 offset:17536
    ds_read_b64_tr_b16 v[70:71], v28 offset:18560
    v_mfma_f32_16x16x32_bf16 v[236:239], v[108:111], v[92:95], v[236:239]
    buffer_load_dwordx4 v19, s[24:27], s36 offen offset:2048 lds
    v_mfma_f32_16x16x32_bf16 v[144:147], v[112:115], v[80:83], v[144:147]
    ds_read_b64_tr_b16 v[72:73], v29 offset:17536
    ds_read_b64_tr_b16 v[74:75], v29 offset:18560
    v_mfma_f32_16x16x32_bf16 v[176:179], v[112:115], v[84:87], v[176:179]
    v_accvgpr_read_b32 v10, a86
    v_accvgpr_read_b32 v11, a87
    v_mfma_f32_16x16x32_bf16 v[208:211], v[112:115], v[88:91], v[208:211]
    ds_read_b64_tr_b16 v[76:77], v30 offset:17536
    ds_read_b64_tr_b16 v[78:79], v30 offset:18560
    v_mfma_f32_16x16x32_bf16 v[240:243], v[112:115], v[92:95], v[240:243]
    v_mul_f32 v8, s40, v8
    v_mul_f32 v9, s40, v9
    v_mfma_f32_16x16x32_bf16 v[148:151], v[116:119], v[80:83], v[148:151]
    v_mul_f32 v10, s40, v10
    v_mul_f32 v11, s40, v11
    v_mfma_f32_16x16x32_bf16 v[180:183], v[116:119], v[84:87], v[180:183]
    buffer_load_dwordx4 v20, s[24:27], s36 offen offset:3072 lds
    v_mfma_f32_16x16x32_bf16 v[212:215], v[116:119], v[88:91], v[212:215]
    s_add_u32 s37, s49, 4718592
    v_mul_f32 v12, s40, v12
    v_mul_f32 v13, s40, v13
    v_mfma_f32_16x16x32_bf16 v[244:247], v[116:119], v[92:95], v[244:247]
    s_add_u32 m0, s50, 0
    v_mul_f32 v14, s40, v14
    v_mul_f32 v15, s40, v15
    v_mfma_f32_16x16x32_bf16 v[152:155], v[120:123], v[80:83], v[152:155]
    buffer_load_dwordx4 v21, s[20:23], s37 offen offset:0 lds
    v_mfma_f32_16x16x32_bf16 v[184:187], v[120:123], v[84:87], v[184:187]
    v_cvt_pk_bf16_f32 v8, v8, v9
    v_cvt_pk_bf16_f32 v9, v10, v11
    v_mfma_f32_16x16x32_bf16 v[216:219], v[120:123], v[88:91], v[216:219]
    v_cvt_pk_bf16_f32 v10, v12, v13
    v_cvt_pk_bf16_f32 v11, v14, v15
    v_mfma_f32_16x16x32_bf16 v[248:251], v[120:123], v[92:95], v[248:251]
    buffer_store_dwordx4 v[8:11], v16, s[16:19], s41 offen offset:1024
    v_mfma_f32_16x16x32_bf16 v[156:159], v[124:127], v[80:83], v[156:159]
    s_add_u32 s41, s41, 12288
    v_accvgpr_read_b32 v4, a156
    v_accvgpr_read_b32 v5, a157
    v_mfma_f32_16x16x32_bf16 v[188:191], v[124:127], v[84:87], v[188:191]
    v_accvgpr_read_b32 v6, a158
    v_accvgpr_read_b32 v7, a159
    v_mfma_f32_16x16x32_bf16 v[220:223], v[124:127], v[88:91], v[220:223]
    buffer_load_dwordx4 v22, s[20:23], s37 offen offset:1024 lds
    v_mfma_f32_16x16x32_bf16 v[252:255], v[124:127], v[92:95], v[252:255]
    s_waitcnt lgkmcnt(0)
    v_accvgpr_read_b32 v0, a152
    v_accvgpr_read_b32 v1, a153
    v_mfma_f32_16x16x32_bf16 v[128:131], v[48:51], v[32:35], v[128:131]
    ds_read_b64_tr_b16 v[96:97], v27 offset:26112
    ds_read_b64_tr_b16 v[98:99], v27 offset:27136
    v_mfma_f32_16x16x32_bf16 v[160:163], v[48:51], v[36:39], v[160:163]
    s_add_u32 s36, s45, 1152
    v_accvgpr_read_b32 v2, a154
    v_accvgpr_read_b32 v3, a155
    v_mfma_f32_16x16x32_bf16 v[192:195], v[48:51], v[40:43], v[192:195]
    s_add_u32 m0, s42, 69632
    ds_read_b128 v[80:83], v24 offset:0
    ds_read_b128 v[84:87], v24 offset:2048
    v_mfma_f32_16x16x32_bf16 v[224:227], v[48:51], v[44:47], v[224:227]
    buffer_load_dwordx4 v17, s[24:27], s36 offen offset:0 lds
    v_mfma_f32_16x16x32_bf16 v[132:135], v[52:55], v[32:35], v[132:135]
    ds_read_b128 v[88:91], v24 offset:4096
    ds_read_b128 v[92:95], v24 offset:6144
    v_mfma_f32_16x16x32_bf16 v[164:167], v[52:55], v[36:39], v[164:167]
    v_cvt_pk_bf16_f32 v0, v0, v1
    v_cvt_pk_bf16_f32 v1, v2, v3
    v_mfma_f32_16x16x32_bf16 v[196:199], v[52:55], v[40:43], v[196:199]
    ds_read_b64_tr_b16 v[100:101], v28 offset:26112
    ds_read_b64_tr_b16 v[102:103], v28 offset:27136
    v_mfma_f32_16x16x32_bf16 v[228:231], v[52:55], v[44:47], v[228:231]
    buffer_load_dwordx4 v18, s[24:27], s36 offen offset:1024 lds
    v_mfma_f32_16x16x32_bf16 v[136:139], v[56:59], v[32:35], v[136:139]
    ds_read_b64_tr_b16 v[104:105], v29 offset:26112
    ds_read_b64_tr_b16 v[106:107], v29 offset:27136
    v_mfma_f32_16x16x32_bf16 v[168:171], v[56:59], v[36:39], v[168:171]
    v_cvt_pk_bf16_f32 v2, v4, v5
    v_cvt_pk_bf16_f32 v3, v6, v7
    v_mfma_f32_16x16x32_bf16 v[200:203], v[56:59], v[40:43], v[200:203]
    ds_read_b64_tr_b16 v[108:109], v30 offset:26112
    ds_read_b64_tr_b16 v[110:111], v30 offset:27136
    v_mfma_f32_16x16x32_bf16 v[232:235], v[56:59], v[44:47], v[232:235]
    buffer_store_dwordx4 v[0:3], v16, s[16:19], s38 offen offset:0
    v_mfma_f32_16x16x32_bf16 v[140:143], v[60:63], v[32:35], v[140:143]
    ds_read_b64_tr_b16 v[112:113], v27 offset:26240
    ds_read_b64_tr_b16 v[114:115], v27 offset:27264
    v_mfma_f32_16x16x32_bf16 v[172:175], v[60:63], v[36:39], v[172:175]
    v_accvgpr_read_b32 v12, a56
    v_accvgpr_read_b32 v13, a57
    v_mfma_f32_16x16x32_bf16 v[204:207], v[60:63], v[40:43], v[204:207]
    ds_read_b64_tr_b16 v[116:117], v28 offset:26240
    ds_read_b64_tr_b16 v[118:119], v28 offset:27264
    v_mfma_f32_16x16x32_bf16 v[236:239], v[60:63], v[44:47], v[236:239]
    buffer_load_dwordx4 v19, s[24:27], s36 offen offset:2048 lds
    v_mfma_f32_16x16x32_bf16 v[144:147], v[64:67], v[32:35], v[144:147]
    ds_read_b64_tr_b16 v[120:121], v29 offset:26240
    ds_read_b64_tr_b16 v[122:123], v29 offset:27264
    v_mfma_f32_16x16x32_bf16 v[176:179], v[64:67], v[36:39], v[176:179]
    v_accvgpr_read_b32 v14, a58
    v_accvgpr_read_b32 v15, a59
    v_mfma_f32_16x16x32_bf16 v[208:211], v[64:67], v[40:43], v[208:211]
    ds_read_b64_tr_b16 v[124:125], v30 offset:26240
    ds_read_b64_tr_b16 v[126:127], v30 offset:27264
    v_mfma_f32_16x16x32_bf16 v[240:243], v[64:67], v[44:47], v[240:243]
    v_accvgpr_read_b32 v8, a24
    v_accvgpr_read_b32 v9, a25
    v_mfma_f32_16x16x32_bf16 v[148:151], v[68:71], v[32:35], v[148:151]
    v_accvgpr_read_b32 v10, a26
    v_accvgpr_read_b32 v11, a27
    v_mfma_f32_16x16x32_bf16 v[180:183], v[68:71], v[36:39], v[180:183]
    buffer_load_dwordx4 v20, s[24:27], s36 offen offset:3072 lds
    v_mfma_f32_16x16x32_bf16 v[212:215], v[68:71], v[40:43], v[212:215]
    s_add_u32 s37, s49, 4980736
    v_mul_f32 v8, s40, v8
    v_mul_f32 v9, s40, v9
    v_mfma_f32_16x16x32_bf16 v[244:247], v[68:71], v[44:47], v[244:247]
    s_add_u32 m0, s50, 8704
    v_mul_f32 v10, s40, v10
    v_mul_f32 v11, s40, v11
    v_mfma_f32_16x16x32_bf16 v[152:155], v[72:75], v[32:35], v[152:155]
    buffer_load_dwordx4 v21, s[20:23], s37 offen offset:0 lds
    v_mfma_f32_16x16x32_bf16 v[184:187], v[72:75], v[36:39], v[184:187]
    v_mul_f32 v12, s40, v12
    v_mul_f32 v13, s40, v13
    v_mfma_f32_16x16x32_bf16 v[216:219], v[72:75], v[40:43], v[216:219]
    v_mul_f32 v14, s40, v14
    v_mul_f32 v15, s40, v15
    v_mfma_f32_16x16x32_bf16 v[248:251], v[72:75], v[44:47], v[248:251]
    v_mfma_f32_16x16x32_bf16 v[156:159], v[76:79], v[32:35], v[156:159]
    v_cvt_pk_bf16_f32 v8, v8, v9
    v_cvt_pk_bf16_f32 v9, v10, v11
    v_mfma_f32_16x16x32_bf16 v[188:191], v[76:79], v[36:39], v[188:191]
    v_cvt_pk_bf16_f32 v10, v12, v13
    v_cvt_pk_bf16_f32 v11, v14, v15
    v_mfma_f32_16x16x32_bf16 v[220:223], v[76:79], v[40:43], v[220:223]
    buffer_load_dwordx4 v22, s[20:23], s37 offen offset:1024 lds
    v_mfma_f32_16x16x32_bf16 v[252:255], v[76:79], v[44:47], v[252:255]
    s_waitcnt vmcnt(15) lgkmcnt(0)
    s_barrier
    v_accvgpr_read_b32 v4, a188
    v_accvgpr_read_b32 v5, a189
    v_mfma_f32_16x16x32_bf16 v[128:131], v[96:99], v[80:83], v[128:131]
    ds_read_b64_tr_b16 v[48:49], v27 offset:34816
    ds_read_b64_tr_b16 v[50:51], v27 offset:35840
    v_mfma_f32_16x16x32_bf16 v[160:163], v[96:99], v[84:87], v[160:163]
    s_add_u32 s36, s44, 1280
    v_accvgpr_read_b32 v6, a190
    v_accvgpr_read_b32 v7, a191
    v_mfma_f32_16x16x32_bf16 v[192:195], v[96:99], v[88:91], v[192:195]
    s_add_u32 m0, s42, 0
    ds_read_b128 v[32:35], v23 offset:32768
    ds_read_b128 v[36:39], v23 offset:34816
    v_mfma_f32_16x16x32_bf16 v[224:227], v[96:99], v[92:95], v[224:227]
    buffer_load_dwordx4 v17, s[24:27], s36 offen offset:0 lds
    v_mfma_f32_16x16x32_bf16 v[132:135], v[100:103], v[80:83], v[132:135]
    ds_read_b128 v[40:43], v23 offset:36864
    ds_read_b128 v[44:47], v23 offset:38912
    v_mfma_f32_16x16x32_bf16 v[164:167], v[100:103], v[84:87], v[164:167]
    v_accvgpr_read_b32 v0, a184
    v_accvgpr_read_b32 v1, a185
    v_mfma_f32_16x16x32_bf16 v[196:199], v[100:103], v[88:91], v[196:199]
    ds_read_b64_tr_b16 v[52:53], v28 offset:34816
    ds_read_b64_tr_b16 v[54:55], v28 offset:35840
    v_mfma_f32_16x16x32_bf16 v[228:231], v[100:103], v[92:95], v[228:231]
    buffer_load_dwordx4 v18, s[24:27], s36 offen offset:1024 lds
    v_mfma_f32_16x16x32_bf16 v[136:139], v[104:107], v[80:83], v[136:139]
    ds_read_b64_tr_b16 v[56:57], v29 offset:34816
    ds_read_b64_tr_b16 v[58:59], v29 offset:35840
    v_mfma_f32_16x16x32_bf16 v[168:171], v[104:107], v[84:87], v[168:171]
    v_accvgpr_read_b32 v2, a186
    v_accvgpr_read_b32 v3, a187
    v_mfma_f32_16x16x32_bf16 v[200:203], v[104:107], v[88:91], v[200:203]
    ds_read_b64_tr_b16 v[60:61], v30 offset:34816
    ds_read_b64_tr_b16 v[62:63], v30 offset:35840
    v_mfma_f32_16x16x32_bf16 v[232:235], v[104:107], v[92:95], v[232:235]
    buffer_store_dwordx4 v[8:11], v16, s[16:19], s41 offen offset:0
    v_mfma_f32_16x16x32_bf16 v[140:143], v[108:111], v[80:83], v[140:143]
    ds_read_b64_tr_b16 v[64:65], v27 offset:34944
    ds_read_b64_tr_b16 v[66:67], v27 offset:35968
    v_mfma_f32_16x16x32_bf16 v[172:175], v[108:111], v[84:87], v[172:175]
    v_cvt_pk_bf16_f32 v0, v0, v1
    v_cvt_pk_bf16_f32 v1, v2, v3
    v_mfma_f32_16x16x32_bf16 v[204:207], v[108:111], v[88:91], v[204:207]
    ds_read_b64_tr_b16 v[68:69], v28 offset:34944
    ds_read_b64_tr_b16 v[70:71], v28 offset:35968
    v_mfma_f32_16x16x32_bf16 v[236:239], v[108:111], v[92:95], v[236:239]
    buffer_load_dwordx4 v19, s[24:27], s36 offen offset:2048 lds
    v_mfma_f32_16x16x32_bf16 v[144:147], v[112:115], v[80:83], v[144:147]
    ds_read_b64_tr_b16 v[72:73], v29 offset:34944
    ds_read_b64_tr_b16 v[74:75], v29 offset:35968
    v_mfma_f32_16x16x32_bf16 v[176:179], v[112:115], v[84:87], v[176:179]
    v_cvt_pk_bf16_f32 v2, v4, v5
    v_cvt_pk_bf16_f32 v3, v6, v7
    v_mfma_f32_16x16x32_bf16 v[208:211], v[112:115], v[88:91], v[208:211]
    ds_read_b64_tr_b16 v[76:77], v30 offset:34944
    ds_read_b64_tr_b16 v[78:79], v30 offset:35968
    v_mfma_f32_16x16x32_bf16 v[240:243], v[112:115], v[92:95], v[240:243]
    v_accvgpr_read_b32 v12, a120
    v_accvgpr_read_b32 v13, a121
    v_mfma_f32_16x16x32_bf16 v[148:151], v[116:119], v[80:83], v[148:151]
    v_accvgpr_read_b32 v14, a122
    v_accvgpr_read_b32 v15, a123
    v_mfma_f32_16x16x32_bf16 v[180:183], v[116:119], v[84:87], v[180:183]
    buffer_load_dwordx4 v20, s[24:27], s36 offen offset:3072 lds
    v_mfma_f32_16x16x32_bf16 v[212:215], v[116:119], v[88:91], v[212:215]
    s_add_u32 s37, s49, 5242880
    v_accvgpr_read_b32 v8, a88
    v_accvgpr_read_b32 v9, a89
    v_mfma_f32_16x16x32_bf16 v[244:247], v[116:119], v[92:95], v[244:247]
    s_add_u32 m0, s50, 17408
    v_accvgpr_read_b32 v10, a90
    v_accvgpr_read_b32 v11, a91
    v_mfma_f32_16x16x32_bf16 v[152:155], v[120:123], v[80:83], v[152:155]
    buffer_load_dwordx4 v21, s[20:23], s37 offen offset:0 lds
    v_mfma_f32_16x16x32_bf16 v[184:187], v[120:123], v[84:87], v[184:187]
    v_mul_f32 v8, s40, v8
    v_mul_f32 v9, s40, v9
    v_mfma_f32_16x16x32_bf16 v[216:219], v[120:123], v[88:91], v[216:219]
    v_mul_f32 v10, s40, v10
    v_mul_f32 v11, s40, v11
    v_mfma_f32_16x16x32_bf16 v[248:251], v[120:123], v[92:95], v[248:251]
    buffer_store_dwordx4 v[0:3], v16, s[16:19], s38 offen offset:1024
    v_mfma_f32_16x16x32_bf16 v[156:159], v[124:127], v[80:83], v[156:159]
    v_mul_f32 v12, s40, v12
    v_mul_f32 v13, s40, v13
    v_mfma_f32_16x16x32_bf16 v[188:191], v[124:127], v[84:87], v[188:191]
    v_mul_f32 v14, s40, v14
    v_mul_f32 v15, s40, v15
    v_mfma_f32_16x16x32_bf16 v[220:223], v[124:127], v[88:91], v[220:223]
    buffer_load_dwordx4 v22, s[20:23], s37 offen offset:1024 lds
    v_mfma_f32_16x16x32_bf16 v[252:255], v[124:127], v[92:95], v[252:255]
    s_waitcnt lgkmcnt(0)
    v_cvt_pk_bf16_f32 v8, v8, v9
    v_cvt_pk_bf16_f32 v9, v10, v11
    v_mfma_f32_16x16x32_bf16 v[128:131], v[48:51], v[32:35], v[128:131]
    ds_read_b64_tr_b16 v[96:97], v27 offset:43520
    ds_read_b64_tr_b16 v[98:99], v27 offset:44544
    v_mfma_f32_16x16x32_bf16 v[160:163], v[48:51], v[36:39], v[160:163]
    s_add_u32 s36, s45, 1280
    v_cvt_pk_bf16_f32 v10, v12, v13
    v_cvt_pk_bf16_f32 v11, v14, v15
    v_mfma_f32_16x16x32_bf16 v[192:195], v[48:51], v[40:43], v[192:195]
    s_add_u32 m0, s42, 4096
    ds_read_b128 v[80:83], v24 offset:32768
    ds_read_b128 v[84:87], v24 offset:34816
    v_mfma_f32_16x16x32_bf16 v[224:227], v[48:51], v[44:47], v[224:227]
    buffer_load_dwordx4 v17, s[24:27], s36 offen offset:0 lds
    v_mfma_f32_16x16x32_bf16 v[132:135], v[52:55], v[32:35], v[132:135]
    ds_read_b128 v[88:91], v24 offset:36864
    ds_read_b128 v[92:95], v24 offset:38912
    v_mfma_f32_16x16x32_bf16 v[164:167], v[52:55], v[36:39], v[164:167]
    v_accvgpr_read_b32 v4, a220
    v_accvgpr_read_b32 v5, a221
    v_mfma_f32_16x16x32_bf16 v[196:199], v[52:55], v[40:43], v[196:199]
    ds_read_b64_tr_b16 v[100:101], v28 offset:43520
    ds_read_b64_tr_b16 v[102:103], v28 offset:44544
    v_mfma_f32_16x16x32_bf16 v[228:231], v[52:55], v[44:47], v[228:231]
    buffer_load_dwordx4 v18, s[24:27], s36 offen offset:1024 lds
    v_mfma_f32_16x16x32_bf16 v[136:139], v[56:59], v[32:35], v[136:139]
    ds_read_b64_tr_b16 v[104:105], v29 offset:43520
    ds_read_b64_tr_b16 v[106:107], v29 offset:44544
    v_mfma_f32_16x16x32_bf16 v[168:171], v[56:59], v[36:39], v[168:171]
    v_accvgpr_read_b32 v6, a222
    v_accvgpr_read_b32 v7, a223
    v_mfma_f32_16x16x32_bf16 v[200:203], v[56:59], v[40:43], v[200:203]
    ds_read_b64_tr_b16 v[108:109], v30 offset:43520
    ds_read_b64_tr_b16 v[110:111], v30 offset:44544
    v_mfma_f32_16x16x32_bf16 v[232:235], v[56:59], v[44:47], v[232:235]
    buffer_store_dwordx4 v[8:11], v16, s[16:19], s41 offen offset:1024
    v_mfma_f32_16x16x32_bf16 v[140:143], v[60:63], v[32:35], v[140:143]
    s_add_u32 s41, s41, 4096
    ds_read_b64_tr_b16 v[112:113], v27 offset:43648
    ds_read_b64_tr_b16 v[114:115], v27 offset:44672
    v_mfma_f32_16x16x32_bf16 v[172:175], v[60:63], v[36:39], v[172:175]
    v_accvgpr_read_b32 v0, a216
    v_accvgpr_read_b32 v1, a217
    v_mfma_f32_16x16x32_bf16 v[204:207], v[60:63], v[40:43], v[204:207]
    ds_read_b64_tr_b16 v[116:117], v28 offset:43648
    ds_read_b64_tr_b16 v[118:119], v28 offset:44672
    v_mfma_f32_16x16x32_bf16 v[236:239], v[60:63], v[44:47], v[236:239]
    buffer_load_dwordx4 v19, s[24:27], s36 offen offset:2048 lds
    v_mfma_f32_16x16x32_bf16 v[144:147], v[64:67], v[32:35], v[144:147]
    ds_read_b64_tr_b16 v[120:121], v29 offset:43648
    ds_read_b64_tr_b16 v[122:123], v29 offset:44672
    v_mfma_f32_16x16x32_bf16 v[176:179], v[64:67], v[36:39], v[176:179]
    v_accvgpr_read_b32 v2, a218
    v_accvgpr_read_b32 v3, a219
    v_mfma_f32_16x16x32_bf16 v[208:211], v[64:67], v[40:43], v[208:211]
    ds_read_b64_tr_b16 v[124:125], v30 offset:43648
    ds_read_b64_tr_b16 v[126:127], v30 offset:44672
    v_mfma_f32_16x16x32_bf16 v[240:243], v[64:67], v[44:47], v[240:243]
    v_cvt_pk_bf16_f32 v0, v0, v1
    v_cvt_pk_bf16_f32 v1, v2, v3
    v_mfma_f32_16x16x32_bf16 v[148:151], v[68:71], v[32:35], v[148:151]
    v_cvt_pk_bf16_f32 v2, v4, v5
    v_cvt_pk_bf16_f32 v3, v6, v7
    v_mfma_f32_16x16x32_bf16 v[180:183], v[68:71], v[36:39], v[180:183]
    buffer_load_dwordx4 v20, s[24:27], s36 offen offset:3072 lds
    v_mfma_f32_16x16x32_bf16 v[212:215], v[68:71], v[40:43], v[212:215]
    s_add_u32 s37, s49, 5505024
    v_accvgpr_read_b32 v12, a60
    v_accvgpr_read_b32 v13, a61
    v_mfma_f32_16x16x32_bf16 v[244:247], v[68:71], v[44:47], v[244:247]
    s_add_u32 m0, s50, 26112
    v_accvgpr_read_b32 v14, a62
    v_accvgpr_read_b32 v15, a63
    v_mfma_f32_16x16x32_bf16 v[152:155], v[72:75], v[32:35], v[152:155]
    buffer_load_dwordx4 v21, s[20:23], s37 offen offset:0 lds
    v_mfma_f32_16x16x32_bf16 v[184:187], v[72:75], v[36:39], v[184:187]
    v_accvgpr_read_b32 v8, a28
    v_accvgpr_read_b32 v9, a29
    v_mfma_f32_16x16x32_bf16 v[216:219], v[72:75], v[40:43], v[216:219]
    v_accvgpr_read_b32 v10, a30
    v_accvgpr_read_b32 v11, a31
    v_mfma_f32_16x16x32_bf16 v[248:251], v[72:75], v[44:47], v[248:251]
    buffer_store_dwordx4 v[0:3], v16, s[16:19], s38 offen offset:2048
    v_mfma_f32_16x16x32_bf16 v[156:159], v[76:79], v[32:35], v[156:159]
    v_mul_f32 v8, s40, v8
    v_mul_f32 v9, s40, v9
    v_mfma_f32_16x16x32_bf16 v[188:191], v[76:79], v[36:39], v[188:191]
    v_mul_f32 v10, s40, v10
    v_mul_f32 v11, s40, v11
    v_mfma_f32_16x16x32_bf16 v[220:223], v[76:79], v[40:43], v[220:223]
    buffer_load_dwordx4 v22, s[20:23], s37 offen offset:1024 lds
    v_mfma_f32_16x16x32_bf16 v[252:255], v[76:79], v[44:47], v[252:255]
    s_waitcnt vmcnt(16) lgkmcnt(0)
    s_barrier
    v_mul_f32 v12, s40, v12
    v_mul_f32 v13, s40, v13
    v_mfma_f32_16x16x32_bf16 v[128:131], v[96:99], v[80:83], v[128:131]
    ds_read_b64_tr_b16 v[48:49], v27 offset:0
    ds_read_b64_tr_b16 v[50:51], v27 offset:1024
    v_mfma_f32_16x16x32_bf16 v[160:163], v[96:99], v[84:87], v[160:163]
    s_add_u32 s36, s44, 1408
    v_mul_f32 v14, s40, v14
    v_mul_f32 v15, s40, v15
    v_mfma_f32_16x16x32_bf16 v[192:195], v[96:99], v[88:91], v[192:195]
    s_add_u32 m0, s42, 32768
    ds_read_b128 v[32:35], v25 offset:0
    ds_read_b128 v[36:39], v25 offset:2048
    v_mfma_f32_16x16x32_bf16 v[224:227], v[96:99], v[92:95], v[224:227]
    buffer_load_dwordx4 v17, s[24:27], s36 offen offset:0 lds
    v_mfma_f32_16x16x32_bf16 v[132:135], v[100:103], v[80:83], v[132:135]
    ds_read_b128 v[40:43], v25 offset:4096
    ds_read_b128 v[44:47], v25 offset:6144
    v_mfma_f32_16x16x32_bf16 v[164:167], v[100:103], v[84:87], v[164:167]
    v_cvt_pk_bf16_f32 v8, v8, v9
    v_cvt_pk_bf16_f32 v9, v10, v11
    v_mfma_f32_16x16x32_bf16 v[196:199], v[100:103], v[88:91], v[196:199]
    ds_read_b64_tr_b16 v[52:53], v28 offset:0
    ds_read_b64_tr_b16 v[54:55], v28 offset:1024
    v_mfma_f32_16x16x32_bf16 v[228:231], v[100:103], v[92:95], v[228:231]
    buffer_load_dwordx4 v18, s[24:27], s36 offen offset:1024 lds
    v_mfma_f32_16x16x32_bf16 v[136:139], v[104:107], v[80:83], v[136:139]
    ds_read_b64_tr_b16 v[56:57], v29 offset:0
    ds_read_b64_tr_b16 v[58:59], v29 offset:1024
    v_mfma_f32_16x16x32_bf16 v[168:171], v[104:107], v[84:87], v[168:171]
    v_cvt_pk_bf16_f32 v10, v12, v13
    v_cvt_pk_bf16_f32 v11, v14, v15
    v_mfma_f32_16x16x32_bf16 v[200:203], v[104:107], v[88:91], v[200:203]
    ds_read_b64_tr_b16 v[60:61], v30 offset:0
    ds_read_b64_tr_b16 v[62:63], v30 offset:1024
    v_mfma_f32_16x16x32_bf16 v[232:235], v[104:107], v[92:95], v[232:235]
    buffer_store_dwordx4 v[8:11], v16, s[16:19], s41 offen offset:0
    v_mfma_f32_16x16x32_bf16 v[140:143], v[108:111], v[80:83], v[140:143]
    ds_read_b64_tr_b16 v[64:65], v27 offset:128
    ds_read_b64_tr_b16 v[66:67], v27 offset:1152
    v_mfma_f32_16x16x32_bf16 v[172:175], v[108:111], v[84:87], v[172:175]
    v_accvgpr_read_b32 v4, a252
    v_accvgpr_read_b32 v5, a253
    v_mfma_f32_16x16x32_bf16 v[204:207], v[108:111], v[88:91], v[204:207]
    ds_read_b64_tr_b16 v[68:69], v28 offset:128
    ds_read_b64_tr_b16 v[70:71], v28 offset:1152
    v_mfma_f32_16x16x32_bf16 v[236:239], v[108:111], v[92:95], v[236:239]
    buffer_load_dwordx4 v19, s[24:27], s36 offen offset:2048 lds
    v_mfma_f32_16x16x32_bf16 v[144:147], v[112:115], v[80:83], v[144:147]
    ds_read_b64_tr_b16 v[72:73], v29 offset:128
    ds_read_b64_tr_b16 v[74:75], v29 offset:1152
    v_mfma_f32_16x16x32_bf16 v[176:179], v[112:115], v[84:87], v[176:179]
    v_accvgpr_read_b32 v6, a254
    v_accvgpr_read_b32 v7, a255
    v_mfma_f32_16x16x32_bf16 v[208:211], v[112:115], v[88:91], v[208:211]
    ds_read_b64_tr_b16 v[76:77], v30 offset:128
    ds_read_b64_tr_b16 v[78:79], v30 offset:1152
    v_mfma_f32_16x16x32_bf16 v[240:243], v[112:115], v[92:95], v[240:243]
    v_accvgpr_read_b32 v0, a248
    v_accvgpr_read_b32 v1, a249
    v_mfma_f32_16x16x32_bf16 v[148:151], v[116:119], v[80:83], v[148:151]
    v_accvgpr_read_b32 v2, a250
    v_accvgpr_read_b32 v3, a251
    v_mfma_f32_16x16x32_bf16 v[180:183], v[116:119], v[84:87], v[180:183]
    buffer_load_dwordx4 v20, s[24:27], s36 offen offset:3072 lds
    v_mfma_f32_16x16x32_bf16 v[212:215], v[116:119], v[88:91], v[212:215]
    s_add_u32 s37, s49, 5767168
    v_cvt_pk_bf16_f32 v0, v0, v1
    v_cvt_pk_bf16_f32 v1, v2, v3
    v_mfma_f32_16x16x32_bf16 v[244:247], v[116:119], v[92:95], v[244:247]
    s_add_u32 m0, s50, 34816
    v_cvt_pk_bf16_f32 v2, v4, v5
    v_cvt_pk_bf16_f32 v3, v6, v7
    v_mfma_f32_16x16x32_bf16 v[152:155], v[120:123], v[80:83], v[152:155]
    buffer_load_dwordx4 v21, s[20:23], s37 offen offset:0 lds
    v_mfma_f32_16x16x32_bf16 v[184:187], v[120:123], v[84:87], v[184:187]
    v_accvgpr_read_b32 v12, a124
    v_accvgpr_read_b32 v13, a125
    v_mfma_f32_16x16x32_bf16 v[216:219], v[120:123], v[88:91], v[216:219]
gated_mix__ssm_conv_h3__compressed_kv_cla__prompt_kernel_pad6:
    s_cbranch_execz gated_mix__ssm_conv_h3__compressed_kv_cla__prompt_kernel_pad10
    v_accvgpr_read_b32 v14, a126
    v_accvgpr_read_b32 v15, a127
    v_mfma_f32_16x16x32_bf16 v[248:251], v[120:123], v[92:95], v[248:251]
    buffer_store_dwordx4 v[0:3], v16, s[16:19], s38 offen offset:3072
    v_mfma_f32_16x16x32_bf16 v[156:159], v[124:127], v[80:83], v[156:159]
    s_add_u32 s38, s38, 16384
    v_accvgpr_read_b32 v8, a92
    v_accvgpr_read_b32 v9, a93
    v_mfma_f32_16x16x32_bf16 v[188:191], v[124:127], v[84:87], v[188:191]
    v_accvgpr_read_b32 v10, a94
    v_accvgpr_read_b32 v11, a95
    v_mfma_f32_16x16x32_bf16 v[220:223], v[124:127], v[88:91], v[220:223]
    buffer_load_dwordx4 v22, s[20:23], s37 offen offset:1024 lds
    v_mfma_f32_16x16x32_bf16 v[252:255], v[124:127], v[92:95], v[252:255]
    s_waitcnt lgkmcnt(0)
    v_mul_f32 v8, s40, v8
    v_mul_f32 v9, s40, v9
    v_mfma_f32_16x16x32_bf16 v[128:131], v[48:51], v[32:35], v[128:131]
    ds_read_b64_tr_b16 v[96:97], v27 offset:8704
    ds_read_b64_tr_b16 v[98:99], v27 offset:9728
    v_mfma_f32_16x16x32_bf16 v[160:163], v[48:51], v[36:39], v[160:163]
    s_add_u32 s36, s45, 1408
    v_mul_f32 v10, s40, v10
    v_mul_f32 v11, s40, v11
    v_mfma_f32_16x16x32_bf16 v[192:195], v[48:51], v[40:43], v[192:195]
    s_add_u32 m0, s42, 36864
    ds_read_b128 v[80:83], v26 offset:0
    ds_read_b128 v[84:87], v26 offset:2048
    v_mfma_f32_16x16x32_bf16 v[224:227], v[48:51], v[44:47], v[224:227]
    buffer_load_dwordx4 v17, s[24:27], s36 offen offset:0 lds
    v_mfma_f32_16x16x32_bf16 v[132:135], v[52:55], v[32:35], v[132:135]
    ds_read_b128 v[88:91], v26 offset:4096
    ds_read_b128 v[92:95], v26 offset:6144
    v_mfma_f32_16x16x32_bf16 v[164:167], v[52:55], v[36:39], v[164:167]
    v_mul_f32 v12, s40, v12
    v_mul_f32 v13, s40, v13
    v_mfma_f32_16x16x32_bf16 v[196:199], v[52:55], v[40:43], v[196:199]
    ds_read_b64_tr_b16 v[100:101], v28 offset:8704
    ds_read_b64_tr_b16 v[102:103], v28 offset:9728
    v_mfma_f32_16x16x32_bf16 v[228:231], v[52:55], v[44:47], v[228:231]
    buffer_load_dwordx4 v18, s[24:27], s36 offen offset:1024 lds
    v_mfma_f32_16x16x32_bf16 v[136:139], v[56:59], v[32:35], v[136:139]
    ds_read_b64_tr_b16 v[104:105], v29 offset:8704
    ds_read_b64_tr_b16 v[106:107], v29 offset:9728
    v_mfma_f32_16x16x32_bf16 v[168:171], v[56:59], v[36:39], v[168:171]
    v_mul_f32 v14, s40, v14
    v_mul_f32 v15, s40, v15
    v_mfma_f32_16x16x32_bf16 v[200:203], v[56:59], v[40:43], v[200:203]
    ds_read_b64_tr_b16 v[108:109], v30 offset:8704
    ds_read_b64_tr_b16 v[110:111], v30 offset:9728
    v_mfma_f32_16x16x32_bf16 v[232:235], v[56:59], v[44:47], v[232:235]
    v_mfma_f32_16x16x32_bf16 v[140:143], v[60:63], v[32:35], v[140:143]
    ds_read_b64_tr_b16 v[112:113], v27 offset:8832
    ds_read_b64_tr_b16 v[114:115], v27 offset:9856
    v_mfma_f32_16x16x32_bf16 v[172:175], v[60:63], v[36:39], v[172:175]
    v_cvt_pk_bf16_f32 v8, v8, v9
    v_cvt_pk_bf16_f32 v9, v10, v11
    v_mfma_f32_16x16x32_bf16 v[204:207], v[60:63], v[40:43], v[204:207]
    ds_read_b64_tr_b16 v[116:117], v28 offset:8832
    ds_read_b64_tr_b16 v[118:119], v28 offset:9856
    v_mfma_f32_16x16x32_bf16 v[236:239], v[60:63], v[44:47], v[236:239]
    buffer_load_dwordx4 v19, s[24:27], s36 offen offset:2048 lds
    v_mfma_f32_16x16x32_bf16 v[144:147], v[64:67], v[32:35], v[144:147]
    ds_read_b64_tr_b16 v[120:121], v29 offset:8832
    ds_read_b64_tr_b16 v[122:123], v29 offset:9856
    v_mfma_f32_16x16x32_bf16 v[176:179], v[64:67], v[36:39], v[176:179]
    v_cvt_pk_bf16_f32 v10, v12, v13
    v_cvt_pk_bf16_f32 v11, v14, v15
    v_mfma_f32_16x16x32_bf16 v[208:211], v[64:67], v[40:43], v[208:211]
    ds_read_b64_tr_b16 v[124:125], v30 offset:8832
    ds_read_b64_tr_b16 v[126:127], v30 offset:9856
    v_mfma_f32_16x16x32_bf16 v[240:243], v[64:67], v[44:47], v[240:243]
    v_mfma_f32_16x16x32_bf16 v[148:151], v[68:71], v[32:35], v[148:151]
    v_mfma_f32_16x16x32_bf16 v[180:183], v[68:71], v[36:39], v[180:183]
    buffer_load_dwordx4 v20, s[24:27], s36 offen offset:3072 lds
    v_mfma_f32_16x16x32_bf16 v[212:215], v[68:71], v[40:43], v[212:215]
    s_add_u32 s37, s49, 6029312
    v_mfma_f32_16x16x32_bf16 v[244:247], v[68:71], v[44:47], v[244:247]
    s_add_u32 m0, s50, 43520
    v_mfma_f32_16x16x32_bf16 v[152:155], v[72:75], v[32:35], v[152:155]
    buffer_load_dwordx4 v21, s[20:23], s37 offen offset:0 lds
    v_mfma_f32_16x16x32_bf16 v[184:187], v[72:75], v[36:39], v[184:187]
    v_mfma_f32_16x16x32_bf16 v[216:219], v[72:75], v[40:43], v[216:219]
    v_mfma_f32_16x16x32_bf16 v[248:251], v[72:75], v[44:47], v[248:251]
    buffer_store_dwordx4 v[8:11], v16, s[16:19], s41 offen offset:1024
    v_mfma_f32_16x16x32_bf16 v[156:159], v[76:79], v[32:35], v[156:159]
    s_add_u32 s41, s41, 12288
    v_mfma_f32_16x16x32_bf16 v[188:191], v[76:79], v[36:39], v[188:191]
    v_mov_b32 v1, 1
    v_mov_b32 v0, 0
    v_mfma_f32_16x16x32_bf16 v[220:223], v[76:79], v[40:43], v[220:223]
    buffer_load_dwordx4 v22, s[20:23], s37 offen offset:1024 lds
    v_mfma_f32_16x16x32_bf16 v[252:255], v[76:79], v[44:47], v[252:255]
    s_waitcnt vmcnt(15) lgkmcnt(0)
    s_barrier
    v_bfe_u32 v3, v16, 1, 8
    v_mfma_f32_16x16x32_bf16 v[128:131], v[96:99], v[80:83], v[128:131]
    s_and_b32 s40, s3, 4294967264
    ds_read_b64_tr_b16 v[48:49], v27 offset:17408
    ds_read_b64_tr_b16 v[50:51], v27 offset:18432
    v_mfma_f32_16x16x32_bf16 v[160:163], v[96:99], v[84:87], v[160:163]
    s_add_u32 s36, s44, 1536
    v_mov_b32 v10, 0x0f0f0f0f
    v_mov_b32 v4, 0
    v_mfma_f32_16x16x32_bf16 v[192:195], v[96:99], v[88:91], v[192:195]
    s_add_u32 m0, s42, 65536
    ds_read_b128 v[32:35], v23 offset:0
    ds_read_b128 v[36:39], v23 offset:2048
    v_mfma_f32_16x16x32_bf16 v[224:227], v[96:99], v[92:95], v[224:227]
    buffer_load_dwordx4 v17, s[24:27], s36 offen offset:0 lds
    v_mfma_f32_16x16x32_bf16 v[132:135], v[100:103], v[80:83], v[132:135]
    ds_read_b128 v[40:43], v23 offset:4096
    ds_read_b128 v[44:47], v23 offset:6144
    v_mfma_f32_16x16x32_bf16 v[164:167], v[100:103], v[84:87], v[164:167]
    v_mov_b32 v5, 0
    v_mov_b32 v6, 0
    v_mfma_f32_16x16x32_bf16 v[196:199], v[100:103], v[88:91], v[196:199]
    ds_read_b64_tr_b16 v[52:53], v28 offset:17408
    ds_read_b64_tr_b16 v[54:55], v28 offset:18432
    v_mfma_f32_16x16x32_bf16 v[228:231], v[100:103], v[92:95], v[228:231]
    buffer_load_dwordx4 v18, s[24:27], s36 offen offset:1024 lds
    v_mfma_f32_16x16x32_bf16 v[136:139], v[104:107], v[80:83], v[136:139]
    ds_read_b64_tr_b16 v[56:57], v29 offset:17408
    ds_read_b64_tr_b16 v[58:59], v29 offset:18432
    v_mfma_f32_16x16x32_bf16 v[168:171], v[104:107], v[84:87], v[168:171]
    v_mov_b32 v7, 0
    v_mov_b32 v8, 153600
    v_mfma_f32_16x16x32_bf16 v[200:203], v[104:107], v[88:91], v[200:203]
    ds_read_b64_tr_b16 v[60:61], v30 offset:17408
    ds_read_b64_tr_b16 v[62:63], v30 offset:18432
    v_mfma_f32_16x16x32_bf16 v[232:235], v[104:107], v[92:95], v[232:235]
    buffer_load_dword v9, v3, s[76:79], 0 offen sc1
    v_mfma_f32_16x16x32_bf16 v[140:143], v[108:111], v[80:83], v[140:143]
    ds_read_b64_tr_b16 v[64:65], v27 offset:17536
    ds_read_b64_tr_b16 v[66:67], v27 offset:18560
    v_mfma_f32_16x16x32_bf16 v[172:175], v[108:111], v[84:87], v[172:175]
    ds_write_b128 v8, v[4:7]
    ds_read_b128 a[0:3], v8
    v_mfma_f32_16x16x32_bf16 v[204:207], v[108:111], v[88:91], v[204:207]
    ds_read_b64_tr_b16 v[68:69], v28 offset:17536
    ds_read_b64_tr_b16 v[70:71], v28 offset:18560
    v_mfma_f32_16x16x32_bf16 v[236:239], v[108:111], v[92:95], v[236:239]
    buffer_load_dwordx4 v19, s[24:27], s36 offen offset:2048 lds
    v_mfma_f32_16x16x32_bf16 v[144:147], v[112:115], v[80:83], v[144:147]
    ds_read_b64_tr_b16 v[72:73], v29 offset:17536
    ds_read_b64_tr_b16 v[74:75], v29 offset:18560
    v_mfma_f32_16x16x32_bf16 v[176:179], v[112:115], v[84:87], v[176:179]
    ds_read_b128 a[4:7], v8
    ds_read_b128 a[8:11], v8
    v_mfma_f32_16x16x32_bf16 v[208:211], v[112:115], v[88:91], v[208:211]
    ds_read_b64_tr_b16 v[76:77], v30 offset:17536
    ds_read_b64_tr_b16 v[78:79], v30 offset:18560
    v_mfma_f32_16x16x32_bf16 v[240:243], v[112:115], v[92:95], v[240:243]
    ds_read_b128 a[12:15], v8
    ds_read_b128 a[16:19], v8
    v_mfma_f32_16x16x32_bf16 v[148:151], v[116:119], v[80:83], v[148:151]
    ds_read_b128 a[20:23], v8
    ds_read_b128 a[24:27], v8
    v_mfma_f32_16x16x32_bf16 v[180:183], v[116:119], v[84:87], v[180:183]
    buffer_load_dwordx4 v20, s[24:27], s36 offen offset:3072 lds
    v_mfma_f32_16x16x32_bf16 v[212:215], v[116:119], v[88:91], v[212:215]
    s_add_u32 s37, s49, 6291456
    ds_read_b128 a[28:31], v8
    ds_read_b128 a[32:35], v8
    v_mfma_f32_16x16x32_bf16 v[244:247], v[116:119], v[92:95], v[244:247]
    s_add_u32 m0, s50, 0
    ds_read_b128 a[36:39], v8
    ds_read_b128 a[40:43], v8
    v_mfma_f32_16x16x32_bf16 v[152:155], v[120:123], v[80:83], v[152:155]
    buffer_load_dwordx4 v21, s[20:23], s37 offen offset:0 lds
    v_mfma_f32_16x16x32_bf16 v[184:187], v[120:123], v[84:87], v[184:187]
    ds_read_b128 a[44:47], v8
    ds_read_b128 a[48:51], v8
    v_mfma_f32_16x16x32_bf16 v[216:219], v[120:123], v[88:91], v[216:219]
    ds_read_b128 a[52:55], v8
    ds_read_b128 a[56:59], v8
    v_mfma_f32_16x16x32_bf16 v[248:251], v[120:123], v[92:95], v[248:251]
    v_mfma_f32_16x16x32_bf16 v[156:159], v[124:127], v[80:83], v[156:159]
    v_mfma_f32_16x16x32_bf16 v[188:191], v[124:127], v[84:87], v[188:191]
    v_mfma_f32_16x16x32_bf16 v[220:223], v[124:127], v[88:91], v[220:223]
    buffer_load_dwordx4 v22, s[20:23], s37 offen offset:1024 lds
    v_mfma_f32_16x16x32_bf16 v[252:255], v[124:127], v[92:95], v[252:255]
    s_waitcnt lgkmcnt(0)
    v_mfma_f32_16x16x32_bf16 v[128:131], v[48:51], v[32:35], v[128:131]
    s_getreg_b32 s58, hwreg(HW_REG_XCC_ID, 0, 3)
    ds_read_b64_tr_b16 v[96:97], v27 offset:26112
    ds_read_b64_tr_b16 v[98:99], v27 offset:27136
    v_mfma_f32_16x16x32_bf16 v[160:163], v[48:51], v[36:39], v[160:163]
    s_add_u32 s36, s45, 1536
    ds_read_b128 a[60:63], v8
    ds_read_b128 a[64:67], v8
    v_mfma_f32_16x16x32_bf16 v[192:195], v[48:51], v[40:43], v[192:195]
    s_add_u32 m0, s42, 69632
    ds_read_b128 v[80:83], v24 offset:0
    ds_read_b128 v[84:87], v24 offset:2048
    v_mfma_f32_16x16x32_bf16 v[224:227], v[48:51], v[44:47], v[224:227]
    buffer_load_dwordx4 v17, s[24:27], s36 offen offset:0 lds
    v_mfma_f32_16x16x32_bf16 v[132:135], v[52:55], v[32:35], v[132:135]
    s_lshl_b32 s58, s58, 2
    ds_read_b128 v[88:91], v24 offset:4096
    ds_read_b128 v[92:95], v24 offset:6144
    v_mfma_f32_16x16x32_bf16 v[164:167], v[52:55], v[36:39], v[164:167]
    s_lshl_b32 s58, 8, s58
    ds_read_b128 a[68:71], v8
    ds_read_b128 a[72:75], v8
    v_mfma_f32_16x16x32_bf16 v[196:199], v[52:55], v[40:43], v[196:199]
    ds_read_b64_tr_b16 v[100:101], v28 offset:26112
    ds_read_b64_tr_b16 v[102:103], v28 offset:27136
    v_mfma_f32_16x16x32_bf16 v[228:231], v[52:55], v[44:47], v[228:231]
    buffer_load_dwordx4 v18, s[24:27], s36 offen offset:1024 lds
    v_mfma_f32_16x16x32_bf16 v[136:139], v[56:59], v[32:35], v[136:139]
    ds_read_b64_tr_b16 v[104:105], v29 offset:26112
    ds_read_b64_tr_b16 v[106:107], v29 offset:27136
    v_mfma_f32_16x16x32_bf16 v[168:171], v[56:59], v[36:39], v[168:171]
    ds_read_b128 a[76:79], v8
    ds_read_b128 a[80:83], v8
    v_mfma_f32_16x16x32_bf16 v[200:203], v[56:59], v[40:43], v[200:203]
    ds_read_b64_tr_b16 v[108:109], v30 offset:26112
    ds_read_b64_tr_b16 v[110:111], v30 offset:27136
    v_mfma_f32_16x16x32_bf16 v[232:235], v[56:59], v[44:47], v[232:235]
    v_mfma_f32_16x16x32_bf16 v[140:143], v[60:63], v[32:35], v[140:143]
    ds_read_b64_tr_b16 v[112:113], v27 offset:26240
    ds_read_b64_tr_b16 v[114:115], v27 offset:27264
    v_mfma_f32_16x16x32_bf16 v[172:175], v[60:63], v[36:39], v[172:175]
    ds_read_b128 a[84:87], v8
    ds_read_b128 a[88:91], v8
    v_mfma_f32_16x16x32_bf16 v[204:207], v[60:63], v[40:43], v[204:207]
    ds_read_b64_tr_b16 v[116:117], v28 offset:26240
    ds_read_b64_tr_b16 v[118:119], v28 offset:27264
    v_mfma_f32_16x16x32_bf16 v[236:239], v[60:63], v[44:47], v[236:239]
    buffer_load_dwordx4 v19, s[24:27], s36 offen offset:2048 lds
    v_mfma_f32_16x16x32_bf16 v[144:147], v[64:67], v[32:35], v[144:147]
    ds_read_b64_tr_b16 v[120:121], v29 offset:26240
    ds_read_b64_tr_b16 v[122:123], v29 offset:27264
    v_mfma_f32_16x16x32_bf16 v[176:179], v[64:67], v[36:39], v[176:179]
    ds_read_b128 a[92:95], v8
    ds_read_b128 a[96:99], v8
    v_mfma_f32_16x16x32_bf16 v[208:211], v[64:67], v[40:43], v[208:211]
    ds_read_b64_tr_b16 v[124:125], v30 offset:26240
    ds_read_b64_tr_b16 v[126:127], v30 offset:27264
    v_mfma_f32_16x16x32_bf16 v[240:243], v[64:67], v[44:47], v[240:243]
    ds_read_b128 a[100:103], v8
    ds_read_b128 a[104:107], v8
    v_mfma_f32_16x16x32_bf16 v[148:151], v[68:71], v[32:35], v[148:151]
    ds_read_b128 a[108:111], v8
    ds_read_b128 a[112:115], v8
    v_mfma_f32_16x16x32_bf16 v[180:183], v[68:71], v[36:39], v[180:183]
    buffer_load_dwordx4 v20, s[24:27], s36 offen offset:3072 lds
    v_mfma_f32_16x16x32_bf16 v[212:215], v[68:71], v[40:43], v[212:215]
    s_add_u32 s37, s49, 6553600
    ds_read_b128 a[116:119], v8
    ds_read_b128 a[120:123], v8
    v_mfma_f32_16x16x32_bf16 v[244:247], v[68:71], v[44:47], v[244:247]
    s_add_u32 m0, s50, 8704
    ds_read_b128 a[124:127], v8
    v_mfma_f32_16x16x32_bf16 v[152:155], v[72:75], v[32:35], v[152:155]
    buffer_load_dwordx4 v21, s[20:23], s37 offen offset:0 lds
    v_mfma_f32_16x16x32_bf16 v[184:187], v[72:75], v[36:39], v[184:187]
    v_mfma_f32_16x16x32_bf16 v[216:219], v[72:75], v[40:43], v[216:219]
    v_mfma_f32_16x16x32_bf16 v[248:251], v[72:75], v[44:47], v[248:251]
    v_mfma_f32_16x16x32_bf16 v[156:159], v[76:79], v[32:35], v[156:159]
    v_mfma_f32_16x16x32_bf16 v[188:191], v[76:79], v[36:39], v[188:191]
    v_mfma_f32_16x16x32_bf16 v[220:223], v[76:79], v[40:43], v[220:223]
    buffer_load_dwordx4 v22, s[20:23], s37 offen offset:1024 lds
    v_mfma_f32_16x16x32_bf16 v[252:255], v[76:79], v[44:47], v[252:255]
    s_waitcnt vmcnt(10) lgkmcnt(0)
    s_barrier
    v_readlane_b32 s54, v9, s33
    v_and_b32 v11, v10, v9
    v_mfma_f32_16x16x32_bf16 v[128:131], v[96:99], v[80:83], v[128:131]
    ds_read_b64_tr_b16 v[48:49], v27 offset:34816
    ds_read_b64_tr_b16 v[50:51], v27 offset:35840
    v_mfma_f32_16x16x32_bf16 v[160:163], v[96:99], v[84:87], v[160:163]
    s_add_u32 s36, s44, 1664
    v_lshrrev_b32 v12, 4, v9
    v_and_b32 v12, v10, v12
    v_mfma_f32_16x16x32_bf16 v[192:195], v[96:99], v[88:91], v[192:195]
    s_add_u32 m0, s42, 0
    ds_read_b128 v[32:35], v23 offset:32768
    ds_read_b128 v[36:39], v23 offset:34816
    v_mfma_f32_16x16x32_bf16 v[224:227], v[96:99], v[92:95], v[224:227]
    buffer_load_dwordx4 v17, s[24:27], s36 offen offset:0 lds
    v_mfma_f32_16x16x32_bf16 v[132:135], v[100:103], v[80:83], v[132:135]
    ds_read_b128 v[40:43], v23 offset:36864
    ds_read_b128 v[44:47], v23 offset:38912
    v_mfma_f32_16x16x32_bf16 v[164:167], v[100:103], v[84:87], v[164:167]
    v_sad_u8 v11, v11, 0, 0
    v_sad_u8 v11, v12, 0, v11
    v_mfma_f32_16x16x32_bf16 v[196:199], v[100:103], v[88:91], v[196:199]
    ds_read_b64_tr_b16 v[52:53], v28 offset:34816
    ds_read_b64_tr_b16 v[54:55], v28 offset:35840
    v_mfma_f32_16x16x32_bf16 v[228:231], v[100:103], v[92:95], v[228:231]
    buffer_load_dwordx4 v18, s[24:27], s36 offen offset:1024 lds
    v_mfma_f32_16x16x32_bf16 v[136:139], v[104:107], v[80:83], v[136:139]
    ds_read_b64_tr_b16 v[56:57], v29 offset:34816
    ds_read_b64_tr_b16 v[58:59], v29 offset:35840
    v_mfma_f32_16x16x32_bf16 v[168:171], v[104:107], v[84:87], v[168:171]
    v_cmp_ne_u32 vcc, 8, v11
    v_bfe_u32 v3, v16, 2, 5
    v_mfma_f32_16x16x32_bf16 v[200:203], v[104:107], v[88:91], v[200:203]
    ds_read_b64_tr_b16 v[60:61], v30 offset:34816
    ds_read_b64_tr_b16 v[62:63], v30 offset:35840
    v_mfma_f32_16x16x32_bf16 v[232:235], v[104:107], v[92:95], v[232:235]
    v_mfma_f32_16x16x32_bf16 v[140:143], v[108:111], v[80:83], v[140:143]
    s_cbranch_vccnz gated_mix__ssm_conv_h3__compressed_kv_cla__prompt_kernel_wb
    ds_read_b64_tr_b16 v[64:65], v27 offset:34944
    ds_read_b64_tr_b16 v[66:67], v27 offset:35968
    v_mfma_f32_16x16x32_bf16 v[172:175], v[108:111], v[84:87], v[172:175]
    s_cmp_lg_u32 s54, s58
    s_cbranch_scc1 gated_mix__ssm_conv_h3__compressed_kv_cla__prompt_kernel_wb
gated_mix__ssm_conv_h3__compressed_kv_cla__prompt_kernel_wb_ret:
    v_mfma_f32_16x16x32_bf16 v[204:207], v[108:111], v[88:91], v[204:207]
    ds_read_b64_tr_b16 v[68:69], v28 offset:34944
    ds_read_b64_tr_b16 v[70:71], v28 offset:35968
    v_mfma_f32_16x16x32_bf16 v[236:239], v[108:111], v[92:95], v[236:239]
    buffer_load_dwordx4 v19, s[24:27], s36 offen offset:2048 lds
    v_mfma_f32_16x16x32_bf16 v[144:147], v[112:115], v[80:83], v[144:147]
    ds_read_b64_tr_b16 v[72:73], v29 offset:34944
    ds_read_b64_tr_b16 v[74:75], v29 offset:35968
    v_mfma_f32_16x16x32_bf16 v[176:179], v[112:115], v[84:87], v[176:179]
    v_mfma_f32_16x16x32_bf16 v[208:211], v[112:115], v[88:91], v[208:211]
    ds_read_b64_tr_b16 v[76:77], v30 offset:34944
    ds_read_b64_tr_b16 v[78:79], v30 offset:35968
    v_mfma_f32_16x16x32_bf16 v[240:243], v[112:115], v[92:95], v[240:243]
    v_mfma_f32_16x16x32_bf16 v[148:151], v[116:119], v[80:83], v[148:151]
    v_mfma_f32_16x16x32_bf16 v[180:183], v[116:119], v[84:87], v[180:183]
    buffer_load_dwordx4 v20, s[24:27], s36 offen offset:3072 lds
    v_mfma_f32_16x16x32_bf16 v[212:215], v[116:119], v[88:91], v[212:215]
    s_add_u32 s37, s49, 6815744
    v_mfma_f32_16x16x32_bf16 v[244:247], v[116:119], v[92:95], v[244:247]
    s_add_u32 m0, s50, 17408
    v_mfma_f32_16x16x32_bf16 v[152:155], v[120:123], v[80:83], v[152:155]
    buffer_load_dwordx4 v21, s[20:23], s37 offen offset:0 lds
    v_mfma_f32_16x16x32_bf16 v[184:187], v[120:123], v[84:87], v[184:187]
    v_mfma_f32_16x16x32_bf16 v[216:219], v[120:123], v[88:91], v[216:219]
    v_mfma_f32_16x16x32_bf16 v[248:251], v[120:123], v[92:95], v[248:251]
    buffer_store_dword v1, v0, s[28:31], s3 offen sc1
    v_mfma_f32_16x16x32_bf16 v[156:159], v[124:127], v[80:83], v[156:159]
    v_mfma_f32_16x16x32_bf16 v[188:191], v[124:127], v[84:87], v[188:191]
    v_mfma_f32_16x16x32_bf16 v[220:223], v[124:127], v[88:91], v[220:223]
    buffer_load_dwordx4 v22, s[20:23], s37 offen offset:1024 lds
    v_mfma_f32_16x16x32_bf16 v[252:255], v[124:127], v[92:95], v[252:255]
    s_waitcnt lgkmcnt(0)
    v_mfma_f32_16x16x32_bf16 v[128:131], v[48:51], v[32:35], v[128:131]
    ds_read_b64_tr_b16 v[96:97], v27 offset:43520
    ds_read_b64_tr_b16 v[98:99], v27 offset:44544
    v_mfma_f32_16x16x32_bf16 v[160:163], v[48:51], v[36:39], v[160:163]
    s_add_u32 s36, s45, 1664
    v_mfma_f32_16x16x32_bf16 v[192:195], v[48:51], v[40:43], v[192:195]
    s_add_u32 m0, s42, 4096
    ds_read_b128 v[80:83], v24 offset:32768
    ds_read_b128 v[84:87], v24 offset:34816
    v_mfma_f32_16x16x32_bf16 v[224:227], v[48:51], v[44:47], v[224:227]
    buffer_load_dwordx4 v17, s[24:27], s36 offen offset:0 lds
    v_mfma_f32_16x16x32_bf16 v[132:135], v[52:55], v[32:35], v[132:135]
    ds_read_b128 v[88:91], v24 offset:36864
    ds_read_b128 v[92:95], v24 offset:38912
    v_mfma_f32_16x16x32_bf16 v[164:167], v[52:55], v[36:39], v[164:167]
    v_mfma_f32_16x16x32_bf16 v[196:199], v[52:55], v[40:43], v[196:199]
    ds_read_b64_tr_b16 v[100:101], v28 offset:43520
    ds_read_b64_tr_b16 v[102:103], v28 offset:44544
    v_mfma_f32_16x16x32_bf16 v[228:231], v[52:55], v[44:47], v[228:231]
    buffer_load_dwordx4 v18, s[24:27], s36 offen offset:1024 lds
    v_mfma_f32_16x16x32_bf16 v[136:139], v[56:59], v[32:35], v[136:139]
    ds_read_b64_tr_b16 v[104:105], v29 offset:43520
    ds_read_b64_tr_b16 v[106:107], v29 offset:44544
    v_mfma_f32_16x16x32_bf16 v[168:171], v[56:59], v[36:39], v[168:171]
    v_mfma_f32_16x16x32_bf16 v[200:203], v[56:59], v[40:43], v[200:203]
    ds_read_b64_tr_b16 v[108:109], v30 offset:43520
    ds_read_b64_tr_b16 v[110:111], v30 offset:44544
    v_mfma_f32_16x16x32_bf16 v[232:235], v[56:59], v[44:47], v[232:235]
    v_mfma_f32_16x16x32_bf16 v[140:143], v[60:63], v[32:35], v[140:143]
    ds_read_b64_tr_b16 v[112:113], v27 offset:43648
    ds_read_b64_tr_b16 v[114:115], v27 offset:44672
    v_mfma_f32_16x16x32_bf16 v[172:175], v[60:63], v[36:39], v[172:175]
    v_mfma_f32_16x16x32_bf16 v[204:207], v[60:63], v[40:43], v[204:207]
    ds_read_b64_tr_b16 v[116:117], v28 offset:43648
    ds_read_b64_tr_b16 v[118:119], v28 offset:44672
    v_mfma_f32_16x16x32_bf16 v[236:239], v[60:63], v[44:47], v[236:239]
    buffer_load_dwordx4 v19, s[24:27], s36 offen offset:2048 lds
    v_mfma_f32_16x16x32_bf16 v[144:147], v[64:67], v[32:35], v[144:147]
    ds_read_b64_tr_b16 v[120:121], v29 offset:43648
    ds_read_b64_tr_b16 v[122:123], v29 offset:44672
    v_mfma_f32_16x16x32_bf16 v[176:179], v[64:67], v[36:39], v[176:179]
    v_mfma_f32_16x16x32_bf16 v[208:211], v[64:67], v[40:43], v[208:211]
    ds_read_b64_tr_b16 v[124:125], v30 offset:43648
    ds_read_b64_tr_b16 v[126:127], v30 offset:44672
    v_mfma_f32_16x16x32_bf16 v[240:243], v[64:67], v[44:47], v[240:243]
    v_mfma_f32_16x16x32_bf16 v[148:151], v[68:71], v[32:35], v[148:151]
    v_mfma_f32_16x16x32_bf16 v[180:183], v[68:71], v[36:39], v[180:183]
    buffer_load_dwordx4 v20, s[24:27], s36 offen offset:3072 lds
    v_mfma_f32_16x16x32_bf16 v[212:215], v[68:71], v[40:43], v[212:215]
    s_add_u32 s37, s49, 7077888
    v_mfma_f32_16x16x32_bf16 v[244:247], v[68:71], v[44:47], v[244:247]
    s_add_u32 m0, s50, 26112
    v_mfma_f32_16x16x32_bf16 v[152:155], v[72:75], v[32:35], v[152:155]
    buffer_load_dwordx4 v21, s[20:23], s37 offen offset:0 lds
    v_mfma_f32_16x16x32_bf16 v[184:187], v[72:75], v[36:39], v[184:187]
    v_mfma_f32_16x16x32_bf16 v[216:219], v[72:75], v[40:43], v[216:219]
    v_mfma_f32_16x16x32_bf16 v[248:251], v[72:75], v[44:47], v[248:251]
    v_mfma_f32_16x16x32_bf16 v[156:159], v[76:79], v[32:35], v[156:159]
    v_mfma_f32_16x16x32_bf16 v[188:191], v[76:79], v[36:39], v[188:191]
    v_mfma_f32_16x16x32_bf16 v[220:223], v[76:79], v[40:43], v[220:223]
    buffer_load_dwordx4 v22, s[20:23], s37 offen offset:1024 lds
    v_mfma_f32_16x16x32_bf16 v[252:255], v[76:79], v[44:47], v[252:255]
    s_waitcnt vmcnt(13) lgkmcnt(0)
    s_barrier
    v_mfma_f32_16x16x32_bf16 v[128:131], v[96:99], v[80:83], v[128:131]
    ds_read_b64_tr_b16 v[48:49], v27 offset:0
    ds_read_b64_tr_b16 v[50:51], v27 offset:1024
    v_mfma_f32_16x16x32_bf16 v[160:163], v[96:99], v[84:87], v[160:163]
    s_add_u32 s36, s44, 1792
    v_mfma_f32_16x16x32_bf16 v[192:195], v[96:99], v[88:91], v[192:195]
    s_add_u32 m0, s42, 32768
    ds_read_b128 v[32:35], v25 offset:0
    ds_read_b128 v[36:39], v25 offset:2048
    v_mfma_f32_16x16x32_bf16 v[224:227], v[96:99], v[92:95], v[224:227]
    buffer_load_dwordx4 v17, s[24:27], s36 offen offset:0 lds
    v_mfma_f32_16x16x32_bf16 v[132:135], v[100:103], v[80:83], v[132:135]
    ds_read_b128 v[40:43], v25 offset:4096
    ds_read_b128 v[44:47], v25 offset:6144
    v_mfma_f32_16x16x32_bf16 v[164:167], v[100:103], v[84:87], v[164:167]
    v_mfma_f32_16x16x32_bf16 v[196:199], v[100:103], v[88:91], v[196:199]
    ds_read_b64_tr_b16 v[52:53], v28 offset:0
    ds_read_b64_tr_b16 v[54:55], v28 offset:1024
    v_mfma_f32_16x16x32_bf16 v[228:231], v[100:103], v[92:95], v[228:231]
    buffer_load_dwordx4 v18, s[24:27], s36 offen offset:1024 lds
    v_mfma_f32_16x16x32_bf16 v[136:139], v[104:107], v[80:83], v[136:139]
    ds_read_b64_tr_b16 v[56:57], v29 offset:0
    ds_read_b64_tr_b16 v[58:59], v29 offset:1024
    v_mfma_f32_16x16x32_bf16 v[168:171], v[104:107], v[84:87], v[168:171]
    v_mfma_f32_16x16x32_bf16 v[200:203], v[104:107], v[88:91], v[200:203]
    ds_read_b64_tr_b16 v[60:61], v30 offset:0
    ds_read_b64_tr_b16 v[62:63], v30 offset:1024
    v_mfma_f32_16x16x32_bf16 v[232:235], v[104:107], v[92:95], v[232:235]
    v_mfma_f32_16x16x32_bf16 v[140:143], v[108:111], v[80:83], v[140:143]
    ds_read_b64_tr_b16 v[64:65], v27 offset:128
    ds_read_b64_tr_b16 v[66:67], v27 offset:1152
    v_mfma_f32_16x16x32_bf16 v[172:175], v[108:111], v[84:87], v[172:175]
    v_mfma_f32_16x16x32_bf16 v[204:207], v[108:111], v[88:91], v[204:207]
    ds_read_b64_tr_b16 v[68:69], v28 offset:128
    ds_read_b64_tr_b16 v[70:71], v28 offset:1152
    v_mfma_f32_16x16x32_bf16 v[236:239], v[108:111], v[92:95], v[236:239]
    buffer_load_dwordx4 v19, s[24:27], s36 offen offset:2048 lds
    v_mfma_f32_16x16x32_bf16 v[144:147], v[112:115], v[80:83], v[144:147]
    ds_read_b64_tr_b16 v[72:73], v29 offset:128
    ds_read_b64_tr_b16 v[74:75], v29 offset:1152
    v_mfma_f32_16x16x32_bf16 v[176:179], v[112:115], v[84:87], v[176:179]
    v_mfma_f32_16x16x32_bf16 v[208:211], v[112:115], v[88:91], v[208:211]
    ds_read_b64_tr_b16 v[76:77], v30 offset:128
    ds_read_b64_tr_b16 v[78:79], v30 offset:1152
    v_mfma_f32_16x16x32_bf16 v[240:243], v[112:115], v[92:95], v[240:243]
    v_mfma_f32_16x16x32_bf16 v[148:151], v[116:119], v[80:83], v[148:151]
    v_mfma_f32_16x16x32_bf16 v[180:183], v[116:119], v[84:87], v[180:183]
    buffer_load_dwordx4 v20, s[24:27], s36 offen offset:3072 lds
    v_mfma_f32_16x16x32_bf16 v[212:215], v[116:119], v[88:91], v[212:215]
    s_add_u32 s37, s49, 7340032
    v_mfma_f32_16x16x32_bf16 v[244:247], v[116:119], v[92:95], v[244:247]
    s_add_u32 m0, s50, 34816
    v_mfma_f32_16x16x32_bf16 v[152:155], v[120:123], v[80:83], v[152:155]
    buffer_load_dwordx4 v21, s[20:23], s37 offen offset:0 lds
    v_mfma_f32_16x16x32_bf16 v[184:187], v[120:123], v[84:87], v[184:187]
    v_mfma_f32_16x16x32_bf16 v[216:219], v[120:123], v[88:91], v[216:219]
    v_mfma_f32_16x16x32_bf16 v[248:251], v[120:123], v[92:95], v[248:251]
    v_mfma_f32_16x16x32_bf16 v[156:159], v[124:127], v[80:83], v[156:159]
    v_mfma_f32_16x16x32_bf16 v[188:191], v[124:127], v[84:87], v[188:191]
    v_mfma_f32_16x16x32_bf16 v[220:223], v[124:127], v[88:91], v[220:223]
    buffer_load_dwordx4 v22, s[20:23], s37 offen offset:1024 lds
    v_mfma_f32_16x16x32_bf16 v[252:255], v[124:127], v[92:95], v[252:255]
    s_waitcnt lgkmcnt(0)
    v_mfma_f32_16x16x32_bf16 v[128:131], v[48:51], v[32:35], v[128:131]
    ds_read_b64_tr_b16 v[96:97], v27 offset:8704
    ds_read_b64_tr_b16 v[98:99], v27 offset:9728
    v_mfma_f32_16x16x32_bf16 v[160:163], v[48:51], v[36:39], v[160:163]
    s_add_u32 s36, s45, 1792
    v_mfma_f32_16x16x32_bf16 v[192:195], v[48:51], v[40:43], v[192:195]
    s_add_u32 m0, s42, 36864
    ds_read_b128 v[80:83], v26 offset:0
    ds_read_b128 v[84:87], v26 offset:2048
    v_mfma_f32_16x16x32_bf16 v[224:227], v[48:51], v[44:47], v[224:227]
    buffer_load_dwordx4 v17, s[24:27], s36 offen offset:0 lds
    v_mfma_f32_16x16x32_bf16 v[132:135], v[52:55], v[32:35], v[132:135]
    ds_read_b128 v[88:91], v26 offset:4096
    ds_read_b128 v[92:95], v26 offset:6144
    v_mfma_f32_16x16x32_bf16 v[164:167], v[52:55], v[36:39], v[164:167]
    v_mfma_f32_16x16x32_bf16 v[196:199], v[52:55], v[40:43], v[196:199]
    ds_read_b64_tr_b16 v[100:101], v28 offset:8704
    ds_read_b64_tr_b16 v[102:103], v28 offset:9728
    v_mfma_f32_16x16x32_bf16 v[228:231], v[52:55], v[44:47], v[228:231]
    buffer_load_dwordx4 v18, s[24:27], s36 offen offset:1024 lds
    v_mfma_f32_16x16x32_bf16 v[136:139], v[56:59], v[32:35], v[136:139]
    ds_read_b64_tr_b16 v[104:105], v29 offset:8704
    ds_read_b64_tr_b16 v[106:107], v29 offset:9728
    v_mfma_f32_16x16x32_bf16 v[168:171], v[56:59], v[36:39], v[168:171]
    v_mfma_f32_16x16x32_bf16 v[200:203], v[56:59], v[40:43], v[200:203]
    ds_read_b64_tr_b16 v[108:109], v30 offset:8704
    ds_read_b64_tr_b16 v[110:111], v30 offset:9728
    v_mfma_f32_16x16x32_bf16 v[232:235], v[56:59], v[44:47], v[232:235]
    v_mfma_f32_16x16x32_bf16 v[140:143], v[60:63], v[32:35], v[140:143]
    ds_read_b64_tr_b16 v[112:113], v27 offset:8832
    ds_read_b64_tr_b16 v[114:115], v27 offset:9856
    v_mfma_f32_16x16x32_bf16 v[172:175], v[60:63], v[36:39], v[172:175]
    v_mfma_f32_16x16x32_bf16 v[204:207], v[60:63], v[40:43], v[204:207]
    ds_read_b64_tr_b16 v[116:117], v28 offset:8832
    ds_read_b64_tr_b16 v[118:119], v28 offset:9856
    v_mfma_f32_16x16x32_bf16 v[236:239], v[60:63], v[44:47], v[236:239]
    buffer_load_dwordx4 v19, s[24:27], s36 offen offset:2048 lds
    v_mfma_f32_16x16x32_bf16 v[144:147], v[64:67], v[32:35], v[144:147]
    ds_read_b64_tr_b16 v[120:121], v29 offset:8832
    ds_read_b64_tr_b16 v[122:123], v29 offset:9856
    v_mfma_f32_16x16x32_bf16 v[176:179], v[64:67], v[36:39], v[176:179]
    v_mfma_f32_16x16x32_bf16 v[208:211], v[64:67], v[40:43], v[208:211]
    ds_read_b64_tr_b16 v[124:125], v30 offset:8832
    ds_read_b64_tr_b16 v[126:127], v30 offset:9856
    v_mfma_f32_16x16x32_bf16 v[240:243], v[64:67], v[44:47], v[240:243]
    v_mfma_f32_16x16x32_bf16 v[148:151], v[68:71], v[32:35], v[148:151]
    v_mfma_f32_16x16x32_bf16 v[180:183], v[68:71], v[36:39], v[180:183]
    buffer_load_dwordx4 v20, s[24:27], s36 offen offset:3072 lds
    v_mfma_f32_16x16x32_bf16 v[212:215], v[68:71], v[40:43], v[212:215]
    s_add_u32 s37, s49, 7602176
    v_mfma_f32_16x16x32_bf16 v[244:247], v[68:71], v[44:47], v[244:247]
    s_add_u32 m0, s50, 43520
    v_mfma_f32_16x16x32_bf16 v[152:155], v[72:75], v[32:35], v[152:155]
    buffer_load_dwordx4 v21, s[20:23], s37 offen offset:0 lds
    v_mfma_f32_16x16x32_bf16 v[184:187], v[72:75], v[36:39], v[184:187]
    v_mfma_f32_16x16x32_bf16 v[216:219], v[72:75], v[40:43], v[216:219]
    v_mfma_f32_16x16x32_bf16 v[248:251], v[72:75], v[44:47], v[248:251]
    v_mfma_f32_16x16x32_bf16 v[156:159], v[76:79], v[32:35], v[156:159]
gated_mix__ssm_conv_h3__compressed_kv_cla__prompt_kernel_pad7:
    s_cbranch_execz gated_mix__ssm_conv_h3__compressed_kv_cla__prompt_kernel_pad11
    v_mfma_f32_16x16x32_bf16 v[188:191], v[76:79], v[36:39], v[188:191]
    v_mfma_f32_16x16x32_bf16 v[220:223], v[76:79], v[40:43], v[220:223]
    buffer_load_dwordx4 v22, s[20:23], s37 offen offset:1024 lds
    v_mfma_f32_16x16x32_bf16 v[252:255], v[76:79], v[44:47], v[252:255]
    s_waitcnt vmcnt(12) lgkmcnt(0)
    s_barrier
    v_mfma_f32_16x16x32_bf16 v[128:131], v[96:99], v[80:83], v[128:131]
    s_add_u32 s8, s94, 67108864
    s_addc_u32 s9, s95, 0
    ds_read_b64_tr_b16 v[48:49], v27 offset:17408
    ds_read_b64_tr_b16 v[50:51], v27 offset:18432
    v_mfma_f32_16x16x32_bf16 v[160:163], v[96:99], v[84:87], v[160:163]
    s_add_u32 s36, s44, 1920
    v_mfma_f32_16x16x32_bf16 v[192:195], v[96:99], v[88:91], v[192:195]
    s_add_u32 m0, s42, 65536
    ds_read_b128 v[32:35], v23 offset:0
    ds_read_b128 v[36:39], v23 offset:2048
    v_mfma_f32_16x16x32_bf16 v[224:227], v[96:99], v[92:95], v[224:227]
    buffer_load_dwordx4 v17, s[24:27], s36 offen offset:0 lds
    v_mfma_f32_16x16x32_bf16 v[132:135], v[100:103], v[80:83], v[132:135]
    s_mov_b32 s10, 16777216
    ds_read_b128 v[40:43], v23 offset:4096
    ds_read_b128 v[44:47], v23 offset:6144
    v_mfma_f32_16x16x32_bf16 v[164:167], v[100:103], v[84:87], v[164:167]
    s_lshl_b32 s41, s2, 2
    v_mfma_f32_16x16x32_bf16 v[196:199], v[100:103], v[88:91], v[196:199]
    s_add_u32 s41, s41, s32
    ds_read_b64_tr_b16 v[52:53], v28 offset:17408
    ds_read_b64_tr_b16 v[54:55], v28 offset:18432
    v_mfma_f32_16x16x32_bf16 v[228:231], v[100:103], v[92:95], v[228:231]
    buffer_load_dwordx4 v18, s[24:27], s36 offen offset:1024 lds
    v_mfma_f32_16x16x32_bf16 v[136:139], v[104:107], v[80:83], v[136:139]
    s_lshl_b32 s41, s41, 14
    ds_read_b64_tr_b16 v[56:57], v29 offset:17408
    ds_read_b64_tr_b16 v[58:59], v29 offset:18432
    v_mfma_f32_16x16x32_bf16 v[168:171], v[104:107], v[84:87], v[168:171]
    s_add_u32 s38, s41, 4096
    v_mfma_f32_16x16x32_bf16 v[200:203], v[104:107], v[88:91], v[200:203]
    ds_read_b64_tr_b16 v[60:61], v30 offset:17408
    ds_read_b64_tr_b16 v[62:63], v30 offset:18432
    v_mfma_f32_16x16x32_bf16 v[232:235], v[104:107], v[92:95], v[232:235]
    v_mfma_f32_16x16x32_bf16 v[140:143], v[108:111], v[80:83], v[140:143]
    ds_read_b64_tr_b16 v[64:65], v27 offset:17536
    ds_read_b64_tr_b16 v[66:67], v27 offset:18560
    v_mfma_f32_16x16x32_bf16 v[172:175], v[108:111], v[84:87], v[172:175]
    v_mfma_f32_16x16x32_bf16 v[204:207], v[108:111], v[88:91], v[204:207]
    ds_read_b64_tr_b16 v[68:69], v28 offset:17536
    ds_read_b64_tr_b16 v[70:71], v28 offset:18560
    v_mfma_f32_16x16x32_bf16 v[236:239], v[108:111], v[92:95], v[236:239]
    buffer_load_dwordx4 v19, s[24:27], s36 offen offset:2048 lds
    v_mfma_f32_16x16x32_bf16 v[144:147], v[112:115], v[80:83], v[144:147]
    ds_read_b64_tr_b16 v[72:73], v29 offset:17536
    ds_read_b64_tr_b16 v[74:75], v29 offset:18560
    v_mfma_f32_16x16x32_bf16 v[176:179], v[112:115], v[84:87], v[176:179]
    v_mfma_f32_16x16x32_bf16 v[208:211], v[112:115], v[88:91], v[208:211]
    ds_read_b64_tr_b16 v[76:77], v30 offset:17536
    ds_read_b64_tr_b16 v[78:79], v30 offset:18560
    v_mfma_f32_16x16x32_bf16 v[240:243], v[112:115], v[92:95], v[240:243]
    v_mfma_f32_16x16x32_bf16 v[148:151], v[116:119], v[80:83], v[148:151]
    v_mfma_f32_16x16x32_bf16 v[180:183], v[116:119], v[84:87], v[180:183]
    buffer_load_dwordx4 v20, s[24:27], s36 offen offset:3072 lds
    v_mfma_f32_16x16x32_bf16 v[212:215], v[116:119], v[88:91], v[212:215]
    s_add_u32 s37, s49, 7864320
    v_mfma_f32_16x16x32_bf16 v[244:247], v[116:119], v[92:95], v[244:247]
    s_add_u32 m0, s50, 0
    v_mfma_f32_16x16x32_bf16 v[152:155], v[120:123], v[80:83], v[152:155]
    buffer_load_dwordx4 v21, s[20:23], s37 offen offset:0 lds
    v_mfma_f32_16x16x32_bf16 v[184:187], v[120:123], v[84:87], v[184:187]
    v_mfma_f32_16x16x32_bf16 v[216:219], v[120:123], v[88:91], v[216:219]
    v_mfma_f32_16x16x32_bf16 v[248:251], v[120:123], v[92:95], v[248:251]
    v_mfma_f32_16x16x32_bf16 v[156:159], v[124:127], v[80:83], v[156:159]
    v_mfma_f32_16x16x32_bf16 v[188:191], v[124:127], v[84:87], v[188:191]
    v_mfma_f32_16x16x32_bf16 v[220:223], v[124:127], v[88:91], v[220:223]
    buffer_load_dwordx4 v22, s[20:23], s37 offen offset:1024 lds
    v_mfma_f32_16x16x32_bf16 v[252:255], v[124:127], v[92:95], v[252:255]
    s_waitcnt lgkmcnt(0)
    v_mfma_f32_16x16x32_bf16 v[128:131], v[48:51], v[32:35], v[128:131]
    ds_read_b64_tr_b16 v[96:97], v27 offset:26112
    ds_read_b64_tr_b16 v[98:99], v27 offset:27136
    v_mfma_f32_16x16x32_bf16 v[160:163], v[48:51], v[36:39], v[160:163]
    s_add_u32 s36, s45, 1920
    v_mfma_f32_16x16x32_bf16 v[192:195], v[48:51], v[40:43], v[192:195]
    s_add_u32 m0, s42, 69632
    ds_read_b128 v[80:83], v24 offset:0
    ds_read_b128 v[84:87], v24 offset:2048
    v_mfma_f32_16x16x32_bf16 v[224:227], v[48:51], v[44:47], v[224:227]
    buffer_load_dwordx4 v17, s[24:27], s36 offen offset:0 lds
    v_mfma_f32_16x16x32_bf16 v[132:135], v[52:55], v[32:35], v[132:135]
    ds_read_b128 v[88:91], v24 offset:4096
    ds_read_b128 v[92:95], v24 offset:6144
    v_mfma_f32_16x16x32_bf16 v[164:167], v[52:55], v[36:39], v[164:167]
    v_mfma_f32_16x16x32_bf16 v[196:199], v[52:55], v[40:43], v[196:199]
    ds_read_b64_tr_b16 v[100:101], v28 offset:26112
    ds_read_b64_tr_b16 v[102:103], v28 offset:27136
    v_mfma_f32_16x16x32_bf16 v[228:231], v[52:55], v[44:47], v[228:231]
    buffer_load_dwordx4 v18, s[24:27], s36 offen offset:1024 lds
    v_mfma_f32_16x16x32_bf16 v[136:139], v[56:59], v[32:35], v[136:139]
    ds_read_b64_tr_b16 v[104:105], v29 offset:26112
    ds_read_b64_tr_b16 v[106:107], v29 offset:27136
    v_mfma_f32_16x16x32_bf16 v[168:171], v[56:59], v[36:39], v[168:171]
    v_mfma_f32_16x16x32_bf16 v[200:203], v[56:59], v[40:43], v[200:203]
    ds_read_b64_tr_b16 v[108:109], v30 offset:26112
    ds_read_b64_tr_b16 v[110:111], v30 offset:27136
    v_mfma_f32_16x16x32_bf16 v[232:235], v[56:59], v[44:47], v[232:235]
    v_mfma_f32_16x16x32_bf16 v[140:143], v[60:63], v[32:35], v[140:143]
    ds_read_b64_tr_b16 v[112:113], v27 offset:26240
    ds_read_b64_tr_b16 v[114:115], v27 offset:27264
    v_mfma_f32_16x16x32_bf16 v[172:175], v[60:63], v[36:39], v[172:175]
    v_mfma_f32_16x16x32_bf16 v[204:207], v[60:63], v[40:43], v[204:207]
    ds_read_b64_tr_b16 v[116:117], v28 offset:26240
    ds_read_b64_tr_b16 v[118:119], v28 offset:27264
    v_mfma_f32_16x16x32_bf16 v[236:239], v[60:63], v[44:47], v[236:239]
    buffer_load_dwordx4 v19, s[24:27], s36 offen offset:2048 lds
    v_mfma_f32_16x16x32_bf16 v[144:147], v[64:67], v[32:35], v[144:147]
    ds_read_b64_tr_b16 v[120:121], v29 offset:26240
    ds_read_b64_tr_b16 v[122:123], v29 offset:27264
    v_mfma_f32_16x16x32_bf16 v[176:179], v[64:67], v[36:39], v[176:179]
    v_mfma_f32_16x16x32_bf16 v[208:211], v[64:67], v[40:43], v[208:211]
    ds_read_b64_tr_b16 v[124:125], v30 offset:26240
    ds_read_b64_tr_b16 v[126:127], v30 offset:27264
    v_mfma_f32_16x16x32_bf16 v[240:243], v[64:67], v[44:47], v[240:243]
    v_mfma_f32_16x16x32_bf16 v[148:151], v[68:71], v[32:35], v[148:151]
    v_mov_b32 v12, -1
    v_mov_b32 v13, -1
    v_mfma_f32_16x16x32_bf16 v[180:183], v[68:71], v[36:39], v[180:183]
    buffer_load_dwordx4 v20, s[24:27], s36 offen offset:3072 lds
    v_mfma_f32_16x16x32_bf16 v[212:215], v[68:71], v[40:43], v[212:215]
    s_add_u32 s37, s49, 8126464
    v_mov_b32 v14, -1
    v_mov_b32 v15, -1
    v_mfma_f32_16x16x32_bf16 v[244:247], v[68:71], v[44:47], v[244:247]
    s_add_u32 m0, s50, 8704
    v_mfma_f32_16x16x32_bf16 v[152:155], v[72:75], v[32:35], v[152:155]
    buffer_load_dwordx4 v21, s[20:23], s37 offen offset:0 lds
    v_mfma_f32_16x16x32_bf16 v[184:187], v[72:75], v[36:39], v[184:187]
    v_mfma_f32_16x16x32_bf16 v[216:219], v[72:75], v[40:43], v[216:219]
    v_mfma_f32_16x16x32_bf16 v[248:251], v[72:75], v[44:47], v[248:251]
    v_mfma_f32_16x16x32_bf16 v[156:159], v[76:79], v[32:35], v[156:159]
    v_mfma_f32_16x16x32_bf16 v[188:191], v[76:79], v[36:39], v[188:191]
    v_mfma_f32_16x16x32_bf16 v[220:223], v[76:79], v[40:43], v[220:223]
    buffer_load_dwordx4 v22, s[20:23], s37 offen offset:1024 lds
    v_mfma_f32_16x16x32_bf16 v[252:255], v[76:79], v[44:47], v[252:255]
    s_waitcnt vmcnt(12) lgkmcnt(0)
    s_barrier
    v_mfma_f32_16x16x32_bf16 v[128:131], v[96:99], v[80:83], v[128:131]
    s_lshl_b32 s36, s33, 20
    ds_read_b64_tr_b16 v[48:49], v27 offset:34816
    ds_read_b64_tr_b16 v[50:51], v27 offset:35840
    v_mfma_f32_16x16x32_bf16 v[160:163], v[96:99], v[84:87], v[160:163]
    s_add_u32 s12, s94, s36
    s_addc_u32 s13, s95, 0
    v_mfma_f32_16x16x32_bf16 v[192:195], v[96:99], v[88:91], v[192:195]
    s_lshl_b32 s36, s34, 16
    ds_read_b128 v[32:35], v23 offset:32768
    ds_read_b128 v[36:39], v23 offset:34816
    v_mfma_f32_16x16x32_bf16 v[224:227], v[96:99], v[92:95], v[224:227]
    buffer_store_dwordx4 v[12:15], v16, s[8:11], s41 offen offset:0 sc1
    v_mfma_f32_16x16x32_bf16 v[132:135], v[100:103], v[80:83], v[132:135]
    s_sub_u32 s14, 1048576, s36
    ds_read_b128 v[40:43], v23 offset:36864
    ds_read_b128 v[44:47], v23 offset:38912
    v_mfma_f32_16x16x32_bf16 v[164:167], v[100:103], v[84:87], v[164:167]
    s_lshl_b32 s59, s32, 12
    v_mfma_f32_16x16x32_bf16 v[196:199], v[100:103], v[88:91], v[196:199]
    s_lshl_b32 s36, s34, 1
    ds_read_b64_tr_b16 v[52:53], v28 offset:34816
    ds_read_b64_tr_b16 v[54:55], v28 offset:35840
    v_mfma_f32_16x16x32_bf16 v[228:231], v[100:103], v[92:95], v[228:231]
    v_mfma_f32_16x16x32_bf16 v[136:139], v[104:107], v[80:83], v[136:139]
    s_add_u32 s36, s36, 3
    ds_read_b64_tr_b16 v[56:57], v29 offset:34816
    ds_read_b64_tr_b16 v[58:59], v29 offset:35840
    v_mfma_f32_16x16x32_bf16 v[168:171], v[104:107], v[84:87], v[168:171]
    s_mul_i32 s37, s36, 52
    v_mfma_f32_16x16x32_bf16 v[200:203], v[104:107], v[88:91], v[200:203]
    s_lshr_b32 s37, s37, 8
    ds_read_b64_tr_b16 v[60:61], v30 offset:34816
    ds_read_b64_tr_b16 v[62:63], v30 offset:35840
    v_mfma_f32_16x16x32_bf16 v[232:235], v[104:107], v[92:95], v[232:235]
    buffer_store_dwordx4 v[12:15], v16, s[8:11], s41 offen offset:1024 sc1
    v_mfma_f32_16x16x32_bf16 v[140:143], v[108:111], v[80:83], v[140:143]
    s_mul_i32 s37, s37, 5
    ds_read_b64_tr_b16 v[64:65], v27 offset:34944
    ds_read_b64_tr_b16 v[66:67], v27 offset:35968
    v_mfma_f32_16x16x32_bf16 v[172:175], v[108:111], v[84:87], v[172:175]
    s_sub_u32 s36, s36, s37
    v_mfma_f32_16x16x32_bf16 v[204:207], v[108:111], v[88:91], v[204:207]
    s_lshl_b32 s47, s36, 15
    ds_read_b64_tr_b16 v[68:69], v28 offset:34944
    ds_read_b64_tr_b16 v[70:71], v28 offset:35968
    v_mfma_f32_16x16x32_bf16 v[236:239], v[108:111], v[92:95], v[236:239]
    v_mfma_f32_16x16x32_bf16 v[144:147], v[112:115], v[80:83], v[144:147]
    s_add_u32 s48, s47, 32768
    ds_read_b64_tr_b16 v[72:73], v29 offset:34944
    ds_read_b64_tr_b16 v[74:75], v29 offset:35968
    v_mfma_f32_16x16x32_bf16 v[176:179], v[112:115], v[84:87], v[176:179]
    s_cmp_eq_u32 s48, 163840
    s_cselect_b32 s48, 0, s48
    v_mfma_f32_16x16x32_bf16 v[208:211], v[112:115], v[88:91], v[208:211]
    s_add_u32 s51, s48, 32768
    ds_read_b64_tr_b16 v[76:77], v30 offset:34944
    ds_read_b64_tr_b16 v[78:79], v30 offset:35968
    v_mfma_f32_16x16x32_bf16 v[240:243], v[112:115], v[92:95], v[240:243]
    s_cmp_eq_u32 s51, 163840
    s_cselect_b32 s51, 0, s51
    v_mfma_f32_16x16x32_bf16 v[148:151], v[116:119], v[80:83], v[148:151]
    s_add_u32 s52, s51, 32768
    v_mfma_f32_16x16x32_bf16 v[180:183], v[116:119], v[84:87], v[180:183]
    buffer_store_dwordx4 v[12:15], v16, s[8:11], s41 offen offset:2048 sc1
    v_mfma_f32_16x16x32_bf16 v[212:215], v[116:119], v[88:91], v[212:215]
    s_cmp_eq_u32 s52, 163840
    s_cselect_b32 s52, 0, s52
    v_mfma_f32_16x16x32_bf16 v[244:247], v[116:119], v[92:95], v[244:247]
    s_add_u32 s53, s52, 32768
    v_mfma_f32_16x16x32_bf16 v[152:155], v[120:123], v[80:83], v[152:155]
    v_mfma_f32_16x16x32_bf16 v[184:187], v[120:123], v[84:87], v[184:187]
    s_cmp_eq_u32 s53, 163840
    s_cselect_b32 s53, 0, s53
    v_mfma_f32_16x16x32_bf16 v[216:219], v[120:123], v[88:91], v[216:219]
    v_mfma_f32_16x16x32_bf16 v[248:251], v[120:123], v[92:95], v[248:251]
    buffer_store_dwordx4 v[12:15], v16, s[8:11], s41 offen offset:3072 sc1
    v_mfma_f32_16x16x32_bf16 v[156:159], v[124:127], v[80:83], v[156:159]
    v_mfma_f32_16x16x32_bf16 v[188:191], v[124:127], v[84:87], v[188:191]
    v_mfma_f32_16x16x32_bf16 v[220:223], v[124:127], v[88:91], v[220:223]
    v_mfma_f32_16x16x32_bf16 v[252:255], v[124:127], v[92:95], v[252:255]
    s_waitcnt lgkmcnt(0)
    v_mfma_f32_16x16x32_bf16 v[128:131], v[48:51], v[32:35], v[128:131]
    ds_read_b64_tr_b16 v[96:97], v27 offset:43520
    ds_read_b64_tr_b16 v[98:99], v27 offset:44544
    v_mfma_f32_16x16x32_bf16 v[160:163], v[48:51], v[36:39], v[160:163]
    v_mfma_f32_16x16x32_bf16 v[192:195], v[48:51], v[40:43], v[192:195]
    ds_read_b128 v[80:83], v24 offset:32768
    ds_read_b128 v[84:87], v24 offset:34816
    v_mfma_f32_16x16x32_bf16 v[224:227], v[48:51], v[44:47], v[224:227]
    buffer_store_dwordx4 v[12:15], v16, s[8:11], s38 offen offset:0 sc1
    v_mfma_f32_16x16x32_bf16 v[132:135], v[52:55], v[32:35], v[132:135]
    ds_read_b128 v[88:91], v24 offset:36864
    ds_read_b128 v[92:95], v24 offset:38912
    v_mfma_f32_16x16x32_bf16 v[164:167], v[52:55], v[36:39], v[164:167]
    v_mfma_f32_16x16x32_bf16 v[196:199], v[52:55], v[40:43], v[196:199]
    ds_read_b64_tr_b16 v[100:101], v28 offset:43520
    ds_read_b64_tr_b16 v[102:103], v28 offset:44544
    v_mfma_f32_16x16x32_bf16 v[228:231], v[52:55], v[44:47], v[228:231]
    v_mfma_f32_16x16x32_bf16 v[136:139], v[56:59], v[32:35], v[136:139]
    ds_read_b64_tr_b16 v[104:105], v29 offset:43520
    ds_read_b64_tr_b16 v[106:107], v29 offset:44544
    v_mfma_f32_16x16x32_bf16 v[168:171], v[56:59], v[36:39], v[168:171]
    v_mfma_f32_16x16x32_bf16 v[200:203], v[56:59], v[40:43], v[200:203]
    ds_read_b64_tr_b16 v[108:109], v30 offset:43520
    ds_read_b64_tr_b16 v[110:111], v30 offset:44544
    v_mfma_f32_16x16x32_bf16 v[232:235], v[56:59], v[44:47], v[232:235]
    buffer_store_dwordx4 v[12:15], v16, s[8:11], s38 offen offset:1024 sc1
    v_mfma_f32_16x16x32_bf16 v[140:143], v[60:63], v[32:35], v[140:143]
    ds_read_b64_tr_b16 v[112:113], v27 offset:43648
    ds_read_b64_tr_b16 v[114:115], v27 offset:44672
    v_mfma_f32_16x16x32_bf16 v[172:175], v[60:63], v[36:39], v[172:175]
    v_mfma_f32_16x16x32_bf16 v[204:207], v[60:63], v[40:43], v[204:207]
    ds_read_b64_tr_b16 v[116:117], v28 offset:43648
    ds_read_b64_tr_b16 v[118:119], v28 offset:44672
    v_mfma_f32_16x16x32_bf16 v[236:239], v[60:63], v[44:47], v[236:239]
    v_mfma_f32_16x16x32_bf16 v[144:147], v[64:67], v[32:35], v[144:147]
    ds_read_b64_tr_b16 v[120:121], v29 offset:43648
    ds_read_b64_tr_b16 v[122:123], v29 offset:44672
    v_mfma_f32_16x16x32_bf16 v[176:179], v[64:67], v[36:39], v[176:179]
    v_mfma_f32_16x16x32_bf16 v[208:211], v[64:67], v[40:43], v[208:211]
    ds_read_b64_tr_b16 v[124:125], v30 offset:43648
    ds_read_b64_tr_b16 v[126:127], v30 offset:44672
    v_mfma_f32_16x16x32_bf16 v[240:243], v[64:67], v[44:47], v[240:243]
    v_mfma_f32_16x16x32_bf16 v[148:151], v[68:71], v[32:35], v[148:151]
    v_mfma_f32_16x16x32_bf16 v[180:183], v[68:71], v[36:39], v[180:183]
    buffer_store_dwordx4 v[12:15], v16, s[8:11], s38 offen offset:2048 sc1
    v_mfma_f32_16x16x32_bf16 v[212:215], v[68:71], v[40:43], v[212:215]
    v_mfma_f32_16x16x32_bf16 v[244:247], v[68:71], v[44:47], v[244:247]
    v_mfma_f32_16x16x32_bf16 v[152:155], v[72:75], v[32:35], v[152:155]
    v_mfma_f32_16x16x32_bf16 v[184:187], v[72:75], v[36:39], v[184:187]
    v_mfma_f32_16x16x32_bf16 v[216:219], v[72:75], v[40:43], v[216:219]
    v_mfma_f32_16x16x32_bf16 v[248:251], v[72:75], v[44:47], v[248:251]
    buffer_store_dwordx4 v[12:15], v16, s[8:11], s38 offen offset:3072 sc1
    v_mfma_f32_16x16x32_bf16 v[156:159], v[76:79], v[32:35], v[156:159]
    v_mfma_f32_16x16x32_bf16 v[188:191], v[76:79], v[36:39], v[188:191]
    v_mfma_f32_16x16x32_bf16 v[220:223], v[76:79], v[40:43], v[220:223]
    v_mfma_f32_16x16x32_bf16 v[252:255], v[76:79], v[44:47], v[252:255]
    s_waitcnt vmcnt(8) lgkmcnt(0)
    s_barrier
    v_mfma_f32_16x16x32_bf16 v[128:131], v[96:99], v[80:83], v[128:131]
    s_add_u32 s38, s59, 131072
    ds_read_b64_tr_b16 v[48:49], v27 offset:0
    ds_read_b64_tr_b16 v[50:51], v27 offset:1024
    v_mfma_f32_16x16x32_bf16 v[160:163], v[96:99], v[84:87], v[160:163]
    s_mov_b32 s42, 0x40004000
    v_mfma_f32_16x16x32_bf16 v[192:195], v[96:99], v[88:91], v[192:195]
    s_mov_b32 s39, s47
    ds_read_b128 v[32:35], v25 offset:0
    ds_read_b128 v[36:39], v25 offset:2048
    v_mfma_f32_16x16x32_bf16 v[224:227], v[96:99], v[92:95], v[224:227]
    v_mfma_f32_16x16x32_bf16 v[132:135], v[100:103], v[80:83], v[132:135]
    s_mov_b32 s45, s48
    ds_read_b128 v[40:43], v25 offset:4096
    ds_read_b128 v[44:47], v25 offset:6144
    v_mfma_f32_16x16x32_bf16 v[164:167], v[100:103], v[84:87], v[164:167]
    s_mov_b32 s44, 32768
    v_mfma_f32_16x16x32_bf16 v[196:199], v[100:103], v[88:91], v[196:199]
    s_movk_i32 s49, 16384
    ds_read_b64_tr_b16 v[52:53], v28 offset:0
    ds_read_b64_tr_b16 v[54:55], v28 offset:1024
    v_mfma_f32_16x16x32_bf16 v[228:231], v[100:103], v[92:95], v[228:231]
    v_mfma_f32_16x16x32_bf16 v[136:139], v[104:107], v[80:83], v[136:139]
    s_movk_i32 s50, 16384
    ds_read_b64_tr_b16 v[56:57], v29 offset:0
    ds_read_b64_tr_b16 v[58:59], v29 offset:1024
    v_mfma_f32_16x16x32_bf16 v[168:171], v[104:107], v[84:87], v[168:171]
    s_add_u32 s16, s94, 33554432
    s_addc_u32 s17, s95, 0
    v_mfma_f32_16x16x32_bf16 v[200:203], v[104:107], v[88:91], v[200:203]
    s_mov_b32 s18, 16777216
    ds_read_b64_tr_b16 v[60:61], v30 offset:0
    ds_read_b64_tr_b16 v[62:63], v30 offset:1024
    v_mfma_f32_16x16x32_bf16 v[232:235], v[104:107], v[92:95], v[232:235]
    v_mfma_f32_16x16x32_bf16 v[140:143], v[108:111], v[80:83], v[140:143]
    s_mov_b32 s8, s86
    ds_read_b64_tr_b16 v[64:65], v27 offset:128
    ds_read_b64_tr_b16 v[66:67], v27 offset:1152
    v_mfma_f32_16x16x32_bf16 v[172:175], v[108:111], v[84:87], v[172:175]
    s_mov_b32 s9, s87
    v_mfma_f32_16x16x32_bf16 v[204:207], v[108:111], v[88:91], v[204:207]
    s_mov_b32 s10, 8388608
    ds_read_b64_tr_b16 v[68:69], v28 offset:128
    ds_read_b64_tr_b16 v[70:71], v28 offset:1152
    v_mfma_f32_16x16x32_bf16 v[236:239], v[108:111], v[92:95], v[236:239]
    v_mfma_f32_16x16x32_bf16 v[144:147], v[112:115], v[80:83], v[144:147]
    s_mov_b32 s4, s72
    ds_read_b64_tr_b16 v[72:73], v29 offset:128
    ds_read_b64_tr_b16 v[74:75], v29 offset:1152
    v_mfma_f32_16x16x32_bf16 v[176:179], v[112:115], v[84:87], v[176:179]
    s_mov_b32 s5, s73
    v_mfma_f32_16x16x32_bf16 v[208:211], v[112:115], v[88:91], v[208:211]
    s_mov_b32 s6, 4194304
    ds_read_b64_tr_b16 v[76:77], v30 offset:128
    ds_read_b64_tr_b16 v[78:79], v30 offset:1152
    v_mfma_f32_16x16x32_bf16 v[240:243], v[112:115], v[92:95], v[240:243]
    s_lshl_b32 s58, s2, 2
    v_mfma_f32_16x16x32_bf16 v[148:151], v[116:119], v[80:83], v[148:151]
    s_add_u32 s58, s58, s32
    v_mfma_f32_16x16x32_bf16 v[180:183], v[116:119], v[84:87], v[180:183]
    v_mfma_f32_16x16x32_bf16 v[212:215], v[116:119], v[88:91], v[212:215]
    s_sub_u32 s46, s58, 512
    v_mfma_f32_16x16x32_bf16 v[244:247], v[116:119], v[92:95], v[244:247]
    s_lshl_b32 s46, s46, 11
    v_mfma_f32_16x16x32_bf16 v[152:155], v[120:123], v[80:83], v[152:155]
    v_mfma_f32_16x16x32_bf16 v[184:187], v[120:123], v[84:87], v[184:187]
    s_cmp_lt_u32 s34, 4
    s_cselect_b32 s46, 0x80000000, s46
    v_mfma_f32_16x16x32_bf16 v[216:219], v[120:123], v[88:91], v[216:219]
    v_mfma_f32_16x16x32_bf16 v[248:251], v[120:123], v[92:95], v[248:251]
    v_mfma_f32_16x16x32_bf16 v[156:159], v[124:127], v[80:83], v[156:159]
    v_mfma_f32_16x16x32_bf16 v[188:191], v[124:127], v[84:87], v[188:191]
    v_mfma_f32_16x16x32_bf16 v[220:223], v[124:127], v[88:91], v[220:223]
    v_mfma_f32_16x16x32_bf16 v[252:255], v[124:127], v[92:95], v[252:255]
    s_waitcnt lgkmcnt(0)
    v_mfma_f32_16x16x32_bf16 v[128:131], v[48:51], v[32:35], v[128:131]
    ds_read_b64_tr_b16 v[96:97], v27 offset:8704
    ds_read_b64_tr_b16 v[98:99], v27 offset:9728
    v_mfma_f32_16x16x32_bf16 v[160:163], v[48:51], v[36:39], v[160:163]
    v_mfma_f32_16x16x32_bf16 v[192:195], v[48:51], v[40:43], v[192:195]
    ds_read_b128 v[80:83], v26 offset:0
    ds_read_b128 v[84:87], v26 offset:2048
    v_mfma_f32_16x16x32_bf16 v[224:227], v[48:51], v[44:47], v[224:227]
    buffer_load_dword v2, v3, s[28:31], s40 offen sc1
    v_mfma_f32_16x16x32_bf16 v[132:135], v[52:55], v[32:35], v[132:135]
    ds_read_b128 v[88:91], v26 offset:4096
    ds_read_b128 v[92:95], v26 offset:6144
    v_mfma_f32_16x16x32_bf16 v[164:167], v[52:55], v[36:39], v[164:167]
    v_mfma_f32_16x16x32_bf16 v[196:199], v[52:55], v[40:43], v[196:199]
    ds_read_b64_tr_b16 v[100:101], v28 offset:8704
    ds_read_b64_tr_b16 v[102:103], v28 offset:9728
    v_mfma_f32_16x16x32_bf16 v[228:231], v[52:55], v[44:47], v[228:231]
    v_mfma_f32_16x16x32_bf16 v[136:139], v[56:59], v[32:35], v[136:139]
    ds_read_b64_tr_b16 v[104:105], v29 offset:8704
    ds_read_b64_tr_b16 v[106:107], v29 offset:9728
    v_mfma_f32_16x16x32_bf16 v[168:171], v[56:59], v[36:39], v[168:171]
    v_mfma_f32_16x16x32_bf16 v[200:203], v[56:59], v[40:43], v[200:203]
    ds_read_b64_tr_b16 v[108:109], v30 offset:8704
    ds_read_b64_tr_b16 v[110:111], v30 offset:9728
    v_mfma_f32_16x16x32_bf16 v[232:235], v[56:59], v[44:47], v[232:235]
    v_mfma_f32_16x16x32_bf16 v[140:143], v[60:63], v[32:35], v[140:143]
    ds_read_b64_tr_b16 v[112:113], v27 offset:8832
    ds_read_b64_tr_b16 v[114:115], v27 offset:9856
    v_mfma_f32_16x16x32_bf16 v[172:175], v[60:63], v[36:39], v[172:175]
    v_mfma_f32_16x16x32_bf16 v[204:207], v[60:63], v[40:43], v[204:207]
    ds_read_b64_tr_b16 v[116:117], v28 offset:8832
    ds_read_b64_tr_b16 v[118:119], v28 offset:9856
    v_mfma_f32_16x16x32_bf16 v[236:239], v[60:63], v[44:47], v[236:239]
    v_mfma_f32_16x16x32_bf16 v[144:147], v[64:67], v[32:35], v[144:147]
    ds_read_b64_tr_b16 v[120:121], v29 offset:8832
    ds_read_b64_tr_b16 v[122:123], v29 offset:9856
    v_mfma_f32_16x16x32_bf16 v[176:179], v[64:67], v[36:39], v[176:179]
    v_mfma_f32_16x16x32_bf16 v[208:211], v[64:67], v[40:43], v[208:211]
    ds_read_b64_tr_b16 v[124:125], v30 offset:8832
    ds_read_b64_tr_b16 v[126:127], v30 offset:9856
    v_mfma_f32_16x16x32_bf16 v[240:243], v[64:67], v[44:47], v[240:243]
    v_mfma_f32_16x16x32_bf16 v[148:151], v[68:71], v[32:35], v[148:151]
    v_mfma_f32_16x16x32_bf16 v[180:183], v[68:71], v[36:39], v[180:183]
    v_mfma_f32_16x16x32_bf16 v[212:215], v[68:71], v[40:43], v[212:215]
    v_mfma_f32_16x16x32_bf16 v[244:247], v[68:71], v[44:47], v[244:247]
    v_mfma_f32_16x16x32_bf16 v[152:155], v[72:75], v[32:35], v[152:155]
    v_mfma_f32_16x16x32_bf16 v[184:187], v[72:75], v[36:39], v[184:187]
    v_mfma_f32_16x16x32_bf16 v[216:219], v[72:75], v[40:43], v[216:219]
    v_mfma_f32_16x16x32_bf16 v[248:251], v[72:75], v[44:47], v[248:251]
    v_mfma_f32_16x16x32_bf16 v[156:159], v[76:79], v[32:35], v[156:159]
    v_mfma_f32_16x16x32_bf16 v[188:191], v[76:79], v[36:39], v[188:191]
    v_mfma_f32_16x16x32_bf16 v[220:223], v[76:79], v[40:43], v[220:223]
    v_mfma_f32_16x16x32_bf16 v[252:255], v[76:79], v[44:47], v[252:255]
    s_waitcnt vmcnt(0) lgkmcnt(0)
    s_barrier
    v_cmp_ne_u32 vcc, 1, v2
    v_mfma_f32_16x16x32_bf16 v[128:131], v[96:99], v[80:83], v[128:131]
    s_nop 0
    s_cbranch_vccnz gated_mix__ssm_conv_h3__compressed_kv_cla__prompt_kernel_spin_kv
gated_mix__ssm_conv_h3__compressed_kv_cla__prompt_kernel_spin_kv_ret:
    v_mfma_f32_16x16x32_bf16 v[160:163], v[96:99], v[84:87], v[160:163]
    s_add_u32 s36, s59, 0
    v_bfe_u32 v40, v16, 4, 4
    v_lshrrev_b32 v41, 8, v16
    v_mfma_f32_16x16x32_bf16 v[192:195], v[96:99], v[88:91], v[192:195]
    s_add_u32 s37, s59, s47
    s_mov_b32 m0, s37
    v_sub_u32 v40, v40, v41
    v_cmp_gt_u32 vcc, 256, v16
    v_mfma_f32_16x16x32_bf16 v[224:227], v[96:99], v[92:95], v[224:227]
    buffer_load_dwordx4 v16, s[12:15], s36 offen offset:0 sc1 lds
    v_mfma_f32_16x16x32_bf16 v[132:135], v[100:103], v[80:83], v[132:135]
    s_add_u32 s40, s59, s53
    v_lshl_add_u32 v40, v40, 2, s32
    v_mov_b32 v41, 0xff000000
    v_mfma_f32_16x16x32_bf16 v[164:167], v[100:103], v[84:87], v[164:167]
    s_add_u32 s41, s40, 16384
    v_lshlrev_b32 v15, 3, v16
    v_cndmask_b32 v19, v41, v15, vcc
    v_mfma_f32_16x16x32_bf16 v[196:199], v[100:103], v[88:91], v[196:199]
    s_lshl_b32 s54, s58, 12
    v_cmp_gt_i32 vcc, 0, v40
    v_cmp_gt_i32 s[66:67], 1, v40
    v_mfma_f32_16x16x32_bf16 v[228:231], v[100:103], v[92:95], v[228:231]
    buffer_load_dwordx4 v16, s[12:15], s36 offen offset:1024 sc1 lds
    v_mfma_f32_16x16x32_bf16 v[136:139], v[104:107], v[80:83], v[136:139]
    v_cndmask_b32 v48, 0, v41, vcc
    v_cndmask_b32 v49, 0, v41, s[66:67]
    v_mfma_f32_16x16x32_bf16 v[168:171], v[104:107], v[84:87], v[168:171]
    v_cmp_gt_i32 vcc, 2, v40
    v_cmp_gt_i32 s[66:67], 3, v40
    v_mfma_f32_16x16x32_bf16 v[200:203], v[104:107], v[88:91], v[200:203]
    v_cndmask_b32 v50, 0, v41, vcc
    v_cndmask_b32 v51, 0, v41, s[66:67]
    v_mfma_f32_16x16x32_bf16 v[232:235], v[104:107], v[92:95], v[232:235]
    buffer_load_dwordx4 v16, s[12:15], s36 offen offset:2048 sc1 lds
    v_mfma_f32_16x16x32_bf16 v[140:143], v[108:111], v[80:83], v[140:143]
    v_cmp_gt_i32 vcc, 16, v40
    v_cmp_gt_i32 s[66:67], 17, v40
    v_mfma_f32_16x16x32_bf16 v[172:175], v[108:111], v[84:87], v[172:175]
    v_cndmask_b32 v52, 0, v41, vcc
    v_cndmask_b32 v53, 0, v41, s[66:67]
    v_mfma_f32_16x16x32_bf16 v[204:207], v[108:111], v[88:91], v[204:207]
    v_cmp_gt_i32 vcc, 18, v40
    v_cmp_gt_i32 s[66:67], 19, v40
    v_mfma_f32_16x16x32_bf16 v[236:239], v[108:111], v[92:95], v[236:239]
    buffer_load_dwordx4 v16, s[12:15], s36 offen offset:3072 sc1 lds
    v_mfma_f32_16x16x32_bf16 v[144:147], v[112:115], v[80:83], v[144:147]
    v_cndmask_b32 v54, 0, v41, vcc
    v_cndmask_b32 v55, 0, v41, s[66:67]
    v_mfma_f32_16x16x32_bf16 v[176:179], v[112:115], v[84:87], v[176:179]
    v_cmp_gt_i32 vcc, 32, v40
    v_cmp_gt_i32 s[66:67], 33, v40
    v_mfma_f32_16x16x32_bf16 v[208:211], v[112:115], v[88:91], v[208:211]
    v_cndmask_b32 v56, 0, v41, vcc
    v_cndmask_b32 v57, 0, v41, s[66:67]
    v_mfma_f32_16x16x32_bf16 v[240:243], v[112:115], v[92:95], v[240:243]
    s_add_u32 s36, s59, 16384
    v_cmp_gt_i32 vcc, 34, v40
    v_cmp_gt_i32 s[66:67], 35, v40
    v_mfma_f32_16x16x32_bf16 v[148:151], v[116:119], v[80:83], v[148:151]
    s_add_u32 s37, s59, s47
    s_add_u32 m0, s37, 16384
    v_cndmask_b32 v58, 0, v41, vcc
    v_cndmask_b32 v59, 0, v41, s[66:67]
    v_mfma_f32_16x16x32_bf16 v[180:183], v[116:119], v[84:87], v[180:183]
    buffer_load_dwordx4 v16, s[12:15], s36 offen offset:0 sc1 lds
    v_mfma_f32_16x16x32_bf16 v[212:215], v[116:119], v[88:91], v[212:215]
    v_cmp_gt_i32 vcc, 48, v40
    v_cmp_gt_i32 s[66:67], 49, v40
    v_mfma_f32_16x16x32_bf16 v[244:247], v[116:119], v[92:95], v[244:247]
    v_cndmask_b32 v60, 0, v41, vcc
    v_cndmask_b32 v61, 0, v41, s[66:67]
    v_mfma_f32_16x16x32_bf16 v[152:155], v[120:123], v[80:83], v[152:155]
    buffer_load_dwordx4 v16, s[12:15], s36 offen offset:1024 sc1 lds
    v_mfma_f32_16x16x32_bf16 v[184:187], v[120:123], v[84:87], v[184:187]
    v_cmp_gt_i32 vcc, 50, v40
    v_cmp_gt_i32 s[66:67], 51, v40
    v_mfma_f32_16x16x32_bf16 v[216:219], v[120:123], v[88:91], v[216:219]
    v_cndmask_b32 v62, 0, v41, vcc
    v_cndmask_b32 v63, 0, v41, s[66:67]
    v_mfma_f32_16x16x32_bf16 v[248:251], v[120:123], v[92:95], v[248:251]
    buffer_load_dwordx4 v16, s[12:15], s36 offen offset:2048 sc1 lds
    v_mfma_f32_16x16x32_bf16 v[156:159], v[124:127], v[80:83], v[156:159]
    v_add_u32 v2, s47, v16
    v_add_u32 v3, s47, v16
    v_mfma_f32_16x16x32_bf16 v[188:191], v[124:127], v[84:87], v[188:191]
    v_mov_b32 v24, 0x3f803f80
    v_mov_b32 v25, 0x3f803f80
    v_mfma_f32_16x16x32_bf16 v[220:223], v[124:127], v[88:91], v[220:223]
    buffer_load_dwordx4 v16, s[12:15], s36 offen offset:3072 sc1 lds
    v_mfma_f32_16x16x32_bf16 v[252:255], v[124:127], v[92:95], v[252:255]
    v_mov_b32 v26, 0x3f803f80
    v_mov_b32 v27, 0x3f803f80
    v_cvt_pk_bf16_f32 v80, v128, v129
    v_cvt_pk_bf16_f32 v81, v130, v131
    v_cvt_pk_bf16_f32 v82, v132, v133
    v_cvt_pk_bf16_f32 v83, v134, v135
    v_cvt_pk_bf16_f32 v84, v136, v137
    v_cvt_pk_bf16_f32 v85, v138, v139
    v_cvt_pk_bf16_f32 v86, v140, v141
    v_cvt_pk_bf16_f32 v87, v142, v143
    v_cvt_pk_bf16_f32 v88, v144, v145
    v_cvt_pk_bf16_f32 v89, v146, v147
    v_cvt_pk_bf16_f32 v90, v148, v149
    v_cvt_pk_bf16_f32 v91, v150, v151
    v_cvt_pk_bf16_f32 v92, v152, v153
    v_cvt_pk_bf16_f32 v93, v154, v155
    v_cvt_pk_bf16_f32 v94, v156, v157
    s_add_u32 s36, s59, 32768
    s_add_u32 s37, s59, s48
    s_mov_b32 m0, s37
    s_nop 0
    buffer_load_dwordx4 v16, s[12:15], s36 offen offset:0 sc1 lds
    v_cvt_pk_bf16_f32 v95, v158, v159
    v_cvt_pk_bf16_f32 v96, v160, v161
    v_cvt_pk_bf16_f32 v97, v162, v163
    v_cvt_pk_bf16_f32 v98, v164, v165
    v_cvt_pk_bf16_f32 v99, v166, v167
    v_cvt_pk_bf16_f32 v100, v168, v169
    v_cvt_pk_bf16_f32 v101, v170, v171
    v_cvt_pk_bf16_f32 v102, v172, v173
    v_cvt_pk_bf16_f32 v103, v174, v175
    v_cvt_pk_bf16_f32 v104, v176, v177
    v_cvt_pk_bf16_f32 v105, v178, v179
    v_cvt_pk_bf16_f32 v106, v180, v181
    v_cvt_pk_bf16_f32 v107, v182, v183
    v_cvt_pk_bf16_f32 v108, v184, v185
    v_cvt_pk_bf16_f32 v109, v186, v187
    buffer_load_dwordx4 v16, s[12:15], s36 offen offset:1024 sc1 lds
    v_cvt_pk_bf16_f32 v110, v188, v189
    v_cvt_pk_bf16_f32 v111, v190, v191
    v_cvt_pk_bf16_f32 v112, v192, v193
    v_cvt_pk_bf16_f32 v113, v194, v195
    v_cvt_pk_bf16_f32 v114, v196, v197
    v_cvt_pk_bf16_f32 v115, v198, v199
    v_cvt_pk_bf16_f32 v116, v200, v201
    v_cvt_pk_bf16_f32 v117, v202, v203
    v_cvt_pk_bf16_f32 v118, v204, v205
    v_cvt_pk_bf16_f32 v119, v206, v207
    v_cvt_pk_bf16_f32 v120, v208, v209
    v_cvt_pk_bf16_f32 v121, v210, v211
gated_mix__ssm_conv_h3__compressed_kv_cla__prompt_kernel_pad8:
    s_cbranch_execz gated_mix__ssm_conv_h3__compressed_kv_cla__prompt_kernel_pad12
    v_cvt_pk_bf16_f32 v122, v212, v213
    v_cvt_pk_bf16_f32 v123, v214, v215
    v_cvt_pk_bf16_f32 v124, v216, v217
    buffer_load_dwordx4 v16, s[12:15], s36 offen offset:2048 sc1 lds
    v_cvt_pk_bf16_f32 v125, v218, v219
    v_cvt_pk_bf16_f32 v126, v220, v221
    v_cvt_pk_bf16_f32 v127, v222, v223
    v_cvt_pk_bf16_f32 v128, v224, v225
    v_cvt_pk_bf16_f32 v129, v226, v227
    v_cvt_pk_bf16_f32 v130, v228, v229
    v_cvt_pk_bf16_f32 v131, v230, v231
    v_cvt_pk_bf16_f32 v132, v232, v233
    v_cvt_pk_bf16_f32 v133, v234, v235
    v_cvt_pk_bf16_f32 v134, v236, v237
    v_cvt_pk_bf16_f32 v135, v238, v239
    v_cvt_pk_bf16_f32 v136, v240, v241
    v_cvt_pk_bf16_f32 v137, v242, v243
    v_cvt_pk_bf16_f32 v138, v244, v245
    v_cvt_pk_bf16_f32 v139, v246, v247
    buffer_load_dwordx4 v16, s[12:15], s36 offen offset:3072 sc1 lds
    v_cvt_pk_bf16_f32 v140, v248, v249
    v_cvt_pk_bf16_f32 v141, v250, v251
    v_cvt_pk_bf16_f32 v142, v252, v253
    v_cvt_pk_bf16_f32 v143, v254, v255
    s_waitcnt vmcnt(4)
    s_barrier
    ds_read_b128 a[128:131], v2 offset:0
    ds_read_b128 a[132:135], v2 offset:1024
    ds_read_b128 a[136:139], v2 offset:2048
    ds_read_b128 a[140:143], v2 offset:3072
    ds_read_b128 a[144:147], v2 offset:4096
    ds_read_b128 a[148:151], v2 offset:5120
    ds_read_b128 a[152:155], v2 offset:6144
    ds_read_b128 a[156:159], v2 offset:7168
    v_mov_b32 v240, 0
    v_mov_b32 v241, 0
    v_mov_b32 v242, 0
    s_add_u32 s36, s59, 49152
    s_add_u32 s37, s59, s48
    s_add_u32 m0, s37, 16384
    s_nop 0
    buffer_load_dwordx4 v16, s[12:15], s36 offen offset:0 sc1 lds
    v_mov_b32 v243, 0
    v_mov_b32 v244, 0
    v_mov_b32 v245, 0
    v_mov_b32 v246, 0
    v_mov_b32 v247, 0
    v_mov_b32 v248, 0
    v_mov_b32 v249, 0
    v_mov_b32 v250, 0
    v_mov_b32 v251, 0
    v_mov_b32 v252, 0
    v_mov_b32 v253, 0
    v_mov_b32 v254, 0
    v_mov_b32 v255, 0
    s_waitcnt lgkmcnt(7)
    v_mfma_f32_16x16x32_bf16 v[144:147], a[128:131], v[80:83], 0
    buffer_load_dwordx4 v16, s[12:15], s36 offen offset:1024 sc1 lds
    v_mfma_f32_16x16x32_bf16 v[152:155], a[128:131], v[96:99], 0
    v_mfma_f32_16x16x32_bf16 v[160:163], a[128:131], v[112:115], 0
    v_mfma_f32_16x16x32_bf16 v[168:171], a[128:131], v[128:131], 0
    s_waitcnt lgkmcnt(6)
    v_mfma_f32_16x16x32_bf16 v[144:147], a[132:135], v[84:87], v[144:147]
    buffer_load_dwordx4 v16, s[12:15], s36 offen offset:2048 sc1 lds
    v_mfma_f32_16x16x32_bf16 v[152:155], a[132:135], v[100:103], v[152:155]
    v_mfma_f32_16x16x32_bf16 v[160:163], a[132:135], v[116:119], v[160:163]
    v_mfma_f32_16x16x32_bf16 v[168:171], a[132:135], v[132:135], v[168:171]
    s_waitcnt lgkmcnt(5)
    v_mfma_f32_16x16x32_bf16 v[144:147], a[136:139], v[88:91], v[144:147]
    buffer_load_dwordx4 v16, s[12:15], s36 offen offset:3072 sc1 lds
    v_mfma_f32_16x16x32_bf16 v[152:155], a[136:139], v[104:107], v[152:155]
    v_mfma_f32_16x16x32_bf16 v[160:163], a[136:139], v[120:123], v[160:163]
    v_mfma_f32_16x16x32_bf16 v[168:171], a[136:139], v[136:139], v[168:171]
    s_waitcnt lgkmcnt(4)
    v_mfma_f32_16x16x32_bf16 v[144:147], a[140:143], v[92:95], v[144:147]
    s_add_u32 s36, s59, 65536
    s_add_u32 s37, s59, s51
    s_mov_b32 m0, s37
    s_nop 0
    buffer_load_dwordx4 v16, s[12:15], s36 offen offset:0 sc1 lds
    v_mfma_f32_16x16x32_bf16 v[152:155], a[140:143], v[108:111], v[152:155]
    v_mfma_f32_16x16x32_bf16 v[160:163], a[140:143], v[124:127], v[160:163]
    v_mfma_f32_16x16x32_bf16 v[168:171], a[140:143], v[140:143], v[168:171]
    s_waitcnt lgkmcnt(3)
    v_mfma_f32_16x16x32_bf16 v[148:151], a[144:147], v[80:83], 0
    buffer_load_dwordx4 v16, s[12:15], s36 offen offset:1024 sc1 lds
    v_mfma_f32_16x16x32_bf16 v[156:159], a[144:147], v[96:99], 0
    v_mfma_f32_16x16x32_bf16 v[164:167], a[144:147], v[112:115], 0
    v_mfma_f32_16x16x32_bf16 v[172:175], a[144:147], v[128:131], 0
    s_waitcnt lgkmcnt(2)
    v_mfma_f32_16x16x32_bf16 v[148:151], a[148:151], v[84:87], v[148:151]
    buffer_load_dwordx4 v16, s[12:15], s36 offen offset:2048 sc1 lds
    v_mfma_f32_16x16x32_bf16 v[156:159], a[148:151], v[100:103], v[156:159]
    v_mfma_f32_16x16x32_bf16 v[164:167], a[148:151], v[116:119], v[164:167]
    v_mfma_f32_16x16x32_bf16 v[172:175], a[148:151], v[132:135], v[172:175]
    s_waitcnt lgkmcnt(1)
    v_mfma_f32_16x16x32_bf16 v[148:151], a[152:155], v[88:91], v[148:151]
    buffer_load_dwordx4 v16, s[12:15], s36 offen offset:3072 sc1 lds
    v_mfma_f32_16x16x32_bf16 v[156:159], a[152:155], v[104:107], v[156:159]
    v_mfma_f32_16x16x32_bf16 v[164:167], a[152:155], v[120:123], v[164:167]
    v_mfma_f32_16x16x32_bf16 v[172:175], a[152:155], v[136:139], v[172:175]
    s_waitcnt lgkmcnt(0)
    v_mfma_f32_16x16x32_bf16 v[148:151], a[156:159], v[92:95], v[148:151]
    s_add_u32 s36, s59, 81920
    s_add_u32 s37, s59, s51
    s_add_u32 m0, s37, 16384
    s_nop 0
    buffer_load_dwordx4 v16, s[12:15], s36 offen offset:0 sc1 lds
    v_mfma_f32_16x16x32_bf16 v[156:159], a[156:159], v[108:111], v[156:159]
    v_mfma_f32_16x16x32_bf16 v[164:167], a[156:159], v[124:127], v[164:167]
    v_mfma_f32_16x16x32_bf16 v[172:175], a[156:159], v[140:143], v[172:175]
    ds_read_b128 a[128:131], v2 offset:16384
    ds_read_b128 a[132:135], v2 offset:17408
    ds_read_b128 a[136:139], v2 offset:18432
    ds_read_b128 a[140:143], v2 offset:19456
    ds_read_b128 a[144:147], v2 offset:20480
    ds_read_b128 a[148:151], v2 offset:21504
    ds_read_b128 a[152:155], v2 offset:22528
    ds_read_b128 a[156:159], v2 offset:23552
    ds_read_b128 a[160:163], v2 offset:8192
    ds_read_b128 a[164:167], v2 offset:9216
    ds_read_b128 a[168:171], v2 offset:10240
    ds_read_b128 a[172:175], v2 offset:11264
    s_cmp_lg_u32 s34, 0
    s_cbranch_scc1 gated_mix__ssm_conv_h3__compressed_kv_cla__prompt_kernel_nomask0
    v_add_f32 v144, v48, v144
    v_add_f32 v145, v49, v145
    v_add_f32 v146, v50, v146
    v_add_f32 v147, v51, v147
    v_add_f32 v148, v52, v148
    v_add_f32 v149, v53, v149
    v_add_f32 v150, v54, v150
    v_add_f32 v151, v55, v151
gated_mix__ssm_conv_h3__compressed_kv_cla__prompt_kernel_nomask0:
    v_max3_f32 v32, v144, v145, v146
    v_max3_f32 v32, v147, v148, v32
    v_max3_f32 v32, v149, v150, v32
    buffer_load_dwordx4 v16, s[12:15], s36 offen offset:1024 sc1 lds
    v_max_f32 v32, v151, v32
    v_max3_f32 v34, v152, v153, v154
    v_max3_f32 v34, v155, v156, v34
    v_max3_f32 v34, v157, v158, v34
    v_max_f32 v34, v159, v34
    v_max3_f32 v36, v160, v161, v162
    v_max3_f32 v36, v163, v164, v36
    v_max3_f32 v36, v165, v166, v36
    v_max_f32 v36, v167, v36
    v_max3_f32 v38, v168, v169, v170
    v_max3_f32 v38, v171, v172, v38
    v_max3_f32 v38, v173, v174, v38
    v_max_f32 v38, v175, v38
    v_mov_b32 v33, v32
    v_mov_b32 v35, v34
    buffer_load_dwordx4 v16, s[12:15], s36 offen offset:2048 sc1 lds
    v_mov_b32 v37, v36
    v_mov_b32 v39, v38
    v_permlane16_swap_b32 v32, v33
    v_permlane16_swap_b32 v34, v35
    v_permlane16_swap_b32 v36, v37
    v_permlane16_swap_b32 v38, v39
    v_max_f32 v32, v32, v33
    v_max_f32 v34, v34, v35
    v_max_f32 v36, v36, v37
    v_max_f32 v38, v38, v39
    v_mov_b32 v33, v32
    v_mov_b32 v35, v34
    v_mov_b32 v37, v36
    v_mov_b32 v39, v38
    v_permlane32_swap_b32 v32, v33
    buffer_load_dwordx4 v16, s[12:15], s36 offen offset:3072 sc1 lds
    v_permlane32_swap_b32 v34, v35
    v_permlane32_swap_b32 v36, v37
    v_permlane32_swap_b32 v38, v39
    v_max_f32 v32, v32, v33
    v_max_f32 v34, v34, v35
    v_max_f32 v36, v36, v37
    v_max_f32 v38, v38, v39
    v_add_f32 v32, 0x41c00000, v32
    v_sub_f32 v64, 0, v32
    v_sub_f32 v65, 0, v32
    v_sub_f32 v66, 0, v32
    v_sub_f32 v67, 0, v32
    v_sub_f32 v144, v144, v32
    v_sub_f32 v145, v145, v32
    v_sub_f32 v146, v146, v32
    s_add_u32 s36, s59, 98304
    s_add_u32 s37, s59, s52
    s_mov_b32 m0, s37
    s_nop 0
    buffer_load_dwordx4 v16, s[12:15], s36 offen offset:0 sc1 lds
    v_sub_f32 v147, v147, v32
    v_sub_f32 v148, v148, v32
    v_sub_f32 v149, v149, v32
    v_sub_f32 v150, v150, v32
    v_sub_f32 v151, v151, v32
    v_add_f32 v34, 0x41c00000, v34
    v_sub_f32 v68, 0, v34
    v_sub_f32 v69, 0, v34
    v_sub_f32 v70, 0, v34
    v_sub_f32 v71, 0, v34
    v_sub_f32 v152, v152, v34
    v_sub_f32 v153, v153, v34
    v_sub_f32 v154, v154, v34
    v_sub_f32 v155, v155, v34
    v_sub_f32 v156, v156, v34
    buffer_load_dwordx4 v16, s[12:15], s36 offen offset:1024 sc1 lds
    v_sub_f32 v157, v157, v34
    v_sub_f32 v158, v158, v34
    v_sub_f32 v159, v159, v34
    v_add_f32 v36, 0x41c00000, v36
    v_sub_f32 v72, 0, v36
    v_sub_f32 v73, 0, v36
    v_sub_f32 v74, 0, v36
    v_sub_f32 v75, 0, v36
    v_sub_f32 v160, v160, v36
    v_sub_f32 v161, v161, v36
    v_sub_f32 v162, v162, v36
    v_sub_f32 v163, v163, v36
    v_sub_f32 v164, v164, v36
    v_sub_f32 v165, v165, v36
    v_sub_f32 v166, v166, v36
    buffer_load_dwordx4 v16, s[12:15], s36 offen offset:2048 sc1 lds
    v_sub_f32 v167, v167, v36
    v_add_f32 v38, 0x41c00000, v38
    v_sub_f32 v76, 0, v38
    v_sub_f32 v77, 0, v38
    v_sub_f32 v78, 0, v38
    v_sub_f32 v79, 0, v38
    v_sub_f32 v168, v168, v38
    v_sub_f32 v169, v169, v38
    v_sub_f32 v170, v170, v38
    v_sub_f32 v171, v171, v38
    v_sub_f32 v172, v172, v38
    v_sub_f32 v173, v173, v38
    v_sub_f32 v174, v174, v38
    v_sub_f32 v175, v175, v38
    v_exp_f32 v4, v168
    v_exp_f32 v5, v169
    s_nop 0
    v_cvt_pk_bf16_f32 v220, v4, v5
    buffer_load_dwordx4 v16, s[12:15], s36 offen offset:3072 sc1 lds
    v_exp_f32 v6, v170
    v_exp_f32 v7, v171
    s_nop 0
    v_cvt_pk_bf16_f32 v221, v6, v7
    v_or_b32 v12, v220, v221
    v_exp_f32 v8, v172
    v_exp_f32 v9, v173
    s_nop 0
    v_cvt_pk_bf16_f32 v222, v8, v9
    v_exp_f32 v10, v174
    v_exp_f32 v11, v175
    s_nop 0
    v_cvt_pk_bf16_f32 v223, v10, v11
    s_add_u32 s36, s59, 114688
    s_add_u32 s37, s59, s52
    s_add_u32 m0, s37, 16384
    s_nop 0
    buffer_load_dwordx4 v16, s[12:15], s36 offen offset:0 sc1 lds
    v_or3_b32 v12, v12, v222, v223
    v_exp_f32 v4, v160
    v_exp_f32 v5, v161
    s_nop 0
    v_cvt_pk_bf16_f32 v216, v4, v5
    v_exp_f32 v6, v162
    v_exp_f32 v7, v163
    s_nop 0
    v_cvt_pk_bf16_f32 v217, v6, v7
    v_or3_b32 v12, v12, v216, v217
    v_exp_f32 v8, v164
    v_exp_f32 v9, v165
    s_nop 0
    v_cvt_pk_bf16_f32 v218, v8, v9
    buffer_load_dwordx4 v16, s[12:15], s36 offen offset:1024 sc1 lds
    v_exp_f32 v10, v166
    v_exp_f32 v11, v167
    s_nop 0
    v_cvt_pk_bf16_f32 v219, v10, v11
    v_or3_b32 v12, v12, v218, v219
    buffer_load_dwordx4 v16, s[12:15], s36 offen offset:2048 sc1 lds
    buffer_load_dwordx4 v16, s[12:15], s36 offen offset:3072 sc1 lds
    s_movk_i32 s47, 12288
    buffer_load_dwordx4 v[28:31], v16, s[28:31], s47 offen sc1
    buffer_load_dword a200, v15, s[4:7], s54 offen
    s_mov_b32 s48, 0
    v_add_u32 v2, s45, v16
    s_waitcnt vmcnt(18) lgkmcnt(0)
    s_barrier
    s_lshl_b32 s35, s34, 1
    s_add_u32 s35, s35, 1
    s_min_u32 s58, s35, 14
    s_cmp_eq_u32 s34, 7
    s_cselect_b32 s58, s58, s35
    s_nop 0
    s_nop 0
    s_nop 0
    s_nop 0
    s_nop 0
    s_nop 0
    s_nop 0
    s_nop 0
gated_mix__ssm_conv_h3__compressed_kv_cla__prompt_kernel_b4_loop:
    v_mfma_f32_16x16x32_bf16 v[176:179], a[128:131], v[80:83], v[64:67]
    s_cmp_eq_u32 s35, 1
    v_exp_f32 v4, v152
    v_mfma_f32_16x16x32_bf16 v[184:187], a[128:131], v[96:99], v[68:71]
    s_cbranch_scc1 gated_mix__ssm_conv_h3__compressed_kv_cla__prompt_kernel_b4_m0
gated_mix__ssm_conv_h3__compressed_kv_cla__prompt_kernel_b4_m0_ret:
    ds_read_b128 a[176:179], v3 offset:12288
    ds_read_b128 a[180:183], v3 offset:13312
    v_mfma_f32_16x16x32_bf16 v[192:195], a[128:131], v[112:115], v[72:75]
    s_waitcnt vmcnt(18)
    v_exp_f32 v5, v153
    v_mfma_f32_16x16x32_bf16 v[200:203], a[128:131], v[128:131], v[76:79]
    s_barrier
    ds_read_b128 a[184:187], v3 offset:14336
    v_mfma_f32_16x16x32_bf16 v[176:179], a[132:135], v[84:87], v[176:179]
    s_mov_b32 m0, s40
    v_exp_f32 v6, v154
    v_mfma_f32_16x16x32_bf16 v[184:187], a[132:135], v[100:103], v[184:187]
    s_add_u32 s43, s38, s49
    v_exp_f32 v7, v155
    v_mfma_f32_16x16x32_bf16 v[192:195], a[132:135], v[116:119], v[192:195]
    ds_read_b128 a[188:191], v3 offset:15360
    v_cvt_pk_bf16_f32 v212, v4, v5
    v_mfma_f32_16x16x32_bf16 v[200:203], a[132:135], v[132:135], v[200:203]
    ds_read_b128 a[128:131], v2 offset:0
    v_cvt_pk_bf16_f32 v213, v6, v7
    v_mfma_f32_16x16x32_bf16 v[176:179], a[136:139], v[88:91], v[176:179]
    v_exp_f32 v8, v156
    v_mfma_f32_16x16x32_bf16 v[184:187], a[136:139], v[104:107], v[184:187]
    v_exp_f32 v9, v157
    v_mfma_f32_16x16x32_bf16 v[192:195], a[136:139], v[120:123], v[192:195]
    ds_read_b128 a[132:135], v2 offset:1024
    v_or3_b32 v12, v12, v212, v213
    v_mfma_f32_16x16x32_bf16 v[200:203], a[136:139], v[136:139], v[200:203]
    ds_read_b128 a[136:139], v2 offset:2048
    v_cvt_pk_bf16_f32 v214, v8, v9
    v_mfma_f32_16x16x32_bf16 v[176:179], a[140:143], v[92:95], v[176:179]
    v_exp_f32 v10, v158
    v_mfma_f32_16x16x32_bf16 v[184:187], a[140:143], v[108:111], v[184:187]
    v_exp_f32 v11, v159
    v_mfma_f32_16x16x32_bf16 v[192:195], a[140:143], v[124:127], v[192:195]
    v_exp_f32 v4, v144
    v_mfma_f32_16x16x32_bf16 v[200:203], a[140:143], v[140:143], v[200:203]
    s_waitcnt lgkmcnt(11)
    ds_read_b128 a[140:143], v2 offset:3072
    v_cvt_pk_bf16_f32 v215, v10, v11
    v_mfma_f32_16x16x32_bf16 v[180:183], a[144:147], v[80:83], v[64:67]
    v_exp_f32 v5, v145
    v_mfma_f32_16x16x32_bf16 v[188:191], a[144:147], v[96:99], v[68:71]
    v_exp_f32 v6, v146
    v_mfma_f32_16x16x32_bf16 v[196:199], a[144:147], v[112:115], v[72:75]
    v_exp_f32 v7, v147
    v_mfma_f32_16x16x32_bf16 v[204:207], a[144:147], v[128:131], v[76:79]
    ds_read_b128 a[144:147], v2 offset:4096
    v_or3_b32 v12, v12, v214, v215
    v_mfma_f32_16x16x32_bf16 v[180:183], a[148:151], v[84:87], v[180:183]
    buffer_load_dword a200, v19, s[8:11], s46 offen
    v_mfma_f32_16x16x32_bf16 v[188:191], a[148:151], v[100:103], v[188:191]
    v_exp_f32 v8, v148
    v_mfma_f32_16x16x32_bf16 v[196:199], a[148:151], v[116:119], v[196:199]
    v_exp_f32 v9, v149
    v_mfma_f32_16x16x32_bf16 v[204:207], a[148:151], v[132:135], v[204:207]
    ds_read_b128 a[148:151], v2 offset:5120
    v_cvt_pk_bf16_f32 v208, v4, v5
    v_mfma_f32_16x16x32_bf16 v[180:183], a[152:155], v[88:91], v[180:183]
    v_exp_f32 v10, v150
    v_mfma_f32_16x16x32_bf16 v[188:191], a[152:155], v[104:107], v[188:191]
    v_exp_f32 v11, v151
    v_mfma_f32_16x16x32_bf16 v[196:199], a[152:155], v[120:123], v[196:199]
    v_cvt_pk_bf16_f32 v209, v6, v7
    v_or3_b32 v12, v12, v208, v209
    v_mfma_f32_16x16x32_bf16 v[204:207], a[152:155], v[136:139], v[204:207]
    ds_read_b128 a[152:155], v2 offset:6144
    v_cvt_pk_bf16_f32 v210, v8, v9
    v_mfma_f32_16x16x32_bf16 v[180:183], a[156:159], v[92:95], v[180:183]
    v_cvt_pk_bf16_f32 v211, v10, v11
    v_or3_b32 v12, v12, v210, v211
    v_mfma_f32_16x16x32_bf16 v[188:191], a[156:159], v[108:111], v[188:191]
    v_and_b32 v12, s42, v12
    v_cmp_ne_u32 vcc, 0, v12
    v_mfma_f32_16x16x32_bf16 v[196:199], a[156:159], v[124:127], v[196:199]
    s_waitcnt lgkmcnt(11)
    v_mfma_f32_16x16x32_bf16 v[204:207], a[156:159], v[140:143], v[204:207]
    s_cbranch_vccnz gated_mix__ssm_conv_h3__compressed_kv_cla__prompt_kernel_b4_r0
gated_mix__ssm_conv_h3__compressed_kv_cla__prompt_kernel_b4_r0_ret:
    ds_read_b128 a[156:159], v2 offset:7168
    v_mfma_f32_16x16x32_bf16 a[0:3], a[160:163], v[208:211], a[0:3]
    v_mfma_f32_16x16x32_bf16 a[32:35], a[160:163], v[212:215], a[32:35]
    v_mfma_f32_16x16x32_bf16 a[64:67], a[160:163], v[216:219], a[64:67]
    buffer_load_dwordx4 v16, s[12:15], s38 offen offset:0 sc1 lds
    v_mfma_f32_16x16x32_bf16 a[96:99], a[160:163], v[220:223], a[96:99]
    s_cmp_eq_u32 s35, 1
    ds_read_b128 a[160:163], v3 offset:24576
    v_mfma_f32_16x16x32_bf16 a[4:7], a[164:167], v[208:211], a[4:7]
    s_cbranch_scc1 gated_mix__ssm_conv_h3__compressed_kv_cla__prompt_kernel_b4_m1
gated_mix__ssm_conv_h3__compressed_kv_cla__prompt_kernel_b4_m1_ret:
    v_mfma_f32_16x16x32_bf16 a[36:39], a[164:167], v[212:215], a[36:39]
    v_mfma_f32_16x16x32_bf16 a[68:71], a[164:167], v[216:219], a[68:71]
    v_mfma_f32_16x16x32_bf16 a[100:103], a[164:167], v[220:223], a[100:103]
    ds_read_b128 a[164:167], v3 offset:25600
    v_mfma_f32_16x16x32_bf16 a[8:11], a[168:171], v[208:211], a[8:11]
    v_mfma_f32_16x16x32_bf16 a[40:43], a[168:171], v[212:215], a[40:43]
    v_mfma_f32_16x16x32_bf16 a[72:75], a[168:171], v[216:219], a[72:75]
    v_exp_f32 v4, v200
    v_mfma_f32_16x16x32_bf16 a[104:107], a[168:171], v[220:223], a[104:107]
    ds_read_b128 a[168:171], v3 offset:26624
    v_mfma_f32_16x16x32_bf16 a[12:15], a[172:175], v[208:211], a[12:15]
    v_exp_f32 v5, v201
    v_mfma_f32_16x16x32_bf16 a[44:47], a[172:175], v[212:215], a[44:47]
    v_exp_f32 v6, v202
    v_mfma_f32_16x16x32_bf16 a[76:79], a[172:175], v[216:219], a[76:79]
    v_exp_f32 v7, v203
    v_mfma_f32_16x16x32_bf16 a[108:111], a[172:175], v[220:223], a[108:111]
    s_waitcnt lgkmcnt(11)
    ds_read_b128 a[172:175], v3 offset:27648
    v_cvt_pk_bf16_f32 v236, v4, v5
    v_mfma_f32_16x16x32_bf16 a[16:19], a[176:179], v[208:211], a[16:19]
    buffer_load_dwordx4 v16, s[12:15], s38 offen offset:1024 sc1 lds
    v_mfma_f32_16x16x32_bf16 a[48:51], a[176:179], v[212:215], a[48:51]
    v_exp_f32 v8, v204
    v_mfma_f32_16x16x32_bf16 a[80:83], a[176:179], v[216:219], a[80:83]
    v_exp_f32 v9, v205
    v_mfma_f32_16x16x32_bf16 a[112:115], a[176:179], v[220:223], a[112:115]
    ds_read_b128 a[176:179], v3 offset:28672
    v_cvt_pk_bf16_f32 v237, v6, v7
    v_mfma_f32_16x16x32_bf16 a[20:23], a[180:183], v[208:211], a[20:23]
    v_exp_f32 v10, v206
    v_mfma_f32_16x16x32_bf16 a[52:55], a[180:183], v[212:215], a[52:55]
    v_exp_f32 v11, v207
    v_mfma_f32_16x16x32_bf16 a[84:87], a[180:183], v[216:219], a[84:87]
    v_exp_f32 v4, v192
    v_mfma_f32_16x16x32_bf16 a[116:119], a[180:183], v[220:223], a[116:119]
    ds_read_b128 a[180:183], v3 offset:29696
    v_or_b32 v12, v236, v237
    v_mfma_f32_16x16x32_bf16 a[24:27], a[184:187], v[208:211], a[24:27]
    v_exp_f32 v5, v193
    v_mfma_f32_16x16x32_bf16 a[56:59], a[184:187], v[212:215], a[56:59]
    v_exp_f32 v6, v194
    v_mfma_f32_16x16x32_bf16 a[88:91], a[184:187], v[216:219], a[88:91]
    v_exp_f32 v7, v195
    v_mfma_f32_16x16x32_bf16 a[120:123], a[184:187], v[220:223], a[120:123]
    ds_read_b128 a[184:187], v3 offset:30720
    v_cvt_pk_bf16_f32 v238, v8, v9
    v_mfma_f32_16x16x32_bf16 a[28:31], a[188:191], v[208:211], a[28:31]
    v_exp_f32 v8, v196
    v_mfma_f32_16x16x32_bf16 a[60:63], a[188:191], v[212:215], a[60:63]
    v_exp_f32 v9, v197
    v_mfma_f32_16x16x32_bf16 a[92:95], a[188:191], v[216:219], a[92:95]
    buffer_load_dwordx4 v16, s[12:15], s38 offen offset:2048 sc1 lds
    v_mfma_f32_16x16x32_bf16 a[124:127], a[188:191], v[220:223], a[124:127]
    ds_read_b128 a[188:191], v3 offset:31744
    v_cvt_pk_bf16_f32 v239, v10, v11
    v_mfma_f32_16x16x32_bf16 v[240:243], v[24:27], v[208:211], v[240:243]
    v_exp_f32 v10, v198
    v_mfma_f32_16x16x32_bf16 v[244:247], v[24:27], v[212:215], v[244:247]
    v_exp_f32 v11, v199
    v_mfma_f32_16x16x32_bf16 v[248:251], v[24:27], v[216:219], v[248:251]
    v_or3_b32 v12, v12, v238, v239
    v_cvt_pk_bf16_f32 v232, v4, v5
    v_mfma_f32_16x16x32_bf16 v[252:255], v[24:27], v[220:223], v[252:255]
    s_waitcnt lgkmcnt(12)
    v_exp_f32 v4, v184
    v_mfma_f32_16x16x32_bf16 v[144:147], a[128:131], v[80:83], v[64:67]
    v_exp_f32 v5, v185
    v_mfma_f32_16x16x32_bf16 v[152:155], a[128:131], v[96:99], v[68:71]
    v_cvt_pk_bf16_f32 v233, v6, v7
    v_or3_b32 v12, v12, v232, v233
    v_mfma_f32_16x16x32_bf16 v[160:163], a[128:131], v[112:115], v[72:75]
    v_exp_f32 v6, v186
    v_mfma_f32_16x16x32_bf16 v[168:171], a[128:131], v[128:131], v[76:79]
    ds_read_b128 a[128:131], v2 offset:16384
    v_cvt_pk_bf16_f32 v234, v8, v9
    v_mfma_f32_16x16x32_bf16 v[144:147], a[132:135], v[84:87], v[144:147]
    v_exp_f32 v7, v187
    v_mfma_f32_16x16x32_bf16 v[152:155], a[132:135], v[100:103], v[152:155]
    v_exp_f32 v8, v188
    v_mfma_f32_16x16x32_bf16 v[160:163], a[132:135], v[116:119], v[160:163]
    v_exp_f32 v9, v189
    v_mfma_f32_16x16x32_bf16 v[168:171], a[132:135], v[132:135], v[168:171]
    ds_read_b128 a[132:135], v2 offset:17408
    v_cvt_pk_bf16_f32 v235, v10, v11
    v_mfma_f32_16x16x32_bf16 v[144:147], a[136:139], v[88:91], v[144:147]
    v_exp_f32 v10, v190
    v_mfma_f32_16x16x32_bf16 v[152:155], a[136:139], v[104:107], v[152:155]
    buffer_load_dwordx4 v16, s[12:15], s38 offen offset:3072 sc1 lds
    v_mfma_f32_16x16x32_bf16 v[160:163], a[136:139], v[120:123], v[160:163]
    s_mov_b32 m0, s41
    v_exp_f32 v11, v191
    v_mfma_f32_16x16x32_bf16 v[168:171], a[136:139], v[136:139], v[168:171]
    ds_read_b128 a[136:139], v2 offset:18432
    v_or3_b32 v12, v12, v234, v235
    v_mfma_f32_16x16x32_bf16 v[144:147], a[140:143], v[92:95], v[144:147]
    v_cvt_pk_bf16_f32 v228, v4, v5
    v_cvt_pk_bf16_f32 v229, v6, v7
    v_mfma_f32_16x16x32_bf16 v[152:155], a[140:143], v[108:111], v[152:155]
    v_exp_f32 v4, v176
    v_mfma_f32_16x16x32_bf16 v[160:163], a[140:143], v[124:127], v[160:163]
    v_exp_f32 v5, v177
    v_mfma_f32_16x16x32_bf16 v[168:171], a[140:143], v[140:143], v[168:171]
    s_waitcnt lgkmcnt(11)
    ds_read_b128 a[140:143], v2 offset:19456
    v_or3_b32 v12, v12, v228, v229
    v_mfma_f32_16x16x32_bf16 v[148:151], a[144:147], v[80:83], v[64:67]
    v_exp_f32 v6, v178
    v_mfma_f32_16x16x32_bf16 v[156:159], a[144:147], v[96:99], v[68:71]
    v_exp_f32 v7, v179
    v_mfma_f32_16x16x32_bf16 v[164:167], a[144:147], v[112:115], v[72:75]
    v_cvt_pk_bf16_f32 v230, v8, v9
    v_cvt_pk_bf16_f32 v231, v10, v11
    v_mfma_f32_16x16x32_bf16 v[172:175], a[144:147], v[128:131], v[76:79]
    ds_read_b128 a[144:147], v2 offset:20480
    v_or3_b32 v12, v12, v230, v231
    v_mfma_f32_16x16x32_bf16 v[148:151], a[148:151], v[84:87], v[148:151]
    v_exp_f32 v8, v180
    v_mfma_f32_16x16x32_bf16 v[156:159], a[148:151], v[100:103], v[156:159]
    v_exp_f32 v9, v181
    v_mfma_f32_16x16x32_bf16 v[164:167], a[148:151], v[116:119], v[164:167]
    buffer_load_dwordx4 v16, s[12:15], s43 offen offset:0 sc1 lds
    v_mfma_f32_16x16x32_bf16 v[172:175], a[148:151], v[132:135], v[172:175]
    ds_read_b128 a[148:151], v2 offset:21504
    v_cvt_pk_bf16_f32 v224, v4, v5
    v_mfma_f32_16x16x32_bf16 v[148:151], a[152:155], v[88:91], v[148:151]
    v_exp_f32 v10, v182
    v_mfma_f32_16x16x32_bf16 v[156:159], a[152:155], v[104:107], v[156:159]
    v_exp_f32 v11, v183
    v_mfma_f32_16x16x32_bf16 v[164:167], a[152:155], v[120:123], v[164:167]
    v_cvt_pk_bf16_f32 v225, v6, v7
    v_or3_b32 v12, v12, v224, v225
    v_mfma_f32_16x16x32_bf16 v[172:175], a[152:155], v[136:139], v[172:175]
    ds_read_b128 a[152:155], v2 offset:22528
    v_cvt_pk_bf16_f32 v226, v8, v9
    v_mfma_f32_16x16x32_bf16 v[148:151], a[156:159], v[92:95], v[148:151]
    v_cvt_pk_bf16_f32 v227, v10, v11
    v_or3_b32 v12, v12, v226, v227
    v_mfma_f32_16x16x32_bf16 v[156:159], a[156:159], v[108:111], v[156:159]
    v_and_b32 v12, s42, v12
    v_cmp_ne_u32 vcc, 0, v12
    v_mfma_f32_16x16x32_bf16 v[164:167], a[156:159], v[124:127], v[164:167]
    s_waitcnt lgkmcnt(11)
    v_mfma_f32_16x16x32_bf16 v[172:175], a[156:159], v[140:143], v[172:175]
    s_cbranch_vccnz gated_mix__ssm_conv_h3__compressed_kv_cla__prompt_kernel_b4_r1
gated_mix__ssm_conv_h3__compressed_kv_cla__prompt_kernel_b4_r1_ret:
    ds_read_b128 a[156:159], v2 offset:23552
    v_mfma_f32_16x16x32_bf16 a[0:3], a[160:163], v[224:227], a[0:3]
    v_mfma_f32_16x16x32_bf16 a[32:35], a[160:163], v[228:231], a[32:35]
    s_add_u32 s38, s38, s44
    v_mfma_f32_16x16x32_bf16 a[64:67], a[160:163], v[232:235], a[64:67]
    s_add_u32 s40, s39, s59
    v_mfma_f32_16x16x32_bf16 a[96:99], a[160:163], v[236:239], a[96:99]
    s_add_u32 s41, s40, s50
    ds_read_b128 a[160:163], v2 offset:8192
    v_mfma_f32_16x16x32_bf16 a[4:7], a[164:167], v[224:227], a[4:7]
    s_mov_b32 s39, s45
    v_mfma_f32_16x16x32_bf16 a[36:39], a[164:167], v[228:231], a[36:39]
    buffer_load_dwordx4 v16, s[12:15], s43 offen offset:1024 sc1 lds
    v_mfma_f32_16x16x32_bf16 a[68:71], a[164:167], v[232:235], a[68:71]
    s_add_u32 s59, s59, s48
    v_mfma_f32_16x16x32_bf16 a[100:103], a[164:167], v[236:239], a[100:103]
    s_add_u32 s45, s45, 32768
    ds_read_b128 a[164:167], v2 offset:9216
    v_mfma_f32_16x16x32_bf16 a[8:11], a[168:171], v[224:227], a[8:11]
    s_cmp_eq_u32 s45, 163840
    v_mfma_f32_16x16x32_bf16 a[40:43], a[168:171], v[228:231], a[40:43]
    s_cselect_b32 s45, 0, s45
    v_exp_f32 v4, v168
    v_mfma_f32_16x16x32_bf16 a[72:75], a[168:171], v[232:235], a[72:75]
    s_add_u32 s46, s46, 1048576
    v_exp_f32 v5, v169
    v_mfma_f32_16x16x32_bf16 a[104:107], a[168:171], v[236:239], a[104:107]
    s_sub_u32 s35, s35, 1
    ds_read_b128 a[168:171], v2 offset:10240
    v_mfma_f32_16x16x32_bf16 a[12:15], a[172:175], v[224:227], a[12:15]
    s_sub_u32 s58, s58, 1
    v_exp_f32 v6, v170
    v_mfma_f32_16x16x32_bf16 a[44:47], a[172:175], v[228:231], a[44:47]
    s_cmp_lg_u32 s58, 0
    v_exp_f32 v7, v171
    v_mfma_f32_16x16x32_bf16 a[76:79], a[172:175], v[232:235], a[76:79]
    v_exp_f32 v8, v172
    v_mfma_f32_16x16x32_bf16 a[108:111], a[172:175], v[236:239], a[108:111]
    s_waitcnt lgkmcnt(11)
    ds_read_b128 a[172:175], v2 offset:11264
    v_mfma_f32_16x16x32_bf16 a[16:19], a[176:179], v[224:227], a[16:19]
    v_exp_f32 v9, v173
    v_mfma_f32_16x16x32_bf16 a[48:51], a[176:179], v[228:231], a[48:51]
    v_exp_f32 v10, v174
    v_mfma_f32_16x16x32_bf16 a[80:83], a[176:179], v[232:235], a[80:83]
    v_exp_f32 v11, v175
    v_mfma_f32_16x16x32_bf16 a[112:115], a[176:179], v[236:239], a[112:115]
    buffer_load_dwordx4 v16, s[12:15], s43 offen offset:2048 sc1 lds
    v_mfma_f32_16x16x32_bf16 a[20:23], a[180:183], v[224:227], a[20:23]
    v_cvt_pk_bf16_f32 v220, v4, v5
    v_cvt_pk_bf16_f32 v221, v6, v7
    v_mfma_f32_16x16x32_bf16 a[52:55], a[180:183], v[228:231], a[52:55]
    v_exp_f32 v4, v160
    v_mfma_f32_16x16x32_bf16 a[84:87], a[180:183], v[232:235], a[84:87]
    v_exp_f32 v5, v161
    v_mfma_f32_16x16x32_bf16 a[116:119], a[180:183], v[236:239], a[116:119]
    v_exp_f32 v6, v162
    v_mfma_f32_16x16x32_bf16 a[24:27], a[184:187], v[224:227], a[24:27]
    v_exp_f32 v7, v163
    v_mfma_f32_16x16x32_bf16 a[56:59], a[184:187], v[228:231], a[56:59]
    v_or_b32 v12, v220, v221
    v_cvt_pk_bf16_f32 v222, v8, v9
    v_mfma_f32_16x16x32_bf16 a[88:91], a[184:187], v[232:235], a[88:91]
    v_exp_f32 v8, v164
    v_mfma_f32_16x16x32_bf16 a[120:123], a[184:187], v[236:239], a[120:123]
    v_exp_f32 v9, v165
    v_mfma_f32_16x16x32_bf16 a[28:31], a[188:191], v[224:227], a[28:31]
    v_cvt_pk_bf16_f32 v223, v10, v11
    v_or3_b32 v12, v12, v222, v223
    v_mfma_f32_16x16x32_bf16 a[60:63], a[188:191], v[228:231], a[60:63]
    v_exp_f32 v10, v166
    v_mfma_f32_16x16x32_bf16 a[92:95], a[188:191], v[232:235], a[92:95]
    v_exp_f32 v11, v167
    v_mfma_f32_16x16x32_bf16 a[124:127], a[188:191], v[236:239], a[124:127]
    v_cvt_pk_bf16_f32 v216, v4, v5
    v_cvt_pk_bf16_f32 v217, v6, v7
    v_mfma_f32_16x16x32_bf16 v[240:243], v[24:27], v[224:227], v[240:243]
    v_or3_b32 v12, v12, v216, v217
    v_cvt_pk_bf16_f32 v218, v8, v9
    v_mfma_f32_16x16x32_bf16 v[244:247], v[24:27], v[228:231], v[244:247]
    v_cvt_pk_bf16_f32 v219, v10, v11
    v_or3_b32 v12, v12, v218, v219
    v_mfma_f32_16x16x32_bf16 v[248:251], v[24:27], v[232:235], v[248:251]
    buffer_load_dwordx4 v16, s[12:15], s43 offen offset:3072 sc1 lds
    v_mfma_f32_16x16x32_bf16 v[252:255], v[24:27], v[236:239], v[252:255]
    s_waitcnt lgkmcnt(8)
    v_mov_b32 v3, v2
    v_add_u32 v2, s45, v16
    s_cbranch_scc1 gated_mix__ssm_conv_h3__compressed_kv_cla__prompt_kernel_b4_loop
    s_cmp_lg_u32 s35, 0
    s_cbranch_scc1 gated_mix__ssm_conv_h3__compressed_kv_cla__prompt_kernel_b4_sw
    s_add_u32 s24, s94, 67108864
    s_addc_u32 s25, s95, 0
    s_mov_b32 s26, 16777216
    s_lshl_b32 s46, s2, 2
    s_add_u32 s46, s46, s32
    s_lshl_b32 s46, s46, 14
    s_add_u32 s46, s46, 8192
    s_nop 4
    v_accvgpr_read_b32 v36, a0
    v_accvgpr_read_b32 v37, a1
    v_accvgpr_read_b32 v38, a2
    v_accvgpr_read_b32 v39, a3
    v_accvgpr_read_b32 v40, a4
    v_accvgpr_read_b32 v41, a5
    v_accvgpr_read_b32 v42, a6
    v_accvgpr_read_b32 v43, a7
    v_rcp_f32 v32, v240
    s_nop 0
    v_mul_f32 v36, v36, v32
    v_mul_f32 v37, v37, v32
    v_mul_f32 v38, v38, v32
    v_mul_f32 v39, v39, v32
    v_mul_f32 v40, v40, v32
    v_mul_f32 v41, v41, v32
    v_mul_f32 v42, v42, v32
gated_mix__ssm_conv_h3__compressed_kv_cla__prompt_kernel_pad9:
    s_cbranch_execz gated_mix__ssm_conv_h3__compressed_kv_cla__prompt_kernel_pad13
    v_mul_f32 v43, v43, v32
    v_cvt_pk_bf16_f32 v44, v36, v37
    v_cvt_pk_bf16_f32 v45, v38, v39
    v_cvt_pk_bf16_f32 v46, v40, v41
    v_cvt_pk_bf16_f32 v47, v42, v43
    buffer_store_dwordx4 v[44:47], v16, s[16:19], s60 offen offset:0 sc1
    v_accvgpr_read_b32 v36, a8
    v_accvgpr_read_b32 v37, a9
    v_accvgpr_read_b32 v38, a10
    v_accvgpr_read_b32 v39, a11
    v_accvgpr_read_b32 v40, a12
    v_accvgpr_read_b32 v41, a13
    v_accvgpr_read_b32 v42, a14
    v_accvgpr_read_b32 v43, a15
    v_mul_f32 v36, v36, v32
    v_mul_f32 v37, v37, v32
    v_mul_f32 v38, v38, v32
    v_mul_f32 v39, v39, v32
    v_mul_f32 v40, v40, v32
    v_mul_f32 v41, v41, v32
    v_mul_f32 v42, v42, v32
    v_mul_f32 v43, v43, v32
    v_cvt_pk_bf16_f32 v20, v36, v37
    v_cvt_pk_bf16_f32 v21, v38, v39
    v_cvt_pk_bf16_f32 v22, v40, v41
    v_cvt_pk_bf16_f32 v23, v42, v43
    buffer_store_dwordx4 v[20:23], v16, s[16:19], s60 offen offset:1024 sc1
    v_accvgpr_read_b32 v36, a16
    v_accvgpr_read_b32 v37, a17
    v_accvgpr_read_b32 v38, a18
    v_accvgpr_read_b32 v39, a19
    v_accvgpr_read_b32 v40, a20
    v_accvgpr_read_b32 v41, a21
    v_accvgpr_read_b32 v42, a22
    v_accvgpr_read_b32 v43, a23
    v_mul_f32 v36, v36, v32
    v_mul_f32 v37, v37, v32
    v_mul_f32 v38, v38, v32
    v_mul_f32 v39, v39, v32
    v_mul_f32 v40, v40, v32
    v_mul_f32 v41, v41, v32
    v_mul_f32 v42, v42, v32
    v_mul_f32 v43, v43, v32
    v_cvt_pk_bf16_f32 v44, v36, v37
    v_cvt_pk_bf16_f32 v45, v38, v39
    v_cvt_pk_bf16_f32 v46, v40, v41
    v_cvt_pk_bf16_f32 v47, v42, v43
    buffer_store_dwordx4 v[44:47], v16, s[16:19], s60 offen offset:2048 sc1
    v_accvgpr_read_b32 v36, a24
    v_accvgpr_read_b32 v37, a25
    v_accvgpr_read_b32 v38, a26
    v_accvgpr_read_b32 v39, a27
    v_accvgpr_read_b32 v40, a28
    v_accvgpr_read_b32 v41, a29
    v_accvgpr_read_b32 v42, a30
    v_accvgpr_read_b32 v43, a31
    v_mul_f32 v36, v36, v32
    v_mul_f32 v37, v37, v32
    v_mul_f32 v38, v38, v32
    v_mul_f32 v39, v39, v32
    v_mul_f32 v40, v40, v32
    v_mul_f32 v41, v41, v32
    v_mul_f32 v42, v42, v32
    v_mul_f32 v43, v43, v32
    v_cvt_pk_bf16_f32 v20, v36, v37
    v_cvt_pk_bf16_f32 v21, v38, v39
    v_cvt_pk_bf16_f32 v22, v40, v41
    v_cvt_pk_bf16_f32 v23, v42, v43
    buffer_store_dwordx4 v[20:23], v16, s[16:19], s60 offen offset:3072 sc1
    v_mfma_f32_16x16x32_bf16 v[184:187], a[128:131], v[96:99], v[68:71]
    ds_read_b128 a[176:179], v3 offset:12288
    ds_read_b128 a[180:183], v3 offset:13312
    v_mfma_f32_16x16x32_bf16 v[192:195], a[128:131], v[112:115], v[72:75]
    v_mov_b32 v20, -1
    v_mov_b32 v21, -1
    v_mfma_f32_16x16x32_bf16 v[200:203], a[128:131], v[128:131], v[76:79]
    s_waitcnt vmcnt(16)
    ds_read_b128 a[184:187], v3 offset:14336
    v_mov_b32 v22, -1
    v_mfma_f32_16x16x32_bf16 v[184:187], a[132:135], v[100:103], v[184:187]
    s_barrier
    ds_read_b128 a[188:191], v3 offset:15360
    v_mov_b32 v23, -1
    v_mfma_f32_16x16x32_bf16 v[192:195], a[132:135], v[116:119], v[192:195]
    s_mov_b32 m0, s40
    v_add_f32 v152, v48, v152
    v_add_f32 v153, v49, v153
    v_mfma_f32_16x16x32_bf16 v[200:203], a[132:135], v[132:135], v[200:203]
    s_add_u32 s43, s38, s49
    v_add_f32 v154, v50, v154
    v_add_f32 v155, v51, v155
    v_mfma_f32_16x16x32_bf16 v[184:187], a[136:139], v[104:107], v[184:187]
    v_add_f32 v156, v52, v156
    v_add_f32 v157, v53, v157
    v_mfma_f32_16x16x32_bf16 v[192:195], a[136:139], v[120:123], v[192:195]
    v_add_f32 v158, v54, v158
    v_add_f32 v159, v55, v159
    v_mfma_f32_16x16x32_bf16 v[200:203], a[136:139], v[136:139], v[200:203]
    v_exp_f32 v4, v152
    v_mfma_f32_16x16x32_bf16 v[184:187], a[140:143], v[108:111], v[184:187]
    v_exp_f32 v5, v153
    v_mfma_f32_16x16x32_bf16 v[192:195], a[140:143], v[124:127], v[192:195]
    v_exp_f32 v6, v154
    v_mfma_f32_16x16x32_bf16 v[200:203], a[140:143], v[140:143], v[200:203]
    s_waitcnt lgkmcnt(8)
    v_exp_f32 v7, v155
    v_mfma_f32_16x16x32_bf16 v[188:191], a[144:147], v[96:99], v[68:71]
    v_exp_f32 v8, v156
    v_mfma_f32_16x16x32_bf16 v[196:199], a[144:147], v[112:115], v[72:75]
    buffer_store_dwordx4 v[20:23], v16, s[24:27], s46 offen offset:0 sc1
    v_mfma_f32_16x16x32_bf16 v[204:207], a[144:147], v[128:131], v[76:79]
    v_exp_f32 v9, v157
    v_mfma_f32_16x16x32_bf16 v[188:191], a[148:151], v[100:103], v[188:191]
    v_exp_f32 v10, v158
    v_mfma_f32_16x16x32_bf16 v[196:199], a[148:151], v[116:119], v[196:199]
    v_exp_f32 v11, v159
    v_mfma_f32_16x16x32_bf16 v[204:207], a[148:151], v[132:135], v[204:207]
    v_cvt_pk_bf16_f32 v212, v4, v5
    v_cvt_pk_bf16_f32 v213, v6, v7
    v_mfma_f32_16x16x32_bf16 v[188:191], a[152:155], v[104:107], v[188:191]
    v_or3_b32 v12, v12, v212, v213
    v_cvt_pk_bf16_f32 v214, v8, v9
    v_mfma_f32_16x16x32_bf16 v[196:199], a[152:155], v[120:123], v[196:199]
    v_cvt_pk_bf16_f32 v215, v10, v11
    v_or3_b32 v12, v12, v214, v215
    v_mfma_f32_16x16x32_bf16 v[204:207], a[152:155], v[136:139], v[204:207]
    v_and_b32 v12, s42, v12
    v_cmp_ne_u32 vcc, 0, v12
    v_mfma_f32_16x16x32_bf16 v[188:191], a[156:159], v[108:111], v[188:191]
    buffer_store_dwordx4 v[20:23], v16, s[24:27], s46 offen offset:1024 sc1
    v_mfma_f32_16x16x32_bf16 v[196:199], a[156:159], v[124:127], v[196:199]
    s_waitcnt lgkmcnt(4)
    ds_read_b128 a[128:131], v2 offset:0
    ds_read_b128 a[132:135], v2 offset:1024
    v_mfma_f32_16x16x32_bf16 v[204:207], a[156:159], v[140:143], v[204:207]
    s_cbranch_vccnz gated_mix__ssm_conv_h3__compressed_kv_cla__prompt_kernel_b3_r0
gated_mix__ssm_conv_h3__compressed_kv_cla__prompt_kernel_b3_r0_ret:
    ds_read_b128 a[136:139], v2 offset:2048
    ds_read_b128 a[140:143], v2 offset:3072
    v_mfma_f32_16x16x32_bf16 a[32:35], a[160:163], v[212:215], a[32:35]
    ds_read_b128 a[144:147], v2 offset:4096
    ds_read_b128 a[148:151], v2 offset:5120
    v_mfma_f32_16x16x32_bf16 a[64:67], a[160:163], v[216:219], a[64:67]
    ds_read_b128 a[152:155], v2 offset:6144
    ds_read_b128 a[156:159], v2 offset:7168
    v_mfma_f32_16x16x32_bf16 a[96:99], a[160:163], v[220:223], a[96:99]
    v_exp_f32 v4, v200
    v_mfma_f32_16x16x32_bf16 a[36:39], a[164:167], v[212:215], a[36:39]
    v_exp_f32 v5, v201
    v_mfma_f32_16x16x32_bf16 a[68:71], a[164:167], v[216:219], a[68:71]
    v_exp_f32 v6, v202
    v_mfma_f32_16x16x32_bf16 a[100:103], a[164:167], v[220:223], a[100:103]
    buffer_store_dwordx4 v[20:23], v16, s[24:27], s46 offen offset:2048 sc1
    v_mfma_f32_16x16x32_bf16 a[40:43], a[168:171], v[212:215], a[40:43]
    v_exp_f32 v7, v203
    v_mfma_f32_16x16x32_bf16 a[72:75], a[168:171], v[216:219], a[72:75]
    ds_read_b128 a[160:163], v3 offset:24576
    v_cvt_pk_bf16_f32 v236, v4, v5
    v_mfma_f32_16x16x32_bf16 a[104:107], a[168:171], v[220:223], a[104:107]
    v_exp_f32 v8, v204
    v_mfma_f32_16x16x32_bf16 a[44:47], a[172:175], v[212:215], a[44:47]
    v_exp_f32 v9, v205
    v_mfma_f32_16x16x32_bf16 a[76:79], a[172:175], v[216:219], a[76:79]
    ds_read_b128 a[164:167], v3 offset:25600
    v_cvt_pk_bf16_f32 v237, v6, v7
    v_mfma_f32_16x16x32_bf16 a[108:111], a[172:175], v[220:223], a[108:111]
    s_waitcnt lgkmcnt(10)
    ds_read_b128 a[168:171], v3 offset:26624
    v_or_b32 v12, v236, v237
    v_mfma_f32_16x16x32_bf16 a[48:51], a[176:179], v[212:215], a[48:51]
    v_exp_f32 v10, v206
    v_mfma_f32_16x16x32_bf16 a[80:83], a[176:179], v[216:219], a[80:83]
    buffer_store_dwordx4 v[20:23], v16, s[24:27], s46 offen offset:3072 sc1
    v_mfma_f32_16x16x32_bf16 a[112:115], a[176:179], v[220:223], a[112:115]
    v_exp_f32 v11, v207
    v_mfma_f32_16x16x32_bf16 a[52:55], a[180:183], v[212:215], a[52:55]
    ds_read_b128 a[172:175], v3 offset:27648
    v_cvt_pk_bf16_f32 v238, v8, v9
    v_mfma_f32_16x16x32_bf16 a[84:87], a[180:183], v[216:219], a[84:87]
    v_exp_f32 v4, v192
    v_mfma_f32_16x16x32_bf16 a[116:119], a[180:183], v[220:223], a[116:119]
    v_exp_f32 v5, v193
    v_mfma_f32_16x16x32_bf16 a[56:59], a[184:187], v[212:215], a[56:59]
    ds_read_b128 a[176:179], v3 offset:28672
    v_cvt_pk_bf16_f32 v239, v10, v11
    v_mfma_f32_16x16x32_bf16 a[88:91], a[184:187], v[216:219], a[88:91]
    ds_read_b128 a[180:183], v3 offset:29696
    v_or3_b32 v12, v12, v238, v239
    v_mfma_f32_16x16x32_bf16 a[120:123], a[184:187], v[220:223], a[120:123]
    v_exp_f32 v6, v194
    v_mfma_f32_16x16x32_bf16 a[60:63], a[188:191], v[212:215], a[60:63]
    buffer_load_dwordx4 v16, s[12:15], s38 offen offset:0 sc1 lds
    v_mfma_f32_16x16x32_bf16 a[92:95], a[188:191], v[216:219], a[92:95]
    v_exp_f32 v7, v195
    v_mfma_f32_16x16x32_bf16 a[124:127], a[188:191], v[220:223], a[124:127]
    v_exp_f32 v8, v196
    v_mfma_f32_16x16x32_bf16 v[244:247], v[24:27], v[212:215], v[244:247]
    v_exp_f32 v9, v197
    v_mfma_f32_16x16x32_bf16 v[248:251], v[24:27], v[216:219], v[248:251]
    v_exp_f32 v10, v198
    v_mfma_f32_16x16x32_bf16 v[252:255], v[24:27], v[220:223], v[252:255]
    s_waitcnt lgkmcnt(10)
    v_exp_f32 v11, v199
    v_mfma_f32_16x16x32_bf16 v[152:155], a[128:131], v[96:99], v[68:71]
    v_cvt_pk_bf16_f32 v232, v4, v5
    v_cvt_pk_bf16_f32 v233, v6, v7
    v_mfma_f32_16x16x32_bf16 v[160:163], a[128:131], v[112:115], v[72:75]
    v_or3_b32 v12, v12, v232, v233
    v_cvt_pk_bf16_f32 v234, v8, v9
    v_mfma_f32_16x16x32_bf16 v[168:171], a[128:131], v[128:131], v[76:79]
    buffer_load_dwordx4 v16, s[12:15], s38 offen offset:1024 sc1 lds
    v_mfma_f32_16x16x32_bf16 v[152:155], a[132:135], v[100:103], v[152:155]
    v_cvt_pk_bf16_f32 v235, v10, v11
    v_or3_b32 v12, v12, v234, v235
    v_mfma_f32_16x16x32_bf16 v[160:163], a[132:135], v[116:119], v[160:163]
    v_add_f32 v184, v56, v184
    v_add_f32 v185, v57, v185
    v_mfma_f32_16x16x32_bf16 v[168:171], a[132:135], v[132:135], v[168:171]
    v_add_f32 v186, v58, v186
    v_add_f32 v187, v59, v187
    v_mfma_f32_16x16x32_bf16 v[152:155], a[136:139], v[104:107], v[152:155]
    v_add_f32 v188, v60, v188
    v_add_f32 v189, v61, v189
    v_mfma_f32_16x16x32_bf16 v[160:163], a[136:139], v[120:123], v[160:163]
    v_add_f32 v190, v62, v190
    v_add_f32 v191, v63, v191
    v_mfma_f32_16x16x32_bf16 v[168:171], a[136:139], v[136:139], v[168:171]
    v_exp_f32 v4, v184
    v_mfma_f32_16x16x32_bf16 v[152:155], a[140:143], v[108:111], v[152:155]
    buffer_load_dwordx4 v16, s[12:15], s38 offen offset:2048 sc1 lds
    v_mfma_f32_16x16x32_bf16 v[160:163], a[140:143], v[124:127], v[160:163]
    v_exp_f32 v5, v185
    v_mfma_f32_16x16x32_bf16 v[168:171], a[140:143], v[140:143], v[168:171]
    s_waitcnt lgkmcnt(6)
    v_exp_f32 v6, v186
    v_mfma_f32_16x16x32_bf16 v[156:159], a[144:147], v[96:99], v[68:71]
    v_exp_f32 v7, v187
    v_mfma_f32_16x16x32_bf16 v[164:167], a[144:147], v[112:115], v[72:75]
    v_exp_f32 v8, v188
    v_mfma_f32_16x16x32_bf16 v[172:175], a[144:147], v[128:131], v[76:79]
    v_exp_f32 v9, v189
    v_mfma_f32_16x16x32_bf16 v[156:159], a[148:151], v[100:103], v[156:159]
    v_exp_f32 v10, v190
    v_mfma_f32_16x16x32_bf16 v[164:167], a[148:151], v[116:119], v[164:167]
    v_exp_f32 v11, v191
    v_mfma_f32_16x16x32_bf16 v[172:175], a[148:151], v[132:135], v[172:175]
    buffer_load_dwordx4 v16, s[12:15], s38 offen offset:3072 sc1 lds
    v_mfma_f32_16x16x32_bf16 v[156:159], a[152:155], v[104:107], v[156:159]
    s_mov_b32 m0, s41
    v_cvt_pk_bf16_f32 v228, v4, v5
    v_cvt_pk_bf16_f32 v229, v6, v7
    v_mfma_f32_16x16x32_bf16 v[164:167], a[152:155], v[120:123], v[164:167]
    v_or3_b32 v12, v12, v228, v229
    v_cvt_pk_bf16_f32 v230, v8, v9
    v_mfma_f32_16x16x32_bf16 v[172:175], a[152:155], v[136:139], v[172:175]
    v_cvt_pk_bf16_f32 v231, v10, v11
    v_or3_b32 v12, v12, v230, v231
    v_mfma_f32_16x16x32_bf16 v[156:159], a[156:159], v[108:111], v[156:159]
    v_and_b32 v12, s42, v12
    v_cmp_ne_u32 vcc, 0, v12
    v_mfma_f32_16x16x32_bf16 v[164:167], a[156:159], v[124:127], v[164:167]
    s_waitcnt lgkmcnt(2)
    ds_read_b128 a[184:187], v3 offset:30720
    ds_read_b128 a[188:191], v3 offset:31744
    v_mfma_f32_16x16x32_bf16 v[172:175], a[156:159], v[140:143], v[172:175]
    s_cbranch_vccnz gated_mix__ssm_conv_h3__compressed_kv_cla__prompt_kernel_b3_r1
gated_mix__ssm_conv_h3__compressed_kv_cla__prompt_kernel_b3_r1_ret:
    ds_read_b128 a[128:131], v2 offset:16384
    v_mfma_f32_16x16x32_bf16 a[32:35], a[160:163], v[228:231], a[32:35]
    ds_read_b128 a[132:135], v2 offset:17408
    v_mfma_f32_16x16x32_bf16 a[64:67], a[160:163], v[232:235], a[64:67]
    buffer_load_dwordx4 v16, s[12:15], s43 offen offset:0 sc1 lds
    v_mfma_f32_16x16x32_bf16 a[96:99], a[160:163], v[236:239], a[96:99]
    s_add_u32 s38, s38, s44
    ds_read_b128 a[136:139], v2 offset:18432
    v_mfma_f32_16x16x32_bf16 a[36:39], a[164:167], v[228:231], a[36:39]
    s_add_u32 s40, s39, s59
    ds_read_b128 a[140:143], v2 offset:19456
    v_mfma_f32_16x16x32_bf16 a[68:71], a[164:167], v[232:235], a[68:71]
    s_add_u32 s41, s40, s50
    ds_read_b128 a[144:147], v2 offset:20480
    v_mfma_f32_16x16x32_bf16 a[100:103], a[164:167], v[236:239], a[100:103]
    s_mov_b32 s39, s45
    ds_read_b128 a[148:151], v2 offset:21504
    v_mfma_f32_16x16x32_bf16 a[40:43], a[168:171], v[228:231], a[40:43]
    s_add_u32 s59, s59, s48
    ds_read_b128 a[152:155], v2 offset:22528
    v_mfma_f32_16x16x32_bf16 a[72:75], a[168:171], v[232:235], a[72:75]
    s_add_u32 s45, s45, 32768
    ds_read_b128 a[156:159], v2 offset:23552
    v_mfma_f32_16x16x32_bf16 a[104:107], a[168:171], v[236:239], a[104:107]
    s_cmp_eq_u32 s45, 163840
    ds_read_b128 a[160:163], v2 offset:8192
    v_mfma_f32_16x16x32_bf16 a[44:47], a[172:175], v[228:231], a[44:47]
    buffer_load_dwordx4 v16, s[12:15], s43 offen offset:1024 sc1 lds
    v_mfma_f32_16x16x32_bf16 a[76:79], a[172:175], v[232:235], a[76:79]
    s_cselect_b32 s45, 0, s45
    ds_read_b128 a[164:167], v2 offset:9216
    v_mfma_f32_16x16x32_bf16 a[108:111], a[172:175], v[236:239], a[108:111]
    s_waitcnt lgkmcnt(10)
    ds_read_b128 a[168:171], v2 offset:10240
    v_mfma_f32_16x16x32_bf16 a[48:51], a[176:179], v[228:231], a[48:51]
    ds_read_b128 a[172:175], v2 offset:11264
    v_mfma_f32_16x16x32_bf16 a[80:83], a[176:179], v[232:235], a[80:83]
    v_exp_f32 v4, v168
    v_mfma_f32_16x16x32_bf16 a[112:115], a[176:179], v[236:239], a[112:115]
    v_exp_f32 v5, v169
    v_mfma_f32_16x16x32_bf16 a[52:55], a[180:183], v[228:231], a[52:55]
    v_exp_f32 v6, v170
    v_mfma_f32_16x16x32_bf16 a[84:87], a[180:183], v[232:235], a[84:87]
    v_exp_f32 v7, v171
    v_mfma_f32_16x16x32_bf16 a[116:119], a[180:183], v[236:239], a[116:119]
    buffer_load_dwordx4 v16, s[12:15], s43 offen offset:2048 sc1 lds
    v_mfma_f32_16x16x32_bf16 a[56:59], a[184:187], v[228:231], a[56:59]
    v_exp_f32 v8, v172
    v_mfma_f32_16x16x32_bf16 a[88:91], a[184:187], v[232:235], a[88:91]
    v_exp_f32 v9, v173
    v_mfma_f32_16x16x32_bf16 a[120:123], a[184:187], v[236:239], a[120:123]
    v_exp_f32 v10, v174
    v_mfma_f32_16x16x32_bf16 a[60:63], a[188:191], v[228:231], a[60:63]
    v_exp_f32 v11, v175
    v_mfma_f32_16x16x32_bf16 a[92:95], a[188:191], v[232:235], a[92:95]
    v_cvt_pk_bf16_f32 v220, v4, v5
    v_cvt_pk_bf16_f32 v221, v6, v7
    v_mfma_f32_16x16x32_bf16 a[124:127], a[188:191], v[236:239], a[124:127]
    v_or_b32 v12, v220, v221
    v_cvt_pk_bf16_f32 v222, v8, v9
    v_mfma_f32_16x16x32_bf16 v[244:247], v[24:27], v[228:231], v[244:247]
    v_cvt_pk_bf16_f32 v223, v10, v11
    v_or3_b32 v12, v12, v222, v223
    v_mfma_f32_16x16x32_bf16 v[248:251], v[24:27], v[232:235], v[248:251]
    buffer_load_dwordx4 v16, s[12:15], s43 offen offset:3072 sc1 lds
    v_mfma_f32_16x16x32_bf16 v[252:255], v[24:27], v[236:239], v[252:255]
    s_waitcnt lgkmcnt(8)
    v_mov_b32 v3, v2
    v_add_u32 v2, s45, v16
    s_nop 4
    v_accvgpr_read_b32 v36, a32
    v_accvgpr_read_b32 v37, a33
    v_accvgpr_read_b32 v38, a34
    v_accvgpr_read_b32 v39, a35
    v_accvgpr_read_b32 v40, a36
    v_accvgpr_read_b32 v41, a37
    v_accvgpr_read_b32 v42, a38
    v_accvgpr_read_b32 v43, a39
    v_rcp_f32 v32, v244
    s_nop 0
    v_mul_f32 v36, v36, v32
    v_mul_f32 v37, v37, v32
    v_mul_f32 v38, v38, v32
    v_mul_f32 v39, v39, v32
    v_mul_f32 v40, v40, v32
    v_mul_f32 v41, v41, v32
    v_mul_f32 v42, v42, v32
    v_mul_f32 v43, v43, v32
    v_cvt_pk_bf16_f32 v44, v36, v37
    v_cvt_pk_bf16_f32 v45, v38, v39
    v_cvt_pk_bf16_f32 v46, v40, v41
    v_cvt_pk_bf16_f32 v47, v42, v43
    buffer_store_dwordx4 v[44:47], v16, s[16:19], s61 offen offset:0 sc1
    v_accvgpr_read_b32 v36, a40
    v_accvgpr_read_b32 v37, a41
    v_accvgpr_read_b32 v38, a42
    v_accvgpr_read_b32 v39, a43
    v_accvgpr_read_b32 v40, a44
    v_accvgpr_read_b32 v41, a45
    v_accvgpr_read_b32 v42, a46
    v_accvgpr_read_b32 v43, a47
    v_mul_f32 v36, v36, v32
    v_mul_f32 v37, v37, v32
    v_mul_f32 v38, v38, v32
    v_mul_f32 v39, v39, v32
    v_mul_f32 v40, v40, v32
    v_mul_f32 v41, v41, v32
    v_mul_f32 v42, v42, v32
    v_mul_f32 v43, v43, v32
    v_cvt_pk_bf16_f32 v20, v36, v37
    v_cvt_pk_bf16_f32 v21, v38, v39
    v_cvt_pk_bf16_f32 v22, v40, v41
    v_cvt_pk_bf16_f32 v23, v42, v43
    buffer_store_dwordx4 v[20:23], v16, s[16:19], s61 offen offset:1024 sc1
    v_accvgpr_read_b32 v36, a48
    v_accvgpr_read_b32 v37, a49
    v_accvgpr_read_b32 v38, a50
    v_accvgpr_read_b32 v39, a51
    v_accvgpr_read_b32 v40, a52
    v_accvgpr_read_b32 v41, a53
    v_accvgpr_read_b32 v42, a54
    v_accvgpr_read_b32 v43, a55
    v_mul_f32 v36, v36, v32
    v_mul_f32 v37, v37, v32
    v_mul_f32 v38, v38, v32
    v_mul_f32 v39, v39, v32
    v_mul_f32 v40, v40, v32
    v_mul_f32 v41, v41, v32
    v_mul_f32 v42, v42, v32
    v_mul_f32 v43, v43, v32
    v_cvt_pk_bf16_f32 v44, v36, v37
    v_cvt_pk_bf16_f32 v45, v38, v39
    v_cvt_pk_bf16_f32 v46, v40, v41
    v_cvt_pk_bf16_f32 v47, v42, v43
    buffer_store_dwordx4 v[44:47], v16, s[16:19], s61 offen offset:2048 sc1
    v_accvgpr_read_b32 v36, a56
    v_accvgpr_read_b32 v37, a57
    v_accvgpr_read_b32 v38, a58
    v_accvgpr_read_b32 v39, a59
    v_accvgpr_read_b32 v40, a60
    v_accvgpr_read_b32 v41, a61
    v_accvgpr_read_b32 v42, a62
    v_accvgpr_read_b32 v43, a63
    v_mul_f32 v36, v36, v32
    v_mul_f32 v37, v37, v32
    v_mul_f32 v38, v38, v32
    v_mul_f32 v39, v39, v32
    v_mul_f32 v40, v40, v32
    v_mul_f32 v41, v41, v32
    v_mul_f32 v42, v42, v32
    v_mul_f32 v43, v43, v32
    v_cvt_pk_bf16_f32 v20, v36, v37
    v_cvt_pk_bf16_f32 v21, v38, v39
    v_cvt_pk_bf16_f32 v22, v40, v41
    v_cvt_pk_bf16_f32 v23, v42, v43
    buffer_store_dwordx4 v[20:23], v16, s[16:19], s61 offen offset:3072 sc1
    s_lshl_b32 s35, s34, 2
    s_sub_u32 s35, 29, s35
    s_sub_u32 s58, s35, 3
    s_cmp_eq_u32 s34, 7
    s_cselect_b32 s58, s35, s58
    s_nop 0
    s_nop 0
    s_nop 0
    s_nop 0
    s_nop 0
    s_nop 0
gated_mix__ssm_conv_h3__compressed_kv_cla__prompt_kernel_b2_loop:
    v_mfma_f32_16x16x32_bf16 v[192:195], a[128:131], v[112:115], v[72:75]
    s_cmp_eq_u32 s35, 1
    ds_read_b128 a[176:179], v3 offset:12288
    ds_read_b128 a[180:183], v3 offset:13312
    v_mfma_f32_16x16x32_bf16 v[200:203], a[128:131], v[128:131], v[76:79]
    s_cbranch_scc1 gated_mix__ssm_conv_h3__compressed_kv_cla__prompt_kernel_b2_m0
gated_mix__ssm_conv_h3__compressed_kv_cla__prompt_kernel_b2_m0_ret:
    ds_read_b128 a[184:187], v3 offset:14336
    v_exp_f32 v4, v160
    v_mfma_f32_16x16x32_bf16 v[192:195], a[132:135], v[116:119], v[192:195]
    s_waitcnt vmcnt(16)
    ds_read_b128 a[188:191], v3 offset:15360
    v_exp_f32 v5, v161
    v_mfma_f32_16x16x32_bf16 v[200:203], a[132:135], v[132:135], v[200:203]
    s_barrier
    ds_read_b128 a[128:131], v2 offset:0
    v_exp_f32 v6, v162
    v_mfma_f32_16x16x32_bf16 v[192:195], a[136:139], v[120:123], v[192:195]
    s_mov_b32 m0, s40
    v_exp_f32 v7, v163
    v_mfma_f32_16x16x32_bf16 v[200:203], a[136:139], v[136:139], v[200:203]
    s_add_u32 s43, s38, s49
    ds_read_b128 a[132:135], v2 offset:1024
    v_exp_f32 v8, v164
    v_mfma_f32_16x16x32_bf16 v[192:195], a[140:143], v[124:127], v[192:195]
    ds_read_b128 a[136:139], v2 offset:2048
    v_exp_f32 v9, v165
    v_mfma_f32_16x16x32_bf16 v[200:203], a[140:143], v[140:143], v[200:203]
    s_waitcnt lgkmcnt(11)
    ds_read_b128 a[140:143], v2 offset:3072
    v_exp_f32 v10, v166
    v_mfma_f32_16x16x32_bf16 v[196:199], a[144:147], v[112:115], v[72:75]
    v_exp_f32 v11, v167
    v_mfma_f32_16x16x32_bf16 v[204:207], a[144:147], v[128:131], v[76:79]
    v_cvt_pk_bf16_f32 v216, v4, v5
    v_cvt_pk_bf16_f32 v217, v6, v7
    v_mfma_f32_16x16x32_bf16 v[196:199], a[148:151], v[116:119], v[196:199]
    v_or3_b32 v12, v12, v216, v217
    v_cvt_pk_bf16_f32 v218, v8, v9
    v_mfma_f32_16x16x32_bf16 v[204:207], a[148:151], v[132:135], v[204:207]
    v_cvt_pk_bf16_f32 v219, v10, v11
    v_or3_b32 v12, v12, v218, v219
    v_mfma_f32_16x16x32_bf16 v[196:199], a[152:155], v[120:123], v[196:199]
    v_and_b32 v12, s42, v12
    v_cmp_ne_u32 vcc, 0, v12
    v_mfma_f32_16x16x32_bf16 v[204:207], a[152:155], v[136:139], v[204:207]
    buffer_load_dwordx4 v16, s[12:15], s38 offen offset:0 sc1 lds
    v_mfma_f32_16x16x32_bf16 v[196:199], a[156:159], v[124:127], v[196:199]
    s_waitcnt lgkmcnt(8)
    ds_read_b128 a[144:147], v2 offset:4096
    ds_read_b128 a[148:151], v2 offset:5120
    v_mfma_f32_16x16x32_bf16 v[204:207], a[156:159], v[140:143], v[204:207]
    s_cbranch_vccnz gated_mix__ssm_conv_h3__compressed_kv_cla__prompt_kernel_b2_r0
gated_mix__ssm_conv_h3__compressed_kv_cla__prompt_kernel_b2_r0_ret:
    ds_read_b128 a[152:155], v2 offset:6144
    ds_read_b128 a[156:159], v2 offset:7168
    v_mfma_f32_16x16x32_bf16 a[64:67], a[160:163], v[216:219], a[64:67]
    v_exp_f32 v4, v200
    v_mfma_f32_16x16x32_bf16 a[96:99], a[160:163], v[220:223], a[96:99]
    v_exp_f32 v5, v201
    v_mfma_f32_16x16x32_bf16 a[68:71], a[164:167], v[216:219], a[68:71]
    v_exp_f32 v6, v202
    v_mfma_f32_16x16x32_bf16 a[100:103], a[164:167], v[220:223], a[100:103]
    s_cmp_eq_u32 s35, 1
    ds_read_b128 a[160:163], v3 offset:24576
    ds_read_b128 a[164:167], v3 offset:25600
    v_mfma_f32_16x16x32_bf16 a[72:75], a[168:171], v[216:219], a[72:75]
    s_cbranch_scc1 gated_mix__ssm_conv_h3__compressed_kv_cla__prompt_kernel_b2_m1
gated_mix__ssm_conv_h3__compressed_kv_cla__prompt_kernel_b2_m1_ret:
    v_exp_f32 v7, v203
    v_mfma_f32_16x16x32_bf16 a[104:107], a[168:171], v[220:223], a[104:107]
    buffer_load_dwordx4 v16, s[12:15], s38 offen offset:1024 sc1 lds
    v_mfma_f32_16x16x32_bf16 a[76:79], a[172:175], v[216:219], a[76:79]
    ds_read_b128 a[168:171], v3 offset:26624
    v_cvt_pk_bf16_f32 v236, v4, v5
    v_mfma_f32_16x16x32_bf16 a[108:111], a[172:175], v[220:223], a[108:111]
    s_waitcnt lgkmcnt(11)
    ds_read_b128 a[172:175], v3 offset:27648
    v_cvt_pk_bf16_f32 v237, v6, v7
    v_mfma_f32_16x16x32_bf16 a[80:83], a[176:179], v[216:219], a[80:83]
    v_exp_f32 v8, v204
    v_mfma_f32_16x16x32_bf16 a[112:115], a[176:179], v[220:223], a[112:115]
    v_exp_f32 v9, v205
    v_mfma_f32_16x16x32_bf16 a[84:87], a[180:183], v[216:219], a[84:87]
    ds_read_b128 a[176:179], v3 offset:28672
    v_or_b32 v12, v236, v237
    v_mfma_f32_16x16x32_bf16 a[116:119], a[180:183], v[220:223], a[116:119]
    ds_read_b128 a[180:183], v3 offset:29696
    v_cvt_pk_bf16_f32 v238, v8, v9
    v_mfma_f32_16x16x32_bf16 a[88:91], a[184:187], v[216:219], a[88:91]
    buffer_load_dwordx4 v16, s[12:15], s38 offen offset:2048 sc1 lds
    v_mfma_f32_16x16x32_bf16 a[120:123], a[184:187], v[220:223], a[120:123]
    v_exp_f32 v10, v206
    v_mfma_f32_16x16x32_bf16 a[92:95], a[188:191], v[216:219], a[92:95]
    v_exp_f32 v11, v207
    v_mfma_f32_16x16x32_bf16 a[124:127], a[188:191], v[220:223], a[124:127]
    ds_read_b128 a[184:187], v3 offset:30720
    v_cvt_pk_bf16_f32 v239, v10, v11
    v_mfma_f32_16x16x32_bf16 v[248:251], v[24:27], v[216:219], v[248:251]
    v_exp_f32 v4, v192
    v_mfma_f32_16x16x32_bf16 v[252:255], v[24:27], v[220:223], v[252:255]
    s_waitcnt lgkmcnt(11)
    v_exp_f32 v5, v193
    v_mfma_f32_16x16x32_bf16 v[160:163], a[128:131], v[112:115], v[72:75]
    ds_read_b128 a[188:191], v3 offset:31744
    v_or3_b32 v12, v12, v238, v239
    v_mfma_f32_16x16x32_bf16 v[168:171], a[128:131], v[128:131], v[76:79]
    ds_read_b128 a[128:131], v2 offset:16384
    v_cvt_pk_bf16_f32 v232, v4, v5
    v_mfma_f32_16x16x32_bf16 v[160:163], a[132:135], v[116:119], v[160:163]
    buffer_load_dwordx4 v16, s[12:15], s38 offen offset:3072 sc1 lds
    v_mfma_f32_16x16x32_bf16 v[168:171], a[132:135], v[132:135], v[168:171]
    s_mov_b32 m0, s41
    v_exp_f32 v6, v194
    v_mfma_f32_16x16x32_bf16 v[160:163], a[136:139], v[120:123], v[160:163]
    v_exp_f32 v7, v195
    v_mfma_f32_16x16x32_bf16 v[168:171], a[136:139], v[136:139], v[168:171]
    ds_read_b128 a[132:135], v2 offset:17408
    v_cvt_pk_bf16_f32 v233, v6, v7
    v_mfma_f32_16x16x32_bf16 v[160:163], a[140:143], v[124:127], v[160:163]
    v_exp_f32 v8, v196
    v_mfma_f32_16x16x32_bf16 v[168:171], a[140:143], v[140:143], v[168:171]
    s_waitcnt lgkmcnt(10)
    v_exp_f32 v9, v197
    v_mfma_f32_16x16x32_bf16 v[164:167], a[144:147], v[112:115], v[72:75]
    v_exp_f32 v10, v198
    v_mfma_f32_16x16x32_bf16 v[172:175], a[144:147], v[128:131], v[76:79]
    buffer_load_dwordx4 v16, s[12:15], s43 offen offset:0 sc1 lds
    v_mfma_f32_16x16x32_bf16 v[164:167], a[148:151], v[116:119], v[164:167]
    v_exp_f32 v11, v199
    v_mfma_f32_16x16x32_bf16 v[172:175], a[148:151], v[132:135], v[172:175]
    v_or3_b32 v12, v12, v232, v233
    v_cvt_pk_bf16_f32 v234, v8, v9
    v_mfma_f32_16x16x32_bf16 v[164:167], a[152:155], v[120:123], v[164:167]
    v_cvt_pk_bf16_f32 v235, v10, v11
    v_or3_b32 v12, v12, v234, v235
    v_mfma_f32_16x16x32_bf16 v[172:175], a[152:155], v[136:139], v[172:175]
    s_cmp_eq_u32 s35, 1
    v_and_b32 v12, s42, v12
    v_cmp_ne_u32 vcc, 0, v12
    v_mfma_f32_16x16x32_bf16 v[164:167], a[156:159], v[124:127], v[164:167]
    s_waitcnt lgkmcnt(6)
    ds_read_b128 a[136:139], v2 offset:18432
    ds_read_b128 a[140:143], v2 offset:19456
    v_mfma_f32_16x16x32_bf16 v[172:175], a[156:159], v[140:143], v[172:175]
    s_cbranch_vccnz gated_mix__ssm_conv_h3__compressed_kv_cla__prompt_kernel_b2_r1
gated_mix__ssm_conv_h3__compressed_kv_cla__prompt_kernel_b2_r1_ret:
    ds_read_b128 a[144:147], v2 offset:20480
    ds_read_b128 a[148:151], v2 offset:21504
    v_mfma_f32_16x16x32_bf16 a[64:67], a[160:163], v[232:235], a[64:67]
    s_cbranch_scc1 gated_mix__ssm_conv_h3__compressed_kv_cla__prompt_kernel_b2_m2
gated_mix__ssm_conv_h3__compressed_kv_cla__prompt_kernel_b2_m2_ret:
    ds_read_b128 a[152:155], v2 offset:22528
    ds_read_b128 a[156:159], v2 offset:23552
    v_mfma_f32_16x16x32_bf16 a[96:99], a[160:163], v[236:239], a[96:99]
    buffer_load_dwordx4 v16, s[12:15], s43 offen offset:1024 sc1 lds
    v_mfma_f32_16x16x32_bf16 a[68:71], a[164:167], v[232:235], a[68:71]
    s_add_u32 s38, s38, s44
    v_exp_f32 v4, v168
    v_mfma_f32_16x16x32_bf16 a[100:103], a[164:167], v[236:239], a[100:103]
    s_add_u32 s40, s39, s59
    v_exp_f32 v5, v169
    v_mfma_f32_16x16x32_bf16 a[72:75], a[168:171], v[232:235], a[72:75]
    s_add_u32 s41, s40, s50
    v_exp_f32 v6, v170
    v_mfma_f32_16x16x32_bf16 a[104:107], a[168:171], v[236:239], a[104:107]
    s_mov_b32 s39, s45
    ds_read_b128 a[160:163], v2 offset:8192
    v_cvt_pk_bf16_f32 v220, v4, v5
    v_mfma_f32_16x16x32_bf16 a[76:79], a[172:175], v[232:235], a[76:79]
    s_add_u32 s59, s59, s48
    v_exp_f32 v7, v171
    v_mfma_f32_16x16x32_bf16 a[108:111], a[172:175], v[236:239], a[108:111]
    s_waitcnt lgkmcnt(9)
    ds_read_b128 a[164:167], v2 offset:9216
    v_cvt_pk_bf16_f32 v221, v6, v7
    v_mfma_f32_16x16x32_bf16 a[80:83], a[176:179], v[232:235], a[80:83]
    buffer_load_dwordx4 v16, s[12:15], s43 offen offset:2048 sc1 lds
    v_mfma_f32_16x16x32_bf16 a[112:115], a[176:179], v[236:239], a[112:115]
    s_add_u32 s45, s45, 32768
    ds_read_b128 a[168:171], v2 offset:10240
    v_or_b32 v12, v220, v221
    v_mfma_f32_16x16x32_bf16 a[84:87], a[180:183], v[232:235], a[84:87]
    s_cmp_eq_u32 s45, 163840
    v_exp_f32 v8, v172
    v_mfma_f32_16x16x32_bf16 a[116:119], a[180:183], v[236:239], a[116:119]
    s_cselect_b32 s45, 0, s45
    v_exp_f32 v9, v173
    v_mfma_f32_16x16x32_bf16 a[88:91], a[184:187], v[232:235], a[88:91]
gated_mix__ssm_conv_h3__compressed_kv_cla__prompt_kernel_pad10:
    s_cbranch_execz gated_mix__ssm_conv_h3__compressed_kv_cla__prompt_kernel_pad14
    s_sub_u32 s35, s35, 1
    v_exp_f32 v10, v174
    v_mfma_f32_16x16x32_bf16 a[120:123], a[184:187], v[236:239], a[120:123]
    s_sub_u32 s58, s58, 1
    ds_read_b128 a[172:175], v2 offset:11264
    v_cvt_pk_bf16_f32 v222, v8, v9
    v_mfma_f32_16x16x32_bf16 a[92:95], a[188:191], v[232:235], a[92:95]
    s_cmp_lg_u32 s58, 0
    v_exp_f32 v11, v175
    v_mfma_f32_16x16x32_bf16 a[124:127], a[188:191], v[236:239], a[124:127]
    v_cvt_pk_bf16_f32 v223, v10, v11
    v_or3_b32 v12, v12, v222, v223
    v_mfma_f32_16x16x32_bf16 v[248:251], v[24:27], v[232:235], v[248:251]
    buffer_load_dwordx4 v16, s[12:15], s43 offen offset:3072 sc1 lds
    v_mfma_f32_16x16x32_bf16 v[252:255], v[24:27], v[236:239], v[252:255]
    s_waitcnt lgkmcnt(8)
    v_mov_b32 v3, v2
    v_add_u32 v2, s45, v16
    s_cbranch_scc1 gated_mix__ssm_conv_h3__compressed_kv_cla__prompt_kernel_b2_loop
    s_cmp_lg_u32 s35, 0
    s_cbranch_scc1 gated_mix__ssm_conv_h3__compressed_kv_cla__prompt_kernel_b2_sw
    s_waitcnt vmcnt(8)
    v_mov_b32 v13, 0
    v_mov_b32 v14, 1
    buffer_store_dword v14, v13, s[28:31], s55 offen sc1
    s_nop 4
    v_accvgpr_read_b32 v36, a64
    v_accvgpr_read_b32 v37, a65
    v_accvgpr_read_b32 v38, a66
    v_accvgpr_read_b32 v39, a67
    v_accvgpr_read_b32 v40, a68
    v_accvgpr_read_b32 v41, a69
    v_accvgpr_read_b32 v42, a70
    v_accvgpr_read_b32 v43, a71
    v_rcp_f32 v32, v248
    s_nop 0
    v_mul_f32 v36, v36, v32
    v_mul_f32 v37, v37, v32
    v_mul_f32 v38, v38, v32
    v_mul_f32 v39, v39, v32
    v_mul_f32 v40, v40, v32
    v_mul_f32 v41, v41, v32
    v_mul_f32 v42, v42, v32
    v_mul_f32 v43, v43, v32
    v_cvt_pk_bf16_f32 v44, v36, v37
    v_cvt_pk_bf16_f32 v45, v38, v39
    v_cvt_pk_bf16_f32 v46, v40, v41
    v_cvt_pk_bf16_f32 v47, v42, v43
    buffer_store_dwordx4 v[44:47], v16, s[16:19], s62 offen offset:0 sc1
    v_accvgpr_read_b32 v36, a72
    v_accvgpr_read_b32 v37, a73
    v_accvgpr_read_b32 v38, a74
    v_accvgpr_read_b32 v39, a75
    v_accvgpr_read_b32 v40, a76
    v_accvgpr_read_b32 v41, a77
    v_accvgpr_read_b32 v42, a78
    v_accvgpr_read_b32 v43, a79
    v_mul_f32 v36, v36, v32
    v_mul_f32 v37, v37, v32
    v_mul_f32 v38, v38, v32
    v_mul_f32 v39, v39, v32
    v_mul_f32 v40, v40, v32
    v_mul_f32 v41, v41, v32
    v_mul_f32 v42, v42, v32
    v_mul_f32 v43, v43, v32
    v_cvt_pk_bf16_f32 v20, v36, v37
    v_cvt_pk_bf16_f32 v21, v38, v39
    v_cvt_pk_bf16_f32 v22, v40, v41
    v_cvt_pk_bf16_f32 v23, v42, v43
    buffer_store_dwordx4 v[20:23], v16, s[16:19], s62 offen offset:1024 sc1
    v_accvgpr_read_b32 v36, a80
    v_accvgpr_read_b32 v37, a81
    v_accvgpr_read_b32 v38, a82
    v_accvgpr_read_b32 v39, a83
    v_accvgpr_read_b32 v40, a84
    v_accvgpr_read_b32 v41, a85
    v_accvgpr_read_b32 v42, a86
    v_accvgpr_read_b32 v43, a87
    v_mul_f32 v36, v36, v32
    v_mul_f32 v37, v37, v32
    v_mul_f32 v38, v38, v32
    v_mul_f32 v39, v39, v32
    v_mul_f32 v40, v40, v32
    v_mul_f32 v41, v41, v32
    v_mul_f32 v42, v42, v32
    v_mul_f32 v43, v43, v32
    v_cvt_pk_bf16_f32 v44, v36, v37
    v_cvt_pk_bf16_f32 v45, v38, v39
    v_cvt_pk_bf16_f32 v46, v40, v41
    v_cvt_pk_bf16_f32 v47, v42, v43
    buffer_store_dwordx4 v[44:47], v16, s[16:19], s62 offen offset:2048 sc1
    v_accvgpr_read_b32 v36, a88
    v_accvgpr_read_b32 v37, a89
    v_accvgpr_read_b32 v38, a90
    v_accvgpr_read_b32 v39, a91
    v_accvgpr_read_b32 v40, a92
    v_accvgpr_read_b32 v41, a93
    v_accvgpr_read_b32 v42, a94
    v_accvgpr_read_b32 v43, a95
    v_mul_f32 v36, v36, v32
    v_mul_f32 v37, v37, v32
    v_mul_f32 v38, v38, v32
    v_mul_f32 v39, v39, v32
    v_mul_f32 v40, v40, v32
    v_mul_f32 v41, v41, v32
    v_mul_f32 v42, v42, v32
    v_mul_f32 v43, v43, v32
    v_cvt_pk_bf16_f32 v20, v36, v37
    v_cvt_pk_bf16_f32 v21, v38, v39
    v_cvt_pk_bf16_f32 v22, v40, v41
    v_cvt_pk_bf16_f32 v23, v42, v43
    buffer_store_dwordx4 v[20:23], v16, s[16:19], s62 offen offset:3072 sc1
    s_mov_b32 m0, s40
    s_add_u32 s43, s38, s49
    s_barrier
    v_and_b32 v12, s42, v12
    v_cmp_ne_u32 vcc, 0, v12
    v_mfma_f32_16x16x32_bf16 v[200:203], a[128:131], v[128:131], v[76:79]
    v_mfma_f32_16x16x32_bf16 v[200:203], a[132:135], v[132:135], v[200:203]
    buffer_load_dwordx4 v16, s[12:15], s38 offen offset:0 sc1 lds
    v_mfma_f32_16x16x32_bf16 v[200:203], a[136:139], v[136:139], v[200:203]
    v_mfma_f32_16x16x32_bf16 v[200:203], a[140:143], v[140:143], v[200:203]
    s_waitcnt lgkmcnt(4)
    buffer_load_dwordx4 v16, s[12:15], s38 offen offset:1024 sc1 lds
    v_mfma_f32_16x16x32_bf16 v[204:207], a[144:147], v[128:131], v[76:79]
    ds_read_b128 a[176:179], v3 offset:12288
    v_mfma_f32_16x16x32_bf16 v[204:207], a[148:151], v[132:135], v[204:207]
    ds_read_b128 a[180:183], v3 offset:13312
    buffer_load_dwordx4 v16, s[12:15], s38 offen offset:2048 sc1 lds
    v_mfma_f32_16x16x32_bf16 v[204:207], a[152:155], v[136:139], v[204:207]
    ds_read_b128 a[184:187], v3 offset:14336
    v_mfma_f32_16x16x32_bf16 v[204:207], a[156:159], v[140:143], v[204:207]
    s_waitcnt lgkmcnt(3)
    ds_read_b128 a[188:191], v3 offset:15360
    buffer_load_dwordx4 v16, s[12:15], s38 offen offset:3072 sc1 lds
    s_mov_b32 m0, s41
    s_cbranch_vccnz gated_mix__ssm_conv_h3__compressed_kv_cla__prompt_kernel_b1_r0
gated_mix__ssm_conv_h3__compressed_kv_cla__prompt_kernel_b1_r0_ret:
    ds_read_b128 a[128:131], v3 offset:24576
    ds_read_b128 a[132:135], v3 offset:25600
    ds_read_b128 a[136:139], v3 offset:26624
    ds_read_b128 a[140:143], v3 offset:27648
    ds_read_b128 a[144:147], v3 offset:28672
    ds_read_b128 a[148:151], v3 offset:29696
    ds_read_b128 a[152:155], v3 offset:30720
    ds_read_b128 a[156:159], v3 offset:31744
    v_mfma_f32_16x16x32_bf16 a[96:99], a[160:163], v[220:223], a[96:99]
    buffer_load_dwordx4 v16, s[12:15], s43 offen offset:0 sc1 lds
    v_mfma_f32_16x16x32_bf16 a[100:103], a[164:167], v[220:223], a[100:103]
    buffer_load_dwordx4 v16, s[12:15], s43 offen offset:1024 sc1 lds
    v_mfma_f32_16x16x32_bf16 a[104:107], a[168:171], v[220:223], a[104:107]
    buffer_load_dwordx4 v16, s[12:15], s43 offen offset:2048 sc1 lds
    v_mfma_f32_16x16x32_bf16 a[108:111], a[172:175], v[220:223], a[108:111]
    s_waitcnt lgkmcnt(8)
    buffer_load_dwordx4 v16, s[12:15], s43 offen offset:3072 sc1 lds
    v_mfma_f32_16x16x32_bf16 a[112:115], a[176:179], v[220:223], a[112:115]
    v_add_f32 v200, v56, v200
    v_add_f32 v201, v57, v201
    v_add_f32 v202, v58, v202
    v_add_f32 v203, v59, v203
    v_add_f32 v204, v60, v204
    v_add_f32 v205, v61, v205
    v_add_f32 v206, v62, v206
    v_add_f32 v207, v63, v207
    v_mfma_f32_16x16x32_bf16 a[116:119], a[180:183], v[220:223], a[116:119]
    v_exp_f32 v4, v200
    v_exp_f32 v5, v201
    s_nop 0
    v_cvt_pk_bf16_f32 v236, v4, v5
    v_mfma_f32_16x16x32_bf16 a[120:123], a[184:187], v[220:223], a[120:123]
    v_exp_f32 v6, v202
    v_exp_f32 v7, v203
    s_nop 0
    v_cvt_pk_bf16_f32 v237, v6, v7
    v_mfma_f32_16x16x32_bf16 a[124:127], a[188:191], v[220:223], a[124:127]
    v_or_b32 v12, v236, v237
    v_exp_f32 v8, v204
    v_exp_f32 v9, v205
    s_nop 0
    v_mfma_f32_16x16x32_bf16 v[252:255], v[24:27], v[220:223], v[252:255]
    s_waitcnt lgkmcnt(4)
    v_cvt_pk_bf16_f32 v238, v8, v9
    v_exp_f32 v10, v206
    v_exp_f32 v11, v207
    s_nop 0
    v_cvt_pk_bf16_f32 v239, v10, v11
    v_or3_b32 v12, v12, v238, v239
    v_and_b32 v12, s42, v12
    v_cmp_ne_u32 vcc, 0, v12
    s_cbranch_vccnz gated_mix__ssm_conv_h3__compressed_kv_cla__prompt_kernel_b1_r1
gated_mix__ssm_conv_h3__compressed_kv_cla__prompt_kernel_b1_r1_ret:
    v_mfma_f32_16x16x32_bf16 a[96:99], a[128:131], v[236:239], a[96:99]
    v_mfma_f32_16x16x32_bf16 a[100:103], a[132:135], v[236:239], a[100:103]
    v_mfma_f32_16x16x32_bf16 a[104:107], a[136:139], v[236:239], a[104:107]
    v_mfma_f32_16x16x32_bf16 a[108:111], a[140:143], v[236:239], a[108:111]
    s_waitcnt lgkmcnt(0)
    v_mfma_f32_16x16x32_bf16 a[112:115], a[144:147], v[236:239], a[112:115]
    v_mfma_f32_16x16x32_bf16 a[116:119], a[148:151], v[236:239], a[116:119]
    v_mfma_f32_16x16x32_bf16 a[120:123], a[152:155], v[236:239], a[120:123]
    v_mfma_f32_16x16x32_bf16 a[124:127], a[156:159], v[236:239], a[124:127]
    v_mfma_f32_16x16x32_bf16 v[252:255], v[24:27], v[236:239], v[252:255]
    s_mov_b32 s20, s74
    s_mov_b32 s21, s75
    s_mov_b32 s22, 2048
    s_lshl_b32 s36, s2, 2
    s_add_u32 s36, s36, s32
    s_mul_i32 s43, s32, 27040
    s_lshl_b32 s44, s36, 12
    s_lshl_b32 s47, s36, 1
    s_mul_i32 s59, s32, 2304
    v_mov_b32 v8, 0
    v_mov_b32 v9, 1
    buffer_load_dwordx2 v[10:11], v8, s[4:7], s44 offen
    buffer_load_ushort v12, v8, s[20:23], s47 offen
    s_nop 4
    v_accvgpr_read_b32 v36, a96
    v_accvgpr_read_b32 v37, a97
    v_accvgpr_read_b32 v38, a98
    v_accvgpr_read_b32 v39, a99
    v_accvgpr_read_b32 v40, a100
    v_accvgpr_read_b32 v41, a101
    v_accvgpr_read_b32 v42, a102
    v_accvgpr_read_b32 v43, a103
    v_rcp_f32 v32, v252
    s_nop 0
    v_mul_f32 v36, v36, v32
    v_mul_f32 v37, v37, v32
    v_mul_f32 v38, v38, v32
    v_mul_f32 v39, v39, v32
    v_mul_f32 v40, v40, v32
    v_mul_f32 v41, v41, v32
    v_mul_f32 v42, v42, v32
    v_mul_f32 v43, v43, v32
    v_cvt_pk_bf16_f32 v44, v36, v37
    v_cvt_pk_bf16_f32 v45, v38, v39
    v_cvt_pk_bf16_f32 v46, v40, v41
    v_cvt_pk_bf16_f32 v47, v42, v43
    buffer_store_dwordx4 v[44:47], v16, s[16:19], s63 offen offset:0 sc1
    v_accvgpr_read_b32 v36, a104
    v_accvgpr_read_b32 v37, a105
    v_accvgpr_read_b32 v38, a106
    v_accvgpr_read_b32 v39, a107
    v_accvgpr_read_b32 v40, a108
    v_accvgpr_read_b32 v41, a109
    v_accvgpr_read_b32 v42, a110
    v_accvgpr_read_b32 v43, a111
    v_mul_f32 v36, v36, v32
    v_mul_f32 v37, v37, v32
    v_mul_f32 v38, v38, v32
    v_mul_f32 v39, v39, v32
    v_mul_f32 v40, v40, v32
    v_mul_f32 v41, v41, v32
    v_mul_f32 v42, v42, v32
    v_mul_f32 v43, v43, v32
    v_cvt_pk_bf16_f32 v20, v36, v37
    v_cvt_pk_bf16_f32 v21, v38, v39
    v_cvt_pk_bf16_f32 v22, v40, v41
    v_cvt_pk_bf16_f32 v23, v42, v43
    buffer_store_dwordx4 v[20:23], v16, s[16:19], s63 offen offset:1024 sc1
    v_accvgpr_read_b32 v36, a112
    v_accvgpr_read_b32 v37, a113
    v_accvgpr_read_b32 v38, a114
    v_accvgpr_read_b32 v39, a115
    v_accvgpr_read_b32 v40, a116
    v_accvgpr_read_b32 v41, a117
    v_accvgpr_read_b32 v42, a118
    v_accvgpr_read_b32 v43, a119
    v_mul_f32 v36, v36, v32
    v_mul_f32 v37, v37, v32
    v_mul_f32 v38, v38, v32
    v_mul_f32 v39, v39, v32
    v_mul_f32 v40, v40, v32
    v_mul_f32 v41, v41, v32
    v_mul_f32 v42, v42, v32
    v_mul_f32 v43, v43, v32
    v_cvt_pk_bf16_f32 v44, v36, v37
    v_cvt_pk_bf16_f32 v45, v38, v39
    v_cvt_pk_bf16_f32 v46, v40, v41
    v_cvt_pk_bf16_f32 v47, v42, v43
    buffer_store_dwordx4 v[44:47], v16, s[16:19], s63 offen offset:2048 sc1
    v_accvgpr_read_b32 v36, a120
    v_accvgpr_read_b32 v37, a121
    v_accvgpr_read_b32 v38, a122
    v_accvgpr_read_b32 v39, a123
    v_accvgpr_read_b32 v40, a124
    v_accvgpr_read_b32 v41, a125
    v_accvgpr_read_b32 v42, a126
    v_accvgpr_read_b32 v43, a127
    v_mul_f32 v36, v36, v32
    v_mul_f32 v37, v37, v32
    v_mul_f32 v38, v38, v32
    v_mul_f32 v39, v39, v32
    v_mul_f32 v40, v40, v32
    v_mul_f32 v41, v41, v32
    v_mul_f32 v42, v42, v32
    v_mul_f32 v43, v43, v32
    v_cvt_pk_bf16_f32 v20, v36, v37
    v_cvt_pk_bf16_f32 v21, v38, v39
    v_cvt_pk_bf16_f32 v22, v40, v41
    v_cvt_pk_bf16_f32 v23, v42, v43
    buffer_store_dwordx4 v[20:23], v16, s[16:19], s63 offen offset:3072 sc1
    v_lshrrev_b32 v232, 4, v16
    v_and_b32 v6, 15, v232
    v_lshrrev_b32 v7, 4, v232
    v_and_b32 v233, 1, v6
    v_cmp_eq_u32 vcc, 1, v233
    v_mov_b32 v234, 4240
    v_lshlrev_b32 v235, 4, v7
    v_cndmask_b32 v234, v234, 8, vcc
    v_lshl_add_u32 v234, v6, 3, v234
    v_add3_u32 v3, v234, v235, s43
    v_and_b32 v236, 3, v6
    v_mul_u32_u24 v236, 4640, v236
    v_lshrrev_b32 v234, 2, v6
    v_lshlrev_b32 v234, 7, v234
    v_sub_u32 v236, v236, v234
    v_add3_u32 v4, v236, v235, s43
    v_add_u32 v4, 8864, v4
    v_mov_b32 v20, 0
    v_mov_b32 v21, 0
    v_mov_b32 v22, 0
    v_mov_b32 v23, 0
    v_and_b32 v234, 7, v232
    v_lshlrev_b32 v234, 4, v234
    v_bfe_u32 v235, v232, 3, 1
    v_mul_u32_u24 v235, 4240, v235
    v_add3_u32 v234, v234, v235, s43
    ds_write_b128 v234, v[20:23]
    v_min_u32 v235, 368, v16
    v_add_u32 v235, s43, v235
    ds_write_b128 v235, v[20:23] offset:12576
    ds_write_b128 v235, v[20:23] offset:17216
    ds_write_b128 v235, v[20:23] offset:21856
    ds_write_b128 v235, v[20:23] offset:26496
    v_lshlrev_b32 v236, 2, v6
    v_sub_u32 v236, 60, v236
    v_lshrrev_b32 v236, 3, v236
    v_sub_u32 v236, v236, v7
    v_lshl_add_u32 v236, v233, 4, v236
    s_waitcnt vmcnt(4)
    v_mov_b32 v234, s43
    ds_write_b64 v234, v[10:11] offset:4360
    v_cmp_eq_u32 vcc, 16, v236
    v_mov_b32 v25, 0
    s_nop 0
    v_cndmask_b32 v24, 0, v12, vcc
    v_cmp_eq_u32 vcc, 0, v236
    v_mov_b32 v27, 0
    s_nop 0
    v_cndmask_b32 v26, 0, v12, vcc
    v_cmp_eq_u32 vcc, 20, v236
    v_mov_b32 v29, 0
    s_nop 0
    v_cndmask_b32 v28, 0, v12, vcc
    v_cmp_eq_u32 vcc, 4, v236
    v_mov_b32 v31, 0
    s_nop 0
    v_cndmask_b32 v30, 0, v12, vcc
    s_waitcnt vmcnt(6) lgkmcnt(0)
    s_barrier
    ds_read_b128 v[96:99], v4 offset:3584
    ds_read_b128 v[64:67], v3 offset:0
    ds_read_b128 v[100:103], v4 offset:3072
    ds_read_b128 v[68:71], v3 offset:512
    ds_read_b128 v[104:107], v4 offset:2560
    ds_read_b128 v[72:75], v3 offset:1024
    ds_read_b128 v[108:111], v4 offset:2048
    ds_read_b128 v[76:79], v3 offset:1536
    ds_read_b128 v[112:115], v4 offset:1536
    ds_read_b128 v[80:83], v3 offset:2048
    ds_read_b128 v[116:119], v4 offset:1024
    ds_read_b128 v[84:87], v3 offset:2560
    ds_read_b128 v[120:123], v4 offset:512
    ds_read_b128 v[88:91], v3 offset:3072
    ds_read_b128 v[124:127], v4 offset:0
    ds_read_b128 v[92:95], v3 offset:3584
    s_waitcnt lgkmcnt(0)
    v_mfma_f32_16x16x32_bf16 v[32:35], v[24:27], v[96:99], 0
    s_and_b32 s45, s2, 3
    s_bfe_u32 s38, s2, 0x20003
    v_mfma_f32_16x16x32_bf16 v[36:39], v[24:27], v[100:103], 0
    s_and_b32 s36, s2, 4
    s_add_u32 s38, s38, s36
    v_mfma_f32_16x16x32_bf16 v[40:43], v[24:27], v[104:107], 0
    ds_read_b128 v[160:163], v4 offset:3648
    s_lshr_b32 s39, s2, 5
    s_xor_b32 s37, s45, 3
    v_mfma_f32_16x16x32_bf16 v[44:47], v[24:27], v[108:111], 0
    s_lshl_b32 s37, s37, 2
    v_lshlrev_b32 v233, 1, v7
    v_xor_b32 v233, v233, v6
    v_mfma_f32_16x16x32_bf16 v[48:51], v[24:27], v[112:115], 0
    ds_read_b128 v[128:131], v3 offset:64
    v_xor_b32 v233, s37, v233
    v_mfma_f32_16x16x32_bf16 v[52:55], v[24:27], v[116:119], 0
    v_lshlrev_b32 v233, 4, v233
    v_lshl_add_u32 v0, v7, 11, v233
    v_mfma_f32_16x16x32_bf16 v[56:59], v[24:27], v[120:123], 0
    ds_read_b128 v[164:167], v4 offset:3136
    v_add_u32 v1, 7040, v0
    s_lshl_b32 s40, s45, 21
    s_lshl_b32 s37, s32, 14
    v_mfma_f32_16x16x32_bf16 v[60:63], v[24:27], v[124:127], 0
    s_add_u32 s40, s40, s37
    s_lshl_b32 s37, s39, 8
    v_mfma_f32_16x16x32_bf16 v[32:35], v[64:67], v[96:99], v[32:35]
    ds_read_b128 v[132:135], v3 offset:576
    s_add_u32 s40, s40, s37
    s_add_u32 m0, s59, 108544
    v_mfma_f32_16x16x32_bf16 v[36:39], v[64:67], v[100:103], v[36:39]
    buffer_load_dwordx4 v0, s[8:11], s40 offen offset:0 lds
    v_mfma_f32_16x16x32_bf16 v[40:43], v[64:67], v[104:107], v[40:43]
    ds_read_b128 v[168:171], v4 offset:2624
    v_mfma_f32_16x16x32_bf16 v[44:47], v[64:67], v[108:111], v[44:47]
    buffer_load_dwordx4 v1, s[8:11], s40 offen offset:1152 lds
    v_mfma_f32_16x16x32_bf16 v[48:51], v[64:67], v[112:115], v[48:51]
    ds_read_b128 v[136:139], v3 offset:1088
    s_add_u32 s40, s40, 65536
    s_add_u32 m0, s59, 117760
    v_mfma_f32_16x16x32_bf16 v[52:55], v[64:67], v[116:119], v[52:55]
    buffer_load_dwordx4 v0, s[8:11], s40 offen offset:0 lds
    v_mfma_f32_16x16x32_bf16 v[56:59], v[64:67], v[120:123], v[56:59]
    ds_read_b128 v[172:175], v4 offset:2112
    v_mfma_f32_16x16x32_bf16 v[60:63], v[64:67], v[124:127], v[60:63]
    buffer_load_dwordx4 v1, s[8:11], s40 offen offset:1152 lds
    v_mfma_f32_16x16x32_bf16 v[36:39], v[68:71], v[96:99], v[36:39]
    ds_read_b128 v[140:143], v3 offset:1600
    s_add_u32 s40, s40, 65536
    s_add_u32 m0, s59, 126976
    v_mfma_f32_16x16x32_bf16 v[40:43], v[68:71], v[100:103], v[40:43]
    buffer_load_dwordx4 v0, s[8:11], s40 offen offset:0 lds
    v_mfma_f32_16x16x32_bf16 v[44:47], v[68:71], v[104:107], v[44:47]
    ds_read_b128 v[176:179], v4 offset:1600
    v_mfma_f32_16x16x32_bf16 v[48:51], v[68:71], v[108:111], v[48:51]
    buffer_load_dwordx4 v1, s[8:11], s40 offen offset:1152 lds
    v_mfma_f32_16x16x32_bf16 v[52:55], v[68:71], v[112:115], v[52:55]
    ds_read_b128 v[144:147], v3 offset:2112
    s_add_u32 s40, s40, 65536
    s_lshl_b32 s52, s38, 2
    v_mfma_f32_16x16x32_bf16 v[56:59], v[68:71], v[116:119], v[56:59]
    s_add_u32 s52, s52, s32
    s_lshl_b32 s52, s52, 7
    v_mfma_f32_16x16x32_bf16 v[60:63], v[68:71], v[120:123], v[60:63]
    ds_read_b128 v[180:183], v4 offset:1088
    s_lshl_b32 s37, s45, 5
    s_add_u32 s52, s52, s37
    v_and_b32 v13, 7, v6
    v_mfma_f32_16x16x32_bf16 v[40:43], v[72:75], v[96:99], v[40:43]
    v_lshlrev_b32 v13, 2, v13
    v_add_u32 v2, 524288, v16
    s_lshl_b32 s41, s38, 3
    s_add_u32 s41, s41, s32
    v_mfma_f32_16x16x32_bf16 v[44:47], v[72:75], v[100:103], v[44:47]
    ds_read_b128 v[148:151], v3 offset:2624
    s_lshl_b32 s41, s41, 17
    s_lshl_b32 s37, s45, 15
    v_mfma_f32_16x16x32_bf16 v[48:51], v[72:75], v[104:107], v[48:51]
    s_add_u32 s41, s41, s37
    s_add_u32 s42, s41, 8388608
    buffer_load_dword v14, v13, s[28:31], s52 offen sc1
    v_mfma_f32_16x16x32_bf16 v[52:55], v[72:75], v[108:111], v[52:55]
    ds_read_b128 v[184:187], v4 offset:576
    s_add_u32 m0, s59, 136192
    v_mfma_f32_16x16x32_bf16 v[56:59], v[72:75], v[112:115], v[56:59]
    buffer_load_dwordx4 v0, s[8:11], s40 offen offset:0 lds
    v_mfma_f32_16x16x32_bf16 v[60:63], v[72:75], v[116:119], v[60:63]
    ds_read_b128 v[152:155], v3 offset:3136
    v_mfma_f32_16x16x32_bf16 v[44:47], v[76:79], v[96:99], v[44:47]
    buffer_load_dwordx4 v1, s[8:11], s40 offen offset:1152 lds
    v_mfma_f32_16x16x32_bf16 v[48:51], v[76:79], v[100:103], v[48:51]
    ds_read_b128 v[188:191], v4 offset:64
    s_add_u32 s40, s40, 65536
    v_mfma_f32_16x16x32_bf16 v[52:55], v[76:79], v[104:107], v[52:55]
    v_mfma_f32_16x16x32_bf16 v[56:59], v[76:79], v[108:111], v[56:59]
    ds_read_b128 v[156:159], v3 offset:3648
    v_mfma_f32_16x16x32_bf16 v[60:63], v[76:79], v[112:115], v[60:63]
    v_mfma_f32_16x16x32_bf16 v[48:51], v[80:83], v[96:99], v[48:51]
    v_mfma_f32_16x16x32_bf16 v[52:55], v[80:83], v[100:103], v[52:55]
    v_mfma_f32_16x16x32_bf16 v[56:59], v[80:83], v[104:107], v[56:59]
    v_mfma_f32_16x16x32_bf16 v[60:63], v[80:83], v[108:111], v[60:63]
    v_mfma_f32_16x16x32_bf16 v[52:55], v[84:87], v[96:99], v[52:55]
    v_mfma_f32_16x16x32_bf16 v[56:59], v[84:87], v[100:103], v[56:59]
    v_mfma_f32_16x16x32_bf16 v[60:63], v[84:87], v[104:107], v[60:63]
    v_mfma_f32_16x16x32_bf16 v[56:59], v[88:91], v[96:99], v[56:59]
    v_mfma_f32_16x16x32_bf16 v[60:63], v[88:91], v[100:103], v[60:63]
    v_mfma_f32_16x16x32_bf16 v[60:63], v[92:95], v[96:99], v[60:63]
    s_waitcnt lgkmcnt(0)
    v_mfma_f32_16x16x32_bf16 v[32:35], v[28:31], v[160:163], v[32:35]
    s_waitcnt vmcnt(9)
    buffer_store_dword v9, v8, s[28:31], s56 offen sc1
    v_mfma_f32_16x16x32_bf16 v[36:39], v[28:31], v[164:167], v[36:39]
    s_add_u32 m0, s59, 145408
    v_mfma_f32_16x16x32_bf16 v[40:43], v[28:31], v[168:171], v[40:43]
    ds_read_b128 v[96:99], v4 offset:3712
    v_mfma_f32_16x16x32_bf16 v[44:47], v[28:31], v[172:175], v[44:47]
    buffer_load_dwordx4 v0, s[8:11], s40 offen offset:0 lds
    v_mfma_f32_16x16x32_bf16 v[48:51], v[28:31], v[176:179], v[48:51]
    ds_read_b128 v[64:67], v3 offset:128
    v_mfma_f32_16x16x32_bf16 v[52:55], v[28:31], v[180:183], v[52:55]
    buffer_load_dwordx4 v1, s[8:11], s40 offen offset:1152 lds
    v_mfma_f32_16x16x32_bf16 v[56:59], v[28:31], v[184:187], v[56:59]
    ds_read_b128 v[100:103], v4 offset:3200
    s_add_u32 s40, s40, 65536
    s_add_u32 m0, s59, 154624
    v_mfma_f32_16x16x32_bf16 v[60:63], v[28:31], v[188:191], v[60:63]
    buffer_load_dwordx4 v0, s[8:11], s40 offen offset:0 lds
    v_mfma_f32_16x16x32_bf16 v[32:35], v[128:131], v[160:163], v[32:35]
    ds_read_b128 v[68:71], v3 offset:640
    v_mfma_f32_16x16x32_bf16 v[36:39], v[128:131], v[164:167], v[36:39]
    buffer_load_dwordx4 v1, s[8:11], s40 offen offset:1152 lds
    v_mfma_f32_16x16x32_bf16 v[40:43], v[128:131], v[168:171], v[40:43]
    ds_read_b128 v[104:107], v4 offset:2688
    s_add_u32 s40, s40, 65536
    v_mul_u32_u24 v233, 1152, v7
    v_mfma_f32_16x16x32_bf16 v[44:47], v[128:131], v[172:175], v[44:47]
    v_lshrrev_b32 v234, 2, v6
    v_lshl_add_u32 v233, v234, 8, v233
    v_mfma_f32_16x16x32_bf16 v[48:51], v[128:131], v[176:179], v[48:51]
    ds_read_b128 v[72:75], v3 offset:1152
    v_and_b32 v235, 3, v6
    v_mfma_f32_16x16x32_bf16 v[52:55], v[128:131], v[180:183], v[52:55]
    v_lshl_add_u32 v233, v235, 3, v233
    v_add_u32 v233, 80896, v233
    v_mfma_f32_16x16x32_bf16 v[56:59], v[128:131], v[184:187], v[56:59]
    ds_read_b128 v[108:111], v4 offset:2176
    v_xor_b32 v236, 0, v234
    v_mfma_f32_16x16x32_bf16 v[60:63], v[128:131], v[188:191], v[60:63]
    v_lshl_add_u32 v17, v236, 5, v233
    v_xor_b32 v236, 1, v234
    v_mfma_f32_16x16x32_bf16 v[36:39], v[132:135], v[160:163], v[36:39]
    ds_read_b128 v[76:79], v3 offset:1664
    v_lshl_add_u32 v18, v236, 5, v233
    v_mfma_f32_16x16x32_bf16 v[40:43], v[132:135], v[164:167], v[40:43]
    v_xor_b32 v236, 2, v234
    v_lshl_add_u32 v19, v236, 5, v233
    v_mfma_f32_16x16x32_bf16 v[44:47], v[132:135], v[168:171], v[44:47]
    ds_read_b128 v[112:115], v4 offset:1664
    v_xor_b32 v236, 3, v234
    v_mfma_f32_16x16x32_bf16 v[48:51], v[132:135], v[172:175], v[48:51]
    v_lshl_add_u32 v20, v236, 5, v233
    v_lshlrev_b32 v236, 3, v7
    v_mfma_f32_16x16x32_bf16 v[52:55], v[132:135], v[176:179], v[52:55]
    ds_read_b128 v[80:83], v3 offset:2176
    v_lshl_add_u32 v5, v6, 5, v236
    v_mfma_f32_16x16x32_bf16 v[56:59], v[132:135], v[180:183], v[56:59]
    v_lshl_add_u32 v21, v6, 13, v236
    v_and_b32 v236, 1, v7
    v_mfma_f32_16x16x32_bf16 v[60:63], v[132:135], v[184:187], v[60:63]
    ds_read_b128 v[116:119], v4 offset:1152
    v_mad_u32_u24 v21, v236, 24, v21
    v_mfma_f32_16x16x32_bf16 v[40:43], v[136:139], v[160:163], v[40:43]
    v_mul_u32_u24 v236, 504, v236
    v_add_u32 v5, v5, v236
    v_mfma_f32_16x16x32_bf16 v[44:47], v[136:139], v[164:167], v[44:47]
    ds_read_b128 v[84:87], v3 offset:2688
    v_lshlrev_b32 v10, 11, v7
    v_mfma_f32_16x16x32_bf16 v[48:51], v[136:139], v[168:171], v[48:51]
    v_lshl_add_u32 v10, v6, 4, v10
    v_lshrrev_b32 v236, 2, v232
    v_mfma_f32_16x16x32_bf16 v[52:55], v[136:139], v[172:175], v[52:55]
    ds_read_b128 v[120:123], v4 offset:640
    v_lshlrev_b32 v236, 9, v236
    v_mfma_f32_16x16x32_bf16 v[56:59], v[136:139], v[176:179], v[56:59]
    v_lshl_add_u32 v236, v235, 3, v236
    s_lshl_b32 s37, s32, 5
    v_add_u32 v22, s37, v236
    v_mfma_f32_16x16x32_bf16 v[60:63], v[136:139], v[180:183], v[60:63]
    ds_read_b128 v[88:91], v3 offset:3200
    v_lshlrev_b32 v23, 4, v6
    s_lshl_b32 s48, s38, 7
    s_add_u32 s48, s48, s32
    v_mfma_f32_16x16x32_bf16 v[44:47], v[140:143], v[160:163], v[44:47]
    s_lshl_b32 s50, s48, 2
    s_lshl_b32 s48, s48, 11
    v_mfma_f32_16x16x32_bf16 v[48:51], v[140:143], v[164:167], v[48:51]
    ds_read_b128 v[124:127], v4 offset:128
    s_lshl_b32 s37, s39, 2
    s_add_u32 s37, s37, s45
    v_mfma_f32_16x16x32_bf16 v[52:55], v[140:143], v[168:171], v[52:55]
    s_lshl_b32 s51, s37, 2
    s_lshl_b32 s37, s37, 6
    v_mfma_f32_16x16x32_bf16 v[56:59], v[140:143], v[172:175], v[56:59]
    ds_read_b128 v[92:95], v3 offset:3712
    s_add_u32 s48, s48, s37
    s_add_u32 s51, s51, s32
    v_mfma_f32_16x16x32_bf16 v[60:63], v[140:143], v[176:179], v[60:63]
    s_lshl_b32 s53, s51, 5
    s_add_u32 s53, s53, 8192
    v_mfma_f32_16x16x32_bf16 v[48:51], v[144:147], v[160:163], v[48:51]
    s_lshl_b32 s51, s51, 15
    s_lshl_b32 s37, s38, 8
    v_mfma_f32_16x16x32_bf16 v[52:55], v[144:147], v[164:167], v[52:55]
    s_add_u32 s51, s51, s37
    s_add_u32 s12, s94, 55574528
    s_addc_u32 s13, s95, 0
    v_mfma_f32_16x16x32_bf16 v[56:59], v[144:147], v[168:171], v[56:59]
    s_mov_b32 s14, 4194304
    s_mov_b32 s20, s90
    v_mfma_f32_16x16x32_bf16 v[60:63], v[144:147], v[172:175], v[60:63]
    s_mov_b32 s21, s91
    s_mov_b32 s22, 4194304
    v_mfma_f32_16x16x32_bf16 v[52:55], v[148:151], v[160:163], v[52:55]
    s_add_u32 s4, s94, 59768832
    s_addc_u32 s5, s95, 0
    s_mov_b32 s6, 8192
    v_mfma_f32_16x16x32_bf16 v[56:59], v[148:151], v[164:167], v[56:59]
    s_mov_b32 s24, s64
    s_mov_b32 s25, s65
    v_mfma_f32_16x16x32_bf16 v[60:63], v[148:151], v[168:171], v[60:63]
    s_mov_b32 s26, 4194304
    s_lshl_b32 s46, s44, 2
    v_mfma_f32_16x16x32_bf16 v[56:59], v[152:155], v[160:163], v[56:59]
    v_mfma_f32_16x16x32_bf16 v[60:63], v[152:155], v[164:167], v[60:63]
    v_mfma_f32_16x16x32_bf16 v[60:63], v[156:159], v[160:163], v[60:63]
    s_waitcnt lgkmcnt(0)
    s_waitcnt vmcnt(7)
    v_cmp_ne_u32 vcc, 1, v14
    s_nop 0
    s_cbranch_vccnz gated_mix__ssm_conv_h3__compressed_kv_cla__prompt_kernel_spin_s
gated_mix__ssm_conv_h3__compressed_kv_cla__prompt_kernel_spin_s_ret:
    v_mfma_f32_16x16x32_bf16 v[32:35], v[64:67], v[96:99], v[32:35]
    buffer_load_dwordx4 a[0:3], v16, s[16:19], s41 offen offset:0 sc1
    v_mfma_f32_16x16x32_bf16 v[36:39], v[64:67], v[100:103], v[36:39]
    buffer_load_dwordx4 a[4:7], v2, s[16:19], s41 offen offset:0 sc1
    v_mfma_f32_16x16x32_bf16 v[40:43], v[64:67], v[104:107], v[40:43]
    ds_read_b128 v[160:163], v4 offset:3776
    v_mfma_f32_16x16x32_bf16 v[44:47], v[64:67], v[108:111], v[44:47]
    buffer_load_dwordx4 a[8:11], v16, s[16:19], s41 offen offset:1024 sc1
    v_mfma_f32_16x16x32_bf16 v[48:51], v[64:67], v[112:115], v[48:51]
    ds_read_b128 v[128:131], v3 offset:192
    v_mfma_f32_16x16x32_bf16 v[52:55], v[64:67], v[116:119], v[52:55]
    buffer_load_dwordx4 a[12:15], v2, s[16:19], s41 offen offset:1024 sc1
    v_mfma_f32_16x16x32_bf16 v[56:59], v[64:67], v[120:123], v[56:59]
    ds_read_b128 v[164:167], v4 offset:3264
    v_mfma_f32_16x16x32_bf16 v[60:63], v[64:67], v[124:127], v[60:63]
gated_mix__ssm_conv_h3__compressed_kv_cla__prompt_kernel_pad11:
    s_cbranch_execz gated_mix__ssm_conv_h3__compressed_kv_cla__prompt_kernel_pad15
    buffer_load_dwordx4 a[16:19], v16, s[16:19], s41 offen offset:2048 sc1
    v_mfma_f32_16x16x32_bf16 v[36:39], v[68:71], v[96:99], v[36:39]
    ds_read_b128 v[132:135], v3 offset:704
    v_mfma_f32_16x16x32_bf16 v[40:43], v[68:71], v[100:103], v[40:43]
    buffer_load_dwordx4 a[20:23], v2, s[16:19], s41 offen offset:2048 sc1
    v_mfma_f32_16x16x32_bf16 v[44:47], v[68:71], v[104:107], v[44:47]
    ds_read_b128 v[168:171], v4 offset:2752
    v_mfma_f32_16x16x32_bf16 v[48:51], v[68:71], v[108:111], v[48:51]
    buffer_load_dwordx4 a[24:27], v16, s[16:19], s41 offen offset:3072 sc1
    v_mfma_f32_16x16x32_bf16 v[52:55], v[68:71], v[112:115], v[52:55]
    ds_read_b128 v[136:139], v3 offset:1216
    v_mfma_f32_16x16x32_bf16 v[56:59], v[68:71], v[116:119], v[56:59]
    buffer_load_dwordx4 a[28:31], v2, s[16:19], s41 offen offset:3072 sc1
    v_mfma_f32_16x16x32_bf16 v[60:63], v[68:71], v[120:123], v[60:63]
    ds_read_b128 v[172:175], v4 offset:2240
    s_add_u32 s41, s41, 4096
    v_mfma_f32_16x16x32_bf16 v[40:43], v[72:75], v[96:99], v[40:43]
    buffer_load_dwordx4 a[32:35], v16, s[16:19], s41 offen offset:0 sc1
    v_mfma_f32_16x16x32_bf16 v[44:47], v[72:75], v[100:103], v[44:47]
    ds_read_b128 v[140:143], v3 offset:1728
    v_mfma_f32_16x16x32_bf16 v[48:51], v[72:75], v[104:107], v[48:51]
    buffer_load_dwordx4 a[36:39], v2, s[16:19], s41 offen offset:0 sc1
    v_mfma_f32_16x16x32_bf16 v[52:55], v[72:75], v[108:111], v[52:55]
    ds_read_b128 v[176:179], v4 offset:1728
    v_mfma_f32_16x16x32_bf16 v[56:59], v[72:75], v[112:115], v[56:59]
    buffer_load_dwordx4 a[40:43], v16, s[16:19], s41 offen offset:1024 sc1
    v_mfma_f32_16x16x32_bf16 v[60:63], v[72:75], v[116:119], v[60:63]
    ds_read_b128 v[144:147], v3 offset:2240
    v_mfma_f32_16x16x32_bf16 v[44:47], v[76:79], v[96:99], v[44:47]
    buffer_load_dwordx4 a[44:47], v2, s[16:19], s41 offen offset:1024 sc1
    v_mfma_f32_16x16x32_bf16 v[48:51], v[76:79], v[100:103], v[48:51]
    ds_read_b128 v[180:183], v4 offset:1216
    v_mfma_f32_16x16x32_bf16 v[52:55], v[76:79], v[104:107], v[52:55]
    buffer_load_dwordx4 a[48:51], v16, s[16:19], s41 offen offset:2048 sc1
    v_mfma_f32_16x16x32_bf16 v[56:59], v[76:79], v[108:111], v[56:59]
    ds_read_b128 v[148:151], v3 offset:2752
    v_mfma_f32_16x16x32_bf16 v[60:63], v[76:79], v[112:115], v[60:63]
    buffer_load_dwordx4 a[52:55], v2, s[16:19], s41 offen offset:2048 sc1
    v_mfma_f32_16x16x32_bf16 v[48:51], v[80:83], v[96:99], v[48:51]
    ds_read_b128 v[184:187], v4 offset:704
    v_mfma_f32_16x16x32_bf16 v[52:55], v[80:83], v[100:103], v[52:55]
    buffer_load_dwordx4 a[56:59], v16, s[16:19], s41 offen offset:3072 sc1
    v_mfma_f32_16x16x32_bf16 v[56:59], v[80:83], v[104:107], v[56:59]
    ds_read_b128 v[152:155], v3 offset:3264
    v_mfma_f32_16x16x32_bf16 v[60:63], v[80:83], v[108:111], v[60:63]
    buffer_load_dwordx4 a[60:63], v2, s[16:19], s41 offen offset:3072 sc1
    v_mfma_f32_16x16x32_bf16 v[52:55], v[84:87], v[96:99], v[52:55]
    ds_read_b128 v[188:191], v4 offset:192
    s_add_u32 s41, s41, 4096
    v_mfma_f32_16x16x32_bf16 v[56:59], v[84:87], v[100:103], v[56:59]
    v_mfma_f32_16x16x32_bf16 v[60:63], v[84:87], v[104:107], v[60:63]
    ds_read_b128 v[156:159], v3 offset:3776
    v_mfma_f32_16x16x32_bf16 v[56:59], v[88:91], v[96:99], v[56:59]
    v_mfma_f32_16x16x32_bf16 v[60:63], v[88:91], v[100:103], v[60:63]
    v_mfma_f32_16x16x32_bf16 v[60:63], v[92:95], v[96:99], v[60:63]
    s_waitcnt lgkmcnt(0)
    v_mfma_f32_16x16x32_bf16 v[32:35], v[128:131], v[160:163], v[32:35]
    buffer_load_dwordx4 a[64:67], v16, s[16:19], s41 offen offset:0 sc1
    v_mfma_f32_16x16x32_bf16 v[36:39], v[128:131], v[164:167], v[36:39]
    buffer_load_dwordx4 a[68:71], v2, s[16:19], s41 offen offset:0 sc1
    v_mfma_f32_16x16x32_bf16 v[40:43], v[128:131], v[168:171], v[40:43]
    ds_read_b128 v[96:99], v4 offset:3840
    v_mfma_f32_16x16x32_bf16 v[44:47], v[128:131], v[172:175], v[44:47]
    buffer_load_dwordx4 a[72:75], v16, s[16:19], s41 offen offset:1024 sc1
    v_mfma_f32_16x16x32_bf16 v[48:51], v[128:131], v[176:179], v[48:51]
    ds_read_b128 v[64:67], v3 offset:256
    v_mfma_f32_16x16x32_bf16 v[52:55], v[128:131], v[180:183], v[52:55]
    buffer_load_dwordx4 a[76:79], v2, s[16:19], s41 offen offset:1024 sc1
    v_mfma_f32_16x16x32_bf16 v[56:59], v[128:131], v[184:187], v[56:59]
    ds_read_b128 v[100:103], v4 offset:3328
    v_mfma_f32_16x16x32_bf16 v[60:63], v[128:131], v[188:191], v[60:63]
    buffer_load_dwordx4 a[80:83], v16, s[16:19], s41 offen offset:2048 sc1
    v_mfma_f32_16x16x32_bf16 v[36:39], v[132:135], v[160:163], v[36:39]
    ds_read_b128 v[68:71], v3 offset:768
    v_mfma_f32_16x16x32_bf16 v[40:43], v[132:135], v[164:167], v[40:43]
    buffer_load_dwordx4 a[84:87], v2, s[16:19], s41 offen offset:2048 sc1
    v_mfma_f32_16x16x32_bf16 v[44:47], v[132:135], v[168:171], v[44:47]
    ds_read_b128 v[104:107], v4 offset:2816
    v_mfma_f32_16x16x32_bf16 v[48:51], v[132:135], v[172:175], v[48:51]
    buffer_load_dwordx4 a[88:91], v16, s[16:19], s41 offen offset:3072 sc1
    v_mfma_f32_16x16x32_bf16 v[52:55], v[132:135], v[176:179], v[52:55]
    ds_read_b128 v[72:75], v3 offset:1280
    v_mfma_f32_16x16x32_bf16 v[56:59], v[132:135], v[180:183], v[56:59]
    buffer_load_dwordx4 a[92:95], v2, s[16:19], s41 offen offset:3072 sc1
    v_mfma_f32_16x16x32_bf16 v[60:63], v[132:135], v[184:187], v[60:63]
    ds_read_b128 v[108:111], v4 offset:2304
    s_add_u32 s41, s41, 4096
    v_mfma_f32_16x16x32_bf16 v[40:43], v[136:139], v[160:163], v[40:43]
    buffer_load_dwordx4 a[96:99], v16, s[16:19], s41 offen offset:0 sc1
    v_mfma_f32_16x16x32_bf16 v[44:47], v[136:139], v[164:167], v[44:47]
    ds_read_b128 v[76:79], v3 offset:1792
    v_mfma_f32_16x16x32_bf16 v[48:51], v[136:139], v[168:171], v[48:51]
    buffer_load_dwordx4 a[100:103], v2, s[16:19], s41 offen offset:0 sc1
    v_mfma_f32_16x16x32_bf16 v[52:55], v[136:139], v[172:175], v[52:55]
    ds_read_b128 v[112:115], v4 offset:1792
    v_mfma_f32_16x16x32_bf16 v[56:59], v[136:139], v[176:179], v[56:59]
    buffer_load_dwordx4 a[104:107], v16, s[16:19], s41 offen offset:1024 sc1
    v_mfma_f32_16x16x32_bf16 v[60:63], v[136:139], v[180:183], v[60:63]
    ds_read_b128 v[80:83], v3 offset:2304
    v_mfma_f32_16x16x32_bf16 v[44:47], v[140:143], v[160:163], v[44:47]
    buffer_load_dwordx4 a[108:111], v2, s[16:19], s41 offen offset:1024 sc1
    v_mfma_f32_16x16x32_bf16 v[48:51], v[140:143], v[164:167], v[48:51]
    ds_read_b128 v[116:119], v4 offset:1280
    v_mfma_f32_16x16x32_bf16 v[52:55], v[140:143], v[168:171], v[52:55]
    buffer_load_dwordx4 a[112:115], v16, s[16:19], s41 offen offset:2048 sc1
    v_mfma_f32_16x16x32_bf16 v[56:59], v[140:143], v[172:175], v[56:59]
    ds_read_b128 v[84:87], v3 offset:2816
    v_mfma_f32_16x16x32_bf16 v[60:63], v[140:143], v[176:179], v[60:63]
    buffer_load_dwordx4 a[116:119], v2, s[16:19], s41 offen offset:2048 sc1
    v_mfma_f32_16x16x32_bf16 v[48:51], v[144:147], v[160:163], v[48:51]
    ds_read_b128 v[120:123], v4 offset:768
    v_mfma_f32_16x16x32_bf16 v[52:55], v[144:147], v[164:167], v[52:55]
    v_mfma_f32_16x16x32_bf16 v[56:59], v[144:147], v[168:171], v[56:59]
    ds_read_b128 v[88:91], v3 offset:3328
    v_mfma_f32_16x16x32_bf16 v[60:63], v[144:147], v[172:175], v[60:63]
    v_mfma_f32_16x16x32_bf16 v[52:55], v[148:151], v[160:163], v[52:55]
    ds_read_b128 v[124:127], v4 offset:256
    v_mfma_f32_16x16x32_bf16 v[56:59], v[148:151], v[164:167], v[56:59]
    v_mfma_f32_16x16x32_bf16 v[60:63], v[148:151], v[168:171], v[60:63]
    ds_read_b128 v[92:95], v3 offset:3840
    v_mfma_f32_16x16x32_bf16 v[56:59], v[152:155], v[160:163], v[56:59]
    v_mfma_f32_16x16x32_bf16 v[60:63], v[152:155], v[164:167], v[60:63]
    v_mfma_f32_16x16x32_bf16 v[60:63], v[156:159], v[160:163], v[60:63]
    s_waitcnt lgkmcnt(0)
    v_mfma_f32_16x16x32_bf16 v[32:35], v[64:67], v[96:99], v[32:35]
    s_add_u32 s36, s48, 0
    buffer_load_dwordx4 v[24:27], v21, s[24:27], s36 offen
    v_mfma_f32_16x16x32_bf16 v[36:39], v[64:67], v[100:103], v[36:39]
    s_add_u32 s36, s48, 131072
    buffer_load_dwordx4 v[28:31], v21, s[24:27], s36 offen
    v_mfma_f32_16x16x32_bf16 v[40:43], v[64:67], v[104:107], v[40:43]
    ds_read_b128 v[160:163], v4 offset:3904
    s_add_u32 s36, s50, 0
    v_mfma_f32_16x16x32_bf16 v[44:47], v[64:67], v[108:111], v[44:47]
    buffer_load_dword v6, v23, s[4:7], s36 offen sc1
    v_mfma_f32_16x16x32_bf16 v[48:51], v[64:67], v[112:115], v[48:51]
    ds_read_b128 v[128:131], v3 offset:320
    s_add_u32 s36, s50, 256
    v_mfma_f32_16x16x32_bf16 v[52:55], v[64:67], v[116:119], v[52:55]
    buffer_load_dword v7, v23, s[4:7], s36 offen sc1
    v_mfma_f32_16x16x32_bf16 v[56:59], v[64:67], v[120:123], v[56:59]
    ds_read_b128 v[164:167], v4 offset:3392
    s_add_u32 s36, s50, 4096
    v_mfma_f32_16x16x32_bf16 v[60:63], v[64:67], v[124:127], v[60:63]
    buffer_load_dword v11, v23, s[4:7], s36 offen sc1
    v_mfma_f32_16x16x32_bf16 v[36:39], v[68:71], v[96:99], v[36:39]
    ds_read_b128 v[132:135], v3 offset:832
    s_add_u32 s36, s50, 4352
    v_mfma_f32_16x16x32_bf16 v[40:43], v[68:71], v[100:103], v[40:43]
    buffer_load_dword v12, v23, s[4:7], s36 offen sc1
    v_mfma_f32_16x16x32_bf16 v[44:47], v[68:71], v[104:107], v[44:47]
    ds_read_b128 v[168:171], v4 offset:2880
    s_add_u32 s52, s52, 4096
    v_mfma_f32_16x16x32_bf16 v[48:51], v[68:71], v[108:111], v[48:51]
    buffer_load_dword v14, v13, s[28:31], s52 offen sc1
    v_mfma_f32_16x16x32_bf16 v[52:55], v[68:71], v[112:115], v[52:55]
    ds_read_b128 v[136:139], v3 offset:1344
    v_mfma_f32_16x16x32_bf16 v[56:59], v[68:71], v[116:119], v[56:59]
    v_mfma_f32_16x16x32_bf16 v[60:63], v[68:71], v[120:123], v[60:63]
    ds_read_b128 v[172:175], v4 offset:2368
    v_mfma_f32_16x16x32_bf16 v[40:43], v[72:75], v[96:99], v[40:43]
    v_mfma_f32_16x16x32_bf16 v[44:47], v[72:75], v[100:103], v[44:47]
    ds_read_b128 v[140:143], v3 offset:1856
    v_mfma_f32_16x16x32_bf16 v[48:51], v[72:75], v[104:107], v[48:51]
    v_mfma_f32_16x16x32_bf16 v[52:55], v[72:75], v[108:111], v[52:55]
    ds_read_b128 v[176:179], v4 offset:1856
    v_mfma_f32_16x16x32_bf16 v[56:59], v[72:75], v[112:115], v[56:59]
    v_mfma_f32_16x16x32_bf16 v[60:63], v[72:75], v[116:119], v[60:63]
    ds_read_b128 v[144:147], v3 offset:2368
    v_mfma_f32_16x16x32_bf16 v[44:47], v[76:79], v[96:99], v[44:47]
    v_mfma_f32_16x16x32_bf16 v[48:51], v[76:79], v[100:103], v[48:51]
    ds_read_b128 v[180:183], v4 offset:1344
    v_mfma_f32_16x16x32_bf16 v[52:55], v[76:79], v[104:107], v[52:55]
    v_mfma_f32_16x16x32_bf16 v[56:59], v[76:79], v[108:111], v[56:59]
    ds_read_b128 v[148:151], v3 offset:2880
    v_mfma_f32_16x16x32_bf16 v[60:63], v[76:79], v[112:115], v[60:63]
    v_mfma_f32_16x16x32_bf16 v[48:51], v[80:83], v[96:99], v[48:51]
    ds_read_b128 v[184:187], v4 offset:832
    v_mfma_f32_16x16x32_bf16 v[52:55], v[80:83], v[100:103], v[52:55]
    v_mfma_f32_16x16x32_bf16 v[56:59], v[80:83], v[104:107], v[56:59]
    ds_read_b128 v[152:155], v3 offset:3392
    v_mfma_f32_16x16x32_bf16 v[60:63], v[80:83], v[108:111], v[60:63]
    v_mfma_f32_16x16x32_bf16 v[52:55], v[84:87], v[96:99], v[52:55]
    ds_read_b128 v[188:191], v4 offset:320
    v_mfma_f32_16x16x32_bf16 v[56:59], v[84:87], v[100:103], v[56:59]
    v_mfma_f32_16x16x32_bf16 v[60:63], v[84:87], v[104:107], v[60:63]
    ds_read_b128 v[156:159], v3 offset:3904
    v_mfma_f32_16x16x32_bf16 v[56:59], v[88:91], v[96:99], v[56:59]
    v_mfma_f32_16x16x32_bf16 v[60:63], v[88:91], v[100:103], v[60:63]
    v_mfma_f32_16x16x32_bf16 v[60:63], v[92:95], v[96:99], v[60:63]
    s_waitcnt lgkmcnt(0)
    v_mfma_f32_16x16x32_bf16 v[32:35], v[128:131], v[160:163], v[32:35]
    v_mfma_f32_16x16x32_bf16 v[36:39], v[128:131], v[164:167], v[36:39]
    v_mfma_f32_16x16x32_bf16 v[40:43], v[128:131], v[168:171], v[40:43]
    ds_read_b128 v[96:99], v4 offset:3968
    v_mfma_f32_16x16x32_bf16 v[44:47], v[128:131], v[172:175], v[44:47]
    v_mfma_f32_16x16x32_bf16 v[48:51], v[128:131], v[176:179], v[48:51]
    ds_read_b128 v[64:67], v3 offset:384
    v_mfma_f32_16x16x32_bf16 v[52:55], v[128:131], v[180:183], v[52:55]
    v_mfma_f32_16x16x32_bf16 v[56:59], v[128:131], v[184:187], v[56:59]
    ds_read_b128 v[100:103], v4 offset:3456
    v_mfma_f32_16x16x32_bf16 v[60:63], v[128:131], v[188:191], v[60:63]
    v_mfma_f32_16x16x32_bf16 v[36:39], v[132:135], v[160:163], v[36:39]
    ds_read_b128 v[68:71], v3 offset:896
    v_mfma_f32_16x16x32_bf16 v[40:43], v[132:135], v[164:167], v[40:43]
    v_mfma_f32_16x16x32_bf16 v[44:47], v[132:135], v[168:171], v[44:47]
    ds_read_b128 v[104:107], v4 offset:2944
    v_mfma_f32_16x16x32_bf16 v[48:51], v[132:135], v[172:175], v[48:51]
    v_mfma_f32_16x16x32_bf16 v[52:55], v[132:135], v[176:179], v[52:55]
    ds_read_b128 v[72:75], v3 offset:1408
    v_mfma_f32_16x16x32_bf16 v[56:59], v[132:135], v[180:183], v[56:59]
    v_mfma_f32_16x16x32_bf16 v[60:63], v[132:135], v[184:187], v[60:63]
    ds_read_b128 v[108:111], v4 offset:2432
    v_mfma_f32_16x16x32_bf16 v[40:43], v[136:139], v[160:163], v[40:43]
    v_mfma_f32_16x16x32_bf16 v[44:47], v[136:139], v[164:167], v[44:47]
    ds_read_b128 v[76:79], v3 offset:1920
    v_mfma_f32_16x16x32_bf16 v[48:51], v[136:139], v[168:171], v[48:51]
    v_mfma_f32_16x16x32_bf16 v[52:55], v[136:139], v[172:175], v[52:55]
    ds_read_b128 v[112:115], v4 offset:1920
    v_mfma_f32_16x16x32_bf16 v[56:59], v[136:139], v[176:179], v[56:59]
    v_mfma_f32_16x16x32_bf16 v[60:63], v[136:139], v[180:183], v[60:63]
    ds_read_b128 v[80:83], v3 offset:2432
    v_mfma_f32_16x16x32_bf16 v[44:47], v[140:143], v[160:163], v[44:47]
    v_mfma_f32_16x16x32_bf16 v[48:51], v[140:143], v[164:167], v[48:51]
    ds_read_b128 v[116:119], v4 offset:1408
    v_mfma_f32_16x16x32_bf16 v[52:55], v[140:143], v[168:171], v[52:55]
    v_mfma_f32_16x16x32_bf16 v[56:59], v[140:143], v[172:175], v[56:59]
    ds_read_b128 v[84:87], v3 offset:2944
    v_mfma_f32_16x16x32_bf16 v[60:63], v[140:143], v[176:179], v[60:63]
    v_mfma_f32_16x16x32_bf16 v[48:51], v[144:147], v[160:163], v[48:51]
    ds_read_b128 v[120:123], v4 offset:896
    v_mfma_f32_16x16x32_bf16 v[52:55], v[144:147], v[164:167], v[52:55]
    v_mfma_f32_16x16x32_bf16 v[56:59], v[144:147], v[168:171], v[56:59]
    ds_read_b128 v[88:91], v3 offset:3456
    v_mfma_f32_16x16x32_bf16 v[60:63], v[144:147], v[172:175], v[60:63]
    v_mfma_f32_16x16x32_bf16 v[52:55], v[148:151], v[160:163], v[52:55]
    ds_read_b128 v[124:127], v4 offset:384
    v_mfma_f32_16x16x32_bf16 v[56:59], v[148:151], v[164:167], v[56:59]
    v_mfma_f32_16x16x32_bf16 v[60:63], v[148:151], v[168:171], v[60:63]
    ds_read_b128 v[92:95], v3 offset:3968
    v_mfma_f32_16x16x32_bf16 v[56:59], v[152:155], v[160:163], v[56:59]
    v_mfma_f32_16x16x32_bf16 v[60:63], v[152:155], v[164:167], v[60:63]
    v_mfma_f32_16x16x32_bf16 v[60:63], v[156:159], v[160:163], v[60:63]
    s_waitcnt lgkmcnt(0)
    s_waitcnt vmcnt(0)
    v_cmp_ne_u32 vcc, 1, v14
    s_nop 0
    s_cbranch_vccnz gated_mix__ssm_conv_h3__compressed_kv_cla__prompt_kernel_spin_l
gated_mix__ssm_conv_h3__compressed_kv_cla__prompt_kernel_spin_l_ret:
    v_mfma_f32_16x16x32_bf16 v[32:35], v[64:67], v[96:99], v[32:35]
    buffer_load_dwordx4 a[128:131], v16, s[16:19], s42 offen offset:0 sc1
    v_mfma_f32_16x16x32_bf16 v[36:39], v[64:67], v[100:103], v[36:39]
    buffer_load_dwordx4 a[132:135], v2, s[16:19], s42 offen offset:0 sc1
    v_mfma_f32_16x16x32_bf16 v[40:43], v[64:67], v[104:107], v[40:43]
    ds_read_b128 v[160:163], v4 offset:4032
    v_mfma_f32_16x16x32_bf16 v[44:47], v[64:67], v[108:111], v[44:47]
    buffer_load_dwordx4 a[136:139], v16, s[16:19], s42 offen offset:1024 sc1
    v_mfma_f32_16x16x32_bf16 v[48:51], v[64:67], v[112:115], v[48:51]
    ds_read_b128 v[128:131], v3 offset:448
    v_mfma_f32_16x16x32_bf16 v[52:55], v[64:67], v[116:119], v[52:55]
    buffer_load_dwordx4 a[140:143], v2, s[16:19], s42 offen offset:1024 sc1
    v_mfma_f32_16x16x32_bf16 v[56:59], v[64:67], v[120:123], v[56:59]
    ds_read_b128 v[164:167], v4 offset:3520
    v_mfma_f32_16x16x32_bf16 v[60:63], v[64:67], v[124:127], v[60:63]
    buffer_load_dwordx4 a[144:147], v16, s[16:19], s42 offen offset:2048 sc1
    v_mfma_f32_16x16x32_bf16 v[36:39], v[68:71], v[96:99], v[36:39]
    ds_read_b128 v[132:135], v3 offset:960
    v_mfma_f32_16x16x32_bf16 v[40:43], v[68:71], v[100:103], v[40:43]
    buffer_load_dwordx4 a[148:151], v2, s[16:19], s42 offen offset:2048 sc1
    v_mfma_f32_16x16x32_bf16 v[44:47], v[68:71], v[104:107], v[44:47]
    ds_read_b128 v[168:171], v4 offset:3008
    v_mfma_f32_16x16x32_bf16 v[48:51], v[68:71], v[108:111], v[48:51]
    buffer_load_dwordx4 a[152:155], v16, s[16:19], s42 offen offset:3072 sc1
    v_mfma_f32_16x16x32_bf16 v[52:55], v[68:71], v[112:115], v[52:55]
    ds_read_b128 v[136:139], v3 offset:1472
    v_mfma_f32_16x16x32_bf16 v[56:59], v[68:71], v[116:119], v[56:59]
    buffer_load_dwordx4 a[156:159], v2, s[16:19], s42 offen offset:3072 sc1
    v_mfma_f32_16x16x32_bf16 v[60:63], v[68:71], v[120:123], v[60:63]
    ds_read_b128 v[172:175], v4 offset:2496
    s_add_u32 s42, s42, 4096
    v_mfma_f32_16x16x32_bf16 v[40:43], v[72:75], v[96:99], v[40:43]
    buffer_load_dwordx4 a[160:163], v16, s[16:19], s42 offen offset:0 sc1
    v_mfma_f32_16x16x32_bf16 v[44:47], v[72:75], v[100:103], v[44:47]
    ds_read_b128 v[140:143], v3 offset:1984
    v_mfma_f32_16x16x32_bf16 v[48:51], v[72:75], v[104:107], v[48:51]
    buffer_load_dwordx4 a[164:167], v2, s[16:19], s42 offen offset:0 sc1
    v_mfma_f32_16x16x32_bf16 v[52:55], v[72:75], v[108:111], v[52:55]
    ds_read_b128 v[176:179], v4 offset:1984
    v_mfma_f32_16x16x32_bf16 v[56:59], v[72:75], v[112:115], v[56:59]
    buffer_load_dwordx4 a[168:171], v16, s[16:19], s42 offen offset:1024 sc1
    v_mfma_f32_16x16x32_bf16 v[60:63], v[72:75], v[116:119], v[60:63]
    ds_read_b128 v[144:147], v3 offset:2496
    v_mfma_f32_16x16x32_bf16 v[44:47], v[76:79], v[96:99], v[44:47]
    buffer_load_dwordx4 a[172:175], v2, s[16:19], s42 offen offset:1024 sc1
    v_mfma_f32_16x16x32_bf16 v[48:51], v[76:79], v[100:103], v[48:51]
    ds_read_b128 v[180:183], v4 offset:1472
    v_mfma_f32_16x16x32_bf16 v[52:55], v[76:79], v[104:107], v[52:55]
    buffer_load_dwordx4 a[176:179], v16, s[16:19], s42 offen offset:2048 sc1
    v_mfma_f32_16x16x32_bf16 v[56:59], v[76:79], v[108:111], v[56:59]
    ds_read_b128 v[148:151], v3 offset:3008
    v_mfma_f32_16x16x32_bf16 v[60:63], v[76:79], v[112:115], v[60:63]
    buffer_load_dwordx4 a[180:183], v2, s[16:19], s42 offen offset:2048 sc1
    v_mfma_f32_16x16x32_bf16 v[48:51], v[80:83], v[96:99], v[48:51]
    ds_read_b128 v[184:187], v4 offset:960
    v_mfma_f32_16x16x32_bf16 v[52:55], v[80:83], v[100:103], v[52:55]
    buffer_load_dwordx4 a[184:187], v16, s[16:19], s42 offen offset:3072 sc1
    v_mfma_f32_16x16x32_bf16 v[56:59], v[80:83], v[104:107], v[56:59]
    ds_read_b128 v[152:155], v3 offset:3520
    v_mfma_f32_16x16x32_bf16 v[60:63], v[80:83], v[108:111], v[60:63]
    buffer_load_dwordx4 a[188:191], v2, s[16:19], s42 offen offset:3072 sc1
    v_mfma_f32_16x16x32_bf16 v[52:55], v[84:87], v[96:99], v[52:55]
    ds_read_b128 v[188:191], v4 offset:448
    s_add_u32 s42, s42, 4096
    v_mfma_f32_16x16x32_bf16 v[56:59], v[84:87], v[100:103], v[56:59]
    buffer_load_dwordx4 a[192:195], v16, s[16:19], s42 offen offset:0 sc1
    v_mfma_f32_16x16x32_bf16 v[60:63], v[84:87], v[104:107], v[60:63]
    ds_read_b128 v[156:159], v3 offset:4032
    v_mfma_f32_16x16x32_bf16 v[56:59], v[88:91], v[96:99], v[56:59]
    buffer_load_dwordx4 a[196:199], v2, s[16:19], s42 offen offset:0 sc1
    v_mfma_f32_16x16x32_bf16 v[60:63], v[88:91], v[100:103], v[60:63]
    buffer_load_dwordx4 a[200:203], v16, s[16:19], s42 offen offset:1024 sc1
    v_mfma_f32_16x16x32_bf16 v[60:63], v[92:95], v[96:99], v[60:63]
    buffer_load_dwordx4 a[204:207], v2, s[16:19], s42 offen offset:1024 sc1
    s_waitcnt lgkmcnt(0)
    s_barrier
    v_mfma_f32_16x16x32_bf16 v[32:35], v[128:131], v[160:163], v[32:35]
    ds_read_b64_tr_b16 v[192:193], v17 offset:27648
    ds_read_b64_tr_b16 v[194:195], v17 offset:32256
    v_mfma_f32_16x16x32_bf16 v[36:39], v[128:131], v[164:167], v[36:39]
    ds_read_b64_tr_b16 v[196:197], v18 offset:27648
    ds_read_b64_tr_b16 v[198:199], v18 offset:32256
    v_mfma_f32_16x16x32_bf16 v[40:43], v[128:131], v[168:171], v[40:43]
    ds_read_b64_tr_b16 v[200:201], v19 offset:27648
    ds_read_b64_tr_b16 v[202:203], v19 offset:32256
    v_mfma_f32_16x16x32_bf16 v[44:47], v[128:131], v[172:175], v[44:47]
    ds_read_b64_tr_b16 v[204:205], v20 offset:27648
    ds_read_b64_tr_b16 v[206:207], v20 offset:32256
    v_mfma_f32_16x16x32_bf16 v[48:51], v[128:131], v[176:179], v[48:51]
    ds_read_b64_tr_b16 v[208:209], v17 offset:27776
    ds_read_b64_tr_b16 v[210:211], v17 offset:32384
    v_mfma_f32_16x16x32_bf16 v[52:55], v[128:131], v[180:183], v[52:55]
    ds_read_b64_tr_b16 v[212:213], v18 offset:27776
    ds_read_b64_tr_b16 v[214:215], v18 offset:32384
    v_mfma_f32_16x16x32_bf16 v[56:59], v[128:131], v[184:187], v[56:59]
    ds_read_b64_tr_b16 v[216:217], v19 offset:27776
    ds_read_b64_tr_b16 v[218:219], v19 offset:32384
    v_mfma_f32_16x16x32_bf16 v[60:63], v[128:131], v[188:191], v[60:63]
    ds_read_b64_tr_b16 v[220:221], v20 offset:27776
    ds_read_b64_tr_b16 v[222:223], v20 offset:32384
    s_add_u32 m0, s59, 16384
    v_mfma_f32_16x16x32_bf16 v[36:39], v[132:135], v[160:163], v[36:39]
    buffer_load_dwordx4 v0, s[8:11], s40 offen offset:0 lds
    v_mfma_f32_16x16x32_bf16 v[40:43], v[132:135], v[164:167], v[40:43]
    buffer_load_dwordx4 v1, s[8:11], s40 offen offset:1152 lds
    v_mfma_f32_16x16x32_bf16 v[44:47], v[132:135], v[168:171], v[44:47]
    s_add_u32 s40, s40, 65536
    s_add_u32 m0, s59, 25600
    v_mfma_f32_16x16x32_bf16 v[48:51], v[132:135], v[172:175], v[48:51]
    buffer_load_dwordx4 v0, s[8:11], s40 offen offset:0 lds
    v_mfma_f32_16x16x32_bf16 v[52:55], v[132:135], v[176:179], v[52:55]
    buffer_load_dwordx4 v1, s[8:11], s40 offen offset:1152 lds
    v_mfma_f32_16x16x32_bf16 v[56:59], v[132:135], v[180:183], v[56:59]
    s_add_u32 s40, s40, 65536
    s_add_u32 m0, s59, 34816
    v_mfma_f32_16x16x32_bf16 v[60:63], v[132:135], v[184:187], v[60:63]
    buffer_load_dwordx4 v0, s[8:11], s40 offen offset:0 lds
    v_mfma_f32_16x16x32_bf16 v[40:43], v[136:139], v[160:163], v[40:43]
    buffer_load_dwordx4 v1, s[8:11], s40 offen offset:1152 lds
    v_mfma_f32_16x16x32_bf16 v[44:47], v[136:139], v[164:167], v[44:47]
    s_add_u32 s40, s40, 65536
    s_add_u32 m0, s59, 44032
    v_mfma_f32_16x16x32_bf16 v[48:51], v[136:139], v[168:171], v[48:51]
    buffer_load_dwordx4 v0, s[8:11], s40 offen offset:0 lds
    v_mfma_f32_16x16x32_bf16 v[52:55], v[136:139], v[172:175], v[52:55]
    buffer_load_dwordx4 v1, s[8:11], s40 offen offset:1152 lds
    v_mfma_f32_16x16x32_bf16 v[56:59], v[136:139], v[176:179], v[56:59]
    s_add_u32 s40, s40, 65536
    s_add_u32 m0, s59, 53248
    v_mfma_f32_16x16x32_bf16 v[60:63], v[136:139], v[180:183], v[60:63]
    buffer_load_dwordx4 v0, s[8:11], s40 offen offset:0 lds
    v_mfma_f32_16x16x32_bf16 v[44:47], v[140:143], v[160:163], v[44:47]
    buffer_load_dwordx4 v1, s[8:11], s40 offen offset:1152 lds
    v_mfma_f32_16x16x32_bf16 v[48:51], v[140:143], v[164:167], v[48:51]
    s_add_u32 s40, s40, 65536
    s_add_u32 m0, s59, 62464
    v_mfma_f32_16x16x32_bf16 v[52:55], v[140:143], v[168:171], v[52:55]
    buffer_load_dwordx4 v0, s[8:11], s40 offen offset:0 lds
    v_mfma_f32_16x16x32_bf16 v[56:59], v[140:143], v[172:175], v[56:59]
    buffer_load_dwordx4 v1, s[8:11], s40 offen offset:1152 lds
    v_mfma_f32_16x16x32_bf16 v[60:63], v[140:143], v[176:179], v[60:63]
    s_add_u32 s40, s40, 65536
    s_add_u32 m0, s59, 71680
    v_mfma_f32_16x16x32_bf16 v[48:51], v[144:147], v[160:163], v[48:51]
    buffer_load_dwordx4 v0, s[8:11], s40 offen offset:0 lds
    v_mfma_f32_16x16x32_bf16 v[52:55], v[144:147], v[164:167], v[52:55]
    buffer_load_dwordx4 v1, s[8:11], s40 offen offset:1152 lds
    v_mfma_f32_16x16x32_bf16 v[56:59], v[144:147], v[168:171], v[56:59]
    s_add_u32 s40, s40, 65536
    s_add_u32 m0, s59, 80896
    v_mfma_f32_16x16x32_bf16 v[60:63], v[144:147], v[172:175], v[60:63]
    buffer_load_dwordx4 v0, s[8:11], s40 offen offset:0 lds
    v_mfma_f32_16x16x32_bf16 v[52:55], v[148:151], v[160:163], v[52:55]
    buffer_load_dwordx4 v1, s[8:11], s40 offen offset:1152 lds
    v_mfma_f32_16x16x32_bf16 v[56:59], v[148:151], v[164:167], v[56:59]
    s_add_u32 s40, s40, 65536
    v_mfma_f32_16x16x32_bf16 v[60:63], v[148:151], v[168:171], v[60:63]
    v_mfma_f32_16x16x32_bf16 v[56:59], v[152:155], v[160:163], v[56:59]
    v_mfma_f32_16x16x32_bf16 v[60:63], v[152:155], v[164:167], v[60:63]
    v_mfma_f32_16x16x32_bf16 v[60:63], v[156:159], v[160:163], v[60:63]
    s_nop 4
    v_cvt_pk_bf16_f32 v32, v32, v33
    v_cvt_pk_bf16_f32 v33, v34, v35
    v_cvt_pk_bf16_f32 v34, v36, v37
    v_cvt_pk_bf16_f32 v35, v38, v39
    v_cvt_pk_bf16_f32 v40, v40, v41
    v_cvt_pk_bf16_f32 v41, v42, v43
    v_cvt_pk_bf16_f32 v42, v44, v45
    v_cvt_pk_bf16_f32 v43, v46, v47
    v_cvt_pk_bf16_f32 v48, v48, v49
    v_cvt_pk_bf16_f32 v49, v50, v51
    v_cvt_pk_bf16_f32 v50, v52, v53
    v_cvt_pk_bf16_f32 v51, v54, v55
    v_cvt_pk_bf16_f32 v56, v56, v57
    v_cvt_pk_bf16_f32 v57, v58, v59
    v_cvt_pk_bf16_f32 v58, v60, v61
    v_cvt_pk_bf16_f32 v59, v62, v63
    v_permlane16_swap_b32 v32, v34
    v_permlane16_swap_b32 v33, v35
    v_permlane16_swap_b32 v40, v42
    v_permlane16_swap_b32 v41, v43
    v_permlane16_swap_b32 v48, v50
    v_permlane16_swap_b32 v49, v51
    v_permlane16_swap_b32 v56, v58
    v_permlane16_swap_b32 v57, v59
    buffer_store_dwordx4 v[32:35], v5, s[12:15], s44 offen offset:0 sc1
    buffer_store_dwordx4 v[40:43], v5, s[12:15], s44 offen offset:1024 sc1
    buffer_store_dwordx4 v[48:51], v5, s[12:15], s44 offen offset:2048 sc1
    buffer_store_dwordx4 v[56:59], v5, s[12:15], s44 offen offset:3072 sc1
    s_waitcnt vmcnt(38) lgkmcnt(0)
    v_mfma_f32_16x16x32_bf16 v[64:67], v[192:195], a[0:3], 0
    v_mfma_f32_16x16x32_bf16 v[68:71], v[192:195], a[4:7], 0
    v_mfma_f32_16x16x32_bf16 v[72:75], v[192:195], a[128:131], 0
    s_add_u32 m0, s59, 90112
    ds_read_b64_tr_b16 v[224:225], v17 offset:36864
    ds_read_b64_tr_b16 v[226:227], v17 offset:41472
    v_mfma_f32_16x16x32_bf16 v[76:79], v[192:195], a[132:135], 0
    ds_read_b64_tr_b16 v[228:229], v18 offset:36864
    ds_read_b64_tr_b16 v[230:231], v18 offset:41472
    v_mfma_f32_16x16x32_bf16 v[80:83], v[196:199], a[0:3], 0
    buffer_load_dwordx4 v0, s[8:11], s40 offen offset:0 lds
    v_mfma_f32_16x16x32_bf16 v[84:87], v[196:199], a[4:7], 0
    ds_read_b64_tr_b16 v[232:233], v19 offset:36864
    ds_read_b64_tr_b16 v[234:235], v19 offset:41472
    v_mfma_f32_16x16x32_bf16 v[88:91], v[196:199], a[128:131], 0
    ds_read_b64_tr_b16 v[236:237], v20 offset:36864
    ds_read_b64_tr_b16 v[238:239], v20 offset:41472
    v_mfma_f32_16x16x32_bf16 v[92:95], v[196:199], a[132:135], 0
    v_mfma_f32_16x16x32_bf16 v[96:99], v[200:203], a[0:3], 0
    ds_read_b64_tr_b16 v[240:241], v17 offset:36992
    ds_read_b64_tr_b16 v[242:243], v17 offset:41600
    v_mfma_f32_16x16x32_bf16 v[100:103], v[200:203], a[4:7], 0
    buffer_load_dwordx4 v1, s[8:11], s40 offen offset:1152 lds
    v_mfma_f32_16x16x32_bf16 v[104:107], v[200:203], a[128:131], 0
    s_add_u32 s40, s40, 65536
    ds_read_b64_tr_b16 v[244:245], v18 offset:36992
    ds_read_b64_tr_b16 v[246:247], v18 offset:41600
    v_mfma_f32_16x16x32_bf16 v[108:111], v[200:203], a[132:135], 0
    ds_read_b64_tr_b16 v[248:249], v19 offset:36992
    ds_read_b64_tr_b16 v[250:251], v19 offset:41600
    v_mfma_f32_16x16x32_bf16 v[112:115], v[204:207], a[0:3], 0
    v_mfma_f32_16x16x32_bf16 v[116:119], v[204:207], a[4:7], 0
    ds_read_b64_tr_b16 v[252:253], v20 offset:36992
    ds_read_b64_tr_b16 v[254:255], v20 offset:41600
    v_mfma_f32_16x16x32_bf16 v[120:123], v[204:207], a[128:131], 0
    buffer_load_dwordx4 a[208:211], v16, s[16:19], s42 offen offset:2048 sc1
    v_mfma_f32_16x16x32_bf16 v[124:127], v[204:207], a[132:135], 0
    v_mfma_f32_16x16x32_bf16 v[128:131], v[208:211], a[0:3], 0
    v_mfma_f32_16x16x32_bf16 v[132:135], v[208:211], a[4:7], 0
    v_mfma_f32_16x16x32_bf16 v[136:139], v[208:211], a[128:131], 0
    v_mfma_f32_16x16x32_bf16 v[140:143], v[208:211], a[132:135], 0
    buffer_load_dwordx4 a[212:215], v2, s[16:19], s42 offen offset:2048 sc1
    v_mfma_f32_16x16x32_bf16 v[144:147], v[212:215], a[0:3], 0
    v_mfma_f32_16x16x32_bf16 v[148:151], v[212:215], a[4:7], 0
    v_mfma_f32_16x16x32_bf16 v[152:155], v[212:215], a[128:131], 0
    v_mfma_f32_16x16x32_bf16 v[156:159], v[212:215], a[132:135], 0
    v_mfma_f32_16x16x32_bf16 v[160:163], v[216:219], a[0:3], 0
    buffer_load_dwordx4 a[120:123], v16, s[16:19], s41 offen offset:3072 sc1
    v_mfma_f32_16x16x32_bf16 v[164:167], v[216:219], a[4:7], 0
    v_mfma_f32_16x16x32_bf16 v[168:171], v[216:219], a[128:131], 0
    v_mfma_f32_16x16x32_bf16 v[172:175], v[216:219], a[132:135], 0
    v_mfma_f32_16x16x32_bf16 v[176:179], v[220:223], a[0:3], 0
    v_mfma_f32_16x16x32_bf16 v[180:183], v[220:223], a[4:7], 0
    buffer_load_dwordx4 a[124:127], v2, s[16:19], s41 offen offset:3072 sc1
    v_mfma_f32_16x16x32_bf16 v[184:187], v[220:223], a[128:131], 0
    s_add_u32 s41, s41, 4096
    v_mfma_f32_16x16x32_bf16 v[188:191], v[220:223], a[132:135], 0
    s_waitcnt vmcnt(40) lgkmcnt(0)
    s_barrier
    v_mfma_f32_16x16x32_bf16 v[64:67], v[224:227], a[8:11], v[64:67]
    v_mfma_f32_16x16x32_bf16 v[68:71], v[224:227], a[12:15], v[68:71]
    v_mfma_f32_16x16x32_bf16 v[72:75], v[224:227], a[136:139], v[72:75]
    s_add_u32 m0, s59, 99328
    ds_read_b64_tr_b16 v[192:193], v17 offset:46080
    ds_read_b64_tr_b16 v[194:195], v17 offset:50688
    v_mfma_f32_16x16x32_bf16 v[76:79], v[224:227], a[140:143], v[76:79]
    ds_read_b64_tr_b16 v[196:197], v18 offset:46080
    ds_read_b64_tr_b16 v[198:199], v18 offset:50688
    v_mfma_f32_16x16x32_bf16 v[80:83], v[228:231], a[8:11], v[80:83]
    buffer_load_dwordx4 v0, s[8:11], s40 offen offset:0 lds
    v_mfma_f32_16x16x32_bf16 v[84:87], v[228:231], a[12:15], v[84:87]
    ds_read_b64_tr_b16 v[200:201], v19 offset:46080
    ds_read_b64_tr_b16 v[202:203], v19 offset:50688
    v_mfma_f32_16x16x32_bf16 v[88:91], v[228:231], a[136:139], v[88:91]
    ds_read_b64_tr_b16 v[204:205], v20 offset:46080
    ds_read_b64_tr_b16 v[206:207], v20 offset:50688
    v_mfma_f32_16x16x32_bf16 v[92:95], v[228:231], a[140:143], v[92:95]
    v_mfma_f32_16x16x32_bf16 v[96:99], v[232:235], a[8:11], v[96:99]
    ds_read_b64_tr_b16 v[208:209], v17 offset:46208
    ds_read_b64_tr_b16 v[210:211], v17 offset:50816
    v_mfma_f32_16x16x32_bf16 v[100:103], v[232:235], a[12:15], v[100:103]
    buffer_load_dwordx4 v1, s[8:11], s40 offen offset:1152 lds
    v_mfma_f32_16x16x32_bf16 v[104:107], v[232:235], a[136:139], v[104:107]
    s_add_u32 s40, s40, 65536
    ds_read_b64_tr_b16 v[212:213], v18 offset:46208
    ds_read_b64_tr_b16 v[214:215], v18 offset:50816
    v_mfma_f32_16x16x32_bf16 v[108:111], v[232:235], a[140:143], v[108:111]
gated_mix__ssm_conv_h3__compressed_kv_cla__prompt_kernel_pad12:
    s_cbranch_execz gated_mix__ssm_conv_h3__compressed_kv_cla__prompt_kernel_pad16
    ds_read_b64_tr_b16 v[216:217], v19 offset:46208
    ds_read_b64_tr_b16 v[218:219], v19 offset:50816
    v_mfma_f32_16x16x32_bf16 v[112:115], v[236:239], a[8:11], v[112:115]
    v_mfma_f32_16x16x32_bf16 v[116:119], v[236:239], a[12:15], v[116:119]
    ds_read_b64_tr_b16 v[220:221], v20 offset:46208
    ds_read_b64_tr_b16 v[222:223], v20 offset:50816
    v_mfma_f32_16x16x32_bf16 v[120:123], v[236:239], a[136:139], v[120:123]
    buffer_load_dwordx4 a[216:219], v16, s[16:19], s42 offen offset:3072 sc1
    v_mfma_f32_16x16x32_bf16 v[124:127], v[236:239], a[140:143], v[124:127]
    v_mfma_f32_16x16x32_bf16 v[128:131], v[240:243], a[8:11], v[128:131]
    v_mfma_f32_16x16x32_bf16 v[132:135], v[240:243], a[12:15], v[132:135]
    v_mfma_f32_16x16x32_bf16 v[136:139], v[240:243], a[136:139], v[136:139]
    v_mfma_f32_16x16x32_bf16 v[140:143], v[240:243], a[140:143], v[140:143]
    buffer_load_dwordx4 a[220:223], v2, s[16:19], s42 offen offset:3072 sc1
    v_mfma_f32_16x16x32_bf16 v[144:147], v[244:247], a[8:11], v[144:147]
    s_add_u32 s42, s42, 4096
    v_mfma_f32_16x16x32_bf16 v[148:151], v[244:247], a[12:15], v[148:151]
    v_mfma_f32_16x16x32_bf16 v[152:155], v[244:247], a[136:139], v[152:155]
    v_mfma_f32_16x16x32_bf16 v[156:159], v[244:247], a[140:143], v[156:159]
    v_mfma_f32_16x16x32_bf16 v[160:163], v[248:251], a[8:11], v[160:163]
    buffer_load_dwordx4 a[0:3], v16, s[16:19], s41 offen offset:0 sc1
    v_mfma_f32_16x16x32_bf16 v[164:167], v[248:251], a[12:15], v[164:167]
    v_mfma_f32_16x16x32_bf16 v[168:171], v[248:251], a[136:139], v[168:171]
    v_mfma_f32_16x16x32_bf16 v[172:175], v[248:251], a[140:143], v[172:175]
    v_mfma_f32_16x16x32_bf16 v[176:179], v[252:255], a[8:11], v[176:179]
    v_mfma_f32_16x16x32_bf16 v[180:183], v[252:255], a[12:15], v[180:183]
    buffer_load_dwordx4 a[4:7], v2, s[16:19], s41 offen offset:0 sc1
    v_mfma_f32_16x16x32_bf16 v[184:187], v[252:255], a[136:139], v[184:187]
    v_mfma_f32_16x16x32_bf16 v[188:191], v[252:255], a[140:143], v[188:191]
    s_waitcnt lgkmcnt(0)
    v_mfma_f32_16x16x32_bf16 v[64:67], v[192:195], a[16:19], v[64:67]
    v_mfma_f32_16x16x32_bf16 v[68:71], v[192:195], a[20:23], v[68:71]
    v_mfma_f32_16x16x32_bf16 v[72:75], v[192:195], a[144:147], v[72:75]
    s_add_u32 m0, s59, 108544
    ds_read_b64_tr_b16 v[224:225], v17 offset:55296
    ds_read_b64_tr_b16 v[226:227], v17 offset:59904
    v_mfma_f32_16x16x32_bf16 v[76:79], v[192:195], a[148:151], v[76:79]
    ds_read_b64_tr_b16 v[228:229], v18 offset:55296
    ds_read_b64_tr_b16 v[230:231], v18 offset:59904
    v_mfma_f32_16x16x32_bf16 v[80:83], v[196:199], a[16:19], v[80:83]
    buffer_load_dwordx4 v0, s[8:11], s40 offen offset:0 lds
    v_mfma_f32_16x16x32_bf16 v[84:87], v[196:199], a[20:23], v[84:87]
    ds_read_b64_tr_b16 v[232:233], v19 offset:55296
    ds_read_b64_tr_b16 v[234:235], v19 offset:59904
    v_mfma_f32_16x16x32_bf16 v[88:91], v[196:199], a[144:147], v[88:91]
    ds_read_b64_tr_b16 v[236:237], v20 offset:55296
    ds_read_b64_tr_b16 v[238:239], v20 offset:59904
    v_mfma_f32_16x16x32_bf16 v[92:95], v[196:199], a[148:151], v[92:95]
    v_mfma_f32_16x16x32_bf16 v[96:99], v[200:203], a[16:19], v[96:99]
    ds_read_b64_tr_b16 v[240:241], v17 offset:55424
    ds_read_b64_tr_b16 v[242:243], v17 offset:60032
    v_mfma_f32_16x16x32_bf16 v[100:103], v[200:203], a[20:23], v[100:103]
    buffer_load_dwordx4 v1, s[8:11], s40 offen offset:1152 lds
    v_mfma_f32_16x16x32_bf16 v[104:107], v[200:203], a[144:147], v[104:107]
    s_add_u32 s40, s40, 65536
    ds_read_b64_tr_b16 v[244:245], v18 offset:55424
    ds_read_b64_tr_b16 v[246:247], v18 offset:60032
    v_mfma_f32_16x16x32_bf16 v[108:111], v[200:203], a[148:151], v[108:111]
    ds_read_b64_tr_b16 v[248:249], v19 offset:55424
    ds_read_b64_tr_b16 v[250:251], v19 offset:60032
    v_mfma_f32_16x16x32_bf16 v[112:115], v[204:207], a[16:19], v[112:115]
    v_mfma_f32_16x16x32_bf16 v[116:119], v[204:207], a[20:23], v[116:119]
    ds_read_b64_tr_b16 v[252:253], v20 offset:55424
    ds_read_b64_tr_b16 v[254:255], v20 offset:60032
    v_mfma_f32_16x16x32_bf16 v[120:123], v[204:207], a[144:147], v[120:123]
    buffer_load_dwordx4 a[224:227], v16, s[16:19], s42 offen offset:0 sc1
    v_mfma_f32_16x16x32_bf16 v[124:127], v[204:207], a[148:151], v[124:127]
    v_mfma_f32_16x16x32_bf16 v[128:131], v[208:211], a[16:19], v[128:131]
    v_mfma_f32_16x16x32_bf16 v[132:135], v[208:211], a[20:23], v[132:135]
    v_mfma_f32_16x16x32_bf16 v[136:139], v[208:211], a[144:147], v[136:139]
    v_mfma_f32_16x16x32_bf16 v[140:143], v[208:211], a[148:151], v[140:143]
    buffer_load_dwordx4 a[228:231], v2, s[16:19], s42 offen offset:0 sc1
    v_mfma_f32_16x16x32_bf16 v[144:147], v[212:215], a[16:19], v[144:147]
    v_mfma_f32_16x16x32_bf16 v[148:151], v[212:215], a[20:23], v[148:151]
    v_mfma_f32_16x16x32_bf16 v[152:155], v[212:215], a[144:147], v[152:155]
    v_mfma_f32_16x16x32_bf16 v[156:159], v[212:215], a[148:151], v[156:159]
    v_mfma_f32_16x16x32_bf16 v[160:163], v[216:219], a[16:19], v[160:163]
    buffer_load_dwordx4 a[8:11], v16, s[16:19], s41 offen offset:1024 sc1
    v_mfma_f32_16x16x32_bf16 v[164:167], v[216:219], a[20:23], v[164:167]
    v_mfma_f32_16x16x32_bf16 v[168:171], v[216:219], a[144:147], v[168:171]
    v_mfma_f32_16x16x32_bf16 v[172:175], v[216:219], a[148:151], v[172:175]
    v_mfma_f32_16x16x32_bf16 v[176:179], v[220:223], a[16:19], v[176:179]
    v_mfma_f32_16x16x32_bf16 v[180:183], v[220:223], a[20:23], v[180:183]
    buffer_load_dwordx4 a[12:15], v2, s[16:19], s41 offen offset:1024 sc1
    v_mfma_f32_16x16x32_bf16 v[184:187], v[220:223], a[144:147], v[184:187]
    v_mfma_f32_16x16x32_bf16 v[188:191], v[220:223], a[148:151], v[188:191]
    s_waitcnt vmcnt(48) lgkmcnt(0)
    s_barrier
    v_mfma_f32_16x16x32_bf16 v[64:67], v[224:227], a[24:27], v[64:67]
    v_add_u32 v17, 64512, v17
    v_add_u32 v18, 64512, v18
    v_mfma_f32_16x16x32_bf16 v[68:71], v[224:227], a[28:31], v[68:71]
    v_add_u32 v19, 64512, v19
    v_add_u32 v20, 64512, v20
    v_mfma_f32_16x16x32_bf16 v[72:75], v[224:227], a[152:155], v[72:75]
    s_add_u32 m0, s59, 117760
    ds_read_b64_tr_b16 v[192:193], v17 offset:0
    ds_read_b64_tr_b16 v[194:195], v17 offset:4608
    v_mfma_f32_16x16x32_bf16 v[76:79], v[224:227], a[156:159], v[76:79]
    ds_read_b64_tr_b16 v[196:197], v18 offset:0
    ds_read_b64_tr_b16 v[198:199], v18 offset:4608
    v_mfma_f32_16x16x32_bf16 v[80:83], v[228:231], a[24:27], v[80:83]
    buffer_load_dwordx4 v0, s[8:11], s40 offen offset:0 lds
    v_mfma_f32_16x16x32_bf16 v[84:87], v[228:231], a[28:31], v[84:87]
    ds_read_b64_tr_b16 v[200:201], v19 offset:0
    ds_read_b64_tr_b16 v[202:203], v19 offset:4608
    v_mfma_f32_16x16x32_bf16 v[88:91], v[228:231], a[152:155], v[88:91]
    ds_read_b64_tr_b16 v[204:205], v20 offset:0
    ds_read_b64_tr_b16 v[206:207], v20 offset:4608
    v_mfma_f32_16x16x32_bf16 v[92:95], v[228:231], a[156:159], v[92:95]
    v_mfma_f32_16x16x32_bf16 v[96:99], v[232:235], a[24:27], v[96:99]
    ds_read_b64_tr_b16 v[208:209], v17 offset:128
    ds_read_b64_tr_b16 v[210:211], v17 offset:4736
    v_mfma_f32_16x16x32_bf16 v[100:103], v[232:235], a[28:31], v[100:103]
    buffer_load_dwordx4 v1, s[8:11], s40 offen offset:1152 lds
    v_mfma_f32_16x16x32_bf16 v[104:107], v[232:235], a[152:155], v[104:107]
    s_add_u32 s40, s40, 65536
    ds_read_b64_tr_b16 v[212:213], v18 offset:128
    ds_read_b64_tr_b16 v[214:215], v18 offset:4736
    v_mfma_f32_16x16x32_bf16 v[108:111], v[232:235], a[156:159], v[108:111]
    ds_read_b64_tr_b16 v[216:217], v19 offset:128
    ds_read_b64_tr_b16 v[218:219], v19 offset:4736
    v_mfma_f32_16x16x32_bf16 v[112:115], v[236:239], a[24:27], v[112:115]
    s_waitcnt vmcnt(20)
    buffer_store_dword v9, v8, s[28:31], s57 offen sc1
    v_mfma_f32_16x16x32_bf16 v[116:119], v[236:239], a[28:31], v[116:119]
    ds_read_b64_tr_b16 v[220:221], v20 offset:128
    ds_read_b64_tr_b16 v[222:223], v20 offset:4736
    v_mfma_f32_16x16x32_bf16 v[120:123], v[236:239], a[152:155], v[120:123]
    buffer_load_dwordx4 a[232:235], v16, s[16:19], s42 offen offset:1024 sc1
    v_mfma_f32_16x16x32_bf16 v[124:127], v[236:239], a[156:159], v[124:127]
    v_mfma_f32_16x16x32_bf16 v[128:131], v[240:243], a[24:27], v[128:131]
    v_mfma_f32_16x16x32_bf16 v[132:135], v[240:243], a[28:31], v[132:135]
    v_mfma_f32_16x16x32_bf16 v[136:139], v[240:243], a[152:155], v[136:139]
    v_mfma_f32_16x16x32_bf16 v[140:143], v[240:243], a[156:159], v[140:143]
    buffer_load_dwordx4 a[236:239], v2, s[16:19], s42 offen offset:1024 sc1
    v_mfma_f32_16x16x32_bf16 v[144:147], v[244:247], a[24:27], v[144:147]
    v_mfma_f32_16x16x32_bf16 v[148:151], v[244:247], a[28:31], v[148:151]
    v_mfma_f32_16x16x32_bf16 v[152:155], v[244:247], a[152:155], v[152:155]
    v_mfma_f32_16x16x32_bf16 v[156:159], v[244:247], a[156:159], v[156:159]
    v_mfma_f32_16x16x32_bf16 v[160:163], v[248:251], a[24:27], v[160:163]
    buffer_load_dwordx4 a[16:19], v16, s[16:19], s41 offen offset:2048 sc1
    v_mfma_f32_16x16x32_bf16 v[164:167], v[248:251], a[28:31], v[164:167]
    v_mfma_f32_16x16x32_bf16 v[168:171], v[248:251], a[152:155], v[168:171]
    v_mfma_f32_16x16x32_bf16 v[172:175], v[248:251], a[156:159], v[172:175]
    v_mfma_f32_16x16x32_bf16 v[176:179], v[252:255], a[24:27], v[176:179]
    v_mfma_f32_16x16x32_bf16 v[180:183], v[252:255], a[28:31], v[180:183]
    buffer_load_dwordx4 a[20:23], v2, s[16:19], s41 offen offset:2048 sc1
    v_mfma_f32_16x16x32_bf16 v[184:187], v[252:255], a[152:155], v[184:187]
    v_mfma_f32_16x16x32_bf16 v[188:191], v[252:255], a[156:159], v[188:191]
    s_waitcnt lgkmcnt(0)
    v_mfma_f32_16x16x32_bf16 v[64:67], v[192:195], a[32:35], v[64:67]
    v_mfma_f32_16x16x32_bf16 v[68:71], v[192:195], a[36:39], v[68:71]
    v_mfma_f32_16x16x32_bf16 v[72:75], v[192:195], a[160:163], v[72:75]
    s_add_u32 m0, s59, 126976
    ds_read_b64_tr_b16 v[224:225], v17 offset:9216
    ds_read_b64_tr_b16 v[226:227], v17 offset:13824
    v_mfma_f32_16x16x32_bf16 v[76:79], v[192:195], a[164:167], v[76:79]
    ds_read_b64_tr_b16 v[228:229], v18 offset:9216
    ds_read_b64_tr_b16 v[230:231], v18 offset:13824
    v_mfma_f32_16x16x32_bf16 v[80:83], v[196:199], a[32:35], v[80:83]
    buffer_load_dwordx4 v0, s[8:11], s40 offen offset:0 lds
    v_mfma_f32_16x16x32_bf16 v[84:87], v[196:199], a[36:39], v[84:87]
    ds_read_b64_tr_b16 v[232:233], v19 offset:9216
    ds_read_b64_tr_b16 v[234:235], v19 offset:13824
    v_mfma_f32_16x16x32_bf16 v[88:91], v[196:199], a[160:163], v[88:91]
    ds_read_b64_tr_b16 v[236:237], v20 offset:9216
    ds_read_b64_tr_b16 v[238:239], v20 offset:13824
    v_mfma_f32_16x16x32_bf16 v[92:95], v[196:199], a[164:167], v[92:95]
    v_mfma_f32_16x16x32_bf16 v[96:99], v[200:203], a[32:35], v[96:99]
    ds_read_b64_tr_b16 v[240:241], v17 offset:9344
    ds_read_b64_tr_b16 v[242:243], v17 offset:13952
    v_mfma_f32_16x16x32_bf16 v[100:103], v[200:203], a[36:39], v[100:103]
    buffer_load_dwordx4 v1, s[8:11], s40 offen offset:1152 lds
    v_mfma_f32_16x16x32_bf16 v[104:107], v[200:203], a[160:163], v[104:107]
    s_add_u32 s40, s40, 65536
    ds_read_b64_tr_b16 v[244:245], v18 offset:9344
    ds_read_b64_tr_b16 v[246:247], v18 offset:13952
    v_mfma_f32_16x16x32_bf16 v[108:111], v[200:203], a[164:167], v[108:111]
    ds_read_b64_tr_b16 v[248:249], v19 offset:9344
    ds_read_b64_tr_b16 v[250:251], v19 offset:13952
    v_mfma_f32_16x16x32_bf16 v[112:115], v[204:207], a[32:35], v[112:115]
    v_mfma_f32_16x16x32_bf16 v[116:119], v[204:207], a[36:39], v[116:119]
    ds_read_b64_tr_b16 v[252:253], v20 offset:9344
    ds_read_b64_tr_b16 v[254:255], v20 offset:13952
    v_mfma_f32_16x16x32_bf16 v[120:123], v[204:207], a[160:163], v[120:123]
    buffer_load_dwordx4 a[240:243], v16, s[16:19], s42 offen offset:2048 sc1
    v_mfma_f32_16x16x32_bf16 v[124:127], v[204:207], a[164:167], v[124:127]
    v_mfma_f32_16x16x32_bf16 v[128:131], v[208:211], a[32:35], v[128:131]
    v_mfma_f32_16x16x32_bf16 v[132:135], v[208:211], a[36:39], v[132:135]
    v_mfma_f32_16x16x32_bf16 v[136:139], v[208:211], a[160:163], v[136:139]
    v_mfma_f32_16x16x32_bf16 v[140:143], v[208:211], a[164:167], v[140:143]
    buffer_load_dwordx4 a[244:247], v2, s[16:19], s42 offen offset:2048 sc1
    v_mfma_f32_16x16x32_bf16 v[144:147], v[212:215], a[32:35], v[144:147]
    v_mfma_f32_16x16x32_bf16 v[148:151], v[212:215], a[36:39], v[148:151]
    v_mfma_f32_16x16x32_bf16 v[152:155], v[212:215], a[160:163], v[152:155]
    v_mfma_f32_16x16x32_bf16 v[156:159], v[212:215], a[164:167], v[156:159]
    v_mfma_f32_16x16x32_bf16 v[160:163], v[216:219], a[32:35], v[160:163]
    buffer_load_dwordx4 a[24:27], v16, s[16:19], s41 offen offset:3072 sc1
    v_mfma_f32_16x16x32_bf16 v[164:167], v[216:219], a[36:39], v[164:167]
    v_mfma_f32_16x16x32_bf16 v[168:171], v[216:219], a[160:163], v[168:171]
    v_mfma_f32_16x16x32_bf16 v[172:175], v[216:219], a[164:167], v[172:175]
    v_mfma_f32_16x16x32_bf16 v[176:179], v[220:223], a[32:35], v[176:179]
    v_mfma_f32_16x16x32_bf16 v[180:183], v[220:223], a[36:39], v[180:183]
    buffer_load_dwordx4 a[28:31], v2, s[16:19], s41 offen offset:3072 sc1
    v_mfma_f32_16x16x32_bf16 v[184:187], v[220:223], a[160:163], v[184:187]
    s_add_u32 s41, s41, 4096
    v_mfma_f32_16x16x32_bf16 v[188:191], v[220:223], a[164:167], v[188:191]
    s_waitcnt vmcnt(47) lgkmcnt(0)
    s_barrier
    v_mfma_f32_16x16x32_bf16 v[64:67], v[224:227], a[40:43], v[64:67]
    v_add_u32 v17, 4294838272, v17
    v_add_u32 v18, 4294838272, v18
    v_mfma_f32_16x16x32_bf16 v[68:71], v[224:227], a[44:47], v[68:71]
    v_add_u32 v19, 4294838272, v19
    v_add_u32 v20, 4294838272, v20
    v_mfma_f32_16x16x32_bf16 v[72:75], v[224:227], a[168:171], v[72:75]
    s_add_u32 m0, s59, 136192
    ds_read_b64_tr_b16 v[192:193], v17 offset:0
    ds_read_b64_tr_b16 v[194:195], v17 offset:4608
    v_mfma_f32_16x16x32_bf16 v[76:79], v[224:227], a[172:175], v[76:79]
    ds_read_b64_tr_b16 v[196:197], v18 offset:0
    ds_read_b64_tr_b16 v[198:199], v18 offset:4608
    v_mfma_f32_16x16x32_bf16 v[80:83], v[228:231], a[40:43], v[80:83]
    buffer_load_dwordx4 v0, s[8:11], s40 offen offset:0 lds
    v_mfma_f32_16x16x32_bf16 v[84:87], v[228:231], a[44:47], v[84:87]
    ds_read_b64_tr_b16 v[200:201], v19 offset:0
    ds_read_b64_tr_b16 v[202:203], v19 offset:4608
    v_mfma_f32_16x16x32_bf16 v[88:91], v[228:231], a[168:171], v[88:91]
    ds_read_b64_tr_b16 v[204:205], v20 offset:0
    ds_read_b64_tr_b16 v[206:207], v20 offset:4608
    v_mfma_f32_16x16x32_bf16 v[92:95], v[228:231], a[172:175], v[92:95]
    v_mfma_f32_16x16x32_bf16 v[96:99], v[232:235], a[40:43], v[96:99]
    ds_read_b64_tr_b16 v[208:209], v17 offset:128
    ds_read_b64_tr_b16 v[210:211], v17 offset:4736
    v_mfma_f32_16x16x32_bf16 v[100:103], v[232:235], a[44:47], v[100:103]
    buffer_load_dwordx4 v1, s[8:11], s40 offen offset:1152 lds
    v_mfma_f32_16x16x32_bf16 v[104:107], v[232:235], a[168:171], v[104:107]
    s_add_u32 s40, s40, 65536
    ds_read_b64_tr_b16 v[212:213], v18 offset:128
    ds_read_b64_tr_b16 v[214:215], v18 offset:4736
    v_mfma_f32_16x16x32_bf16 v[108:111], v[232:235], a[172:175], v[108:111]
    ds_read_b64_tr_b16 v[216:217], v19 offset:128
    ds_read_b64_tr_b16 v[218:219], v19 offset:4736
    v_mfma_f32_16x16x32_bf16 v[112:115], v[236:239], a[40:43], v[112:115]
    s_add_u32 s36, s48, 2097152
    buffer_load_dwordx4 v[32:35], v21, s[24:27], s36 offen
    v_mfma_f32_16x16x32_bf16 v[116:119], v[236:239], a[44:47], v[116:119]
    ds_read_b64_tr_b16 v[220:221], v20 offset:128
    ds_read_b64_tr_b16 v[222:223], v20 offset:4736
    v_mfma_f32_16x16x32_bf16 v[120:123], v[236:239], a[168:171], v[120:123]
    buffer_load_dwordx4 a[248:251], v16, s[16:19], s42 offen offset:3072 sc1
    v_mfma_f32_16x16x32_bf16 v[124:127], v[236:239], a[172:175], v[124:127]
    s_add_u32 s36, s48, 2228224
    buffer_load_dwordx4 v[36:39], v21, s[24:27], s36 offen
    v_mfma_f32_16x16x32_bf16 v[128:131], v[240:243], a[40:43], v[128:131]
    v_mfma_f32_16x16x32_bf16 v[132:135], v[240:243], a[44:47], v[132:135]
    v_mfma_f32_16x16x32_bf16 v[136:139], v[240:243], a[168:171], v[136:139]
    v_mfma_f32_16x16x32_bf16 v[140:143], v[240:243], a[172:175], v[140:143]
    buffer_load_dwordx4 a[252:255], v2, s[16:19], s42 offen offset:3072 sc1
    v_mfma_f32_16x16x32_bf16 v[144:147], v[244:247], a[40:43], v[144:147]
    s_add_u32 s42, s42, 4096
    v_mfma_f32_16x16x32_bf16 v[148:151], v[244:247], a[44:47], v[148:151]
    v_mfma_f32_16x16x32_bf16 v[152:155], v[244:247], a[168:171], v[152:155]
    v_mfma_f32_16x16x32_bf16 v[156:159], v[244:247], a[172:175], v[156:159]
    v_mfma_f32_16x16x32_bf16 v[160:163], v[248:251], a[40:43], v[160:163]
    buffer_load_dwordx4 a[32:35], v16, s[16:19], s41 offen offset:0 sc1
    v_mfma_f32_16x16x32_bf16 v[164:167], v[248:251], a[44:47], v[164:167]
    v_mfma_f32_16x16x32_bf16 v[168:171], v[248:251], a[168:171], v[168:171]
    v_mfma_f32_16x16x32_bf16 v[172:175], v[248:251], a[172:175], v[172:175]
    v_mfma_f32_16x16x32_bf16 v[176:179], v[252:255], a[40:43], v[176:179]
    v_mfma_f32_16x16x32_bf16 v[180:183], v[252:255], a[44:47], v[180:183]
    buffer_load_dwordx4 a[36:39], v2, s[16:19], s41 offen offset:0 sc1
    v_mfma_f32_16x16x32_bf16 v[184:187], v[252:255], a[168:171], v[184:187]
    v_mfma_f32_16x16x32_bf16 v[188:191], v[252:255], a[172:175], v[188:191]
    s_waitcnt lgkmcnt(0)
    v_mfma_f32_16x16x32_bf16 v[64:67], v[192:195], a[48:51], v[64:67]
    v_mfma_f32_16x16x32_bf16 v[68:71], v[192:195], a[52:55], v[68:71]
    v_mfma_f32_16x16x32_bf16 v[72:75], v[192:195], a[176:179], v[72:75]
    s_add_u32 m0, s59, 145408
    ds_read_b64_tr_b16 v[224:225], v17 offset:9216
    ds_read_b64_tr_b16 v[226:227], v17 offset:13824
    v_mfma_f32_16x16x32_bf16 v[76:79], v[192:195], a[180:183], v[76:79]
    ds_read_b64_tr_b16 v[228:229], v18 offset:9216
    ds_read_b64_tr_b16 v[230:231], v18 offset:13824
    v_mfma_f32_16x16x32_bf16 v[80:83], v[196:199], a[48:51], v[80:83]
    buffer_load_dwordx4 v0, s[8:11], s40 offen offset:0 lds
    v_mfma_f32_16x16x32_bf16 v[84:87], v[196:199], a[52:55], v[84:87]
    ds_read_b64_tr_b16 v[232:233], v19 offset:9216
    ds_read_b64_tr_b16 v[234:235], v19 offset:13824
    v_mfma_f32_16x16x32_bf16 v[88:91], v[196:199], a[176:179], v[88:91]
    ds_read_b64_tr_b16 v[236:237], v20 offset:9216
    ds_read_b64_tr_b16 v[238:239], v20 offset:13824
    v_mfma_f32_16x16x32_bf16 v[92:95], v[196:199], a[180:183], v[92:95]
    v_mfma_f32_16x16x32_bf16 v[96:99], v[200:203], a[48:51], v[96:99]
    ds_read_b64_tr_b16 v[240:241], v17 offset:9344
    ds_read_b64_tr_b16 v[242:243], v17 offset:13952
    v_mfma_f32_16x16x32_bf16 v[100:103], v[200:203], a[52:55], v[100:103]
    buffer_load_dwordx4 v1, s[8:11], s40 offen offset:1152 lds
    v_mfma_f32_16x16x32_bf16 v[104:107], v[200:203], a[176:179], v[104:107]
    s_add_u32 s40, s40, 65536
    ds_read_b64_tr_b16 v[244:245], v18 offset:9344
    ds_read_b64_tr_b16 v[246:247], v18 offset:13952
    v_mfma_f32_16x16x32_bf16 v[108:111], v[200:203], a[180:183], v[108:111]
    ds_read_b64_tr_b16 v[248:249], v19 offset:9344
    ds_read_b64_tr_b16 v[250:251], v19 offset:13952
    v_mfma_f32_16x16x32_bf16 v[112:115], v[204:207], a[48:51], v[112:115]
    v_mfma_f32_16x16x32_bf16 v[116:119], v[204:207], a[52:55], v[116:119]
    ds_read_b64_tr_b16 v[252:253], v20 offset:9344
    ds_read_b64_tr_b16 v[254:255], v20 offset:13952
    v_mfma_f32_16x16x32_bf16 v[120:123], v[204:207], a[176:179], v[120:123]
    buffer_load_dwordx4 a[128:131], v16, s[16:19], s42 offen offset:0 sc1
    v_mfma_f32_16x16x32_bf16 v[124:127], v[204:207], a[180:183], v[124:127]
    v_mfma_f32_16x16x32_bf16 v[128:131], v[208:211], a[48:51], v[128:131]
    v_mfma_f32_16x16x32_bf16 v[132:135], v[208:211], a[52:55], v[132:135]
    v_mfma_f32_16x16x32_bf16 v[136:139], v[208:211], a[176:179], v[136:139]
    v_mfma_f32_16x16x32_bf16 v[140:143], v[208:211], a[180:183], v[140:143]
    buffer_load_dwordx4 a[132:135], v2, s[16:19], s42 offen offset:0 sc1
    v_mfma_f32_16x16x32_bf16 v[144:147], v[212:215], a[48:51], v[144:147]
    v_mfma_f32_16x16x32_bf16 v[148:151], v[212:215], a[52:55], v[148:151]
    v_mfma_f32_16x16x32_bf16 v[152:155], v[212:215], a[176:179], v[152:155]
    v_mfma_f32_16x16x32_bf16 v[156:159], v[212:215], a[180:183], v[156:159]
    v_mfma_f32_16x16x32_bf16 v[160:163], v[216:219], a[48:51], v[160:163]
    buffer_load_dwordx4 a[40:43], v16, s[16:19], s41 offen offset:1024 sc1
    v_mfma_f32_16x16x32_bf16 v[164:167], v[216:219], a[52:55], v[164:167]
    v_mfma_f32_16x16x32_bf16 v[168:171], v[216:219], a[176:179], v[168:171]
    v_mfma_f32_16x16x32_bf16 v[172:175], v[216:219], a[180:183], v[172:175]
    v_mfma_f32_16x16x32_bf16 v[176:179], v[220:223], a[48:51], v[176:179]
    v_mfma_f32_16x16x32_bf16 v[180:183], v[220:223], a[52:55], v[180:183]
    buffer_load_dwordx4 a[44:47], v2, s[16:19], s41 offen offset:1024 sc1
    v_mfma_f32_16x16x32_bf16 v[184:187], v[220:223], a[176:179], v[184:187]
    v_mfma_f32_16x16x32_bf16 v[188:191], v[220:223], a[180:183], v[188:191]
    s_waitcnt vmcnt(57) lgkmcnt(0)
    s_barrier
    v_mfma_f32_16x16x32_bf16 v[64:67], v[224:227], a[56:59], v[64:67]
    v_mfma_f32_16x16x32_bf16 v[68:71], v[224:227], a[60:63], v[68:71]
    v_mfma_f32_16x16x32_bf16 v[72:75], v[224:227], a[184:187], v[72:75]
    s_add_u32 m0, s59, 154624
    ds_read_b64_tr_b16 v[192:193], v17 offset:18432
    ds_read_b64_tr_b16 v[194:195], v17 offset:23040
    v_mfma_f32_16x16x32_bf16 v[76:79], v[224:227], a[188:191], v[76:79]
    ds_read_b64_tr_b16 v[196:197], v18 offset:18432
    ds_read_b64_tr_b16 v[198:199], v18 offset:23040
    v_mfma_f32_16x16x32_bf16 v[80:83], v[228:231], a[56:59], v[80:83]
    buffer_load_dwordx4 v0, s[8:11], s40 offen offset:0 lds
    v_mfma_f32_16x16x32_bf16 v[84:87], v[228:231], a[60:63], v[84:87]
    ds_read_b64_tr_b16 v[200:201], v19 offset:18432
    ds_read_b64_tr_b16 v[202:203], v19 offset:23040
    v_mfma_f32_16x16x32_bf16 v[88:91], v[228:231], a[184:187], v[88:91]
    ds_read_b64_tr_b16 v[204:205], v20 offset:18432
    ds_read_b64_tr_b16 v[206:207], v20 offset:23040
    v_mfma_f32_16x16x32_bf16 v[92:95], v[228:231], a[188:191], v[92:95]
    v_mfma_f32_16x16x32_bf16 v[96:99], v[232:235], a[56:59], v[96:99]
    ds_read_b64_tr_b16 v[208:209], v17 offset:18560
    ds_read_b64_tr_b16 v[210:211], v17 offset:23168
    v_mfma_f32_16x16x32_bf16 v[100:103], v[232:235], a[60:63], v[100:103]
    buffer_load_dwordx4 v1, s[8:11], s40 offen offset:1152 lds
    v_mfma_f32_16x16x32_bf16 v[104:107], v[232:235], a[184:187], v[104:107]
    s_add_u32 s40, s40, 65536
    ds_read_b64_tr_b16 v[212:213], v18 offset:18560
    ds_read_b64_tr_b16 v[214:215], v18 offset:23168
    v_mfma_f32_16x16x32_bf16 v[108:111], v[232:235], a[188:191], v[108:111]
    ds_read_b64_tr_b16 v[216:217], v19 offset:18560
    ds_read_b64_tr_b16 v[218:219], v19 offset:23168
    v_mfma_f32_16x16x32_bf16 v[112:115], v[236:239], a[56:59], v[112:115]
    v_mfma_f32_16x16x32_bf16 v[116:119], v[236:239], a[60:63], v[116:119]
    ds_read_b64_tr_b16 v[220:221], v20 offset:18560
    ds_read_b64_tr_b16 v[222:223], v20 offset:23168
    v_mfma_f32_16x16x32_bf16 v[120:123], v[236:239], a[184:187], v[120:123]
    buffer_load_dwordx4 a[136:139], v16, s[16:19], s42 offen offset:1024 sc1
    v_mfma_f32_16x16x32_bf16 v[124:127], v[236:239], a[188:191], v[124:127]
    v_mfma_f32_16x16x32_bf16 v[128:131], v[240:243], a[56:59], v[128:131]
    v_mfma_f32_16x16x32_bf16 v[132:135], v[240:243], a[60:63], v[132:135]
    v_mfma_f32_16x16x32_bf16 v[136:139], v[240:243], a[184:187], v[136:139]
    v_mfma_f32_16x16x32_bf16 v[140:143], v[240:243], a[188:191], v[140:143]
    buffer_load_dwordx4 a[140:143], v2, s[16:19], s42 offen offset:1024 sc1
    v_mfma_f32_16x16x32_bf16 v[144:147], v[244:247], a[56:59], v[144:147]
    v_mfma_f32_16x16x32_bf16 v[148:151], v[244:247], a[60:63], v[148:151]
    v_mfma_f32_16x16x32_bf16 v[152:155], v[244:247], a[184:187], v[152:155]
    v_mfma_f32_16x16x32_bf16 v[156:159], v[244:247], a[188:191], v[156:159]
    v_mfma_f32_16x16x32_bf16 v[160:163], v[248:251], a[56:59], v[160:163]
    buffer_load_dwordx4 a[48:51], v16, s[16:19], s41 offen offset:2048 sc1
    v_mfma_f32_16x16x32_bf16 v[164:167], v[248:251], a[60:63], v[164:167]
    v_mfma_f32_16x16x32_bf16 v[168:171], v[248:251], a[184:187], v[168:171]
    v_mfma_f32_16x16x32_bf16 v[172:175], v[248:251], a[188:191], v[172:175]
    v_mfma_f32_16x16x32_bf16 v[176:179], v[252:255], a[56:59], v[176:179]
    v_mfma_f32_16x16x32_bf16 v[180:183], v[252:255], a[60:63], v[180:183]
    buffer_load_dwordx4 a[52:55], v2, s[16:19], s41 offen offset:2048 sc1
    v_mfma_f32_16x16x32_bf16 v[184:187], v[252:255], a[184:187], v[184:187]
    v_mfma_f32_16x16x32_bf16 v[188:191], v[252:255], a[188:191], v[188:191]
    s_waitcnt lgkmcnt(0)
    v_mfma_f32_16x16x32_bf16 v[64:67], v[192:195], a[64:67], v[64:67]
    v_mfma_f32_16x16x32_bf16 v[68:71], v[192:195], a[68:71], v[68:71]
    v_mfma_f32_16x16x32_bf16 v[72:75], v[192:195], a[192:195], v[72:75]
    s_add_u32 m0, s59, 16384
    ds_read_b64_tr_b16 v[224:225], v17 offset:27648
    ds_read_b64_tr_b16 v[226:227], v17 offset:32256
    v_mfma_f32_16x16x32_bf16 v[76:79], v[192:195], a[196:199], v[76:79]
    ds_read_b64_tr_b16 v[228:229], v18 offset:27648
    ds_read_b64_tr_b16 v[230:231], v18 offset:32256
    v_mfma_f32_16x16x32_bf16 v[80:83], v[196:199], a[64:67], v[80:83]
    buffer_load_dwordx4 v0, s[8:11], s40 offen offset:0 lds
    v_mfma_f32_16x16x32_bf16 v[84:87], v[196:199], a[68:71], v[84:87]
    ds_read_b64_tr_b16 v[232:233], v19 offset:27648
    ds_read_b64_tr_b16 v[234:235], v19 offset:32256
    v_mfma_f32_16x16x32_bf16 v[88:91], v[196:199], a[192:195], v[88:91]
    ds_read_b64_tr_b16 v[236:237], v20 offset:27648
    ds_read_b64_tr_b16 v[238:239], v20 offset:32256
    v_mfma_f32_16x16x32_bf16 v[92:95], v[196:199], a[196:199], v[92:95]
    v_mfma_f32_16x16x32_bf16 v[96:99], v[200:203], a[64:67], v[96:99]
    ds_read_b64_tr_b16 v[240:241], v17 offset:27776
    ds_read_b64_tr_b16 v[242:243], v17 offset:32384
    v_mfma_f32_16x16x32_bf16 v[100:103], v[200:203], a[68:71], v[100:103]
    buffer_load_dwordx4 v1, s[8:11], s40 offen offset:1152 lds
    v_mfma_f32_16x16x32_bf16 v[104:107], v[200:203], a[192:195], v[104:107]
    s_add_u32 s40, s40, 65536
    ds_read_b64_tr_b16 v[244:245], v18 offset:27776
    ds_read_b64_tr_b16 v[246:247], v18 offset:32384
    v_mfma_f32_16x16x32_bf16 v[108:111], v[200:203], a[196:199], v[108:111]
    ds_read_b64_tr_b16 v[248:249], v19 offset:27776
    ds_read_b64_tr_b16 v[250:251], v19 offset:32384
    v_mfma_f32_16x16x32_bf16 v[112:115], v[204:207], a[64:67], v[112:115]
    v_mfma_f32_16x16x32_bf16 v[116:119], v[204:207], a[68:71], v[116:119]
    ds_read_b64_tr_b16 v[252:253], v20 offset:27776
    ds_read_b64_tr_b16 v[254:255], v20 offset:32384
    v_mfma_f32_16x16x32_bf16 v[120:123], v[204:207], a[192:195], v[120:123]
    buffer_load_dwordx4 a[144:147], v16, s[16:19], s42 offen offset:2048 sc1
    v_mfma_f32_16x16x32_bf16 v[124:127], v[204:207], a[196:199], v[124:127]
    v_mfma_f32_16x16x32_bf16 v[128:131], v[208:211], a[64:67], v[128:131]
    v_mfma_f32_16x16x32_bf16 v[132:135], v[208:211], a[68:71], v[132:135]
    v_mfma_f32_16x16x32_bf16 v[136:139], v[208:211], a[192:195], v[136:139]
    v_mfma_f32_16x16x32_bf16 v[140:143], v[208:211], a[196:199], v[140:143]
    buffer_load_dwordx4 a[148:151], v2, s[16:19], s42 offen offset:2048 sc1
    v_mfma_f32_16x16x32_bf16 v[144:147], v[212:215], a[64:67], v[144:147]
    v_mfma_f32_16x16x32_bf16 v[148:151], v[212:215], a[68:71], v[148:151]
    v_mfma_f32_16x16x32_bf16 v[152:155], v[212:215], a[192:195], v[152:155]
    v_mfma_f32_16x16x32_bf16 v[156:159], v[212:215], a[196:199], v[156:159]
    v_mfma_f32_16x16x32_bf16 v[160:163], v[216:219], a[64:67], v[160:163]
    buffer_load_dwordx4 a[56:59], v16, s[16:19], s41 offen offset:3072 sc1
    v_mfma_f32_16x16x32_bf16 v[164:167], v[216:219], a[68:71], v[164:167]
    v_mfma_f32_16x16x32_bf16 v[168:171], v[216:219], a[192:195], v[168:171]
    v_mfma_f32_16x16x32_bf16 v[172:175], v[216:219], a[196:199], v[172:175]
    v_mfma_f32_16x16x32_bf16 v[176:179], v[220:223], a[64:67], v[176:179]
    v_mfma_f32_16x16x32_bf16 v[180:183], v[220:223], a[68:71], v[180:183]
    buffer_load_dwordx4 a[60:63], v2, s[16:19], s41 offen offset:3072 sc1
    v_mfma_f32_16x16x32_bf16 v[184:187], v[220:223], a[192:195], v[184:187]
    s_add_u32 s41, s41, 4096
    v_mfma_f32_16x16x32_bf16 v[188:191], v[220:223], a[196:199], v[188:191]
    s_waitcnt vmcnt(53) lgkmcnt(0)
    s_barrier
    v_mfma_f32_16x16x32_bf16 v[64:67], v[224:227], a[72:75], v[64:67]
    v_mfma_f32_16x16x32_bf16 v[68:71], v[224:227], a[76:79], v[68:71]
    v_mfma_f32_16x16x32_bf16 v[72:75], v[224:227], a[200:203], v[72:75]
    s_add_u32 m0, s59, 25600
    ds_read_b64_tr_b16 v[192:193], v17 offset:36864
    ds_read_b64_tr_b16 v[194:195], v17 offset:41472
    v_mfma_f32_16x16x32_bf16 v[76:79], v[224:227], a[204:207], v[76:79]
    ds_read_b64_tr_b16 v[196:197], v18 offset:36864
    ds_read_b64_tr_b16 v[198:199], v18 offset:41472
    v_mfma_f32_16x16x32_bf16 v[80:83], v[228:231], a[72:75], v[80:83]
    buffer_load_dwordx4 v0, s[8:11], s40 offen offset:0 lds
    v_mfma_f32_16x16x32_bf16 v[84:87], v[228:231], a[76:79], v[84:87]
    ds_read_b64_tr_b16 v[200:201], v19 offset:36864
    ds_read_b64_tr_b16 v[202:203], v19 offset:41472
    v_mfma_f32_16x16x32_bf16 v[88:91], v[228:231], a[200:203], v[88:91]
    ds_read_b64_tr_b16 v[204:205], v20 offset:36864
    ds_read_b64_tr_b16 v[206:207], v20 offset:41472
    v_mfma_f32_16x16x32_bf16 v[92:95], v[228:231], a[204:207], v[92:95]
    v_mfma_f32_16x16x32_bf16 v[96:99], v[232:235], a[72:75], v[96:99]
    ds_read_b64_tr_b16 v[208:209], v17 offset:36992
    ds_read_b64_tr_b16 v[210:211], v17 offset:41600
    v_mfma_f32_16x16x32_bf16 v[100:103], v[232:235], a[76:79], v[100:103]
    buffer_load_dwordx4 v1, s[8:11], s40 offen offset:1152 lds
    v_mfma_f32_16x16x32_bf16 v[104:107], v[232:235], a[200:203], v[104:107]
    s_add_u32 s40, s40, 65536
    ds_read_b64_tr_b16 v[212:213], v18 offset:36992
    ds_read_b64_tr_b16 v[214:215], v18 offset:41600
    v_mfma_f32_16x16x32_bf16 v[108:111], v[232:235], a[204:207], v[108:111]
    ds_read_b64_tr_b16 v[216:217], v19 offset:36992
    ds_read_b64_tr_b16 v[218:219], v19 offset:41600
    v_mfma_f32_16x16x32_bf16 v[112:115], v[236:239], a[72:75], v[112:115]
    v_mfma_f32_16x16x32_bf16 v[116:119], v[236:239], a[76:79], v[116:119]
    ds_read_b64_tr_b16 v[220:221], v20 offset:36992
    ds_read_b64_tr_b16 v[222:223], v20 offset:41600
    v_mfma_f32_16x16x32_bf16 v[120:123], v[236:239], a[200:203], v[120:123]
    buffer_load_dwordx4 a[152:155], v16, s[16:19], s42 offen offset:3072 sc1
    v_mfma_f32_16x16x32_bf16 v[124:127], v[236:239], a[204:207], v[124:127]
    v_mfma_f32_16x16x32_bf16 v[128:131], v[240:243], a[72:75], v[128:131]
    v_mfma_f32_16x16x32_bf16 v[132:135], v[240:243], a[76:79], v[132:135]
    v_mfma_f32_16x16x32_bf16 v[136:139], v[240:243], a[200:203], v[136:139]
    v_mfma_f32_16x16x32_bf16 v[140:143], v[240:243], a[204:207], v[140:143]
    buffer_load_dwordx4 a[156:159], v2, s[16:19], s42 offen offset:3072 sc1
    v_mfma_f32_16x16x32_bf16 v[144:147], v[244:247], a[72:75], v[144:147]
    s_add_u32 s42, s42, 4096
    v_mfma_f32_16x16x32_bf16 v[148:151], v[244:247], a[76:79], v[148:151]
    v_mfma_f32_16x16x32_bf16 v[152:155], v[244:247], a[200:203], v[152:155]
    v_mfma_f32_16x16x32_bf16 v[156:159], v[244:247], a[204:207], v[156:159]
    v_mfma_f32_16x16x32_bf16 v[160:163], v[248:251], a[72:75], v[160:163]
    buffer_load_dwordx4 a[64:67], v16, s[16:19], s41 offen offset:0 sc1
    v_mfma_f32_16x16x32_bf16 v[164:167], v[248:251], a[76:79], v[164:167]
    v_mfma_f32_16x16x32_bf16 v[168:171], v[248:251], a[200:203], v[168:171]
    v_mfma_f32_16x16x32_bf16 v[172:175], v[248:251], a[204:207], v[172:175]
    v_mfma_f32_16x16x32_bf16 v[176:179], v[252:255], a[72:75], v[176:179]
    v_mfma_f32_16x16x32_bf16 v[180:183], v[252:255], a[76:79], v[180:183]
    buffer_load_dwordx4 a[68:71], v2, s[16:19], s41 offen offset:0 sc1
    v_mfma_f32_16x16x32_bf16 v[184:187], v[252:255], a[200:203], v[184:187]
    v_mfma_f32_16x16x32_bf16 v[188:191], v[252:255], a[204:207], v[188:191]
    s_waitcnt lgkmcnt(0)
    v_mfma_f32_16x16x32_bf16 v[64:67], v[192:195], a[80:83], v[64:67]
    v_mfma_f32_16x16x32_bf16 v[68:71], v[192:195], a[84:87], v[68:71]
    v_mfma_f32_16x16x32_bf16 v[72:75], v[192:195], a[208:211], v[72:75]
    s_add_u32 m0, s59, 34816
    ds_read_b64_tr_b16 v[224:225], v17 offset:46080
    ds_read_b64_tr_b16 v[226:227], v17 offset:50688
    v_mfma_f32_16x16x32_bf16 v[76:79], v[192:195], a[212:215], v[76:79]
    ds_read_b64_tr_b16 v[228:229], v18 offset:46080
    ds_read_b64_tr_b16 v[230:231], v18 offset:50688
    v_mfma_f32_16x16x32_bf16 v[80:83], v[196:199], a[80:83], v[80:83]
gated_mix__ssm_conv_h3__compressed_kv_cla__prompt_kernel_pad13:
    s_cbranch_execz gated_mix__ssm_conv_h3__compressed_kv_cla__prompt_kernel_pad17
    buffer_load_dwordx4 v0, s[8:11], s40 offen offset:0 lds
    v_mfma_f32_16x16x32_bf16 v[84:87], v[196:199], a[84:87], v[84:87]
    ds_read_b64_tr_b16 v[232:233], v19 offset:46080
    ds_read_b64_tr_b16 v[234:235], v19 offset:50688
    v_mfma_f32_16x16x32_bf16 v[88:91], v[196:199], a[208:211], v[88:91]
    ds_read_b64_tr_b16 v[236:237], v20 offset:46080
    ds_read_b64_tr_b16 v[238:239], v20 offset:50688
    v_mfma_f32_16x16x32_bf16 v[92:95], v[196:199], a[212:215], v[92:95]
    v_mfma_f32_16x16x32_bf16 v[96:99], v[200:203], a[80:83], v[96:99]
    ds_read_b64_tr_b16 v[240:241], v17 offset:46208
    ds_read_b64_tr_b16 v[242:243], v17 offset:50816
    v_mfma_f32_16x16x32_bf16 v[100:103], v[200:203], a[84:87], v[100:103]
    buffer_load_dwordx4 v1, s[8:11], s40 offen offset:1152 lds
    v_mfma_f32_16x16x32_bf16 v[104:107], v[200:203], a[208:211], v[104:107]
    s_add_u32 s40, s40, 65536
    ds_read_b64_tr_b16 v[244:245], v18 offset:46208
    ds_read_b64_tr_b16 v[246:247], v18 offset:50816
    v_mfma_f32_16x16x32_bf16 v[108:111], v[200:203], a[212:215], v[108:111]
    ds_read_b64_tr_b16 v[248:249], v19 offset:46208
    ds_read_b64_tr_b16 v[250:251], v19 offset:50816
    v_mfma_f32_16x16x32_bf16 v[112:115], v[204:207], a[80:83], v[112:115]
    v_add_u32 v13, s53, v13
    v_lshrrev_b32 v15, 4, v16
    v_mfma_f32_16x16x32_bf16 v[116:119], v[204:207], a[84:87], v[116:119]
    ds_read_b64_tr_b16 v[252:253], v20 offset:46208
    ds_read_b64_tr_b16 v[254:255], v20 offset:50816
    v_mfma_f32_16x16x32_bf16 v[120:123], v[204:207], a[208:211], v[120:123]
    buffer_load_dwordx4 a[160:163], v16, s[16:19], s42 offen offset:0 sc1
    v_mfma_f32_16x16x32_bf16 v[124:127], v[204:207], a[212:215], v[124:127]
    v_and_b32 v15, 48, v15
    v_cmp_gt_u32 vcc, 256, v16
    v_mfma_f32_16x16x32_bf16 v[128:131], v[208:211], a[80:83], v[128:131]
    v_xor_b32 v15, s57, v15
    v_mfma_f32_16x16x32_bf16 v[132:135], v[208:211], a[84:87], v[132:135]
    v_cndmask_b32 v13, v15, v13, vcc
    v_mfma_f32_16x16x32_bf16 v[136:139], v[208:211], a[208:211], v[136:139]
    buffer_load_dword v14, v13, s[28:31], 0 offen sc1
    v_mfma_f32_16x16x32_bf16 v[140:143], v[208:211], a[212:215], v[140:143]
    buffer_load_dwordx4 a[164:167], v2, s[16:19], s42 offen offset:0 sc1
    v_mfma_f32_16x16x32_bf16 v[144:147], v[212:215], a[80:83], v[144:147]
    v_mfma_f32_16x16x32_bf16 v[148:151], v[212:215], a[84:87], v[148:151]
    v_mfma_f32_16x16x32_bf16 v[152:155], v[212:215], a[208:211], v[152:155]
    v_mfma_f32_16x16x32_bf16 v[156:159], v[212:215], a[212:215], v[156:159]
    v_mfma_f32_16x16x32_bf16 v[160:163], v[216:219], a[80:83], v[160:163]
    buffer_load_dwordx4 a[72:75], v16, s[16:19], s41 offen offset:1024 sc1
    v_mfma_f32_16x16x32_bf16 v[164:167], v[216:219], a[84:87], v[164:167]
    v_mfma_f32_16x16x32_bf16 v[168:171], v[216:219], a[208:211], v[168:171]
    v_mfma_f32_16x16x32_bf16 v[172:175], v[216:219], a[212:215], v[172:175]
    v_mfma_f32_16x16x32_bf16 v[176:179], v[220:223], a[80:83], v[176:179]
    v_mfma_f32_16x16x32_bf16 v[180:183], v[220:223], a[84:87], v[180:183]
    buffer_load_dwordx4 a[76:79], v2, s[16:19], s41 offen offset:1024 sc1
    v_mfma_f32_16x16x32_bf16 v[184:187], v[220:223], a[208:211], v[184:187]
    v_mfma_f32_16x16x32_bf16 v[188:191], v[220:223], a[212:215], v[188:191]
    s_waitcnt vmcnt(54) lgkmcnt(0)
    s_barrier
    v_mfma_f32_16x16x32_bf16 v[64:67], v[224:227], a[88:91], v[64:67]
    v_mfma_f32_16x16x32_bf16 v[68:71], v[224:227], a[92:95], v[68:71]
    v_mfma_f32_16x16x32_bf16 v[72:75], v[224:227], a[216:219], v[72:75]
    s_add_u32 m0, s59, 44032
    ds_read_b64_tr_b16 v[192:193], v17 offset:55296
    ds_read_b64_tr_b16 v[194:195], v17 offset:59904
    v_mfma_f32_16x16x32_bf16 v[76:79], v[224:227], a[220:223], v[76:79]
    ds_read_b64_tr_b16 v[196:197], v18 offset:55296
    ds_read_b64_tr_b16 v[198:199], v18 offset:59904
    v_mfma_f32_16x16x32_bf16 v[80:83], v[228:231], a[88:91], v[80:83]
    buffer_load_dwordx4 v0, s[8:11], s40 offen offset:0 lds
    v_mfma_f32_16x16x32_bf16 v[84:87], v[228:231], a[92:95], v[84:87]
    ds_read_b64_tr_b16 v[200:201], v19 offset:55296
    ds_read_b64_tr_b16 v[202:203], v19 offset:59904
    v_mfma_f32_16x16x32_bf16 v[88:91], v[228:231], a[216:219], v[88:91]
    ds_read_b64_tr_b16 v[204:205], v20 offset:55296
    ds_read_b64_tr_b16 v[206:207], v20 offset:59904
    v_mfma_f32_16x16x32_bf16 v[92:95], v[228:231], a[220:223], v[92:95]
    v_mfma_f32_16x16x32_bf16 v[96:99], v[232:235], a[88:91], v[96:99]
    ds_read_b64_tr_b16 v[208:209], v17 offset:55424
    ds_read_b64_tr_b16 v[210:211], v17 offset:60032
    v_mfma_f32_16x16x32_bf16 v[100:103], v[232:235], a[92:95], v[100:103]
    buffer_load_dwordx4 v1, s[8:11], s40 offen offset:1152 lds
    v_mfma_f32_16x16x32_bf16 v[104:107], v[232:235], a[216:219], v[104:107]
    s_add_u32 s40, s40, 65536
    ds_read_b64_tr_b16 v[212:213], v18 offset:55424
    ds_read_b64_tr_b16 v[214:215], v18 offset:60032
    v_mfma_f32_16x16x32_bf16 v[108:111], v[232:235], a[220:223], v[108:111]
    ds_read_b64_tr_b16 v[216:217], v19 offset:55424
    ds_read_b64_tr_b16 v[218:219], v19 offset:60032
    v_mfma_f32_16x16x32_bf16 v[112:115], v[236:239], a[88:91], v[112:115]
    v_mfma_f32_16x16x32_bf16 v[116:119], v[236:239], a[92:95], v[116:119]
    ds_read_b64_tr_b16 v[220:221], v20 offset:55424
    ds_read_b64_tr_b16 v[222:223], v20 offset:60032
    v_mfma_f32_16x16x32_bf16 v[120:123], v[236:239], a[216:219], v[120:123]
    buffer_load_dwordx4 a[168:171], v16, s[16:19], s42 offen offset:1024 sc1
    v_mfma_f32_16x16x32_bf16 v[124:127], v[236:239], a[220:223], v[124:127]
    v_mfma_f32_16x16x32_bf16 v[128:131], v[240:243], a[88:91], v[128:131]
    v_mfma_f32_16x16x32_bf16 v[132:135], v[240:243], a[92:95], v[132:135]
    v_mfma_f32_16x16x32_bf16 v[136:139], v[240:243], a[216:219], v[136:139]
    v_mfma_f32_16x16x32_bf16 v[140:143], v[240:243], a[220:223], v[140:143]
    buffer_load_dwordx4 a[172:175], v2, s[16:19], s42 offen offset:1024 sc1
    v_mfma_f32_16x16x32_bf16 v[144:147], v[244:247], a[88:91], v[144:147]
    v_mfma_f32_16x16x32_bf16 v[148:151], v[244:247], a[92:95], v[148:151]
    v_mfma_f32_16x16x32_bf16 v[152:155], v[244:247], a[216:219], v[152:155]
    v_mfma_f32_16x16x32_bf16 v[156:159], v[244:247], a[220:223], v[156:159]
    v_mfma_f32_16x16x32_bf16 v[160:163], v[248:251], a[88:91], v[160:163]
    buffer_load_dwordx4 a[80:83], v16, s[16:19], s41 offen offset:2048 sc1
    v_mfma_f32_16x16x32_bf16 v[164:167], v[248:251], a[92:95], v[164:167]
    v_mfma_f32_16x16x32_bf16 v[168:171], v[248:251], a[216:219], v[168:171]
    v_mfma_f32_16x16x32_bf16 v[172:175], v[248:251], a[220:223], v[172:175]
    v_mfma_f32_16x16x32_bf16 v[176:179], v[252:255], a[88:91], v[176:179]
    v_mfma_f32_16x16x32_bf16 v[180:183], v[252:255], a[92:95], v[180:183]
    buffer_load_dwordx4 a[84:87], v2, s[16:19], s41 offen offset:2048 sc1
    v_mfma_f32_16x16x32_bf16 v[184:187], v[252:255], a[216:219], v[184:187]
    v_mfma_f32_16x16x32_bf16 v[188:191], v[252:255], a[220:223], v[188:191]
    s_waitcnt lgkmcnt(0)
    v_mfma_f32_16x16x32_bf16 v[64:67], v[192:195], a[96:99], v[64:67]
    v_add_u32 v17, 64512, v17
    v_add_u32 v18, 64512, v18
    v_mfma_f32_16x16x32_bf16 v[68:71], v[192:195], a[100:103], v[68:71]
    v_add_u32 v19, 64512, v19
    v_add_u32 v20, 64512, v20
    v_mfma_f32_16x16x32_bf16 v[72:75], v[192:195], a[224:227], v[72:75]
    s_add_u32 m0, s59, 53248
    ds_read_b64_tr_b16 v[224:225], v17 offset:0
    ds_read_b64_tr_b16 v[226:227], v17 offset:4608
    v_mfma_f32_16x16x32_bf16 v[76:79], v[192:195], a[228:231], v[76:79]
    ds_read_b64_tr_b16 v[228:229], v18 offset:0
    ds_read_b64_tr_b16 v[230:231], v18 offset:4608
    v_mfma_f32_16x16x32_bf16 v[80:83], v[196:199], a[96:99], v[80:83]
    buffer_load_dwordx4 v0, s[8:11], s40 offen offset:0 lds
    v_mfma_f32_16x16x32_bf16 v[84:87], v[196:199], a[100:103], v[84:87]
    ds_read_b64_tr_b16 v[232:233], v19 offset:0
    ds_read_b64_tr_b16 v[234:235], v19 offset:4608
    v_mfma_f32_16x16x32_bf16 v[88:91], v[196:199], a[224:227], v[88:91]
    ds_read_b64_tr_b16 v[236:237], v20 offset:0
    ds_read_b64_tr_b16 v[238:239], v20 offset:4608
    v_mfma_f32_16x16x32_bf16 v[92:95], v[196:199], a[228:231], v[92:95]
    v_mfma_f32_16x16x32_bf16 v[96:99], v[200:203], a[96:99], v[96:99]
    ds_read_b64_tr_b16 v[240:241], v17 offset:128
    ds_read_b64_tr_b16 v[242:243], v17 offset:4736
    v_mfma_f32_16x16x32_bf16 v[100:103], v[200:203], a[100:103], v[100:103]
    buffer_load_dwordx4 v1, s[8:11], s40 offen offset:1152 lds
    v_mfma_f32_16x16x32_bf16 v[104:107], v[200:203], a[224:227], v[104:107]
    s_add_u32 s40, s40, 65536
    ds_read_b64_tr_b16 v[244:245], v18 offset:128
    ds_read_b64_tr_b16 v[246:247], v18 offset:4736
    v_mfma_f32_16x16x32_bf16 v[108:111], v[200:203], a[228:231], v[108:111]
    ds_read_b64_tr_b16 v[248:249], v19 offset:128
    ds_read_b64_tr_b16 v[250:251], v19 offset:4736
    v_mfma_f32_16x16x32_bf16 v[112:115], v[204:207], a[96:99], v[112:115]
    v_mfma_f32_16x16x32_bf16 v[116:119], v[204:207], a[100:103], v[116:119]
    ds_read_b64_tr_b16 v[252:253], v20 offset:128
    ds_read_b64_tr_b16 v[254:255], v20 offset:4736
    v_mfma_f32_16x16x32_bf16 v[120:123], v[204:207], a[224:227], v[120:123]
    buffer_load_dwordx4 a[176:179], v16, s[16:19], s42 offen offset:2048 sc1
    v_mfma_f32_16x16x32_bf16 v[124:127], v[204:207], a[228:231], v[124:127]
    v_mfma_f32_16x16x32_bf16 v[128:131], v[208:211], a[96:99], v[128:131]
    v_mfma_f32_16x16x32_bf16 v[132:135], v[208:211], a[100:103], v[132:135]
    v_mfma_f32_16x16x32_bf16 v[136:139], v[208:211], a[224:227], v[136:139]
    v_mfma_f32_16x16x32_bf16 v[140:143], v[208:211], a[228:231], v[140:143]
    buffer_load_dwordx4 a[180:183], v2, s[16:19], s42 offen offset:2048 sc1
    v_mfma_f32_16x16x32_bf16 v[144:147], v[212:215], a[96:99], v[144:147]
    v_mfma_f32_16x16x32_bf16 v[148:151], v[212:215], a[100:103], v[148:151]
    v_mfma_f32_16x16x32_bf16 v[152:155], v[212:215], a[224:227], v[152:155]
    v_mfma_f32_16x16x32_bf16 v[156:159], v[212:215], a[228:231], v[156:159]
    v_mfma_f32_16x16x32_bf16 v[160:163], v[216:219], a[96:99], v[160:163]
    buffer_load_dwordx4 a[88:91], v16, s[16:19], s41 offen offset:3072 sc1
    v_mfma_f32_16x16x32_bf16 v[164:167], v[216:219], a[100:103], v[164:167]
    v_mfma_f32_16x16x32_bf16 v[168:171], v[216:219], a[224:227], v[168:171]
    v_mfma_f32_16x16x32_bf16 v[172:175], v[216:219], a[228:231], v[172:175]
    v_mfma_f32_16x16x32_bf16 v[176:179], v[220:223], a[96:99], v[176:179]
    v_mfma_f32_16x16x32_bf16 v[180:183], v[220:223], a[100:103], v[180:183]
    buffer_load_dwordx4 a[92:95], v2, s[16:19], s41 offen offset:3072 sc1
    v_mfma_f32_16x16x32_bf16 v[184:187], v[220:223], a[224:227], v[184:187]
    s_add_u32 s41, s41, 4096
    v_mfma_f32_16x16x32_bf16 v[188:191], v[220:223], a[228:231], v[188:191]
    s_waitcnt vmcnt(53) lgkmcnt(0)
    s_barrier
    v_mfma_f32_16x16x32_bf16 v[64:67], v[224:227], a[104:107], v[64:67]
    v_mfma_f32_16x16x32_bf16 v[68:71], v[224:227], a[108:111], v[68:71]
    v_mfma_f32_16x16x32_bf16 v[72:75], v[224:227], a[232:235], v[72:75]
    s_add_u32 m0, s59, 62464
    ds_read_b64_tr_b16 v[192:193], v17 offset:9216
    ds_read_b64_tr_b16 v[194:195], v17 offset:13824
    v_mfma_f32_16x16x32_bf16 v[76:79], v[224:227], a[236:239], v[76:79]
    ds_read_b64_tr_b16 v[196:197], v18 offset:9216
    ds_read_b64_tr_b16 v[198:199], v18 offset:13824
    v_mfma_f32_16x16x32_bf16 v[80:83], v[228:231], a[104:107], v[80:83]
    buffer_load_dwordx4 v0, s[8:11], s40 offen offset:0 lds
    v_mfma_f32_16x16x32_bf16 v[84:87], v[228:231], a[108:111], v[84:87]
    ds_read_b64_tr_b16 v[200:201], v19 offset:9216
    ds_read_b64_tr_b16 v[202:203], v19 offset:13824
    v_mfma_f32_16x16x32_bf16 v[88:91], v[228:231], a[232:235], v[88:91]
    ds_read_b64_tr_b16 v[204:205], v20 offset:9216
    ds_read_b64_tr_b16 v[206:207], v20 offset:13824
    v_mfma_f32_16x16x32_bf16 v[92:95], v[228:231], a[236:239], v[92:95]
    v_mfma_f32_16x16x32_bf16 v[96:99], v[232:235], a[104:107], v[96:99]
    ds_read_b64_tr_b16 v[208:209], v17 offset:9344
    ds_read_b64_tr_b16 v[210:211], v17 offset:13952
    v_mfma_f32_16x16x32_bf16 v[100:103], v[232:235], a[108:111], v[100:103]
    buffer_load_dwordx4 v1, s[8:11], s40 offen offset:1152 lds
    v_mfma_f32_16x16x32_bf16 v[104:107], v[232:235], a[232:235], v[104:107]
    s_add_u32 s40, s40, 65536
    ds_read_b64_tr_b16 v[212:213], v18 offset:9344
    ds_read_b64_tr_b16 v[214:215], v18 offset:13952
    v_mfma_f32_16x16x32_bf16 v[108:111], v[232:235], a[236:239], v[108:111]
    ds_read_b64_tr_b16 v[216:217], v19 offset:9344
    ds_read_b64_tr_b16 v[218:219], v19 offset:13952
    v_mfma_f32_16x16x32_bf16 v[112:115], v[236:239], a[104:107], v[112:115]
    s_waitcnt vmcnt(17)
    v_cmp_ne_u32 vcc, 1, v14
    s_nop 0
    v_mfma_f32_16x16x32_bf16 v[116:119], v[236:239], a[108:111], v[116:119]
    ds_read_b64_tr_b16 v[220:221], v20 offset:9344
    ds_read_b64_tr_b16 v[222:223], v20 offset:13952
    v_mfma_f32_16x16x32_bf16 v[120:123], v[236:239], a[232:235], v[120:123]
    buffer_load_dwordx4 a[184:187], v16, s[16:19], s42 offen offset:3072 sc1
    v_mfma_f32_16x16x32_bf16 v[124:127], v[236:239], a[236:239], v[124:127]
    s_cbranch_vccnz gated_mix__ssm_conv_h3__compressed_kv_cla__prompt_kernel_spin_y
gated_mix__ssm_conv_h3__compressed_kv_cla__prompt_kernel_spin_y_ret:
    v_mfma_f32_16x16x32_bf16 v[128:131], v[240:243], a[104:107], v[128:131]
    s_lshl_b32 s53, s32, 12
    s_add_u32 m0, s53, 0
    v_mfma_f32_16x16x32_bf16 v[132:135], v[240:243], a[108:111], v[132:135]
    s_add_u32 s36, s51, 0
    buffer_load_dwordx4 v10, s[12:15], s36 offen sc1 lds
    v_mfma_f32_16x16x32_bf16 v[136:139], v[240:243], a[232:235], v[136:139]
    v_mfma_f32_16x16x32_bf16 v[140:143], v[240:243], a[236:239], v[140:143]
    buffer_load_dwordx4 a[188:191], v2, s[16:19], s42 offen offset:3072 sc1
    v_mfma_f32_16x16x32_bf16 v[144:147], v[244:247], a[104:107], v[144:147]
    s_add_u32 s42, s42, 4096
    v_mfma_f32_16x16x32_bf16 v[148:151], v[244:247], a[108:111], v[148:151]
    v_mfma_f32_16x16x32_bf16 v[152:155], v[244:247], a[232:235], v[152:155]
    v_mfma_f32_16x16x32_bf16 v[156:159], v[244:247], a[236:239], v[156:159]
    v_mfma_f32_16x16x32_bf16 v[160:163], v[248:251], a[104:107], v[160:163]
    buffer_load_dwordx4 a[96:99], v16, s[16:19], s41 offen offset:0 sc1
    v_mfma_f32_16x16x32_bf16 v[164:167], v[248:251], a[108:111], v[164:167]
    v_mfma_f32_16x16x32_bf16 v[168:171], v[248:251], a[232:235], v[168:171]
    v_mfma_f32_16x16x32_bf16 v[172:175], v[248:251], a[236:239], v[172:175]
    v_mfma_f32_16x16x32_bf16 v[176:179], v[252:255], a[104:107], v[176:179]
    v_mfma_f32_16x16x32_bf16 v[180:183], v[252:255], a[108:111], v[180:183]
    buffer_load_dwordx4 a[100:103], v2, s[16:19], s41 offen offset:0 sc1
    v_mfma_f32_16x16x32_bf16 v[184:187], v[252:255], a[232:235], v[184:187]
    v_mfma_f32_16x16x32_bf16 v[188:191], v[252:255], a[236:239], v[188:191]
    s_waitcnt lgkmcnt(0)
    v_mfma_f32_16x16x32_bf16 v[64:67], v[192:195], a[112:115], v[64:67]
    v_mfma_f32_16x16x32_bf16 v[68:71], v[192:195], a[116:119], v[68:71]
    v_mfma_f32_16x16x32_bf16 v[72:75], v[192:195], a[240:243], v[72:75]
    s_add_u32 m0, s59, 71680
    ds_read_b64_tr_b16 v[224:225], v17 offset:18432
    ds_read_b64_tr_b16 v[226:227], v17 offset:23040
    v_mfma_f32_16x16x32_bf16 v[76:79], v[192:195], a[244:247], v[76:79]
    ds_read_b64_tr_b16 v[228:229], v18 offset:18432
    ds_read_b64_tr_b16 v[230:231], v18 offset:23040
    v_mfma_f32_16x16x32_bf16 v[80:83], v[196:199], a[112:115], v[80:83]
    buffer_load_dwordx4 v0, s[8:11], s40 offen offset:0 lds
    v_mfma_f32_16x16x32_bf16 v[84:87], v[196:199], a[116:119], v[84:87]
    ds_read_b64_tr_b16 v[232:233], v19 offset:18432
    ds_read_b64_tr_b16 v[234:235], v19 offset:23040
    v_mfma_f32_16x16x32_bf16 v[88:91], v[196:199], a[240:243], v[88:91]
    ds_read_b64_tr_b16 v[236:237], v20 offset:18432
    ds_read_b64_tr_b16 v[238:239], v20 offset:23040
    v_mfma_f32_16x16x32_bf16 v[92:95], v[196:199], a[244:247], v[92:95]
    v_mfma_f32_16x16x32_bf16 v[96:99], v[200:203], a[112:115], v[96:99]
    ds_read_b64_tr_b16 v[240:241], v17 offset:18560
    ds_read_b64_tr_b16 v[242:243], v17 offset:23168
    v_mfma_f32_16x16x32_bf16 v[100:103], v[200:203], a[116:119], v[100:103]
    buffer_load_dwordx4 v1, s[8:11], s40 offen offset:1152 lds
    v_mfma_f32_16x16x32_bf16 v[104:107], v[200:203], a[240:243], v[104:107]
    s_add_u32 s40, s40, 65536
    ds_read_b64_tr_b16 v[244:245], v18 offset:18560
    ds_read_b64_tr_b16 v[246:247], v18 offset:23168
    v_mfma_f32_16x16x32_bf16 v[108:111], v[200:203], a[244:247], v[108:111]
    ds_read_b64_tr_b16 v[248:249], v19 offset:18560
    ds_read_b64_tr_b16 v[250:251], v19 offset:23168
    v_mfma_f32_16x16x32_bf16 v[112:115], v[204:207], a[112:115], v[112:115]
    s_add_u32 m0, s53, 1024
    s_add_u32 s36, s51, 8192
    buffer_load_dwordx4 v10, s[12:15], s36 offen sc1 lds
    v_mfma_f32_16x16x32_bf16 v[116:119], v[204:207], a[116:119], v[116:119]
    ds_read_b64_tr_b16 v[252:253], v20 offset:18560
    ds_read_b64_tr_b16 v[254:255], v20 offset:23168
    v_mfma_f32_16x16x32_bf16 v[120:123], v[204:207], a[240:243], v[120:123]
    buffer_load_dwordx4 a[192:195], v16, s[16:19], s42 offen offset:0 sc1
    v_mfma_f32_16x16x32_bf16 v[124:127], v[204:207], a[244:247], v[124:127]
    s_add_u32 m0, s53, 2048
    s_add_u32 s36, s51, 16384
    buffer_load_dwordx4 v10, s[12:15], s36 offen sc1 lds
    v_mfma_f32_16x16x32_bf16 v[128:131], v[208:211], a[112:115], v[128:131]
    s_add_u32 m0, s53, 3072
    s_add_u32 s36, s51, 24576
    buffer_load_dwordx4 v10, s[12:15], s36 offen sc1 lds
    v_mfma_f32_16x16x32_bf16 v[132:135], v[208:211], a[116:119], v[132:135]
    s_mov_b32 s37, 0xffff0000
    s_waitcnt vmcnt(59)
    v_permlane16_swap_b32 v24, v26
    v_mfma_f32_16x16x32_bf16 v[136:139], v[208:211], a[240:243], v[136:139]
    v_permlane16_swap_b32 v25, v27
    v_mfma_f32_16x16x32_bf16 v[140:143], v[208:211], a[244:247], v[140:143]
    buffer_load_dwordx4 a[196:199], v2, s[16:19], s42 offen offset:0 sc1
    v_mfma_f32_16x16x32_bf16 v[144:147], v[212:215], a[112:115], v[144:147]
    v_permlane16_swap_b32 v28, v30
    v_mfma_f32_16x16x32_bf16 v[148:151], v[212:215], a[116:119], v[148:151]
    v_permlane16_swap_b32 v29, v31
    v_mfma_f32_16x16x32_bf16 v[152:155], v[212:215], a[240:243], v[152:155]
    v_permlane16_swap_b32 v32, v34
    v_mfma_f32_16x16x32_bf16 v[156:159], v[212:215], a[244:247], v[156:159]
    v_permlane16_swap_b32 v33, v35
    v_mfma_f32_16x16x32_bf16 v[160:163], v[216:219], a[112:115], v[160:163]
    buffer_load_dwordx4 a[104:107], v16, s[16:19], s41 offen offset:1024 sc1
    v_mfma_f32_16x16x32_bf16 v[164:167], v[216:219], a[116:119], v[164:167]
    v_permlane16_swap_b32 v36, v38
    v_mfma_f32_16x16x32_bf16 v[168:171], v[216:219], a[240:243], v[168:171]
    v_permlane16_swap_b32 v37, v39
    v_mfma_f32_16x16x32_bf16 v[172:175], v[216:219], a[244:247], v[172:175]
    v_mfma_f32_16x16x32_bf16 v[176:179], v[220:223], a[112:115], v[176:179]
    v_mfma_f32_16x16x32_bf16 v[180:183], v[220:223], a[116:119], v[180:183]
    buffer_load_dwordx4 a[108:111], v2, s[16:19], s41 offen offset:1024 sc1
    v_mfma_f32_16x16x32_bf16 v[184:187], v[220:223], a[240:243], v[184:187]
    v_mfma_f32_16x16x32_bf16 v[188:191], v[220:223], a[244:247], v[188:191]
    s_waitcnt vmcnt(55) lgkmcnt(0)
    s_barrier
    v_mfma_f32_16x16x32_bf16 v[64:67], v[224:227], a[120:123], v[64:67]
    v_mfma_f32_16x16x32_bf16 v[68:71], v[224:227], a[124:127], v[68:71]
    v_mfma_f32_16x16x32_bf16 v[72:75], v[224:227], a[248:251], v[72:75]
    s_add_u32 m0, s59, 80896
    ds_read_b64_tr_b16 v[192:193], v17 offset:27648
    ds_read_b64_tr_b16 v[194:195], v17 offset:32256
    v_mfma_f32_16x16x32_bf16 v[76:79], v[224:227], a[252:255], v[76:79]
    ds_read_b64_tr_b16 v[196:197], v18 offset:27648
    ds_read_b64_tr_b16 v[198:199], v18 offset:32256
    v_mfma_f32_16x16x32_bf16 v[80:83], v[228:231], a[120:123], v[80:83]
    buffer_load_dwordx4 v0, s[8:11], s40 offen offset:0 lds
    v_mfma_f32_16x16x32_bf16 v[84:87], v[228:231], a[124:127], v[84:87]
    ds_read_b64_tr_b16 v[200:201], v19 offset:27648
    ds_read_b64_tr_b16 v[202:203], v19 offset:32256
    v_mfma_f32_16x16x32_bf16 v[88:91], v[228:231], a[248:251], v[88:91]
    ds_read_b64_tr_b16 v[204:205], v20 offset:27648
    ds_read_b64_tr_b16 v[206:207], v20 offset:32256
    v_mfma_f32_16x16x32_bf16 v[92:95], v[228:231], a[252:255], v[92:95]
    v_mfma_f32_16x16x32_bf16 v[96:99], v[232:235], a[120:123], v[96:99]
    ds_read_b64_tr_b16 v[208:209], v17 offset:27776
    ds_read_b64_tr_b16 v[210:211], v17 offset:32384
    v_mfma_f32_16x16x32_bf16 v[100:103], v[232:235], a[124:127], v[100:103]
    buffer_load_dwordx4 v1, s[8:11], s40 offen offset:1152 lds
    v_mfma_f32_16x16x32_bf16 v[104:107], v[232:235], a[248:251], v[104:107]
    s_add_u32 s40, s40, 65536
    ds_read_b64_tr_b16 v[212:213], v18 offset:27776
    ds_read_b64_tr_b16 v[214:215], v18 offset:32384
    v_mfma_f32_16x16x32_bf16 v[108:111], v[232:235], a[252:255], v[108:111]
    ds_read_b64_tr_b16 v[216:217], v19 offset:27776
    ds_read_b64_tr_b16 v[218:219], v19 offset:32384
    v_mfma_f32_16x16x32_bf16 v[112:115], v[236:239], a[120:123], v[112:115]
    v_mfma_f32_16x16x32_bf16 v[116:119], v[236:239], a[124:127], v[116:119]
    ds_read_b64_tr_b16 v[220:221], v20 offset:27776
    ds_read_b64_tr_b16 v[222:223], v20 offset:32384
    v_mfma_f32_16x16x32_bf16 v[120:123], v[236:239], a[248:251], v[120:123]
    buffer_load_dwordx4 a[200:203], v16, s[16:19], s42 offen offset:1024 sc1
    v_mfma_f32_16x16x32_bf16 v[124:127], v[236:239], a[252:255], v[124:127]
    v_mfma_f32_16x16x32_bf16 v[128:131], v[240:243], a[120:123], v[128:131]
    v_mfma_f32_16x16x32_bf16 v[132:135], v[240:243], a[124:127], v[132:135]
    v_mfma_f32_16x16x32_bf16 v[136:139], v[240:243], a[248:251], v[136:139]
    v_mfma_f32_16x16x32_bf16 v[140:143], v[240:243], a[252:255], v[140:143]
    buffer_load_dwordx4 a[204:207], v2, s[16:19], s42 offen offset:1024 sc1
    v_mfma_f32_16x16x32_bf16 v[144:147], v[244:247], a[120:123], v[144:147]
    v_mfma_f32_16x16x32_bf16 v[148:151], v[244:247], a[124:127], v[148:151]
    v_mfma_f32_16x16x32_bf16 v[152:155], v[244:247], a[248:251], v[152:155]
    v_mfma_f32_16x16x32_bf16 v[156:159], v[244:247], a[252:255], v[156:159]
    v_mfma_f32_16x16x32_bf16 v[160:163], v[248:251], a[120:123], v[160:163]
    buffer_load_dwordx4 a[112:115], v16, s[16:19], s41 offen offset:2048 sc1
    v_mfma_f32_16x16x32_bf16 v[164:167], v[248:251], a[124:127], v[164:167]
    v_mfma_f32_16x16x32_bf16 v[168:171], v[248:251], a[248:251], v[168:171]
    v_mfma_f32_16x16x32_bf16 v[172:175], v[248:251], a[252:255], v[172:175]
    v_mfma_f32_16x16x32_bf16 v[176:179], v[252:255], a[120:123], v[176:179]
    v_mfma_f32_16x16x32_bf16 v[180:183], v[252:255], a[124:127], v[180:183]
    buffer_load_dwordx4 a[116:119], v2, s[16:19], s41 offen offset:2048 sc1
    v_mfma_f32_16x16x32_bf16 v[184:187], v[252:255], a[248:251], v[184:187]
    v_mfma_f32_16x16x32_bf16 v[188:191], v[252:255], a[252:255], v[188:191]
    s_waitcnt lgkmcnt(0)
    v_mfma_f32_16x16x32_bf16 v[64:67], v[192:195], a[0:3], v[64:67]
    ds_read_b64_tr_b16 v[224:225], v17 offset:36864
    ds_read_b64_tr_b16 v[226:227], v17 offset:41472
    v_mfma_f32_16x16x32_bf16 v[68:71], v[192:195], a[4:7], v[68:71]
    s_add_u32 m0, s59, 90112
    v_mfma_f32_16x16x32_bf16 v[72:75], v[192:195], a[128:131], v[72:75]
    ds_read_b64_tr_b16 v[228:229], v18 offset:36864
    ds_read_b64_tr_b16 v[230:231], v18 offset:41472
    v_mfma_f32_16x16x32_bf16 v[76:79], v[192:195], a[132:135], v[76:79]
    buffer_load_dwordx4 v0, s[8:11], s40 offen offset:0 lds
    v_mfma_f32_16x16x32_bf16 v[80:83], v[196:199], a[0:3], v[80:83]
    buffer_load_dwordx4 v1, s[8:11], s40 offen offset:1152 lds
    v_mfma_f32_16x16x32_bf16 v[84:87], v[196:199], a[4:7], v[84:87]
    s_add_u32 s40, s40, 65536
    buffer_load_dwordx4 a[208:211], v16, s[16:19], s42 offen offset:2048 sc1
    v_mfma_f32_16x16x32_bf16 v[88:91], v[196:199], a[128:131], v[88:91]
    buffer_load_dwordx4 a[212:215], v2, s[16:19], s42 offen offset:2048 sc1
    v_mfma_f32_16x16x32_bf16 v[92:95], v[196:199], a[132:135], v[92:95]
    s_waitcnt vmcnt(13) lgkmcnt(0)
    s_barrier
    v_mfma_f32_16x16x32_bf16 v[64:67], v[224:227], a[8:11], v[64:67]
    ds_read_b64_tr_b16 v[192:193], v17 offset:46080
    ds_read_b64_tr_b16 v[194:195], v17 offset:50688
    v_mfma_f32_16x16x32_bf16 v[68:71], v[224:227], a[12:15], v[68:71]
    buffer_load_dwordx4 a[120:123], v16, s[16:19], s41 offen offset:3072 sc1
    v_mfma_f32_16x16x32_bf16 v[72:75], v[224:227], a[136:139], v[72:75]
    ds_read_b64_tr_b16 v[196:197], v18 offset:46080
    ds_read_b64_tr_b16 v[198:199], v18 offset:50688
    v_mfma_f32_16x16x32_bf16 v[76:79], v[224:227], a[140:143], v[76:79]
    buffer_load_dwordx4 a[124:127], v2, s[16:19], s41 offen offset:3072 sc1
    v_mfma_f32_16x16x32_bf16 v[80:83], v[228:231], a[8:11], v[80:83]
    s_add_u32 s41, s41, 4096
    s_add_u32 m0, s59, 99328
    v_mfma_f32_16x16x32_bf16 v[84:87], v[228:231], a[12:15], v[84:87]
    buffer_load_dwordx4 v0, s[8:11], s40 offen offset:0 lds
    v_mfma_f32_16x16x32_bf16 v[88:91], v[228:231], a[136:139], v[88:91]
    buffer_load_dwordx4 v1, s[8:11], s40 offen offset:1152 lds
    v_mfma_f32_16x16x32_bf16 v[92:95], v[228:231], a[140:143], v[92:95]
    s_waitcnt lgkmcnt(0)
    s_add_u32 s40, s40, 65536
    buffer_load_dwordx4 a[216:219], v16, s[16:19], s42 offen offset:3072 sc1
    v_mfma_f32_16x16x32_bf16 v[64:67], v[192:195], a[16:19], v[64:67]
    ds_read_b64_tr_b16 v[224:225], v17 offset:55296
    ds_read_b64_tr_b16 v[226:227], v17 offset:59904
    v_mfma_f32_16x16x32_bf16 v[68:71], v[192:195], a[20:23], v[68:71]
    buffer_load_dwordx4 a[220:223], v2, s[16:19], s42 offen offset:3072 sc1
    v_mfma_f32_16x16x32_bf16 v[72:75], v[192:195], a[144:147], v[72:75]
    ds_read_b64_tr_b16 v[228:229], v18 offset:55296
    ds_read_b64_tr_b16 v[230:231], v18 offset:59904
    v_mfma_f32_16x16x32_bf16 v[76:79], v[192:195], a[148:151], v[76:79]
    s_add_u32 s42, s42, 4096
    buffer_load_dwordx4 a[224:227], v16, s[16:19], s42 offen offset:0 sc1
    v_mfma_f32_16x16x32_bf16 v[80:83], v[196:199], a[16:19], v[80:83]
    buffer_load_dwordx4 a[228:231], v2, s[16:19], s42 offen offset:0 sc1
    v_mfma_f32_16x16x32_bf16 v[84:87], v[196:199], a[20:23], v[84:87]
    buffer_load_dwordx4 a[232:235], v16, s[16:19], s42 offen offset:1024 sc1
    v_mfma_f32_16x16x32_bf16 v[88:91], v[196:199], a[144:147], v[88:91]
    buffer_load_dwordx4 a[236:239], v2, s[16:19], s42 offen offset:1024 sc1
    v_mfma_f32_16x16x32_bf16 v[92:95], v[196:199], a[148:151], v[92:95]
    s_waitcnt vmcnt(50) lgkmcnt(0)
    s_barrier
    v_mfma_f32_16x16x32_bf16 v[64:67], v[224:227], a[24:27], v[64:67]
    v_add_u32 v17, 64512, v17
    v_add_u32 v18, 64512, v18
    v_mfma_f32_16x16x32_bf16 v[68:71], v[224:227], a[28:31], v[68:71]
    v_add_u32 v19, 64512, v19
    v_add_u32 v20, 64512, v20
    v_mfma_f32_16x16x32_bf16 v[72:75], v[224:227], a[152:155], v[72:75]
    ds_read_b64_tr_b16 v[192:193], v17 offset:0
    ds_read_b64_tr_b16 v[194:195], v17 offset:4608
    v_mfma_f32_16x16x32_bf16 v[76:79], v[224:227], a[156:159], v[76:79]
    ds_read_b64_tr_b16 v[196:197], v18 offset:0
    ds_read_b64_tr_b16 v[198:199], v18 offset:4608
    v_mfma_f32_16x16x32_bf16 v[80:83], v[228:231], a[24:27], v[80:83]
    buffer_load_dwordx4 a[240:243], v16, s[16:19], s42 offen offset:2048 sc1
    v_mfma_f32_16x16x32_bf16 v[84:87], v[228:231], a[28:31], v[84:87]
    buffer_load_dwordx4 a[244:247], v2, s[16:19], s42 offen offset:2048 sc1
    v_mfma_f32_16x16x32_bf16 v[88:91], v[228:231], a[152:155], v[88:91]
    buffer_load_dwordx4 a[248:251], v16, s[16:19], s42 offen offset:3072 sc1
    v_mfma_f32_16x16x32_bf16 v[92:95], v[228:231], a[156:159], v[92:95]
    s_waitcnt lgkmcnt(0)
    v_mfma_f32_16x16x32_bf16 v[64:67], v[192:195], a[32:35], v[64:67]
    ds_read_b64_tr_b16 v[224:225], v17 offset:9216
    ds_read_b64_tr_b16 v[226:227], v17 offset:13824
    v_mfma_f32_16x16x32_bf16 v[68:71], v[192:195], a[36:39], v[68:71]
    buffer_load_dwordx4 a[252:255], v2, s[16:19], s42 offen offset:3072 sc1
    v_mfma_f32_16x16x32_bf16 v[72:75], v[192:195], a[160:163], v[72:75]
    ds_read_b64_tr_b16 v[228:229], v18 offset:9216
    ds_read_b64_tr_b16 v[230:231], v18 offset:13824
    v_mfma_f32_16x16x32_bf16 v[76:79], v[192:195], a[164:167], v[76:79]
    s_add_u32 s42, s42, 4096
    s_add_u32 s16, s94, 67108864
    s_addc_u32 s17, s95, 0
    v_mfma_f32_16x16x32_bf16 v[80:83], v[196:199], a[32:35], v[80:83]
    s_mov_b32 s18, 16777216
    ds_read_b64_tr_b16 v[48:49], v22 offset:0
    ds_read_b64_tr_b16 v[50:51], v22 offset:128
    v_mfma_f32_16x16x32_bf16 v[84:87], v[196:199], a[36:39], v[84:87]
    ds_read_b64_tr_b16 v[52:53], v22 offset:256
    ds_read_b64_tr_b16 v[54:55], v22 offset:384
    v_mfma_f32_16x16x32_bf16 v[88:91], v[196:199], a[160:163], v[88:91]
    ds_read_b64_tr_b16 v[56:57], v22 offset:8192
    ds_read_b64_tr_b16 v[58:59], v22 offset:8320
    v_mfma_f32_16x16x32_bf16 v[92:95], v[196:199], a[164:167], v[92:95]
    ds_read_b64_tr_b16 v[60:61], v22 offset:8448
    ds_read_b64_tr_b16 v[62:63], v22 offset:8576
    s_waitcnt vmcnt(42) lgkmcnt(0)
    s_barrier
    v_mfma_f32_16x16x32_bf16 v[64:67], v[224:227], a[40:43], v[64:67]
    v_add_u32 v17, 4294838272, v17
    v_add_u32 v18, 4294838272, v18
    v_mfma_f32_16x16x32_bf16 v[68:71], v[224:227], a[44:47], v[68:71]
    v_add_u32 v19, 4294838272, v19
    v_add_u32 v20, 4294838272, v20
    v_mfma_f32_16x16x32_bf16 v[72:75], v[224:227], a[168:171], v[72:75]
    ds_read_b64_tr_b16 v[192:193], v17 offset:0
    ds_read_b64_tr_b16 v[194:195], v17 offset:4608
    v_mfma_f32_16x16x32_bf16 v[76:79], v[224:227], a[172:175], v[76:79]
    ds_read_b64_tr_b16 v[196:197], v18 offset:0
    ds_read_b64_tr_b16 v[198:199], v18 offset:4608
    v_mfma_f32_16x16x32_bf16 v[80:83], v[228:231], a[40:43], v[80:83]
    v_mfma_f32_16x16x32_bf16 v[84:87], v[228:231], a[44:47], v[84:87]
    v_mfma_f32_16x16x32_bf16 v[88:91], v[228:231], a[168:171], v[88:91]
    v_mfma_f32_16x16x32_bf16 v[92:95], v[228:231], a[172:175], v[92:95]
    s_waitcnt lgkmcnt(0)
    s_waitcnt lgkmcnt(0)
    v_lshlrev_b32 v3, 16, v24
    v_lshlrev_b32 v4, 16, v48
    v_mfma_f32_16x16x32_bf16 v[64:67], v[192:195], a[48:51], v[64:67]
    ds_read_b64_tr_b16 v[224:225], v17 offset:9216
    ds_read_b64_tr_b16 v[226:227], v17 offset:13824
    v_mfma_f32_16x16x32_bf16 v[68:71], v[192:195], a[52:55], v[68:71]
    v_mul_f32 v3, v3, v4
    v_mul_f32 v40, v6, v3
    v_mfma_f32_16x16x32_bf16 v[72:75], v[192:195], a[176:179], v[72:75]
    ds_read_b64_tr_b16 v[228:229], v18 offset:9216
    ds_read_b64_tr_b16 v[230:231], v18 offset:13824
    v_mfma_f32_16x16x32_bf16 v[76:79], v[192:195], a[180:183], v[76:79]
    v_and_b32 v3, s37, v24
    v_and_b32 v4, s37, v48
    v_mfma_f32_16x16x32_bf16 v[80:83], v[196:199], a[48:51], v[80:83]
    v_mul_f32 v3, v3, v4
    v_mul_f32 v41, v6, v3
    v_mfma_f32_16x16x32_bf16 v[84:87], v[196:199], a[52:55], v[84:87]
    v_lshlrev_b32 v3, 16, v25
    v_lshlrev_b32 v4, 16, v49
    v_mfma_f32_16x16x32_bf16 v[88:91], v[196:199], a[176:179], v[88:91]
    v_mul_f32 v3, v3, v4
    v_mul_f32 v42, v6, v3
    v_mfma_f32_16x16x32_bf16 v[92:95], v[196:199], a[180:183], v[92:95]
    v_and_b32 v3, s37, v25
    v_and_b32 v4, s37, v49
    s_waitcnt vmcnt(26) lgkmcnt(0)
    s_barrier
    v_mfma_f32_16x16x32_bf16 v[64:67], v[224:227], a[56:59], v[64:67]
    ds_read_b64_tr_b16 v[192:193], v17 offset:18432
    ds_read_b64_tr_b16 v[194:195], v17 offset:23040
    v_mfma_f32_16x16x32_bf16 v[68:71], v[224:227], a[60:63], v[68:71]
    v_mul_f32 v3, v3, v4
    v_mul_f32 v43, v6, v3
    v_mfma_f32_16x16x32_bf16 v[72:75], v[224:227], a[184:187], v[72:75]
    ds_read_b64_tr_b16 v[196:197], v18 offset:18432
    ds_read_b64_tr_b16 v[198:199], v18 offset:23040
    v_mfma_f32_16x16x32_bf16 v[76:79], v[224:227], a[188:191], v[76:79]
gated_mix__ssm_conv_h3__compressed_kv_cla__prompt_kernel_pad14:
    s_cbranch_execz gated_mix__ssm_conv_h3__compressed_kv_cla__prompt_kernel_pad18
    v_lshlrev_b32 v3, 16, v28
    v_lshlrev_b32 v4, 16, v50
    v_mfma_f32_16x16x32_bf16 v[80:83], v[228:231], a[56:59], v[80:83]
    v_mul_f32 v3, v3, v4
    v_mul_f32 v44, v7, v3
    v_mfma_f32_16x16x32_bf16 v[84:87], v[228:231], a[60:63], v[84:87]
    v_and_b32 v3, s37, v28
    v_and_b32 v4, s37, v50
    v_mfma_f32_16x16x32_bf16 v[88:91], v[228:231], a[184:187], v[88:91]
    v_mul_f32 v3, v3, v4
    v_mul_f32 v45, v7, v3
    v_mfma_f32_16x16x32_bf16 v[92:95], v[228:231], a[188:191], v[92:95]
    s_waitcnt lgkmcnt(0)
    v_lshlrev_b32 v3, 16, v29
    v_lshlrev_b32 v4, 16, v51
    v_mfma_f32_16x16x32_bf16 v[64:67], v[192:195], a[64:67], v[64:67]
    ds_read_b64_tr_b16 v[224:225], v17 offset:27648
    ds_read_b64_tr_b16 v[226:227], v17 offset:32256
    v_mfma_f32_16x16x32_bf16 v[68:71], v[192:195], a[68:71], v[68:71]
    v_mul_f32 v3, v3, v4
    v_mul_f32 v46, v7, v3
    v_mfma_f32_16x16x32_bf16 v[72:75], v[192:195], a[192:195], v[72:75]
    ds_read_b64_tr_b16 v[228:229], v18 offset:27648
    ds_read_b64_tr_b16 v[230:231], v18 offset:32256
    v_mfma_f32_16x16x32_bf16 v[76:79], v[192:195], a[196:199], v[76:79]
    v_and_b32 v3, s37, v29
    v_and_b32 v4, s37, v51
    v_mfma_f32_16x16x32_bf16 v[80:83], v[196:199], a[64:67], v[80:83]
    v_mul_f32 v3, v3, v4
    v_mul_f32 v47, v7, v3
    v_mfma_f32_16x16x32_bf16 v[84:87], v[196:199], a[68:71], v[84:87]
    v_lshlrev_b32 v3, 16, v32
    v_lshlrev_b32 v4, 16, v52
    v_mfma_f32_16x16x32_bf16 v[88:91], v[196:199], a[192:195], v[88:91]
    v_mul_f32 v3, v3, v4
    v_mul_f32 v48, v11, v3
    v_mfma_f32_16x16x32_bf16 v[92:95], v[196:199], a[196:199], v[92:95]
    v_and_b32 v3, s37, v32
    v_and_b32 v4, s37, v52
    s_waitcnt vmcnt(14) lgkmcnt(0)
    s_barrier
    v_mfma_f32_16x16x32_bf16 v[64:67], v[224:227], a[72:75], v[64:67]
    ds_read_b64_tr_b16 v[192:193], v17 offset:36864
    ds_read_b64_tr_b16 v[194:195], v17 offset:41472
    v_mfma_f32_16x16x32_bf16 v[68:71], v[224:227], a[76:79], v[68:71]
    v_mul_f32 v3, v3, v4
    v_mul_f32 v49, v11, v3
    v_mfma_f32_16x16x32_bf16 v[72:75], v[224:227], a[200:203], v[72:75]
    ds_read_b64_tr_b16 v[196:197], v18 offset:36864
    ds_read_b64_tr_b16 v[198:199], v18 offset:41472
    v_mfma_f32_16x16x32_bf16 v[76:79], v[224:227], a[204:207], v[76:79]
    v_lshlrev_b32 v3, 16, v33
    v_lshlrev_b32 v4, 16, v53
    v_mfma_f32_16x16x32_bf16 v[80:83], v[228:231], a[72:75], v[80:83]
    v_mul_f32 v3, v3, v4
    v_mul_f32 v50, v11, v3
    v_mfma_f32_16x16x32_bf16 v[84:87], v[228:231], a[76:79], v[84:87]
    v_and_b32 v3, s37, v33
    v_and_b32 v4, s37, v53
    v_mfma_f32_16x16x32_bf16 v[88:91], v[228:231], a[200:203], v[88:91]
    v_mul_f32 v3, v3, v4
    v_mul_f32 v51, v11, v3
    v_mfma_f32_16x16x32_bf16 v[92:95], v[228:231], a[204:207], v[92:95]
    s_waitcnt lgkmcnt(0)
    v_lshlrev_b32 v3, 16, v36
    v_lshlrev_b32 v4, 16, v54
    v_mfma_f32_16x16x32_bf16 v[64:67], v[192:195], a[80:83], v[64:67]
    ds_read_b64_tr_b16 v[224:225], v17 offset:46080
    ds_read_b64_tr_b16 v[226:227], v17 offset:50688
    v_mfma_f32_16x16x32_bf16 v[68:71], v[192:195], a[84:87], v[68:71]
    v_mul_f32 v3, v3, v4
    v_mul_f32 v52, v12, v3
    v_mfma_f32_16x16x32_bf16 v[72:75], v[192:195], a[208:211], v[72:75]
    ds_read_b64_tr_b16 v[228:229], v18 offset:46080
    ds_read_b64_tr_b16 v[230:231], v18 offset:50688
    v_mfma_f32_16x16x32_bf16 v[76:79], v[192:195], a[212:215], v[76:79]
    v_and_b32 v3, s37, v36
    v_and_b32 v4, s37, v54
    v_mfma_f32_16x16x32_bf16 v[80:83], v[196:199], a[80:83], v[80:83]
    v_mul_f32 v3, v3, v4
    v_mul_f32 v53, v12, v3
    v_mfma_f32_16x16x32_bf16 v[84:87], v[196:199], a[84:87], v[84:87]
    v_lshlrev_b32 v3, 16, v37
    v_lshlrev_b32 v4, 16, v55
    v_mfma_f32_16x16x32_bf16 v[88:91], v[196:199], a[208:211], v[88:91]
    v_mul_f32 v3, v3, v4
    v_mul_f32 v54, v12, v3
    v_mfma_f32_16x16x32_bf16 v[92:95], v[196:199], a[212:215], v[92:95]
    v_and_b32 v3, s37, v37
    v_and_b32 v4, s37, v55
    s_waitcnt vmcnt(6) lgkmcnt(0)
    s_barrier
    v_mfma_f32_16x16x32_bf16 v[64:67], v[224:227], a[88:91], v[64:67]
    ds_read_b64_tr_b16 v[192:193], v17 offset:55296
    ds_read_b64_tr_b16 v[194:195], v17 offset:59904
    v_mfma_f32_16x16x32_bf16 v[68:71], v[224:227], a[92:95], v[68:71]
    v_mul_f32 v3, v3, v4
    v_mul_f32 v55, v12, v3
    v_mfma_f32_16x16x32_bf16 v[72:75], v[224:227], a[216:219], v[72:75]
    ds_read_b64_tr_b16 v[196:197], v18 offset:55296
    ds_read_b64_tr_b16 v[198:199], v18 offset:59904
    v_mfma_f32_16x16x32_bf16 v[76:79], v[224:227], a[220:223], v[76:79]
    v_lshlrev_b32 v3, 16, v26
    v_lshlrev_b32 v4, 16, v56
    v_mfma_f32_16x16x32_bf16 v[80:83], v[228:231], a[88:91], v[80:83]
    v_mul_f32 v3, v3, v4
    v_mul_f32 v24, v6, v3
    v_mfma_f32_16x16x32_bf16 v[84:87], v[228:231], a[92:95], v[84:87]
    v_and_b32 v3, s37, v26
    v_and_b32 v4, s37, v56
    v_mfma_f32_16x16x32_bf16 v[88:91], v[228:231], a[216:219], v[88:91]
    v_mul_f32 v3, v3, v4
    v_mul_f32 v25, v6, v3
    v_mfma_f32_16x16x32_bf16 v[92:95], v[228:231], a[220:223], v[92:95]
    s_waitcnt lgkmcnt(0)
    v_lshlrev_b32 v3, 16, v27
    v_lshlrev_b32 v4, 16, v57
    v_mfma_f32_16x16x32_bf16 v[64:67], v[192:195], a[96:99], v[64:67]
    v_add_u32 v17, 64512, v17
    v_add_u32 v18, 64512, v18
    v_mfma_f32_16x16x32_bf16 v[68:71], v[192:195], a[100:103], v[68:71]
    v_add_u32 v19, 64512, v19
    v_add_u32 v20, 64512, v20
    v_mfma_f32_16x16x32_bf16 v[72:75], v[192:195], a[224:227], v[72:75]
    ds_read_b64_tr_b16 v[224:225], v17 offset:0
    ds_read_b64_tr_b16 v[226:227], v17 offset:4608
    v_mfma_f32_16x16x32_bf16 v[76:79], v[192:195], a[228:231], v[76:79]
    ds_read_b64_tr_b16 v[228:229], v18 offset:0
    ds_read_b64_tr_b16 v[230:231], v18 offset:4608
    v_mfma_f32_16x16x32_bf16 v[80:83], v[196:199], a[96:99], v[80:83]
    v_mul_f32 v3, v3, v4
    v_mul_f32 v28, v6, v3
    v_mfma_f32_16x16x32_bf16 v[84:87], v[196:199], a[100:103], v[84:87]
    v_and_b32 v3, s37, v27
    v_and_b32 v4, s37, v57
    v_mfma_f32_16x16x32_bf16 v[88:91], v[196:199], a[224:227], v[88:91]
    v_mul_f32 v3, v3, v4
    v_mul_f32 v29, v6, v3
    v_mfma_f32_16x16x32_bf16 v[92:95], v[196:199], a[228:231], v[92:95]
    v_lshlrev_b32 v3, 16, v30
    v_lshlrev_b32 v4, 16, v58
    s_waitcnt vmcnt(2) lgkmcnt(0)
    s_barrier
    v_mfma_f32_16x16x32_bf16 v[64:67], v[224:227], a[104:107], v[64:67]
    ds_read_b64_tr_b16 v[192:193], v17 offset:9216
    ds_read_b64_tr_b16 v[194:195], v17 offset:13824
    v_mfma_f32_16x16x32_bf16 v[68:71], v[224:227], a[108:111], v[68:71]
    v_mul_f32 v3, v3, v4
    v_mul_f32 v32, v7, v3
    v_mfma_f32_16x16x32_bf16 v[72:75], v[224:227], a[232:235], v[72:75]
    ds_read_b64_tr_b16 v[196:197], v18 offset:9216
    ds_read_b64_tr_b16 v[198:199], v18 offset:13824
    v_mfma_f32_16x16x32_bf16 v[76:79], v[224:227], a[236:239], v[76:79]
    v_and_b32 v3, s37, v30
    v_and_b32 v4, s37, v58
    v_mfma_f32_16x16x32_bf16 v[80:83], v[228:231], a[104:107], v[80:83]
    v_mul_f32 v3, v3, v4
    v_mul_f32 v33, v7, v3
    v_mfma_f32_16x16x32_bf16 v[84:87], v[228:231], a[108:111], v[84:87]
    v_lshlrev_b32 v3, 16, v31
    v_lshlrev_b32 v4, 16, v59
    v_mfma_f32_16x16x32_bf16 v[88:91], v[228:231], a[232:235], v[88:91]
    v_mul_f32 v3, v3, v4
    v_mul_f32 v36, v7, v3
    v_mfma_f32_16x16x32_bf16 v[92:95], v[228:231], a[236:239], v[92:95]
    s_waitcnt lgkmcnt(0)
    v_and_b32 v3, s37, v31
    v_and_b32 v4, s37, v59
    v_mfma_f32_16x16x32_bf16 v[64:67], v[192:195], a[112:115], v[64:67]
    ds_read_b64_tr_b16 v[224:225], v17 offset:18432
    ds_read_b64_tr_b16 v[226:227], v17 offset:23040
    v_mfma_f32_16x16x32_bf16 v[68:71], v[192:195], a[116:119], v[68:71]
    v_mul_f32 v3, v3, v4
    v_mul_f32 v37, v7, v3
    v_mfma_f32_16x16x32_bf16 v[72:75], v[192:195], a[240:243], v[72:75]
    ds_read_b64_tr_b16 v[228:229], v18 offset:18432
    ds_read_b64_tr_b16 v[230:231], v18 offset:23040
    v_mfma_f32_16x16x32_bf16 v[76:79], v[192:195], a[244:247], v[76:79]
    v_lshlrev_b32 v3, 16, v34
    v_lshlrev_b32 v4, 16, v60
    v_mfma_f32_16x16x32_bf16 v[80:83], v[196:199], a[112:115], v[80:83]
    v_mul_f32 v3, v3, v4
    v_mul_f32 v56, v11, v3
    v_mfma_f32_16x16x32_bf16 v[84:87], v[196:199], a[116:119], v[84:87]
    v_and_b32 v3, s37, v34
    v_and_b32 v4, s37, v60
    v_mfma_f32_16x16x32_bf16 v[88:91], v[196:199], a[240:243], v[88:91]
    v_mul_f32 v3, v3, v4
    v_mul_f32 v57, v11, v3
    v_mfma_f32_16x16x32_bf16 v[92:95], v[196:199], a[244:247], v[92:95]
    v_lshlrev_b32 v3, 16, v35
    v_lshlrev_b32 v4, 16, v61
    s_waitcnt vmcnt(0) lgkmcnt(0)
    s_barrier
    v_mfma_f32_16x16x32_bf16 v[64:67], v[224:227], a[120:123], v[64:67]
    v_mfma_f32_16x16x32_bf16 v[68:71], v[224:227], a[124:127], v[68:71]
    v_mul_f32 v3, v3, v4
    v_mul_f32 v58, v11, v3
    v_mfma_f32_16x16x32_bf16 v[72:75], v[224:227], a[248:251], v[72:75]
    v_mfma_f32_16x16x32_bf16 v[76:79], v[224:227], a[252:255], v[76:79]
    v_and_b32 v3, s37, v35
    v_and_b32 v4, s37, v61
    v_mfma_f32_16x16x32_bf16 v[80:83], v[228:231], a[120:123], v[80:83]
    v_mul_f32 v3, v3, v4
    v_mul_f32 v59, v11, v3
    v_mfma_f32_16x16x32_bf16 v[84:87], v[228:231], a[124:127], v[84:87]
    v_lshlrev_b32 v3, 16, v38
    v_lshlrev_b32 v4, 16, v62
    v_mfma_f32_16x16x32_bf16 v[88:91], v[228:231], a[248:251], v[88:91]
    v_mul_f32 v3, v3, v4
    v_mul_f32 v26, v12, v3
    v_mfma_f32_16x16x32_bf16 v[92:95], v[228:231], a[252:255], v[92:95]
    s_waitcnt lgkmcnt(0)
    v_and_b32 v3, s37, v38
    v_and_b32 v4, s37, v62
    v_mfma_f32_16x16x32_bf16 v[96:99], v[200:203], a[0:3], v[96:99]
    ds_read_b64_tr_b16 v[232:233], v19 offset:36864
    ds_read_b64_tr_b16 v[234:235], v19 offset:41472
    v_mfma_f32_16x16x32_bf16 v[100:103], v[200:203], a[4:7], v[100:103]
    v_mfma_f32_16x16x32_bf16 v[104:107], v[200:203], a[128:131], v[104:107]
    ds_read_b64_tr_b16 v[236:237], v20 offset:36864
    ds_read_b64_tr_b16 v[238:239], v20 offset:41472
    v_mfma_f32_16x16x32_bf16 v[108:111], v[200:203], a[132:135], v[108:111]
    v_mfma_f32_16x16x32_bf16 v[112:115], v[204:207], a[0:3], v[112:115]
    v_mfma_f32_16x16x32_bf16 v[116:119], v[204:207], a[4:7], v[116:119]
    v_cvt_pk_bf16_f32 v64, v64, v65
    v_cvt_pk_bf16_f32 v65, v66, v67
    v_mfma_f32_16x16x32_bf16 v[120:123], v[204:207], a[128:131], v[120:123]
    v_cvt_pk_bf16_f32 v66, v68, v69
    v_cvt_pk_bf16_f32 v67, v70, v71
    v_mfma_f32_16x16x32_bf16 v[124:127], v[204:207], a[132:135], v[124:127]
    s_waitcnt lgkmcnt(0)
    v_mfma_f32_16x16x32_bf16 v[96:99], v[232:235], a[8:11], v[96:99]
    ds_read_b64_tr_b16 v[200:201], v19 offset:46080
    ds_read_b64_tr_b16 v[202:203], v19 offset:50688
    v_mfma_f32_16x16x32_bf16 v[100:103], v[232:235], a[12:15], v[100:103]
    buffer_store_dwordx4 v[64:67], v16, s[16:19], s46 offen offset:0 sc1
    v_mfma_f32_16x16x32_bf16 v[104:107], v[232:235], a[136:139], v[104:107]
    ds_read_b64_tr_b16 v[204:205], v20 offset:46080
    ds_read_b64_tr_b16 v[206:207], v20 offset:50688
    v_mfma_f32_16x16x32_bf16 v[108:111], v[232:235], a[140:143], v[108:111]
    v_cvt_pk_bf16_f32 v68, v72, v73
    v_cvt_pk_bf16_f32 v69, v74, v75
    v_mfma_f32_16x16x32_bf16 v[112:115], v[236:239], a[8:11], v[112:115]
    v_cvt_pk_bf16_f32 v70, v76, v77
    v_cvt_pk_bf16_f32 v71, v78, v79
    v_mfma_f32_16x16x32_bf16 v[116:119], v[236:239], a[12:15], v[116:119]
    buffer_store_dwordx4 v[68:71], v16, s[16:19], s46 offen offset:1024 sc1
    v_mfma_f32_16x16x32_bf16 v[120:123], v[236:239], a[136:139], v[120:123]
    v_cvt_pk_bf16_f32 v72, v80, v81
    v_cvt_pk_bf16_f32 v73, v82, v83
    v_mfma_f32_16x16x32_bf16 v[124:127], v[236:239], a[140:143], v[124:127]
    s_waitcnt lgkmcnt(0)
    v_cvt_pk_bf16_f32 v74, v84, v85
    v_cvt_pk_bf16_f32 v75, v86, v87
    v_mfma_f32_16x16x32_bf16 v[96:99], v[200:203], a[16:19], v[96:99]
    ds_read_b64_tr_b16 v[232:233], v19 offset:55296
    ds_read_b64_tr_b16 v[234:235], v19 offset:59904
    v_mfma_f32_16x16x32_bf16 v[100:103], v[200:203], a[20:23], v[100:103]
    buffer_store_dwordx4 v[72:75], v16, s[16:19], s46 offen offset:2048 sc1
    v_mfma_f32_16x16x32_bf16 v[104:107], v[200:203], a[144:147], v[104:107]
    ds_read_b64_tr_b16 v[236:237], v20 offset:55296
    ds_read_b64_tr_b16 v[238:239], v20 offset:59904
    v_mfma_f32_16x16x32_bf16 v[108:111], v[200:203], a[148:151], v[108:111]
    v_cvt_pk_bf16_f32 v76, v88, v89
    v_cvt_pk_bf16_f32 v77, v90, v91
    v_mfma_f32_16x16x32_bf16 v[112:115], v[204:207], a[16:19], v[112:115]
    v_cvt_pk_bf16_f32 v78, v92, v93
    v_cvt_pk_bf16_f32 v79, v94, v95
    v_mfma_f32_16x16x32_bf16 v[116:119], v[204:207], a[20:23], v[116:119]
    buffer_store_dwordx4 v[76:79], v16, s[16:19], s46 offen offset:3072 sc1
    v_mfma_f32_16x16x32_bf16 v[120:123], v[204:207], a[144:147], v[120:123]
    s_add_u32 s46, s46, 4096
    v_mul_f32 v3, v3, v4
    v_mul_f32 v27, v12, v3
    v_mfma_f32_16x16x32_bf16 v[124:127], v[204:207], a[148:151], v[124:127]
    s_waitcnt lgkmcnt(0)
    v_lshlrev_b32 v3, 16, v39
    v_lshlrev_b32 v4, 16, v63
    v_mfma_f32_16x16x32_bf16 v[96:99], v[232:235], a[24:27], v[96:99]
    v_add_u32 v17, 64512, v17
    v_add_u32 v18, 64512, v18
    v_mfma_f32_16x16x32_bf16 v[100:103], v[232:235], a[28:31], v[100:103]
    v_add_u32 v19, 64512, v19
    v_add_u32 v20, 64512, v20
    v_mfma_f32_16x16x32_bf16 v[104:107], v[232:235], a[152:155], v[104:107]
    ds_read_b64_tr_b16 v[200:201], v19 offset:0
    ds_read_b64_tr_b16 v[202:203], v19 offset:4608
    v_mfma_f32_16x16x32_bf16 v[108:111], v[232:235], a[156:159], v[108:111]
    ds_read_b64_tr_b16 v[204:205], v20 offset:0
    ds_read_b64_tr_b16 v[206:207], v20 offset:4608
    v_mfma_f32_16x16x32_bf16 v[112:115], v[236:239], a[24:27], v[112:115]
    v_mul_f32 v3, v3, v4
    v_mul_f32 v30, v12, v3
    v_mfma_f32_16x16x32_bf16 v[116:119], v[236:239], a[28:31], v[116:119]
    v_and_b32 v3, s37, v39
    v_and_b32 v4, s37, v63
    v_mfma_f32_16x16x32_bf16 v[120:123], v[236:239], a[152:155], v[120:123]
    v_mul_f32 v3, v3, v4
    v_mul_f32 v31, v12, v3
    v_mfma_f32_16x16x32_bf16 v[124:127], v[236:239], a[156:159], v[124:127]
    s_waitcnt lgkmcnt(0)
    v_sub_f32 v6, 1.0, v6
    v_sub_f32 v7, 1.0, v7
    v_mfma_f32_16x16x32_bf16 v[96:99], v[200:203], a[32:35], v[96:99]
    ds_read_b64_tr_b16 v[232:233], v19 offset:9216
    ds_read_b64_tr_b16 v[234:235], v19 offset:13824
    v_mfma_f32_16x16x32_bf16 v[100:103], v[200:203], a[36:39], v[100:103]
    v_sub_f32 v11, 1.0, v11
    v_sub_f32 v12, 1.0, v12
    v_mfma_f32_16x16x32_bf16 v[104:107], v[200:203], a[160:163], v[104:107]
    ds_read_b64_tr_b16 v[236:237], v20 offset:9216
    ds_read_b64_tr_b16 v[238:239], v20 offset:13824
    v_mfma_f32_16x16x32_bf16 v[108:111], v[200:203], a[164:167], v[108:111]
    v_mfma_f32_16x16x32_bf16 v[112:115], v[204:207], a[32:35], v[112:115]
    v_mfma_f32_16x16x32_bf16 v[116:119], v[204:207], a[36:39], v[116:119]
    v_mfma_f32_16x16x32_bf16 v[120:123], v[204:207], a[160:163], v[120:123]
    v_mfma_f32_16x16x32_bf16 v[124:127], v[204:207], a[164:167], v[124:127]
    s_waitcnt lgkmcnt(0)
    v_mfma_f32_16x16x32_bf16 v[96:99], v[232:235], a[40:43], v[96:99]
    v_add_u32 v17, 4294838272, v17
    v_add_u32 v18, 4294838272, v18
    v_mfma_f32_16x16x32_bf16 v[100:103], v[232:235], a[44:47], v[100:103]
    v_add_u32 v19, 4294838272, v19
    v_add_u32 v20, 4294838272, v20
    v_mfma_f32_16x16x32_bf16 v[104:107], v[232:235], a[168:171], v[104:107]
    ds_read_b64_tr_b16 v[200:201], v19 offset:0
    ds_read_b64_tr_b16 v[202:203], v19 offset:4608
    v_mfma_f32_16x16x32_bf16 v[108:111], v[232:235], a[172:175], v[108:111]
    ds_read_b64_tr_b16 v[204:205], v20 offset:0
    ds_read_b64_tr_b16 v[206:207], v20 offset:4608
    v_mfma_f32_16x16x32_bf16 v[112:115], v[236:239], a[40:43], v[112:115]
    v_mfma_f32_16x16x32_bf16 v[116:119], v[236:239], a[44:47], v[116:119]
    v_mfma_f32_16x16x32_bf16 v[120:123], v[236:239], a[168:171], v[120:123]
    v_mfma_f32_16x16x32_bf16 v[124:127], v[236:239], a[172:175], v[124:127]
    s_waitcnt lgkmcnt(0)
    v_mfma_f32_16x16x32_bf16 v[96:99], v[200:203], a[48:51], v[96:99]
    ds_read_b64_tr_b16 v[232:233], v19 offset:9216
    ds_read_b64_tr_b16 v[234:235], v19 offset:13824
    v_mfma_f32_16x16x32_bf16 v[100:103], v[200:203], a[52:55], v[100:103]
    v_mfma_f32_16x16x32_bf16 v[104:107], v[200:203], a[176:179], v[104:107]
    ds_read_b64_tr_b16 v[236:237], v20 offset:9216
    ds_read_b64_tr_b16 v[238:239], v20 offset:13824
    v_mfma_f32_16x16x32_bf16 v[108:111], v[200:203], a[180:183], v[108:111]
    v_mfma_f32_16x16x32_bf16 v[112:115], v[204:207], a[48:51], v[112:115]
    v_mfma_f32_16x16x32_bf16 v[116:119], v[204:207], a[52:55], v[116:119]
    v_mfma_f32_16x16x32_bf16 v[120:123], v[204:207], a[176:179], v[120:123]
    v_mfma_f32_16x16x32_bf16 v[124:127], v[204:207], a[180:183], v[124:127]
    s_waitcnt lgkmcnt(0)
    v_mfma_f32_16x16x32_bf16 v[96:99], v[232:235], a[56:59], v[96:99]
    ds_read_b64_tr_b16 v[200:201], v19 offset:18432
    ds_read_b64_tr_b16 v[202:203], v19 offset:23040
    v_mfma_f32_16x16x32_bf16 v[100:103], v[232:235], a[60:63], v[100:103]
    v_mfma_f32_16x16x32_bf16 v[104:107], v[232:235], a[184:187], v[104:107]
    ds_read_b64_tr_b16 v[204:205], v20 offset:18432
    ds_read_b64_tr_b16 v[206:207], v20 offset:23040
    v_mfma_f32_16x16x32_bf16 v[108:111], v[232:235], a[188:191], v[108:111]
    v_mfma_f32_16x16x32_bf16 v[112:115], v[236:239], a[56:59], v[112:115]
    v_mfma_f32_16x16x32_bf16 v[116:119], v[236:239], a[60:63], v[116:119]
    v_mfma_f32_16x16x32_bf16 v[120:123], v[236:239], a[184:187], v[120:123]
    v_mfma_f32_16x16x32_bf16 v[124:127], v[236:239], a[188:191], v[124:127]
    s_waitcnt lgkmcnt(0)
    v_mfma_f32_16x16x32_bf16 v[96:99], v[200:203], a[64:67], v[96:99]
    ds_read_b64_tr_b16 v[232:233], v19 offset:27648
    ds_read_b64_tr_b16 v[234:235], v19 offset:32256
    v_mfma_f32_16x16x32_bf16 v[100:103], v[200:203], a[68:71], v[100:103]
    v_mfma_f32_16x16x32_bf16 v[104:107], v[200:203], a[192:195], v[104:107]
    ds_read_b64_tr_b16 v[236:237], v20 offset:27648
    ds_read_b64_tr_b16 v[238:239], v20 offset:32256
    v_mfma_f32_16x16x32_bf16 v[108:111], v[200:203], a[196:199], v[108:111]
    v_mfma_f32_16x16x32_bf16 v[112:115], v[204:207], a[64:67], v[112:115]
    v_mfma_f32_16x16x32_bf16 v[116:119], v[204:207], a[68:71], v[116:119]
    v_mfma_f32_16x16x32_bf16 v[120:123], v[204:207], a[192:195], v[120:123]
    v_mfma_f32_16x16x32_bf16 v[124:127], v[204:207], a[196:199], v[124:127]
    s_waitcnt lgkmcnt(0)
    v_mfma_f32_16x16x32_bf16 v[96:99], v[232:235], a[72:75], v[96:99]
    ds_read_b64_tr_b16 v[200:201], v19 offset:36864
    ds_read_b64_tr_b16 v[202:203], v19 offset:41472
    v_mfma_f32_16x16x32_bf16 v[100:103], v[232:235], a[76:79], v[100:103]
    v_mfma_f32_16x16x32_bf16 v[104:107], v[232:235], a[200:203], v[104:107]
    ds_read_b64_tr_b16 v[204:205], v20 offset:36864
    ds_read_b64_tr_b16 v[206:207], v20 offset:41472
    v_mfma_f32_16x16x32_bf16 v[108:111], v[232:235], a[204:207], v[108:111]
    v_mfma_f32_16x16x32_bf16 v[112:115], v[236:239], a[72:75], v[112:115]
    v_mfma_f32_16x16x32_bf16 v[116:119], v[236:239], a[76:79], v[116:119]
    v_mfma_f32_16x16x32_bf16 v[120:123], v[236:239], a[200:203], v[120:123]
    v_mfma_f32_16x16x32_bf16 v[124:127], v[236:239], a[204:207], v[124:127]
    s_waitcnt lgkmcnt(0)
    v_mfma_f32_16x16x32_bf16 v[96:99], v[200:203], a[80:83], v[96:99]
    ds_read_b64_tr_b16 v[232:233], v19 offset:46080
    ds_read_b64_tr_b16 v[234:235], v19 offset:50688
    v_mfma_f32_16x16x32_bf16 v[100:103], v[200:203], a[84:87], v[100:103]
    v_mfma_f32_16x16x32_bf16 v[104:107], v[200:203], a[208:211], v[104:107]
    ds_read_b64_tr_b16 v[236:237], v20 offset:46080
    ds_read_b64_tr_b16 v[238:239], v20 offset:50688
    v_mfma_f32_16x16x32_bf16 v[108:111], v[200:203], a[212:215], v[108:111]
    v_mfma_f32_16x16x32_bf16 v[112:115], v[204:207], a[80:83], v[112:115]
    v_mfma_f32_16x16x32_bf16 v[116:119], v[204:207], a[84:87], v[116:119]
    v_mfma_f32_16x16x32_bf16 v[120:123], v[204:207], a[208:211], v[120:123]
    v_mfma_f32_16x16x32_bf16 v[124:127], v[204:207], a[212:215], v[124:127]
    s_waitcnt lgkmcnt(0)
    v_mfma_f32_16x16x32_bf16 v[96:99], v[232:235], a[88:91], v[96:99]
    ds_read_b64_tr_b16 v[200:201], v19 offset:55296
    ds_read_b64_tr_b16 v[202:203], v19 offset:59904
    v_mfma_f32_16x16x32_bf16 v[100:103], v[232:235], a[92:95], v[100:103]
    v_mfma_f32_16x16x32_bf16 v[104:107], v[232:235], a[216:219], v[104:107]
    ds_read_b64_tr_b16 v[204:205], v20 offset:55296
    ds_read_b64_tr_b16 v[206:207], v20 offset:59904
    v_mfma_f32_16x16x32_bf16 v[108:111], v[232:235], a[220:223], v[108:111]
    v_mfma_f32_16x16x32_bf16 v[112:115], v[236:239], a[88:91], v[112:115]
    v_mfma_f32_16x16x32_bf16 v[116:119], v[236:239], a[92:95], v[116:119]
    v_mfma_f32_16x16x32_bf16 v[120:123], v[236:239], a[216:219], v[120:123]
    v_mfma_f32_16x16x32_bf16 v[124:127], v[236:239], a[220:223], v[124:127]
    s_waitcnt lgkmcnt(0)
    v_mfma_f32_16x16x32_bf16 v[96:99], v[200:203], a[96:99], v[96:99]
    v_add_u32 v17, 64512, v17
    v_add_u32 v18, 64512, v18
    v_mfma_f32_16x16x32_bf16 v[100:103], v[200:203], a[100:103], v[100:103]
    v_add_u32 v19, 64512, v19
    v_add_u32 v20, 64512, v20
    v_mfma_f32_16x16x32_bf16 v[104:107], v[200:203], a[224:227], v[104:107]
    ds_read_b64_tr_b16 v[232:233], v19 offset:0
    ds_read_b64_tr_b16 v[234:235], v19 offset:4608
    v_mfma_f32_16x16x32_bf16 v[108:111], v[200:203], a[228:231], v[108:111]
    ds_read_b64_tr_b16 v[236:237], v20 offset:0
    ds_read_b64_tr_b16 v[238:239], v20 offset:4608
    v_mfma_f32_16x16x32_bf16 v[112:115], v[204:207], a[96:99], v[112:115]
    v_mfma_f32_16x16x32_bf16 v[116:119], v[204:207], a[100:103], v[116:119]
    v_mfma_f32_16x16x32_bf16 v[120:123], v[204:207], a[224:227], v[120:123]
    v_mfma_f32_16x16x32_bf16 v[124:127], v[204:207], a[228:231], v[124:127]
    s_waitcnt lgkmcnt(0)
    v_mfma_f32_16x16x32_bf16 v[96:99], v[232:235], a[104:107], v[96:99]
    ds_read_b64_tr_b16 v[200:201], v19 offset:9216
    ds_read_b64_tr_b16 v[202:203], v19 offset:13824
    v_mfma_f32_16x16x32_bf16 v[100:103], v[232:235], a[108:111], v[100:103]
    v_mfma_f32_16x16x32_bf16 v[104:107], v[232:235], a[232:235], v[104:107]
    ds_read_b64_tr_b16 v[204:205], v20 offset:9216
    ds_read_b64_tr_b16 v[206:207], v20 offset:13824
    v_mfma_f32_16x16x32_bf16 v[108:111], v[232:235], a[236:239], v[108:111]
    v_mfma_f32_16x16x32_bf16 v[112:115], v[236:239], a[104:107], v[112:115]
    v_mfma_f32_16x16x32_bf16 v[116:119], v[236:239], a[108:111], v[116:119]
    v_mfma_f32_16x16x32_bf16 v[120:123], v[236:239], a[232:235], v[120:123]
    v_mfma_f32_16x16x32_bf16 v[124:127], v[236:239], a[236:239], v[124:127]
    s_waitcnt lgkmcnt(0)
    v_mfma_f32_16x16x32_bf16 v[96:99], v[200:203], a[112:115], v[96:99]
    ds_read_b64_tr_b16 v[232:233], v19 offset:18432
    ds_read_b64_tr_b16 v[234:235], v19 offset:23040
    v_mfma_f32_16x16x32_bf16 v[100:103], v[200:203], a[116:119], v[100:103]
    v_mfma_f32_16x16x32_bf16 v[104:107], v[200:203], a[240:243], v[104:107]
    ds_read_b64_tr_b16 v[236:237], v20 offset:18432
    ds_read_b64_tr_b16 v[238:239], v20 offset:23040
    v_mfma_f32_16x16x32_bf16 v[108:111], v[200:203], a[244:247], v[108:111]
    v_mfma_f32_16x16x32_bf16 v[112:115], v[204:207], a[112:115], v[112:115]
    v_mfma_f32_16x16x32_bf16 v[116:119], v[204:207], a[116:119], v[116:119]
    v_mfma_f32_16x16x32_bf16 v[120:123], v[204:207], a[240:243], v[120:123]
    v_mfma_f32_16x16x32_bf16 v[124:127], v[204:207], a[244:247], v[124:127]
    s_waitcnt lgkmcnt(0)
    v_mfma_f32_16x16x32_bf16 v[96:99], v[232:235], a[120:123], v[96:99]
    v_mfma_f32_16x16x32_bf16 v[100:103], v[232:235], a[124:127], v[100:103]
    s_lshl_b32 s52, s44, 2
    s_xor_b32 s52, s52, 196608
    v_mfma_f32_16x16x32_bf16 v[104:107], v[232:235], a[248:251], v[104:107]
    v_mfma_f32_16x16x32_bf16 v[108:111], v[232:235], a[252:255], v[108:111]
    s_add_u32 s52, s52, 0
    buffer_load_dwordx4 v[80:83], v16, s[16:19], s52 offen offset:0 sc1
    v_mfma_f32_16x16x32_bf16 v[112:115], v[236:239], a[120:123], v[112:115]
    buffer_load_dwordx4 v[84:87], v16, s[16:19], s52 offen offset:1024 sc1
    v_mfma_f32_16x16x32_bf16 v[116:119], v[236:239], a[124:127], v[116:119]
    buffer_load_dwordx4 v[88:91], v16, s[16:19], s52 offen offset:2048 sc1
    v_mfma_f32_16x16x32_bf16 v[120:123], v[236:239], a[248:251], v[120:123]
    buffer_load_dwordx4 v[92:95], v16, s[16:19], s52 offen offset:3072 sc1
    v_mfma_f32_16x16x32_bf16 v[124:127], v[236:239], a[252:255], v[124:127]
    s_waitcnt lgkmcnt(0)
    v_mfma_f32_16x16x32_bf16 v[128:131], v[208:211], a[0:3], v[128:131]
    ds_read_b64_tr_b16 v[240:241], v17 offset:36992
    ds_read_b64_tr_b16 v[242:243], v17 offset:41600
    v_mfma_f32_16x16x32_bf16 v[132:135], v[208:211], a[4:7], v[132:135]
    v_mfma_f32_16x16x32_bf16 v[136:139], v[208:211], a[128:131], v[136:139]
    ds_read_b64_tr_b16 v[244:245], v18 offset:36992
    ds_read_b64_tr_b16 v[246:247], v18 offset:41600
    v_mfma_f32_16x16x32_bf16 v[140:143], v[208:211], a[132:135], v[140:143]
    v_mfma_f32_16x16x32_bf16 v[144:147], v[212:215], a[0:3], v[144:147]
    v_mfma_f32_16x16x32_bf16 v[148:151], v[212:215], a[4:7], v[148:151]
    v_cvt_pk_bf16_f32 v96, v96, v97
    v_cvt_pk_bf16_f32 v97, v98, v99
    v_mfma_f32_16x16x32_bf16 v[152:155], v[212:215], a[128:131], v[152:155]
    v_cvt_pk_bf16_f32 v98, v100, v101
    v_cvt_pk_bf16_f32 v99, v102, v103
    v_mfma_f32_16x16x32_bf16 v[156:159], v[212:215], a[132:135], v[156:159]
    s_waitcnt lgkmcnt(0)
    v_mfma_f32_16x16x32_bf16 v[128:131], v[240:243], a[8:11], v[128:131]
    ds_read_b64_tr_b16 v[208:209], v17 offset:46208
    ds_read_b64_tr_b16 v[210:211], v17 offset:50816
    v_mfma_f32_16x16x32_bf16 v[132:135], v[240:243], a[12:15], v[132:135]
    buffer_store_dwordx4 v[96:99], v16, s[16:19], s46 offen offset:0 sc1
    v_mfma_f32_16x16x32_bf16 v[136:139], v[240:243], a[136:139], v[136:139]
    ds_read_b64_tr_b16 v[212:213], v18 offset:46208
    ds_read_b64_tr_b16 v[214:215], v18 offset:50816
    v_mfma_f32_16x16x32_bf16 v[140:143], v[240:243], a[140:143], v[140:143]
    v_cvt_pk_bf16_f32 v100, v104, v105
    v_cvt_pk_bf16_f32 v101, v106, v107
    v_mfma_f32_16x16x32_bf16 v[144:147], v[244:247], a[8:11], v[144:147]
    v_cvt_pk_bf16_f32 v102, v108, v109
    v_cvt_pk_bf16_f32 v103, v110, v111
    v_mfma_f32_16x16x32_bf16 v[148:151], v[244:247], a[12:15], v[148:151]
    buffer_store_dwordx4 v[100:103], v16, s[16:19], s46 offen offset:1024 sc1
    v_mfma_f32_16x16x32_bf16 v[152:155], v[244:247], a[136:139], v[152:155]
    v_cvt_pk_bf16_f32 v104, v112, v113
    v_cvt_pk_bf16_f32 v105, v114, v115
    v_mfma_f32_16x16x32_bf16 v[156:159], v[244:247], a[140:143], v[156:159]
    s_waitcnt lgkmcnt(0)
    v_cvt_pk_bf16_f32 v106, v116, v117
    v_cvt_pk_bf16_f32 v107, v118, v119
    v_mfma_f32_16x16x32_bf16 v[128:131], v[208:211], a[16:19], v[128:131]
    ds_read_b64_tr_b16 v[240:241], v17 offset:55424
    ds_read_b64_tr_b16 v[242:243], v17 offset:60032
    v_mfma_f32_16x16x32_bf16 v[132:135], v[208:211], a[20:23], v[132:135]
    buffer_store_dwordx4 v[104:107], v16, s[16:19], s46 offen offset:2048 sc1
    v_mfma_f32_16x16x32_bf16 v[136:139], v[208:211], a[144:147], v[136:139]
    ds_read_b64_tr_b16 v[244:245], v18 offset:55424
    ds_read_b64_tr_b16 v[246:247], v18 offset:60032
    v_mfma_f32_16x16x32_bf16 v[140:143], v[208:211], a[148:151], v[140:143]
    v_cvt_pk_bf16_f32 v108, v120, v121
    v_cvt_pk_bf16_f32 v109, v122, v123
    v_mfma_f32_16x16x32_bf16 v[144:147], v[212:215], a[16:19], v[144:147]
    v_cvt_pk_bf16_f32 v110, v124, v125
    v_cvt_pk_bf16_f32 v111, v126, v127
    v_mfma_f32_16x16x32_bf16 v[148:151], v[212:215], a[20:23], v[148:151]
    buffer_store_dwordx4 v[108:111], v16, s[16:19], s46 offen offset:3072 sc1
    v_mfma_f32_16x16x32_bf16 v[152:155], v[212:215], a[144:147], v[152:155]
    s_add_u32 s46, s46, 4096
    v_mfma_f32_16x16x32_bf16 v[156:159], v[212:215], a[148:151], v[156:159]
    s_waitcnt lgkmcnt(0)
    v_mfma_f32_16x16x32_bf16 v[128:131], v[240:243], a[24:27], v[128:131]
    v_add_u32 v17, 64512, v17
    v_add_u32 v18, 64512, v18
    v_mfma_f32_16x16x32_bf16 v[132:135], v[240:243], a[28:31], v[132:135]
    v_add_u32 v19, 64512, v19
    v_add_u32 v20, 64512, v20
    v_mfma_f32_16x16x32_bf16 v[136:139], v[240:243], a[152:155], v[136:139]
    ds_read_b64_tr_b16 v[208:209], v17 offset:128
    ds_read_b64_tr_b16 v[210:211], v17 offset:4736
    v_mfma_f32_16x16x32_bf16 v[140:143], v[240:243], a[156:159], v[140:143]
    ds_read_b64_tr_b16 v[212:213], v18 offset:128
    ds_read_b64_tr_b16 v[214:215], v18 offset:4736
    v_mfma_f32_16x16x32_bf16 v[144:147], v[244:247], a[24:27], v[144:147]
    v_mfma_f32_16x16x32_bf16 v[148:151], v[244:247], a[28:31], v[148:151]
    v_mfma_f32_16x16x32_bf16 v[152:155], v[244:247], a[152:155], v[152:155]
    v_mfma_f32_16x16x32_bf16 v[156:159], v[244:247], a[156:159], v[156:159]
    s_waitcnt lgkmcnt(0)
    v_mfma_f32_16x16x32_bf16 v[128:131], v[208:211], a[32:35], v[128:131]
    ds_read_b64_tr_b16 v[240:241], v17 offset:9344
    ds_read_b64_tr_b16 v[242:243], v17 offset:13952
    v_mfma_f32_16x16x32_bf16 v[132:135], v[208:211], a[36:39], v[132:135]
    v_mfma_f32_16x16x32_bf16 v[136:139], v[208:211], a[160:163], v[136:139]
    ds_read_b64_tr_b16 v[244:245], v18 offset:9344
    ds_read_b64_tr_b16 v[246:247], v18 offset:13952
    v_mfma_f32_16x16x32_bf16 v[140:143], v[208:211], a[164:167], v[140:143]
    v_mfma_f32_16x16x32_bf16 v[144:147], v[212:215], a[32:35], v[144:147]
    v_mfma_f32_16x16x32_bf16 v[148:151], v[212:215], a[36:39], v[148:151]
    v_mfma_f32_16x16x32_bf16 v[152:155], v[212:215], a[160:163], v[152:155]
    v_mfma_f32_16x16x32_bf16 v[156:159], v[212:215], a[164:167], v[156:159]
    s_waitcnt lgkmcnt(0)
    v_mfma_f32_16x16x32_bf16 v[128:131], v[240:243], a[40:43], v[128:131]
    v_add_u32 v17, 4294838272, v17
    v_add_u32 v18, 4294838272, v18
    v_mfma_f32_16x16x32_bf16 v[132:135], v[240:243], a[44:47], v[132:135]
    v_add_u32 v19, 4294838272, v19
    v_add_u32 v20, 4294838272, v20
    v_mfma_f32_16x16x32_bf16 v[136:139], v[240:243], a[168:171], v[136:139]
    ds_read_b64_tr_b16 v[208:209], v17 offset:128
    ds_read_b64_tr_b16 v[210:211], v17 offset:4736
    v_mfma_f32_16x16x32_bf16 v[140:143], v[240:243], a[172:175], v[140:143]
    ds_read_b64_tr_b16 v[212:213], v18 offset:128
    ds_read_b64_tr_b16 v[214:215], v18 offset:4736
    v_mfma_f32_16x16x32_bf16 v[144:147], v[244:247], a[40:43], v[144:147]
    s_waitcnt vmcnt(4)
    v_max3_u32 v15, v80, v81, v82
    v_max3_u32 v15, v15, v83, v84
    v_mfma_f32_16x16x32_bf16 v[148:151], v[244:247], a[44:47], v[148:151]
    v_max3_u32 v15, v15, v85, v86
    v_max3_u32 v15, v15, v87, v88
    v_mfma_f32_16x16x32_bf16 v[152:155], v[244:247], a[168:171], v[152:155]
    v_max3_u32 v15, v15, v89, v90
    v_max3_u32 v15, v15, v91, v92
    v_mfma_f32_16x16x32_bf16 v[156:159], v[244:247], a[172:175], v[156:159]
    s_waitcnt lgkmcnt(0)
    v_max3_u32 v15, v15, v93, v94
    v_max_u32 v15, v15, v95
    v_mfma_f32_16x16x32_bf16 v[128:131], v[208:211], a[48:51], v[128:131]
gated_mix__ssm_conv_h3__compressed_kv_cla__prompt_kernel_pad15:
    s_cbranch_execz gated_mix__ssm_conv_h3__compressed_kv_cla__prompt_kernel_pad19
    ds_read_b64_tr_b16 v[240:241], v17 offset:9344
    ds_read_b64_tr_b16 v[242:243], v17 offset:13952
    v_mfma_f32_16x16x32_bf16 v[132:135], v[208:211], a[52:55], v[132:135]
    v_cmp_eq_u32 vcc, -1, v15
    v_mfma_f32_16x16x32_bf16 v[136:139], v[208:211], a[176:179], v[136:139]
    ds_read_b64_tr_b16 v[244:245], v18 offset:9344
    ds_read_b64_tr_b16 v[246:247], v18 offset:13952
    v_mfma_f32_16x16x32_bf16 v[140:143], v[208:211], a[180:183], v[140:143]
    v_mfma_f32_16x16x32_bf16 v[144:147], v[212:215], a[48:51], v[144:147]
    s_cbranch_vccnz gated_mix__ssm_conv_h3__compressed_kv_cla__prompt_kernel_spin_x3
gated_mix__ssm_conv_h3__compressed_kv_cla__prompt_kernel_spin_x3_ret:
    v_lshlrev_b32 v3, 16, v80
    v_fmac_f32 v40, v6, v3
    v_mfma_f32_16x16x32_bf16 v[148:151], v[212:215], a[52:55], v[148:151]
    v_and_b32 v4, s37, v80
    v_fmac_f32 v41, v6, v4
    v_mfma_f32_16x16x32_bf16 v[152:155], v[212:215], a[176:179], v[152:155]
    v_lshlrev_b32 v3, 16, v81
    v_fmac_f32 v42, v6, v3
    v_mfma_f32_16x16x32_bf16 v[156:159], v[212:215], a[180:183], v[156:159]
    s_waitcnt lgkmcnt(0)
    v_and_b32 v4, s37, v81
    v_fmac_f32 v43, v6, v4
    v_mfma_f32_16x16x32_bf16 v[128:131], v[240:243], a[56:59], v[128:131]
    ds_read_b64_tr_b16 v[208:209], v17 offset:18560
    ds_read_b64_tr_b16 v[210:211], v17 offset:23168
    v_mfma_f32_16x16x32_bf16 v[132:135], v[240:243], a[60:63], v[132:135]
    v_lshlrev_b32 v3, 16, v82
    v_fmac_f32 v44, v7, v3
    v_mfma_f32_16x16x32_bf16 v[136:139], v[240:243], a[184:187], v[136:139]
    ds_read_b64_tr_b16 v[212:213], v18 offset:18560
    ds_read_b64_tr_b16 v[214:215], v18 offset:23168
    v_mfma_f32_16x16x32_bf16 v[140:143], v[240:243], a[188:191], v[140:143]
    v_and_b32 v4, s37, v82
    v_fmac_f32 v45, v7, v4
    v_mfma_f32_16x16x32_bf16 v[144:147], v[244:247], a[56:59], v[144:147]
    v_lshlrev_b32 v3, 16, v83
    v_fmac_f32 v46, v7, v3
    v_mfma_f32_16x16x32_bf16 v[148:151], v[244:247], a[60:63], v[148:151]
    v_and_b32 v4, s37, v83
    v_fmac_f32 v47, v7, v4
    v_mfma_f32_16x16x32_bf16 v[152:155], v[244:247], a[184:187], v[152:155]
    v_lshlrev_b32 v3, 16, v84
    v_fmac_f32 v48, v11, v3
    v_mfma_f32_16x16x32_bf16 v[156:159], v[244:247], a[188:191], v[156:159]
    s_waitcnt lgkmcnt(0)
    v_and_b32 v4, s37, v84
    v_fmac_f32 v49, v11, v4
    v_mfma_f32_16x16x32_bf16 v[128:131], v[208:211], a[64:67], v[128:131]
    ds_read_b64_tr_b16 v[240:241], v17 offset:27776
    ds_read_b64_tr_b16 v[242:243], v17 offset:32384
    v_mfma_f32_16x16x32_bf16 v[132:135], v[208:211], a[68:71], v[132:135]
    v_lshlrev_b32 v3, 16, v85
    v_fmac_f32 v50, v11, v3
    v_mfma_f32_16x16x32_bf16 v[136:139], v[208:211], a[192:195], v[136:139]
    ds_read_b64_tr_b16 v[244:245], v18 offset:27776
    ds_read_b64_tr_b16 v[246:247], v18 offset:32384
    v_mfma_f32_16x16x32_bf16 v[140:143], v[208:211], a[196:199], v[140:143]
    v_and_b32 v4, s37, v85
    v_fmac_f32 v51, v11, v4
    v_mfma_f32_16x16x32_bf16 v[144:147], v[212:215], a[64:67], v[144:147]
    v_lshlrev_b32 v3, 16, v86
    v_fmac_f32 v52, v12, v3
    v_mfma_f32_16x16x32_bf16 v[148:151], v[212:215], a[68:71], v[148:151]
    v_and_b32 v4, s37, v86
    v_fmac_f32 v53, v12, v4
    v_mfma_f32_16x16x32_bf16 v[152:155], v[212:215], a[192:195], v[152:155]
    v_lshlrev_b32 v3, 16, v87
    v_fmac_f32 v54, v12, v3
    v_mfma_f32_16x16x32_bf16 v[156:159], v[212:215], a[196:199], v[156:159]
    s_waitcnt lgkmcnt(0)
    v_and_b32 v4, s37, v87
    v_fmac_f32 v55, v12, v4
    v_mfma_f32_16x16x32_bf16 v[128:131], v[240:243], a[72:75], v[128:131]
    ds_read_b64_tr_b16 v[208:209], v17 offset:36992
    ds_read_b64_tr_b16 v[210:211], v17 offset:41600
    v_mfma_f32_16x16x32_bf16 v[132:135], v[240:243], a[76:79], v[132:135]
    v_lshlrev_b32 v3, 16, v88
    v_fmac_f32 v24, v6, v3
    v_mfma_f32_16x16x32_bf16 v[136:139], v[240:243], a[200:203], v[136:139]
    ds_read_b64_tr_b16 v[212:213], v18 offset:36992
    ds_read_b64_tr_b16 v[214:215], v18 offset:41600
    v_mfma_f32_16x16x32_bf16 v[140:143], v[240:243], a[204:207], v[140:143]
    v_and_b32 v4, s37, v88
    v_fmac_f32 v25, v6, v4
    v_mfma_f32_16x16x32_bf16 v[144:147], v[244:247], a[72:75], v[144:147]
    v_lshlrev_b32 v3, 16, v89
    v_fmac_f32 v28, v6, v3
    v_mfma_f32_16x16x32_bf16 v[148:151], v[244:247], a[76:79], v[148:151]
    v_and_b32 v4, s37, v89
    v_fmac_f32 v29, v6, v4
    v_mfma_f32_16x16x32_bf16 v[152:155], v[244:247], a[200:203], v[152:155]
    v_lshlrev_b32 v3, 16, v90
    v_fmac_f32 v32, v7, v3
    v_mfma_f32_16x16x32_bf16 v[156:159], v[244:247], a[204:207], v[156:159]
    s_waitcnt lgkmcnt(0)
    v_and_b32 v4, s37, v90
    v_fmac_f32 v33, v7, v4
    v_mfma_f32_16x16x32_bf16 v[128:131], v[208:211], a[80:83], v[128:131]
    ds_read_b64_tr_b16 v[240:241], v17 offset:46208
    ds_read_b64_tr_b16 v[242:243], v17 offset:50816
    v_mfma_f32_16x16x32_bf16 v[132:135], v[208:211], a[84:87], v[132:135]
    v_lshlrev_b32 v3, 16, v91
    v_fmac_f32 v36, v7, v3
    v_mfma_f32_16x16x32_bf16 v[136:139], v[208:211], a[208:211], v[136:139]
    ds_read_b64_tr_b16 v[244:245], v18 offset:46208
    ds_read_b64_tr_b16 v[246:247], v18 offset:50816
    v_mfma_f32_16x16x32_bf16 v[140:143], v[208:211], a[212:215], v[140:143]
    v_and_b32 v4, s37, v91
    v_fmac_f32 v37, v7, v4
    v_mfma_f32_16x16x32_bf16 v[144:147], v[212:215], a[80:83], v[144:147]
    v_lshlrev_b32 v3, 16, v92
    v_fmac_f32 v56, v11, v3
    v_mfma_f32_16x16x32_bf16 v[148:151], v[212:215], a[84:87], v[148:151]
    v_and_b32 v4, s37, v92
    v_fmac_f32 v57, v11, v4
    v_mfma_f32_16x16x32_bf16 v[152:155], v[212:215], a[208:211], v[152:155]
    v_lshlrev_b32 v3, 16, v93
    v_fmac_f32 v58, v11, v3
    v_mfma_f32_16x16x32_bf16 v[156:159], v[212:215], a[212:215], v[156:159]
    s_waitcnt lgkmcnt(0)
    v_and_b32 v4, s37, v93
    v_fmac_f32 v59, v11, v4
    v_mfma_f32_16x16x32_bf16 v[128:131], v[240:243], a[88:91], v[128:131]
    ds_read_b64_tr_b16 v[208:209], v17 offset:55424
    ds_read_b64_tr_b16 v[210:211], v17 offset:60032
    v_mfma_f32_16x16x32_bf16 v[132:135], v[240:243], a[92:95], v[132:135]
    v_lshlrev_b32 v3, 16, v94
    v_fmac_f32 v26, v12, v3
    v_mfma_f32_16x16x32_bf16 v[136:139], v[240:243], a[216:219], v[136:139]
    ds_read_b64_tr_b16 v[212:213], v18 offset:55424
    ds_read_b64_tr_b16 v[214:215], v18 offset:60032
    v_mfma_f32_16x16x32_bf16 v[140:143], v[240:243], a[220:223], v[140:143]
    v_and_b32 v4, s37, v94
    v_fmac_f32 v27, v12, v4
    v_mfma_f32_16x16x32_bf16 v[144:147], v[244:247], a[88:91], v[144:147]
    v_lshlrev_b32 v3, 16, v95
    v_fmac_f32 v30, v12, v3
    v_mfma_f32_16x16x32_bf16 v[148:151], v[244:247], a[92:95], v[148:151]
    v_and_b32 v4, s37, v95
    v_fmac_f32 v31, v12, v4
    v_mfma_f32_16x16x32_bf16 v[152:155], v[244:247], a[216:219], v[152:155]
    v_mfma_f32_16x16x32_bf16 v[156:159], v[244:247], a[220:223], v[156:159]
    s_waitcnt lgkmcnt(0)
    v_mfma_f32_16x16x32_bf16 v[128:131], v[208:211], a[96:99], v[128:131]
    v_add_u32 v17, 64512, v17
    v_add_u32 v18, 64512, v18
    v_mfma_f32_16x16x32_bf16 v[132:135], v[208:211], a[100:103], v[132:135]
    v_add_u32 v19, 64512, v19
    v_add_u32 v20, 64512, v20
    v_mfma_f32_16x16x32_bf16 v[136:139], v[208:211], a[224:227], v[136:139]
    ds_read_b64_tr_b16 v[240:241], v17 offset:128
    ds_read_b64_tr_b16 v[242:243], v17 offset:4736
    v_mfma_f32_16x16x32_bf16 v[140:143], v[208:211], a[228:231], v[140:143]
    ds_read_b64_tr_b16 v[244:245], v18 offset:128
    ds_read_b64_tr_b16 v[246:247], v18 offset:4736
    v_mfma_f32_16x16x32_bf16 v[144:147], v[212:215], a[96:99], v[144:147]
    v_mfma_f32_16x16x32_bf16 v[148:151], v[212:215], a[100:103], v[148:151]
    v_mfma_f32_16x16x32_bf16 v[152:155], v[212:215], a[224:227], v[152:155]
    v_mfma_f32_16x16x32_bf16 v[156:159], v[212:215], a[228:231], v[156:159]
    s_waitcnt lgkmcnt(0)
    v_mfma_f32_16x16x32_bf16 v[128:131], v[240:243], a[104:107], v[128:131]
    ds_read_b64_tr_b16 v[208:209], v17 offset:9344
    ds_read_b64_tr_b16 v[210:211], v17 offset:13952
    v_mfma_f32_16x16x32_bf16 v[132:135], v[240:243], a[108:111], v[132:135]
    v_mfma_f32_16x16x32_bf16 v[136:139], v[240:243], a[232:235], v[136:139]
    ds_read_b64_tr_b16 v[212:213], v18 offset:9344
    ds_read_b64_tr_b16 v[214:215], v18 offset:13952
    v_mfma_f32_16x16x32_bf16 v[140:143], v[240:243], a[236:239], v[140:143]
    v_mfma_f32_16x16x32_bf16 v[144:147], v[244:247], a[104:107], v[144:147]
    v_mfma_f32_16x16x32_bf16 v[148:151], v[244:247], a[108:111], v[148:151]
    v_mfma_f32_16x16x32_bf16 v[152:155], v[244:247], a[232:235], v[152:155]
    v_mfma_f32_16x16x32_bf16 v[156:159], v[244:247], a[236:239], v[156:159]
    s_waitcnt lgkmcnt(0)
    v_mfma_f32_16x16x32_bf16 v[128:131], v[208:211], a[112:115], v[128:131]
    ds_read_b64_tr_b16 v[240:241], v17 offset:18560
    ds_read_b64_tr_b16 v[242:243], v17 offset:23168
    v_mfma_f32_16x16x32_bf16 v[132:135], v[208:211], a[116:119], v[132:135]
    v_mfma_f32_16x16x32_bf16 v[136:139], v[208:211], a[240:243], v[136:139]
    ds_read_b64_tr_b16 v[244:245], v18 offset:18560
    ds_read_b64_tr_b16 v[246:247], v18 offset:23168
    v_mfma_f32_16x16x32_bf16 v[140:143], v[208:211], a[244:247], v[140:143]
    v_mfma_f32_16x16x32_bf16 v[144:147], v[212:215], a[112:115], v[144:147]
    v_mfma_f32_16x16x32_bf16 v[148:151], v[212:215], a[116:119], v[148:151]
    v_mfma_f32_16x16x32_bf16 v[152:155], v[212:215], a[240:243], v[152:155]
    v_mfma_f32_16x16x32_bf16 v[156:159], v[212:215], a[244:247], v[156:159]
    s_waitcnt lgkmcnt(0)
    v_mfma_f32_16x16x32_bf16 v[128:131], v[240:243], a[120:123], v[128:131]
    v_mfma_f32_16x16x32_bf16 v[132:135], v[240:243], a[124:127], v[132:135]
    s_lshl_b32 s42, s44, 2
    s_xor_b32 s42, s42, 131072
    v_mfma_f32_16x16x32_bf16 v[136:139], v[240:243], a[248:251], v[136:139]
    v_mfma_f32_16x16x32_bf16 v[140:143], v[240:243], a[252:255], v[140:143]
    s_add_u32 s42, s42, 4096
    buffer_load_dwordx4 v[64:67], v16, s[16:19], s42 offen offset:0 sc1
    v_mfma_f32_16x16x32_bf16 v[144:147], v[244:247], a[120:123], v[144:147]
    buffer_load_dwordx4 v[68:71], v16, s[16:19], s42 offen offset:1024 sc1
    v_mfma_f32_16x16x32_bf16 v[148:151], v[244:247], a[124:127], v[148:151]
    buffer_load_dwordx4 v[72:75], v16, s[16:19], s42 offen offset:2048 sc1
    v_mfma_f32_16x16x32_bf16 v[152:155], v[244:247], a[248:251], v[152:155]
    buffer_load_dwordx4 v[76:79], v16, s[16:19], s42 offen offset:3072 sc1
    v_mfma_f32_16x16x32_bf16 v[156:159], v[244:247], a[252:255], v[156:159]
    s_waitcnt lgkmcnt(0)
    v_mfma_f32_16x16x32_bf16 v[160:163], v[216:219], a[0:3], v[160:163]
    ds_read_b64_tr_b16 v[248:249], v19 offset:36992
    ds_read_b64_tr_b16 v[250:251], v19 offset:41600
    v_mfma_f32_16x16x32_bf16 v[164:167], v[216:219], a[4:7], v[164:167]
    v_mfma_f32_16x16x32_bf16 v[168:171], v[216:219], a[128:131], v[168:171]
    ds_read_b64_tr_b16 v[252:253], v20 offset:36992
    ds_read_b64_tr_b16 v[254:255], v20 offset:41600
    v_mfma_f32_16x16x32_bf16 v[172:175], v[216:219], a[132:135], v[172:175]
    v_mfma_f32_16x16x32_bf16 v[176:179], v[220:223], a[0:3], v[176:179]
    v_mfma_f32_16x16x32_bf16 v[180:183], v[220:223], a[4:7], v[180:183]
    v_cvt_pk_bf16_f32 v128, v128, v129
    v_cvt_pk_bf16_f32 v129, v130, v131
    v_mfma_f32_16x16x32_bf16 v[184:187], v[220:223], a[128:131], v[184:187]
    v_cvt_pk_bf16_f32 v130, v132, v133
    v_cvt_pk_bf16_f32 v131, v134, v135
    v_mfma_f32_16x16x32_bf16 v[188:191], v[220:223], a[132:135], v[188:191]
    s_waitcnt lgkmcnt(0)
    v_mfma_f32_16x16x32_bf16 v[160:163], v[248:251], a[8:11], v[160:163]
    ds_read_b64_tr_b16 v[216:217], v19 offset:46208
    ds_read_b64_tr_b16 v[218:219], v19 offset:50816
    v_mfma_f32_16x16x32_bf16 v[164:167], v[248:251], a[12:15], v[164:167]
    buffer_store_dwordx4 v[128:131], v16, s[16:19], s46 offen offset:0 sc1
    v_mfma_f32_16x16x32_bf16 v[168:171], v[248:251], a[136:139], v[168:171]
    ds_read_b64_tr_b16 v[220:221], v20 offset:46208
    ds_read_b64_tr_b16 v[222:223], v20 offset:50816
    v_mfma_f32_16x16x32_bf16 v[172:175], v[248:251], a[140:143], v[172:175]
    v_cvt_pk_bf16_f32 v132, v136, v137
    v_cvt_pk_bf16_f32 v133, v138, v139
    v_mfma_f32_16x16x32_bf16 v[176:179], v[252:255], a[8:11], v[176:179]
    v_cvt_pk_bf16_f32 v134, v140, v141
    v_cvt_pk_bf16_f32 v135, v142, v143
    v_mfma_f32_16x16x32_bf16 v[180:183], v[252:255], a[12:15], v[180:183]
    buffer_store_dwordx4 v[132:135], v16, s[16:19], s46 offen offset:1024 sc1
    v_mfma_f32_16x16x32_bf16 v[184:187], v[252:255], a[136:139], v[184:187]
    v_cvt_pk_bf16_f32 v136, v144, v145
    v_cvt_pk_bf16_f32 v137, v146, v147
    v_mfma_f32_16x16x32_bf16 v[188:191], v[252:255], a[140:143], v[188:191]
    s_waitcnt lgkmcnt(0)
    v_cvt_pk_bf16_f32 v138, v148, v149
    v_cvt_pk_bf16_f32 v139, v150, v151
    v_mfma_f32_16x16x32_bf16 v[160:163], v[216:219], a[16:19], v[160:163]
    ds_read_b64_tr_b16 v[248:249], v19 offset:55424
    ds_read_b64_tr_b16 v[250:251], v19 offset:60032
    v_mfma_f32_16x16x32_bf16 v[164:167], v[216:219], a[20:23], v[164:167]
    buffer_store_dwordx4 v[136:139], v16, s[16:19], s46 offen offset:2048 sc1
    v_mfma_f32_16x16x32_bf16 v[168:171], v[216:219], a[144:147], v[168:171]
    ds_read_b64_tr_b16 v[252:253], v20 offset:55424
    ds_read_b64_tr_b16 v[254:255], v20 offset:60032
    v_mfma_f32_16x16x32_bf16 v[172:175], v[216:219], a[148:151], v[172:175]
    v_cvt_pk_bf16_f32 v140, v152, v153
    v_cvt_pk_bf16_f32 v141, v154, v155
    v_mfma_f32_16x16x32_bf16 v[176:179], v[220:223], a[16:19], v[176:179]
    v_cvt_pk_bf16_f32 v142, v156, v157
    v_cvt_pk_bf16_f32 v143, v158, v159
    v_mfma_f32_16x16x32_bf16 v[180:183], v[220:223], a[20:23], v[180:183]
    buffer_store_dwordx4 v[140:143], v16, s[16:19], s46 offen offset:3072 sc1
    v_mfma_f32_16x16x32_bf16 v[184:187], v[220:223], a[144:147], v[184:187]
    s_add_u32 s46, s46, 4096
    v_mfma_f32_16x16x32_bf16 v[188:191], v[220:223], a[148:151], v[188:191]
    s_waitcnt lgkmcnt(0)
    v_mfma_f32_16x16x32_bf16 v[160:163], v[248:251], a[24:27], v[160:163]
    v_add_u32 v17, 64512, v17
    v_add_u32 v18, 64512, v18
    v_mfma_f32_16x16x32_bf16 v[164:167], v[248:251], a[28:31], v[164:167]
    v_add_u32 v19, 64512, v19
    v_add_u32 v20, 64512, v20
    v_mfma_f32_16x16x32_bf16 v[168:171], v[248:251], a[152:155], v[168:171]
    ds_read_b64_tr_b16 v[216:217], v19 offset:128
    ds_read_b64_tr_b16 v[218:219], v19 offset:4736
    v_mfma_f32_16x16x32_bf16 v[172:175], v[248:251], a[156:159], v[172:175]
    ds_read_b64_tr_b16 v[220:221], v20 offset:128
    ds_read_b64_tr_b16 v[222:223], v20 offset:4736
    v_mfma_f32_16x16x32_bf16 v[176:179], v[252:255], a[24:27], v[176:179]
    v_mfma_f32_16x16x32_bf16 v[180:183], v[252:255], a[28:31], v[180:183]
    v_mfma_f32_16x16x32_bf16 v[184:187], v[252:255], a[152:155], v[184:187]
    v_mfma_f32_16x16x32_bf16 v[188:191], v[252:255], a[156:159], v[188:191]
    s_waitcnt lgkmcnt(0)
    v_mfma_f32_16x16x32_bf16 v[160:163], v[216:219], a[32:35], v[160:163]
    ds_read_b64_tr_b16 v[248:249], v19 offset:9344
    ds_read_b64_tr_b16 v[250:251], v19 offset:13952
    v_mfma_f32_16x16x32_bf16 v[164:167], v[216:219], a[36:39], v[164:167]
    v_mfma_f32_16x16x32_bf16 v[168:171], v[216:219], a[160:163], v[168:171]
    ds_read_b64_tr_b16 v[252:253], v20 offset:9344
    ds_read_b64_tr_b16 v[254:255], v20 offset:13952
    v_mfma_f32_16x16x32_bf16 v[172:175], v[216:219], a[164:167], v[172:175]
    v_mfma_f32_16x16x32_bf16 v[176:179], v[220:223], a[32:35], v[176:179]
    v_mfma_f32_16x16x32_bf16 v[180:183], v[220:223], a[36:39], v[180:183]
    v_mfma_f32_16x16x32_bf16 v[184:187], v[220:223], a[160:163], v[184:187]
    v_mfma_f32_16x16x32_bf16 v[188:191], v[220:223], a[164:167], v[188:191]
    s_waitcnt lgkmcnt(0)
    v_mfma_f32_16x16x32_bf16 v[160:163], v[248:251], a[40:43], v[160:163]
    v_add_u32 v17, 4294838272, v17
    v_add_u32 v18, 4294838272, v18
    v_mfma_f32_16x16x32_bf16 v[164:167], v[248:251], a[44:47], v[164:167]
    v_add_u32 v19, 4294838272, v19
    v_add_u32 v20, 4294838272, v20
    v_mfma_f32_16x16x32_bf16 v[168:171], v[248:251], a[168:171], v[168:171]
    ds_read_b64_tr_b16 v[216:217], v19 offset:128
    ds_read_b64_tr_b16 v[218:219], v19 offset:4736
    v_mfma_f32_16x16x32_bf16 v[172:175], v[248:251], a[172:175], v[172:175]
    ds_read_b64_tr_b16 v[220:221], v20 offset:128
    ds_read_b64_tr_b16 v[222:223], v20 offset:4736
    v_mfma_f32_16x16x32_bf16 v[176:179], v[252:255], a[40:43], v[176:179]
    s_waitcnt vmcnt(4)
    v_max3_u32 v15, v64, v65, v66
    v_max3_u32 v15, v15, v67, v68
    v_mfma_f32_16x16x32_bf16 v[180:183], v[252:255], a[44:47], v[180:183]
    v_max3_u32 v15, v15, v69, v70
    v_max3_u32 v15, v15, v71, v72
    v_mfma_f32_16x16x32_bf16 v[184:187], v[252:255], a[168:171], v[184:187]
    v_max3_u32 v15, v15, v73, v74
    v_max3_u32 v15, v15, v75, v76
    v_mfma_f32_16x16x32_bf16 v[188:191], v[252:255], a[172:175], v[188:191]
    s_waitcnt lgkmcnt(0)
    v_max3_u32 v15, v15, v77, v78
    v_max_u32 v15, v15, v79
    v_mfma_f32_16x16x32_bf16 v[160:163], v[216:219], a[48:51], v[160:163]
    ds_read_b64_tr_b16 v[248:249], v19 offset:9344
    ds_read_b64_tr_b16 v[250:251], v19 offset:13952
    v_mfma_f32_16x16x32_bf16 v[164:167], v[216:219], a[52:55], v[164:167]
    v_cmp_eq_u32 vcc, -1, v15
    v_mfma_f32_16x16x32_bf16 v[168:171], v[216:219], a[176:179], v[168:171]
    ds_read_b64_tr_b16 v[252:253], v20 offset:9344
    ds_read_b64_tr_b16 v[254:255], v20 offset:13952
    v_mfma_f32_16x16x32_bf16 v[172:175], v[216:219], a[180:183], v[172:175]
    v_mfma_f32_16x16x32_bf16 v[176:179], v[220:223], a[48:51], v[176:179]
    s_cbranch_vccnz gated_mix__ssm_conv_h3__compressed_kv_cla__prompt_kernel_spin_x2
gated_mix__ssm_conv_h3__compressed_kv_cla__prompt_kernel_spin_x2_ret:
    v_lshlrev_b32 v3, 16, v64
    v_fmac_f32 v40, v6, v3
    v_mfma_f32_16x16x32_bf16 v[180:183], v[220:223], a[52:55], v[180:183]
    v_and_b32 v4, s37, v64
    v_fmac_f32 v41, v6, v4
    v_mfma_f32_16x16x32_bf16 v[184:187], v[220:223], a[176:179], v[184:187]
    v_lshlrev_b32 v3, 16, v65
    v_fmac_f32 v42, v6, v3
    v_mfma_f32_16x16x32_bf16 v[188:191], v[220:223], a[180:183], v[188:191]
    s_waitcnt lgkmcnt(0)
    v_and_b32 v4, s37, v65
    v_fmac_f32 v43, v6, v4
    v_mfma_f32_16x16x32_bf16 v[160:163], v[248:251], a[56:59], v[160:163]
    ds_read_b64_tr_b16 v[216:217], v19 offset:18560
    ds_read_b64_tr_b16 v[218:219], v19 offset:23168
    v_mfma_f32_16x16x32_bf16 v[164:167], v[248:251], a[60:63], v[164:167]
    v_lshlrev_b32 v3, 16, v66
    v_fmac_f32 v44, v7, v3
    v_mfma_f32_16x16x32_bf16 v[168:171], v[248:251], a[184:187], v[168:171]
    ds_read_b64_tr_b16 v[220:221], v20 offset:18560
    ds_read_b64_tr_b16 v[222:223], v20 offset:23168
    v_mfma_f32_16x16x32_bf16 v[172:175], v[248:251], a[188:191], v[172:175]
    v_and_b32 v4, s37, v66
    v_fmac_f32 v45, v7, v4
    v_mfma_f32_16x16x32_bf16 v[176:179], v[252:255], a[56:59], v[176:179]
    v_lshlrev_b32 v3, 16, v67
    v_fmac_f32 v46, v7, v3
    v_mfma_f32_16x16x32_bf16 v[180:183], v[252:255], a[60:63], v[180:183]
    v_and_b32 v4, s37, v67
    v_fmac_f32 v47, v7, v4
    v_mfma_f32_16x16x32_bf16 v[184:187], v[252:255], a[184:187], v[184:187]
    v_lshlrev_b32 v3, 16, v68
    v_fmac_f32 v48, v11, v3
    v_mfma_f32_16x16x32_bf16 v[188:191], v[252:255], a[188:191], v[188:191]
    s_waitcnt lgkmcnt(0)
    v_and_b32 v4, s37, v68
    v_fmac_f32 v49, v11, v4
    v_mfma_f32_16x16x32_bf16 v[160:163], v[216:219], a[64:67], v[160:163]
    ds_read_b64_tr_b16 v[248:249], v19 offset:27776
    ds_read_b64_tr_b16 v[250:251], v19 offset:32384
    v_mfma_f32_16x16x32_bf16 v[164:167], v[216:219], a[68:71], v[164:167]
    v_lshlrev_b32 v3, 16, v69
    v_fmac_f32 v50, v11, v3
    v_mfma_f32_16x16x32_bf16 v[168:171], v[216:219], a[192:195], v[168:171]
    ds_read_b64_tr_b16 v[252:253], v20 offset:27776
    ds_read_b64_tr_b16 v[254:255], v20 offset:32384
    v_mfma_f32_16x16x32_bf16 v[172:175], v[216:219], a[196:199], v[172:175]
    v_and_b32 v4, s37, v69
    v_fmac_f32 v51, v11, v4
    v_mfma_f32_16x16x32_bf16 v[176:179], v[220:223], a[64:67], v[176:179]
    v_lshlrev_b32 v3, 16, v70
    v_fmac_f32 v52, v12, v3
    v_mfma_f32_16x16x32_bf16 v[180:183], v[220:223], a[68:71], v[180:183]
    v_and_b32 v4, s37, v70
    v_fmac_f32 v53, v12, v4
    v_mfma_f32_16x16x32_bf16 v[184:187], v[220:223], a[192:195], v[184:187]
    v_lshlrev_b32 v3, 16, v71
    v_fmac_f32 v54, v12, v3
    v_mfma_f32_16x16x32_bf16 v[188:191], v[220:223], a[196:199], v[188:191]
    s_waitcnt lgkmcnt(0)
    v_and_b32 v4, s37, v71
    v_fmac_f32 v55, v12, v4
    v_mfma_f32_16x16x32_bf16 v[160:163], v[248:251], a[72:75], v[160:163]
    ds_read_b64_tr_b16 v[216:217], v19 offset:36992
    ds_read_b64_tr_b16 v[218:219], v19 offset:41600
    v_mfma_f32_16x16x32_bf16 v[164:167], v[248:251], a[76:79], v[164:167]
    v_lshlrev_b32 v3, 16, v72
    v_fmac_f32 v24, v6, v3
    v_mfma_f32_16x16x32_bf16 v[168:171], v[248:251], a[200:203], v[168:171]
    ds_read_b64_tr_b16 v[220:221], v20 offset:36992
    ds_read_b64_tr_b16 v[222:223], v20 offset:41600
    v_mfma_f32_16x16x32_bf16 v[172:175], v[248:251], a[204:207], v[172:175]
    v_and_b32 v4, s37, v72
    v_fmac_f32 v25, v6, v4
    v_mfma_f32_16x16x32_bf16 v[176:179], v[252:255], a[72:75], v[176:179]
    v_lshlrev_b32 v3, 16, v73
    v_fmac_f32 v28, v6, v3
    v_mfma_f32_16x16x32_bf16 v[180:183], v[252:255], a[76:79], v[180:183]
    v_and_b32 v4, s37, v73
    v_fmac_f32 v29, v6, v4
    v_mfma_f32_16x16x32_bf16 v[184:187], v[252:255], a[200:203], v[184:187]
    v_lshlrev_b32 v3, 16, v74
    v_fmac_f32 v32, v7, v3
    v_mfma_f32_16x16x32_bf16 v[188:191], v[252:255], a[204:207], v[188:191]
    s_waitcnt lgkmcnt(0)
    v_and_b32 v4, s37, v74
    v_fmac_f32 v33, v7, v4
    v_mfma_f32_16x16x32_bf16 v[160:163], v[216:219], a[80:83], v[160:163]
    ds_read_b64_tr_b16 v[248:249], v19 offset:46208
    ds_read_b64_tr_b16 v[250:251], v19 offset:50816
    v_mfma_f32_16x16x32_bf16 v[164:167], v[216:219], a[84:87], v[164:167]
    s_lshl_b32 s41, s44, 2
    s_xor_b32 s41, s41, 65536
    v_mfma_f32_16x16x32_bf16 v[168:171], v[216:219], a[208:211], v[168:171]
    ds_read_b64_tr_b16 v[252:253], v20 offset:46208
    ds_read_b64_tr_b16 v[254:255], v20 offset:50816
    v_mfma_f32_16x16x32_bf16 v[172:175], v[216:219], a[212:215], v[172:175]
    s_add_u32 s41, s41, 8192
    buffer_load_dwordx4 v[96:99], v16, s[16:19], s41 offen offset:0 sc1
    v_mfma_f32_16x16x32_bf16 v[176:179], v[220:223], a[80:83], v[176:179]
    buffer_load_dwordx4 v[100:103], v16, s[16:19], s41 offen offset:1024 sc1
    v_mfma_f32_16x16x32_bf16 v[180:183], v[220:223], a[84:87], v[180:183]
    buffer_load_dwordx4 v[104:107], v16, s[16:19], s41 offen offset:2048 sc1
    v_mfma_f32_16x16x32_bf16 v[184:187], v[220:223], a[208:211], v[184:187]
    buffer_load_dwordx4 v[108:111], v16, s[16:19], s41 offen offset:3072 sc1
    v_mfma_f32_16x16x32_bf16 v[188:191], v[220:223], a[212:215], v[188:191]
    s_waitcnt lgkmcnt(0)
    v_lshlrev_b32 v3, 16, v75
    v_fmac_f32 v36, v7, v3
    v_mfma_f32_16x16x32_bf16 v[160:163], v[248:251], a[88:91], v[160:163]
    ds_read_b64_tr_b16 v[216:217], v19 offset:55424
    ds_read_b64_tr_b16 v[218:219], v19 offset:60032
    v_mfma_f32_16x16x32_bf16 v[164:167], v[248:251], a[92:95], v[164:167]
    v_and_b32 v4, s37, v75
    v_fmac_f32 v37, v7, v4
    v_mfma_f32_16x16x32_bf16 v[168:171], v[248:251], a[216:219], v[168:171]
    ds_read_b64_tr_b16 v[220:221], v20 offset:55424
    ds_read_b64_tr_b16 v[222:223], v20 offset:60032
    v_mfma_f32_16x16x32_bf16 v[172:175], v[248:251], a[220:223], v[172:175]
    v_lshlrev_b32 v3, 16, v76
    v_fmac_f32 v56, v11, v3
    v_mfma_f32_16x16x32_bf16 v[176:179], v[252:255], a[88:91], v[176:179]
    v_and_b32 v4, s37, v76
    v_fmac_f32 v57, v11, v4
    v_mfma_f32_16x16x32_bf16 v[180:183], v[252:255], a[92:95], v[180:183]
    v_lshlrev_b32 v3, 16, v77
    v_fmac_f32 v58, v11, v3
    v_mfma_f32_16x16x32_bf16 v[184:187], v[252:255], a[216:219], v[184:187]
    v_and_b32 v4, s37, v77
    v_fmac_f32 v59, v11, v4
    v_mfma_f32_16x16x32_bf16 v[188:191], v[252:255], a[220:223], v[188:191]
    s_waitcnt lgkmcnt(0)
    v_lshlrev_b32 v3, 16, v78
    v_fmac_f32 v26, v12, v3
    v_mfma_f32_16x16x32_bf16 v[160:163], v[216:219], a[96:99], v[160:163]
    v_add_u32 v17, 64512, v17
    v_add_u32 v18, 64512, v18
    v_mfma_f32_16x16x32_bf16 v[164:167], v[216:219], a[100:103], v[164:167]
    v_add_u32 v19, 64512, v19
    v_add_u32 v20, 64512, v20
    v_mfma_f32_16x16x32_bf16 v[168:171], v[216:219], a[224:227], v[168:171]
    ds_read_b64_tr_b16 v[248:249], v19 offset:128
    ds_read_b64_tr_b16 v[250:251], v19 offset:4736
    v_mfma_f32_16x16x32_bf16 v[172:175], v[216:219], a[228:231], v[172:175]
    ds_read_b64_tr_b16 v[252:253], v20 offset:128
    ds_read_b64_tr_b16 v[254:255], v20 offset:4736
    v_mfma_f32_16x16x32_bf16 v[176:179], v[220:223], a[96:99], v[176:179]
    v_and_b32 v4, s37, v78
    v_fmac_f32 v27, v12, v4
    v_mfma_f32_16x16x32_bf16 v[180:183], v[220:223], a[100:103], v[180:183]
    v_lshlrev_b32 v3, 16, v79
    v_fmac_f32 v30, v12, v3
    v_mfma_f32_16x16x32_bf16 v[184:187], v[220:223], a[224:227], v[184:187]
    v_and_b32 v4, s37, v79
    v_fmac_f32 v31, v12, v4
    v_mfma_f32_16x16x32_bf16 v[188:191], v[220:223], a[228:231], v[188:191]
    s_waitcnt lgkmcnt(0)
    v_mfma_f32_16x16x32_bf16 v[160:163], v[248:251], a[104:107], v[160:163]
    ds_read_b64_tr_b16 v[216:217], v19 offset:9344
    ds_read_b64_tr_b16 v[218:219], v19 offset:13952
    v_mfma_f32_16x16x32_bf16 v[164:167], v[248:251], a[108:111], v[164:167]
    v_mfma_f32_16x16x32_bf16 v[168:171], v[248:251], a[232:235], v[168:171]
    ds_read_b64_tr_b16 v[220:221], v20 offset:9344
    ds_read_b64_tr_b16 v[222:223], v20 offset:13952
    v_mfma_f32_16x16x32_bf16 v[172:175], v[248:251], a[236:239], v[172:175]
    v_mfma_f32_16x16x32_bf16 v[176:179], v[252:255], a[104:107], v[176:179]
    v_mfma_f32_16x16x32_bf16 v[180:183], v[252:255], a[108:111], v[180:183]
    v_mfma_f32_16x16x32_bf16 v[184:187], v[252:255], a[232:235], v[184:187]
    v_mfma_f32_16x16x32_bf16 v[188:191], v[252:255], a[236:239], v[188:191]
    s_waitcnt lgkmcnt(0)
    v_mfma_f32_16x16x32_bf16 v[160:163], v[216:219], a[112:115], v[160:163]
    ds_read_b64_tr_b16 v[248:249], v19 offset:18560
    ds_read_b64_tr_b16 v[250:251], v19 offset:23168
    v_mfma_f32_16x16x32_bf16 v[164:167], v[216:219], a[116:119], v[164:167]
    v_mfma_f32_16x16x32_bf16 v[168:171], v[216:219], a[240:243], v[168:171]
    ds_read_b64_tr_b16 v[252:253], v20 offset:18560
    ds_read_b64_tr_b16 v[254:255], v20 offset:23168
    v_mfma_f32_16x16x32_bf16 v[172:175], v[216:219], a[244:247], v[172:175]
    v_mfma_f32_16x16x32_bf16 v[176:179], v[220:223], a[112:115], v[176:179]
    v_mfma_f32_16x16x32_bf16 v[180:183], v[220:223], a[116:119], v[180:183]
    v_mfma_f32_16x16x32_bf16 v[184:187], v[220:223], a[240:243], v[184:187]
    v_mfma_f32_16x16x32_bf16 v[188:191], v[220:223], a[244:247], v[188:191]
    s_waitcnt lgkmcnt(0)
    v_mfma_f32_16x16x32_bf16 v[160:163], v[248:251], a[120:123], v[160:163]
    v_mfma_f32_16x16x32_bf16 v[164:167], v[248:251], a[124:127], v[164:167]
    v_mfma_f32_16x16x32_bf16 v[168:171], v[248:251], a[248:251], v[168:171]
    v_mfma_f32_16x16x32_bf16 v[172:175], v[248:251], a[252:255], v[172:175]
    v_mfma_f32_16x16x32_bf16 v[176:179], v[252:255], a[120:123], v[176:179]
    v_mfma_f32_16x16x32_bf16 v[180:183], v[252:255], a[124:127], v[180:183]
    v_mfma_f32_16x16x32_bf16 v[184:187], v[252:255], a[248:251], v[184:187]
    v_mfma_f32_16x16x32_bf16 v[188:191], v[252:255], a[252:255], v[188:191]
    s_waitcnt lgkmcnt(0)
    s_waitcnt vmcnt(0)
    v_max3_u32 v15, v96, v97, v98
    v_max3_u32 v15, v15, v99, v100
    v_max3_u32 v15, v15, v101, v102
    v_max3_u32 v15, v15, v103, v104
    v_max3_u32 v15, v15, v105, v106
    v_max3_u32 v15, v15, v107, v108
    v_max3_u32 v15, v15, v109, v110
    v_max_u32 v15, v15, v111
    v_cmp_eq_u32 vcc, -1, v15
    s_nop 0
    s_nop 0
    s_cbranch_vccnz gated_mix__ssm_conv_h3__compressed_kv_cla__prompt_kernel_spin_x1
gated_mix__ssm_conv_h3__compressed_kv_cla__prompt_kernel_spin_x1_ret:
    v_lshlrev_b32 v3, 16, v96
    v_add_f32 v160, v160, v3
    v_and_b32 v4, s37, v96
    v_add_f32 v161, v161, v4
    v_lshlrev_b32 v5, 16, v97
    v_add_f32 v162, v162, v5
    v_and_b32 v15, s37, v97
    v_add_f32 v163, v163, v15
    v_fma_f32 v160, v160, v6, v40
    v_fma_f32 v161, v161, v6, v41
    v_fma_f32 v162, v162, v6, v42
    v_fma_f32 v163, v163, v6, v43
    v_cvt_pk_bf16_f32 v112, v160, v161
    v_cvt_pk_bf16_f32 v113, v162, v163
    v_lshlrev_b32 v3, 16, v104
    v_add_f32 v176, v176, v3
    v_and_b32 v4, s37, v104
    v_add_f32 v177, v177, v4
    v_lshlrev_b32 v5, 16, v105
    v_add_f32 v178, v178, v5
    v_and_b32 v15, s37, v105
    v_add_f32 v179, v179, v15
    v_fma_f32 v176, v176, v6, v24
    v_fma_f32 v177, v177, v6, v25
    v_fma_f32 v178, v178, v6, v28
    v_fma_f32 v179, v179, v6, v29
    v_cvt_pk_bf16_f32 v114, v176, v177
    v_cvt_pk_bf16_f32 v115, v178, v179
    s_add_u32 s36, s48, 0
    v_permlane16_swap_b32 v112, v114
    v_permlane16_swap_b32 v113, v115
    buffer_store_dwordx4 v[112:115], v21, s[20:23], s36 offen
    v_lshlrev_b32 v3, 16, v98
    v_add_f32 v164, v164, v3
    v_and_b32 v4, s37, v98
    v_add_f32 v165, v165, v4
    v_lshlrev_b32 v5, 16, v99
    v_add_f32 v166, v166, v5
    v_and_b32 v15, s37, v99
    v_add_f32 v167, v167, v15
    v_fma_f32 v164, v164, v7, v44
    v_fma_f32 v165, v165, v7, v45
    v_fma_f32 v166, v166, v7, v46
    v_fma_f32 v167, v167, v7, v47
    v_cvt_pk_bf16_f32 v116, v164, v165
    v_cvt_pk_bf16_f32 v117, v166, v167
    v_lshlrev_b32 v3, 16, v106
    v_add_f32 v180, v180, v3
    v_and_b32 v4, s37, v106
    v_add_f32 v181, v181, v4
    v_lshlrev_b32 v5, 16, v107
    v_add_f32 v182, v182, v5
    v_and_b32 v15, s37, v107
    v_add_f32 v183, v183, v15
    v_fma_f32 v180, v180, v7, v32
    v_fma_f32 v181, v181, v7, v33
    v_fma_f32 v182, v182, v7, v36
    v_fma_f32 v183, v183, v7, v37
    v_cvt_pk_bf16_f32 v118, v180, v181
    v_cvt_pk_bf16_f32 v119, v182, v183
    s_add_u32 s36, s48, 131072
    v_permlane16_swap_b32 v116, v118
    v_permlane16_swap_b32 v117, v119
    buffer_store_dwordx4 v[116:119], v21, s[20:23], s36 offen
    v_lshlrev_b32 v3, 16, v100
    v_add_f32 v168, v168, v3
    v_and_b32 v4, s37, v100
    v_add_f32 v169, v169, v4
    v_lshlrev_b32 v5, 16, v101
    v_add_f32 v170, v170, v5
    v_and_b32 v15, s37, v101
    v_add_f32 v171, v171, v15
    v_fma_f32 v168, v168, v11, v48
    v_fma_f32 v169, v169, v11, v49
    v_fma_f32 v170, v170, v11, v50
    v_fma_f32 v171, v171, v11, v51
    v_cvt_pk_bf16_f32 v112, v168, v169
    v_cvt_pk_bf16_f32 v113, v170, v171
    v_lshlrev_b32 v3, 16, v108
    v_add_f32 v184, v184, v3
    v_and_b32 v4, s37, v108
    v_add_f32 v185, v185, v4
    v_lshlrev_b32 v5, 16, v109
    v_add_f32 v186, v186, v5
    v_and_b32 v15, s37, v109
    v_add_f32 v187, v187, v15
    v_fma_f32 v184, v184, v11, v56
    v_fma_f32 v185, v185, v11, v57
    v_fma_f32 v186, v186, v11, v58
    v_fma_f32 v187, v187, v11, v59
    v_cvt_pk_bf16_f32 v114, v184, v185
    v_cvt_pk_bf16_f32 v115, v186, v187
    s_add_u32 s36, s48, 2097152
    v_permlane16_swap_b32 v112, v114
    v_permlane16_swap_b32 v113, v115
gated_mix__ssm_conv_h3__compressed_kv_cla__prompt_kernel_pad16:
    s_cbranch_execz gated_mix__ssm_conv_h3__compressed_kv_cla__prompt_kernel_pad20
    buffer_store_dwordx4 v[112:115], v21, s[20:23], s36 offen
    v_lshlrev_b32 v3, 16, v102
    v_add_f32 v172, v172, v3
    v_and_b32 v4, s37, v102
    v_add_f32 v173, v173, v4
    v_lshlrev_b32 v5, 16, v103
    v_add_f32 v174, v174, v5
    v_and_b32 v15, s37, v103
    v_add_f32 v175, v175, v15
    v_fma_f32 v172, v172, v12, v52
    v_fma_f32 v173, v173, v12, v53
    v_fma_f32 v174, v174, v12, v54
    v_fma_f32 v175, v175, v12, v55
    v_cvt_pk_bf16_f32 v116, v172, v173
    v_cvt_pk_bf16_f32 v117, v174, v175
    v_lshlrev_b32 v3, 16, v110
    v_add_f32 v188, v188, v3
    v_and_b32 v4, s37, v110
    v_add_f32 v189, v189, v4
    v_lshlrev_b32 v5, 16, v111
    v_add_f32 v190, v190, v5
    v_and_b32 v15, s37, v111
    v_add_f32 v191, v191, v15
    v_fma_f32 v188, v188, v12, v26
    v_fma_f32 v189, v189, v12, v27
    v_fma_f32 v190, v190, v12, v30
    v_fma_f32 v191, v191, v12, v31
    v_cvt_pk_bf16_f32 v118, v188, v189
    v_cvt_pk_bf16_f32 v119, v190, v191
    s_add_u32 s36, s48, 2228224
    v_permlane16_swap_b32 v116, v118
    v_permlane16_swap_b32 v117, v119
    buffer_store_dwordx4 v[116:119], v21, s[20:23], s36 offen
gated_mix__ssm_conv_h3__compressed_kv_cla__prompt_kernel_end:
    s_endpgm
gated_mix__ssm_conv_h3__compressed_kv_cla__prompt_kernel_wb:
    v_bfe_u32 v3, v16, 1, 8
    s_branch gated_mix__ssm_conv_h3__compressed_kv_cla__prompt_kernel_wbs
gated_mix__ssm_conv_h3__compressed_kv_cla__prompt_kernel_wbs_ret:
    v_bfe_u32 v3, v16, 2, 5
    buffer_wbl2 sc1
    s_waitcnt vmcnt(0)
    s_branch gated_mix__ssm_conv_h3__compressed_kv_cla__prompt_kernel_wb_ret
gated_mix__ssm_conv_h3__compressed_kv_cla__prompt_kernel_wbs:
    s_mov_b32 s54, 0
gated_mix__ssm_conv_h3__compressed_kv_cla__prompt_kernel_wbs_again:
    s_sleep 2
    buffer_load_dword v9, v3, s[76:79], 0 offen sc1
    s_waitcnt vmcnt(0)
    v_and_b32 v11, v10, v9
    v_lshrrev_b32 v12, 4, v9
    v_and_b32 v12, v10, v12
    v_sad_u8 v11, v11, 0, 0
    v_sad_u8 v11, v12, 0, v11
    v_cmp_ne_u32 vcc, 8, v11
    s_add_u32 s54, s54, 1
    s_cmp_gt_u32 s54, 0x40000
    s_cbranch_scc1 gated_mix__ssm_conv_h3__compressed_kv_cla__prompt_kernel_wbs_ret
    s_cbranch_vccnz gated_mix__ssm_conv_h3__compressed_kv_cla__prompt_kernel_wbs_again
    s_branch gated_mix__ssm_conv_h3__compressed_kv_cla__prompt_kernel_wbs_ret
gated_mix__ssm_conv_h3__compressed_kv_cla__prompt_kernel_spin_kv:
    s_mov_b32 s54, 0
gated_mix__ssm_conv_h3__compressed_kv_cla__prompt_kernel_spin_kv_again:
    s_sleep 2
    buffer_load_dword v2, v3, s[28:31], s40 offen sc1
    s_waitcnt vmcnt(0)
    v_cmp_ne_u32 vcc, 1, v2
    s_add_u32 s54, s54, 1
    s_cmp_gt_u32 s54, 0x40000
    s_cbranch_scc1 gated_mix__ssm_conv_h3__compressed_kv_cla__prompt_kernel_spin_kv_ret
    s_cbranch_vccnz gated_mix__ssm_conv_h3__compressed_kv_cla__prompt_kernel_spin_kv_again
    s_branch gated_mix__ssm_conv_h3__compressed_kv_cla__prompt_kernel_spin_kv_ret
gated_mix__ssm_conv_h3__compressed_kv_cla__prompt_kernel_b4_sw:
gated_mix__ssm_conv_h3__compressed_kv_cla__prompt_kernel_pad17:
    s_cbranch_execz gated_mix__ssm_conv_h3__compressed_kv_cla__prompt_kernel_pad21
    s_waitcnt vmcnt(8)
    v_and_b32 v17, v28, v29
    v_and_b32 v18, v30, v31
    v_and_b32 v17, v17, v18
    v_cmp_ne_u32 vcc, 1, v17
    s_mov_b32 s58, s35
    s_cbranch_vccnz gated_mix__ssm_conv_h3__compressed_kv_cla__prompt_kernel_b4_sw_spin
gated_mix__ssm_conv_h3__compressed_kv_cla__prompt_kernel_b4_sw_spin_ret:
    s_lshl_b32 s36, s2, 2
    s_cmp_eq_u32 s32, 0
    s_cbranch_scc1 gated_mix__ssm_conv_h3__compressed_kv_cla__prompt_kernel_b4_sw_h
    s_add_u32 s12, s94, 50331648
    s_addc_u32 s13, s95, 0
    s_mov_b32 s14, 4718592
    s_mov_b32 s15, 0x00020000
    s_mul_i32 s38, s36, 4608
    s_movk_i32 s44, 4608
    s_mov_b32 s49, -2
    s_movk_i32 s50, 4640
    s_lshl_b32 s37, s32, 2
    s_sub_u32 s37, 10, s37
    s_add_u32 s38, s38, s37
    s_mul_i32 s59, s32, 9280
    s_add_u32 s59, s59, 4294966496
    s_cmp_eq_u32 s32, 3
    s_cbranch_scc0 gated_mix__ssm_conv_h3__compressed_kv_cla__prompt_kernel_b4_sw_go
    s_mov_b32 s14, 0
    s_mov_b32 s38, 2
    s_mov_b32 s59, 163840
    s_mov_b32 s50, 0
    s_branch gated_mix__ssm_conv_h3__compressed_kv_cla__prompt_kernel_b4_sw_go
gated_mix__ssm_conv_h3__compressed_kv_cla__prompt_kernel_b4_sw_h:
gated_mix__ssm_conv_h3__compressed_kv_cla__prompt_kernel_pad18:
    s_cbranch_execz gated_mix__ssm_conv_h3__compressed_kv_cla__prompt_kernel_pad22
    s_mov_b32 s12, s72
    s_mov_b32 s13, s73
    s_mov_b32 s14, 4194304
    s_mov_b32 s15, 0x00020000
    s_lshl_b32 s38, s36, 12
    s_movk_i32 s44, 4096
    s_mov_b32 s49, 8
    s_movk_i32 s50, 4240
    s_movk_i32 s59, 128
gated_mix__ssm_conv_h3__compressed_kv_cla__prompt_kernel_b4_sw_go:
    s_mov_b32 s40, s59
    s_add_u32 s41, s59, s50
    s_movk_i32 s48, -5728
    s_add_u32 s59, s59, s48
    s_branch gated_mix__ssm_conv_h3__compressed_kv_cla__prompt_kernel_b4_loop
gated_mix__ssm_conv_h3__compressed_kv_cla__prompt_kernel_b4_sw_spin:
    s_mov_b32 s54, 0
gated_mix__ssm_conv_h3__compressed_kv_cla__prompt_kernel_b4_sw_spin_again:
    s_sleep 2
    buffer_load_dwordx4 v[28:31], v16, s[28:31], s47 offen sc1
    s_waitcnt vmcnt(0)
    v_and_b32 v17, v28, v29
    v_and_b32 v18, v30, v31
    v_and_b32 v17, v17, v18
    v_cmp_ne_u32 vcc, 1, v17
    s_add_u32 s54, s54, 1
    s_cmp_gt_u32 s54, 0x40000
    s_cbranch_scc1 gated_mix__ssm_conv_h3__compressed_kv_cla__prompt_kernel_b4_sw_spin_ret
    s_cbranch_vccnz gated_mix__ssm_conv_h3__compressed_kv_cla__prompt_kernel_b4_sw_spin_again
    s_branch gated_mix__ssm_conv_h3__compressed_kv_cla__prompt_kernel_b4_sw_spin_ret
gated_mix__ssm_conv_h3__compressed_kv_cla__prompt_kernel_b2_sw:
gated_mix__ssm_conv_h3__compressed_kv_cla__prompt_kernel_pad19:
    s_cbranch_execz gated_mix__ssm_conv_h3__compressed_kv_cla__prompt_kernel_pad23
    s_waitcnt vmcnt(8)
    v_and_b32 v17, v28, v29
    v_and_b32 v18, v30, v31
    v_and_b32 v17, v17, v18
    v_cmp_ne_u32 vcc, 1, v17
    s_mov_b32 s58, s35
    s_cbranch_vccnz gated_mix__ssm_conv_h3__compressed_kv_cla__prompt_kernel_b2_sw_spin
gated_mix__ssm_conv_h3__compressed_kv_cla__prompt_kernel_b2_sw_spin_ret:
    v_mov_b32 v13, 0
    v_mov_b32 v14, 1
    buffer_store_dword v14, v13, s[28:31], s55 offen sc1
    s_lshl_b32 s36, s2, 2
    s_cmp_eq_u32 s32, 0
    s_cbranch_scc1 gated_mix__ssm_conv_h3__compressed_kv_cla__prompt_kernel_b2_sw_h
    s_add_u32 s12, s94, 50331648
    s_addc_u32 s13, s95, 0
    s_mov_b32 s14, 4718592
    s_mov_b32 s15, 0x00020000
    s_mul_i32 s38, s36, 4608
    s_movk_i32 s44, 4608
    s_mov_b32 s49, -2
    s_movk_i32 s50, 4640
    s_lshl_b32 s37, s32, 2
    s_sub_u32 s37, 10, s37
    s_add_u32 s38, s38, s37
    s_mul_i32 s59, s32, 9280
    s_add_u32 s59, s59, 4294966496
    s_cmp_eq_u32 s32, 3
    s_cbranch_scc0 gated_mix__ssm_conv_h3__compressed_kv_cla__prompt_kernel_b2_sw_go
    s_mov_b32 s14, 0
    s_mov_b32 s38, 2
    s_mov_b32 s59, 163840
    s_mov_b32 s50, 0
    s_branch gated_mix__ssm_conv_h3__compressed_kv_cla__prompt_kernel_b2_sw_go
gated_mix__ssm_conv_h3__compressed_kv_cla__prompt_kernel_b2_sw_h:
gated_mix__ssm_conv_h3__compressed_kv_cla__prompt_kernel_pad20:
    s_cbranch_execz gated_mix__ssm_conv_h3__compressed_kv_cla__prompt_kernel_pad24
    s_mov_b32 s12, s72
    s_mov_b32 s13, s73
    s_mov_b32 s14, 4194304
    s_mov_b32 s15, 0x00020000
    s_lshl_b32 s38, s36, 12
    s_movk_i32 s44, 4096
    s_mov_b32 s49, 8
    s_movk_i32 s50, 4240
    s_movk_i32 s59, 128
gated_mix__ssm_conv_h3__compressed_kv_cla__prompt_kernel_b2_sw_go:
    s_mov_b32 s40, s59
    s_add_u32 s41, s59, s50
    s_movk_i32 s48, -5728
    s_add_u32 s59, s59, s48
    s_branch gated_mix__ssm_conv_h3__compressed_kv_cla__prompt_kernel_b2_loop
gated_mix__ssm_conv_h3__compressed_kv_cla__prompt_kernel_b2_sw_spin:
    s_mov_b32 s54, 0
gated_mix__ssm_conv_h3__compressed_kv_cla__prompt_kernel_b2_sw_spin_again:
    s_sleep 2
    buffer_load_dwordx4 v[28:31], v16, s[28:31], s47 offen sc1
    s_waitcnt vmcnt(0)
    v_and_b32 v17, v28, v29
    v_and_b32 v18, v30, v31
    v_and_b32 v17, v17, v18
    v_cmp_ne_u32 vcc, 1, v17
    s_add_u32 s54, s54, 1
    s_cmp_gt_u32 s54, 0x40000
    s_cbranch_scc1 gated_mix__ssm_conv_h3__compressed_kv_cla__prompt_kernel_b2_sw_spin_ret
    s_cbranch_vccnz gated_mix__ssm_conv_h3__compressed_kv_cla__prompt_kernel_b2_sw_spin_again
    s_branch gated_mix__ssm_conv_h3__compressed_kv_cla__prompt_kernel_b2_sw_spin_ret
gated_mix__ssm_conv_h3__compressed_kv_cla__prompt_kernel_b4_m0:
gated_mix__ssm_conv_h3__compressed_kv_cla__prompt_kernel_pad21:
    s_cbranch_execz gated_mix__ssm_conv_h3__compressed_kv_cla__prompt_kernel_pad25
    s_nop 7
    v_add_f32 v144, v48, v144
    v_add_f32 v145, v49, v145
    v_add_f32 v146, v50, v146
    v_add_f32 v147, v51, v147
    v_add_f32 v148, v52, v148
    v_add_f32 v149, v53, v149
    v_add_f32 v150, v54, v150
    v_add_f32 v151, v55, v151
    s_branch gated_mix__ssm_conv_h3__compressed_kv_cla__prompt_kernel_b4_m0_ret
gated_mix__ssm_conv_h3__compressed_kv_cla__prompt_kernel_b4_m1:
gated_mix__ssm_conv_h3__compressed_kv_cla__prompt_kernel_pad22:
    s_cbranch_execz gated_mix__ssm_conv_h3__compressed_kv_cla__prompt_kernel_body
    s_nop 7
    v_add_f32 v176, v56, v176
    v_add_f32 v177, v57, v177
    v_add_f32 v178, v58, v178
    v_add_f32 v179, v59, v179
    v_add_f32 v180, v60, v180
    v_add_f32 v181, v61, v181
    v_add_f32 v182, v62, v182
    v_add_f32 v183, v63, v183
    s_branch gated_mix__ssm_conv_h3__compressed_kv_cla__prompt_kernel_b4_m1_ret
gated_mix__ssm_conv_h3__compressed_kv_cla__prompt_kernel_b2_m0:
gated_mix__ssm_conv_h3__compressed_kv_cla__prompt_kernel_pad23:
    s_cbranch_execz gated_mix__ssm_conv_h3__compressed_kv_cla__prompt_kernel_body
    s_nop 7
    v_add_f32 v160, v48, v160
    v_add_f32 v161, v49, v161
    v_add_f32 v162, v50, v162
    v_add_f32 v163, v51, v163
    v_add_f32 v164, v52, v164
    v_add_f32 v165, v53, v165
    v_add_f32 v166, v54, v166
    v_add_f32 v167, v55, v167
    s_branch gated_mix__ssm_conv_h3__compressed_kv_cla__prompt_kernel_b2_m0_ret
gated_mix__ssm_conv_h3__compressed_kv_cla__prompt_kernel_b2_m1:
gated_mix__ssm_conv_h3__compressed_kv_cla__prompt_kernel_pad24:
    s_cbranch_execz gated_mix__ssm_conv_h3__compressed_kv_cla__prompt_kernel_body
    s_nop 7
    v_add_f32 v192, v56, v192
    v_add_f32 v193, v57, v193
    v_add_f32 v194, v58, v194
    v_add_f32 v195, v59, v195
    v_add_f32 v196, v60, v196
    v_add_f32 v197, v61, v197
    v_add_f32 v198, v62, v198
    v_add_f32 v199, v63, v199
    s_branch gated_mix__ssm_conv_h3__compressed_kv_cla__prompt_kernel_b2_m1_ret
gated_mix__ssm_conv_h3__compressed_kv_cla__prompt_kernel_b2_m2:
gated_mix__ssm_conv_h3__compressed_kv_cla__prompt_kernel_pad25:
    s_cbranch_execz gated_mix__ssm_conv_h3__compressed_kv_cla__prompt_kernel_body
    s_nop 7
    v_add_f32 v168, v48, v168
    v_add_f32 v169, v49, v169
    v_add_f32 v170, v50, v170
    v_add_f32 v171, v51, v171
    v_add_f32 v172, v52, v172
    v_add_f32 v173, v53, v173
    v_add_f32 v174, v54, v174
    v_add_f32 v175, v55, v175
    s_branch gated_mix__ssm_conv_h3__compressed_kv_cla__prompt_kernel_b2_m2_ret
gated_mix__ssm_conv_h3__compressed_kv_cla__prompt_kernel_spin_s:
    s_mov_b32 s54, 0
gated_mix__ssm_conv_h3__compressed_kv_cla__prompt_kernel_spin_s_again:
    s_sleep 2
    buffer_load_dword v14, v13, s[28:31], s52 offen sc1
    s_waitcnt vmcnt(0)
    v_cmp_ne_u32 vcc, 1, v14
    s_add_u32 s54, s54, 1
    s_cmp_gt_u32 s54, 0x40000
    s_cbranch_scc1 gated_mix__ssm_conv_h3__compressed_kv_cla__prompt_kernel_spin_s_ret
    s_cbranch_vccnz gated_mix__ssm_conv_h3__compressed_kv_cla__prompt_kernel_spin_s_again
    s_branch gated_mix__ssm_conv_h3__compressed_kv_cla__prompt_kernel_spin_s_ret
gated_mix__ssm_conv_h3__compressed_kv_cla__prompt_kernel_spin_l:
    s_mov_b32 s54, 0
gated_mix__ssm_conv_h3__compressed_kv_cla__prompt_kernel_spin_l_again:
    s_sleep 2
    buffer_load_dword v14, v13, s[28:31], s52 offen sc1
    s_waitcnt vmcnt(0)
    v_cmp_ne_u32 vcc, 1, v14
    s_add_u32 s54, s54, 1
    s_cmp_gt_u32 s54, 0x40000
    s_cbranch_scc1 gated_mix__ssm_conv_h3__compressed_kv_cla__prompt_kernel_spin_l_ret
    s_cbranch_vccnz gated_mix__ssm_conv_h3__compressed_kv_cla__prompt_kernel_spin_l_again
    s_branch gated_mix__ssm_conv_h3__compressed_kv_cla__prompt_kernel_spin_l_ret
gated_mix__ssm_conv_h3__compressed_kv_cla__prompt_kernel_spin_y:
    s_mov_b32 s54, 0
gated_mix__ssm_conv_h3__compressed_kv_cla__prompt_kernel_spin_y_again:
    s_sleep 2
    buffer_load_dword v14, v13, s[28:31], 0 offen sc1
    s_waitcnt vmcnt(0)
    v_cmp_ne_u32 vcc, 1, v14
    s_add_u32 s54, s54, 1
    s_cmp_gt_u32 s54, 0x40000
    s_cbranch_scc1 gated_mix__ssm_conv_h3__compressed_kv_cla__prompt_kernel_spin_y_ret
    s_cbranch_vccnz gated_mix__ssm_conv_h3__compressed_kv_cla__prompt_kernel_spin_y_again
    s_branch gated_mix__ssm_conv_h3__compressed_kv_cla__prompt_kernel_spin_y_ret
gated_mix__ssm_conv_h3__compressed_kv_cla__prompt_kernel_spin_x3:
    s_mov_b32 s54, 0
gated_mix__ssm_conv_h3__compressed_kv_cla__prompt_kernel_spin_x3_again:
    s_sleep 2
    buffer_load_dwordx4 v[80:83], v16, s[16:19], s52 offen offset:0 sc1
    buffer_load_dwordx4 v[84:87], v16, s[16:19], s52 offen offset:1024 sc1
    buffer_load_dwordx4 v[88:91], v16, s[16:19], s52 offen offset:2048 sc1
    buffer_load_dwordx4 v[92:95], v16, s[16:19], s52 offen offset:3072 sc1
    s_waitcnt vmcnt(0)
    v_max3_u32 v15, v80, v81, v82
    v_max3_u32 v15, v15, v83, v84
    v_max3_u32 v15, v15, v85, v86
    v_max3_u32 v15, v15, v87, v88
    v_max3_u32 v15, v15, v89, v90
    v_max3_u32 v15, v15, v91, v92
    v_max3_u32 v15, v15, v93, v94
    v_max_u32 v15, v15, v95
    v_cmp_eq_u32 vcc, -1, v15
    s_add_u32 s54, s54, 1
    s_cmp_gt_u32 s54, 0x40000
    s_cbranch_scc1 gated_mix__ssm_conv_h3__compressed_kv_cla__prompt_kernel_spin_x3_ret
    s_cbranch_vccnz gated_mix__ssm_conv_h3__compressed_kv_cla__prompt_kernel_spin_x3_again
    s_branch gated_mix__ssm_conv_h3__compressed_kv_cla__prompt_kernel_spin_x3_ret
gated_mix__ssm_conv_h3__compressed_kv_cla__prompt_kernel_spin_x2:
    s_mov_b32 s54, 0
gated_mix__ssm_conv_h3__compressed_kv_cla__prompt_kernel_spin_x2_again:
    s_sleep 2
    buffer_load_dwordx4 v[64:67], v16, s[16:19], s42 offen offset:0 sc1
    buffer_load_dwordx4 v[68:71], v16, s[16:19], s42 offen offset:1024 sc1
    buffer_load_dwordx4 v[72:75], v16, s[16:19], s42 offen offset:2048 sc1
    buffer_load_dwordx4 v[76:79], v16, s[16:19], s42 offen offset:3072 sc1
    s_waitcnt vmcnt(0)
    v_max3_u32 v15, v64, v65, v66
    v_max3_u32 v15, v15, v67, v68
    v_max3_u32 v15, v15, v69, v70
    v_max3_u32 v15, v15, v71, v72
    v_max3_u32 v15, v15, v73, v74
    v_max3_u32 v15, v15, v75, v76
    v_max3_u32 v15, v15, v77, v78
    v_max_u32 v15, v15, v79
    v_cmp_eq_u32 vcc, -1, v15
    s_add_u32 s54, s54, 1
    s_cmp_gt_u32 s54, 0x40000
    s_cbranch_scc1 gated_mix__ssm_conv_h3__compressed_kv_cla__prompt_kernel_spin_x2_ret
    s_cbranch_vccnz gated_mix__ssm_conv_h3__compressed_kv_cla__prompt_kernel_spin_x2_again
    s_branch gated_mix__ssm_conv_h3__compressed_kv_cla__prompt_kernel_spin_x2_ret
gated_mix__ssm_conv_h3__compressed_kv_cla__prompt_kernel_spin_x1:
    s_mov_b32 s54, 0
gated_mix__ssm_conv_h3__compressed_kv_cla__prompt_kernel_spin_x1_again:
    s_sleep 2
    buffer_load_dwordx4 v[96:99], v16, s[16:19], s41 offen offset:0 sc1
    buffer_load_dwordx4 v[100:103], v16, s[16:19], s41 offen offset:1024 sc1
    buffer_load_dwordx4 v[104:107], v16, s[16:19], s41 offen offset:2048 sc1
    buffer_load_dwordx4 v[108:111], v16, s[16:19], s41 offen offset:3072 sc1
    s_waitcnt vmcnt(0)
    v_max3_u32 v15, v96, v97, v98
    v_max3_u32 v15, v15, v99, v100
    v_max3_u32 v15, v15, v101, v102
    v_max3_u32 v15, v15, v103, v104
    v_max3_u32 v15, v15, v105, v106
    v_max3_u32 v15, v15, v107, v108
    v_max3_u32 v15, v15, v109, v110
    v_max_u32 v15, v15, v111
    v_cmp_eq_u32 vcc, -1, v15
    s_add_u32 s54, s54, 1
    s_cmp_gt_u32 s54, 0x40000
    s_cbranch_scc1 gated_mix__ssm_conv_h3__compressed_kv_cla__prompt_kernel_spin_x1_ret
    s_cbranch_vccnz gated_mix__ssm_conv_h3__compressed_kv_cla__prompt_kernel_spin_x1_again
    s_branch gated_mix__ssm_conv_h3__compressed_kv_cla__prompt_kernel_spin_x1_ret
gated_mix__ssm_conv_h3__compressed_kv_cla__prompt_kernel_hotend:
gated_mix__ssm_conv_h3__compressed_kv_cla__prompt_kernel_b4_r0:
    s_nop 7
    v_max3_f32 v32, v144, v145, v146
    v_max3_f32 v32, v147, v148, v32
    v_max3_f32 v32, v149, v150, v32
    v_max_f32 v32, v151, v32
    v_mov_b32 v33, v32
    s_nop 1
    v_permlane16_swap_b32 v32, v33
    s_nop 1
    v_max_f32 v32, v32, v33
    v_mov_b32 v33, v32
    s_nop 1
    v_permlane32_swap_b32 v32, v33
    s_nop 1
    v_max_f32 v32, v32, v33
    v_add_f32 v32, 0x41c00000, v32
    v_max_f32 v32, 0, v32
    v_exp_f32 v34, -v32
    v_sub_f32 v64, v64, v32
    v_sub_f32 v65, v65, v32
    v_sub_f32 v66, v66, v32
    v_sub_f32 v67, v67, v32
    v_sub_f32 v144, v144, v32
    v_sub_f32 v145, v145, v32
    v_sub_f32 v146, v146, v32
    v_sub_f32 v147, v147, v32
    v_sub_f32 v148, v148, v32
    v_sub_f32 v149, v149, v32
    v_sub_f32 v150, v150, v32
    v_sub_f32 v151, v151, v32
    v_sub_f32 v176, v176, v32
    v_sub_f32 v177, v177, v32
    v_sub_f32 v178, v178, v32
    v_sub_f32 v179, v179, v32
    v_sub_f32 v180, v180, v32
    v_sub_f32 v181, v181, v32
    v_sub_f32 v182, v182, v32
    v_sub_f32 v183, v183, v32
    v_mul_f32 v240, v240, v34
    v_mul_f32 v241, v241, v34
    v_mul_f32 v242, v242, v34
    v_mul_f32 v243, v243, v34
    v_accvgpr_read_b32 v33, a0
    v_mul_f32 v33, v33, v34
    v_accvgpr_write_b32 a0, v33
    v_accvgpr_read_b32 v33, a1
    v_mul_f32 v33, v33, v34
    v_accvgpr_write_b32 a1, v33
    v_accvgpr_read_b32 v33, a2
    v_mul_f32 v33, v33, v34
    v_accvgpr_write_b32 a2, v33
    v_accvgpr_read_b32 v33, a3
    v_mul_f32 v33, v33, v34
    v_accvgpr_write_b32 a3, v33
    v_accvgpr_read_b32 v33, a4
    v_mul_f32 v33, v33, v34
    v_accvgpr_write_b32 a4, v33
    v_accvgpr_read_b32 v33, a5
    v_mul_f32 v33, v33, v34
    v_accvgpr_write_b32 a5, v33
    v_accvgpr_read_b32 v33, a6
    v_mul_f32 v33, v33, v34
    v_accvgpr_write_b32 a6, v33
    v_accvgpr_read_b32 v33, a7
    v_mul_f32 v33, v33, v34
    v_accvgpr_write_b32 a7, v33
    v_accvgpr_read_b32 v33, a8
    v_mul_f32 v33, v33, v34
    v_accvgpr_write_b32 a8, v33
    v_accvgpr_read_b32 v33, a9
    v_mul_f32 v33, v33, v34
    v_accvgpr_write_b32 a9, v33
    v_accvgpr_read_b32 v33, a10
    v_mul_f32 v33, v33, v34
    v_accvgpr_write_b32 a10, v33
    v_accvgpr_read_b32 v33, a11
    v_mul_f32 v33, v33, v34
    v_accvgpr_write_b32 a11, v33
    v_accvgpr_read_b32 v33, a12
    v_mul_f32 v33, v33, v34
    v_accvgpr_write_b32 a12, v33
    v_accvgpr_read_b32 v33, a13
    v_mul_f32 v33, v33, v34
    v_accvgpr_write_b32 a13, v33
    v_accvgpr_read_b32 v33, a14
    v_mul_f32 v33, v33, v34
    v_accvgpr_write_b32 a14, v33
    v_accvgpr_read_b32 v33, a15
    v_mul_f32 v33, v33, v34
    v_accvgpr_write_b32 a15, v33
    v_accvgpr_read_b32 v33, a16
    v_mul_f32 v33, v33, v34
    v_accvgpr_write_b32 a16, v33
    v_accvgpr_read_b32 v33, a17
    v_mul_f32 v33, v33, v34
    v_accvgpr_write_b32 a17, v33
    v_accvgpr_read_b32 v33, a18
    v_mul_f32 v33, v33, v34
    v_accvgpr_write_b32 a18, v33
    v_accvgpr_read_b32 v33, a19
    v_mul_f32 v33, v33, v34
    v_accvgpr_write_b32 a19, v33
    v_accvgpr_read_b32 v33, a20
    v_mul_f32 v33, v33, v34
    v_accvgpr_write_b32 a20, v33
    v_accvgpr_read_b32 v33, a21
    v_mul_f32 v33, v33, v34
    v_accvgpr_write_b32 a21, v33
    v_accvgpr_read_b32 v33, a22
    v_mul_f32 v33, v33, v34
    v_accvgpr_write_b32 a22, v33
    v_accvgpr_read_b32 v33, a23
    v_mul_f32 v33, v33, v34
    v_accvgpr_write_b32 a23, v33
    v_accvgpr_read_b32 v33, a24
    v_mul_f32 v33, v33, v34
    v_accvgpr_write_b32 a24, v33
    v_accvgpr_read_b32 v33, a25
    v_mul_f32 v33, v33, v34
    v_accvgpr_write_b32 a25, v33
    v_accvgpr_read_b32 v33, a26
    v_mul_f32 v33, v33, v34
    v_accvgpr_write_b32 a26, v33
    v_accvgpr_read_b32 v33, a27
    v_mul_f32 v33, v33, v34
    v_accvgpr_write_b32 a27, v33
    v_accvgpr_read_b32 v33, a28
    v_mul_f32 v33, v33, v34
    v_accvgpr_write_b32 a28, v33
    v_accvgpr_read_b32 v33, a29
    v_mul_f32 v33, v33, v34
    v_accvgpr_write_b32 a29, v33
    v_accvgpr_read_b32 v33, a30
    v_mul_f32 v33, v33, v34
    v_accvgpr_write_b32 a30, v33
    v_accvgpr_read_b32 v33, a31
    v_mul_f32 v33, v33, v34
    v_accvgpr_write_b32 a31, v33
    v_exp_f32 v36, v144
    v_exp_f32 v37, v145
    s_nop 0
    v_cvt_pk_bf16_f32 v208, v36, v37
    v_exp_f32 v36, v146
    v_exp_f32 v37, v147
    s_nop 0
    v_cvt_pk_bf16_f32 v209, v36, v37
    v_exp_f32 v36, v148
    v_exp_f32 v37, v149
    s_nop 0
    v_cvt_pk_bf16_f32 v210, v36, v37
    v_exp_f32 v36, v150
    v_exp_f32 v37, v151
    s_nop 0
    v_cvt_pk_bf16_f32 v211, v36, v37
    v_max3_f32 v32, v152, v153, v154
    v_max3_f32 v32, v155, v156, v32
    v_max3_f32 v32, v157, v158, v32
    v_max_f32 v32, v159, v32
    v_mov_b32 v33, v32
    s_nop 1
    v_permlane16_swap_b32 v32, v33
    s_nop 1
    v_max_f32 v32, v32, v33
    v_mov_b32 v33, v32
    s_nop 1
    v_permlane32_swap_b32 v32, v33
    s_nop 1
    v_max_f32 v32, v32, v33
    v_add_f32 v32, 0x41c00000, v32
    v_max_f32 v32, 0, v32
    v_exp_f32 v34, -v32
    v_sub_f32 v68, v68, v32
    v_sub_f32 v69, v69, v32
    v_sub_f32 v70, v70, v32
    v_sub_f32 v71, v71, v32
    v_sub_f32 v152, v152, v32
    v_sub_f32 v153, v153, v32
    v_sub_f32 v154, v154, v32
    v_sub_f32 v155, v155, v32
    v_sub_f32 v156, v156, v32
    v_sub_f32 v157, v157, v32
    v_sub_f32 v158, v158, v32
    v_sub_f32 v159, v159, v32
    v_sub_f32 v184, v184, v32
    v_sub_f32 v185, v185, v32
    v_sub_f32 v186, v186, v32
    v_sub_f32 v187, v187, v32
    v_sub_f32 v188, v188, v32
    v_sub_f32 v189, v189, v32
    v_sub_f32 v190, v190, v32
    v_sub_f32 v191, v191, v32
    v_mul_f32 v244, v244, v34
    v_mul_f32 v245, v245, v34
    v_mul_f32 v246, v246, v34
    v_mul_f32 v247, v247, v34
    v_accvgpr_read_b32 v33, a32
    v_mul_f32 v33, v33, v34
    v_accvgpr_write_b32 a32, v33
    v_accvgpr_read_b32 v33, a33
    v_mul_f32 v33, v33, v34
    v_accvgpr_write_b32 a33, v33
    v_accvgpr_read_b32 v33, a34
    v_mul_f32 v33, v33, v34
    v_accvgpr_write_b32 a34, v33
    v_accvgpr_read_b32 v33, a35
    v_mul_f32 v33, v33, v34
    v_accvgpr_write_b32 a35, v33
    v_accvgpr_read_b32 v33, a36
    v_mul_f32 v33, v33, v34
    v_accvgpr_write_b32 a36, v33
    v_accvgpr_read_b32 v33, a37
    v_mul_f32 v33, v33, v34
    v_accvgpr_write_b32 a37, v33
    v_accvgpr_read_b32 v33, a38
    v_mul_f32 v33, v33, v34
    v_accvgpr_write_b32 a38, v33
    v_accvgpr_read_b32 v33, a39
    v_mul_f32 v33, v33, v34
    v_accvgpr_write_b32 a39, v33
    v_accvgpr_read_b32 v33, a40
    v_mul_f32 v33, v33, v34
    v_accvgpr_write_b32 a40, v33
    v_accvgpr_read_b32 v33, a41
    v_mul_f32 v33, v33, v34
    v_accvgpr_write_b32 a41, v33
    v_accvgpr_read_b32 v33, a42
    v_mul_f32 v33, v33, v34
    v_accvgpr_write_b32 a42, v33
    v_accvgpr_read_b32 v33, a43
    v_mul_f32 v33, v33, v34
    v_accvgpr_write_b32 a43, v33
    v_accvgpr_read_b32 v33, a44
    v_mul_f32 v33, v33, v34
    v_accvgpr_write_b32 a44, v33
    v_accvgpr_read_b32 v33, a45
    v_mul_f32 v33, v33, v34
    v_accvgpr_write_b32 a45, v33
    v_accvgpr_read_b32 v33, a46
    v_mul_f32 v33, v33, v34
    v_accvgpr_write_b32 a46, v33
    v_accvgpr_read_b32 v33, a47
    v_mul_f32 v33, v33, v34
    v_accvgpr_write_b32 a47, v33
    v_accvgpr_read_b32 v33, a48
    v_mul_f32 v33, v33, v34
    v_accvgpr_write_b32 a48, v33
    v_accvgpr_read_b32 v33, a49
    v_mul_f32 v33, v33, v34
    v_accvgpr_write_b32 a49, v33
    v_accvgpr_read_b32 v33, a50
    v_mul_f32 v33, v33, v34
    v_accvgpr_write_b32 a50, v33
    v_accvgpr_read_b32 v33, a51
    v_mul_f32 v33, v33, v34
    v_accvgpr_write_b32 a51, v33
    v_accvgpr_read_b32 v33, a52
    v_mul_f32 v33, v33, v34
    v_accvgpr_write_b32 a52, v33
    v_accvgpr_read_b32 v33, a53
    v_mul_f32 v33, v33, v34
    v_accvgpr_write_b32 a53, v33
    v_accvgpr_read_b32 v33, a54
    v_mul_f32 v33, v33, v34
    v_accvgpr_write_b32 a54, v33
    v_accvgpr_read_b32 v33, a55
    v_mul_f32 v33, v33, v34
    v_accvgpr_write_b32 a55, v33
    v_accvgpr_read_b32 v33, a56
    v_mul_f32 v33, v33, v34
    v_accvgpr_write_b32 a56, v33
    v_accvgpr_read_b32 v33, a57
    v_mul_f32 v33, v33, v34
    v_accvgpr_write_b32 a57, v33
    v_accvgpr_read_b32 v33, a58
    v_mul_f32 v33, v33, v34
    v_accvgpr_write_b32 a58, v33
    v_accvgpr_read_b32 v33, a59
    v_mul_f32 v33, v33, v34
    v_accvgpr_write_b32 a59, v33
    v_accvgpr_read_b32 v33, a60
    v_mul_f32 v33, v33, v34
    v_accvgpr_write_b32 a60, v33
    v_accvgpr_read_b32 v33, a61
    v_mul_f32 v33, v33, v34
    v_accvgpr_write_b32 a61, v33
    v_accvgpr_read_b32 v33, a62
    v_mul_f32 v33, v33, v34
    v_accvgpr_write_b32 a62, v33
    v_accvgpr_read_b32 v33, a63
    v_mul_f32 v33, v33, v34
    v_accvgpr_write_b32 a63, v33
    v_exp_f32 v36, v152
    v_exp_f32 v37, v153
    s_nop 0
    v_cvt_pk_bf16_f32 v212, v36, v37
    v_exp_f32 v36, v154
    v_exp_f32 v37, v155
    s_nop 0
    v_cvt_pk_bf16_f32 v213, v36, v37
    v_exp_f32 v36, v156
    v_exp_f32 v37, v157
    s_nop 0
    v_cvt_pk_bf16_f32 v214, v36, v37
    v_exp_f32 v36, v158
    v_exp_f32 v37, v159
    s_nop 0
    v_cvt_pk_bf16_f32 v215, v36, v37
    v_max3_f32 v32, v160, v161, v162
    v_max3_f32 v32, v163, v164, v32
    v_max3_f32 v32, v165, v166, v32
    v_max_f32 v32, v167, v32
    v_mov_b32 v33, v32
    s_nop 1
    v_permlane16_swap_b32 v32, v33
    s_nop 1
    v_max_f32 v32, v32, v33
    v_mov_b32 v33, v32
    s_nop 1
    v_permlane32_swap_b32 v32, v33
    s_nop 1
    v_max_f32 v32, v32, v33
    v_add_f32 v32, 0x41c00000, v32
    v_max_f32 v32, 0, v32
    v_exp_f32 v34, -v32
    v_sub_f32 v72, v72, v32
    v_sub_f32 v73, v73, v32
    v_sub_f32 v74, v74, v32
    v_sub_f32 v75, v75, v32
    v_sub_f32 v160, v160, v32
    v_sub_f32 v161, v161, v32
    v_sub_f32 v162, v162, v32
    v_sub_f32 v163, v163, v32
    v_sub_f32 v164, v164, v32
    v_sub_f32 v165, v165, v32
    v_sub_f32 v166, v166, v32
    v_sub_f32 v167, v167, v32
    v_sub_f32 v192, v192, v32
    v_sub_f32 v193, v193, v32
    v_sub_f32 v194, v194, v32
    v_sub_f32 v195, v195, v32
    v_sub_f32 v196, v196, v32
    v_sub_f32 v197, v197, v32
    v_sub_f32 v198, v198, v32
    v_sub_f32 v199, v199, v32
    v_mul_f32 v248, v248, v34
    v_mul_f32 v249, v249, v34
    v_mul_f32 v250, v250, v34
    v_mul_f32 v251, v251, v34
    v_accvgpr_read_b32 v33, a64
    v_mul_f32 v33, v33, v34
    v_accvgpr_write_b32 a64, v33
    v_accvgpr_read_b32 v33, a65
    v_mul_f32 v33, v33, v34
    v_accvgpr_write_b32 a65, v33
    v_accvgpr_read_b32 v33, a66
    v_mul_f32 v33, v33, v34
    v_accvgpr_write_b32 a66, v33
    v_accvgpr_read_b32 v33, a67
    v_mul_f32 v33, v33, v34
    v_accvgpr_write_b32 a67, v33
    v_accvgpr_read_b32 v33, a68
    v_mul_f32 v33, v33, v34
    v_accvgpr_write_b32 a68, v33
    v_accvgpr_read_b32 v33, a69
    v_mul_f32 v33, v33, v34
    v_accvgpr_write_b32 a69, v33
    v_accvgpr_read_b32 v33, a70
    v_mul_f32 v33, v33, v34
    v_accvgpr_write_b32 a70, v33
    v_accvgpr_read_b32 v33, a71
    v_mul_f32 v33, v33, v34
    v_accvgpr_write_b32 a71, v33
    v_accvgpr_read_b32 v33, a72
    v_mul_f32 v33, v33, v34
    v_accvgpr_write_b32 a72, v33
    v_accvgpr_read_b32 v33, a73
    v_mul_f32 v33, v33, v34
    v_accvgpr_write_b32 a73, v33
    v_accvgpr_read_b32 v33, a74
    v_mul_f32 v33, v33, v34
    v_accvgpr_write_b32 a74, v33
    v_accvgpr_read_b32 v33, a75
    v_mul_f32 v33, v33, v34
    v_accvgpr_write_b32 a75, v33
    v_accvgpr_read_b32 v33, a76
    v_mul_f32 v33, v33, v34
    v_accvgpr_write_b32 a76, v33
    v_accvgpr_read_b32 v33, a77
    v_mul_f32 v33, v33, v34
    v_accvgpr_write_b32 a77, v33
    v_accvgpr_read_b32 v33, a78
    v_mul_f32 v33, v33, v34
    v_accvgpr_write_b32 a78, v33
    v_accvgpr_read_b32 v33, a79
    v_mul_f32 v33, v33, v34
    v_accvgpr_write_b32 a79, v33
    v_accvgpr_read_b32 v33, a80
    v_mul_f32 v33, v33, v34
    v_accvgpr_write_b32 a80, v33
    v_accvgpr_read_b32 v33, a81
    v_mul_f32 v33, v33, v34
    v_accvgpr_write_b32 a81, v33
    v_accvgpr_read_b32 v33, a82
    v_mul_f32 v33, v33, v34
    v_accvgpr_write_b32 a82, v33
    v_accvgpr_read_b32 v33, a83
    v_mul_f32 v33, v33, v34
    v_accvgpr_write_b32 a83, v33
    v_accvgpr_read_b32 v33, a84
    v_mul_f32 v33, v33, v34
    v_accvgpr_write_b32 a84, v33
    v_accvgpr_read_b32 v33, a85
    v_mul_f32 v33, v33, v34
    v_accvgpr_write_b32 a85, v33
    v_accvgpr_read_b32 v33, a86
    v_mul_f32 v33, v33, v34
    v_accvgpr_write_b32 a86, v33
    v_accvgpr_read_b32 v33, a87
    v_mul_f32 v33, v33, v34
    v_accvgpr_write_b32 a87, v33
    v_accvgpr_read_b32 v33, a88
    v_mul_f32 v33, v33, v34
    v_accvgpr_write_b32 a88, v33
    v_accvgpr_read_b32 v33, a89
    v_mul_f32 v33, v33, v34
    v_accvgpr_write_b32 a89, v33
    v_accvgpr_read_b32 v33, a90
    v_mul_f32 v33, v33, v34
    v_accvgpr_write_b32 a90, v33
    v_accvgpr_read_b32 v33, a91
    v_mul_f32 v33, v33, v34
    v_accvgpr_write_b32 a91, v33
    v_accvgpr_read_b32 v33, a92
    v_mul_f32 v33, v33, v34
    v_accvgpr_write_b32 a92, v33
    v_accvgpr_read_b32 v33, a93
    v_mul_f32 v33, v33, v34
    v_accvgpr_write_b32 a93, v33
    v_accvgpr_read_b32 v33, a94
    v_mul_f32 v33, v33, v34
    v_accvgpr_write_b32 a94, v33
    v_accvgpr_read_b32 v33, a95
    v_mul_f32 v33, v33, v34
    v_accvgpr_write_b32 a95, v33
    v_exp_f32 v36, v160
    v_exp_f32 v37, v161
    s_nop 0
    v_cvt_pk_bf16_f32 v216, v36, v37
    v_exp_f32 v36, v162
    v_exp_f32 v37, v163
    s_nop 0
    v_cvt_pk_bf16_f32 v217, v36, v37
    v_exp_f32 v36, v164
    v_exp_f32 v37, v165
    s_nop 0
    v_cvt_pk_bf16_f32 v218, v36, v37
    v_exp_f32 v36, v166
    v_exp_f32 v37, v167
    s_nop 0
    v_cvt_pk_bf16_f32 v219, v36, v37
    v_max3_f32 v32, v168, v169, v170
    v_max3_f32 v32, v171, v172, v32
    v_max3_f32 v32, v173, v174, v32
    v_max_f32 v32, v175, v32
    v_mov_b32 v33, v32
    s_nop 1
    v_permlane16_swap_b32 v32, v33
    s_nop 1
    v_max_f32 v32, v32, v33
    v_mov_b32 v33, v32
    s_nop 1
    v_permlane32_swap_b32 v32, v33
    s_nop 1
    v_max_f32 v32, v32, v33
    v_add_f32 v32, 0x41c00000, v32
    v_max_f32 v32, 0, v32
    v_exp_f32 v34, -v32
    v_sub_f32 v76, v76, v32
    v_sub_f32 v77, v77, v32
    v_sub_f32 v78, v78, v32
    v_sub_f32 v79, v79, v32
    v_sub_f32 v168, v168, v32
    v_sub_f32 v169, v169, v32
    v_sub_f32 v170, v170, v32
    v_sub_f32 v171, v171, v32
    v_sub_f32 v172, v172, v32
    v_sub_f32 v173, v173, v32
    v_sub_f32 v174, v174, v32
    v_sub_f32 v175, v175, v32
    v_sub_f32 v200, v200, v32
    v_sub_f32 v201, v201, v32
    v_sub_f32 v202, v202, v32
    v_sub_f32 v203, v203, v32
    v_sub_f32 v204, v204, v32
    v_sub_f32 v205, v205, v32
    v_sub_f32 v206, v206, v32
    v_sub_f32 v207, v207, v32
    v_mul_f32 v252, v252, v34
    v_mul_f32 v253, v253, v34
    v_mul_f32 v254, v254, v34
    v_mul_f32 v255, v255, v34
    v_accvgpr_read_b32 v33, a96
    v_mul_f32 v33, v33, v34
    v_accvgpr_write_b32 a96, v33
    v_accvgpr_read_b32 v33, a97
    v_mul_f32 v33, v33, v34
    v_accvgpr_write_b32 a97, v33
    v_accvgpr_read_b32 v33, a98
    v_mul_f32 v33, v33, v34
    v_accvgpr_write_b32 a98, v33
    v_accvgpr_read_b32 v33, a99
    v_mul_f32 v33, v33, v34
    v_accvgpr_write_b32 a99, v33
    v_accvgpr_read_b32 v33, a100
    v_mul_f32 v33, v33, v34
    v_accvgpr_write_b32 a100, v33
    v_accvgpr_read_b32 v33, a101
    v_mul_f32 v33, v33, v34
    v_accvgpr_write_b32 a101, v33
    v_accvgpr_read_b32 v33, a102
    v_mul_f32 v33, v33, v34
    v_accvgpr_write_b32 a102, v33
    v_accvgpr_read_b32 v33, a103
    v_mul_f32 v33, v33, v34
    v_accvgpr_write_b32 a103, v33
    v_accvgpr_read_b32 v33, a104
    v_mul_f32 v33, v33, v34
    v_accvgpr_write_b32 a104, v33
    v_accvgpr_read_b32 v33, a105
    v_mul_f32 v33, v33, v34
    v_accvgpr_write_b32 a105, v33
    v_accvgpr_read_b32 v33, a106
    v_mul_f32 v33, v33, v34
    v_accvgpr_write_b32 a106, v33
    v_accvgpr_read_b32 v33, a107
    v_mul_f32 v33, v33, v34
    v_accvgpr_write_b32 a107, v33
    v_accvgpr_read_b32 v33, a108
    v_mul_f32 v33, v33, v34
    v_accvgpr_write_b32 a108, v33
    v_accvgpr_read_b32 v33, a109
    v_mul_f32 v33, v33, v34
    v_accvgpr_write_b32 a109, v33
    v_accvgpr_read_b32 v33, a110
    v_mul_f32 v33, v33, v34
    v_accvgpr_write_b32 a110, v33
    v_accvgpr_read_b32 v33, a111
    v_mul_f32 v33, v33, v34
    v_accvgpr_write_b32 a111, v33
    v_accvgpr_read_b32 v33, a112
    v_mul_f32 v33, v33, v34
    v_accvgpr_write_b32 a112, v33
    v_accvgpr_read_b32 v33, a113
    v_mul_f32 v33, v33, v34
    v_accvgpr_write_b32 a113, v33
    v_accvgpr_read_b32 v33, a114
    v_mul_f32 v33, v33, v34
    v_accvgpr_write_b32 a114, v33
    v_accvgpr_read_b32 v33, a115
    v_mul_f32 v33, v33, v34
    v_accvgpr_write_b32 a115, v33
    v_accvgpr_read_b32 v33, a116
    v_mul_f32 v33, v33, v34
    v_accvgpr_write_b32 a116, v33
    v_accvgpr_read_b32 v33, a117
    v_mul_f32 v33, v33, v34
    v_accvgpr_write_b32 a117, v33
    v_accvgpr_read_b32 v33, a118
    v_mul_f32 v33, v33, v34
    v_accvgpr_write_b32 a118, v33
    v_accvgpr_read_b32 v33, a119
    v_mul_f32 v33, v33, v34
    v_accvgpr_write_b32 a119, v33
    v_accvgpr_read_b32 v33, a120
    v_mul_f32 v33, v33, v34
    v_accvgpr_write_b32 a120, v33
    v_accvgpr_read_b32 v33, a121
    v_mul_f32 v33, v33, v34
    v_accvgpr_write_b32 a121, v33
    v_accvgpr_read_b32 v33, a122
    v_mul_f32 v33, v33, v34
    v_accvgpr_write_b32 a122, v33
    v_accvgpr_read_b32 v33, a123
    v_mul_f32 v33, v33, v34
    v_accvgpr_write_b32 a123, v33
    v_accvgpr_read_b32 v33, a124
    v_mul_f32 v33, v33, v34
    v_accvgpr_write_b32 a124, v33
    v_accvgpr_read_b32 v33, a125
    v_mul_f32 v33, v33, v34
    v_accvgpr_write_b32 a125, v33
    v_accvgpr_read_b32 v33, a126
    v_mul_f32 v33, v33, v34
    v_accvgpr_write_b32 a126, v33
    v_accvgpr_read_b32 v33, a127
    v_mul_f32 v33, v33, v34
    v_accvgpr_write_b32 a127, v33
    v_exp_f32 v36, v168
    v_exp_f32 v37, v169
    s_nop 0
    v_cvt_pk_bf16_f32 v220, v36, v37
    v_exp_f32 v36, v170
    v_exp_f32 v37, v171
    s_nop 0
    v_cvt_pk_bf16_f32 v221, v36, v37
    v_exp_f32 v36, v172
    v_exp_f32 v37, v173
    s_nop 0
    v_cvt_pk_bf16_f32 v222, v36, v37
    v_exp_f32 v36, v174
    v_exp_f32 v37, v175
    s_nop 0
    v_cvt_pk_bf16_f32 v223, v36, v37
    s_nop 1
    s_branch gated_mix__ssm_conv_h3__compressed_kv_cla__prompt_kernel_b4_r0_ret
gated_mix__ssm_conv_h3__compressed_kv_cla__prompt_kernel_b4_r1:
    s_nop 7
    v_max3_f32 v32, v176, v177, v178
    v_max3_f32 v32, v179, v180, v32
    v_max3_f32 v32, v181, v182, v32
    v_max_f32 v32, v183, v32
    v_mov_b32 v33, v32
    s_nop 1
    v_permlane16_swap_b32 v32, v33
    s_nop 1
    v_max_f32 v32, v32, v33
    v_mov_b32 v33, v32
    s_nop 1
    v_permlane32_swap_b32 v32, v33
    s_nop 1
    v_max_f32 v32, v32, v33
    v_add_f32 v32, 0x41c00000, v32
    v_max_f32 v32, 0, v32
    v_exp_f32 v34, -v32
    v_sub_f32 v64, v64, v32
    v_sub_f32 v65, v65, v32
    v_sub_f32 v66, v66, v32
    v_sub_f32 v67, v67, v32
    v_sub_f32 v176, v176, v32
    v_sub_f32 v177, v177, v32
    v_sub_f32 v178, v178, v32
    v_sub_f32 v179, v179, v32
    v_sub_f32 v180, v180, v32
    v_sub_f32 v181, v181, v32
    v_sub_f32 v182, v182, v32
    v_sub_f32 v183, v183, v32
    v_sub_f32 v144, v144, v32
    v_sub_f32 v145, v145, v32
    v_sub_f32 v146, v146, v32
    v_sub_f32 v147, v147, v32
    v_sub_f32 v148, v148, v32
    v_sub_f32 v149, v149, v32
    v_sub_f32 v150, v150, v32
    v_sub_f32 v151, v151, v32
    v_mul_f32 v240, v240, v34
    v_mul_f32 v241, v241, v34
    v_mul_f32 v242, v242, v34
    v_mul_f32 v243, v243, v34
    v_accvgpr_read_b32 v33, a0
    v_mul_f32 v33, v33, v34
    v_accvgpr_write_b32 a0, v33
    v_accvgpr_read_b32 v33, a1
    v_mul_f32 v33, v33, v34
    v_accvgpr_write_b32 a1, v33
    v_accvgpr_read_b32 v33, a2
    v_mul_f32 v33, v33, v34
    v_accvgpr_write_b32 a2, v33
    v_accvgpr_read_b32 v33, a3
    v_mul_f32 v33, v33, v34
    v_accvgpr_write_b32 a3, v33
    v_accvgpr_read_b32 v33, a4
    v_mul_f32 v33, v33, v34
    v_accvgpr_write_b32 a4, v33
    v_accvgpr_read_b32 v33, a5
    v_mul_f32 v33, v33, v34
    v_accvgpr_write_b32 a5, v33
    v_accvgpr_read_b32 v33, a6
    v_mul_f32 v33, v33, v34
    v_accvgpr_write_b32 a6, v33
    v_accvgpr_read_b32 v33, a7
    v_mul_f32 v33, v33, v34
    v_accvgpr_write_b32 a7, v33
    v_accvgpr_read_b32 v33, a8
    v_mul_f32 v33, v33, v34
    v_accvgpr_write_b32 a8, v33
    v_accvgpr_read_b32 v33, a9
    v_mul_f32 v33, v33, v34
    v_accvgpr_write_b32 a9, v33
    v_accvgpr_read_b32 v33, a10
    v_mul_f32 v33, v33, v34
    v_accvgpr_write_b32 a10, v33
    v_accvgpr_read_b32 v33, a11
    v_mul_f32 v33, v33, v34
    v_accvgpr_write_b32 a11, v33
    v_accvgpr_read_b32 v33, a12
    v_mul_f32 v33, v33, v34
    v_accvgpr_write_b32 a12, v33
    v_accvgpr_read_b32 v33, a13
    v_mul_f32 v33, v33, v34
    v_accvgpr_write_b32 a13, v33
    v_accvgpr_read_b32 v33, a14
    v_mul_f32 v33, v33, v34
    v_accvgpr_write_b32 a14, v33
    v_accvgpr_read_b32 v33, a15
    v_mul_f32 v33, v33, v34
    v_accvgpr_write_b32 a15, v33
    v_accvgpr_read_b32 v33, a16
    v_mul_f32 v33, v33, v34
    v_accvgpr_write_b32 a16, v33
    v_accvgpr_read_b32 v33, a17
    v_mul_f32 v33, v33, v34
    v_accvgpr_write_b32 a17, v33
    v_accvgpr_read_b32 v33, a18
    v_mul_f32 v33, v33, v34
    v_accvgpr_write_b32 a18, v33
    v_accvgpr_read_b32 v33, a19
    v_mul_f32 v33, v33, v34
    v_accvgpr_write_b32 a19, v33
    v_accvgpr_read_b32 v33, a20
    v_mul_f32 v33, v33, v34
    v_accvgpr_write_b32 a20, v33
    v_accvgpr_read_b32 v33, a21
    v_mul_f32 v33, v33, v34
    v_accvgpr_write_b32 a21, v33
    v_accvgpr_read_b32 v33, a22
    v_mul_f32 v33, v33, v34
    v_accvgpr_write_b32 a22, v33
    v_accvgpr_read_b32 v33, a23
    v_mul_f32 v33, v33, v34
    v_accvgpr_write_b32 a23, v33
    v_accvgpr_read_b32 v33, a24
    v_mul_f32 v33, v33, v34
    v_accvgpr_write_b32 a24, v33
    v_accvgpr_read_b32 v33, a25
    v_mul_f32 v33, v33, v34
    v_accvgpr_write_b32 a25, v33
    v_accvgpr_read_b32 v33, a26
    v_mul_f32 v33, v33, v34
    v_accvgpr_write_b32 a26, v33
    v_accvgpr_read_b32 v33, a27
    v_mul_f32 v33, v33, v34
    v_accvgpr_write_b32 a27, v33
    v_accvgpr_read_b32 v33, a28
    v_mul_f32 v33, v33, v34
    v_accvgpr_write_b32 a28, v33
    v_accvgpr_read_b32 v33, a29
    v_mul_f32 v33, v33, v34
    v_accvgpr_write_b32 a29, v33
    v_accvgpr_read_b32 v33, a30
    v_mul_f32 v33, v33, v34
    v_accvgpr_write_b32 a30, v33
    v_accvgpr_read_b32 v33, a31
    v_mul_f32 v33, v33, v34
    v_accvgpr_write_b32 a31, v33
    v_exp_f32 v36, v176
    v_exp_f32 v37, v177
    s_nop 0
    v_cvt_pk_bf16_f32 v224, v36, v37
    v_exp_f32 v36, v178
    v_exp_f32 v37, v179
    s_nop 0
    v_cvt_pk_bf16_f32 v225, v36, v37
    v_exp_f32 v36, v180
    v_exp_f32 v37, v181
    s_nop 0
    v_cvt_pk_bf16_f32 v226, v36, v37
    v_exp_f32 v36, v182
    v_exp_f32 v37, v183
    s_nop 0
    v_cvt_pk_bf16_f32 v227, v36, v37
    v_max3_f32 v32, v184, v185, v186
    v_max3_f32 v32, v187, v188, v32
    v_max3_f32 v32, v189, v190, v32
    v_max_f32 v32, v191, v32
    v_mov_b32 v33, v32
    s_nop 1
    v_permlane16_swap_b32 v32, v33
    s_nop 1
    v_max_f32 v32, v32, v33
    v_mov_b32 v33, v32
    s_nop 1
    v_permlane32_swap_b32 v32, v33
    s_nop 1
    v_max_f32 v32, v32, v33
    v_add_f32 v32, 0x41c00000, v32
    v_max_f32 v32, 0, v32
    v_exp_f32 v34, -v32
    v_sub_f32 v68, v68, v32
    v_sub_f32 v69, v69, v32
    v_sub_f32 v70, v70, v32
    v_sub_f32 v71, v71, v32
    v_sub_f32 v184, v184, v32
    v_sub_f32 v185, v185, v32
    v_sub_f32 v186, v186, v32
    v_sub_f32 v187, v187, v32
    v_sub_f32 v188, v188, v32
    v_sub_f32 v189, v189, v32
    v_sub_f32 v190, v190, v32
    v_sub_f32 v191, v191, v32
    v_sub_f32 v152, v152, v32
    v_sub_f32 v153, v153, v32
    v_sub_f32 v154, v154, v32
    v_sub_f32 v155, v155, v32
    v_sub_f32 v156, v156, v32
    v_sub_f32 v157, v157, v32
    v_sub_f32 v158, v158, v32
    v_sub_f32 v159, v159, v32
    v_mul_f32 v244, v244, v34
    v_mul_f32 v245, v245, v34
    v_mul_f32 v246, v246, v34
    v_mul_f32 v247, v247, v34
    v_accvgpr_read_b32 v33, a32
    v_mul_f32 v33, v33, v34
    v_accvgpr_write_b32 a32, v33
    v_accvgpr_read_b32 v33, a33
    v_mul_f32 v33, v33, v34
    v_accvgpr_write_b32 a33, v33
    v_accvgpr_read_b32 v33, a34
    v_mul_f32 v33, v33, v34
    v_accvgpr_write_b32 a34, v33
    v_accvgpr_read_b32 v33, a35
    v_mul_f32 v33, v33, v34
    v_accvgpr_write_b32 a35, v33
    v_accvgpr_read_b32 v33, a36
    v_mul_f32 v33, v33, v34
    v_accvgpr_write_b32 a36, v33
    v_accvgpr_read_b32 v33, a37
    v_mul_f32 v33, v33, v34
    v_accvgpr_write_b32 a37, v33
    v_accvgpr_read_b32 v33, a38
    v_mul_f32 v33, v33, v34
    v_accvgpr_write_b32 a38, v33
    v_accvgpr_read_b32 v33, a39
    v_mul_f32 v33, v33, v34
    v_accvgpr_write_b32 a39, v33
    v_accvgpr_read_b32 v33, a40
    v_mul_f32 v33, v33, v34
    v_accvgpr_write_b32 a40, v33
    v_accvgpr_read_b32 v33, a41
    v_mul_f32 v33, v33, v34
    v_accvgpr_write_b32 a41, v33
    v_accvgpr_read_b32 v33, a42
    v_mul_f32 v33, v33, v34
    v_accvgpr_write_b32 a42, v33
    v_accvgpr_read_b32 v33, a43
    v_mul_f32 v33, v33, v34
    v_accvgpr_write_b32 a43, v33
    v_accvgpr_read_b32 v33, a44
    v_mul_f32 v33, v33, v34
    v_accvgpr_write_b32 a44, v33
    v_accvgpr_read_b32 v33, a45
    v_mul_f32 v33, v33, v34
    v_accvgpr_write_b32 a45, v33
    v_accvgpr_read_b32 v33, a46
    v_mul_f32 v33, v33, v34
    v_accvgpr_write_b32 a46, v33
    v_accvgpr_read_b32 v33, a47
    v_mul_f32 v33, v33, v34
    v_accvgpr_write_b32 a47, v33
    v_accvgpr_read_b32 v33, a48
    v_mul_f32 v33, v33, v34
    v_accvgpr_write_b32 a48, v33
    v_accvgpr_read_b32 v33, a49
    v_mul_f32 v33, v33, v34
    v_accvgpr_write_b32 a49, v33
    v_accvgpr_read_b32 v33, a50
    v_mul_f32 v33, v33, v34
    v_accvgpr_write_b32 a50, v33
    v_accvgpr_read_b32 v33, a51
    v_mul_f32 v33, v33, v34
    v_accvgpr_write_b32 a51, v33
    v_accvgpr_read_b32 v33, a52
    v_mul_f32 v33, v33, v34
    v_accvgpr_write_b32 a52, v33
    v_accvgpr_read_b32 v33, a53
    v_mul_f32 v33, v33, v34
    v_accvgpr_write_b32 a53, v33
    v_accvgpr_read_b32 v33, a54
    v_mul_f32 v33, v33, v34
    v_accvgpr_write_b32 a54, v33
    v_accvgpr_read_b32 v33, a55
    v_mul_f32 v33, v33, v34
    v_accvgpr_write_b32 a55, v33
    v_accvgpr_read_b32 v33, a56
    v_mul_f32 v33, v33, v34
    v_accvgpr_write_b32 a56, v33
    v_accvgpr_read_b32 v33, a57
    v_mul_f32 v33, v33, v34
    v_accvgpr_write_b32 a57, v33
    v_accvgpr_read_b32 v33, a58
    v_mul_f32 v33, v33, v34
    v_accvgpr_write_b32 a58, v33
    v_accvgpr_read_b32 v33, a59
    v_mul_f32 v33, v33, v34
    v_accvgpr_write_b32 a59, v33
    v_accvgpr_read_b32 v33, a60
    v_mul_f32 v33, v33, v34
    v_accvgpr_write_b32 a60, v33
    v_accvgpr_read_b32 v33, a61
    v_mul_f32 v33, v33, v34
    v_accvgpr_write_b32 a61, v33
    v_accvgpr_read_b32 v33, a62
    v_mul_f32 v33, v33, v34
    v_accvgpr_write_b32 a62, v33
    v_accvgpr_read_b32 v33, a63
    v_mul_f32 v33, v33, v34
    v_accvgpr_write_b32 a63, v33
    v_exp_f32 v36, v184
    v_exp_f32 v37, v185
    s_nop 0
    v_cvt_pk_bf16_f32 v228, v36, v37
    v_exp_f32 v36, v186
    v_exp_f32 v37, v187
    s_nop 0
    v_cvt_pk_bf16_f32 v229, v36, v37
    v_exp_f32 v36, v188
    v_exp_f32 v37, v189
    s_nop 0
    v_cvt_pk_bf16_f32 v230, v36, v37
    v_exp_f32 v36, v190
    v_exp_f32 v37, v191
    s_nop 0
    v_cvt_pk_bf16_f32 v231, v36, v37
    v_max3_f32 v32, v192, v193, v194
    v_max3_f32 v32, v195, v196, v32
    v_max3_f32 v32, v197, v198, v32
    v_max_f32 v32, v199, v32
    v_mov_b32 v33, v32
    s_nop 1
    v_permlane16_swap_b32 v32, v33
    s_nop 1
    v_max_f32 v32, v32, v33
    v_mov_b32 v33, v32
    s_nop 1
    v_permlane32_swap_b32 v32, v33
    s_nop 1
    v_max_f32 v32, v32, v33
    v_add_f32 v32, 0x41c00000, v32
    v_max_f32 v32, 0, v32
    v_exp_f32 v34, -v32
    v_sub_f32 v72, v72, v32
    v_sub_f32 v73, v73, v32
    v_sub_f32 v74, v74, v32
    v_sub_f32 v75, v75, v32
    v_sub_f32 v192, v192, v32
    v_sub_f32 v193, v193, v32
    v_sub_f32 v194, v194, v32
    v_sub_f32 v195, v195, v32
    v_sub_f32 v196, v196, v32
    v_sub_f32 v197, v197, v32
    v_sub_f32 v198, v198, v32
    v_sub_f32 v199, v199, v32
    v_sub_f32 v160, v160, v32
    v_sub_f32 v161, v161, v32
    v_sub_f32 v162, v162, v32
    v_sub_f32 v163, v163, v32
    v_sub_f32 v164, v164, v32
    v_sub_f32 v165, v165, v32
    v_sub_f32 v166, v166, v32
    v_sub_f32 v167, v167, v32
    v_mul_f32 v248, v248, v34
    v_mul_f32 v249, v249, v34
    v_mul_f32 v250, v250, v34
    v_mul_f32 v251, v251, v34
    v_accvgpr_read_b32 v33, a64
    v_mul_f32 v33, v33, v34
    v_accvgpr_write_b32 a64, v33
    v_accvgpr_read_b32 v33, a65
    v_mul_f32 v33, v33, v34
    v_accvgpr_write_b32 a65, v33
    v_accvgpr_read_b32 v33, a66
    v_mul_f32 v33, v33, v34
    v_accvgpr_write_b32 a66, v33
    v_accvgpr_read_b32 v33, a67
    v_mul_f32 v33, v33, v34
    v_accvgpr_write_b32 a67, v33
    v_accvgpr_read_b32 v33, a68
    v_mul_f32 v33, v33, v34
    v_accvgpr_write_b32 a68, v33
    v_accvgpr_read_b32 v33, a69
    v_mul_f32 v33, v33, v34
    v_accvgpr_write_b32 a69, v33
    v_accvgpr_read_b32 v33, a70
    v_mul_f32 v33, v33, v34
    v_accvgpr_write_b32 a70, v33
    v_accvgpr_read_b32 v33, a71
    v_mul_f32 v33, v33, v34
    v_accvgpr_write_b32 a71, v33
    v_accvgpr_read_b32 v33, a72
    v_mul_f32 v33, v33, v34
    v_accvgpr_write_b32 a72, v33
    v_accvgpr_read_b32 v33, a73
    v_mul_f32 v33, v33, v34
    v_accvgpr_write_b32 a73, v33
    v_accvgpr_read_b32 v33, a74
    v_mul_f32 v33, v33, v34
    v_accvgpr_write_b32 a74, v33
    v_accvgpr_read_b32 v33, a75
    v_mul_f32 v33, v33, v34
    v_accvgpr_write_b32 a75, v33
    v_accvgpr_read_b32 v33, a76
    v_mul_f32 v33, v33, v34
    v_accvgpr_write_b32 a76, v33
    v_accvgpr_read_b32 v33, a77
    v_mul_f32 v33, v33, v34
    v_accvgpr_write_b32 a77, v33
    v_accvgpr_read_b32 v33, a78
    v_mul_f32 v33, v33, v34
    v_accvgpr_write_b32 a78, v33
    v_accvgpr_read_b32 v33, a79
    v_mul_f32 v33, v33, v34
    v_accvgpr_write_b32 a79, v33
    v_accvgpr_read_b32 v33, a80
    v_mul_f32 v33, v33, v34
    v_accvgpr_write_b32 a80, v33
    v_accvgpr_read_b32 v33, a81
    v_mul_f32 v33, v33, v34
    v_accvgpr_write_b32 a81, v33
    v_accvgpr_read_b32 v33, a82
    v_mul_f32 v33, v33, v34
    v_accvgpr_write_b32 a82, v33
    v_accvgpr_read_b32 v33, a83
    v_mul_f32 v33, v33, v34
    v_accvgpr_write_b32 a83, v33
    v_accvgpr_read_b32 v33, a84
    v_mul_f32 v33, v33, v34
    v_accvgpr_write_b32 a84, v33
    v_accvgpr_read_b32 v33, a85
    v_mul_f32 v33, v33, v34
    v_accvgpr_write_b32 a85, v33
    v_accvgpr_read_b32 v33, a86
    v_mul_f32 v33, v33, v34
    v_accvgpr_write_b32 a86, v33
    v_accvgpr_read_b32 v33, a87
    v_mul_f32 v33, v33, v34
    v_accvgpr_write_b32 a87, v33
    v_accvgpr_read_b32 v33, a88
    v_mul_f32 v33, v33, v34
    v_accvgpr_write_b32 a88, v33
    v_accvgpr_read_b32 v33, a89
    v_mul_f32 v33, v33, v34
    v_accvgpr_write_b32 a89, v33
    v_accvgpr_read_b32 v33, a90
    v_mul_f32 v33, v33, v34
    v_accvgpr_write_b32 a90, v33
    v_accvgpr_read_b32 v33, a91
    v_mul_f32 v33, v33, v34
    v_accvgpr_write_b32 a91, v33
    v_accvgpr_read_b32 v33, a92
    v_mul_f32 v33, v33, v34
    v_accvgpr_write_b32 a92, v33
    v_accvgpr_read_b32 v33, a93
    v_mul_f32 v33, v33, v34
    v_accvgpr_write_b32 a93, v33
    v_accvgpr_read_b32 v33, a94
    v_mul_f32 v33, v33, v34
    v_accvgpr_write_b32 a94, v33
    v_accvgpr_read_b32 v33, a95
    v_mul_f32 v33, v33, v34
    v_accvgpr_write_b32 a95, v33
    v_exp_f32 v36, v192
    v_exp_f32 v37, v193
    s_nop 0
    v_cvt_pk_bf16_f32 v232, v36, v37
    v_exp_f32 v36, v194
    v_exp_f32 v37, v195
    s_nop 0
    v_cvt_pk_bf16_f32 v233, v36, v37
    v_exp_f32 v36, v196
    v_exp_f32 v37, v197
    s_nop 0
    v_cvt_pk_bf16_f32 v234, v36, v37
    v_exp_f32 v36, v198
    v_exp_f32 v37, v199
    s_nop 0
    v_cvt_pk_bf16_f32 v235, v36, v37
    v_max3_f32 v32, v200, v201, v202
    v_max3_f32 v32, v203, v204, v32
    v_max3_f32 v32, v205, v206, v32
    v_max_f32 v32, v207, v32
    v_mov_b32 v33, v32
    s_nop 1
    v_permlane16_swap_b32 v32, v33
    s_nop 1
    v_max_f32 v32, v32, v33
    v_mov_b32 v33, v32
    s_nop 1
    v_permlane32_swap_b32 v32, v33
    s_nop 1
    v_max_f32 v32, v32, v33
    v_add_f32 v32, 0x41c00000, v32
    v_max_f32 v32, 0, v32
    v_exp_f32 v34, -v32
    v_sub_f32 v76, v76, v32
    v_sub_f32 v77, v77, v32
    v_sub_f32 v78, v78, v32
    v_sub_f32 v79, v79, v32
    v_sub_f32 v200, v200, v32
    v_sub_f32 v201, v201, v32
    v_sub_f32 v202, v202, v32
    v_sub_f32 v203, v203, v32
    v_sub_f32 v204, v204, v32
    v_sub_f32 v205, v205, v32
    v_sub_f32 v206, v206, v32
    v_sub_f32 v207, v207, v32
    v_sub_f32 v168, v168, v32
    v_sub_f32 v169, v169, v32
    v_sub_f32 v170, v170, v32
    v_sub_f32 v171, v171, v32
    v_sub_f32 v172, v172, v32
    v_sub_f32 v173, v173, v32
    v_sub_f32 v174, v174, v32
    v_sub_f32 v175, v175, v32
    v_mul_f32 v252, v252, v34
    v_mul_f32 v253, v253, v34
    v_mul_f32 v254, v254, v34
    v_mul_f32 v255, v255, v34
    v_accvgpr_read_b32 v33, a96
    v_mul_f32 v33, v33, v34
    v_accvgpr_write_b32 a96, v33
    v_accvgpr_read_b32 v33, a97
    v_mul_f32 v33, v33, v34
    v_accvgpr_write_b32 a97, v33
    v_accvgpr_read_b32 v33, a98
    v_mul_f32 v33, v33, v34
    v_accvgpr_write_b32 a98, v33
    v_accvgpr_read_b32 v33, a99
    v_mul_f32 v33, v33, v34
    v_accvgpr_write_b32 a99, v33
    v_accvgpr_read_b32 v33, a100
    v_mul_f32 v33, v33, v34
    v_accvgpr_write_b32 a100, v33
    v_accvgpr_read_b32 v33, a101
    v_mul_f32 v33, v33, v34
    v_accvgpr_write_b32 a101, v33
    v_accvgpr_read_b32 v33, a102
    v_mul_f32 v33, v33, v34
    v_accvgpr_write_b32 a102, v33
    v_accvgpr_read_b32 v33, a103
    v_mul_f32 v33, v33, v34
    v_accvgpr_write_b32 a103, v33
    v_accvgpr_read_b32 v33, a104
    v_mul_f32 v33, v33, v34
    v_accvgpr_write_b32 a104, v33
    v_accvgpr_read_b32 v33, a105
    v_mul_f32 v33, v33, v34
    v_accvgpr_write_b32 a105, v33
    v_accvgpr_read_b32 v33, a106
    v_mul_f32 v33, v33, v34
    v_accvgpr_write_b32 a106, v33
    v_accvgpr_read_b32 v33, a107
    v_mul_f32 v33, v33, v34
    v_accvgpr_write_b32 a107, v33
    v_accvgpr_read_b32 v33, a108
    v_mul_f32 v33, v33, v34
    v_accvgpr_write_b32 a108, v33
    v_accvgpr_read_b32 v33, a109
    v_mul_f32 v33, v33, v34
    v_accvgpr_write_b32 a109, v33
    v_accvgpr_read_b32 v33, a110
    v_mul_f32 v33, v33, v34
    v_accvgpr_write_b32 a110, v33
    v_accvgpr_read_b32 v33, a111
    v_mul_f32 v33, v33, v34
    v_accvgpr_write_b32 a111, v33
    v_accvgpr_read_b32 v33, a112
    v_mul_f32 v33, v33, v34
    v_accvgpr_write_b32 a112, v33
    v_accvgpr_read_b32 v33, a113
    v_mul_f32 v33, v33, v34
    v_accvgpr_write_b32 a113, v33
    v_accvgpr_read_b32 v33, a114
    v_mul_f32 v33, v33, v34
    v_accvgpr_write_b32 a114, v33
    v_accvgpr_read_b32 v33, a115
    v_mul_f32 v33, v33, v34
    v_accvgpr_write_b32 a115, v33
    v_accvgpr_read_b32 v33, a116
    v_mul_f32 v33, v33, v34
    v_accvgpr_write_b32 a116, v33
    v_accvgpr_read_b32 v33, a117
    v_mul_f32 v33, v33, v34
    v_accvgpr_write_b32 a117, v33
    v_accvgpr_read_b32 v33, a118
    v_mul_f32 v33, v33, v34
    v_accvgpr_write_b32 a118, v33
    v_accvgpr_read_b32 v33, a119
    v_mul_f32 v33, v33, v34
    v_accvgpr_write_b32 a119, v33
    v_accvgpr_read_b32 v33, a120
    v_mul_f32 v33, v33, v34
    v_accvgpr_write_b32 a120, v33
    v_accvgpr_read_b32 v33, a121
    v_mul_f32 v33, v33, v34
    v_accvgpr_write_b32 a121, v33
    v_accvgpr_read_b32 v33, a122
    v_mul_f32 v33, v33, v34
    v_accvgpr_write_b32 a122, v33
    v_accvgpr_read_b32 v33, a123
    v_mul_f32 v33, v33, v34
    v_accvgpr_write_b32 a123, v33
    v_accvgpr_read_b32 v33, a124
    v_mul_f32 v33, v33, v34
    v_accvgpr_write_b32 a124, v33
    v_accvgpr_read_b32 v33, a125
    v_mul_f32 v33, v33, v34
    v_accvgpr_write_b32 a125, v33
    v_accvgpr_read_b32 v33, a126
    v_mul_f32 v33, v33, v34
    v_accvgpr_write_b32 a126, v33
    v_accvgpr_read_b32 v33, a127
    v_mul_f32 v33, v33, v34
    v_accvgpr_write_b32 a127, v33
    v_exp_f32 v36, v200
    v_exp_f32 v37, v201
    s_nop 0
    v_cvt_pk_bf16_f32 v236, v36, v37
    v_exp_f32 v36, v202
    v_exp_f32 v37, v203
    s_nop 0
    v_cvt_pk_bf16_f32 v237, v36, v37
    v_exp_f32 v36, v204
    v_exp_f32 v37, v205
    s_nop 0
    v_cvt_pk_bf16_f32 v238, v36, v37
    v_exp_f32 v36, v206
    v_exp_f32 v37, v207
    s_nop 0
    v_cvt_pk_bf16_f32 v239, v36, v37
    s_nop 1
    s_branch gated_mix__ssm_conv_h3__compressed_kv_cla__prompt_kernel_b4_r1_ret
gated_mix__ssm_conv_h3__compressed_kv_cla__prompt_kernel_b3_r0:
    s_nop 7
    v_max3_f32 v32, v152, v153, v154
    v_max3_f32 v32, v155, v156, v32
    v_max3_f32 v32, v157, v158, v32
    v_max_f32 v32, v159, v32
    v_mov_b32 v33, v32
    s_nop 1
    v_permlane16_swap_b32 v32, v33
    s_nop 1
    v_max_f32 v32, v32, v33
    v_mov_b32 v33, v32
    s_nop 1
    v_permlane32_swap_b32 v32, v33
    s_nop 1
    v_max_f32 v32, v32, v33
    v_add_f32 v32, 0x41c00000, v32
    v_max_f32 v32, 0, v32
    v_exp_f32 v34, -v32
    v_sub_f32 v68, v68, v32
    v_sub_f32 v69, v69, v32
    v_sub_f32 v70, v70, v32
    v_sub_f32 v71, v71, v32
    v_sub_f32 v152, v152, v32
    v_sub_f32 v153, v153, v32
    v_sub_f32 v154, v154, v32
    v_sub_f32 v155, v155, v32
    v_sub_f32 v156, v156, v32
    v_sub_f32 v157, v157, v32
    v_sub_f32 v158, v158, v32
    v_sub_f32 v159, v159, v32
    v_sub_f32 v184, v184, v32
    v_sub_f32 v185, v185, v32
    v_sub_f32 v186, v186, v32
    v_sub_f32 v187, v187, v32
    v_sub_f32 v188, v188, v32
    v_sub_f32 v189, v189, v32
    v_sub_f32 v190, v190, v32
    v_sub_f32 v191, v191, v32
    v_mul_f32 v244, v244, v34
    v_mul_f32 v245, v245, v34
    v_mul_f32 v246, v246, v34
    v_mul_f32 v247, v247, v34
    v_accvgpr_read_b32 v33, a32
    v_mul_f32 v33, v33, v34
    v_accvgpr_write_b32 a32, v33
    v_accvgpr_read_b32 v33, a33
    v_mul_f32 v33, v33, v34
    v_accvgpr_write_b32 a33, v33
    v_accvgpr_read_b32 v33, a34
    v_mul_f32 v33, v33, v34
    v_accvgpr_write_b32 a34, v33
    v_accvgpr_read_b32 v33, a35
    v_mul_f32 v33, v33, v34
    v_accvgpr_write_b32 a35, v33
    v_accvgpr_read_b32 v33, a36
    v_mul_f32 v33, v33, v34
    v_accvgpr_write_b32 a36, v33
    v_accvgpr_read_b32 v33, a37
    v_mul_f32 v33, v33, v34
    v_accvgpr_write_b32 a37, v33
    v_accvgpr_read_b32 v33, a38
    v_mul_f32 v33, v33, v34
    v_accvgpr_write_b32 a38, v33
    v_accvgpr_read_b32 v33, a39
    v_mul_f32 v33, v33, v34
    v_accvgpr_write_b32 a39, v33
    v_accvgpr_read_b32 v33, a40
    v_mul_f32 v33, v33, v34
    v_accvgpr_write_b32 a40, v33
    v_accvgpr_read_b32 v33, a41
    v_mul_f32 v33, v33, v34
    v_accvgpr_write_b32 a41, v33
    v_accvgpr_read_b32 v33, a42
    v_mul_f32 v33, v33, v34
    v_accvgpr_write_b32 a42, v33
    v_accvgpr_read_b32 v33, a43
    v_mul_f32 v33, v33, v34
    v_accvgpr_write_b32 a43, v33
    v_accvgpr_read_b32 v33, a44
    v_mul_f32 v33, v33, v34
    v_accvgpr_write_b32 a44, v33
    v_accvgpr_read_b32 v33, a45
    v_mul_f32 v33, v33, v34
    v_accvgpr_write_b32 a45, v33
    v_accvgpr_read_b32 v33, a46
    v_mul_f32 v33, v33, v34
    v_accvgpr_write_b32 a46, v33
    v_accvgpr_read_b32 v33, a47
    v_mul_f32 v33, v33, v34
    v_accvgpr_write_b32 a47, v33
    v_accvgpr_read_b32 v33, a48
    v_mul_f32 v33, v33, v34
    v_accvgpr_write_b32 a48, v33
    v_accvgpr_read_b32 v33, a49
    v_mul_f32 v33, v33, v34
    v_accvgpr_write_b32 a49, v33
    v_accvgpr_read_b32 v33, a50
    v_mul_f32 v33, v33, v34
    v_accvgpr_write_b32 a50, v33
    v_accvgpr_read_b32 v33, a51
    v_mul_f32 v33, v33, v34
    v_accvgpr_write_b32 a51, v33
    v_accvgpr_read_b32 v33, a52
    v_mul_f32 v33, v33, v34
    v_accvgpr_write_b32 a52, v33
    v_accvgpr_read_b32 v33, a53
    v_mul_f32 v33, v33, v34
    v_accvgpr_write_b32 a53, v33
    v_accvgpr_read_b32 v33, a54
    v_mul_f32 v33, v33, v34
    v_accvgpr_write_b32 a54, v33
    v_accvgpr_read_b32 v33, a55
    v_mul_f32 v33, v33, v34
    v_accvgpr_write_b32 a55, v33
    v_accvgpr_read_b32 v33, a56
    v_mul_f32 v33, v33, v34
    v_accvgpr_write_b32 a56, v33
    v_accvgpr_read_b32 v33, a57
    v_mul_f32 v33, v33, v34
    v_accvgpr_write_b32 a57, v33
    v_accvgpr_read_b32 v33, a58
    v_mul_f32 v33, v33, v34
    v_accvgpr_write_b32 a58, v33
    v_accvgpr_read_b32 v33, a59
    v_mul_f32 v33, v33, v34
    v_accvgpr_write_b32 a59, v33
    v_accvgpr_read_b32 v33, a60
    v_mul_f32 v33, v33, v34
    v_accvgpr_write_b32 a60, v33
    v_accvgpr_read_b32 v33, a61
    v_mul_f32 v33, v33, v34
    v_accvgpr_write_b32 a61, v33
    v_accvgpr_read_b32 v33, a62
    v_mul_f32 v33, v33, v34
    v_accvgpr_write_b32 a62, v33
    v_accvgpr_read_b32 v33, a63
    v_mul_f32 v33, v33, v34
    v_accvgpr_write_b32 a63, v33
    v_exp_f32 v36, v152
    v_exp_f32 v37, v153
    s_nop 0
    v_cvt_pk_bf16_f32 v212, v36, v37
    v_exp_f32 v36, v154
    v_exp_f32 v37, v155
    s_nop 0
    v_cvt_pk_bf16_f32 v213, v36, v37
    v_exp_f32 v36, v156
    v_exp_f32 v37, v157
    s_nop 0
    v_cvt_pk_bf16_f32 v214, v36, v37
    v_exp_f32 v36, v158
    v_exp_f32 v37, v159
    s_nop 0
    v_cvt_pk_bf16_f32 v215, v36, v37
    v_max3_f32 v32, v160, v161, v162
    v_max3_f32 v32, v163, v164, v32
    v_max3_f32 v32, v165, v166, v32
    v_max_f32 v32, v167, v32
    v_mov_b32 v33, v32
    s_nop 1
    v_permlane16_swap_b32 v32, v33
    s_nop 1
    v_max_f32 v32, v32, v33
    v_mov_b32 v33, v32
    s_nop 1
    v_permlane32_swap_b32 v32, v33
    s_nop 1
    v_max_f32 v32, v32, v33
    v_add_f32 v32, 0x41c00000, v32
    v_max_f32 v32, 0, v32
    v_exp_f32 v34, -v32
    v_sub_f32 v72, v72, v32
    v_sub_f32 v73, v73, v32
    v_sub_f32 v74, v74, v32
    v_sub_f32 v75, v75, v32
    v_sub_f32 v160, v160, v32
    v_sub_f32 v161, v161, v32
    v_sub_f32 v162, v162, v32
    v_sub_f32 v163, v163, v32
    v_sub_f32 v164, v164, v32
    v_sub_f32 v165, v165, v32
    v_sub_f32 v166, v166, v32
    v_sub_f32 v167, v167, v32
    v_sub_f32 v192, v192, v32
    v_sub_f32 v193, v193, v32
    v_sub_f32 v194, v194, v32
    v_sub_f32 v195, v195, v32
    v_sub_f32 v196, v196, v32
    v_sub_f32 v197, v197, v32
    v_sub_f32 v198, v198, v32
    v_sub_f32 v199, v199, v32
    v_mul_f32 v248, v248, v34
    v_mul_f32 v249, v249, v34
    v_mul_f32 v250, v250, v34
    v_mul_f32 v251, v251, v34
    v_accvgpr_read_b32 v33, a64
    v_mul_f32 v33, v33, v34
    v_accvgpr_write_b32 a64, v33
    v_accvgpr_read_b32 v33, a65
    v_mul_f32 v33, v33, v34
    v_accvgpr_write_b32 a65, v33
    v_accvgpr_read_b32 v33, a66
    v_mul_f32 v33, v33, v34
    v_accvgpr_write_b32 a66, v33
    v_accvgpr_read_b32 v33, a67
    v_mul_f32 v33, v33, v34
    v_accvgpr_write_b32 a67, v33
    v_accvgpr_read_b32 v33, a68
    v_mul_f32 v33, v33, v34
    v_accvgpr_write_b32 a68, v33
    v_accvgpr_read_b32 v33, a69
    v_mul_f32 v33, v33, v34
    v_accvgpr_write_b32 a69, v33
    v_accvgpr_read_b32 v33, a70
    v_mul_f32 v33, v33, v34
    v_accvgpr_write_b32 a70, v33
    v_accvgpr_read_b32 v33, a71
    v_mul_f32 v33, v33, v34
    v_accvgpr_write_b32 a71, v33
    v_accvgpr_read_b32 v33, a72
    v_mul_f32 v33, v33, v34
    v_accvgpr_write_b32 a72, v33
    v_accvgpr_read_b32 v33, a73
    v_mul_f32 v33, v33, v34
    v_accvgpr_write_b32 a73, v33
    v_accvgpr_read_b32 v33, a74
    v_mul_f32 v33, v33, v34
    v_accvgpr_write_b32 a74, v33
    v_accvgpr_read_b32 v33, a75
    v_mul_f32 v33, v33, v34
    v_accvgpr_write_b32 a75, v33
    v_accvgpr_read_b32 v33, a76
    v_mul_f32 v33, v33, v34
    v_accvgpr_write_b32 a76, v33
    v_accvgpr_read_b32 v33, a77
    v_mul_f32 v33, v33, v34
    v_accvgpr_write_b32 a77, v33
    v_accvgpr_read_b32 v33, a78
    v_mul_f32 v33, v33, v34
    v_accvgpr_write_b32 a78, v33
    v_accvgpr_read_b32 v33, a79
    v_mul_f32 v33, v33, v34
    v_accvgpr_write_b32 a79, v33
    v_accvgpr_read_b32 v33, a80
    v_mul_f32 v33, v33, v34
    v_accvgpr_write_b32 a80, v33
    v_accvgpr_read_b32 v33, a81
    v_mul_f32 v33, v33, v34
    v_accvgpr_write_b32 a81, v33
    v_accvgpr_read_b32 v33, a82
    v_mul_f32 v33, v33, v34
    v_accvgpr_write_b32 a82, v33
    v_accvgpr_read_b32 v33, a83
    v_mul_f32 v33, v33, v34
    v_accvgpr_write_b32 a83, v33
    v_accvgpr_read_b32 v33, a84
    v_mul_f32 v33, v33, v34
    v_accvgpr_write_b32 a84, v33
    v_accvgpr_read_b32 v33, a85
    v_mul_f32 v33, v33, v34
    v_accvgpr_write_b32 a85, v33
    v_accvgpr_read_b32 v33, a86
    v_mul_f32 v33, v33, v34
    v_accvgpr_write_b32 a86, v33
    v_accvgpr_read_b32 v33, a87
    v_mul_f32 v33, v33, v34
    v_accvgpr_write_b32 a87, v33
    v_accvgpr_read_b32 v33, a88
    v_mul_f32 v33, v33, v34
    v_accvgpr_write_b32 a88, v33
    v_accvgpr_read_b32 v33, a89
    v_mul_f32 v33, v33, v34
    v_accvgpr_write_b32 a89, v33
    v_accvgpr_read_b32 v33, a90
    v_mul_f32 v33, v33, v34
    v_accvgpr_write_b32 a90, v33
    v_accvgpr_read_b32 v33, a91
    v_mul_f32 v33, v33, v34
    v_accvgpr_write_b32 a91, v33
    v_accvgpr_read_b32 v33, a92
    v_mul_f32 v33, v33, v34
    v_accvgpr_write_b32 a92, v33
    v_accvgpr_read_b32 v33, a93
    v_mul_f32 v33, v33, v34
    v_accvgpr_write_b32 a93, v33
    v_accvgpr_read_b32 v33, a94
    v_mul_f32 v33, v33, v34
    v_accvgpr_write_b32 a94, v33
    v_accvgpr_read_b32 v33, a95
    v_mul_f32 v33, v33, v34
    v_accvgpr_write_b32 a95, v33
    v_exp_f32 v36, v160
    v_exp_f32 v37, v161
    s_nop 0
    v_cvt_pk_bf16_f32 v216, v36, v37
    v_exp_f32 v36, v162
    v_exp_f32 v37, v163
    s_nop 0
    v_cvt_pk_bf16_f32 v217, v36, v37
    v_exp_f32 v36, v164
    v_exp_f32 v37, v165
    s_nop 0
    v_cvt_pk_bf16_f32 v218, v36, v37
    v_exp_f32 v36, v166
    v_exp_f32 v37, v167
    s_nop 0
    v_cvt_pk_bf16_f32 v219, v36, v37
    v_max3_f32 v32, v168, v169, v170
    v_max3_f32 v32, v171, v172, v32
    v_max3_f32 v32, v173, v174, v32
    v_max_f32 v32, v175, v32
    v_mov_b32 v33, v32
    s_nop 1
    v_permlane16_swap_b32 v32, v33
    s_nop 1
    v_max_f32 v32, v32, v33
    v_mov_b32 v33, v32
    s_nop 1
    v_permlane32_swap_b32 v32, v33
    s_nop 1
    v_max_f32 v32, v32, v33
    v_add_f32 v32, 0x41c00000, v32
    v_max_f32 v32, 0, v32
    v_exp_f32 v34, -v32
    v_sub_f32 v76, v76, v32
    v_sub_f32 v77, v77, v32
    v_sub_f32 v78, v78, v32
    v_sub_f32 v79, v79, v32
    v_sub_f32 v168, v168, v32
    v_sub_f32 v169, v169, v32
    v_sub_f32 v170, v170, v32
    v_sub_f32 v171, v171, v32
    v_sub_f32 v172, v172, v32
    v_sub_f32 v173, v173, v32
    v_sub_f32 v174, v174, v32
    v_sub_f32 v175, v175, v32
    v_sub_f32 v200, v200, v32
    v_sub_f32 v201, v201, v32
    v_sub_f32 v202, v202, v32
    v_sub_f32 v203, v203, v32
    v_sub_f32 v204, v204, v32
    v_sub_f32 v205, v205, v32
    v_sub_f32 v206, v206, v32
    v_sub_f32 v207, v207, v32
    v_mul_f32 v252, v252, v34
    v_mul_f32 v253, v253, v34
    v_mul_f32 v254, v254, v34
    v_mul_f32 v255, v255, v34
    v_accvgpr_read_b32 v33, a96
    v_mul_f32 v33, v33, v34
    v_accvgpr_write_b32 a96, v33
    v_accvgpr_read_b32 v33, a97
    v_mul_f32 v33, v33, v34
    v_accvgpr_write_b32 a97, v33
    v_accvgpr_read_b32 v33, a98
    v_mul_f32 v33, v33, v34
    v_accvgpr_write_b32 a98, v33
    v_accvgpr_read_b32 v33, a99
    v_mul_f32 v33, v33, v34
    v_accvgpr_write_b32 a99, v33
    v_accvgpr_read_b32 v33, a100
    v_mul_f32 v33, v33, v34
    v_accvgpr_write_b32 a100, v33
    v_accvgpr_read_b32 v33, a101
    v_mul_f32 v33, v33, v34
    v_accvgpr_write_b32 a101, v33
    v_accvgpr_read_b32 v33, a102
    v_mul_f32 v33, v33, v34
    v_accvgpr_write_b32 a102, v33
    v_accvgpr_read_b32 v33, a103
    v_mul_f32 v33, v33, v34
    v_accvgpr_write_b32 a103, v33
    v_accvgpr_read_b32 v33, a104
    v_mul_f32 v33, v33, v34
    v_accvgpr_write_b32 a104, v33
    v_accvgpr_read_b32 v33, a105
    v_mul_f32 v33, v33, v34
    v_accvgpr_write_b32 a105, v33
    v_accvgpr_read_b32 v33, a106
    v_mul_f32 v33, v33, v34
    v_accvgpr_write_b32 a106, v33
    v_accvgpr_read_b32 v33, a107
    v_mul_f32 v33, v33, v34
    v_accvgpr_write_b32 a107, v33
    v_accvgpr_read_b32 v33, a108
    v_mul_f32 v33, v33, v34
    v_accvgpr_write_b32 a108, v33
    v_accvgpr_read_b32 v33, a109
    v_mul_f32 v33, v33, v34
    v_accvgpr_write_b32 a109, v33
    v_accvgpr_read_b32 v33, a110
    v_mul_f32 v33, v33, v34
    v_accvgpr_write_b32 a110, v33
    v_accvgpr_read_b32 v33, a111
    v_mul_f32 v33, v33, v34
    v_accvgpr_write_b32 a111, v33
    v_accvgpr_read_b32 v33, a112
    v_mul_f32 v33, v33, v34
    v_accvgpr_write_b32 a112, v33
    v_accvgpr_read_b32 v33, a113
    v_mul_f32 v33, v33, v34
    v_accvgpr_write_b32 a113, v33
    v_accvgpr_read_b32 v33, a114
    v_mul_f32 v33, v33, v34
    v_accvgpr_write_b32 a114, v33
    v_accvgpr_read_b32 v33, a115
    v_mul_f32 v33, v33, v34
    v_accvgpr_write_b32 a115, v33
    v_accvgpr_read_b32 v33, a116
    v_mul_f32 v33, v33, v34
    v_accvgpr_write_b32 a116, v33
    v_accvgpr_read_b32 v33, a117
    v_mul_f32 v33, v33, v34
    v_accvgpr_write_b32 a117, v33
    v_accvgpr_read_b32 v33, a118
    v_mul_f32 v33, v33, v34
    v_accvgpr_write_b32 a118, v33
    v_accvgpr_read_b32 v33, a119
    v_mul_f32 v33, v33, v34
    v_accvgpr_write_b32 a119, v33
    v_accvgpr_read_b32 v33, a120
    v_mul_f32 v33, v33, v34
    v_accvgpr_write_b32 a120, v33
    v_accvgpr_read_b32 v33, a121
    v_mul_f32 v33, v33, v34
    v_accvgpr_write_b32 a121, v33
    v_accvgpr_read_b32 v33, a122
    v_mul_f32 v33, v33, v34
    v_accvgpr_write_b32 a122, v33
    v_accvgpr_read_b32 v33, a123
    v_mul_f32 v33, v33, v34
    v_accvgpr_write_b32 a123, v33
    v_accvgpr_read_b32 v33, a124
    v_mul_f32 v33, v33, v34
    v_accvgpr_write_b32 a124, v33
    v_accvgpr_read_b32 v33, a125
    v_mul_f32 v33, v33, v34
    v_accvgpr_write_b32 a125, v33
    v_accvgpr_read_b32 v33, a126
    v_mul_f32 v33, v33, v34
    v_accvgpr_write_b32 a126, v33
    v_accvgpr_read_b32 v33, a127
    v_mul_f32 v33, v33, v34
    v_accvgpr_write_b32 a127, v33
    v_exp_f32 v36, v168
    v_exp_f32 v37, v169
    s_nop 0
    v_cvt_pk_bf16_f32 v220, v36, v37
    v_exp_f32 v36, v170
    v_exp_f32 v37, v171
    s_nop 0
    v_cvt_pk_bf16_f32 v221, v36, v37
    v_exp_f32 v36, v172
    v_exp_f32 v37, v173
    s_nop 0
    v_cvt_pk_bf16_f32 v222, v36, v37
    v_exp_f32 v36, v174
    v_exp_f32 v37, v175
    s_nop 0
    v_cvt_pk_bf16_f32 v223, v36, v37
    s_nop 1
    s_branch gated_mix__ssm_conv_h3__compressed_kv_cla__prompt_kernel_b3_r0_ret
gated_mix__ssm_conv_h3__compressed_kv_cla__prompt_kernel_b3_r1:
    s_nop 7
    v_max3_f32 v32, v184, v185, v186
    v_max3_f32 v32, v187, v188, v32
    v_max3_f32 v32, v189, v190, v32
    v_max_f32 v32, v191, v32
    v_mov_b32 v33, v32
    s_nop 1
    v_permlane16_swap_b32 v32, v33
    s_nop 1
    v_max_f32 v32, v32, v33
    v_mov_b32 v33, v32
    s_nop 1
    v_permlane32_swap_b32 v32, v33
    s_nop 1
    v_max_f32 v32, v32, v33
    v_add_f32 v32, 0x41c00000, v32
    v_max_f32 v32, 0, v32
    v_exp_f32 v34, -v32
    v_sub_f32 v68, v68, v32
    v_sub_f32 v69, v69, v32
    v_sub_f32 v70, v70, v32
    v_sub_f32 v71, v71, v32
    v_sub_f32 v184, v184, v32
    v_sub_f32 v185, v185, v32
    v_sub_f32 v186, v186, v32
    v_sub_f32 v187, v187, v32
    v_sub_f32 v188, v188, v32
    v_sub_f32 v189, v189, v32
    v_sub_f32 v190, v190, v32
    v_sub_f32 v191, v191, v32
    v_sub_f32 v152, v152, v32
    v_sub_f32 v153, v153, v32
    v_sub_f32 v154, v154, v32
    v_sub_f32 v155, v155, v32
    v_sub_f32 v156, v156, v32
    v_sub_f32 v157, v157, v32
    v_sub_f32 v158, v158, v32
    v_sub_f32 v159, v159, v32
    v_mul_f32 v244, v244, v34
    v_mul_f32 v245, v245, v34
    v_mul_f32 v246, v246, v34
    v_mul_f32 v247, v247, v34
    v_accvgpr_read_b32 v33, a32
    v_mul_f32 v33, v33, v34
    v_accvgpr_write_b32 a32, v33
    v_accvgpr_read_b32 v33, a33
    v_mul_f32 v33, v33, v34
    v_accvgpr_write_b32 a33, v33
    v_accvgpr_read_b32 v33, a34
    v_mul_f32 v33, v33, v34
    v_accvgpr_write_b32 a34, v33
    v_accvgpr_read_b32 v33, a35
    v_mul_f32 v33, v33, v34
    v_accvgpr_write_b32 a35, v33
    v_accvgpr_read_b32 v33, a36
    v_mul_f32 v33, v33, v34
    v_accvgpr_write_b32 a36, v33
    v_accvgpr_read_b32 v33, a37
    v_mul_f32 v33, v33, v34
    v_accvgpr_write_b32 a37, v33
    v_accvgpr_read_b32 v33, a38
    v_mul_f32 v33, v33, v34
    v_accvgpr_write_b32 a38, v33
    v_accvgpr_read_b32 v33, a39
    v_mul_f32 v33, v33, v34
    v_accvgpr_write_b32 a39, v33
    v_accvgpr_read_b32 v33, a40
    v_mul_f32 v33, v33, v34
    v_accvgpr_write_b32 a40, v33
    v_accvgpr_read_b32 v33, a41
    v_mul_f32 v33, v33, v34
    v_accvgpr_write_b32 a41, v33
    v_accvgpr_read_b32 v33, a42
    v_mul_f32 v33, v33, v34
    v_accvgpr_write_b32 a42, v33
    v_accvgpr_read_b32 v33, a43
    v_mul_f32 v33, v33, v34
    v_accvgpr_write_b32 a43, v33
    v_accvgpr_read_b32 v33, a44
    v_mul_f32 v33, v33, v34
    v_accvgpr_write_b32 a44, v33
    v_accvgpr_read_b32 v33, a45
    v_mul_f32 v33, v33, v34
    v_accvgpr_write_b32 a45, v33
    v_accvgpr_read_b32 v33, a46
    v_mul_f32 v33, v33, v34
    v_accvgpr_write_b32 a46, v33
    v_accvgpr_read_b32 v33, a47
    v_mul_f32 v33, v33, v34
    v_accvgpr_write_b32 a47, v33
    v_accvgpr_read_b32 v33, a48
    v_mul_f32 v33, v33, v34
    v_accvgpr_write_b32 a48, v33
    v_accvgpr_read_b32 v33, a49
    v_mul_f32 v33, v33, v34
    v_accvgpr_write_b32 a49, v33
    v_accvgpr_read_b32 v33, a50
    v_mul_f32 v33, v33, v34
    v_accvgpr_write_b32 a50, v33
    v_accvgpr_read_b32 v33, a51
    v_mul_f32 v33, v33, v34
    v_accvgpr_write_b32 a51, v33
    v_accvgpr_read_b32 v33, a52
    v_mul_f32 v33, v33, v34
    v_accvgpr_write_b32 a52, v33
    v_accvgpr_read_b32 v33, a53
    v_mul_f32 v33, v33, v34
    v_accvgpr_write_b32 a53, v33
    v_accvgpr_read_b32 v33, a54
    v_mul_f32 v33, v33, v34
    v_accvgpr_write_b32 a54, v33
    v_accvgpr_read_b32 v33, a55
    v_mul_f32 v33, v33, v34
    v_accvgpr_write_b32 a55, v33
    v_accvgpr_read_b32 v33, a56
    v_mul_f32 v33, v33, v34
    v_accvgpr_write_b32 a56, v33
    v_accvgpr_read_b32 v33, a57
    v_mul_f32 v33, v33, v34
    v_accvgpr_write_b32 a57, v33
    v_accvgpr_read_b32 v33, a58
    v_mul_f32 v33, v33, v34
    v_accvgpr_write_b32 a58, v33
    v_accvgpr_read_b32 v33, a59
    v_mul_f32 v33, v33, v34
    v_accvgpr_write_b32 a59, v33
    v_accvgpr_read_b32 v33, a60
    v_mul_f32 v33, v33, v34
    v_accvgpr_write_b32 a60, v33
    v_accvgpr_read_b32 v33, a61
    v_mul_f32 v33, v33, v34
    v_accvgpr_write_b32 a61, v33
    v_accvgpr_read_b32 v33, a62
    v_mul_f32 v33, v33, v34
    v_accvgpr_write_b32 a62, v33
    v_accvgpr_read_b32 v33, a63
    v_mul_f32 v33, v33, v34
    v_accvgpr_write_b32 a63, v33
    v_exp_f32 v36, v184
    v_exp_f32 v37, v185
    s_nop 0
    v_cvt_pk_bf16_f32 v228, v36, v37
    v_exp_f32 v36, v186
    v_exp_f32 v37, v187
    s_nop 0
    v_cvt_pk_bf16_f32 v229, v36, v37
    v_exp_f32 v36, v188
    v_exp_f32 v37, v189
    s_nop 0
    v_cvt_pk_bf16_f32 v230, v36, v37
    v_exp_f32 v36, v190
    v_exp_f32 v37, v191
    s_nop 0
    v_cvt_pk_bf16_f32 v231, v36, v37
    v_max3_f32 v32, v192, v193, v194
    v_max3_f32 v32, v195, v196, v32
    v_max3_f32 v32, v197, v198, v32
    v_max_f32 v32, v199, v32
    v_mov_b32 v33, v32
    s_nop 1
    v_permlane16_swap_b32 v32, v33
    s_nop 1
    v_max_f32 v32, v32, v33
    v_mov_b32 v33, v32
    s_nop 1
    v_permlane32_swap_b32 v32, v33
    s_nop 1
    v_max_f32 v32, v32, v33
    v_add_f32 v32, 0x41c00000, v32
    v_max_f32 v32, 0, v32
    v_exp_f32 v34, -v32
    v_sub_f32 v72, v72, v32
    v_sub_f32 v73, v73, v32
    v_sub_f32 v74, v74, v32
    v_sub_f32 v75, v75, v32
    v_sub_f32 v192, v192, v32
    v_sub_f32 v193, v193, v32
    v_sub_f32 v194, v194, v32
    v_sub_f32 v195, v195, v32
    v_sub_f32 v196, v196, v32
    v_sub_f32 v197, v197, v32
    v_sub_f32 v198, v198, v32
    v_sub_f32 v199, v199, v32
    v_sub_f32 v160, v160, v32
    v_sub_f32 v161, v161, v32
    v_sub_f32 v162, v162, v32
    v_sub_f32 v163, v163, v32
    v_sub_f32 v164, v164, v32
    v_sub_f32 v165, v165, v32
    v_sub_f32 v166, v166, v32
    v_sub_f32 v167, v167, v32
    v_mul_f32 v248, v248, v34
    v_mul_f32 v249, v249, v34
    v_mul_f32 v250, v250, v34
    v_mul_f32 v251, v251, v34
    v_accvgpr_read_b32 v33, a64
    v_mul_f32 v33, v33, v34
    v_accvgpr_write_b32 a64, v33
    v_accvgpr_read_b32 v33, a65
    v_mul_f32 v33, v33, v34
    v_accvgpr_write_b32 a65, v33
    v_accvgpr_read_b32 v33, a66
    v_mul_f32 v33, v33, v34
    v_accvgpr_write_b32 a66, v33
    v_accvgpr_read_b32 v33, a67
    v_mul_f32 v33, v33, v34
    v_accvgpr_write_b32 a67, v33
    v_accvgpr_read_b32 v33, a68
    v_mul_f32 v33, v33, v34
    v_accvgpr_write_b32 a68, v33
    v_accvgpr_read_b32 v33, a69
    v_mul_f32 v33, v33, v34
    v_accvgpr_write_b32 a69, v33
    v_accvgpr_read_b32 v33, a70
    v_mul_f32 v33, v33, v34
    v_accvgpr_write_b32 a70, v33
    v_accvgpr_read_b32 v33, a71
    v_mul_f32 v33, v33, v34
    v_accvgpr_write_b32 a71, v33
    v_accvgpr_read_b32 v33, a72
    v_mul_f32 v33, v33, v34
    v_accvgpr_write_b32 a72, v33
    v_accvgpr_read_b32 v33, a73
    v_mul_f32 v33, v33, v34
    v_accvgpr_write_b32 a73, v33
    v_accvgpr_read_b32 v33, a74
    v_mul_f32 v33, v33, v34
    v_accvgpr_write_b32 a74, v33
    v_accvgpr_read_b32 v33, a75
    v_mul_f32 v33, v33, v34
    v_accvgpr_write_b32 a75, v33
    v_accvgpr_read_b32 v33, a76
    v_mul_f32 v33, v33, v34
    v_accvgpr_write_b32 a76, v33
    v_accvgpr_read_b32 v33, a77
    v_mul_f32 v33, v33, v34
    v_accvgpr_write_b32 a77, v33
    v_accvgpr_read_b32 v33, a78
    v_mul_f32 v33, v33, v34
    v_accvgpr_write_b32 a78, v33
    v_accvgpr_read_b32 v33, a79
    v_mul_f32 v33, v33, v34
    v_accvgpr_write_b32 a79, v33
    v_accvgpr_read_b32 v33, a80
    v_mul_f32 v33, v33, v34
    v_accvgpr_write_b32 a80, v33
    v_accvgpr_read_b32 v33, a81
    v_mul_f32 v33, v33, v34
    v_accvgpr_write_b32 a81, v33
    v_accvgpr_read_b32 v33, a82
    v_mul_f32 v33, v33, v34
    v_accvgpr_write_b32 a82, v33
    v_accvgpr_read_b32 v33, a83
    v_mul_f32 v33, v33, v34
    v_accvgpr_write_b32 a83, v33
    v_accvgpr_read_b32 v33, a84
    v_mul_f32 v33, v33, v34
    v_accvgpr_write_b32 a84, v33
    v_accvgpr_read_b32 v33, a85
    v_mul_f32 v33, v33, v34
    v_accvgpr_write_b32 a85, v33
    v_accvgpr_read_b32 v33, a86
    v_mul_f32 v33, v33, v34
    v_accvgpr_write_b32 a86, v33
    v_accvgpr_read_b32 v33, a87
    v_mul_f32 v33, v33, v34
    v_accvgpr_write_b32 a87, v33
    v_accvgpr_read_b32 v33, a88
    v_mul_f32 v33, v33, v34
    v_accvgpr_write_b32 a88, v33
    v_accvgpr_read_b32 v33, a89
    v_mul_f32 v33, v33, v34
    v_accvgpr_write_b32 a89, v33
    v_accvgpr_read_b32 v33, a90
    v_mul_f32 v33, v33, v34
    v_accvgpr_write_b32 a90, v33
    v_accvgpr_read_b32 v33, a91
    v_mul_f32 v33, v33, v34
    v_accvgpr_write_b32 a91, v33
    v_accvgpr_read_b32 v33, a92
    v_mul_f32 v33, v33, v34
    v_accvgpr_write_b32 a92, v33
    v_accvgpr_read_b32 v33, a93
    v_mul_f32 v33, v33, v34
    v_accvgpr_write_b32 a93, v33
    v_accvgpr_read_b32 v33, a94
    v_mul_f32 v33, v33, v34
    v_accvgpr_write_b32 a94, v33
    v_accvgpr_read_b32 v33, a95
    v_mul_f32 v33, v33, v34
    v_accvgpr_write_b32 a95, v33
    v_exp_f32 v36, v192
    v_exp_f32 v37, v193
    s_nop 0
    v_cvt_pk_bf16_f32 v232, v36, v37
    v_exp_f32 v36, v194
    v_exp_f32 v37, v195
    s_nop 0
    v_cvt_pk_bf16_f32 v233, v36, v37
    v_exp_f32 v36, v196
    v_exp_f32 v37, v197
    s_nop 0
    v_cvt_pk_bf16_f32 v234, v36, v37
    v_exp_f32 v36, v198
    v_exp_f32 v37, v199
    s_nop 0
    v_cvt_pk_bf16_f32 v235, v36, v37
    v_max3_f32 v32, v200, v201, v202
    v_max3_f32 v32, v203, v204, v32
    v_max3_f32 v32, v205, v206, v32
    v_max_f32 v32, v207, v32
    v_mov_b32 v33, v32
    s_nop 1
    v_permlane16_swap_b32 v32, v33
    s_nop 1
    v_max_f32 v32, v32, v33
    v_mov_b32 v33, v32
    s_nop 1
    v_permlane32_swap_b32 v32, v33
    s_nop 1
    v_max_f32 v32, v32, v33
    v_add_f32 v32, 0x41c00000, v32
    v_max_f32 v32, 0, v32
    v_exp_f32 v34, -v32
    v_sub_f32 v76, v76, v32
    v_sub_f32 v77, v77, v32
    v_sub_f32 v78, v78, v32
    v_sub_f32 v79, v79, v32
    v_sub_f32 v200, v200, v32
    v_sub_f32 v201, v201, v32
    v_sub_f32 v202, v202, v32
    v_sub_f32 v203, v203, v32
    v_sub_f32 v204, v204, v32
    v_sub_f32 v205, v205, v32
    v_sub_f32 v206, v206, v32
    v_sub_f32 v207, v207, v32
    v_sub_f32 v168, v168, v32
    v_sub_f32 v169, v169, v32
    v_sub_f32 v170, v170, v32
    v_sub_f32 v171, v171, v32
    v_sub_f32 v172, v172, v32
    v_sub_f32 v173, v173, v32
    v_sub_f32 v174, v174, v32
    v_sub_f32 v175, v175, v32
    v_mul_f32 v252, v252, v34
    v_mul_f32 v253, v253, v34
    v_mul_f32 v254, v254, v34
    v_mul_f32 v255, v255, v34
    v_accvgpr_read_b32 v33, a96
    v_mul_f32 v33, v33, v34
    v_accvgpr_write_b32 a96, v33
    v_accvgpr_read_b32 v33, a97
    v_mul_f32 v33, v33, v34
    v_accvgpr_write_b32 a97, v33
    v_accvgpr_read_b32 v33, a98
    v_mul_f32 v33, v33, v34
    v_accvgpr_write_b32 a98, v33
    v_accvgpr_read_b32 v33, a99
    v_mul_f32 v33, v33, v34
    v_accvgpr_write_b32 a99, v33
    v_accvgpr_read_b32 v33, a100
    v_mul_f32 v33, v33, v34
    v_accvgpr_write_b32 a100, v33
    v_accvgpr_read_b32 v33, a101
    v_mul_f32 v33, v33, v34
    v_accvgpr_write_b32 a101, v33
    v_accvgpr_read_b32 v33, a102
    v_mul_f32 v33, v33, v34
    v_accvgpr_write_b32 a102, v33
    v_accvgpr_read_b32 v33, a103
    v_mul_f32 v33, v33, v34
    v_accvgpr_write_b32 a103, v33
    v_accvgpr_read_b32 v33, a104
    v_mul_f32 v33, v33, v34
    v_accvgpr_write_b32 a104, v33
    v_accvgpr_read_b32 v33, a105
    v_mul_f32 v33, v33, v34
    v_accvgpr_write_b32 a105, v33
    v_accvgpr_read_b32 v33, a106
    v_mul_f32 v33, v33, v34
    v_accvgpr_write_b32 a106, v33
    v_accvgpr_read_b32 v33, a107
    v_mul_f32 v33, v33, v34
    v_accvgpr_write_b32 a107, v33
    v_accvgpr_read_b32 v33, a108
    v_mul_f32 v33, v33, v34
    v_accvgpr_write_b32 a108, v33
    v_accvgpr_read_b32 v33, a109
    v_mul_f32 v33, v33, v34
    v_accvgpr_write_b32 a109, v33
    v_accvgpr_read_b32 v33, a110
    v_mul_f32 v33, v33, v34
    v_accvgpr_write_b32 a110, v33
    v_accvgpr_read_b32 v33, a111
    v_mul_f32 v33, v33, v34
    v_accvgpr_write_b32 a111, v33
    v_accvgpr_read_b32 v33, a112
    v_mul_f32 v33, v33, v34
    v_accvgpr_write_b32 a112, v33
    v_accvgpr_read_b32 v33, a113
    v_mul_f32 v33, v33, v34
    v_accvgpr_write_b32 a113, v33
    v_accvgpr_read_b32 v33, a114
    v_mul_f32 v33, v33, v34
    v_accvgpr_write_b32 a114, v33
    v_accvgpr_read_b32 v33, a115
    v_mul_f32 v33, v33, v34
    v_accvgpr_write_b32 a115, v33
    v_accvgpr_read_b32 v33, a116
    v_mul_f32 v33, v33, v34
    v_accvgpr_write_b32 a116, v33
    v_accvgpr_read_b32 v33, a117
    v_mul_f32 v33, v33, v34
    v_accvgpr_write_b32 a117, v33
    v_accvgpr_read_b32 v33, a118
    v_mul_f32 v33, v33, v34
    v_accvgpr_write_b32 a118, v33
    v_accvgpr_read_b32 v33, a119
    v_mul_f32 v33, v33, v34
    v_accvgpr_write_b32 a119, v33
    v_accvgpr_read_b32 v33, a120
    v_mul_f32 v33, v33, v34
    v_accvgpr_write_b32 a120, v33
    v_accvgpr_read_b32 v33, a121
    v_mul_f32 v33, v33, v34
    v_accvgpr_write_b32 a121, v33
    v_accvgpr_read_b32 v33, a122
    v_mul_f32 v33, v33, v34
    v_accvgpr_write_b32 a122, v33
    v_accvgpr_read_b32 v33, a123
    v_mul_f32 v33, v33, v34
    v_accvgpr_write_b32 a123, v33
    v_accvgpr_read_b32 v33, a124
    v_mul_f32 v33, v33, v34
    v_accvgpr_write_b32 a124, v33
    v_accvgpr_read_b32 v33, a125
    v_mul_f32 v33, v33, v34
    v_accvgpr_write_b32 a125, v33
    v_accvgpr_read_b32 v33, a126
    v_mul_f32 v33, v33, v34
    v_accvgpr_write_b32 a126, v33
    v_accvgpr_read_b32 v33, a127
    v_mul_f32 v33, v33, v34
    v_accvgpr_write_b32 a127, v33
    v_exp_f32 v36, v200
    v_exp_f32 v37, v201
    s_nop 0
    v_cvt_pk_bf16_f32 v236, v36, v37
    v_exp_f32 v36, v202
    v_exp_f32 v37, v203
    s_nop 0
    v_cvt_pk_bf16_f32 v237, v36, v37
    v_exp_f32 v36, v204
    v_exp_f32 v37, v205
    s_nop 0
    v_cvt_pk_bf16_f32 v238, v36, v37
    v_exp_f32 v36, v206
    v_exp_f32 v37, v207
    s_nop 0
    v_cvt_pk_bf16_f32 v239, v36, v37
    s_nop 1
    s_branch gated_mix__ssm_conv_h3__compressed_kv_cla__prompt_kernel_b3_r1_ret
gated_mix__ssm_conv_h3__compressed_kv_cla__prompt_kernel_b2_r0:
    s_nop 7
    v_max3_f32 v32, v160, v161, v162
    v_max3_f32 v32, v163, v164, v32
    v_max3_f32 v32, v165, v166, v32
    v_max_f32 v32, v167, v32
    v_mov_b32 v33, v32
    s_nop 1
    v_permlane16_swap_b32 v32, v33
    s_nop 1
    v_max_f32 v32, v32, v33
    v_mov_b32 v33, v32
    s_nop 1
    v_permlane32_swap_b32 v32, v33
    s_nop 1
    v_max_f32 v32, v32, v33
    v_add_f32 v32, 0x41c00000, v32
    v_max_f32 v32, 0, v32
    v_exp_f32 v34, -v32
    v_sub_f32 v72, v72, v32
    v_sub_f32 v73, v73, v32
    v_sub_f32 v74, v74, v32
    v_sub_f32 v75, v75, v32
    v_sub_f32 v160, v160, v32
    v_sub_f32 v161, v161, v32
    v_sub_f32 v162, v162, v32
    v_sub_f32 v163, v163, v32
    v_sub_f32 v164, v164, v32
    v_sub_f32 v165, v165, v32
    v_sub_f32 v166, v166, v32
    v_sub_f32 v167, v167, v32
    v_sub_f32 v192, v192, v32
    v_sub_f32 v193, v193, v32
    v_sub_f32 v194, v194, v32
    v_sub_f32 v195, v195, v32
    v_sub_f32 v196, v196, v32
    v_sub_f32 v197, v197, v32
    v_sub_f32 v198, v198, v32
    v_sub_f32 v199, v199, v32
    v_mul_f32 v248, v248, v34
    v_mul_f32 v249, v249, v34
    v_mul_f32 v250, v250, v34
    v_mul_f32 v251, v251, v34
    v_accvgpr_read_b32 v33, a64
    v_mul_f32 v33, v33, v34
    v_accvgpr_write_b32 a64, v33
    v_accvgpr_read_b32 v33, a65
    v_mul_f32 v33, v33, v34
    v_accvgpr_write_b32 a65, v33
    v_accvgpr_read_b32 v33, a66
    v_mul_f32 v33, v33, v34
    v_accvgpr_write_b32 a66, v33
    v_accvgpr_read_b32 v33, a67
    v_mul_f32 v33, v33, v34
    v_accvgpr_write_b32 a67, v33
    v_accvgpr_read_b32 v33, a68
    v_mul_f32 v33, v33, v34
    v_accvgpr_write_b32 a68, v33
    v_accvgpr_read_b32 v33, a69
    v_mul_f32 v33, v33, v34
    v_accvgpr_write_b32 a69, v33
    v_accvgpr_read_b32 v33, a70
    v_mul_f32 v33, v33, v34
    v_accvgpr_write_b32 a70, v33
    v_accvgpr_read_b32 v33, a71
    v_mul_f32 v33, v33, v34
    v_accvgpr_write_b32 a71, v33
    v_accvgpr_read_b32 v33, a72
    v_mul_f32 v33, v33, v34
    v_accvgpr_write_b32 a72, v33
    v_accvgpr_read_b32 v33, a73
    v_mul_f32 v33, v33, v34
    v_accvgpr_write_b32 a73, v33
    v_accvgpr_read_b32 v33, a74
    v_mul_f32 v33, v33, v34
    v_accvgpr_write_b32 a74, v33
    v_accvgpr_read_b32 v33, a75
    v_mul_f32 v33, v33, v34
    v_accvgpr_write_b32 a75, v33
    v_accvgpr_read_b32 v33, a76
    v_mul_f32 v33, v33, v34
    v_accvgpr_write_b32 a76, v33
    v_accvgpr_read_b32 v33, a77
    v_mul_f32 v33, v33, v34
    v_accvgpr_write_b32 a77, v33
    v_accvgpr_read_b32 v33, a78
    v_mul_f32 v33, v33, v34
    v_accvgpr_write_b32 a78, v33
    v_accvgpr_read_b32 v33, a79
    v_mul_f32 v33, v33, v34
    v_accvgpr_write_b32 a79, v33
    v_accvgpr_read_b32 v33, a80
    v_mul_f32 v33, v33, v34
    v_accvgpr_write_b32 a80, v33
    v_accvgpr_read_b32 v33, a81
    v_mul_f32 v33, v33, v34
    v_accvgpr_write_b32 a81, v33
    v_accvgpr_read_b32 v33, a82
    v_mul_f32 v33, v33, v34
    v_accvgpr_write_b32 a82, v33
    v_accvgpr_read_b32 v33, a83
    v_mul_f32 v33, v33, v34
    v_accvgpr_write_b32 a83, v33
    v_accvgpr_read_b32 v33, a84
    v_mul_f32 v33, v33, v34
    v_accvgpr_write_b32 a84, v33
    v_accvgpr_read_b32 v33, a85
    v_mul_f32 v33, v33, v34
    v_accvgpr_write_b32 a85, v33
    v_accvgpr_read_b32 v33, a86
    v_mul_f32 v33, v33, v34
    v_accvgpr_write_b32 a86, v33
    v_accvgpr_read_b32 v33, a87
    v_mul_f32 v33, v33, v34
    v_accvgpr_write_b32 a87, v33
    v_accvgpr_read_b32 v33, a88
    v_mul_f32 v33, v33, v34
    v_accvgpr_write_b32 a88, v33
    v_accvgpr_read_b32 v33, a89
    v_mul_f32 v33, v33, v34
    v_accvgpr_write_b32 a89, v33
    v_accvgpr_read_b32 v33, a90
    v_mul_f32 v33, v33, v34
    v_accvgpr_write_b32 a90, v33
    v_accvgpr_read_b32 v33, a91
    v_mul_f32 v33, v33, v34
    v_accvgpr_write_b32 a91, v33
    v_accvgpr_read_b32 v33, a92
    v_mul_f32 v33, v33, v34
    v_accvgpr_write_b32 a92, v33
    v_accvgpr_read_b32 v33, a93
    v_mul_f32 v33, v33, v34
    v_accvgpr_write_b32 a93, v33
    v_accvgpr_read_b32 v33, a94
    v_mul_f32 v33, v33, v34
    v_accvgpr_write_b32 a94, v33
    v_accvgpr_read_b32 v33, a95
    v_mul_f32 v33, v33, v34
    v_accvgpr_write_b32 a95, v33
    v_exp_f32 v36, v160
    v_exp_f32 v37, v161
    s_nop 0
    v_cvt_pk_bf16_f32 v216, v36, v37
    v_exp_f32 v36, v162
    v_exp_f32 v37, v163
    s_nop 0
    v_cvt_pk_bf16_f32 v217, v36, v37
    v_exp_f32 v36, v164
    v_exp_f32 v37, v165
    s_nop 0
    v_cvt_pk_bf16_f32 v218, v36, v37
    v_exp_f32 v36, v166
    v_exp_f32 v37, v167
    s_nop 0
    v_cvt_pk_bf16_f32 v219, v36, v37
    v_max3_f32 v32, v168, v169, v170
    v_max3_f32 v32, v171, v172, v32
    v_max3_f32 v32, v173, v174, v32
    v_max_f32 v32, v175, v32
    v_mov_b32 v33, v32
    s_nop 1
    v_permlane16_swap_b32 v32, v33
    s_nop 1
    v_max_f32 v32, v32, v33
    v_mov_b32 v33, v32
    s_nop 1
    v_permlane32_swap_b32 v32, v33
    s_nop 1
    v_max_f32 v32, v32, v33
    v_add_f32 v32, 0x41c00000, v32
    v_max_f32 v32, 0, v32
    v_exp_f32 v34, -v32
    v_sub_f32 v76, v76, v32
    v_sub_f32 v77, v77, v32
    v_sub_f32 v78, v78, v32
    v_sub_f32 v79, v79, v32
    v_sub_f32 v168, v168, v32
    v_sub_f32 v169, v169, v32
    v_sub_f32 v170, v170, v32
    v_sub_f32 v171, v171, v32
    v_sub_f32 v172, v172, v32
    v_sub_f32 v173, v173, v32
    v_sub_f32 v174, v174, v32
    v_sub_f32 v175, v175, v32
    v_sub_f32 v200, v200, v32
    v_sub_f32 v201, v201, v32
    v_sub_f32 v202, v202, v32
    v_sub_f32 v203, v203, v32
    v_sub_f32 v204, v204, v32
    v_sub_f32 v205, v205, v32
    v_sub_f32 v206, v206, v32
    v_sub_f32 v207, v207, v32
    v_mul_f32 v252, v252, v34
    v_mul_f32 v253, v253, v34
    v_mul_f32 v254, v254, v34
    v_mul_f32 v255, v255, v34
    v_accvgpr_read_b32 v33, a96
    v_mul_f32 v33, v33, v34
    v_accvgpr_write_b32 a96, v33
    v_accvgpr_read_b32 v33, a97
    v_mul_f32 v33, v33, v34
    v_accvgpr_write_b32 a97, v33
    v_accvgpr_read_b32 v33, a98
    v_mul_f32 v33, v33, v34
    v_accvgpr_write_b32 a98, v33
    v_accvgpr_read_b32 v33, a99
    v_mul_f32 v33, v33, v34
    v_accvgpr_write_b32 a99, v33
    v_accvgpr_read_b32 v33, a100
    v_mul_f32 v33, v33, v34
    v_accvgpr_write_b32 a100, v33
    v_accvgpr_read_b32 v33, a101
    v_mul_f32 v33, v33, v34
    v_accvgpr_write_b32 a101, v33
    v_accvgpr_read_b32 v33, a102
    v_mul_f32 v33, v33, v34
    v_accvgpr_write_b32 a102, v33
    v_accvgpr_read_b32 v33, a103
    v_mul_f32 v33, v33, v34
    v_accvgpr_write_b32 a103, v33
    v_accvgpr_read_b32 v33, a104
    v_mul_f32 v33, v33, v34
    v_accvgpr_write_b32 a104, v33
    v_accvgpr_read_b32 v33, a105
    v_mul_f32 v33, v33, v34
    v_accvgpr_write_b32 a105, v33
    v_accvgpr_read_b32 v33, a106
    v_mul_f32 v33, v33, v34
    v_accvgpr_write_b32 a106, v33
    v_accvgpr_read_b32 v33, a107
    v_mul_f32 v33, v33, v34
    v_accvgpr_write_b32 a107, v33
    v_accvgpr_read_b32 v33, a108
    v_mul_f32 v33, v33, v34
    v_accvgpr_write_b32 a108, v33
    v_accvgpr_read_b32 v33, a109
    v_mul_f32 v33, v33, v34
    v_accvgpr_write_b32 a109, v33
    v_accvgpr_read_b32 v33, a110
    v_mul_f32 v33, v33, v34
    v_accvgpr_write_b32 a110, v33
    v_accvgpr_read_b32 v33, a111
    v_mul_f32 v33, v33, v34
    v_accvgpr_write_b32 a111, v33
    v_accvgpr_read_b32 v33, a112
    v_mul_f32 v33, v33, v34
    v_accvgpr_write_b32 a112, v33
    v_accvgpr_read_b32 v33, a113
    v_mul_f32 v33, v33, v34
    v_accvgpr_write_b32 a113, v33
    v_accvgpr_read_b32 v33, a114
    v_mul_f32 v33, v33, v34
    v_accvgpr_write_b32 a114, v33
    v_accvgpr_read_b32 v33, a115
    v_mul_f32 v33, v33, v34
    v_accvgpr_write_b32 a115, v33
    v_accvgpr_read_b32 v33, a116
    v_mul_f32 v33, v33, v34
    v_accvgpr_write_b32 a116, v33
    v_accvgpr_read_b32 v33, a117
    v_mul_f32 v33, v33, v34
    v_accvgpr_write_b32 a117, v33
    v_accvgpr_read_b32 v33, a118
    v_mul_f32 v33, v33, v34
    v_accvgpr_write_b32 a118, v33
    v_accvgpr_read_b32 v33, a119
    v_mul_f32 v33, v33, v34
    v_accvgpr_write_b32 a119, v33
    v_accvgpr_read_b32 v33, a120
    v_mul_f32 v33, v33, v34
    v_accvgpr_write_b32 a120, v33
    v_accvgpr_read_b32 v33, a121
    v_mul_f32 v33, v33, v34
    v_accvgpr_write_b32 a121, v33
    v_accvgpr_read_b32 v33, a122
    v_mul_f32 v33, v33, v34
    v_accvgpr_write_b32 a122, v33
    v_accvgpr_read_b32 v33, a123
    v_mul_f32 v33, v33, v34
    v_accvgpr_write_b32 a123, v33
    v_accvgpr_read_b32 v33, a124
    v_mul_f32 v33, v33, v34
    v_accvgpr_write_b32 a124, v33
    v_accvgpr_read_b32 v33, a125
    v_mul_f32 v33, v33, v34
    v_accvgpr_write_b32 a125, v33
    v_accvgpr_read_b32 v33, a126
    v_mul_f32 v33, v33, v34
    v_accvgpr_write_b32 a126, v33
    v_accvgpr_read_b32 v33, a127
    v_mul_f32 v33, v33, v34
    v_accvgpr_write_b32 a127, v33
    v_exp_f32 v36, v168
    v_exp_f32 v37, v169
    s_nop 0
    v_cvt_pk_bf16_f32 v220, v36, v37
    v_exp_f32 v36, v170
    v_exp_f32 v37, v171
    s_nop 0
    v_cvt_pk_bf16_f32 v221, v36, v37
    v_exp_f32 v36, v172
    v_exp_f32 v37, v173
    s_nop 0
    v_cvt_pk_bf16_f32 v222, v36, v37
    v_exp_f32 v36, v174
    v_exp_f32 v37, v175
    s_nop 0
    v_cvt_pk_bf16_f32 v223, v36, v37
    s_nop 1
    s_branch gated_mix__ssm_conv_h3__compressed_kv_cla__prompt_kernel_b2_r0_ret
gated_mix__ssm_conv_h3__compressed_kv_cla__prompt_kernel_b2_r1:
    s_nop 7
    v_max3_f32 v32, v192, v193, v194
    v_max3_f32 v32, v195, v196, v32
    v_max3_f32 v32, v197, v198, v32
    v_max_f32 v32, v199, v32
    v_mov_b32 v33, v32
    s_nop 1
    v_permlane16_swap_b32 v32, v33
    s_nop 1
    v_max_f32 v32, v32, v33
    v_mov_b32 v33, v32
    s_nop 1
    v_permlane32_swap_b32 v32, v33
    s_nop 1
    v_max_f32 v32, v32, v33
    v_add_f32 v32, 0x41c00000, v32
    v_max_f32 v32, 0, v32
    v_exp_f32 v34, -v32
    v_sub_f32 v72, v72, v32
    v_sub_f32 v73, v73, v32
    v_sub_f32 v74, v74, v32
    v_sub_f32 v75, v75, v32
    v_sub_f32 v192, v192, v32
    v_sub_f32 v193, v193, v32
    v_sub_f32 v194, v194, v32
    v_sub_f32 v195, v195, v32
    v_sub_f32 v196, v196, v32
    v_sub_f32 v197, v197, v32
    v_sub_f32 v198, v198, v32
    v_sub_f32 v199, v199, v32
    v_sub_f32 v160, v160, v32
    v_sub_f32 v161, v161, v32
    v_sub_f32 v162, v162, v32
    v_sub_f32 v163, v163, v32
    v_sub_f32 v164, v164, v32
    v_sub_f32 v165, v165, v32
    v_sub_f32 v166, v166, v32
    v_sub_f32 v167, v167, v32
    v_mul_f32 v248, v248, v34
    v_mul_f32 v249, v249, v34
    v_mul_f32 v250, v250, v34
    v_mul_f32 v251, v251, v34
    v_accvgpr_read_b32 v33, a64
    v_mul_f32 v33, v33, v34
    v_accvgpr_write_b32 a64, v33
    v_accvgpr_read_b32 v33, a65
    v_mul_f32 v33, v33, v34
    v_accvgpr_write_b32 a65, v33
    v_accvgpr_read_b32 v33, a66
    v_mul_f32 v33, v33, v34
    v_accvgpr_write_b32 a66, v33
    v_accvgpr_read_b32 v33, a67
    v_mul_f32 v33, v33, v34
    v_accvgpr_write_b32 a67, v33
    v_accvgpr_read_b32 v33, a68
    v_mul_f32 v33, v33, v34
    v_accvgpr_write_b32 a68, v33
    v_accvgpr_read_b32 v33, a69
    v_mul_f32 v33, v33, v34
    v_accvgpr_write_b32 a69, v33
    v_accvgpr_read_b32 v33, a70
    v_mul_f32 v33, v33, v34
    v_accvgpr_write_b32 a70, v33
    v_accvgpr_read_b32 v33, a71
    v_mul_f32 v33, v33, v34
    v_accvgpr_write_b32 a71, v33
    v_accvgpr_read_b32 v33, a72
    v_mul_f32 v33, v33, v34
    v_accvgpr_write_b32 a72, v33
    v_accvgpr_read_b32 v33, a73
    v_mul_f32 v33, v33, v34
    v_accvgpr_write_b32 a73, v33
    v_accvgpr_read_b32 v33, a74
    v_mul_f32 v33, v33, v34
    v_accvgpr_write_b32 a74, v33
    v_accvgpr_read_b32 v33, a75
    v_mul_f32 v33, v33, v34
    v_accvgpr_write_b32 a75, v33
    v_accvgpr_read_b32 v33, a76
    v_mul_f32 v33, v33, v34
    v_accvgpr_write_b32 a76, v33
    v_accvgpr_read_b32 v33, a77
    v_mul_f32 v33, v33, v34
    v_accvgpr_write_b32 a77, v33
    v_accvgpr_read_b32 v33, a78
    v_mul_f32 v33, v33, v34
    v_accvgpr_write_b32 a78, v33
    v_accvgpr_read_b32 v33, a79
    v_mul_f32 v33, v33, v34
    v_accvgpr_write_b32 a79, v33
    v_accvgpr_read_b32 v33, a80
    v_mul_f32 v33, v33, v34
    v_accvgpr_write_b32 a80, v33
    v_accvgpr_read_b32 v33, a81
    v_mul_f32 v33, v33, v34
    v_accvgpr_write_b32 a81, v33
    v_accvgpr_read_b32 v33, a82
    v_mul_f32 v33, v33, v34
    v_accvgpr_write_b32 a82, v33
    v_accvgpr_read_b32 v33, a83
    v_mul_f32 v33, v33, v34
    v_accvgpr_write_b32 a83, v33
    v_accvgpr_read_b32 v33, a84
    v_mul_f32 v33, v33, v34
    v_accvgpr_write_b32 a84, v33
    v_accvgpr_read_b32 v33, a85
    v_mul_f32 v33, v33, v34
    v_accvgpr_write_b32 a85, v33
    v_accvgpr_read_b32 v33, a86
    v_mul_f32 v33, v33, v34
    v_accvgpr_write_b32 a86, v33
    v_accvgpr_read_b32 v33, a87
    v_mul_f32 v33, v33, v34
    v_accvgpr_write_b32 a87, v33
    v_accvgpr_read_b32 v33, a88
    v_mul_f32 v33, v33, v34
    v_accvgpr_write_b32 a88, v33
    v_accvgpr_read_b32 v33, a89
    v_mul_f32 v33, v33, v34
    v_accvgpr_write_b32 a89, v33
    v_accvgpr_read_b32 v33, a90
    v_mul_f32 v33, v33, v34
    v_accvgpr_write_b32 a90, v33
    v_accvgpr_read_b32 v33, a91
    v_mul_f32 v33, v33, v34
    v_accvgpr_write_b32 a91, v33
    v_accvgpr_read_b32 v33, a92
    v_mul_f32 v33, v33, v34
    v_accvgpr_write_b32 a92, v33
    v_accvgpr_read_b32 v33, a93
    v_mul_f32 v33, v33, v34
    v_accvgpr_write_b32 a93, v33
    v_accvgpr_read_b32 v33, a94
    v_mul_f32 v33, v33, v34
    v_accvgpr_write_b32 a94, v33
    v_accvgpr_read_b32 v33, a95
    v_mul_f32 v33, v33, v34
    v_accvgpr_write_b32 a95, v33
    v_exp_f32 v36, v192
    v_exp_f32 v37, v193
    s_nop 0
    v_cvt_pk_bf16_f32 v232, v36, v37
    v_exp_f32 v36, v194
    v_exp_f32 v37, v195
    s_nop 0
    v_cvt_pk_bf16_f32 v233, v36, v37
    v_exp_f32 v36, v196
    v_exp_f32 v37, v197
    s_nop 0
    v_cvt_pk_bf16_f32 v234, v36, v37
    v_exp_f32 v36, v198
    v_exp_f32 v37, v199
    s_nop 0
    v_cvt_pk_bf16_f32 v235, v36, v37
    v_max3_f32 v32, v200, v201, v202
    v_max3_f32 v32, v203, v204, v32
    v_max3_f32 v32, v205, v206, v32
    v_max_f32 v32, v207, v32
    v_mov_b32 v33, v32
    s_nop 1
    v_permlane16_swap_b32 v32, v33
    s_nop 1
    v_max_f32 v32, v32, v33
    v_mov_b32 v33, v32
    s_nop 1
    v_permlane32_swap_b32 v32, v33
    s_nop 1
    v_max_f32 v32, v32, v33
    v_add_f32 v32, 0x41c00000, v32
    v_max_f32 v32, 0, v32
    v_exp_f32 v34, -v32
    v_sub_f32 v76, v76, v32
    v_sub_f32 v77, v77, v32
    v_sub_f32 v78, v78, v32
    v_sub_f32 v79, v79, v32
    v_sub_f32 v200, v200, v32
    v_sub_f32 v201, v201, v32
    v_sub_f32 v202, v202, v32
    v_sub_f32 v203, v203, v32
    v_sub_f32 v204, v204, v32
    v_sub_f32 v205, v205, v32
    v_sub_f32 v206, v206, v32
    v_sub_f32 v207, v207, v32
    v_sub_f32 v168, v168, v32
    v_sub_f32 v169, v169, v32
    v_sub_f32 v170, v170, v32
    v_sub_f32 v171, v171, v32
    v_sub_f32 v172, v172, v32
    v_sub_f32 v173, v173, v32
    v_sub_f32 v174, v174, v32
    v_sub_f32 v175, v175, v32
    v_mul_f32 v252, v252, v34
    v_mul_f32 v253, v253, v34
    v_mul_f32 v254, v254, v34
    v_mul_f32 v255, v255, v34
    v_accvgpr_read_b32 v33, a96
    v_mul_f32 v33, v33, v34
    v_accvgpr_write_b32 a96, v33
    v_accvgpr_read_b32 v33, a97
    v_mul_f32 v33, v33, v34
    v_accvgpr_write_b32 a97, v33
    v_accvgpr_read_b32 v33, a98
    v_mul_f32 v33, v33, v34
    v_accvgpr_write_b32 a98, v33
    v_accvgpr_read_b32 v33, a99
    v_mul_f32 v33, v33, v34
    v_accvgpr_write_b32 a99, v33
    v_accvgpr_read_b32 v33, a100
    v_mul_f32 v33, v33, v34
    v_accvgpr_write_b32 a100, v33
    v_accvgpr_read_b32 v33, a101
    v_mul_f32 v33, v33, v34
    v_accvgpr_write_b32 a101, v33
    v_accvgpr_read_b32 v33, a102
    v_mul_f32 v33, v33, v34
    v_accvgpr_write_b32 a102, v33
    v_accvgpr_read_b32 v33, a103
    v_mul_f32 v33, v33, v34
    v_accvgpr_write_b32 a103, v33
    v_accvgpr_read_b32 v33, a104
    v_mul_f32 v33, v33, v34
    v_accvgpr_write_b32 a104, v33
    v_accvgpr_read_b32 v33, a105
    v_mul_f32 v33, v33, v34
    v_accvgpr_write_b32 a105, v33
    v_accvgpr_read_b32 v33, a106
    v_mul_f32 v33, v33, v34
    v_accvgpr_write_b32 a106, v33
    v_accvgpr_read_b32 v33, a107
    v_mul_f32 v33, v33, v34
    v_accvgpr_write_b32 a107, v33
    v_accvgpr_read_b32 v33, a108
    v_mul_f32 v33, v33, v34
    v_accvgpr_write_b32 a108, v33
    v_accvgpr_read_b32 v33, a109
    v_mul_f32 v33, v33, v34
    v_accvgpr_write_b32 a109, v33
    v_accvgpr_read_b32 v33, a110
    v_mul_f32 v33, v33, v34
    v_accvgpr_write_b32 a110, v33
    v_accvgpr_read_b32 v33, a111
    v_mul_f32 v33, v33, v34
    v_accvgpr_write_b32 a111, v33
    v_accvgpr_read_b32 v33, a112
    v_mul_f32 v33, v33, v34
    v_accvgpr_write_b32 a112, v33
    v_accvgpr_read_b32 v33, a113
    v_mul_f32 v33, v33, v34
    v_accvgpr_write_b32 a113, v33
    v_accvgpr_read_b32 v33, a114
    v_mul_f32 v33, v33, v34
    v_accvgpr_write_b32 a114, v33
    v_accvgpr_read_b32 v33, a115
    v_mul_f32 v33, v33, v34
    v_accvgpr_write_b32 a115, v33
    v_accvgpr_read_b32 v33, a116
    v_mul_f32 v33, v33, v34
    v_accvgpr_write_b32 a116, v33
    v_accvgpr_read_b32 v33, a117
    v_mul_f32 v33, v33, v34
    v_accvgpr_write_b32 a117, v33
    v_accvgpr_read_b32 v33, a118
    v_mul_f32 v33, v33, v34
    v_accvgpr_write_b32 a118, v33
    v_accvgpr_read_b32 v33, a119
    v_mul_f32 v33, v33, v34
    v_accvgpr_write_b32 a119, v33
    v_accvgpr_read_b32 v33, a120
    v_mul_f32 v33, v33, v34
    v_accvgpr_write_b32 a120, v33
    v_accvgpr_read_b32 v33, a121
    v_mul_f32 v33, v33, v34
    v_accvgpr_write_b32 a121, v33
    v_accvgpr_read_b32 v33, a122
    v_mul_f32 v33, v33, v34
    v_accvgpr_write_b32 a122, v33
    v_accvgpr_read_b32 v33, a123
    v_mul_f32 v33, v33, v34
    v_accvgpr_write_b32 a123, v33
    v_accvgpr_read_b32 v33, a124
    v_mul_f32 v33, v33, v34
    v_accvgpr_write_b32 a124, v33
    v_accvgpr_read_b32 v33, a125
    v_mul_f32 v33, v33, v34
    v_accvgpr_write_b32 a125, v33
    v_accvgpr_read_b32 v33, a126
    v_mul_f32 v33, v33, v34
    v_accvgpr_write_b32 a126, v33
    v_accvgpr_read_b32 v33, a127
    v_mul_f32 v33, v33, v34
    v_accvgpr_write_b32 a127, v33
    v_exp_f32 v36, v200
    v_exp_f32 v37, v201
    s_nop 0
    v_cvt_pk_bf16_f32 v236, v36, v37
    v_exp_f32 v36, v202
    v_exp_f32 v37, v203
    s_nop 0
    v_cvt_pk_bf16_f32 v237, v36, v37
    v_exp_f32 v36, v204
    v_exp_f32 v37, v205
    s_nop 0
    v_cvt_pk_bf16_f32 v238, v36, v37
    v_exp_f32 v36, v206
    v_exp_f32 v37, v207
    s_nop 0
    v_cvt_pk_bf16_f32 v239, v36, v37
    s_nop 1
    s_branch gated_mix__ssm_conv_h3__compressed_kv_cla__prompt_kernel_b2_r1_ret
gated_mix__ssm_conv_h3__compressed_kv_cla__prompt_kernel_b1_r0:
    s_nop 7
    v_max3_f32 v32, v168, v169, v170
    v_max3_f32 v32, v171, v172, v32
    v_max3_f32 v32, v173, v174, v32
    v_max_f32 v32, v175, v32
    v_mov_b32 v33, v32
    s_nop 1
    v_permlane16_swap_b32 v32, v33
    s_nop 1
    v_max_f32 v32, v32, v33
    v_mov_b32 v33, v32
    s_nop 1
    v_permlane32_swap_b32 v32, v33
    s_nop 1
    v_max_f32 v32, v32, v33
    v_add_f32 v32, 0x41c00000, v32
    v_max_f32 v32, 0, v32
    v_exp_f32 v34, -v32
    v_sub_f32 v76, v76, v32
    v_sub_f32 v77, v77, v32
    v_sub_f32 v78, v78, v32
    v_sub_f32 v79, v79, v32
    v_sub_f32 v168, v168, v32
    v_sub_f32 v169, v169, v32
    v_sub_f32 v170, v170, v32
    v_sub_f32 v171, v171, v32
    v_sub_f32 v172, v172, v32
    v_sub_f32 v173, v173, v32
    v_sub_f32 v174, v174, v32
    v_sub_f32 v175, v175, v32
    v_sub_f32 v200, v200, v32
    v_sub_f32 v201, v201, v32
    v_sub_f32 v202, v202, v32
    v_sub_f32 v203, v203, v32
    v_sub_f32 v204, v204, v32
    v_sub_f32 v205, v205, v32
    v_sub_f32 v206, v206, v32
    v_sub_f32 v207, v207, v32
    v_mul_f32 v252, v252, v34
    v_mul_f32 v253, v253, v34
    v_mul_f32 v254, v254, v34
    v_mul_f32 v255, v255, v34
    v_accvgpr_read_b32 v33, a96
    v_mul_f32 v33, v33, v34
    v_accvgpr_write_b32 a96, v33
    v_accvgpr_read_b32 v33, a97
    v_mul_f32 v33, v33, v34
    v_accvgpr_write_b32 a97, v33
    v_accvgpr_read_b32 v33, a98
    v_mul_f32 v33, v33, v34
    v_accvgpr_write_b32 a98, v33
    v_accvgpr_read_b32 v33, a99
    v_mul_f32 v33, v33, v34
    v_accvgpr_write_b32 a99, v33
    v_accvgpr_read_b32 v33, a100
    v_mul_f32 v33, v33, v34
    v_accvgpr_write_b32 a100, v33
    v_accvgpr_read_b32 v33, a101
    v_mul_f32 v33, v33, v34
    v_accvgpr_write_b32 a101, v33
    v_accvgpr_read_b32 v33, a102
    v_mul_f32 v33, v33, v34
    v_accvgpr_write_b32 a102, v33
    v_accvgpr_read_b32 v33, a103
    v_mul_f32 v33, v33, v34
    v_accvgpr_write_b32 a103, v33
    v_accvgpr_read_b32 v33, a104
    v_mul_f32 v33, v33, v34
    v_accvgpr_write_b32 a104, v33
    v_accvgpr_read_b32 v33, a105
    v_mul_f32 v33, v33, v34
    v_accvgpr_write_b32 a105, v33
    v_accvgpr_read_b32 v33, a106
    v_mul_f32 v33, v33, v34
    v_accvgpr_write_b32 a106, v33
    v_accvgpr_read_b32 v33, a107
    v_mul_f32 v33, v33, v34
    v_accvgpr_write_b32 a107, v33
    v_accvgpr_read_b32 v33, a108
    v_mul_f32 v33, v33, v34
    v_accvgpr_write_b32 a108, v33
    v_accvgpr_read_b32 v33, a109
    v_mul_f32 v33, v33, v34
    v_accvgpr_write_b32 a109, v33
    v_accvgpr_read_b32 v33, a110
    v_mul_f32 v33, v33, v34
    v_accvgpr_write_b32 a110, v33
    v_accvgpr_read_b32 v33, a111
    v_mul_f32 v33, v33, v34
    v_accvgpr_write_b32 a111, v33
    v_accvgpr_read_b32 v33, a112
    v_mul_f32 v33, v33, v34
    v_accvgpr_write_b32 a112, v33
    v_accvgpr_read_b32 v33, a113
    v_mul_f32 v33, v33, v34
    v_accvgpr_write_b32 a113, v33
    v_accvgpr_read_b32 v33, a114
    v_mul_f32 v33, v33, v34
    v_accvgpr_write_b32 a114, v33
    v_accvgpr_read_b32 v33, a115
    v_mul_f32 v33, v33, v34
    v_accvgpr_write_b32 a115, v33
    v_accvgpr_read_b32 v33, a116
    v_mul_f32 v33, v33, v34
    v_accvgpr_write_b32 a116, v33
    v_accvgpr_read_b32 v33, a117
    v_mul_f32 v33, v33, v34
    v_accvgpr_write_b32 a117, v33
    v_accvgpr_read_b32 v33, a118
    v_mul_f32 v33, v33, v34
    v_accvgpr_write_b32 a118, v33
    v_accvgpr_read_b32 v33, a119
    v_mul_f32 v33, v33, v34
    v_accvgpr_write_b32 a119, v33
    v_accvgpr_read_b32 v33, a120
    v_mul_f32 v33, v33, v34
    v_accvgpr_write_b32 a120, v33
    v_accvgpr_read_b32 v33, a121
    v_mul_f32 v33, v33, v34
    v_accvgpr_write_b32 a121, v33
    v_accvgpr_read_b32 v33, a122
    v_mul_f32 v33, v33, v34
    v_accvgpr_write_b32 a122, v33
    v_accvgpr_read_b32 v33, a123
    v_mul_f32 v33, v33, v34
    v_accvgpr_write_b32 a123, v33
    v_accvgpr_read_b32 v33, a124
    v_mul_f32 v33, v33, v34
    v_accvgpr_write_b32 a124, v33
    v_accvgpr_read_b32 v33, a125
    v_mul_f32 v33, v33, v34
    v_accvgpr_write_b32 a125, v33
    v_accvgpr_read_b32 v33, a126
    v_mul_f32 v33, v33, v34
    v_accvgpr_write_b32 a126, v33
    v_accvgpr_read_b32 v33, a127
    v_mul_f32 v33, v33, v34
    v_accvgpr_write_b32 a127, v33
    v_exp_f32 v36, v168
    v_exp_f32 v37, v169
    s_nop 0
    v_cvt_pk_bf16_f32 v220, v36, v37
    v_exp_f32 v36, v170
    v_exp_f32 v37, v171
    s_nop 0
    v_cvt_pk_bf16_f32 v221, v36, v37
    v_exp_f32 v36, v172
    v_exp_f32 v37, v173
    s_nop 0
    v_cvt_pk_bf16_f32 v222, v36, v37
    v_exp_f32 v36, v174
    v_exp_f32 v37, v175
    s_nop 0
    v_cvt_pk_bf16_f32 v223, v36, v37
    s_nop 1
    s_branch gated_mix__ssm_conv_h3__compressed_kv_cla__prompt_kernel_b1_r0_ret
gated_mix__ssm_conv_h3__compressed_kv_cla__prompt_kernel_b1_r1:
    s_nop 7
    v_max3_f32 v32, v200, v201, v202
    v_max3_f32 v32, v203, v204, v32
    v_max3_f32 v32, v205, v206, v32
    v_max_f32 v32, v207, v32
    v_mov_b32 v33, v32
    s_nop 1
    v_permlane16_swap_b32 v32, v33
    s_nop 1
    v_max_f32 v32, v32, v33
    v_mov_b32 v33, v32
    s_nop 1
    v_permlane32_swap_b32 v32, v33
    s_nop 1
    v_max_f32 v32, v32, v33
    v_add_f32 v32, 0x41c00000, v32
    v_max_f32 v32, 0, v32
    v_exp_f32 v34, -v32
    v_sub_f32 v76, v76, v32
    v_sub_f32 v77, v77, v32
    v_sub_f32 v78, v78, v32
    v_sub_f32 v79, v79, v32
    v_sub_f32 v200, v200, v32
    v_sub_f32 v201, v201, v32
    v_sub_f32 v202, v202, v32
    v_sub_f32 v203, v203, v32
    v_sub_f32 v204, v204, v32
    v_sub_f32 v205, v205, v32
    v_sub_f32 v206, v206, v32
    v_sub_f32 v207, v207, v32
    v_mul_f32 v252, v252, v34
    v_mul_f32 v253, v253, v34
    v_mul_f32 v254, v254, v34
    v_mul_f32 v255, v255, v34
    v_accvgpr_read_b32 v33, a96
    v_mul_f32 v33, v33, v34
    v_accvgpr_write_b32 a96, v33
    v_accvgpr_read_b32 v33, a97
    v_mul_f32 v33, v33, v34
    v_accvgpr_write_b32 a97, v33
    v_accvgpr_read_b32 v33, a98
    v_mul_f32 v33, v33, v34
    v_accvgpr_write_b32 a98, v33
    v_accvgpr_read_b32 v33, a99
    v_mul_f32 v33, v33, v34
    v_accvgpr_write_b32 a99, v33
    v_accvgpr_read_b32 v33, a100
    v_mul_f32 v33, v33, v34
    v_accvgpr_write_b32 a100, v33
    v_accvgpr_read_b32 v33, a101
    v_mul_f32 v33, v33, v34
    v_accvgpr_write_b32 a101, v33
    v_accvgpr_read_b32 v33, a102
    v_mul_f32 v33, v33, v34
    v_accvgpr_write_b32 a102, v33
    v_accvgpr_read_b32 v33, a103
    v_mul_f32 v33, v33, v34
    v_accvgpr_write_b32 a103, v33
    v_accvgpr_read_b32 v33, a104
    v_mul_f32 v33, v33, v34
    v_accvgpr_write_b32 a104, v33
    v_accvgpr_read_b32 v33, a105
    v_mul_f32 v33, v33, v34
    v_accvgpr_write_b32 a105, v33
    v_accvgpr_read_b32 v33, a106
    v_mul_f32 v33, v33, v34
    v_accvgpr_write_b32 a106, v33
    v_accvgpr_read_b32 v33, a107
    v_mul_f32 v33, v33, v34
    v_accvgpr_write_b32 a107, v33
    v_accvgpr_read_b32 v33, a108
    v_mul_f32 v33, v33, v34
    v_accvgpr_write_b32 a108, v33
    v_accvgpr_read_b32 v33, a109
    v_mul_f32 v33, v33, v34
    v_accvgpr_write_b32 a109, v33
    v_accvgpr_read_b32 v33, a110
    v_mul_f32 v33, v33, v34
    v_accvgpr_write_b32 a110, v33
    v_accvgpr_read_b32 v33, a111
    v_mul_f32 v33, v33, v34
    v_accvgpr_write_b32 a111, v33
    v_accvgpr_read_b32 v33, a112
    v_mul_f32 v33, v33, v34
    v_accvgpr_write_b32 a112, v33
    v_accvgpr_read_b32 v33, a113
    v_mul_f32 v33, v33, v34
    v_accvgpr_write_b32 a113, v33
    v_accvgpr_read_b32 v33, a114
    v_mul_f32 v33, v33, v34
    v_accvgpr_write_b32 a114, v33
    v_accvgpr_read_b32 v33, a115
    v_mul_f32 v33, v33, v34
    v_accvgpr_write_b32 a115, v33
    v_accvgpr_read_b32 v33, a116
    v_mul_f32 v33, v33, v34
    v_accvgpr_write_b32 a116, v33
    v_accvgpr_read_b32 v33, a117
    v_mul_f32 v33, v33, v34
    v_accvgpr_write_b32 a117, v33
    v_accvgpr_read_b32 v33, a118
    v_mul_f32 v33, v33, v34
    v_accvgpr_write_b32 a118, v33
    v_accvgpr_read_b32 v33, a119
    v_mul_f32 v33, v33, v34
    v_accvgpr_write_b32 a119, v33
    v_accvgpr_read_b32 v33, a120
    v_mul_f32 v33, v33, v34
    v_accvgpr_write_b32 a120, v33
    v_accvgpr_read_b32 v33, a121
    v_mul_f32 v33, v33, v34
    v_accvgpr_write_b32 a121, v33
    v_accvgpr_read_b32 v33, a122
    v_mul_f32 v33, v33, v34
    v_accvgpr_write_b32 a122, v33
    v_accvgpr_read_b32 v33, a123
    v_mul_f32 v33, v33, v34
    v_accvgpr_write_b32 a123, v33
    v_accvgpr_read_b32 v33, a124
    v_mul_f32 v33, v33, v34
    v_accvgpr_write_b32 a124, v33
    v_accvgpr_read_b32 v33, a125
    v_mul_f32 v33, v33, v34
    v_accvgpr_write_b32 a125, v33
    v_accvgpr_read_b32 v33, a126
    v_mul_f32 v33, v33, v34
    v_accvgpr_write_b32 a126, v33
    v_accvgpr_read_b32 v33, a127
    v_mul_f32 v33, v33, v34
    v_accvgpr_write_b32 a127, v33
    v_exp_f32 v36, v200
    v_exp_f32 v37, v201
    s_nop 0
    v_cvt_pk_bf16_f32 v236, v36, v37
    v_exp_f32 v36, v202
    v_exp_f32 v37, v203
    s_nop 0
    v_cvt_pk_bf16_f32 v237, v36, v37
    v_exp_f32 v36, v204
    v_exp_f32 v37, v205
    s_nop 0
    v_cvt_pk_bf16_f32 v238, v36, v37
    v_exp_f32 v36, v206
    v_exp_f32 v37, v207
    s_nop 0
    v_cvt_pk_bf16_f32 v239, v36, v37
    s_nop 1
    s_branch gated_mix__ssm_conv_h3__compressed_kv_cla__prompt_kernel_b1_r1_ret

.section .rodata,"a"
.p2align 6
.amdhsa_kernel gated_mix__ssm_conv_h3__compressed_kv_cla__prompt_kernel
  .amdhsa_next_free_vgpr 512
  .amdhsa_next_free_sgpr 102
  .amdhsa_accum_offset 256
  .amdhsa_group_segment_fixed_size 0
  .amdhsa_kernarg_size 128
  .amdhsa_user_sgpr_count 2
  .amdhsa_user_sgpr_kernarg_segment_ptr 1
  .amdhsa_system_sgpr_workgroup_id_x 1
  .amdhsa_float_denorm_mode_32 3
.end_amdhsa_kernel
```

```asm
; @launch grid=(256,1,1) block=(256,1,1) lds=163840
.amdgcn_target "amdgcn-amd-amdhsa--gfx950"
.text
.globl gated_mix__ssm_conv_h3__compressed_kv_cla__prompt_kernel
.p2align 8
.type gated_mix__ssm_conv_h3__compressed_kv_cla__prompt_kernel,@function
gated_mix__ssm_conv_h3__compressed_kv_cla__prompt_kernel:
    s_cmp_ge_u32 s2, 256
    s_cbranch_scc1 gated_mix__ssm_conv_h3__compressed_kv_cla__prompt_kernel_end
    s_load_dwordx16 s[64:79], s[0:1], 0
    s_load_dwordx16 s[80:95], s[0:1], 64
    s_getpc_b64 s[4:5]
gated_mix__ssm_conv_h3__compressed_kv_cla__prompt_kernel_pc:
    s_lshr_b32 s6, s2, 3
    s_mul_i32 s6, s6, 24
    v_min_u32 v242, 23, v0
    v_add_u32 v242, s6, v242
    v_lshlrev_b32 v242, 7, v242
    v_min_u32 v242, gated_mix__ssm_conv_h3__compressed_kv_cla__prompt_kernel_hotend-gated_mix__ssm_conv_h3__compressed_kv_cla__prompt_kernel_pc, v242
    global_load_dword v255, v242, s[4:5]
    v_lshrrev_b32 v242, 6, v0
    v_and_b32 v240, 63, v0
    v_readfirstlane_b32 s32, v242
    v_lshlrev_b32 v16, 4, v240
    s_and_b32 s36, s2, 7
    s_lshl_b32 s36, s36, 2
    s_bfe_u32 s33, s2, 0x20003
    s_add_u32 s33, s33, s36
    s_lshr_b32 s34, s2, 5
    v_lshrrev_b32 v242, 3, v240
    v_and_b32 v247, 7, v240
    v_lshrrev_b32 v245, 4, v240
    v_xor_b32 v243, v245, v247
    v_lshlrev_b32 v243, 4, v243
    v_xor_b32 v244, 64, v243
    v_lshl_add_u32 v2, v242, 10, v243
    v_lshl_add_u32 v3, v242, 10, v244
    v_add_u32 v3, 7168, v3
    v_add_u32 v4, 14336, v2
    v_add_u32 v5, 14336, v3
    v_and_b32 v246, 15, v240
    v_lshlrev_b32 v247, 1, v245
    v_xor_b32 v247, v247, v246
    v_lshlrev_b32 v247, 4, v247
    v_lshl_add_u32 v21, v245, 13, v247
    s_and_b32 s36, s32, 1
    s_lshl_b32 s36, s36, 7
    v_xor_b32 v6, s36, v21
    v_add_u32 v7, 31744, v6
    s_lshl_b32 s38, s34, 18
    s_lshl_b32 s36, s32, 16
    s_add_u32 s38, s38, s36
    s_lshl_b32 s39, s33, 8
    s_add_u32 s39, s39, s36
    s_lshl_b32 s42, s32, 13
    s_lshl_b32 s43, s32, 12
    s_add_u32 s43, s43, 98304
    s_waitcnt lgkmcnt(0)
    s_mov_b32 s4, s78
    s_mov_b32 s5, s79
    s_mov_b32 s6, 2097152
    s_mov_b32 s7, 0x00020000
    s_mov_b32 s8, s82
    s_mov_b32 s9, s83
    s_mov_b32 s10, 4194304
    s_mov_b32 s11, 0x00020000
    s_mov_b32 s12, s84
    s_mov_b32 s13, s85
    s_mov_b32 s14, 4194304
    s_mov_b32 s15, 0x00020000
    s_add_u32 s35, s2, s34
    s_and_b32 s35, s35, 7
    s_lshl_b32 s58, s35, 19
    s_lshl_b32 s35, s35, 7
    s_add_u32 s59, s38, 32768
    s_add_u32 s36, s35, 0
    s_and_b32 s36, s36, 1023
    s_add_u32 s36, s36, s38
    s_add_u32 m0, s42, 0
    s_nop 0
    buffer_load_dwordx4 v2, s[4:7], s36 offen offset:0 lds
    buffer_load_dwordx4 v3, s[4:7], s36 offen offset:1024 lds
    buffer_load_dwordx4 v4, s[4:7], s36 offen offset:2048 lds
    buffer_load_dwordx4 v5, s[4:7], s36 offen offset:3072 lds
    s_add_u32 s36, s35, 0
    s_and_b32 s36, s36, 1023
    s_add_u32 s36, s36, s59
    s_add_u32 m0, s42, 4096
    s_nop 0
    buffer_load_dwordx4 v2, s[4:7], s36 offen offset:0 lds
    buffer_load_dwordx4 v3, s[4:7], s36 offen offset:1024 lds
    buffer_load_dwordx4 v4, s[4:7], s36 offen offset:2048 lds
    buffer_load_dwordx4 v5, s[4:7], s36 offen offset:3072 lds
    s_add_u32 s37, s58, 0
    s_and_b32 s37, s37, 4194303
    s_add_u32 s37, s37, s39
    s_add_u32 m0, s43, 0
    s_nop 0
    buffer_load_dwordx4 v6, s[8:11], s37 offen offset:0 lds
    buffer_load_dwordx4 v7, s[8:11], s37 offen offset:1024 lds
    s_add_u32 m0, s43, 2048
    s_nop 0
    buffer_load_dwordx4 v6, s[12:15], s37 offen offset:0 lds
    buffer_load_dwordx4 v7, s[12:15], s37 offen offset:1024 lds
    s_add_u32 s37, s58, 262144
    s_and_b32 s37, s37, 4194303
    s_add_u32 s37, s37, s39
    s_add_u32 m0, s43, 16384
    s_nop 0
    buffer_load_dwordx4 v6, s[8:11], s37 offen offset:0 lds
    buffer_load_dwordx4 v7, s[8:11], s37 offen offset:1024 lds
    s_add_u32 m0, s43, 18432
    s_nop 0
    buffer_load_dwordx4 v6, s[12:15], s37 offen offset:0 lds
    buffer_load_dwordx4 v7, s[12:15], s37 offen offset:1024 lds
    s_add_u32 s36, s35, 128
    s_and_b32 s36, s36, 1023
    s_add_u32 s36, s36, s38
    s_add_u32 m0, s42, 32768
    s_nop 0
    buffer_load_dwordx4 v2, s[4:7], s36 offen offset:0 lds
    buffer_load_dwordx4 v3, s[4:7], s36 offen offset:1024 lds
    buffer_load_dwordx4 v4, s[4:7], s36 offen offset:2048 lds
    buffer_load_dwordx4 v5, s[4:7], s36 offen offset:3072 lds
    v_lshrrev_b32 v247, 1, v246
    v_xor_b32 v247, v245, v247
    v_lshlrev_b32 v247, 4, v247
    v_lshl_add_u32 v247, v246, 7, v247
    s_lshr_b32 s36, s32, 1
    s_lshl_b32 s36, s36, 14
    v_add_u32 v8, s36, v247
    v_xor_b32 v9, 64, v8
    v_add_u32 v14, 65536, v8
    v_add_u32 v15, 65536, v9
    v_add_u32 v23, s42, v247
    v_xor_b32 v24, 64, v23
    v_add_u32 v25, 65536, v23
    v_add_u32 v26, 65536, v24
    v_lshrrev_b32 v247, 2, v246
    v_and_b32 v248, 3, v246
    v_lshlrev_b32 v248, 3, v248
    v_lshl_add_u32 v248, v247, 8, v248
    v_add_u32 v248, 98304, v248
    v_lshl_add_u32 v249, v245, 12, v248
    v_mul_u32_u24 v250, 2176, v245
    v_add_u32 v250, v250, v248
    v_xor_b32 v248, s32, v245
    v_and_b32 v248, 1, v248
    v_lshl_add_u32 v249, v248, 7, v249
    v_xor_b32 v248, 0, v247
    v_lshl_add_u32 v10, v248, 5, v249
    v_lshl_add_u32 v27, v248, 5, v250
    v_xor_b32 v248, 1, v247
    v_lshl_add_u32 v11, v248, 5, v249
    v_lshl_add_u32 v28, v248, 5, v250
    v_xor_b32 v248, 2, v247
    v_lshl_add_u32 v12, v248, 5, v249
    v_lshl_add_u32 v29, v248, 5, v250
    v_xor_b32 v248, 3, v247
    v_lshl_add_u32 v13, v248, 5, v249
    v_lshl_add_u32 v30, v248, 5, v250
    v_lshl_add_u32 v17, v242, 13, v243
    v_lshl_add_u32 v18, v242, 13, v244
    v_add_u32 v18, 64512, v18
    v_add_u32 v19, 129024, v17
    v_add_u32 v20, 129024, v18
    v_add_u32 v22, 31744, v21
    s_lshl_b32 s54, s2, 2
    s_add_u32 s54, s54, s32
    v_lshlrev_b32 v254, 7, v240
    s_lshl_b32 s46, s54, 13
    s_sub_u32 s46, s46, 4194304
    s_cselect_b32 s46, 0x80000000, s46
    s_mov_b32 s20, s80
    s_mov_b32 s21, s81
    s_mov_b32 s22, 8388608
    s_mov_b32 s23, 0x00020000
    s_mov_b32 s24, s64
    s_mov_b32 s25, s65
    s_mov_b32 s26, 4194304
    s_mov_b32 s27, 0x00020000
    s_add_u32 s28, s94, 60817408
    s_addc_u32 s29, s95, 0
    s_mov_b32 s30, 16384
    s_mov_b32 s31, 0x00020000
    s_mov_b32 s49, s39
    s_mul_i32 s50, s32, 2176
    s_add_u32 s50, s50, 98304
    s_lshl_b32 s44, s34, 7
    s_add_u32 s44, s44, s32
    s_lshl_b32 s44, s44, 11
    s_lshl_b32 s37, s34, 1
    s_sub_u32 s45, 15, s37
    s_lshl_b32 s45, s45, 18
    s_add_u32 s45, s45, s44
    s_lshl_b32 s57, s54, 2
    s_add_u32 s57, s57, 8192
    s_lshl_b32 s36, s32, 5
    s_add_u32 s36, s36, s33
    s_lshl_b32 s36, s36, 2
    s_lshl_b32 s37, s34, 9
    s_add_u32 s55, s36, s37
    s_sub_u32 s56, 7680, s37
    s_add_u32 s56, s56, s36
    s_lshl_b32 s36, s34, 3
    s_add_u32 s36, s36, 0
    s_add_u32 s36, s36, s32
    s_lshl_b32 s36, s36, 5
    s_add_u32 s36, s36, s33
    s_lshl_b32 s60, s36, 12
    s_lshl_b32 s36, s34, 3
    s_add_u32 s36, s36, 4
    s_add_u32 s36, s36, s32
    s_lshl_b32 s36, s36, 5
    s_add_u32 s36, s36, s33
    s_lshl_b32 s61, s36, 12
    s_lshl_b32 s36, s34, 3
    s_sub_u32 s36, 120, s36
    s_add_u32 s36, s36, s32
    s_lshl_b32 s36, s36, 5
    s_add_u32 s36, s36, s33
    s_lshl_b32 s62, s36, 12
    s_lshl_b32 s36, s34, 3
    s_sub_u32 s36, 124, s36
    s_add_u32 s36, s36, s32
    s_lshl_b32 s36, s36, 5
    s_add_u32 s36, s36, s33
    s_lshl_b32 s63, s36, 12
    s_lshr_b32 s36, s2, 4
    s_lshl_b32 s36, s36, 4
    s_lshl_b32 s37, s32, 2
    s_add_u32 s36, s36, s37
    s_and_b32 s37, s2, 15
    s_lshl_b32 s37, s37, 6
    v_add_u32 v247, s36, v245
    v_lshl_add_u32 v248, v246, 2, s37
    v_lshlrev_b32 v0, 14, v247
    v_lshl_add_u32 v0, v248, 1, v0
    v_subrev_u32 v1, 6144, v0
    v_lshlrev_b32 v232, 3, v248
    v_lshlrev_b32 v233, 4, v240
    v_mul_u32_u24 v234, 4608, v248
    v_lshlrev_b32 v247, 4, v247
    v_sub_u32 v247, 4080, v247
    v_add_u32 v234, v234, v247
    v_add_u32 v235, s37, v240
    v_mul_u32_u24 v235, 4608, v235
    s_movk_i32 s47, 4096
    s_movk_i32 s48, 8192
    s_movk_i32 s51, 12288
    s_mov_b32 s52, 0xffff0000
    s_lshr_b32 s37, s2, 4
    s_or_b32 s37, s37, s32
    s_cmp_eq_u32 s37, 0
    s_cselect_b32 s53, s47, 0x80000000
    s_lshl_b32 s36, s33, 13
    s_add_u32 s40, s44, s36
    s_add_u32 s41, s45, s36
    s_branch gated_mix__ssm_conv_h3__compressed_kv_cla__prompt_kernel_body
.p2align 12
gated_mix__ssm_conv_h3__compressed_kv_cla__prompt_kernel_body:
    s_waitcnt vmcnt(8)
    s_barrier
    ds_read_b64_tr_b16 v[64:65], v10 offset:0
    ds_read_b64_tr_b16 v[66:67], v10 offset:1024
    ds_read_b64_tr_b16 v[68:69], v11 offset:0
    ds_read_b64_tr_b16 v[70:71], v11 offset:1024
    ds_read_b128 v[32:35], v8 offset:0
    ds_read_b64_tr_b16 v[72:73], v12 offset:0
    ds_read_b64_tr_b16 v[74:75], v12 offset:1024
    ds_read_b128 v[36:39], v8 offset:2048
    ds_read_b64_tr_b16 v[76:77], v13 offset:0
    ds_read_b64_tr_b16 v[78:79], v13 offset:1024
    ds_read_b128 v[40:43], v8 offset:4096
    ds_read_b64_tr_b16 v[80:81], v10 offset:2048
    ds_read_b64_tr_b16 v[82:83], v10 offset:3072
    ds_read_b128 v[44:47], v8 offset:6144
    ds_read_b64_tr_b16 v[84:85], v11 offset:2048
    ds_read_b64_tr_b16 v[86:87], v11 offset:3072
    ds_read_b128 v[48:51], v8 offset:8192
    ds_read_b64_tr_b16 v[88:89], v12 offset:2048
    ds_read_b64_tr_b16 v[90:91], v12 offset:3072
    ds_read_b128 v[52:55], v8 offset:10240
    ds_read_b64_tr_b16 v[92:93], v13 offset:2048
    ds_read_b64_tr_b16 v[94:95], v13 offset:3072
    ds_read_b128 v[56:59], v8 offset:12288
    ds_read_b128 v[60:63], v8 offset:14336
    s_waitcnt lgkmcnt(0)
    v_mfma_f32_16x16x32_bf16 a[0:3], v[64:67], v[32:35], 0
    ds_read_b128 v[96:99], v9 offset:0
    v_mfma_f32_16x16x32_bf16 a[4:7], v[64:67], v[36:39], 0
    s_add_u32 s36, s35, 128
    s_and_b32 s36, s36, 1023
    s_add_u32 s36, s36, s59
    v_mfma_f32_16x16x32_bf16 a[8:11], v[64:67], v[40:43], 0
    s_add_u32 m0, s42, 36864
    ds_read_b128 v[100:103], v9 offset:2048
    v_mfma_f32_16x16x32_bf16 a[12:15], v[64:67], v[44:47], 0
    buffer_load_dwordx4 v2, s[4:7], s36 offen offset:0 lds
    v_mfma_f32_16x16x32_bf16 a[16:19], v[64:67], v[48:51], 0
    ds_read_b128 v[104:107], v9 offset:4096
    v_mfma_f32_16x16x32_bf16 a[20:23], v[64:67], v[52:55], 0
    v_mfma_f32_16x16x32_bf16 a[24:27], v[64:67], v[56:59], 0
    ds_read_b128 v[108:111], v9 offset:6144
    v_mfma_f32_16x16x32_bf16 a[28:31], v[64:67], v[60:63], 0
    buffer_load_dwordx4 v3, s[4:7], s36 offen offset:1024 lds
    v_mfma_f32_16x16x32_bf16 a[32:35], v[68:71], v[32:35], 0
    ds_read_b128 v[112:115], v9 offset:8192
    v_mfma_f32_16x16x32_bf16 a[36:39], v[68:71], v[36:39], 0
    v_mfma_f32_16x16x32_bf16 a[40:43], v[68:71], v[40:43], 0
    ds_read_b128 v[116:119], v9 offset:10240
    v_mfma_f32_16x16x32_bf16 a[44:47], v[68:71], v[44:47], 0
    buffer_load_dwordx4 v4, s[4:7], s36 offen offset:2048 lds
    v_mfma_f32_16x16x32_bf16 a[48:51], v[68:71], v[48:51], 0
    ds_read_b128 v[120:123], v9 offset:12288
    v_mfma_f32_16x16x32_bf16 a[52:55], v[68:71], v[52:55], 0
    v_mfma_f32_16x16x32_bf16 a[56:59], v[68:71], v[56:59], 0
    ds_read_b128 v[124:127], v9 offset:14336
    v_mfma_f32_16x16x32_bf16 a[60:63], v[68:71], v[60:63], 0
    buffer_load_dwordx4 v5, s[4:7], s36 offen offset:3072 lds
    v_mfma_f32_16x16x32_bf16 a[64:67], v[72:75], v[32:35], 0
    v_mfma_f32_16x16x32_bf16 a[68:71], v[72:75], v[36:39], 0
    s_add_u32 s37, s58, 524288
    s_and_b32 s37, s37, 4194303
    s_add_u32 s37, s37, s39
    v_mfma_f32_16x16x32_bf16 a[72:75], v[72:75], v[40:43], 0
    s_add_u32 m0, s43, 32768
    v_mfma_f32_16x16x32_bf16 a[76:79], v[72:75], v[44:47], 0
    buffer_load_dwordx4 v6, s[8:11], s37 offen offset:0 lds
    v_mfma_f32_16x16x32_bf16 a[80:83], v[72:75], v[48:51], 0
    v_mfma_f32_16x16x32_bf16 a[84:87], v[72:75], v[52:55], 0
    v_mfma_f32_16x16x32_bf16 a[88:91], v[72:75], v[56:59], 0
    v_mfma_f32_16x16x32_bf16 a[92:95], v[72:75], v[60:63], 0
    buffer_load_dwordx4 v7, s[8:11], s37 offen offset:1024 lds
    v_mfma_f32_16x16x32_bf16 a[96:99], v[76:79], v[32:35], 0
    v_mfma_f32_16x16x32_bf16 a[100:103], v[76:79], v[36:39], 0
    v_mfma_f32_16x16x32_bf16 a[104:107], v[76:79], v[40:43], 0
    s_add_u32 m0, s43, 34816
    v_mfma_f32_16x16x32_bf16 a[108:111], v[76:79], v[44:47], 0
    buffer_load_dwordx4 v6, s[12:15], s37 offen offset:0 lds
    v_mfma_f32_16x16x32_bf16 a[112:115], v[76:79], v[48:51], 0
    v_mfma_f32_16x16x32_bf16 a[116:119], v[76:79], v[52:55], 0
    v_mfma_f32_16x16x32_bf16 a[120:123], v[76:79], v[56:59], 0
    v_mfma_f32_16x16x32_bf16 a[124:127], v[76:79], v[60:63], 0
    buffer_load_dwordx4 v7, s[12:15], s37 offen offset:1024 lds
    v_mfma_f32_16x16x32_bf16 a[128:131], v[32:35], v[80:83], 0
    v_mfma_f32_16x16x32_bf16 a[132:135], v[36:39], v[80:83], 0
    s_add_u32 s37, s58, 786432
    s_and_b32 s37, s37, 4194303
    s_add_u32 s37, s37, s39
    v_mfma_f32_16x16x32_bf16 a[136:139], v[40:43], v[80:83], 0
    s_add_u32 m0, s43, 49152
    v_mfma_f32_16x16x32_bf16 a[140:143], v[44:47], v[80:83], 0
    buffer_load_dwordx4 v6, s[8:11], s37 offen offset:0 lds
    v_mfma_f32_16x16x32_bf16 a[144:147], v[48:51], v[80:83], 0
    s_waitcnt vmcnt(13)
    s_barrier
    v_mfma_f32_16x16x32_bf16 a[148:151], v[52:55], v[80:83], 0
    v_mfma_f32_16x16x32_bf16 a[152:155], v[56:59], v[80:83], 0
    ds_read_b64_tr_b16 v[128:129], v10 offset:16384
    ds_read_b64_tr_b16 v[130:131], v10 offset:17408
    v_mfma_f32_16x16x32_bf16 a[156:159], v[60:63], v[80:83], 0
    buffer_load_dwordx4 v7, s[8:11], s37 offen offset:1024 lds
    v_mfma_f32_16x16x32_bf16 a[160:163], v[32:35], v[84:87], 0
    ds_read_b64_tr_b16 v[132:133], v11 offset:16384
    ds_read_b64_tr_b16 v[134:135], v11 offset:17408
    v_mfma_f32_16x16x32_bf16 a[164:167], v[36:39], v[84:87], 0
    v_mfma_f32_16x16x32_bf16 a[168:171], v[40:43], v[84:87], 0
    s_add_u32 m0, s43, 51200
    ds_read_b64_tr_b16 v[136:137], v12 offset:16384
    ds_read_b64_tr_b16 v[138:139], v12 offset:17408
    v_mfma_f32_16x16x32_bf16 a[172:175], v[44:47], v[84:87], 0
    buffer_load_dwordx4 v6, s[12:15], s37 offen offset:0 lds
    v_mfma_f32_16x16x32_bf16 a[176:179], v[48:51], v[84:87], 0
    ds_read_b64_tr_b16 v[140:141], v13 offset:16384
    ds_read_b64_tr_b16 v[142:143], v13 offset:17408
    v_mfma_f32_16x16x32_bf16 a[180:183], v[52:55], v[84:87], 0
    v_mfma_f32_16x16x32_bf16 a[184:187], v[56:59], v[84:87], 0
    ds_read_b64_tr_b16 v[144:145], v10 offset:18432
    ds_read_b64_tr_b16 v[146:147], v10 offset:19456
    v_mfma_f32_16x16x32_bf16 a[188:191], v[60:63], v[84:87], 0
    buffer_load_dwordx4 v7, s[12:15], s37 offen offset:1024 lds
    v_mfma_f32_16x16x32_bf16 a[192:195], v[32:35], v[88:91], 0
    ds_read_b64_tr_b16 v[148:149], v11 offset:18432
    ds_read_b64_tr_b16 v[150:151], v11 offset:19456
    v_mfma_f32_16x16x32_bf16 a[196:199], v[36:39], v[88:91], 0
    v_mfma_f32_16x16x32_bf16 a[200:203], v[40:43], v[88:91], 0
    ds_read_b64_tr_b16 v[152:153], v12 offset:18432
    ds_read_b64_tr_b16 v[154:155], v12 offset:19456
    v_mfma_f32_16x16x32_bf16 a[204:207], v[44:47], v[88:91], 0
    v_mfma_f32_16x16x32_bf16 a[208:211], v[48:51], v[88:91], 0
    ds_read_b64_tr_b16 v[156:157], v13 offset:18432
    ds_read_b64_tr_b16 v[158:159], v13 offset:19456
    v_mfma_f32_16x16x32_bf16 a[212:215], v[52:55], v[88:91], 0
    v_mfma_f32_16x16x32_bf16 a[216:219], v[56:59], v[88:91], 0
    v_mfma_f32_16x16x32_bf16 a[220:223], v[60:63], v[88:91], 0
    v_mfma_f32_16x16x32_bf16 a[224:227], v[32:35], v[92:95], 0
    v_mfma_f32_16x16x32_bf16 a[228:231], v[36:39], v[92:95], 0
    v_mfma_f32_16x16x32_bf16 a[232:235], v[40:43], v[92:95], 0
    v_mfma_f32_16x16x32_bf16 a[236:239], v[44:47], v[92:95], 0
    v_mfma_f32_16x16x32_bf16 a[240:243], v[48:51], v[92:95], 0
    v_mfma_f32_16x16x32_bf16 a[244:247], v[52:55], v[92:95], 0
    v_mfma_f32_16x16x32_bf16 a[248:251], v[56:59], v[92:95], 0
    s_mov_b64 exec, 0
    s_cmp_eq_u32 s32, 0
    s_cbranch_scc1 gated_mix__ssm_conv_h3__compressed_kv_cla__prompt_kernel_pad0
    s_cmp_eq_u32 s32, 1
    s_cbranch_scc1 gated_mix__ssm_conv_h3__compressed_kv_cla__prompt_kernel_pad1
    s_cmp_eq_u32 s32, 2
    s_cbranch_scc1 gated_mix__ssm_conv_h3__compressed_kv_cla__prompt_kernel_pad2
    s_cbranch_execz gated_mix__ssm_conv_h3__compressed_kv_cla__prompt_kernel_pad3
gated_mix__ssm_conv_h3__compressed_kv_cla__prompt_kernel_back:
    s_mov_b64 exec, -1
    v_mfma_f32_16x16x32_bf16 a[252:255], v[60:63], v[92:95], 0
    s_waitcnt vmcnt(4) lgkmcnt(0)
    s_barrier
    v_mfma_f32_16x16x32_bf16 a[0:3], v[128:131], v[96:99], a[0:3]
    ds_read_b64_tr_b16 v[64:65], v10 offset:32768
    v_mfma_f32_16x16x32_bf16 a[4:7], v[128:131], v[100:103], a[4:7]
    s_add_u32 s36, s35, 256
    s_and_b32 s36, s36, 1023
    s_add_u32 s36, s36, s38
    v_mfma_f32_16x16x32_bf16 a[8:11], v[128:131], v[104:107], a[8:11]
    s_add_u32 m0, s42, 65536
    ds_read_b64_tr_b16 v[66:67], v10 offset:33792
    v_mfma_f32_16x16x32_bf16 a[12:15], v[128:131], v[108:111], a[12:15]
    buffer_load_dwordx4 v2, s[4:7], s36 offen offset:0 lds
    v_mfma_f32_16x16x32_bf16 a[16:19], v[128:131], v[112:115], a[16:19]
    ds_read_b64_tr_b16 v[68:69], v11 offset:32768
    v_mfma_f32_16x16x32_bf16 a[20:23], v[128:131], v[116:119], a[20:23]
    v_mfma_f32_16x16x32_bf16 a[24:27], v[128:131], v[120:123], a[24:27]
    ds_read_b64_tr_b16 v[70:71], v11 offset:33792
    v_mfma_f32_16x16x32_bf16 a[28:31], v[128:131], v[124:127], a[28:31]
    buffer_load_dwordx4 v3, s[4:7], s36 offen offset:1024 lds
    v_mfma_f32_16x16x32_bf16 a[32:35], v[132:135], v[96:99], a[32:35]
    ds_read_b128 v[32:35], v8 offset:32768
    v_mfma_f32_16x16x32_bf16 a[36:39], v[132:135], v[100:103], a[36:39]
    v_mfma_f32_16x16x32_bf16 a[40:43], v[132:135], v[104:107], a[40:43]
    ds_read_b64_tr_b16 v[72:73], v12 offset:32768
    v_mfma_f32_16x16x32_bf16 a[44:47], v[132:135], v[108:111], a[44:47]
    buffer_load_dwordx4 v4, s[4:7], s36 offen offset:2048 lds
    v_mfma_f32_16x16x32_bf16 a[48:51], v[132:135], v[112:115], a[48:51]
    ds_read_b64_tr_b16 v[74:75], v12 offset:33792
    v_mfma_f32_16x16x32_bf16 a[52:55], v[132:135], v[116:119], a[52:55]
    v_mfma_f32_16x16x32_bf16 a[56:59], v[132:135], v[120:123], a[56:59]
    ds_read_b128 v[36:39], v8 offset:34816
    v_mfma_f32_16x16x32_bf16 a[60:63], v[132:135], v[124:127], a[60:63]
    buffer_load_dwordx4 v5, s[4:7], s36 offen offset:3072 lds
    v_mfma_f32_16x16x32_bf16 a[64:67], v[136:139], v[96:99], a[64:67]
    ds_read_b64_tr_b16 v[76:77], v13 offset:32768
    v_mfma_f32_16x16x32_bf16 a[68:71], v[136:139], v[100:103], a[68:71]
    s_add_u32 s36, s35, 256
    s_and_b32 s36, s36, 1023
    s_add_u32 s36, s36, s59
    v_mfma_f32_16x16x32_bf16 a[72:75], v[136:139], v[104:107], a[72:75]
    s_add_u32 m0, s42, 69632
    ds_read_b64_tr_b16 v[78:79], v13 offset:33792
    v_mfma_f32_16x16x32_bf16 a[76:79], v[136:139], v[108:111], a[76:79]
    buffer_load_dwordx4 v2, s[4:7], s36 offen offset:0 lds
    v_mfma_f32_16x16x32_bf16 a[80:83], v[136:139], v[112:115], a[80:83]
    ds_read_b128 v[40:43], v8 offset:36864
    v_mfma_f32_16x16x32_bf16 a[84:87], v[136:139], v[116:119], a[84:87]
    v_mfma_f32_16x16x32_bf16 a[88:91], v[136:139], v[120:123], a[88:91]
    ds_read_b64_tr_b16 v[80:81], v10 offset:34816
    v_mfma_f32_16x16x32_bf16 a[92:95], v[136:139], v[124:127], a[92:95]
    buffer_load_dwordx4 v3, s[4:7], s36 offen offset:1024 lds
    v_mfma_f32_16x16x32_bf16 a[96:99], v[140:143], v[96:99], a[96:99]
    ds_read_b64_tr_b16 v[82:83], v10 offset:35840
    v_mfma_f32_16x16x32_bf16 a[100:103], v[140:143], v[100:103], a[100:103]
    v_mfma_f32_16x16x32_bf16 a[104:107], v[140:143], v[104:107], a[104:107]
    ds_read_b128 v[44:47], v8 offset:38912
    v_mfma_f32_16x16x32_bf16 a[108:111], v[140:143], v[108:111], a[108:111]
    buffer_load_dwordx4 v4, s[4:7], s36 offen offset:2048 lds
    v_mfma_f32_16x16x32_bf16 a[112:115], v[140:143], v[112:115], a[112:115]
    ds_read_b64_tr_b16 v[84:85], v11 offset:34816
    v_mfma_f32_16x16x32_bf16 a[116:119], v[140:143], v[116:119], a[116:119]
    v_mfma_f32_16x16x32_bf16 a[120:123], v[140:143], v[120:123], a[120:123]
    ds_read_b64_tr_b16 v[86:87], v11 offset:35840
    v_mfma_f32_16x16x32_bf16 a[124:127], v[140:143], v[124:127], a[124:127]
    buffer_load_dwordx4 v5, s[4:7], s36 offen offset:3072 lds
    v_mfma_f32_16x16x32_bf16 a[128:131], v[96:99], v[144:147], a[128:131]
    ds_read_b128 v[48:51], v8 offset:40960
    v_mfma_f32_16x16x32_bf16 a[132:135], v[100:103], v[144:147], a[132:135]
    s_add_u32 s37, s58, 1048576
    s_and_b32 s37, s37, 4194303
    s_add_u32 s37, s37, s39
    v_mfma_f32_16x16x32_bf16 a[136:139], v[104:107], v[144:147], a[136:139]
    s_add_u32 m0, s43, 0
    ds_read_b64_tr_b16 v[88:89], v12 offset:34816
    v_mfma_f32_16x16x32_bf16 a[140:143], v[108:111], v[144:147], a[140:143]
    buffer_load_dwordx4 v6, s[8:11], s37 offen offset:0 lds
    v_mfma_f32_16x16x32_bf16 a[144:147], v[112:115], v[144:147], a[144:147]
    ds_read_b64_tr_b16 v[90:91], v12 offset:35840
    v_mfma_f32_16x16x32_bf16 a[148:151], v[116:119], v[144:147], a[148:151]
    v_mfma_f32_16x16x32_bf16 a[152:155], v[120:123], v[144:147], a[152:155]
    ds_read_b128 v[52:55], v8 offset:43008
    v_mfma_f32_16x16x32_bf16 a[156:159], v[124:127], v[144:147], a[156:159]
    buffer_load_dwordx4 v7, s[8:11], s37 offen offset:1024 lds
    v_mfma_f32_16x16x32_bf16 a[160:163], v[96:99], v[148:151], a[160:163]
    s_lshl_b32 s3, s33, 3
    ds_read_b64_tr_b16 v[92:93], v13 offset:34816
    v_mfma_f32_16x16x32_bf16 a[164:167], v[100:103], v[148:151], a[164:167]
    s_add_u32 s3, s3, s34
    v_mfma_f32_16x16x32_bf16 a[168:171], v[104:107], v[148:151], a[168:171]
    s_add_u32 m0, s43, 2048
    ds_read_b64_tr_b16 v[94:95], v13 offset:35840
    v_mfma_f32_16x16x32_bf16 a[172:175], v[108:111], v[148:151], a[172:175]
    buffer_load_dwordx4 v6, s[12:15], s37 offen offset:0 lds
    v_mfma_f32_16x16x32_bf16 a[176:179], v[112:115], v[148:151], a[176:179]
    s_lshl_b32 s3, s3, 2
    ds_read_b128 v[56:59], v8 offset:45056
    v_mfma_f32_16x16x32_bf16 a[180:183], v[116:119], v[148:151], a[180:183]
    s_add_u32 s3, s3, 12288
    v_mfma_f32_16x16x32_bf16 a[184:187], v[120:123], v[148:151], a[184:187]
    ds_read_b128 v[60:63], v8 offset:47104
    v_mov_b32 v241, 0
    v_mfma_f32_16x16x32_bf16 a[188:191], v[124:127], v[148:151], a[188:191]
    buffer_load_dwordx4 v7, s[12:15], s37 offen offset:1024 lds
    v_mfma_f32_16x16x32_bf16 a[192:195], v[96:99], v[152:155], a[192:195]
    s_mov_b32 s16, s66
    v_mfma_f32_16x16x32_bf16 a[196:199], v[100:103], v[152:155], a[196:199]
    s_mov_b32 s17, s67
    v_mfma_f32_16x16x32_bf16 a[200:203], v[104:107], v[152:155], a[200:203]
    s_mov_b32 s18, 4194304
    v_mfma_f32_16x16x32_bf16 a[204:207], v[108:111], v[152:155], a[204:207]
    v_mfma_f32_16x16x32_bf16 a[208:211], v[112:115], v[152:155], a[208:211]
    s_mov_b32 s19, 0x00020000
    v_mfma_f32_16x16x32_bf16 a[212:215], v[116:119], v[152:155], a[212:215]
    s_mov_b32 s76, s68
    v_mfma_f32_16x16x32_bf16 a[216:219], v[120:123], v[152:155], a[216:219]
    s_mov_b32 s77, s69
    v_mfma_f32_16x16x32_bf16 a[220:223], v[124:127], v[152:155], a[220:223]
    v_mfma_f32_16x16x32_bf16 a[224:227], v[96:99], v[156:159], a[224:227]
    s_mov_b32 s78, 4194304
    v_mfma_f32_16x16x32_bf16 a[228:231], v[100:103], v[156:159], a[228:231]
    s_mov_b32 s79, 0x00020000
    v_mfma_f32_16x16x32_bf16 a[232:235], v[104:107], v[156:159], a[232:235]
    v_mfma_f32_16x16x32_bf16 a[236:239], v[108:111], v[156:159], a[236:239]
    v_mfma_f32_16x16x32_bf16 a[240:243], v[112:115], v[156:159], a[240:243]
    v_mfma_f32_16x16x32_bf16 a[244:247], v[116:119], v[156:159], a[244:247]
    v_mfma_f32_16x16x32_bf16 a[248:251], v[120:123], v[156:159], a[248:251]
    v_mfma_f32_16x16x32_bf16 a[252:255], v[124:127], v[156:159], a[252:255]
    s_waitcnt vmcnt(12) lgkmcnt(0)
    s_barrier
    v_mfma_f32_16x16x32_bf16 a[0:3], v[64:67], v[32:35], a[0:3]
    ds_read_b64_tr_b16 v[128:129], v10 offset:49152
    v_mfma_f32_16x16x32_bf16 a[4:7], v[64:67], v[36:39], a[4:7]
    s_add_u32 s36, s35, 384
    s_and_b32 s36, s36, 1023
    s_add_u32 s36, s36, s38
    v_mfma_f32_16x16x32_bf16 a[8:11], v[64:67], v[40:43], a[8:11]
    s_add_u32 m0, s42, 0
    ds_read_b64_tr_b16 v[130:131], v10 offset:50176
    v_mfma_f32_16x16x32_bf16 a[12:15], v[64:67], v[44:47], a[12:15]
    buffer_load_dwordx4 v2, s[4:7], s36 offen offset:0 lds
    v_mfma_f32_16x16x32_bf16 a[16:19], v[64:67], v[48:51], a[16:19]
    ds_read_b64_tr_b16 v[132:133], v11 offset:49152
    v_mfma_f32_16x16x32_bf16 a[20:23], v[64:67], v[52:55], a[20:23]
    v_mfma_f32_16x16x32_bf16 a[24:27], v[64:67], v[56:59], a[24:27]
    ds_read_b64_tr_b16 v[134:135], v11 offset:50176
    v_mfma_f32_16x16x32_bf16 a[28:31], v[64:67], v[60:63], a[28:31]
    buffer_load_dwordx4 v3, s[4:7], s36 offen offset:1024 lds
    v_mfma_f32_16x16x32_bf16 a[32:35], v[68:71], v[32:35], a[32:35]
    ds_read_b128 v[96:99], v9 offset:32768
    v_mfma_f32_16x16x32_bf16 a[36:39], v[68:71], v[36:39], a[36:39]
    v_mfma_f32_16x16x32_bf16 a[40:43], v[68:71], v[40:43], a[40:43]
    ds_read_b64_tr_b16 v[136:137], v12 offset:49152
    v_mfma_f32_16x16x32_bf16 a[44:47], v[68:71], v[44:47], a[44:47]
    buffer_load_dwordx4 v4, s[4:7], s36 offen offset:2048 lds
    v_mfma_f32_16x16x32_bf16 a[48:51], v[68:71], v[48:51], a[48:51]
    ds_read_b64_tr_b16 v[138:139], v12 offset:50176
    v_mfma_f32_16x16x32_bf16 a[52:55], v[68:71], v[52:55], a[52:55]
    v_mfma_f32_16x16x32_bf16 a[56:59], v[68:71], v[56:59], a[56:59]
    ds_read_b128 v[100:103], v9 offset:34816
    v_mfma_f32_16x16x32_bf16 a[60:63], v[68:71], v[60:63], a[60:63]
    buffer_load_dwordx4 v5, s[4:7], s36 offen offset:3072 lds
    v_mfma_f32_16x16x32_bf16 a[64:67], v[72:75], v[32:35], a[64:67]
    ds_read_b64_tr_b16 v[140:141], v13 offset:49152
    v_mfma_f32_16x16x32_bf16 a[68:71], v[72:75], v[36:39], a[68:71]
    s_add_u32 s37, s58, 1310720
    s_and_b32 s37, s37, 4194303
    s_add_u32 s37, s37, s39
    v_mfma_f32_16x16x32_bf16 a[72:75], v[72:75], v[40:43], a[72:75]
    s_add_u32 m0, s43, 16384
    ds_read_b64_tr_b16 v[142:143], v13 offset:50176
    v_mfma_f32_16x16x32_bf16 a[76:79], v[72:75], v[44:47], a[76:79]
    buffer_load_dwordx4 v6, s[8:11], s37 offen offset:0 lds
    v_mfma_f32_16x16x32_bf16 a[80:83], v[72:75], v[48:51], a[80:83]
    ds_read_b128 v[104:107], v9 offset:36864
    v_mfma_f32_16x16x32_bf16 a[84:87], v[72:75], v[52:55], a[84:87]
    v_mfma_f32_16x16x32_bf16 a[88:91], v[72:75], v[56:59], a[88:91]
    ds_read_b64_tr_b16 v[144:145], v10 offset:51200
    v_mfma_f32_16x16x32_bf16 a[92:95], v[72:75], v[60:63], a[92:95]
    buffer_load_dwordx4 v7, s[8:11], s37 offen offset:1024 lds
    v_mfma_f32_16x16x32_bf16 a[96:99], v[76:79], v[32:35], a[96:99]
    ds_read_b64_tr_b16 v[146:147], v10 offset:52224
    v_mfma_f32_16x16x32_bf16 a[100:103], v[76:79], v[36:39], a[100:103]
    v_mfma_f32_16x16x32_bf16 a[104:107], v[76:79], v[40:43], a[104:107]
    s_add_u32 m0, s43, 18432
    ds_read_b128 v[108:111], v9 offset:38912
    v_mfma_f32_16x16x32_bf16 a[108:111], v[76:79], v[44:47], a[108:111]
    buffer_load_dwordx4 v6, s[12:15], s37 offen offset:0 lds
    v_mfma_f32_16x16x32_bf16 a[112:115], v[76:79], v[48:51], a[112:115]
    ds_read_b64_tr_b16 v[148:149], v11 offset:51200
    v_mfma_f32_16x16x32_bf16 a[116:119], v[76:79], v[52:55], a[116:119]
    v_mfma_f32_16x16x32_bf16 a[120:123], v[76:79], v[56:59], a[120:123]
    ds_read_b64_tr_b16 v[150:151], v11 offset:52224
    v_mfma_f32_16x16x32_bf16 a[124:127], v[76:79], v[60:63], a[124:127]
    buffer_load_dwordx4 v7, s[12:15], s37 offen offset:1024 lds
    v_mfma_f32_16x16x32_bf16 a[128:131], v[32:35], v[80:83], a[128:131]
    ds_read_b128 v[112:115], v9 offset:40960
    v_mfma_f32_16x16x32_bf16 a[132:135], v[36:39], v[80:83], a[132:135]
    s_add_u32 s36, s35, 384
    s_and_b32 s36, s36, 1023
    s_add_u32 s36, s36, s59
    v_mfma_f32_16x16x32_bf16 a[136:139], v[40:43], v[80:83], a[136:139]
    s_add_u32 m0, s42, 4096
    ds_read_b64_tr_b16 v[152:153], v12 offset:51200
    v_mfma_f32_16x16x32_bf16 a[140:143], v[44:47], v[80:83], a[140:143]
    buffer_load_dwordx4 v2, s[4:7], s36 offen offset:0 lds
    v_mfma_f32_16x16x32_bf16 a[144:147], v[48:51], v[80:83], a[144:147]
    ds_read_b64_tr_b16 v[154:155], v12 offset:52224
    v_mfma_f32_16x16x32_bf16 a[148:151], v[52:55], v[80:83], a[148:151]
    v_mfma_f32_16x16x32_bf16 a[152:155], v[56:59], v[80:83], a[152:155]
    ds_read_b128 v[116:119], v9 offset:43008
    v_mfma_f32_16x16x32_bf16 a[156:159], v[60:63], v[80:83], a[156:159]
    buffer_load_dwordx4 v3, s[4:7], s36 offen offset:1024 lds
    v_mfma_f32_16x16x32_bf16 a[160:163], v[32:35], v[84:87], a[160:163]
    ds_read_b64_tr_b16 v[156:157], v13 offset:51200
    v_mfma_f32_16x16x32_bf16 a[164:167], v[36:39], v[84:87], a[164:167]
    v_mfma_f32_16x16x32_bf16 a[168:171], v[40:43], v[84:87], a[168:171]
    ds_read_b64_tr_b16 v[158:159], v13 offset:52224
    v_mfma_f32_16x16x32_bf16 a[172:175], v[44:47], v[84:87], a[172:175]
    buffer_load_dwordx4 v4, s[4:7], s36 offen offset:2048 lds
    v_mfma_f32_16x16x32_bf16 a[176:179], v[48:51], v[84:87], a[176:179]
    ds_read_b128 v[120:123], v9 offset:45056
    v_mfma_f32_16x16x32_bf16 a[180:183], v[52:55], v[84:87], a[180:183]
    v_mfma_f32_16x16x32_bf16 a[184:187], v[56:59], v[84:87], a[184:187]
    ds_read_b128 v[124:127], v9 offset:47104
    v_mfma_f32_16x16x32_bf16 a[188:191], v[60:63], v[84:87], a[188:191]
    buffer_load_dwordx4 v5, s[4:7], s36 offen offset:3072 lds
    v_mfma_f32_16x16x32_bf16 a[192:195], v[32:35], v[88:91], a[192:195]
    v_mfma_f32_16x16x32_bf16 a[196:199], v[36:39], v[88:91], a[196:199]
    v_mfma_f32_16x16x32_bf16 a[200:203], v[40:43], v[88:91], a[200:203]
    v_mfma_f32_16x16x32_bf16 a[204:207], v[44:47], v[88:91], a[204:207]
    v_mfma_f32_16x16x32_bf16 a[208:211], v[48:51], v[88:91], a[208:211]
    v_mfma_f32_16x16x32_bf16 a[212:215], v[52:55], v[88:91], a[212:215]
    v_mfma_f32_16x16x32_bf16 a[216:219], v[56:59], v[88:91], a[216:219]
    v_mfma_f32_16x16x32_bf16 a[220:223], v[60:63], v[88:91], a[220:223]
    v_mfma_f32_16x16x32_bf16 a[224:227], v[32:35], v[92:95], a[224:227]
    v_mfma_f32_16x16x32_bf16 a[228:231], v[36:39], v[92:95], a[228:231]
    v_mfma_f32_16x16x32_bf16 a[232:235], v[40:43], v[92:95], a[232:235]
    v_mfma_f32_16x16x32_bf16 a[236:239], v[44:47], v[92:95], a[236:239]
    v_mfma_f32_16x16x32_bf16 a[240:243], v[48:51], v[92:95], a[240:243]
    v_mfma_f32_16x16x32_bf16 a[244:247], v[52:55], v[92:95], a[244:247]
    v_mfma_f32_16x16x32_bf16 a[248:251], v[56:59], v[92:95], a[248:251]
    v_mfma_f32_16x16x32_bf16 a[252:255], v[60:63], v[92:95], a[252:255]
    s_waitcnt vmcnt(12) lgkmcnt(0)
    s_barrier
    v_mfma_f32_16x16x32_bf16 a[0:3], v[128:131], v[96:99], a[0:3]
    ds_read_b64_tr_b16 v[64:65], v10 offset:0
    v_mfma_f32_16x16x32_bf16 a[4:7], v[128:131], v[100:103], a[4:7]
    s_add_u32 s37, s58, 1572864
    s_and_b32 s37, s37, 4194303
    s_add_u32 s37, s37, s39
    v_mfma_f32_16x16x32_bf16 a[8:11], v[128:131], v[104:107], a[8:11]
    s_add_u32 m0, s43, 32768
    ds_read_b64_tr_b16 v[66:67], v10 offset:1024
    v_mfma_f32_16x16x32_bf16 a[12:15], v[128:131], v[108:111], a[12:15]
    buffer_load_dwordx4 v6, s[8:11], s37 offen offset:0 lds
    v_mfma_f32_16x16x32_bf16 a[16:19], v[128:131], v[112:115], a[16:19]
    ds_read_b64_tr_b16 v[68:69], v11 offset:0
    v_mfma_f32_16x16x32_bf16 a[20:23], v[128:131], v[116:119], a[20:23]
    v_mfma_f32_16x16x32_bf16 a[24:27], v[128:131], v[120:123], a[24:27]
    ds_read_b64_tr_b16 v[70:71], v11 offset:1024
    v_mfma_f32_16x16x32_bf16 a[28:31], v[128:131], v[124:127], a[28:31]
    buffer_load_dwordx4 v7, s[8:11], s37 offen offset:1024 lds
    v_mfma_f32_16x16x32_bf16 a[32:35], v[132:135], v[96:99], a[32:35]
    ds_read_b128 v[32:35], v14 offset:0
    v_mfma_f32_16x16x32_bf16 a[36:39], v[132:135], v[100:103], a[36:39]
    v_mfma_f32_16x16x32_bf16 a[40:43], v[132:135], v[104:107], a[40:43]
    s_add_u32 m0, s43, 34816
    ds_read_b64_tr_b16 v[72:73], v12 offset:0
    v_mfma_f32_16x16x32_bf16 a[44:47], v[132:135], v[108:111], a[44:47]
    buffer_load_dwordx4 v6, s[12:15], s37 offen offset:0 lds
    v_mfma_f32_16x16x32_bf16 a[48:51], v[132:135], v[112:115], a[48:51]
    ds_read_b64_tr_b16 v[74:75], v12 offset:1024
    v_mfma_f32_16x16x32_bf16 a[52:55], v[132:135], v[116:119], a[52:55]
    v_mfma_f32_16x16x32_bf16 a[56:59], v[132:135], v[120:123], a[56:59]
    ds_read_b128 v[36:39], v14 offset:2048
    v_mfma_f32_16x16x32_bf16 a[60:63], v[132:135], v[124:127], a[60:63]
    buffer_load_dwordx4 v7, s[12:15], s37 offen offset:1024 lds
    v_mfma_f32_16x16x32_bf16 a[64:67], v[136:139], v[96:99], a[64:67]
    ds_read_b64_tr_b16 v[76:77], v13 offset:0
    v_mfma_f32_16x16x32_bf16 a[68:71], v[136:139], v[100:103], a[68:71]
    s_add_u32 s36, s35, 512
    s_and_b32 s36, s36, 1023
    s_add_u32 s36, s36, s38
    v_mfma_f32_16x16x32_bf16 a[72:75], v[136:139], v[104:107], a[72:75]
    s_add_u32 m0, s42, 32768
    ds_read_b64_tr_b16 v[78:79], v13 offset:1024
    v_mfma_f32_16x16x32_bf16 a[76:79], v[136:139], v[108:111], a[76:79]
    buffer_load_dwordx4 v2, s[4:7], s36 offen offset:0 lds
    v_mfma_f32_16x16x32_bf16 a[80:83], v[136:139], v[112:115], a[80:83]
    ds_read_b128 v[40:43], v14 offset:4096
    v_mfma_f32_16x16x32_bf16 a[84:87], v[136:139], v[116:119], a[84:87]
    v_mfma_f32_16x16x32_bf16 a[88:91], v[136:139], v[120:123], a[88:91]
    ds_read_b64_tr_b16 v[80:81], v10 offset:2048
    v_mfma_f32_16x16x32_bf16 a[92:95], v[136:139], v[124:127], a[92:95]
    buffer_load_dwordx4 v3, s[4:7], s36 offen offset:1024 lds
    v_mfma_f32_16x16x32_bf16 a[96:99], v[140:143], v[96:99], a[96:99]
    ds_read_b64_tr_b16 v[82:83], v10 offset:3072
    v_mfma_f32_16x16x32_bf16 a[100:103], v[140:143], v[100:103], a[100:103]
    v_mfma_f32_16x16x32_bf16 a[104:107], v[140:143], v[104:107], a[104:107]
    ds_read_b128 v[44:47], v14 offset:6144
    v_mfma_f32_16x16x32_bf16 a[108:111], v[140:143], v[108:111], a[108:111]
    buffer_load_dwordx4 v4, s[4:7], s36 offen offset:2048 lds
    v_mfma_f32_16x16x32_bf16 a[112:115], v[140:143], v[112:115], a[112:115]
    ds_read_b64_tr_b16 v[84:85], v11 offset:2048
    v_mfma_f32_16x16x32_bf16 a[116:119], v[140:143], v[116:119], a[116:119]
    v_mfma_f32_16x16x32_bf16 a[120:123], v[140:143], v[120:123], a[120:123]
    ds_read_b64_tr_b16 v[86:87], v11 offset:3072
    v_mfma_f32_16x16x32_bf16 a[124:127], v[140:143], v[124:127], a[124:127]
    buffer_load_dwordx4 v5, s[4:7], s36 offen offset:3072 lds
    v_mfma_f32_16x16x32_bf16 a[128:131], v[96:99], v[144:147], a[128:131]
    ds_read_b128 v[48:51], v14 offset:8192
    v_mfma_f32_16x16x32_bf16 a[132:135], v[100:103], v[144:147], a[132:135]
    s_add_u32 s37, s58, 1835008
    s_and_b32 s37, s37, 4194303
    s_add_u32 s37, s37, s39
    v_mfma_f32_16x16x32_bf16 a[136:139], v[104:107], v[144:147], a[136:139]
    s_add_u32 m0, s43, 49152
    ds_read_b64_tr_b16 v[88:89], v12 offset:2048
    v_mfma_f32_16x16x32_bf16 a[140:143], v[108:111], v[144:147], a[140:143]
    buffer_load_dwordx4 v6, s[8:11], s37 offen offset:0 lds
    v_mfma_f32_16x16x32_bf16 a[144:147], v[112:115], v[144:147], a[144:147]
    ds_read_b64_tr_b16 v[90:91], v12 offset:3072
    v_mfma_f32_16x16x32_bf16 a[148:151], v[116:119], v[144:147], a[148:151]
    v_mfma_f32_16x16x32_bf16 a[152:155], v[120:123], v[144:147], a[152:155]
    ds_read_b128 v[52:55], v14 offset:10240
    v_mfma_f32_16x16x32_bf16 a[156:159], v[124:127], v[144:147], a[156:159]
    buffer_load_dwordx4 v7, s[8:11], s37 offen offset:1024 lds
    v_mfma_f32_16x16x32_bf16 a[160:163], v[96:99], v[148:151], a[160:163]
    ds_read_b64_tr_b16 v[92:93], v13 offset:2048
    v_mfma_f32_16x16x32_bf16 a[164:167], v[100:103], v[148:151], a[164:167]
    v_mfma_f32_16x16x32_bf16 a[168:171], v[104:107], v[148:151], a[168:171]
    s_add_u32 m0, s43, 51200
    ds_read_b64_tr_b16 v[94:95], v13 offset:3072
    v_mfma_f32_16x16x32_bf16 a[172:175], v[108:111], v[148:151], a[172:175]
    buffer_load_dwordx4 v6, s[12:15], s37 offen offset:0 lds
    v_mfma_f32_16x16x32_bf16 a[176:179], v[112:115], v[148:151], a[176:179]
    ds_read_b128 v[56:59], v14 offset:12288
    v_mfma_f32_16x16x32_bf16 a[180:183], v[116:119], v[148:151], a[180:183]
    v_mfma_f32_16x16x32_bf16 a[184:187], v[120:123], v[148:151], a[184:187]
    ds_read_b128 v[60:63], v14 offset:14336
    v_mfma_f32_16x16x32_bf16 a[188:191], v[124:127], v[148:151], a[188:191]
    buffer_load_dwordx4 v7, s[12:15], s37 offen offset:1024 lds
    v_mfma_f32_16x16x32_bf16 a[192:195], v[96:99], v[152:155], a[192:195]
    v_mfma_f32_16x16x32_bf16 a[196:199], v[100:103], v[152:155], a[196:199]
    v_mfma_f32_16x16x32_bf16 a[200:203], v[104:107], v[152:155], a[200:203]
    v_mfma_f32_16x16x32_bf16 a[204:207], v[108:111], v[152:155], a[204:207]
    v_mfma_f32_16x16x32_bf16 a[208:211], v[112:115], v[152:155], a[208:211]
    v_mfma_f32_16x16x32_bf16 a[212:215], v[116:119], v[152:155], a[212:215]
    v_mfma_f32_16x16x32_bf16 a[216:219], v[120:123], v[152:155], a[216:219]
    v_mfma_f32_16x16x32_bf16 a[220:223], v[124:127], v[152:155], a[220:223]
    v_mfma_f32_16x16x32_bf16 a[224:227], v[96:99], v[156:159], a[224:227]
    v_mfma_f32_16x16x32_bf16 a[228:231], v[100:103], v[156:159], a[228:231]
    v_mfma_f32_16x16x32_bf16 a[232:235], v[104:107], v[156:159], a[232:235]
    v_mfma_f32_16x16x32_bf16 a[236:239], v[108:111], v[156:159], a[236:239]
    v_mfma_f32_16x16x32_bf16 a[240:243], v[112:115], v[156:159], a[240:243]
    v_mfma_f32_16x16x32_bf16 a[244:247], v[116:119], v[156:159], a[244:247]
    v_mfma_f32_16x16x32_bf16 a[248:251], v[120:123], v[156:159], a[248:251]
    v_mfma_f32_16x16x32_bf16 a[252:255], v[124:127], v[156:159], a[252:255]
    s_waitcnt vmcnt(16) lgkmcnt(0)
    s_barrier
    v_mfma_f32_16x16x32_bf16 a[0:3], v[64:67], v[32:35], a[0:3]
    ds_read_b64_tr_b16 v[128:129], v10 offset:16384
    v_mfma_f32_16x16x32_bf16 a[4:7], v[64:67], v[36:39], a[4:7]
    s_add_u32 s36, s35, 512
    s_and_b32 s36, s36, 1023
    s_add_u32 s36, s36, s59
    v_mfma_f32_16x16x32_bf16 a[8:11], v[64:67], v[40:43], a[8:11]
    s_add_u32 m0, s42, 36864
    ds_read_b64_tr_b16 v[130:131], v10 offset:17408
    v_mfma_f32_16x16x32_bf16 a[12:15], v[64:67], v[44:47], a[12:15]
    buffer_load_dwordx4 v2, s[4:7], s36 offen offset:0 lds
    v_mfma_f32_16x16x32_bf16 a[16:19], v[64:67], v[48:51], a[16:19]
    ds_read_b64_tr_b16 v[132:133], v11 offset:16384
    v_mfma_f32_16x16x32_bf16 a[20:23], v[64:67], v[52:55], a[20:23]
    v_mfma_f32_16x16x32_bf16 a[24:27], v[64:67], v[56:59], a[24:27]
    ds_read_b64_tr_b16 v[134:135], v11 offset:17408
    v_mfma_f32_16x16x32_bf16 a[28:31], v[64:67], v[60:63], a[28:31]
    buffer_load_dwordx4 v3, s[4:7], s36 offen offset:1024 lds
    v_mfma_f32_16x16x32_bf16 a[32:35], v[68:71], v[32:35], a[32:35]
    ds_read_b128 v[96:99], v15 offset:0
    v_mfma_f32_16x16x32_bf16 a[36:39], v[68:71], v[36:39], a[36:39]
    v_mfma_f32_16x16x32_bf16 a[40:43], v[68:71], v[40:43], a[40:43]
gated_mix__ssm_conv_h3__compressed_kv_cla__prompt_kernel_pad0:
    s_cbranch_execz gated_mix__ssm_conv_h3__compressed_kv_cla__prompt_kernel_pad4
    ds_read_b64_tr_b16 v[136:137], v12 offset:16384
    v_mfma_f32_16x16x32_bf16 a[44:47], v[68:71], v[44:47], a[44:47]
    buffer_load_dwordx4 v4, s[4:7], s36 offen offset:2048 lds
    v_mfma_f32_16x16x32_bf16 a[48:51], v[68:71], v[48:51], a[48:51]
    ds_read_b64_tr_b16 v[138:139], v12 offset:17408
    v_mfma_f32_16x16x32_bf16 a[52:55], v[68:71], v[52:55], a[52:55]
    v_mfma_f32_16x16x32_bf16 a[56:59], v[68:71], v[56:59], a[56:59]
    ds_read_b128 v[100:103], v15 offset:2048
    v_mfma_f32_16x16x32_bf16 a[60:63], v[68:71], v[60:63], a[60:63]
    buffer_load_dwordx4 v5, s[4:7], s36 offen offset:3072 lds
    v_mfma_f32_16x16x32_bf16 a[64:67], v[72:75], v[32:35], a[64:67]
    ds_read_b64_tr_b16 v[140:141], v13 offset:16384
    v_mfma_f32_16x16x32_bf16 a[68:71], v[72:75], v[36:39], a[68:71]
    s_add_u32 s37, s58, 2097152
    s_and_b32 s37, s37, 4194303
    s_add_u32 s37, s37, s39
    v_mfma_f32_16x16x32_bf16 a[72:75], v[72:75], v[40:43], a[72:75]
    s_add_u32 m0, s43, 0
    ds_read_b64_tr_b16 v[142:143], v13 offset:17408
    v_mfma_f32_16x16x32_bf16 a[76:79], v[72:75], v[44:47], a[76:79]
    buffer_load_dwordx4 v6, s[8:11], s37 offen offset:0 lds
    v_mfma_f32_16x16x32_bf16 a[80:83], v[72:75], v[48:51], a[80:83]
    ds_read_b128 v[104:107], v15 offset:4096
    v_mfma_f32_16x16x32_bf16 a[84:87], v[72:75], v[52:55], a[84:87]
    v_mfma_f32_16x16x32_bf16 a[88:91], v[72:75], v[56:59], a[88:91]
    ds_read_b64_tr_b16 v[144:145], v10 offset:18432
    v_mfma_f32_16x16x32_bf16 a[92:95], v[72:75], v[60:63], a[92:95]
    buffer_load_dwordx4 v7, s[8:11], s37 offen offset:1024 lds
    v_mfma_f32_16x16x32_bf16 a[96:99], v[76:79], v[32:35], a[96:99]
    ds_read_b64_tr_b16 v[146:147], v10 offset:19456
    v_mfma_f32_16x16x32_bf16 a[100:103], v[76:79], v[36:39], a[100:103]
    v_mfma_f32_16x16x32_bf16 a[104:107], v[76:79], v[40:43], a[104:107]
    s_add_u32 m0, s43, 2048
    ds_read_b128 v[108:111], v15 offset:6144
    v_mfma_f32_16x16x32_bf16 a[108:111], v[76:79], v[44:47], a[108:111]
    buffer_load_dwordx4 v6, s[12:15], s37 offen offset:0 lds
    v_mfma_f32_16x16x32_bf16 a[112:115], v[76:79], v[48:51], a[112:115]
    ds_read_b64_tr_b16 v[148:149], v11 offset:18432
    v_mfma_f32_16x16x32_bf16 a[116:119], v[76:79], v[52:55], a[116:119]
    v_mfma_f32_16x16x32_bf16 a[120:123], v[76:79], v[56:59], a[120:123]
    ds_read_b64_tr_b16 v[150:151], v11 offset:19456
    v_mfma_f32_16x16x32_bf16 a[124:127], v[76:79], v[60:63], a[124:127]
    buffer_load_dwordx4 v7, s[12:15], s37 offen offset:1024 lds
    v_mfma_f32_16x16x32_bf16 a[128:131], v[32:35], v[80:83], a[128:131]
    ds_read_b128 v[112:115], v15 offset:8192
    v_mfma_f32_16x16x32_bf16 a[132:135], v[36:39], v[80:83], a[132:135]
    buffer_load_dwordx2 v[160:161], v1, s[16:19], 0 offen offset:0
    v_mfma_f32_16x16x32_bf16 a[136:139], v[40:43], v[80:83], a[136:139]
    ds_read_b64_tr_b16 v[152:153], v12 offset:18432
    v_mfma_f32_16x16x32_bf16 a[140:143], v[44:47], v[80:83], a[140:143]
    buffer_load_dwordx2 v[162:163], v1, s[16:19], 0 offen offset:2048
    v_mfma_f32_16x16x32_bf16 a[144:147], v[48:51], v[80:83], a[144:147]
    ds_read_b64_tr_b16 v[154:155], v12 offset:19456
    v_mfma_f32_16x16x32_bf16 a[148:151], v[52:55], v[80:83], a[148:151]
    buffer_load_dwordx2 v[164:165], v1, s[16:19], s47 offen offset:0
    v_mfma_f32_16x16x32_bf16 a[152:155], v[56:59], v[80:83], a[152:155]
    ds_read_b128 v[116:119], v15 offset:10240
    v_mfma_f32_16x16x32_bf16 a[156:159], v[60:63], v[80:83], a[156:159]
    buffer_load_dwordx2 v[166:167], v0, s[16:19], 0 offen offset:0
    v_mfma_f32_16x16x32_bf16 a[160:163], v[32:35], v[84:87], a[160:163]
    ds_read_b64_tr_b16 v[156:157], v13 offset:18432
    v_mfma_f32_16x16x32_bf16 a[164:167], v[36:39], v[84:87], a[164:167]
    buffer_load_dwordx2 v[168:169], v0, s[16:19], 0 offen offset:2048
    v_mfma_f32_16x16x32_bf16 a[168:171], v[40:43], v[84:87], a[168:171]
    ds_read_b64_tr_b16 v[158:159], v13 offset:19456
    v_mfma_f32_16x16x32_bf16 a[172:175], v[44:47], v[84:87], a[172:175]
    buffer_load_dwordx2 v[170:171], v0, s[16:19], s47 offen offset:0
    v_mfma_f32_16x16x32_bf16 a[176:179], v[48:51], v[84:87], a[176:179]
    ds_read_b128 v[120:123], v15 offset:12288
    v_mfma_f32_16x16x32_bf16 a[180:183], v[52:55], v[84:87], a[180:183]
    buffer_load_dwordx2 v[172:173], v0, s[16:19], s47 offen offset:2048
    v_mfma_f32_16x16x32_bf16 a[184:187], v[56:59], v[84:87], a[184:187]
    ds_read_b128 v[124:127], v15 offset:14336
    v_mfma_f32_16x16x32_bf16 a[188:191], v[60:63], v[84:87], a[188:191]
    buffer_load_dwordx2 v[174:175], v0, s[16:19], s48 offen offset:0
    v_mfma_f32_16x16x32_bf16 a[192:195], v[32:35], v[88:91], a[192:195]
    buffer_load_dwordx2 v[176:177], v0, s[16:19], s48 offen offset:2048
    v_mfma_f32_16x16x32_bf16 a[196:199], v[36:39], v[88:91], a[196:199]
    buffer_load_dwordx2 v[178:179], v0, s[16:19], s51 offen offset:0
    v_mfma_f32_16x16x32_bf16 a[200:203], v[40:43], v[88:91], a[200:203]
    buffer_load_dwordx2 v[180:181], v0, s[16:19], s51 offen offset:2048
    v_mfma_f32_16x16x32_bf16 a[204:207], v[44:47], v[88:91], a[204:207]
    buffer_load_dwordx2 v[182:183], v0, s[76:79], 0 offen offset:0
    v_mfma_f32_16x16x32_bf16 a[208:211], v[48:51], v[88:91], a[208:211]
    buffer_load_dwordx2 v[184:185], v0, s[76:79], 0 offen offset:2048
    v_mfma_f32_16x16x32_bf16 a[212:215], v[52:55], v[88:91], a[212:215]
    buffer_load_dwordx2 v[186:187], v0, s[76:79], s47 offen offset:0
    v_mfma_f32_16x16x32_bf16 a[216:219], v[56:59], v[88:91], a[216:219]
    buffer_load_dwordx2 v[188:189], v0, s[76:79], s47 offen offset:2048
    v_mfma_f32_16x16x32_bf16 a[220:223], v[60:63], v[88:91], a[220:223]
    buffer_load_dwordx2 v[190:191], v0, s[76:79], s48 offen offset:0
    v_mfma_f32_16x16x32_bf16 a[224:227], v[32:35], v[92:95], a[224:227]
    buffer_load_dwordx2 v[192:193], v0, s[76:79], s48 offen offset:2048
    v_mfma_f32_16x16x32_bf16 a[228:231], v[36:39], v[92:95], a[228:231]
    buffer_load_dwordx2 v[194:195], v0, s[76:79], s51 offen offset:0
    v_mfma_f32_16x16x32_bf16 a[232:235], v[40:43], v[92:95], a[232:235]
    buffer_load_dwordx2 v[196:197], v0, s[76:79], s51 offen offset:2048
    v_mfma_f32_16x16x32_bf16 a[236:239], v[44:47], v[92:95], a[236:239]
    v_mfma_f32_16x16x32_bf16 a[240:243], v[48:51], v[92:95], a[240:243]
    v_mfma_f32_16x16x32_bf16 a[244:247], v[52:55], v[92:95], a[244:247]
    v_mfma_f32_16x16x32_bf16 a[248:251], v[56:59], v[92:95], a[248:251]
    v_mfma_f32_16x16x32_bf16 a[252:255], v[60:63], v[92:95], a[252:255]
    s_waitcnt vmcnt(35) lgkmcnt(0)
    s_barrier
    v_mfma_f32_16x16x32_bf16 a[0:3], v[128:131], v[96:99], a[0:3]
    s_mov_b32 s16, s88
    ds_read_b64_tr_b16 v[64:65], v10 offset:32768
    v_mfma_f32_16x16x32_bf16 a[4:7], v[128:131], v[100:103], a[4:7]
    s_add_u32 s36, s35, 640
    s_and_b32 s36, s36, 1023
    s_add_u32 s36, s36, s38
    v_mfma_f32_16x16x32_bf16 a[8:11], v[128:131], v[104:107], a[8:11]
    s_add_u32 m0, s42, 65536
    ds_read_b64_tr_b16 v[66:67], v10 offset:33792
    v_mfma_f32_16x16x32_bf16 a[12:15], v[128:131], v[108:111], a[12:15]
    buffer_load_dwordx4 v2, s[4:7], s36 offen offset:0 lds
    v_mfma_f32_16x16x32_bf16 a[16:19], v[128:131], v[112:115], a[16:19]
    s_mov_b32 s17, s89
    ds_read_b64_tr_b16 v[68:69], v11 offset:32768
    v_mfma_f32_16x16x32_bf16 a[20:23], v[128:131], v[116:119], a[20:23]
    s_mov_b32 s18, 2048
    v_mfma_f32_16x16x32_bf16 a[24:27], v[128:131], v[120:123], a[24:27]
    s_mov_b32 s76, s70
    ds_read_b64_tr_b16 v[70:71], v11 offset:33792
    v_mfma_f32_16x16x32_bf16 a[28:31], v[128:131], v[124:127], a[28:31]
    buffer_load_dwordx4 v3, s[4:7], s36 offen offset:1024 lds
    v_mfma_f32_16x16x32_bf16 a[32:35], v[132:135], v[96:99], a[32:35]
    s_mov_b32 s77, s71
    ds_read_b128 v[32:35], v8 offset:0
    v_mfma_f32_16x16x32_bf16 a[36:39], v[132:135], v[100:103], a[36:39]
    s_mov_b32 s78, 8192
    v_mfma_f32_16x16x32_bf16 a[40:43], v[132:135], v[104:107], a[40:43]
    ds_read_b64_tr_b16 v[72:73], v12 offset:32768
    v_mfma_f32_16x16x32_bf16 a[44:47], v[132:135], v[108:111], a[44:47]
    buffer_load_dwordx4 v4, s[4:7], s36 offen offset:2048 lds
    v_mfma_f32_16x16x32_bf16 a[48:51], v[132:135], v[112:115], a[48:51]
    ds_read_b64_tr_b16 v[74:75], v12 offset:33792
    v_mfma_f32_16x16x32_bf16 a[52:55], v[132:135], v[116:119], a[52:55]
    v_mfma_f32_16x16x32_bf16 a[56:59], v[132:135], v[120:123], a[56:59]
    ds_read_b128 v[36:39], v8 offset:2048
    v_mfma_f32_16x16x32_bf16 a[60:63], v[132:135], v[124:127], a[60:63]
    buffer_load_dwordx4 v5, s[4:7], s36 offen offset:3072 lds
    v_mfma_f32_16x16x32_bf16 a[64:67], v[136:139], v[96:99], a[64:67]
    ds_read_b64_tr_b16 v[76:77], v13 offset:32768
    v_mfma_f32_16x16x32_bf16 a[68:71], v[136:139], v[100:103], a[68:71]
    s_add_u32 s37, s58, 2359296
    s_and_b32 s37, s37, 4194303
    s_add_u32 s37, s37, s39
    v_mfma_f32_16x16x32_bf16 a[72:75], v[136:139], v[104:107], a[72:75]
    s_add_u32 m0, s43, 16384
    ds_read_b64_tr_b16 v[78:79], v13 offset:33792
    v_mfma_f32_16x16x32_bf16 a[76:79], v[136:139], v[108:111], a[76:79]
    buffer_load_dwordx4 v6, s[8:11], s37 offen offset:0 lds
    v_mfma_f32_16x16x32_bf16 a[80:83], v[136:139], v[112:115], a[80:83]
    ds_read_b128 v[40:43], v8 offset:4096
    v_mfma_f32_16x16x32_bf16 a[84:87], v[136:139], v[116:119], a[84:87]
    v_mfma_f32_16x16x32_bf16 a[88:91], v[136:139], v[120:123], a[88:91]
    ds_read_b64_tr_b16 v[80:81], v10 offset:34816
    v_mfma_f32_16x16x32_bf16 a[92:95], v[136:139], v[124:127], a[92:95]
    buffer_load_dwordx4 v7, s[8:11], s37 offen offset:1024 lds
    v_mfma_f32_16x16x32_bf16 a[96:99], v[140:143], v[96:99], a[96:99]
    ds_read_b64_tr_b16 v[82:83], v10 offset:35840
    v_mfma_f32_16x16x32_bf16 a[100:103], v[140:143], v[100:103], a[100:103]
    v_mfma_f32_16x16x32_bf16 a[104:107], v[140:143], v[104:107], a[104:107]
    s_add_u32 m0, s43, 18432
    ds_read_b128 v[44:47], v8 offset:6144
    v_mfma_f32_16x16x32_bf16 a[108:111], v[140:143], v[108:111], a[108:111]
    buffer_load_dwordx4 v6, s[12:15], s37 offen offset:0 lds
    v_mfma_f32_16x16x32_bf16 a[112:115], v[140:143], v[112:115], a[112:115]
    ds_read_b64_tr_b16 v[84:85], v11 offset:34816
    v_mfma_f32_16x16x32_bf16 a[116:119], v[140:143], v[116:119], a[116:119]
    v_mfma_f32_16x16x32_bf16 a[120:123], v[140:143], v[120:123], a[120:123]
    ds_read_b64_tr_b16 v[86:87], v11 offset:35840
    v_mfma_f32_16x16x32_bf16 a[124:127], v[140:143], v[124:127], a[124:127]
    buffer_load_dwordx4 v7, s[12:15], s37 offen offset:1024 lds
    v_mfma_f32_16x16x32_bf16 a[128:131], v[96:99], v[144:147], a[128:131]
    ds_read_b128 v[48:51], v8 offset:8192
    v_mfma_f32_16x16x32_bf16 a[132:135], v[100:103], v[144:147], a[132:135]
    v_mfma_f32_16x16x32_bf16 a[136:139], v[104:107], v[144:147], a[136:139]
    ds_read_b64_tr_b16 v[88:89], v12 offset:34816
    v_mfma_f32_16x16x32_bf16 a[140:143], v[108:111], v[144:147], a[140:143]
    v_mfma_f32_16x16x32_bf16 a[144:147], v[112:115], v[144:147], a[144:147]
    ds_read_b64_tr_b16 v[90:91], v12 offset:35840
    v_mfma_f32_16x16x32_bf16 a[148:151], v[116:119], v[144:147], a[148:151]
    v_mfma_f32_16x16x32_bf16 a[152:155], v[120:123], v[144:147], a[152:155]
    ds_read_b128 v[52:55], v8 offset:10240
    v_mfma_f32_16x16x32_bf16 a[156:159], v[124:127], v[144:147], a[156:159]
    v_mfma_f32_16x16x32_bf16 a[160:163], v[96:99], v[148:151], a[160:163]
    ds_read_b64_tr_b16 v[92:93], v13 offset:34816
    v_mfma_f32_16x16x32_bf16 a[164:167], v[100:103], v[148:151], a[164:167]
    v_mfma_f32_16x16x32_bf16 a[168:171], v[104:107], v[148:151], a[168:171]
    ds_read_b64_tr_b16 v[94:95], v13 offset:35840
    v_mfma_f32_16x16x32_bf16 a[172:175], v[108:111], v[148:151], a[172:175]
    v_mfma_f32_16x16x32_bf16 a[176:179], v[112:115], v[148:151], a[176:179]
    ds_read_b128 v[56:59], v8 offset:12288
    v_mfma_f32_16x16x32_bf16 a[180:183], v[116:119], v[148:151], a[180:183]
    v_mfma_f32_16x16x32_bf16 a[184:187], v[120:123], v[148:151], a[184:187]
    ds_read_b128 v[60:63], v8 offset:14336
    v_mfma_f32_16x16x32_bf16 a[188:191], v[124:127], v[148:151], a[188:191]
    v_mfma_f32_16x16x32_bf16 a[192:195], v[96:99], v[152:155], a[192:195]
    v_mfma_f32_16x16x32_bf16 a[196:199], v[100:103], v[152:155], a[196:199]
    v_mfma_f32_16x16x32_bf16 a[200:203], v[104:107], v[152:155], a[200:203]
    v_mfma_f32_16x16x32_bf16 a[204:207], v[108:111], v[152:155], a[204:207]
    v_mfma_f32_16x16x32_bf16 a[208:211], v[112:115], v[152:155], a[208:211]
    v_mfma_f32_16x16x32_bf16 a[212:215], v[116:119], v[152:155], a[212:215]
    v_mfma_f32_16x16x32_bf16 a[216:219], v[120:123], v[152:155], a[216:219]
    v_mfma_f32_16x16x32_bf16 a[220:223], v[124:127], v[152:155], a[220:223]
    v_mfma_f32_16x16x32_bf16 a[224:227], v[96:99], v[156:159], a[224:227]
    v_mfma_f32_16x16x32_bf16 a[228:231], v[100:103], v[156:159], a[228:231]
    v_mfma_f32_16x16x32_bf16 a[232:235], v[104:107], v[156:159], a[232:235]
    v_mfma_f32_16x16x32_bf16 a[236:239], v[108:111], v[156:159], a[236:239]
    v_mfma_f32_16x16x32_bf16 a[240:243], v[112:115], v[156:159], a[240:243]
    v_mfma_f32_16x16x32_bf16 a[244:247], v[116:119], v[156:159], a[244:247]
    v_mfma_f32_16x16x32_bf16 a[248:251], v[120:123], v[156:159], a[248:251]
    v_mfma_f32_16x16x32_bf16 a[252:255], v[124:127], v[156:159], a[252:255]
    s_waitcnt vmcnt(35) lgkmcnt(0)
    s_barrier
    v_mfma_f32_16x16x32_bf16 a[0:3], v[64:67], v[32:35], a[0:3]
    ds_read_b64_tr_b16 v[128:129], v10 offset:49152
    v_mfma_f32_16x16x32_bf16 a[4:7], v[64:67], v[36:39], a[4:7]
    s_add_u32 s36, s35, 640
    s_and_b32 s36, s36, 1023
    s_add_u32 s36, s36, s59
    v_mfma_f32_16x16x32_bf16 a[8:11], v[64:67], v[40:43], a[8:11]
    s_add_u32 m0, s42, 69632
    ds_read_b64_tr_b16 v[130:131], v10 offset:50176
    v_mfma_f32_16x16x32_bf16 a[12:15], v[64:67], v[44:47], a[12:15]
    buffer_load_dwordx4 v2, s[4:7], s36 offen offset:0 lds
    v_mfma_f32_16x16x32_bf16 a[16:19], v[64:67], v[48:51], a[16:19]
    ds_read_b64_tr_b16 v[132:133], v11 offset:49152
    v_mfma_f32_16x16x32_bf16 a[20:23], v[64:67], v[52:55], a[20:23]
    v_mfma_f32_16x16x32_bf16 a[24:27], v[64:67], v[56:59], a[24:27]
    ds_read_b64_tr_b16 v[134:135], v11 offset:50176
    v_mfma_f32_16x16x32_bf16 a[28:31], v[64:67], v[60:63], a[28:31]
    buffer_load_dwordx4 v3, s[4:7], s36 offen offset:1024 lds
    v_mfma_f32_16x16x32_bf16 a[32:35], v[68:71], v[32:35], a[32:35]
    ds_read_b128 v[96:99], v9 offset:0
    v_mfma_f32_16x16x32_bf16 a[36:39], v[68:71], v[36:39], a[36:39]
    v_mfma_f32_16x16x32_bf16 a[40:43], v[68:71], v[40:43], a[40:43]
    ds_read_b64_tr_b16 v[136:137], v12 offset:49152
    v_mfma_f32_16x16x32_bf16 a[44:47], v[68:71], v[44:47], a[44:47]
    buffer_load_dwordx4 v4, s[4:7], s36 offen offset:2048 lds
    v_mfma_f32_16x16x32_bf16 a[48:51], v[68:71], v[48:51], a[48:51]
    ds_read_b64_tr_b16 v[138:139], v12 offset:50176
    v_mfma_f32_16x16x32_bf16 a[52:55], v[68:71], v[52:55], a[52:55]
    v_mfma_f32_16x16x32_bf16 a[56:59], v[68:71], v[56:59], a[56:59]
    ds_read_b128 v[100:103], v9 offset:2048
    v_mfma_f32_16x16x32_bf16 a[60:63], v[68:71], v[60:63], a[60:63]
    buffer_load_dwordx4 v5, s[4:7], s36 offen offset:3072 lds
    v_mfma_f32_16x16x32_bf16 a[64:67], v[72:75], v[32:35], a[64:67]
    ds_read_b64_tr_b16 v[140:141], v13 offset:49152
    v_mfma_f32_16x16x32_bf16 a[68:71], v[72:75], v[36:39], a[68:71]
    s_add_u32 s37, s58, 2621440
    s_and_b32 s37, s37, 4194303
    s_add_u32 s37, s37, s39
    v_mfma_f32_16x16x32_bf16 a[72:75], v[72:75], v[40:43], a[72:75]
    s_add_u32 m0, s43, 32768
    ds_read_b64_tr_b16 v[142:143], v13 offset:50176
    v_mfma_f32_16x16x32_bf16 a[76:79], v[72:75], v[44:47], a[76:79]
    buffer_load_dwordx4 v6, s[8:11], s37 offen offset:0 lds
    v_mfma_f32_16x16x32_bf16 a[80:83], v[72:75], v[48:51], a[80:83]
    ds_read_b128 v[104:107], v9 offset:4096
    v_mfma_f32_16x16x32_bf16 a[84:87], v[72:75], v[52:55], a[84:87]
    v_mfma_f32_16x16x32_bf16 a[88:91], v[72:75], v[56:59], a[88:91]
    ds_read_b64_tr_b16 v[144:145], v10 offset:51200
    v_mfma_f32_16x16x32_bf16 a[92:95], v[72:75], v[60:63], a[92:95]
    buffer_load_dwordx4 v7, s[8:11], s37 offen offset:1024 lds
    v_mfma_f32_16x16x32_bf16 a[96:99], v[76:79], v[32:35], a[96:99]
    ds_read_b64_tr_b16 v[146:147], v10 offset:52224
    v_mfma_f32_16x16x32_bf16 a[100:103], v[76:79], v[36:39], a[100:103]
    v_mfma_f32_16x16x32_bf16 a[104:107], v[76:79], v[40:43], a[104:107]
    s_add_u32 m0, s43, 34816
    ds_read_b128 v[108:111], v9 offset:6144
    v_mfma_f32_16x16x32_bf16 a[108:111], v[76:79], v[44:47], a[108:111]
    buffer_load_dwordx4 v6, s[12:15], s37 offen offset:0 lds
    v_mfma_f32_16x16x32_bf16 a[112:115], v[76:79], v[48:51], a[112:115]
    ds_read_b64_tr_b16 v[148:149], v11 offset:51200
    v_mfma_f32_16x16x32_bf16 a[116:119], v[76:79], v[52:55], a[116:119]
    v_mfma_f32_16x16x32_bf16 a[120:123], v[76:79], v[56:59], a[120:123]
    ds_read_b64_tr_b16 v[150:151], v11 offset:52224
    v_mfma_f32_16x16x32_bf16 a[124:127], v[76:79], v[60:63], a[124:127]
    buffer_load_dwordx4 v7, s[12:15], s37 offen offset:1024 lds
    v_mfma_f32_16x16x32_bf16 a[128:131], v[32:35], v[80:83], a[128:131]
    ds_read_b128 v[112:115], v9 offset:8192
    v_mfma_f32_16x16x32_bf16 a[132:135], v[36:39], v[80:83], a[132:135]
    v_mfma_f32_16x16x32_bf16 a[136:139], v[40:43], v[80:83], a[136:139]
    ds_read_b64_tr_b16 v[152:153], v12 offset:51200
    v_mfma_f32_16x16x32_bf16 a[140:143], v[44:47], v[80:83], a[140:143]
    v_mfma_f32_16x16x32_bf16 a[144:147], v[48:51], v[80:83], a[144:147]
    ds_read_b64_tr_b16 v[154:155], v12 offset:52224
    v_mfma_f32_16x16x32_bf16 a[148:151], v[52:55], v[80:83], a[148:151]
    v_mfma_f32_16x16x32_bf16 a[152:155], v[56:59], v[80:83], a[152:155]
    ds_read_b128 v[116:119], v9 offset:10240
    v_mfma_f32_16x16x32_bf16 a[156:159], v[60:63], v[80:83], a[156:159]
    v_mfma_f32_16x16x32_bf16 a[160:163], v[32:35], v[84:87], a[160:163]
    ds_read_b64_tr_b16 v[156:157], v13 offset:51200
    v_mfma_f32_16x16x32_bf16 a[164:167], v[36:39], v[84:87], a[164:167]
    v_mfma_f32_16x16x32_bf16 a[168:171], v[40:43], v[84:87], a[168:171]
    ds_read_b64_tr_b16 v[158:159], v13 offset:52224
    v_mfma_f32_16x16x32_bf16 a[172:175], v[44:47], v[84:87], a[172:175]
    v_mfma_f32_16x16x32_bf16 a[176:179], v[48:51], v[84:87], a[176:179]
    ds_read_b128 v[120:123], v9 offset:12288
    v_mfma_f32_16x16x32_bf16 a[180:183], v[52:55], v[84:87], a[180:183]
    v_mfma_f32_16x16x32_bf16 a[184:187], v[56:59], v[84:87], a[184:187]
    ds_read_b128 v[124:127], v9 offset:14336
    v_mfma_f32_16x16x32_bf16 a[188:191], v[60:63], v[84:87], a[188:191]
    v_mfma_f32_16x16x32_bf16 a[192:195], v[32:35], v[88:91], a[192:195]
    v_mfma_f32_16x16x32_bf16 a[196:199], v[36:39], v[88:91], a[196:199]
    v_mfma_f32_16x16x32_bf16 a[200:203], v[40:43], v[88:91], a[200:203]
    v_mfma_f32_16x16x32_bf16 a[204:207], v[44:47], v[88:91], a[204:207]
    v_mfma_f32_16x16x32_bf16 a[208:211], v[48:51], v[88:91], a[208:211]
    v_mfma_f32_16x16x32_bf16 a[212:215], v[52:55], v[88:91], a[212:215]
    v_mfma_f32_16x16x32_bf16 a[216:219], v[56:59], v[88:91], a[216:219]
    v_mfma_f32_16x16x32_bf16 a[220:223], v[60:63], v[88:91], a[220:223]
    v_mfma_f32_16x16x32_bf16 a[224:227], v[32:35], v[92:95], a[224:227]
    v_mfma_f32_16x16x32_bf16 a[228:231], v[36:39], v[92:95], a[228:231]
    v_mfma_f32_16x16x32_bf16 a[232:235], v[40:43], v[92:95], a[232:235]
    v_mfma_f32_16x16x32_bf16 a[236:239], v[44:47], v[92:95], a[236:239]
    v_mfma_f32_16x16x32_bf16 a[240:243], v[48:51], v[92:95], a[240:243]
    v_mfma_f32_16x16x32_bf16 a[244:247], v[52:55], v[92:95], a[244:247]
    v_mfma_f32_16x16x32_bf16 a[248:251], v[56:59], v[92:95], a[248:251]
    v_mfma_f32_16x16x32_bf16 a[252:255], v[60:63], v[92:95], a[252:255]
    s_waitcnt vmcnt(35) lgkmcnt(0)
    s_barrier
    v_mfma_f32_16x16x32_bf16 a[0:3], v[128:131], v[96:99], a[0:3]
    ds_read_b64_tr_b16 v[64:65], v10 offset:0
    v_mfma_f32_16x16x32_bf16 a[4:7], v[128:131], v[100:103], a[4:7]
    s_add_u32 s36, s35, 768
    s_and_b32 s36, s36, 1023
    s_add_u32 s36, s36, s38
    v_mfma_f32_16x16x32_bf16 a[8:11], v[128:131], v[104:107], a[8:11]
    s_add_u32 m0, s42, 0
    ds_read_b64_tr_b16 v[66:67], v10 offset:1024
    v_mfma_f32_16x16x32_bf16 a[12:15], v[128:131], v[108:111], a[12:15]
    buffer_load_dwordx4 v2, s[4:7], s36 offen offset:0 lds
    v_mfma_f32_16x16x32_bf16 a[16:19], v[128:131], v[112:115], a[16:19]
    ds_read_b64_tr_b16 v[68:69], v11 offset:0
    v_mfma_f32_16x16x32_bf16 a[20:23], v[128:131], v[116:119], a[20:23]
    v_mfma_f32_16x16x32_bf16 a[24:27], v[128:131], v[120:123], a[24:27]
    ds_read_b64_tr_b16 v[70:71], v11 offset:1024
    v_mfma_f32_16x16x32_bf16 a[28:31], v[128:131], v[124:127], a[28:31]
    buffer_load_dwordx4 v3, s[4:7], s36 offen offset:1024 lds
    v_mfma_f32_16x16x32_bf16 a[32:35], v[132:135], v[96:99], a[32:35]
    ds_read_b128 v[32:35], v8 offset:32768
    v_mfma_f32_16x16x32_bf16 a[36:39], v[132:135], v[100:103], a[36:39]
    v_mfma_f32_16x16x32_bf16 a[40:43], v[132:135], v[104:107], a[40:43]
    ds_read_b64_tr_b16 v[72:73], v12 offset:0
    v_mfma_f32_16x16x32_bf16 a[44:47], v[132:135], v[108:111], a[44:47]
    buffer_load_dwordx4 v4, s[4:7], s36 offen offset:2048 lds
    v_mfma_f32_16x16x32_bf16 a[48:51], v[132:135], v[112:115], a[48:51]
    ds_read_b64_tr_b16 v[74:75], v12 offset:1024
    v_mfma_f32_16x16x32_bf16 a[52:55], v[132:135], v[116:119], a[52:55]
    v_mfma_f32_16x16x32_bf16 a[56:59], v[132:135], v[120:123], a[56:59]
    ds_read_b128 v[36:39], v8 offset:34816
    v_mfma_f32_16x16x32_bf16 a[60:63], v[132:135], v[124:127], a[60:63]
    buffer_load_dwordx4 v5, s[4:7], s36 offen offset:3072 lds
    v_mfma_f32_16x16x32_bf16 a[64:67], v[136:139], v[96:99], a[64:67]
    ds_read_b64_tr_b16 v[76:77], v13 offset:0
    v_mfma_f32_16x16x32_bf16 a[68:71], v[136:139], v[100:103], a[68:71]
    s_add_u32 s37, s58, 2883584
    s_and_b32 s37, s37, 4194303
    s_add_u32 s37, s37, s39
    v_mfma_f32_16x16x32_bf16 a[72:75], v[136:139], v[104:107], a[72:75]
    s_add_u32 m0, s43, 49152
    ds_read_b64_tr_b16 v[78:79], v13 offset:1024
    v_mfma_f32_16x16x32_bf16 a[76:79], v[136:139], v[108:111], a[76:79]
    buffer_load_dwordx4 v6, s[8:11], s37 offen offset:0 lds
    v_mfma_f32_16x16x32_bf16 a[80:83], v[136:139], v[112:115], a[80:83]
    ds_read_b128 v[40:43], v8 offset:36864
    v_mfma_f32_16x16x32_bf16 a[84:87], v[136:139], v[116:119], a[84:87]
    v_mfma_f32_16x16x32_bf16 a[88:91], v[136:139], v[120:123], a[88:91]
    ds_read_b64_tr_b16 v[80:81], v10 offset:2048
    v_mfma_f32_16x16x32_bf16 a[92:95], v[136:139], v[124:127], a[92:95]
    buffer_load_dwordx4 v7, s[8:11], s37 offen offset:1024 lds
    v_mfma_f32_16x16x32_bf16 a[96:99], v[140:143], v[96:99], a[96:99]
    ds_read_b64_tr_b16 v[82:83], v10 offset:3072
    v_mfma_f32_16x16x32_bf16 a[100:103], v[140:143], v[100:103], a[100:103]
    v_mfma_f32_16x16x32_bf16 a[104:107], v[140:143], v[104:107], a[104:107]
    s_add_u32 m0, s43, 51200
    ds_read_b128 v[44:47], v8 offset:38912
    v_mfma_f32_16x16x32_bf16 a[108:111], v[140:143], v[108:111], a[108:111]
    buffer_load_dwordx4 v6, s[12:15], s37 offen offset:0 lds
    v_mfma_f32_16x16x32_bf16 a[112:115], v[140:143], v[112:115], a[112:115]
    ds_read_b64_tr_b16 v[84:85], v11 offset:2048
    v_mfma_f32_16x16x32_bf16 a[116:119], v[140:143], v[116:119], a[116:119]
    v_mfma_f32_16x16x32_bf16 a[120:123], v[140:143], v[120:123], a[120:123]
    ds_read_b64_tr_b16 v[86:87], v11 offset:3072
    v_mfma_f32_16x16x32_bf16 a[124:127], v[140:143], v[124:127], a[124:127]
    buffer_load_dwordx4 v7, s[12:15], s37 offen offset:1024 lds
    v_mfma_f32_16x16x32_bf16 a[128:131], v[96:99], v[144:147], a[128:131]
    ds_read_b128 v[48:51], v8 offset:40960
    v_mfma_f32_16x16x32_bf16 a[132:135], v[100:103], v[144:147], a[132:135]
    buffer_load_dwordx4 v[206:209], v233, s[24:27], s40 offen offset:0
    v_mfma_f32_16x16x32_bf16 a[136:139], v[104:107], v[144:147], a[136:139]
    ds_read_b64_tr_b16 v[88:89], v12 offset:2048
    v_mfma_f32_16x16x32_bf16 a[140:143], v[108:111], v[144:147], a[140:143]
    buffer_load_dwordx4 v[210:213], v233, s[24:27], s40 offen offset:1024
    v_mfma_f32_16x16x32_bf16 a[144:147], v[112:115], v[144:147], a[144:147]
    ds_read_b64_tr_b16 v[90:91], v12 offset:3072
    v_mfma_f32_16x16x32_bf16 a[148:151], v[116:119], v[144:147], a[148:151]
    buffer_load_dwordx4 v[214:217], v233, s[24:27], s41 offen offset:0
    v_mfma_f32_16x16x32_bf16 a[152:155], v[120:123], v[144:147], a[152:155]
    ds_read_b128 v[52:55], v8 offset:43008
    v_mfma_f32_16x16x32_bf16 a[156:159], v[124:127], v[144:147], a[156:159]
    buffer_load_dwordx4 v[218:221], v233, s[24:27], s41 offen offset:1024
    v_mfma_f32_16x16x32_bf16 a[160:163], v[96:99], v[148:151], a[160:163]
    ds_read_b64_tr_b16 v[92:93], v13 offset:2048
    v_mfma_f32_16x16x32_bf16 a[164:167], v[100:103], v[148:151], a[164:167]
    buffer_load_dwordx4 v[222:225], v233, s[16:19], 0 offen offset:0
    v_mfma_f32_16x16x32_bf16 a[168:171], v[104:107], v[148:151], a[168:171]
    ds_read_b64_tr_b16 v[94:95], v13 offset:3072
    v_mfma_f32_16x16x32_bf16 a[172:175], v[108:111], v[148:151], a[172:175]
    buffer_load_dwordx4 v[226:229], v233, s[16:19], 0 offen offset:1024
    v_mfma_f32_16x16x32_bf16 a[176:179], v[112:115], v[148:151], a[176:179]
    ds_read_b128 v[56:59], v8 offset:45056
    v_mfma_f32_16x16x32_bf16 a[180:183], v[116:119], v[148:151], a[180:183]
    buffer_load_dwordx4 v[198:201], v232, s[76:79], 0 offen offset:0
    v_mfma_f32_16x16x32_bf16 a[184:187], v[120:123], v[148:151], a[184:187]
    ds_read_b128 v[60:63], v8 offset:47104
    v_mfma_f32_16x16x32_bf16 a[188:191], v[124:127], v[148:151], a[188:191]
    buffer_load_dwordx4 v[202:205], v232, s[76:79], 0 offen offset:16
    v_mfma_f32_16x16x32_bf16 a[192:195], v[96:99], v[152:155], a[192:195]
    buffer_store_dword v241, v241, s[28:31], s55 offen sc1
    v_mfma_f32_16x16x32_bf16 a[196:199], v[100:103], v[152:155], a[196:199]
    buffer_store_dword v241, v241, s[28:31], s56 offen sc1
    v_mfma_f32_16x16x32_bf16 a[200:203], v[104:107], v[152:155], a[200:203]
    buffer_store_dword v241, v241, s[28:31], s57 offen sc1
    v_mfma_f32_16x16x32_bf16 a[204:207], v[108:111], v[152:155], a[204:207]
    buffer_store_dword v241, v241, s[28:31], s3 offen sc1
    v_mfma_f32_16x16x32_bf16 a[208:211], v[112:115], v[152:155], a[208:211]
    v_mfma_f32_16x16x32_bf16 a[212:215], v[116:119], v[152:155], a[212:215]
    v_mfma_f32_16x16x32_bf16 a[216:219], v[120:123], v[152:155], a[216:219]
    v_mfma_f32_16x16x32_bf16 a[220:223], v[124:127], v[152:155], a[220:223]
    v_mfma_f32_16x16x32_bf16 a[224:227], v[96:99], v[156:159], a[224:227]
    v_mfma_f32_16x16x32_bf16 a[228:231], v[100:103], v[156:159], a[228:231]
    v_mfma_f32_16x16x32_bf16 a[232:235], v[104:107], v[156:159], a[232:235]
    v_mfma_f32_16x16x32_bf16 a[236:239], v[108:111], v[156:159], a[236:239]
    v_mfma_f32_16x16x32_bf16 a[240:243], v[112:115], v[156:159], a[240:243]
    v_mfma_f32_16x16x32_bf16 a[244:247], v[116:119], v[156:159], a[244:247]
    v_mfma_f32_16x16x32_bf16 a[248:251], v[120:123], v[156:159], a[248:251]
    v_mfma_f32_16x16x32_bf16 a[252:255], v[124:127], v[156:159], a[252:255]
    s_waitcnt vmcnt(28) lgkmcnt(0)
    s_barrier
    v_mfma_f32_16x16x32_bf16 a[0:3], v[64:67], v[32:35], a[0:3]
    ds_read_b64_tr_b16 v[128:129], v10 offset:16384
    v_mfma_f32_16x16x32_bf16 a[4:7], v[64:67], v[36:39], a[4:7]
    s_add_u32 s36, s35, 768
    s_and_b32 s36, s36, 1023
    s_add_u32 s36, s36, s59
    v_mfma_f32_16x16x32_bf16 a[8:11], v[64:67], v[40:43], a[8:11]
    s_add_u32 m0, s42, 4096
    ds_read_b64_tr_b16 v[130:131], v10 offset:17408
    v_mfma_f32_16x16x32_bf16 a[12:15], v[64:67], v[44:47], a[12:15]
    buffer_load_dwordx4 v2, s[4:7], s36 offen offset:0 lds
    v_mfma_f32_16x16x32_bf16 a[16:19], v[64:67], v[48:51], a[16:19]
    ds_read_b64_tr_b16 v[132:133], v11 offset:16384
    v_mfma_f32_16x16x32_bf16 a[20:23], v[64:67], v[52:55], a[20:23]
    v_mfma_f32_16x16x32_bf16 a[24:27], v[64:67], v[56:59], a[24:27]
    ds_read_b64_tr_b16 v[134:135], v11 offset:17408
    v_mfma_f32_16x16x32_bf16 a[28:31], v[64:67], v[60:63], a[28:31]
    buffer_load_dwordx4 v3, s[4:7], s36 offen offset:1024 lds
    v_mfma_f32_16x16x32_bf16 a[32:35], v[68:71], v[32:35], a[32:35]
    ds_read_b128 v[96:99], v9 offset:32768
    v_mfma_f32_16x16x32_bf16 a[36:39], v[68:71], v[36:39], a[36:39]
    v_mfma_f32_16x16x32_bf16 a[40:43], v[68:71], v[40:43], a[40:43]
    ds_read_b64_tr_b16 v[136:137], v12 offset:16384
    v_mfma_f32_16x16x32_bf16 a[44:47], v[68:71], v[44:47], a[44:47]
    buffer_load_dwordx4 v4, s[4:7], s36 offen offset:2048 lds
    v_mfma_f32_16x16x32_bf16 a[48:51], v[68:71], v[48:51], a[48:51]
    ds_read_b64_tr_b16 v[138:139], v12 offset:17408
    v_mfma_f32_16x16x32_bf16 a[52:55], v[68:71], v[52:55], a[52:55]
    v_mfma_f32_16x16x32_bf16 a[56:59], v[68:71], v[56:59], a[56:59]
    ds_read_b128 v[100:103], v9 offset:34816
    v_mfma_f32_16x16x32_bf16 a[60:63], v[68:71], v[60:63], a[60:63]
    buffer_load_dwordx4 v5, s[4:7], s36 offen offset:3072 lds
    v_mfma_f32_16x16x32_bf16 a[64:67], v[72:75], v[32:35], a[64:67]
    ds_read_b64_tr_b16 v[140:141], v13 offset:16384
    v_mfma_f32_16x16x32_bf16 a[68:71], v[72:75], v[36:39], a[68:71]
    s_add_u32 s37, s58, 3145728
    s_and_b32 s37, s37, 4194303
    s_add_u32 s37, s37, s39
    v_mfma_f32_16x16x32_bf16 a[72:75], v[72:75], v[40:43], a[72:75]
    s_add_u32 m0, s43, 0
    ds_read_b64_tr_b16 v[142:143], v13 offset:17408
    v_mfma_f32_16x16x32_bf16 a[76:79], v[72:75], v[44:47], a[76:79]
    buffer_load_dwordx4 v6, s[8:11], s37 offen offset:0 lds
    v_mfma_f32_16x16x32_bf16 a[80:83], v[72:75], v[48:51], a[80:83]
    ds_read_b128 v[104:107], v9 offset:36864
    v_mfma_f32_16x16x32_bf16 a[84:87], v[72:75], v[52:55], a[84:87]
    v_mfma_f32_16x16x32_bf16 a[88:91], v[72:75], v[56:59], a[88:91]
    ds_read_b64_tr_b16 v[144:145], v10 offset:18432
    v_mfma_f32_16x16x32_bf16 a[92:95], v[72:75], v[60:63], a[92:95]
    buffer_load_dwordx4 v7, s[8:11], s37 offen offset:1024 lds
    v_mfma_f32_16x16x32_bf16 a[96:99], v[76:79], v[32:35], a[96:99]
    ds_read_b64_tr_b16 v[146:147], v10 offset:19456
    v_mfma_f32_16x16x32_bf16 a[100:103], v[76:79], v[36:39], a[100:103]
    v_mfma_f32_16x16x32_bf16 a[104:107], v[76:79], v[40:43], a[104:107]
    s_add_u32 m0, s43, 2048
    ds_read_b128 v[108:111], v9 offset:38912
    v_mfma_f32_16x16x32_bf16 a[108:111], v[76:79], v[44:47], a[108:111]
    buffer_load_dwordx4 v6, s[12:15], s37 offen offset:0 lds
    v_mfma_f32_16x16x32_bf16 a[112:115], v[76:79], v[48:51], a[112:115]
    ds_read_b64_tr_b16 v[148:149], v11 offset:18432
    v_mfma_f32_16x16x32_bf16 a[116:119], v[76:79], v[52:55], a[116:119]
    v_mfma_f32_16x16x32_bf16 a[120:123], v[76:79], v[56:59], a[120:123]
    ds_read_b64_tr_b16 v[150:151], v11 offset:19456
    v_mfma_f32_16x16x32_bf16 a[124:127], v[76:79], v[60:63], a[124:127]
    buffer_load_dwordx4 v7, s[12:15], s37 offen offset:1024 lds
    v_mfma_f32_16x16x32_bf16 a[128:131], v[32:35], v[80:83], a[128:131]
    ds_read_b128 v[112:115], v9 offset:40960
    v_mfma_f32_16x16x32_bf16 a[132:135], v[36:39], v[80:83], a[132:135]
    v_mfma_f32_16x16x32_bf16 a[136:139], v[40:43], v[80:83], a[136:139]
    ds_read_b64_tr_b16 v[152:153], v12 offset:18432
    v_mfma_f32_16x16x32_bf16 a[140:143], v[44:47], v[80:83], a[140:143]
    v_mfma_f32_16x16x32_bf16 a[144:147], v[48:51], v[80:83], a[144:147]
    ds_read_b64_tr_b16 v[154:155], v12 offset:19456
    v_mfma_f32_16x16x32_bf16 a[148:151], v[52:55], v[80:83], a[148:151]
    v_mfma_f32_16x16x32_bf16 a[152:155], v[56:59], v[80:83], a[152:155]
    ds_read_b128 v[116:119], v9 offset:43008
    v_mfma_f32_16x16x32_bf16 a[156:159], v[60:63], v[80:83], a[156:159]
    v_mfma_f32_16x16x32_bf16 a[160:163], v[32:35], v[84:87], a[160:163]
    ds_read_b64_tr_b16 v[156:157], v13 offset:18432
    v_mfma_f32_16x16x32_bf16 a[164:167], v[36:39], v[84:87], a[164:167]
gated_mix__ssm_conv_h3__compressed_kv_cla__prompt_kernel_pad1:
    s_cbranch_execz gated_mix__ssm_conv_h3__compressed_kv_cla__prompt_kernel_pad5
    v_mfma_f32_16x16x32_bf16 a[168:171], v[40:43], v[84:87], a[168:171]
    ds_read_b64_tr_b16 v[158:159], v13 offset:19456
    v_mfma_f32_16x16x32_bf16 a[172:175], v[44:47], v[84:87], a[172:175]
    v_mfma_f32_16x16x32_bf16 a[176:179], v[48:51], v[84:87], a[176:179]
    ds_read_b128 v[120:123], v9 offset:45056
    v_mfma_f32_16x16x32_bf16 a[180:183], v[52:55], v[84:87], a[180:183]
    v_mfma_f32_16x16x32_bf16 a[184:187], v[56:59], v[84:87], a[184:187]
    ds_read_b128 v[124:127], v9 offset:47104
    v_mfma_f32_16x16x32_bf16 a[188:191], v[60:63], v[84:87], a[188:191]
    v_mfma_f32_16x16x32_bf16 a[192:195], v[32:35], v[88:91], a[192:195]
    v_mfma_f32_16x16x32_bf16 a[196:199], v[36:39], v[88:91], a[196:199]
    v_mfma_f32_16x16x32_bf16 a[200:203], v[40:43], v[88:91], a[200:203]
    v_mfma_f32_16x16x32_bf16 a[204:207], v[44:47], v[88:91], a[204:207]
    v_mfma_f32_16x16x32_bf16 a[208:211], v[48:51], v[88:91], a[208:211]
    v_mfma_f32_16x16x32_bf16 a[212:215], v[52:55], v[88:91], a[212:215]
    v_mfma_f32_16x16x32_bf16 a[216:219], v[56:59], v[88:91], a[216:219]
    v_mfma_f32_16x16x32_bf16 a[220:223], v[60:63], v[88:91], a[220:223]
    v_mfma_f32_16x16x32_bf16 a[224:227], v[32:35], v[92:95], a[224:227]
    v_mfma_f32_16x16x32_bf16 a[228:231], v[36:39], v[92:95], a[228:231]
    v_mfma_f32_16x16x32_bf16 a[232:235], v[40:43], v[92:95], a[232:235]
    v_mfma_f32_16x16x32_bf16 a[236:239], v[44:47], v[92:95], a[236:239]
    v_mfma_f32_16x16x32_bf16 a[240:243], v[48:51], v[92:95], a[240:243]
    v_mfma_f32_16x16x32_bf16 a[244:247], v[52:55], v[92:95], a[244:247]
    v_mfma_f32_16x16x32_bf16 a[248:251], v[56:59], v[92:95], a[248:251]
    v_mfma_f32_16x16x32_bf16 a[252:255], v[60:63], v[92:95], a[252:255]
    s_waitcnt vmcnt(28) lgkmcnt(0)
    s_barrier
    v_mfma_f32_16x16x32_bf16 a[0:3], v[128:131], v[96:99], a[0:3]
    s_mov_b32 s76, s92
    ds_read_b64_tr_b16 v[64:65], v10 offset:32768
    v_mfma_f32_16x16x32_bf16 a[4:7], v[128:131], v[100:103], a[4:7]
    s_add_u32 s36, s35, 896
    s_and_b32 s36, s36, 1023
    s_add_u32 s36, s36, s38
    v_mfma_f32_16x16x32_bf16 a[8:11], v[128:131], v[104:107], a[8:11]
    s_add_u32 m0, s42, 32768
    ds_read_b64_tr_b16 v[66:67], v10 offset:33792
    v_mfma_f32_16x16x32_bf16 a[12:15], v[128:131], v[108:111], a[12:15]
    buffer_load_dwordx4 v2, s[4:7], s36 offen offset:0 lds
    v_mfma_f32_16x16x32_bf16 a[16:19], v[128:131], v[112:115], a[16:19]
    s_mov_b32 s77, s93
    ds_read_b64_tr_b16 v[68:69], v11 offset:32768
    v_mfma_f32_16x16x32_bf16 a[20:23], v[128:131], v[116:119], a[20:23]
    s_mov_b32 s78, 256
    v_mfma_f32_16x16x32_bf16 a[24:27], v[128:131], v[120:123], a[24:27]
    s_mov_b32 s79, 0x00020000
    ds_read_b64_tr_b16 v[70:71], v11 offset:33792
    v_mfma_f32_16x16x32_bf16 a[28:31], v[128:131], v[124:127], a[28:31]
    buffer_load_dwordx4 v3, s[4:7], s36 offen offset:1024 lds
    v_mfma_f32_16x16x32_bf16 a[32:35], v[132:135], v[96:99], a[32:35]
    s_getreg_b32 s88, hwreg(HW_REG_XCC_ID, 0, 3)
    ds_read_b128 v[32:35], v14 offset:0
    v_mfma_f32_16x16x32_bf16 a[36:39], v[132:135], v[100:103], a[36:39]
    s_lshl_b32 s88, s88, 2
    v_mfma_f32_16x16x32_bf16 a[40:43], v[132:135], v[104:107], a[40:43]
    s_lshl_b32 s88, 1, s88
    ds_read_b64_tr_b16 v[72:73], v12 offset:32768
    v_mfma_f32_16x16x32_bf16 a[44:47], v[132:135], v[108:111], a[44:47]
    buffer_load_dwordx4 v4, s[4:7], s36 offen offset:2048 lds
    v_mfma_f32_16x16x32_bf16 a[48:51], v[132:135], v[112:115], a[48:51]
    ds_read_b64_tr_b16 v[74:75], v12 offset:33792
    v_or_b32 v242, s32, v16
    v_mfma_f32_16x16x32_bf16 a[52:55], v[132:135], v[116:119], a[52:55]
    v_mov_b32 v243, 0x80000000
    v_cmp_eq_u32 vcc, 0, v242
    v_mfma_f32_16x16x32_bf16 a[56:59], v[132:135], v[120:123], a[56:59]
    ds_read_b128 v[36:39], v14 offset:2048
    v_mov_b32 v241, s88
    v_mfma_f32_16x16x32_bf16 a[60:63], v[132:135], v[124:127], a[60:63]
    buffer_load_dwordx4 v5, s[4:7], s36 offen offset:3072 lds
    v_mfma_f32_16x16x32_bf16 a[64:67], v[136:139], v[96:99], a[64:67]
    s_lshl_b32 s88, s33, 3
    ds_read_b64_tr_b16 v[76:77], v13 offset:32768
    v_mfma_f32_16x16x32_bf16 a[68:71], v[136:139], v[100:103], a[68:71]
    s_add_u32 s37, s58, 3407872
    s_and_b32 s37, s37, 4194303
    s_add_u32 s37, s37, s39
    v_mfma_f32_16x16x32_bf16 a[72:75], v[136:139], v[104:107], a[72:75]
    s_add_u32 m0, s43, 16384
    ds_read_b64_tr_b16 v[78:79], v13 offset:33792
    v_cndmask_b32 v242, v243, v242, vcc
    v_mfma_f32_16x16x32_bf16 a[76:79], v[136:139], v[108:111], a[76:79]
    buffer_load_dwordx4 v6, s[8:11], s37 offen offset:0 lds
    v_mfma_f32_16x16x32_bf16 a[80:83], v[136:139], v[112:115], a[80:83]
    ds_read_b128 v[40:43], v14 offset:4096
    v_mfma_f32_16x16x32_bf16 a[84:87], v[136:139], v[116:119], a[84:87]
    v_mfma_f32_16x16x32_bf16 a[88:91], v[136:139], v[120:123], a[88:91]
    ds_read_b64_tr_b16 v[80:81], v10 offset:34816
    v_mfma_f32_16x16x32_bf16 a[92:95], v[136:139], v[124:127], a[92:95]
    buffer_load_dwordx4 v7, s[8:11], s37 offen offset:1024 lds
    v_mfma_f32_16x16x32_bf16 a[96:99], v[140:143], v[96:99], a[96:99]
    ds_read_b64_tr_b16 v[82:83], v10 offset:35840
    v_mfma_f32_16x16x32_bf16 a[100:103], v[140:143], v[100:103], a[100:103]
    v_mfma_f32_16x16x32_bf16 a[104:107], v[140:143], v[104:107], a[104:107]
    s_add_u32 m0, s43, 18432
    ds_read_b128 v[44:47], v14 offset:6144
    v_mfma_f32_16x16x32_bf16 a[108:111], v[140:143], v[108:111], a[108:111]
    buffer_load_dwordx4 v6, s[12:15], s37 offen offset:0 lds
    v_mfma_f32_16x16x32_bf16 a[112:115], v[140:143], v[112:115], a[112:115]
    ds_read_b64_tr_b16 v[84:85], v11 offset:34816
    v_mfma_f32_16x16x32_bf16 a[116:119], v[140:143], v[116:119], a[116:119]
    v_mfma_f32_16x16x32_bf16 a[120:123], v[140:143], v[120:123], a[120:123]
    ds_read_b64_tr_b16 v[86:87], v11 offset:35840
    v_mfma_f32_16x16x32_bf16 a[124:127], v[140:143], v[124:127], a[124:127]
    buffer_load_dwordx4 v7, s[12:15], s37 offen offset:1024 lds
    v_mfma_f32_16x16x32_bf16 a[128:131], v[96:99], v[144:147], a[128:131]
    ds_read_b128 v[48:51], v14 offset:8192
    v_mfma_f32_16x16x32_bf16 a[132:135], v[100:103], v[144:147], a[132:135]
    v_mfma_f32_16x16x32_bf16 a[136:139], v[104:107], v[144:147], a[136:139]
    ds_read_b64_tr_b16 v[88:89], v12 offset:34816
    v_mfma_f32_16x16x32_bf16 a[140:143], v[108:111], v[144:147], a[140:143]
    v_mfma_f32_16x16x32_bf16 a[144:147], v[112:115], v[144:147], a[144:147]
    ds_read_b64_tr_b16 v[90:91], v12 offset:35840
    v_mfma_f32_16x16x32_bf16 a[148:151], v[116:119], v[144:147], a[148:151]
    v_mfma_f32_16x16x32_bf16 a[152:155], v[120:123], v[144:147], a[152:155]
    ds_read_b128 v[52:55], v14 offset:10240
    v_mfma_f32_16x16x32_bf16 a[156:159], v[124:127], v[144:147], a[156:159]
    v_mfma_f32_16x16x32_bf16 a[160:163], v[96:99], v[148:151], a[160:163]
    ds_read_b64_tr_b16 v[92:93], v13 offset:34816
    v_mfma_f32_16x16x32_bf16 a[164:167], v[100:103], v[148:151], a[164:167]
    v_mfma_f32_16x16x32_bf16 a[168:171], v[104:107], v[148:151], a[168:171]
    ds_read_b64_tr_b16 v[94:95], v13 offset:35840
    v_mfma_f32_16x16x32_bf16 a[172:175], v[108:111], v[148:151], a[172:175]
    v_mfma_f32_16x16x32_bf16 a[176:179], v[112:115], v[148:151], a[176:179]
    ds_read_b128 v[56:59], v14 offset:12288
    v_mfma_f32_16x16x32_bf16 a[180:183], v[116:119], v[148:151], a[180:183]
    v_mfma_f32_16x16x32_bf16 a[184:187], v[120:123], v[148:151], a[184:187]
    ds_read_b128 v[60:63], v14 offset:14336
    v_mfma_f32_16x16x32_bf16 a[188:191], v[124:127], v[148:151], a[188:191]
    v_mfma_f32_16x16x32_bf16 a[192:195], v[96:99], v[152:155], a[192:195]
    v_mfma_f32_16x16x32_bf16 a[196:199], v[100:103], v[152:155], a[196:199]
    v_mfma_f32_16x16x32_bf16 a[200:203], v[104:107], v[152:155], a[200:203]
    v_mfma_f32_16x16x32_bf16 a[204:207], v[108:111], v[152:155], a[204:207]
    v_mfma_f32_16x16x32_bf16 a[208:211], v[112:115], v[152:155], a[208:211]
    v_mfma_f32_16x16x32_bf16 a[212:215], v[116:119], v[152:155], a[212:215]
    v_mfma_f32_16x16x32_bf16 a[216:219], v[120:123], v[152:155], a[216:219]
    v_mfma_f32_16x16x32_bf16 a[220:223], v[124:127], v[152:155], a[220:223]
    v_mfma_f32_16x16x32_bf16 a[224:227], v[96:99], v[156:159], a[224:227]
    v_mfma_f32_16x16x32_bf16 a[228:231], v[100:103], v[156:159], a[228:231]
    v_mfma_f32_16x16x32_bf16 a[232:235], v[104:107], v[156:159], a[232:235]
    v_mfma_f32_16x16x32_bf16 a[236:239], v[108:111], v[156:159], a[236:239]
    v_mfma_f32_16x16x32_bf16 a[240:243], v[112:115], v[156:159], a[240:243]
    v_mfma_f32_16x16x32_bf16 a[244:247], v[116:119], v[156:159], a[244:247]
    v_mfma_f32_16x16x32_bf16 a[248:251], v[120:123], v[156:159], a[248:251]
    v_mfma_f32_16x16x32_bf16 a[252:255], v[124:127], v[156:159], a[252:255]
    s_waitcnt vmcnt(16) lgkmcnt(0)
    s_barrier
    v_mfma_f32_16x16x32_bf16 a[0:3], v[64:67], v[32:35], a[0:3]
    ds_read_b64_tr_b16 v[128:129], v10 offset:49152
    v_lshlrev_b32 v240, 16, v222
    v_mfma_f32_16x16x32_bf16 a[4:7], v[64:67], v[36:39], a[4:7]
    s_add_u32 s36, s35, 896
    s_and_b32 s36, s36, 1023
    s_add_u32 s36, s36, s59
    v_lshlrev_b32 v238, 16, v206
    v_lshlrev_b32 v239, 16, v214
    v_mfma_f32_16x16x32_bf16 a[8:11], v[64:67], v[40:43], a[8:11]
    s_add_u32 m0, s42, 36864
    ds_read_b64_tr_b16 v[130:131], v10 offset:50176
    v_mul_f32 v236, v238, v240
    v_mfma_f32_16x16x32_bf16 a[12:15], v[64:67], v[44:47], a[12:15]
    buffer_load_dwordx4 v2, s[4:7], s36 offen offset:0 lds
    v_mfma_f32_16x16x32_bf16 a[16:19], v[64:67], v[48:51], a[16:19]
    ds_read_b64_tr_b16 v[132:133], v11 offset:49152
    v_mul_f32 v237, v239, v240
    v_mfma_f32_16x16x32_bf16 a[20:23], v[64:67], v[52:55], a[20:23]
    v_and_b32 v240, s52, v222
    v_and_b32 v238, s52, v206
    v_mfma_f32_16x16x32_bf16 a[24:27], v[64:67], v[56:59], a[24:27]
    ds_read_b64_tr_b16 v[134:135], v11 offset:50176
    v_and_b32 v239, s52, v214
    v_mfma_f32_16x16x32_bf16 a[28:31], v[64:67], v[60:63], a[28:31]
    buffer_load_dwordx4 v3, s[4:7], s36 offen offset:1024 lds
    v_mfma_f32_16x16x32_bf16 a[32:35], v[68:71], v[32:35], a[32:35]
    ds_read_b128 v[96:99], v15 offset:0
    v_fmac_f32 v236, v238, v240
    v_mfma_f32_16x16x32_bf16 a[36:39], v[68:71], v[36:39], a[36:39]
    v_fmac_f32 v237, v239, v240
    v_lshlrev_b32 v240, 16, v223
    v_mfma_f32_16x16x32_bf16 a[40:43], v[68:71], v[40:43], a[40:43]
    ds_read_b64_tr_b16 v[136:137], v12 offset:49152
    v_lshlrev_b32 v238, 16, v207
    v_mfma_f32_16x16x32_bf16 a[44:47], v[68:71], v[44:47], a[44:47]
    buffer_load_dwordx4 v4, s[4:7], s36 offen offset:2048 lds
    v_mfma_f32_16x16x32_bf16 a[48:51], v[68:71], v[48:51], a[48:51]
    ds_read_b64_tr_b16 v[138:139], v12 offset:50176
    v_lshlrev_b32 v239, 16, v215
    v_mfma_f32_16x16x32_bf16 a[52:55], v[68:71], v[52:55], a[52:55]
    v_fmac_f32 v236, v238, v240
    v_fmac_f32 v237, v239, v240
    v_mfma_f32_16x16x32_bf16 a[56:59], v[68:71], v[56:59], a[56:59]
    ds_read_b128 v[100:103], v15 offset:2048
    v_and_b32 v240, s52, v223
    v_mfma_f32_16x16x32_bf16 a[60:63], v[68:71], v[60:63], a[60:63]
    buffer_load_dwordx4 v5, s[4:7], s36 offen offset:3072 lds
    v_mfma_f32_16x16x32_bf16 a[64:67], v[72:75], v[32:35], a[64:67]
    ds_read_b64_tr_b16 v[140:141], v13 offset:49152
    v_and_b32 v238, s52, v207
    v_mfma_f32_16x16x32_bf16 a[68:71], v[72:75], v[36:39], a[68:71]
    s_add_u32 s37, s58, 3670016
    s_and_b32 s37, s37, 4194303
    s_add_u32 s37, s37, s39
    v_and_b32 v239, s52, v215
    v_fmac_f32 v236, v238, v240
    v_mfma_f32_16x16x32_bf16 a[72:75], v[72:75], v[40:43], a[72:75]
    s_add_u32 m0, s43, 32768
    ds_read_b64_tr_b16 v[142:143], v13 offset:50176
    v_fmac_f32 v237, v239, v240
    v_mfma_f32_16x16x32_bf16 a[76:79], v[72:75], v[44:47], a[76:79]
    buffer_load_dwordx4 v6, s[8:11], s37 offen offset:0 lds
    v_mfma_f32_16x16x32_bf16 a[80:83], v[72:75], v[48:51], a[80:83]
    ds_read_b128 v[104:107], v15 offset:4096
    v_lshlrev_b32 v240, 16, v224
    v_mfma_f32_16x16x32_bf16 a[84:87], v[72:75], v[52:55], a[84:87]
    v_lshlrev_b32 v238, 16, v208
    v_lshlrev_b32 v239, 16, v216
    v_mfma_f32_16x16x32_bf16 a[88:91], v[72:75], v[56:59], a[88:91]
    ds_read_b64_tr_b16 v[144:145], v10 offset:51200
    v_fmac_f32 v236, v238, v240
    v_mfma_f32_16x16x32_bf16 a[92:95], v[72:75], v[60:63], a[92:95]
    buffer_load_dwordx4 v7, s[8:11], s37 offen offset:1024 lds
    v_mfma_f32_16x16x32_bf16 a[96:99], v[76:79], v[32:35], a[96:99]
    ds_read_b64_tr_b16 v[146:147], v10 offset:52224
    v_fmac_f32 v237, v239, v240
    v_mfma_f32_16x16x32_bf16 a[100:103], v[76:79], v[36:39], a[100:103]
    v_and_b32 v240, s52, v224
    v_and_b32 v238, s52, v208
    v_mfma_f32_16x16x32_bf16 a[104:107], v[76:79], v[40:43], a[104:107]
    s_add_u32 m0, s43, 34816
    ds_read_b128 v[108:111], v15 offset:6144
    v_and_b32 v239, s52, v216
    v_mfma_f32_16x16x32_bf16 a[108:111], v[76:79], v[44:47], a[108:111]
    buffer_load_dwordx4 v6, s[12:15], s37 offen offset:0 lds
    v_mfma_f32_16x16x32_bf16 a[112:115], v[76:79], v[48:51], a[112:115]
    ds_read_b64_tr_b16 v[148:149], v11 offset:51200
    v_fmac_f32 v236, v238, v240
    v_mfma_f32_16x16x32_bf16 a[116:119], v[76:79], v[52:55], a[116:119]
    v_fmac_f32 v237, v239, v240
    v_lshlrev_b32 v240, 16, v225
    v_mfma_f32_16x16x32_bf16 a[120:123], v[76:79], v[56:59], a[120:123]
    ds_read_b64_tr_b16 v[150:151], v11 offset:52224
    v_lshlrev_b32 v238, 16, v209
    v_mfma_f32_16x16x32_bf16 a[124:127], v[76:79], v[60:63], a[124:127]
    buffer_load_dwordx4 v7, s[12:15], s37 offen offset:1024 lds
    v_mfma_f32_16x16x32_bf16 a[128:131], v[32:35], v[80:83], a[128:131]
    ds_read_b128 v[112:115], v15 offset:8192
    v_lshlrev_b32 v239, 16, v217
    v_mfma_f32_16x16x32_bf16 a[132:135], v[36:39], v[80:83], a[132:135]
    buffer_load_dword v31, v254, s[20:23], s46 offen
    v_mfma_f32_16x16x32_bf16 a[136:139], v[40:43], v[80:83], a[136:139]
    s_add_u32 s46, s46, 4194304
    ds_read_b64_tr_b16 v[152:153], v12 offset:51200
    v_fmac_f32 v236, v238, v240
    v_mfma_f32_16x16x32_bf16 a[140:143], v[44:47], v[80:83], a[140:143]
    buffer_load_dword v31, v254, s[20:23], s46 offen
    v_mfma_f32_16x16x32_bf16 a[144:147], v[48:51], v[80:83], a[144:147]
    ds_read_b64_tr_b16 v[154:155], v12 offset:52224
    v_fmac_f32 v237, v239, v240
    v_mfma_f32_16x16x32_bf16 a[148:151], v[52:55], v[80:83], a[148:151]
    v_and_b32 v240, s52, v225
    v_and_b32 v238, s52, v209
    v_mfma_f32_16x16x32_bf16 a[152:155], v[56:59], v[80:83], a[152:155]
    ds_read_b128 v[116:119], v15 offset:10240
    v_and_b32 v239, s52, v217
    v_mfma_f32_16x16x32_bf16 a[156:159], v[60:63], v[80:83], a[156:159]
    buffer_atomic_add v241, v242, s[76:79], s88 offen sc1
    v_mfma_f32_16x16x32_bf16 a[160:163], v[32:35], v[84:87], a[160:163]
    ds_read_b64_tr_b16 v[156:157], v13 offset:51200
    v_fmac_f32 v236, v238, v240
    v_mfma_f32_16x16x32_bf16 a[164:167], v[36:39], v[84:87], a[164:167]
    v_fmac_f32 v237, v239, v240
    v_lshlrev_b32 v240, 16, v226
    v_mfma_f32_16x16x32_bf16 a[168:171], v[40:43], v[84:87], a[168:171]
    ds_read_b64_tr_b16 v[158:159], v13 offset:52224
    v_lshlrev_b32 v238, 16, v210
    v_mfma_f32_16x16x32_bf16 a[172:175], v[44:47], v[84:87], a[172:175]
    v_mfma_f32_16x16x32_bf16 a[176:179], v[48:51], v[84:87], a[176:179]
    ds_read_b128 v[120:123], v15 offset:12288
    v_lshlrev_b32 v239, 16, v218
    v_mfma_f32_16x16x32_bf16 a[180:183], v[52:55], v[84:87], a[180:183]
    v_fmac_f32 v236, v238, v240
    v_fmac_f32 v237, v239, v240
    v_mfma_f32_16x16x32_bf16 a[184:187], v[56:59], v[84:87], a[184:187]
    ds_read_b128 v[124:127], v15 offset:14336
    v_and_b32 v240, s52, v226
    v_mfma_f32_16x16x32_bf16 a[188:191], v[60:63], v[84:87], a[188:191]
    v_mfma_f32_16x16x32_bf16 a[192:195], v[32:35], v[88:91], a[192:195]
    v_and_b32 v238, s52, v210
    v_and_b32 v239, s52, v218
    v_mfma_f32_16x16x32_bf16 a[196:199], v[36:39], v[88:91], a[196:199]
    v_fmac_f32 v236, v238, v240
    v_fmac_f32 v237, v239, v240
    v_mfma_f32_16x16x32_bf16 a[200:203], v[40:43], v[88:91], a[200:203]
    v_lshlrev_b32 v240, 16, v227
    v_lshlrev_b32 v238, 16, v211
    v_mfma_f32_16x16x32_bf16 a[204:207], v[44:47], v[88:91], a[204:207]
    v_mfma_f32_16x16x32_bf16 a[208:211], v[48:51], v[88:91], a[208:211]
    v_lshlrev_b32 v239, 16, v219
    v_fmac_f32 v236, v238, v240
    v_mfma_f32_16x16x32_bf16 a[212:215], v[52:55], v[88:91], a[212:215]
    v_fmac_f32 v237, v239, v240
    v_and_b32 v240, s52, v227
    v_mfma_f32_16x16x32_bf16 a[216:219], v[56:59], v[88:91], a[216:219]
    v_and_b32 v238, s52, v211
    v_and_b32 v239, s52, v219
    v_mfma_f32_16x16x32_bf16 a[220:223], v[60:63], v[88:91], a[220:223]
    v_mfma_f32_16x16x32_bf16 a[224:227], v[32:35], v[92:95], a[224:227]
    v_fmac_f32 v236, v238, v240
    v_fmac_f32 v237, v239, v240
    v_mfma_f32_16x16x32_bf16 a[228:231], v[36:39], v[92:95], a[228:231]
    v_lshlrev_b32 v240, 16, v228
    v_lshlrev_b32 v238, 16, v212
    v_mfma_f32_16x16x32_bf16 a[232:235], v[40:43], v[92:95], a[232:235]
    v_lshlrev_b32 v239, 16, v220
    v_fmac_f32 v236, v238, v240
    v_mfma_f32_16x16x32_bf16 a[236:239], v[44:47], v[92:95], a[236:239]
    v_mfma_f32_16x16x32_bf16 a[240:243], v[48:51], v[92:95], a[240:243]
    v_fmac_f32 v237, v239, v240
    v_and_b32 v240, s52, v228
    v_mfma_f32_16x16x32_bf16 a[244:247], v[52:55], v[92:95], a[244:247]
    v_and_b32 v238, s52, v212
    v_and_b32 v239, s52, v220
    v_mfma_f32_16x16x32_bf16 a[248:251], v[56:59], v[92:95], a[248:251]
    v_fmac_f32 v236, v238, v240
    v_fmac_f32 v237, v239, v240
    v_mfma_f32_16x16x32_bf16 a[252:255], v[60:63], v[92:95], a[252:255]
    s_waitcnt vmcnt(19) lgkmcnt(0)
    s_barrier
    v_lshlrev_b32 v240, 16, v229
    v_lshlrev_b32 v238, 16, v213
    v_mfma_f32_16x16x32_bf16 a[0:3], v[128:131], v[96:99], a[0:3]
    ds_read_b64_tr_b16 v[64:65], v10 offset:0
    v_lshlrev_b32 v239, 16, v221
    v_mfma_f32_16x16x32_bf16 a[4:7], v[128:131], v[100:103], a[4:7]
    s_add_u32 s36, s44, 0
    v_fmac_f32 v236, v238, v240
    v_fmac_f32 v237, v239, v240
    v_mfma_f32_16x16x32_bf16 a[8:11], v[128:131], v[104:107], a[8:11]
    s_add_u32 m0, s42, 65536
    ds_read_b64_tr_b16 v[66:67], v10 offset:1024
    v_and_b32 v240, s52, v229
    v_mfma_f32_16x16x32_bf16 a[12:15], v[128:131], v[108:111], a[12:15]
    buffer_load_dwordx4 v17, s[24:27], s36 offen offset:0 lds
    v_mfma_f32_16x16x32_bf16 a[16:19], v[128:131], v[112:115], a[16:19]
    ds_read_b64_tr_b16 v[68:69], v11 offset:0
    v_and_b32 v238, s52, v213
    v_mfma_f32_16x16x32_bf16 a[20:23], v[128:131], v[116:119], a[20:23]
    v_and_b32 v239, s52, v221
    v_fmac_f32 v236, v238, v240
    v_mfma_f32_16x16x32_bf16 a[24:27], v[128:131], v[120:123], a[24:27]
    ds_read_b64_tr_b16 v[70:71], v11 offset:1024
    v_fmac_f32 v237, v239, v240
    v_mfma_f32_16x16x32_bf16 a[28:31], v[128:131], v[124:127], a[28:31]
    buffer_load_dwordx4 v18, s[24:27], s36 offen offset:1024 lds
    v_mfma_f32_16x16x32_bf16 a[32:35], v[132:135], v[96:99], a[32:35]
    ds_read_b128 v[32:35], v8 offset:0
    v_add_f32_dpp v236, v236, v236 quad_perm:[1,0,3,2] row_mask:0xf bank_mask:0xf
    v_mfma_f32_16x16x32_bf16 a[36:39], v[132:135], v[100:103], a[36:39]
    v_add_f32_dpp v237, v237, v237 quad_perm:[1,0,3,2] row_mask:0xf bank_mask:0xf
    v_mfma_f32_16x16x32_bf16 a[40:43], v[132:135], v[104:107], a[40:43]
    ds_read_b64_tr_b16 v[72:73], v12 offset:0
    v_mfma_f32_16x16x32_bf16 a[44:47], v[132:135], v[108:111], a[44:47]
    buffer_load_dwordx4 v19, s[24:27], s36 offen offset:2048 lds
    v_mfma_f32_16x16x32_bf16 a[48:51], v[132:135], v[112:115], a[48:51]
    ds_read_b64_tr_b16 v[74:75], v12 offset:1024
    v_add_f32_dpp v236, v236, v236 quad_perm:[2,3,0,1] row_mask:0xf bank_mask:0xf
    v_mfma_f32_16x16x32_bf16 a[52:55], v[132:135], v[116:119], a[52:55]
    v_add_f32_dpp v237, v237, v237 quad_perm:[2,3,0,1] row_mask:0xf bank_mask:0xf
    v_mfma_f32_16x16x32_bf16 a[56:59], v[132:135], v[120:123], a[56:59]
    ds_read_b128 v[36:39], v8 offset:2048
    v_mfma_f32_16x16x32_bf16 a[60:63], v[132:135], v[124:127], a[60:63]
    buffer_load_dwordx4 v20, s[24:27], s36 offen offset:3072 lds
    v_mfma_f32_16x16x32_bf16 a[64:67], v[136:139], v[96:99], a[64:67]
    ds_read_b64_tr_b16 v[76:77], v13 offset:0
    v_add_f32_dpp v236, v236, v236 row_half_mirror row_mask:0xf bank_mask:0xf
    v_mfma_f32_16x16x32_bf16 a[68:71], v[136:139], v[100:103], a[68:71]
    s_add_u32 s37, s58, 3932160
    s_and_b32 s37, s37, 4194303
    s_add_u32 s37, s37, s39
    v_add_f32_dpp v237, v237, v237 row_half_mirror row_mask:0xf bank_mask:0xf
    v_mfma_f32_16x16x32_bf16 a[72:75], v[136:139], v[104:107], a[72:75]
    s_add_u32 m0, s43, 49152
    ds_read_b64_tr_b16 v[78:79], v13 offset:1024
    v_mfma_f32_16x16x32_bf16 a[76:79], v[136:139], v[108:111], a[76:79]
    buffer_load_dwordx4 v6, s[8:11], s37 offen offset:0 lds
    v_mfma_f32_16x16x32_bf16 a[80:83], v[136:139], v[112:115], a[80:83]
    ds_read_b128 v[40:43], v8 offset:4096
    v_add_f32_dpp v236, v236, v236 row_mirror row_mask:0xf bank_mask:0xf
    v_mfma_f32_16x16x32_bf16 a[84:87], v[136:139], v[116:119], a[84:87]
    v_add_f32_dpp v237, v237, v237 row_mirror row_mask:0xf bank_mask:0xf
    v_mov_b32 v238, v236
    v_mfma_f32_16x16x32_bf16 a[88:91], v[136:139], v[120:123], a[88:91]
    ds_read_b64_tr_b16 v[80:81], v10 offset:2048
    v_mov_b32 v239, v237
    v_mfma_f32_16x16x32_bf16 a[92:95], v[136:139], v[124:127], a[92:95]
    buffer_load_dwordx4 v7, s[8:11], s37 offen offset:1024 lds
    v_mfma_f32_16x16x32_bf16 a[96:99], v[140:143], v[96:99], a[96:99]
    ds_read_b64_tr_b16 v[82:83], v10 offset:3072
    v_permlane16_swap_b32 v236, v238
    v_mfma_f32_16x16x32_bf16 a[100:103], v[140:143], v[100:103], a[100:103]
    v_permlane16_swap_b32 v237, v239
    v_mfma_f32_16x16x32_bf16 a[104:107], v[140:143], v[104:107], a[104:107]
    s_add_u32 m0, s43, 51200
    ds_read_b128 v[44:47], v8 offset:6144
    v_add_f32 v236, v236, v238
    v_mfma_f32_16x16x32_bf16 a[108:111], v[140:143], v[108:111], a[108:111]
    buffer_load_dwordx4 v6, s[12:15], s37 offen offset:0 lds
    v_mfma_f32_16x16x32_bf16 a[112:115], v[140:143], v[112:115], a[112:115]
    ds_read_b64_tr_b16 v[84:85], v11 offset:2048
    v_add_f32 v237, v237, v239
    v_mfma_f32_16x16x32_bf16 a[116:119], v[140:143], v[116:119], a[116:119]
    v_mov_b32 v238, v236
    v_mov_b32 v239, v237
    v_mfma_f32_16x16x32_bf16 a[120:123], v[140:143], v[120:123], a[120:123]
    ds_read_b64_tr_b16 v[86:87], v11 offset:3072
    v_mfma_f32_16x16x32_bf16 a[124:127], v[140:143], v[124:127], a[124:127]
    buffer_load_dwordx4 v7, s[12:15], s37 offen offset:1024 lds
    v_mfma_f32_16x16x32_bf16 a[128:131], v[96:99], v[144:147], a[128:131]
    ds_read_b128 v[48:51], v8 offset:8192
    v_permlane32_swap_b32 v236, v238
    v_mfma_f32_16x16x32_bf16 a[132:135], v[100:103], v[144:147], a[132:135]
    v_permlane32_swap_b32 v237, v239
    v_mfma_f32_16x16x32_bf16 a[136:139], v[104:107], v[144:147], a[136:139]
    ds_read_b64_tr_b16 v[88:89], v12 offset:2048
    v_add_f32 v236, v236, v238
    v_mfma_f32_16x16x32_bf16 a[140:143], v[108:111], v[144:147], a[140:143]
    v_mfma_f32_16x16x32_bf16 a[144:147], v[112:115], v[144:147], a[144:147]
    ds_read_b64_tr_b16 v[90:91], v12 offset:3072
    v_add_f32 v237, v237, v239
    v_mfma_f32_16x16x32_bf16 a[148:151], v[116:119], v[144:147], a[148:151]
    v_mul_f32 v236, 0xbfb8aa3b, v236
    v_mul_f32 v237, 0xbfb8aa3b, v237
    v_mfma_f32_16x16x32_bf16 a[152:155], v[120:123], v[144:147], a[152:155]
    ds_read_b128 v[52:55], v8 offset:10240
    v_exp_f32 v236, v236
    v_mfma_f32_16x16x32_bf16 a[156:159], v[124:127], v[144:147], a[156:159]
    v_mfma_f32_16x16x32_bf16 a[160:163], v[96:99], v[148:151], a[160:163]
    ds_read_b64_tr_b16 v[92:93], v13 offset:2048
    v_exp_f32 v237, v237
    v_mfma_f32_16x16x32_bf16 a[164:167], v[100:103], v[148:151], a[164:167]
    v_mov_b32 v238, 0
    v_add_f32 v236, 1.0, v236
    v_mfma_f32_16x16x32_bf16 a[168:171], v[104:107], v[148:151], a[168:171]
    ds_read_b64_tr_b16 v[94:95], v13 offset:3072
    v_add_f32 v237, 1.0, v237
    v_mfma_f32_16x16x32_bf16 a[172:175], v[108:111], v[148:151], a[172:175]
    v_mfma_f32_16x16x32_bf16 a[176:179], v[112:115], v[148:151], a[176:179]
    ds_read_b128 v[56:59], v8 offset:12288
    v_rcp_f32 v236, v236
    v_mfma_f32_16x16x32_bf16 a[180:183], v[116:119], v[148:151], a[180:183]
    v_rcp_f32 v237, v237
    v_mfma_f32_16x16x32_bf16 a[184:187], v[120:123], v[148:151], a[184:187]
    s_add_u32 s16, s94, 59768832
    s_addc_u32 s17, s95, 0
    ds_read_b128 v[60:63], v8 offset:14336
    v_mfma_f32_16x16x32_bf16 a[188:191], v[124:127], v[148:151], a[188:191]
    v_mfma_f32_16x16x32_bf16 a[192:195], v[96:99], v[152:155], a[192:195]
    s_mov_b32 s18, 8192
    v_mfma_f32_16x16x32_bf16 a[196:199], v[100:103], v[152:155], a[196:199]
    s_lshr_b32 s40, s40, 9
    v_mfma_f32_16x16x32_bf16 a[200:203], v[104:107], v[152:155], a[200:203]
    s_lshr_b32 s41, s41, 9
    v_mfma_f32_16x16x32_bf16 a[204:207], v[108:111], v[152:155], a[204:207]
    buffer_store_dword v236, v238, s[16:19], s40 offen sc1
    v_mfma_f32_16x16x32_bf16 a[208:211], v[112:115], v[152:155], a[208:211]
    v_mfma_f32_16x16x32_bf16 a[212:215], v[116:119], v[152:155], a[212:215]
    v_mfma_f32_16x16x32_bf16 a[216:219], v[120:123], v[152:155], a[216:219]
    v_mfma_f32_16x16x32_bf16 a[220:223], v[124:127], v[152:155], a[220:223]
    buffer_store_dword v237, v238, s[16:19], s41 offen sc1
    v_mfma_f32_16x16x32_bf16 a[224:227], v[96:99], v[156:159], a[224:227]
    s_add_u32 s16, s94, 50331648
    s_addc_u32 s17, s95, 0
    v_mfma_f32_16x16x32_bf16 a[228:231], v[100:103], v[156:159], a[228:231]
    s_mov_b32 s18, 4718592
    v_mfma_f32_16x16x32_bf16 a[232:235], v[104:107], v[156:159], a[232:235]
    v_mfma_f32_16x16x32_bf16 a[236:239], v[108:111], v[156:159], a[236:239]
    v_mfma_f32_16x16x32_bf16 a[240:243], v[112:115], v[156:159], a[240:243]
    v_mfma_f32_16x16x32_bf16 a[244:247], v[116:119], v[156:159], a[244:247]
    v_mfma_f32_16x16x32_bf16 a[248:251], v[120:123], v[156:159], a[248:251]
    v_mfma_f32_16x16x32_bf16 a[252:255], v[124:127], v[156:159], a[252:255]
    s_waitcnt vmcnt(21) lgkmcnt(0)
    s_barrier
    v_mfma_f32_16x16x32_bf16 a[0:3], v[64:67], v[32:35], a[0:3]
    ds_read_b64_tr_b16 v[128:129], v10 offset:16384
    v_lshlrev_b32 v206, 16, v160
    v_mfma_f32_16x16x32_bf16 a[4:7], v[64:67], v[36:39], a[4:7]
    s_add_u32 s36, s45, 0
    v_lshlrev_b32 v207, 16, v162
    v_lshlrev_b32 v208, 16, v164
    v_mfma_f32_16x16x32_bf16 a[8:11], v[64:67], v[40:43], a[8:11]
    s_add_u32 m0, s42, 69632
    ds_read_b64_tr_b16 v[130:131], v10 offset:17408
    v_lshlrev_b32 v209, 16, v166
    v_mfma_f32_16x16x32_bf16 a[12:15], v[64:67], v[44:47], a[12:15]
    buffer_load_dwordx4 v17, s[24:27], s36 offen offset:0 lds
    v_mfma_f32_16x16x32_bf16 a[16:19], v[64:67], v[48:51], a[16:19]
    ds_read_b64_tr_b16 v[132:133], v11 offset:16384
    v_lshlrev_b32 v210, 16, v168
    v_mfma_f32_16x16x32_bf16 a[20:23], v[64:67], v[52:55], a[20:23]
    v_lshlrev_b32 v211, 16, v170
    v_lshlrev_b32 v212, 16, v172
    v_mfma_f32_16x16x32_bf16 a[24:27], v[64:67], v[56:59], a[24:27]
    ds_read_b64_tr_b16 v[134:135], v11 offset:17408
    v_lshlrev_b32 v213, 16, v174
    v_mfma_f32_16x16x32_bf16 a[28:31], v[64:67], v[60:63], a[28:31]
    buffer_load_dwordx4 v18, s[24:27], s36 offen offset:1024 lds
    v_mfma_f32_16x16x32_bf16 a[32:35], v[68:71], v[32:35], a[32:35]
    ds_read_b128 v[96:99], v9 offset:0
    v_lshlrev_b32 v214, 16, v176
    v_mfma_f32_16x16x32_bf16 a[36:39], v[68:71], v[36:39], a[36:39]
    v_lshlrev_b32 v215, 16, v178
    v_lshlrev_b32 v216, 16, v180
    v_mfma_f32_16x16x32_bf16 a[40:43], v[68:71], v[40:43], a[40:43]
    ds_read_b64_tr_b16 v[136:137], v12 offset:16384
    v_lshlrev_b32 v217, 16, v198
    v_mfma_f32_16x16x32_bf16 a[44:47], v[68:71], v[44:47], a[44:47]
    buffer_load_dwordx4 v19, s[24:27], s36 offen offset:2048 lds
    v_mfma_f32_16x16x32_bf16 a[48:51], v[68:71], v[48:51], a[48:51]
    ds_read_b64_tr_b16 v[138:139], v12 offset:17408
    v_and_b32 v218, s52, v198
    v_mfma_f32_16x16x32_bf16 a[52:55], v[68:71], v[52:55], a[52:55]
    v_lshlrev_b32 v219, 16, v199
    v_and_b32 v220, s52, v199
    v_mfma_f32_16x16x32_bf16 a[56:59], v[68:71], v[56:59], a[56:59]
    ds_read_b128 v[100:103], v9 offset:2048
    v_mul_f32 v221, v209, v217
    v_mfma_f32_16x16x32_bf16 a[60:63], v[68:71], v[60:63], a[60:63]
    buffer_load_dwordx4 v20, s[24:27], s36 offen offset:3072 lds
    v_mfma_f32_16x16x32_bf16 a[64:67], v[72:75], v[32:35], a[64:67]
    ds_read_b64_tr_b16 v[140:141], v13 offset:16384
    v_mul_f32 v222, v210, v217
    v_mfma_f32_16x16x32_bf16 a[68:71], v[72:75], v[36:39], a[68:71]
    s_add_u32 s37, s49, 0
    v_mul_f32 v223, v211, v217
    v_mul_f32 v224, v212, v217
    v_mfma_f32_16x16x32_bf16 a[72:75], v[72:75], v[40:43], a[72:75]
    s_add_u32 m0, s50, 0
    ds_read_b64_tr_b16 v[142:143], v13 offset:17408
    v_mul_f32 v225, v213, v217
    v_mfma_f32_16x16x32_bf16 a[76:79], v[72:75], v[44:47], a[76:79]
    buffer_load_dwordx4 v21, s[20:23], s37 offen offset:0 lds
    v_mfma_f32_16x16x32_bf16 a[80:83], v[72:75], v[48:51], a[80:83]
    ds_read_b128 v[104:107], v9 offset:4096
    v_mul_f32 v226, v214, v217
    v_mfma_f32_16x16x32_bf16 a[84:87], v[72:75], v[52:55], a[84:87]
    v_mul_f32 v227, v215, v217
    v_mul_f32 v228, v216, v217
    v_mfma_f32_16x16x32_bf16 a[88:91], v[72:75], v[56:59], a[88:91]
    ds_read_b64_tr_b16 v[144:145], v10 offset:18432
    v_fmac_f32 v221, v208, v218
    v_mfma_f32_16x16x32_bf16 a[92:95], v[72:75], v[60:63], a[92:95]
    buffer_load_dwordx4 v22, s[20:23], s37 offen offset:1024 lds
    v_mfma_f32_16x16x32_bf16 a[96:99], v[76:79], v[32:35], a[96:99]
    ds_read_b64_tr_b16 v[146:147], v10 offset:19456
    v_fmac_f32 v222, v209, v218
    v_mfma_f32_16x16x32_bf16 a[100:103], v[76:79], v[36:39], a[100:103]
    v_fmac_f32 v223, v210, v218
    v_fmac_f32 v224, v211, v218
    v_mfma_f32_16x16x32_bf16 a[104:107], v[76:79], v[40:43], a[104:107]
    ds_read_b128 v[108:111], v9 offset:6144
    v_fmac_f32 v225, v212, v218
    v_mfma_f32_16x16x32_bf16 a[108:111], v[76:79], v[44:47], a[108:111]
    v_mfma_f32_16x16x32_bf16 a[112:115], v[76:79], v[48:51], a[112:115]
    ds_read_b64_tr_b16 v[148:149], v11 offset:18432
    v_fmac_f32 v226, v213, v218
    v_mfma_f32_16x16x32_bf16 a[116:119], v[76:79], v[52:55], a[116:119]
    v_fmac_f32 v227, v214, v218
    v_fmac_f32 v228, v215, v218
    v_mfma_f32_16x16x32_bf16 a[120:123], v[76:79], v[56:59], a[120:123]
    ds_read_b64_tr_b16 v[150:151], v11 offset:19456
    v_fmac_f32 v221, v207, v219
    v_mfma_f32_16x16x32_bf16 a[124:127], v[76:79], v[60:63], a[124:127]
    v_mfma_f32_16x16x32_bf16 a[128:131], v[32:35], v[80:83], a[128:131]
    ds_read_b128 v[112:115], v9 offset:8192
    v_fmac_f32 v222, v208, v219
    v_mfma_f32_16x16x32_bf16 a[132:135], v[36:39], v[80:83], a[132:135]
    v_fmac_f32 v223, v209, v219
    v_fmac_f32 v224, v210, v219
    v_mfma_f32_16x16x32_bf16 a[136:139], v[40:43], v[80:83], a[136:139]
    ds_read_b64_tr_b16 v[152:153], v12 offset:18432
    v_fmac_f32 v225, v211, v219
    v_mfma_f32_16x16x32_bf16 a[140:143], v[44:47], v[80:83], a[140:143]
    v_mfma_f32_16x16x32_bf16 a[144:147], v[48:51], v[80:83], a[144:147]
    ds_read_b64_tr_b16 v[154:155], v12 offset:19456
    v_fmac_f32 v226, v212, v219
    v_mfma_f32_16x16x32_bf16 a[148:151], v[52:55], v[80:83], a[148:151]
    v_fmac_f32 v227, v213, v219
    v_fmac_f32 v228, v214, v219
    v_mfma_f32_16x16x32_bf16 a[152:155], v[56:59], v[80:83], a[152:155]
    ds_read_b128 v[116:119], v9 offset:10240
    v_fmac_f32 v221, v206, v220
    v_mfma_f32_16x16x32_bf16 a[156:159], v[60:63], v[80:83], a[156:159]
    v_mfma_f32_16x16x32_bf16 a[160:163], v[32:35], v[84:87], a[160:163]
    ds_read_b64_tr_b16 v[156:157], v13 offset:18432
    v_fmac_f32 v222, v207, v220
    v_mfma_f32_16x16x32_bf16 a[164:167], v[36:39], v[84:87], a[164:167]
    v_fmac_f32 v223, v208, v220
    v_fmac_f32 v224, v209, v220
    v_mfma_f32_16x16x32_bf16 a[168:171], v[40:43], v[84:87], a[168:171]
gated_mix__ssm_conv_h3__compressed_kv_cla__prompt_kernel_pad2:
    s_cbranch_execz gated_mix__ssm_conv_h3__compressed_kv_cla__prompt_kernel_pad6
    ds_read_b64_tr_b16 v[158:159], v13 offset:19456
    v_fmac_f32 v225, v210, v220
    v_mfma_f32_16x16x32_bf16 a[172:175], v[44:47], v[84:87], a[172:175]
    v_mfma_f32_16x16x32_bf16 a[176:179], v[48:51], v[84:87], a[176:179]
    ds_read_b128 v[120:123], v9 offset:12288
    v_fmac_f32 v226, v211, v220
    v_mfma_f32_16x16x32_bf16 a[180:183], v[52:55], v[84:87], a[180:183]
    v_fmac_f32 v227, v212, v220
    v_fmac_f32 v228, v213, v220
    v_mfma_f32_16x16x32_bf16 a[184:187], v[56:59], v[84:87], a[184:187]
    ds_read_b128 v[124:127], v9 offset:14336
    v_lshlrev_b32 v206, 16, v182
    v_mfma_f32_16x16x32_bf16 a[188:191], v[60:63], v[84:87], a[188:191]
    v_mfma_f32_16x16x32_bf16 a[192:195], v[32:35], v[88:91], a[192:195]
    v_lshlrev_b32 v207, 16, v184
    v_lshlrev_b32 v208, 16, v186
    v_mfma_f32_16x16x32_bf16 a[196:199], v[36:39], v[88:91], a[196:199]
    v_lshlrev_b32 v209, 16, v188
    v_lshlrev_b32 v210, 16, v190
    v_mfma_f32_16x16x32_bf16 a[200:203], v[40:43], v[88:91], a[200:203]
    v_lshlrev_b32 v211, 16, v192
    v_lshlrev_b32 v212, 16, v194
    v_mfma_f32_16x16x32_bf16 a[204:207], v[44:47], v[88:91], a[204:207]
    v_mfma_f32_16x16x32_bf16 a[208:211], v[48:51], v[88:91], a[208:211]
    v_lshlrev_b32 v213, 16, v196
    v_mul_f32 v221, v221, v206
    v_mfma_f32_16x16x32_bf16 a[212:215], v[52:55], v[88:91], a[212:215]
    v_mul_f32 v222, v222, v207
    v_mul_f32 v223, v223, v208
    v_mfma_f32_16x16x32_bf16 a[216:219], v[56:59], v[88:91], a[216:219]
    v_mul_f32 v224, v224, v209
    v_mul_f32 v225, v225, v210
    v_mfma_f32_16x16x32_bf16 a[220:223], v[60:63], v[88:91], a[220:223]
    v_mfma_f32_16x16x32_bf16 a[224:227], v[32:35], v[92:95], a[224:227]
    v_mul_f32 v226, v226, v211
    v_mul_f32 v227, v227, v212
    v_mfma_f32_16x16x32_bf16 a[228:231], v[36:39], v[92:95], a[228:231]
    v_mul_f32 v228, v228, v213
    v_cvt_pk_bf16_f32 v244, v228, v227
    v_mfma_f32_16x16x32_bf16 a[232:235], v[40:43], v[92:95], a[232:235]
    v_cvt_pk_bf16_f32 v245, v226, v225
    v_cvt_pk_bf16_f32 v246, v224, v223
    v_mfma_f32_16x16x32_bf16 a[236:239], v[44:47], v[92:95], a[236:239]
    v_mfma_f32_16x16x32_bf16 a[240:243], v[48:51], v[92:95], a[240:243]
    v_cvt_pk_bf16_f32 v247, v222, v221
    v_and_b32 v206, s52, v160
    v_mfma_f32_16x16x32_bf16 a[244:247], v[52:55], v[92:95], a[244:247]
    v_and_b32 v207, s52, v162
    v_and_b32 v208, s52, v164
    v_mfma_f32_16x16x32_bf16 a[248:251], v[56:59], v[92:95], a[248:251]
    v_and_b32 v209, s52, v166
    v_and_b32 v210, s52, v168
    v_mfma_f32_16x16x32_bf16 a[252:255], v[60:63], v[92:95], a[252:255]
    s_waitcnt vmcnt(19) lgkmcnt(0)
    s_barrier
    v_and_b32 v211, s52, v170
    v_and_b32 v212, s52, v172
    v_mfma_f32_16x16x32_bf16 a[0:3], v[128:131], v[96:99], a[0:3]
    ds_read_b64_tr_b16 v[64:65], v10 offset:32768
    v_and_b32 v213, s52, v174
    v_mfma_f32_16x16x32_bf16 a[4:7], v[128:131], v[100:103], a[4:7]
    s_add_u32 s36, s44, 128
    v_and_b32 v214, s52, v176
    v_and_b32 v215, s52, v178
    v_mfma_f32_16x16x32_bf16 a[8:11], v[128:131], v[104:107], a[8:11]
    s_add_u32 m0, s42, 0
    ds_read_b64_tr_b16 v[66:67], v10 offset:33792
    v_and_b32 v216, s52, v180
    v_mfma_f32_16x16x32_bf16 a[12:15], v[128:131], v[108:111], a[12:15]
    buffer_load_dwordx4 v17, s[24:27], s36 offen offset:0 lds
    v_mfma_f32_16x16x32_bf16 a[16:19], v[128:131], v[112:115], a[16:19]
    ds_read_b64_tr_b16 v[68:69], v11 offset:32768
    v_lshlrev_b32 v217, 16, v200
    v_mfma_f32_16x16x32_bf16 a[20:23], v[128:131], v[116:119], a[20:23]
    v_and_b32 v218, s52, v200
    v_lshlrev_b32 v219, 16, v201
    v_mfma_f32_16x16x32_bf16 a[24:27], v[128:131], v[120:123], a[24:27]
    ds_read_b64_tr_b16 v[70:71], v11 offset:33792
    v_and_b32 v220, s52, v201
    v_mfma_f32_16x16x32_bf16 a[28:31], v[128:131], v[124:127], a[28:31]
    buffer_load_dwordx4 v18, s[24:27], s36 offen offset:1024 lds
    v_mfma_f32_16x16x32_bf16 a[32:35], v[132:135], v[96:99], a[32:35]
    ds_read_b128 v[32:35], v8 offset:32768
    v_mul_f32 v221, v209, v217
    v_mfma_f32_16x16x32_bf16 a[36:39], v[132:135], v[100:103], a[36:39]
    v_mul_f32 v222, v210, v217
    v_mul_f32 v223, v211, v217
    v_mfma_f32_16x16x32_bf16 a[40:43], v[132:135], v[104:107], a[40:43]
    ds_read_b64_tr_b16 v[72:73], v12 offset:32768
    v_mul_f32 v224, v212, v217
    v_mfma_f32_16x16x32_bf16 a[44:47], v[132:135], v[108:111], a[44:47]
    buffer_load_dwordx4 v19, s[24:27], s36 offen offset:2048 lds
    v_mfma_f32_16x16x32_bf16 a[48:51], v[132:135], v[112:115], a[48:51]
    ds_read_b64_tr_b16 v[74:75], v12 offset:33792
    v_mul_f32 v225, v213, v217
    v_mfma_f32_16x16x32_bf16 a[52:55], v[132:135], v[116:119], a[52:55]
    v_mul_f32 v226, v214, v217
    v_mul_f32 v227, v215, v217
    v_mfma_f32_16x16x32_bf16 a[56:59], v[132:135], v[120:123], a[56:59]
    ds_read_b128 v[36:39], v8 offset:34816
    v_mul_f32 v228, v216, v217
    v_mfma_f32_16x16x32_bf16 a[60:63], v[132:135], v[124:127], a[60:63]
    buffer_load_dwordx4 v20, s[24:27], s36 offen offset:3072 lds
    v_mfma_f32_16x16x32_bf16 a[64:67], v[136:139], v[96:99], a[64:67]
    ds_read_b64_tr_b16 v[76:77], v13 offset:32768
    v_fmac_f32 v221, v208, v218
    v_mfma_f32_16x16x32_bf16 a[68:71], v[136:139], v[100:103], a[68:71]
    s_add_u32 s37, s49, 262144
    v_fmac_f32 v222, v209, v218
    v_fmac_f32 v223, v210, v218
    v_mfma_f32_16x16x32_bf16 a[72:75], v[136:139], v[104:107], a[72:75]
    s_add_u32 m0, s50, 8704
    ds_read_b64_tr_b16 v[78:79], v13 offset:33792
    v_fmac_f32 v224, v211, v218
    v_mfma_f32_16x16x32_bf16 a[76:79], v[136:139], v[108:111], a[76:79]
    buffer_load_dwordx4 v21, s[20:23], s37 offen offset:0 lds
    v_mfma_f32_16x16x32_bf16 a[80:83], v[136:139], v[112:115], a[80:83]
    ds_read_b128 v[40:43], v8 offset:36864
    v_fmac_f32 v225, v212, v218
    v_mfma_f32_16x16x32_bf16 a[84:87], v[136:139], v[116:119], a[84:87]
    v_fmac_f32 v226, v213, v218
    v_fmac_f32 v227, v214, v218
    v_mfma_f32_16x16x32_bf16 a[88:91], v[136:139], v[120:123], a[88:91]
    ds_read_b64_tr_b16 v[80:81], v10 offset:34816
    v_fmac_f32 v228, v215, v218
    v_mfma_f32_16x16x32_bf16 a[92:95], v[136:139], v[124:127], a[92:95]
    buffer_load_dwordx4 v22, s[20:23], s37 offen offset:1024 lds
    v_mfma_f32_16x16x32_bf16 a[96:99], v[140:143], v[96:99], a[96:99]
    ds_read_b64_tr_b16 v[82:83], v10 offset:35840
    v_fmac_f32 v221, v207, v219
    v_mfma_f32_16x16x32_bf16 a[100:103], v[140:143], v[100:103], a[100:103]
    s_add_u32 s37, s49, 524288
    v_fmac_f32 v222, v208, v219
    v_fmac_f32 v223, v209, v219
    v_mfma_f32_16x16x32_bf16 a[104:107], v[140:143], v[104:107], a[104:107]
    s_add_u32 m0, s50, 17408
    ds_read_b128 v[44:47], v8 offset:38912
    v_fmac_f32 v224, v210, v219
    v_mfma_f32_16x16x32_bf16 a[108:111], v[140:143], v[108:111], a[108:111]
    buffer_load_dwordx4 v21, s[20:23], s37 offen offset:0 lds
    v_mfma_f32_16x16x32_bf16 a[112:115], v[140:143], v[112:115], a[112:115]
    ds_read_b64_tr_b16 v[84:85], v11 offset:34816
    v_fmac_f32 v225, v211, v219
    v_mfma_f32_16x16x32_bf16 a[116:119], v[140:143], v[116:119], a[116:119]
    v_fmac_f32 v226, v212, v219
    v_fmac_f32 v227, v213, v219
    v_mfma_f32_16x16x32_bf16 a[120:123], v[140:143], v[120:123], a[120:123]
    ds_read_b64_tr_b16 v[86:87], v11 offset:35840
    v_fmac_f32 v228, v214, v219
    v_mfma_f32_16x16x32_bf16 a[124:127], v[140:143], v[124:127], a[124:127]
    buffer_load_dwordx4 v22, s[20:23], s37 offen offset:1024 lds
    v_mfma_f32_16x16x32_bf16 a[128:131], v[96:99], v[144:147], a[128:131]
    ds_read_b128 v[48:51], v8 offset:40960
    v_fmac_f32 v221, v206, v220
    v_mfma_f32_16x16x32_bf16 a[132:135], v[100:103], v[144:147], a[132:135]
    v_fmac_f32 v222, v207, v220
    v_fmac_f32 v223, v208, v220
    v_mfma_f32_16x16x32_bf16 a[136:139], v[104:107], v[144:147], a[136:139]
    ds_read_b64_tr_b16 v[88:89], v12 offset:34816
    v_fmac_f32 v224, v209, v220
    v_mfma_f32_16x16x32_bf16 a[140:143], v[108:111], v[144:147], a[140:143]
    buffer_store_dwordx4 v[244:247], v234, s[16:19], 0 offen sc1
    v_mfma_f32_16x16x32_bf16 a[144:147], v[112:115], v[144:147], a[144:147]
    s_movk_i32 s54, 4608
    ds_read_b64_tr_b16 v[90:91], v12 offset:35840
    v_fmac_f32 v225, v210, v220
    v_mfma_f32_16x16x32_bf16 a[148:151], v[116:119], v[144:147], a[148:151]
    v_fmac_f32 v226, v211, v220
    v_fmac_f32 v227, v212, v220
    v_mfma_f32_16x16x32_bf16 a[152:155], v[120:123], v[144:147], a[152:155]
    ds_read_b128 v[52:55], v8 offset:43008
    v_fmac_f32 v228, v213, v220
    v_mfma_f32_16x16x32_bf16 a[156:159], v[124:127], v[144:147], a[156:159]
    v_mfma_f32_16x16x32_bf16 a[160:163], v[96:99], v[148:151], a[160:163]
    ds_read_b64_tr_b16 v[92:93], v13 offset:34816
    v_and_b32 v206, s52, v182
    v_mfma_f32_16x16x32_bf16 a[164:167], v[100:103], v[148:151], a[164:167]
    v_and_b32 v207, s52, v184
    v_and_b32 v208, s52, v186
    v_mfma_f32_16x16x32_bf16 a[168:171], v[104:107], v[148:151], a[168:171]
    ds_read_b64_tr_b16 v[94:95], v13 offset:35840
    v_and_b32 v209, s52, v188
    v_mfma_f32_16x16x32_bf16 a[172:175], v[108:111], v[148:151], a[172:175]
    v_mfma_f32_16x16x32_bf16 a[176:179], v[112:115], v[148:151], a[176:179]
    ds_read_b128 v[56:59], v8 offset:45056
    v_and_b32 v210, s52, v190
    v_mfma_f32_16x16x32_bf16 a[180:183], v[116:119], v[148:151], a[180:183]
    v_and_b32 v211, s52, v192
    v_and_b32 v212, s52, v194
    v_mfma_f32_16x16x32_bf16 a[184:187], v[120:123], v[148:151], a[184:187]
    ds_read_b128 v[60:63], v8 offset:47104
    v_and_b32 v213, s52, v196
    v_mfma_f32_16x16x32_bf16 a[188:191], v[124:127], v[148:151], a[188:191]
    v_mfma_f32_16x16x32_bf16 a[192:195], v[96:99], v[152:155], a[192:195]
    v_mul_f32 v221, v221, v206
    v_mul_f32 v222, v222, v207
    v_mfma_f32_16x16x32_bf16 a[196:199], v[100:103], v[152:155], a[196:199]
    v_mul_f32 v223, v223, v208
    v_mul_f32 v224, v224, v209
    v_mfma_f32_16x16x32_bf16 a[200:203], v[104:107], v[152:155], a[200:203]
    v_mul_f32 v225, v225, v210
    v_mul_f32 v226, v226, v211
    v_mfma_f32_16x16x32_bf16 a[204:207], v[108:111], v[152:155], a[204:207]
    v_mfma_f32_16x16x32_bf16 a[208:211], v[112:115], v[152:155], a[208:211]
    v_mul_f32 v227, v227, v212
    v_mul_f32 v228, v228, v213
    v_mfma_f32_16x16x32_bf16 a[212:215], v[116:119], v[152:155], a[212:215]
    v_cvt_pk_bf16_f32 v248, v228, v227
    v_cvt_pk_bf16_f32 v249, v226, v225
    v_mfma_f32_16x16x32_bf16 a[216:219], v[120:123], v[152:155], a[216:219]
    v_cvt_pk_bf16_f32 v250, v224, v223
    v_cvt_pk_bf16_f32 v251, v222, v221
    v_mfma_f32_16x16x32_bf16 a[220:223], v[124:127], v[152:155], a[220:223]
    buffer_store_dwordx4 v[248:251], v234, s[16:19], s54 offen sc1
    v_mfma_f32_16x16x32_bf16 a[224:227], v[96:99], v[156:159], a[224:227]
    s_movk_i32 s54, 9216
    v_lshlrev_b32 v206, 16, v161
    v_lshlrev_b32 v207, 16, v163
    v_mfma_f32_16x16x32_bf16 a[228:231], v[100:103], v[156:159], a[228:231]
    v_lshlrev_b32 v208, 16, v165
    v_lshlrev_b32 v209, 16, v167
    v_mfma_f32_16x16x32_bf16 a[232:235], v[104:107], v[156:159], a[232:235]
    v_lshlrev_b32 v210, 16, v169
    v_lshlrev_b32 v211, 16, v171
    v_mfma_f32_16x16x32_bf16 a[236:239], v[108:111], v[156:159], a[236:239]
    v_mfma_f32_16x16x32_bf16 a[240:243], v[112:115], v[156:159], a[240:243]
    v_lshlrev_b32 v212, 16, v173
    v_lshlrev_b32 v213, 16, v175
    v_mfma_f32_16x16x32_bf16 a[244:247], v[116:119], v[156:159], a[244:247]
    v_lshlrev_b32 v214, 16, v177
    v_lshlrev_b32 v215, 16, v179
    v_mfma_f32_16x16x32_bf16 a[248:251], v[120:123], v[156:159], a[248:251]
    v_lshlrev_b32 v216, 16, v181
    v_lshlrev_b32 v217, 16, v202
    v_mfma_f32_16x16x32_bf16 a[252:255], v[124:127], v[156:159], a[252:255]
    s_waitcnt vmcnt(18) lgkmcnt(0)
    s_barrier
    v_and_b32 v218, s52, v202
    v_lshlrev_b32 v219, 16, v203
    v_mfma_f32_16x16x32_bf16 a[0:3], v[64:67], v[32:35], a[0:3]
    ds_read_b64_tr_b16 v[128:129], v10 offset:49152
    v_and_b32 v220, s52, v203
    v_mfma_f32_16x16x32_bf16 a[4:7], v[64:67], v[36:39], a[4:7]
    s_add_u32 s36, s45, 128
    v_mul_f32 v221, v209, v217
    v_mul_f32 v222, v210, v217
    v_mfma_f32_16x16x32_bf16 a[8:11], v[64:67], v[40:43], a[8:11]
    s_add_u32 m0, s42, 4096
    ds_read_b64_tr_b16 v[130:131], v10 offset:50176
    v_mul_f32 v223, v211, v217
    v_mfma_f32_16x16x32_bf16 a[12:15], v[64:67], v[44:47], a[12:15]
    buffer_load_dwordx4 v17, s[24:27], s36 offen offset:0 lds
    v_mfma_f32_16x16x32_bf16 a[16:19], v[64:67], v[48:51], a[16:19]
    ds_read_b64_tr_b16 v[132:133], v11 offset:49152
    v_mul_f32 v224, v212, v217
    v_mfma_f32_16x16x32_bf16 a[20:23], v[64:67], v[52:55], a[20:23]
    v_mul_f32 v225, v213, v217
    v_mul_f32 v226, v214, v217
    v_mfma_f32_16x16x32_bf16 a[24:27], v[64:67], v[56:59], a[24:27]
    ds_read_b64_tr_b16 v[134:135], v11 offset:50176
    v_mul_f32 v227, v215, v217
    v_mfma_f32_16x16x32_bf16 a[28:31], v[64:67], v[60:63], a[28:31]
    buffer_load_dwordx4 v18, s[24:27], s36 offen offset:1024 lds
    v_mfma_f32_16x16x32_bf16 a[32:35], v[68:71], v[32:35], a[32:35]
    ds_read_b128 v[96:99], v9 offset:32768
    v_mul_f32 v228, v216, v217
    v_mfma_f32_16x16x32_bf16 a[36:39], v[68:71], v[36:39], a[36:39]
    v_fmac_f32 v221, v208, v218
    v_fmac_f32 v222, v209, v218
    v_mfma_f32_16x16x32_bf16 a[40:43], v[68:71], v[40:43], a[40:43]
    ds_read_b64_tr_b16 v[136:137], v12 offset:49152
    v_fmac_f32 v223, v210, v218
    v_mfma_f32_16x16x32_bf16 a[44:47], v[68:71], v[44:47], a[44:47]
    buffer_load_dwordx4 v19, s[24:27], s36 offen offset:2048 lds
    v_mfma_f32_16x16x32_bf16 a[48:51], v[68:71], v[48:51], a[48:51]
    ds_read_b64_tr_b16 v[138:139], v12 offset:50176
    v_fmac_f32 v224, v211, v218
    v_mfma_f32_16x16x32_bf16 a[52:55], v[68:71], v[52:55], a[52:55]
    v_fmac_f32 v225, v212, v218
    v_fmac_f32 v226, v213, v218
    v_mfma_f32_16x16x32_bf16 a[56:59], v[68:71], v[56:59], a[56:59]
    ds_read_b128 v[100:103], v9 offset:34816
    v_fmac_f32 v227, v214, v218
    v_mfma_f32_16x16x32_bf16 a[60:63], v[68:71], v[60:63], a[60:63]
    buffer_load_dwordx4 v20, s[24:27], s36 offen offset:3072 lds
    v_mfma_f32_16x16x32_bf16 a[64:67], v[72:75], v[32:35], a[64:67]
    ds_read_b64_tr_b16 v[140:141], v13 offset:49152
    v_fmac_f32 v228, v215, v218
    v_mfma_f32_16x16x32_bf16 a[68:71], v[72:75], v[36:39], a[68:71]
    s_add_u32 s37, s49, 786432
    v_fmac_f32 v221, v207, v219
    v_fmac_f32 v222, v208, v219
    v_mfma_f32_16x16x32_bf16 a[72:75], v[72:75], v[40:43], a[72:75]
    s_add_u32 m0, s50, 26112
    ds_read_b64_tr_b16 v[142:143], v13 offset:50176
    v_fmac_f32 v223, v209, v219
    v_mfma_f32_16x16x32_bf16 a[76:79], v[72:75], v[44:47], a[76:79]
    buffer_load_dwordx4 v21, s[20:23], s37 offen offset:0 lds
    v_mfma_f32_16x16x32_bf16 a[80:83], v[72:75], v[48:51], a[80:83]
    ds_read_b128 v[104:107], v9 offset:36864
    v_fmac_f32 v224, v210, v219
    v_mfma_f32_16x16x32_bf16 a[84:87], v[72:75], v[52:55], a[84:87]
    v_fmac_f32 v225, v211, v219
    v_fmac_f32 v226, v212, v219
    v_mfma_f32_16x16x32_bf16 a[88:91], v[72:75], v[56:59], a[88:91]
    ds_read_b64_tr_b16 v[144:145], v10 offset:51200
    v_fmac_f32 v227, v213, v219
    v_mfma_f32_16x16x32_bf16 a[92:95], v[72:75], v[60:63], a[92:95]
    buffer_load_dwordx4 v22, s[20:23], s37 offen offset:1024 lds
    v_mfma_f32_16x16x32_bf16 a[96:99], v[76:79], v[32:35], a[96:99]
    ds_read_b64_tr_b16 v[146:147], v10 offset:52224
    v_fmac_f32 v228, v214, v219
    v_mfma_f32_16x16x32_bf16 a[100:103], v[76:79], v[36:39], a[100:103]
    s_add_u32 s37, s49, 1048576
    v_fmac_f32 v221, v206, v220
    v_fmac_f32 v222, v207, v220
    v_mfma_f32_16x16x32_bf16 a[104:107], v[76:79], v[40:43], a[104:107]
    s_add_u32 m0, s50, 34816
    ds_read_b128 v[108:111], v9 offset:38912
    v_fmac_f32 v223, v208, v220
    v_mfma_f32_16x16x32_bf16 a[108:111], v[76:79], v[44:47], a[108:111]
    buffer_load_dwordx4 v21, s[20:23], s37 offen offset:0 lds
    v_mfma_f32_16x16x32_bf16 a[112:115], v[76:79], v[48:51], a[112:115]
    ds_read_b64_tr_b16 v[148:149], v11 offset:51200
    v_fmac_f32 v224, v209, v220
    v_mfma_f32_16x16x32_bf16 a[116:119], v[76:79], v[52:55], a[116:119]
    v_fmac_f32 v225, v210, v220
    v_fmac_f32 v226, v211, v220
    v_mfma_f32_16x16x32_bf16 a[120:123], v[76:79], v[56:59], a[120:123]
    ds_read_b64_tr_b16 v[150:151], v11 offset:52224
    v_fmac_f32 v227, v212, v220
    v_mfma_f32_16x16x32_bf16 a[124:127], v[76:79], v[60:63], a[124:127]
    buffer_load_dwordx4 v22, s[20:23], s37 offen offset:1024 lds
    v_mfma_f32_16x16x32_bf16 a[128:131], v[32:35], v[80:83], a[128:131]
    ds_read_b128 v[112:115], v9 offset:40960
    v_fmac_f32 v228, v213, v220
    v_mfma_f32_16x16x32_bf16 a[132:135], v[36:39], v[80:83], a[132:135]
    v_lshlrev_b32 v206, 16, v183
    v_lshlrev_b32 v207, 16, v185
    v_mfma_f32_16x16x32_bf16 a[136:139], v[40:43], v[80:83], a[136:139]
    ds_read_b64_tr_b16 v[152:153], v12 offset:51200
    v_lshlrev_b32 v208, 16, v187
    v_mfma_f32_16x16x32_bf16 a[140:143], v[44:47], v[80:83], a[140:143]
    v_mfma_f32_16x16x32_bf16 a[144:147], v[48:51], v[80:83], a[144:147]
    ds_read_b64_tr_b16 v[154:155], v12 offset:52224
    v_lshlrev_b32 v209, 16, v189
    v_mfma_f32_16x16x32_bf16 a[148:151], v[52:55], v[80:83], a[148:151]
    v_lshlrev_b32 v210, 16, v191
    v_lshlrev_b32 v211, 16, v193
    v_mfma_f32_16x16x32_bf16 a[152:155], v[56:59], v[80:83], a[152:155]
    ds_read_b128 v[116:119], v9 offset:43008
    v_lshlrev_b32 v212, 16, v195
    v_mfma_f32_16x16x32_bf16 a[156:159], v[60:63], v[80:83], a[156:159]
    v_mfma_f32_16x16x32_bf16 a[160:163], v[32:35], v[84:87], a[160:163]
    ds_read_b64_tr_b16 v[156:157], v13 offset:51200
    v_lshlrev_b32 v213, 16, v197
    v_mfma_f32_16x16x32_bf16 a[164:167], v[36:39], v[84:87], a[164:167]
    v_mul_f32 v221, v221, v206
    v_mul_f32 v222, v222, v207
    v_mfma_f32_16x16x32_bf16 a[168:171], v[40:43], v[84:87], a[168:171]
    ds_read_b64_tr_b16 v[158:159], v13 offset:52224
    v_mul_f32 v223, v223, v208
    v_mfma_f32_16x16x32_bf16 a[172:175], v[44:47], v[84:87], a[172:175]
    v_mfma_f32_16x16x32_bf16 a[176:179], v[48:51], v[84:87], a[176:179]
    ds_read_b128 v[120:123], v9 offset:45056
    v_mul_f32 v224, v224, v209
    v_mfma_f32_16x16x32_bf16 a[180:183], v[52:55], v[84:87], a[180:183]
    v_mul_f32 v225, v225, v210
    v_mul_f32 v226, v226, v211
    v_mfma_f32_16x16x32_bf16 a[184:187], v[56:59], v[84:87], a[184:187]
    ds_read_b128 v[124:127], v9 offset:47104
    v_mul_f32 v227, v227, v212
    v_mfma_f32_16x16x32_bf16 a[188:191], v[60:63], v[84:87], a[188:191]
    v_mfma_f32_16x16x32_bf16 a[192:195], v[32:35], v[88:91], a[192:195]
    v_mul_f32 v228, v228, v213
    v_cvt_pk_bf16_f32 v244, v228, v227
    v_mfma_f32_16x16x32_bf16 a[196:199], v[36:39], v[88:91], a[196:199]
    v_cvt_pk_bf16_f32 v245, v226, v225
    v_cvt_pk_bf16_f32 v246, v224, v223
    v_mfma_f32_16x16x32_bf16 a[200:203], v[40:43], v[88:91], a[200:203]
    v_cvt_pk_bf16_f32 v247, v222, v221
    v_and_b32 v206, s52, v161
    v_mfma_f32_16x16x32_bf16 a[204:207], v[44:47], v[88:91], a[204:207]
    buffer_store_dwordx4 v[244:247], v234, s[16:19], s54 offen sc1
    v_mfma_f32_16x16x32_bf16 a[208:211], v[48:51], v[88:91], a[208:211]
    s_movk_i32 s54, 13824
    v_and_b32 v207, s52, v163
    v_and_b32 v208, s52, v165
    v_mfma_f32_16x16x32_bf16 a[212:215], v[52:55], v[88:91], a[212:215]
    v_and_b32 v209, s52, v167
    v_and_b32 v210, s52, v169
    v_mfma_f32_16x16x32_bf16 a[216:219], v[56:59], v[88:91], a[216:219]
    v_and_b32 v211, s52, v171
    v_and_b32 v212, s52, v173
    v_mfma_f32_16x16x32_bf16 a[220:223], v[60:63], v[88:91], a[220:223]
    v_mfma_f32_16x16x32_bf16 a[224:227], v[32:35], v[92:95], a[224:227]
    v_and_b32 v213, s52, v175
    v_and_b32 v214, s52, v177
    v_mfma_f32_16x16x32_bf16 a[228:231], v[36:39], v[92:95], a[228:231]
    v_and_b32 v215, s52, v179
    v_and_b32 v216, s52, v181
    v_mfma_f32_16x16x32_bf16 a[232:235], v[40:43], v[92:95], a[232:235]
    v_lshlrev_b32 v217, 16, v204
    v_and_b32 v218, s52, v204
    v_mfma_f32_16x16x32_bf16 a[236:239], v[44:47], v[92:95], a[236:239]
    v_mfma_f32_16x16x32_bf16 a[240:243], v[48:51], v[92:95], a[240:243]
    v_lshlrev_b32 v219, 16, v205
    v_and_b32 v220, s52, v205
    v_mfma_f32_16x16x32_bf16 a[244:247], v[52:55], v[92:95], a[244:247]
    v_mul_f32 v221, v209, v217
    v_mul_f32 v222, v210, v217
    v_mfma_f32_16x16x32_bf16 a[248:251], v[56:59], v[92:95], a[248:251]
    v_mul_f32 v223, v211, v217
    v_mul_f32 v224, v212, v217
    v_mfma_f32_16x16x32_bf16 a[252:255], v[60:63], v[92:95], a[252:255]
    s_waitcnt vmcnt(19) lgkmcnt(0)
    s_barrier
    v_mul_f32 v225, v213, v217
    v_mul_f32 v226, v214, v217
    v_mfma_f32_16x16x32_bf16 a[0:3], v[128:131], v[96:99], a[0:3]
    ds_read_b64_tr_b16 v[48:49], v27 offset:0
    v_mul_f32 v227, v215, v217
    v_mfma_f32_16x16x32_bf16 a[4:7], v[128:131], v[100:103], a[4:7]
    s_add_u32 s36, s44, 256
    v_mul_f32 v228, v216, v217
    v_fmac_f32 v221, v208, v218
    v_mfma_f32_16x16x32_bf16 a[8:11], v[128:131], v[104:107], a[8:11]
    s_add_u32 m0, s42, 32768
    ds_read_b64_tr_b16 v[50:51], v27 offset:1024
    v_fmac_f32 v222, v209, v218
    v_mfma_f32_16x16x32_bf16 a[12:15], v[128:131], v[108:111], a[12:15]
    buffer_load_dwordx4 v17, s[24:27], s36 offen offset:0 lds
    v_mfma_f32_16x16x32_bf16 a[16:19], v[128:131], v[112:115], a[16:19]
    ds_read_b128 v[32:35], v25 offset:0
    v_fmac_f32 v223, v210, v218
    v_mfma_f32_16x16x32_bf16 a[20:23], v[128:131], v[116:119], a[20:23]
    v_fmac_f32 v224, v211, v218
    v_fmac_f32 v225, v212, v218
    v_mfma_f32_16x16x32_bf16 a[24:27], v[128:131], v[120:123], a[24:27]
    ds_read_b128 v[36:39], v25 offset:2048
    v_fmac_f32 v226, v213, v218
    v_mfma_f32_16x16x32_bf16 a[28:31], v[128:131], v[124:127], a[28:31]
    buffer_load_dwordx4 v18, s[24:27], s36 offen offset:1024 lds
    v_mfma_f32_16x16x32_bf16 a[32:35], v[132:135], v[96:99], a[32:35]
    ds_read_b128 v[40:43], v25 offset:4096
    v_fmac_f32 v227, v214, v218
    v_mfma_f32_16x16x32_bf16 a[36:39], v[132:135], v[100:103], a[36:39]
    v_fmac_f32 v228, v215, v218
    v_fmac_f32 v221, v207, v219
    v_mfma_f32_16x16x32_bf16 a[40:43], v[132:135], v[104:107], a[40:43]
    ds_read_b128 v[44:47], v25 offset:6144
    v_fmac_f32 v222, v208, v219
    v_mfma_f32_16x16x32_bf16 a[44:47], v[132:135], v[108:111], a[44:47]
    buffer_load_dwordx4 v19, s[24:27], s36 offen offset:2048 lds
    v_mfma_f32_16x16x32_bf16 a[48:51], v[132:135], v[112:115], a[48:51]
    ds_read_b64_tr_b16 v[52:53], v28 offset:0
    v_fmac_f32 v223, v209, v219
    v_mfma_f32_16x16x32_bf16 a[52:55], v[132:135], v[116:119], a[52:55]
    v_fmac_f32 v224, v210, v219
    v_fmac_f32 v225, v211, v219
    v_mfma_f32_16x16x32_bf16 a[56:59], v[132:135], v[120:123], a[56:59]
    ds_read_b64_tr_b16 v[54:55], v28 offset:1024
    v_fmac_f32 v226, v212, v219
    v_mfma_f32_16x16x32_bf16 a[60:63], v[132:135], v[124:127], a[60:63]
    buffer_load_dwordx4 v20, s[24:27], s36 offen offset:3072 lds
    v_mfma_f32_16x16x32_bf16 a[64:67], v[136:139], v[96:99], a[64:67]
    ds_read_b64_tr_b16 v[56:57], v29 offset:0
    v_fmac_f32 v227, v213, v219
    v_mfma_f32_16x16x32_bf16 a[68:71], v[136:139], v[100:103], a[68:71]
    v_fmac_f32 v228, v214, v219
    v_fmac_f32 v221, v206, v220
    v_mfma_f32_16x16x32_bf16 a[72:75], v[136:139], v[104:107], a[72:75]
    ds_read_b64_tr_b16 v[58:59], v29 offset:1024
    v_fmac_f32 v222, v207, v220
    v_mfma_f32_16x16x32_bf16 a[76:79], v[136:139], v[108:111], a[76:79]
    v_mfma_f32_16x16x32_bf16 a[80:83], v[136:139], v[112:115], a[80:83]
    ds_read_b64_tr_b16 v[60:61], v30 offset:0
    v_fmac_f32 v223, v208, v220
    v_mfma_f32_16x16x32_bf16 a[84:87], v[136:139], v[116:119], a[84:87]
    v_fmac_f32 v224, v209, v220
    v_fmac_f32 v225, v210, v220
    v_mfma_f32_16x16x32_bf16 a[88:91], v[136:139], v[120:123], a[88:91]
    ds_read_b64_tr_b16 v[62:63], v30 offset:1024
    v_fmac_f32 v226, v211, v220
    v_mfma_f32_16x16x32_bf16 a[92:95], v[136:139], v[124:127], a[92:95]
    v_mfma_f32_16x16x32_bf16 a[96:99], v[140:143], v[96:99], a[96:99]
    ds_read_b64_tr_b16 v[64:65], v27 offset:128
    v_fmac_f32 v227, v212, v220
    v_mfma_f32_16x16x32_bf16 a[100:103], v[140:143], v[100:103], a[100:103]
    v_fmac_f32 v228, v213, v220
    v_and_b32 v206, s52, v183
    v_mfma_f32_16x16x32_bf16 a[104:107], v[140:143], v[104:107], a[104:107]
    ds_read_b64_tr_b16 v[66:67], v27 offset:1152
    v_and_b32 v207, s52, v185
    v_mfma_f32_16x16x32_bf16 a[108:111], v[140:143], v[108:111], a[108:111]
    v_mfma_f32_16x16x32_bf16 a[112:115], v[140:143], v[112:115], a[112:115]
    ds_read_b64_tr_b16 v[68:69], v28 offset:128
    v_and_b32 v208, s52, v187
    v_mfma_f32_16x16x32_bf16 a[116:119], v[140:143], v[116:119], a[116:119]
    v_and_b32 v209, s52, v189
    v_and_b32 v210, s52, v191
    v_mfma_f32_16x16x32_bf16 a[120:123], v[140:143], v[120:123], a[120:123]
    ds_read_b64_tr_b16 v[70:71], v28 offset:1152
    v_and_b32 v211, s52, v193
    v_mfma_f32_16x16x32_bf16 a[124:127], v[140:143], v[124:127], a[124:127]
    v_mfma_f32_16x16x32_bf16 a[128:131], v[96:99], v[144:147], a[128:131]
    ds_read_b64_tr_b16 v[72:73], v29 offset:128
    v_and_b32 v212, s52, v195
    v_mfma_f32_16x16x32_bf16 a[132:135], v[100:103], v[144:147], a[132:135]
    v_and_b32 v213, s52, v197
    v_mul_f32 v221, v221, v206
    v_mfma_f32_16x16x32_bf16 a[136:139], v[104:107], v[144:147], a[136:139]
    ds_read_b64_tr_b16 v[74:75], v29 offset:1152
    v_mul_f32 v222, v222, v207
    v_mfma_f32_16x16x32_bf16 a[140:143], v[108:111], v[144:147], a[140:143]
    v_mfma_f32_16x16x32_bf16 a[144:147], v[112:115], v[144:147], a[144:147]
    ds_read_b64_tr_b16 v[76:77], v30 offset:128
    v_mul_f32 v223, v223, v208
    v_mfma_f32_16x16x32_bf16 a[148:151], v[116:119], v[144:147], a[148:151]
    v_mul_f32 v224, v224, v209
    v_mul_f32 v225, v225, v210
    v_mfma_f32_16x16x32_bf16 a[152:155], v[120:123], v[144:147], a[152:155]
    ds_read_b64_tr_b16 v[78:79], v30 offset:1152
    v_mul_f32 v226, v226, v211
    v_mfma_f32_16x16x32_bf16 a[156:159], v[124:127], v[144:147], a[156:159]
    v_mfma_f32_16x16x32_bf16 a[160:163], v[96:99], v[148:151], a[160:163]
    v_mul_f32 v227, v227, v212
    v_mul_f32 v228, v228, v213
    v_mfma_f32_16x16x32_bf16 a[164:167], v[100:103], v[148:151], a[164:167]
    v_cvt_pk_bf16_f32 v248, v228, v227
    v_cvt_pk_bf16_f32 v249, v226, v225
    v_mfma_f32_16x16x32_bf16 a[168:171], v[104:107], v[148:151], a[168:171]
    v_cvt_pk_bf16_f32 v250, v224, v223
    v_cvt_pk_bf16_f32 v251, v222, v221
    v_mfma_f32_16x16x32_bf16 a[172:175], v[108:111], v[148:151], a[172:175]
    buffer_store_dwordx4 v[248:251], v234, s[16:19], s54 offen sc1
    v_mfma_f32_16x16x32_bf16 a[176:179], v[112:115], v[148:151], a[176:179]
    v_mov_b32 v160, 0
    v_mov_b32 v161, 0
    v_mfma_f32_16x16x32_bf16 a[180:183], v[116:119], v[148:151], a[180:183]
    v_mov_b32 v162, 0
    v_mov_b32 v163, 0
    v_mfma_f32_16x16x32_bf16 a[184:187], v[120:123], v[148:151], a[184:187]
    v_mfma_f32_16x16x32_bf16 a[188:191], v[124:127], v[148:151], a[188:191]
    buffer_store_dwordx4 v[160:163], v235, s[16:19], s53 offen sc1
    v_mfma_f32_16x16x32_bf16 a[192:195], v[96:99], v[152:155], a[192:195]
    v_mfma_f32_16x16x32_bf16 a[196:199], v[100:103], v[152:155], a[196:199]
    v_mfma_f32_16x16x32_bf16 a[200:203], v[104:107], v[152:155], a[200:203]
    v_mfma_f32_16x16x32_bf16 a[204:207], v[108:111], v[152:155], a[204:207]
    v_mfma_f32_16x16x32_bf16 a[208:211], v[112:115], v[152:155], a[208:211]
    v_mfma_f32_16x16x32_bf16 a[212:215], v[116:119], v[152:155], a[212:215]
    v_mfma_f32_16x16x32_bf16 a[216:219], v[120:123], v[152:155], a[216:219]
    v_mfma_f32_16x16x32_bf16 a[220:223], v[124:127], v[152:155], a[220:223]
    v_mfma_f32_16x16x32_bf16 a[224:227], v[96:99], v[156:159], a[224:227]
    v_mfma_f32_16x16x32_bf16 a[228:231], v[100:103], v[156:159], a[228:231]
    v_mfma_f32_16x16x32_bf16 a[232:235], v[104:107], v[156:159], a[232:235]
    v_mfma_f32_16x16x32_bf16 a[236:239], v[108:111], v[156:159], a[236:239]
    v_mfma_f32_16x16x32_bf16 a[240:243], v[112:115], v[156:159], a[240:243]
    v_mfma_f32_16x16x32_bf16 a[244:247], v[116:119], v[156:159], a[244:247]
    v_mfma_f32_16x16x32_bf16 a[248:251], v[120:123], v[156:159], a[248:251]
    v_mfma_f32_16x16x32_bf16 a[252:255], v[124:127], v[156:159], a[252:255]
    s_waitcnt vmcnt(19) lgkmcnt(0)
    s_barrier
    v_mfma_f32_16x16x32_bf16 v[128:131], v[48:51], v[32:35], 0
    s_lshl_b32 s38, s33, 6
    ds_read_b64_tr_b16 v[96:97], v27 offset:8704
    ds_read_b64_tr_b16 v[98:99], v27 offset:9728
    v_mfma_f32_16x16x32_bf16 v[160:163], v[48:51], v[36:39], 0
    s_add_u32 s36, s45, 256
    v_mfma_f32_16x16x32_bf16 v[192:195], v[48:51], v[40:43], 0
    s_add_u32 m0, s42, 36864
    ds_read_b128 v[80:83], v26 offset:0
    ds_read_b128 v[84:87], v26 offset:2048
    v_mfma_f32_16x16x32_bf16 v[224:227], v[48:51], v[44:47], 0
    buffer_load_dwordx4 v17, s[24:27], s36 offen offset:0 lds
    v_mfma_f32_16x16x32_bf16 v[132:135], v[52:55], v[32:35], 0
    s_lshl_b32 s54, s34, 3
    ds_read_b128 v[88:91], v26 offset:4096
    ds_read_b128 v[92:95], v26 offset:6144
    v_mfma_f32_16x16x32_bf16 v[164:167], v[52:55], v[36:39], 0
    s_add_u32 s38, s38, s54
    v_accvgpr_read_b32 v4, a132
    v_accvgpr_read_b32 v5, a133
    v_mfma_f32_16x16x32_bf16 v[196:199], v[52:55], v[40:43], 0
    s_lshr_b32 s54, s32, 1
    ds_read_b64_tr_b16 v[100:101], v28 offset:8704
    ds_read_b64_tr_b16 v[102:103], v28 offset:9728
    v_mfma_f32_16x16x32_bf16 v[228:231], v[52:55], v[44:47], 0
    buffer_load_dwordx4 v18, s[24:27], s36 offen offset:1024 lds
    v_mfma_f32_16x16x32_bf16 v[136:139], v[56:59], v[32:35], 0
    s_lshl_b32 s54, s54, 2
    ds_read_b64_tr_b16 v[104:105], v29 offset:8704
    ds_read_b64_tr_b16 v[106:107], v29 offset:9728
    v_mfma_f32_16x16x32_bf16 v[168:171], v[56:59], v[36:39], 0
    s_add_u32 s38, s38, s54
    v_accvgpr_read_b32 v6, a134
    v_accvgpr_read_b32 v7, a135
    v_mfma_f32_16x16x32_bf16 v[200:203], v[56:59], v[40:43], 0
    s_lshl_b32 s38, s38, 14
    ds_read_b64_tr_b16 v[108:109], v30 offset:8704
    ds_read_b64_tr_b16 v[110:111], v30 offset:9728
    v_mfma_f32_16x16x32_bf16 v[232:235], v[56:59], v[44:47], 0
    v_mfma_f32_16x16x32_bf16 v[140:143], v[60:63], v[32:35], 0
    s_and_b32 s54, s32, 1
    ds_read_b64_tr_b16 v[112:113], v27 offset:8832
    ds_read_b64_tr_b16 v[114:115], v27 offset:9856
    v_mfma_f32_16x16x32_bf16 v[172:175], v[60:63], v[36:39], 0
    s_lshl_b32 s54, s54, 11
    v_accvgpr_read_b32 v0, a128
    v_accvgpr_read_b32 v1, a129
    v_mfma_f32_16x16x32_bf16 v[204:207], v[60:63], v[40:43], 0
    s_add_u32 s41, s38, s54
    ds_read_b64_tr_b16 v[116:117], v28 offset:8832
    ds_read_b64_tr_b16 v[118:119], v28 offset:9856
    v_mfma_f32_16x16x32_bf16 v[236:239], v[60:63], v[44:47], 0
    buffer_load_dwordx4 v19, s[24:27], s36 offen offset:2048 lds
    v_mfma_f32_16x16x32_bf16 v[144:147], v[64:67], v[32:35], 0
    s_add_u32 s38, s41, s54
    ds_read_b64_tr_b16 v[120:121], v29 offset:8832
    ds_read_b64_tr_b16 v[122:123], v29 offset:9856
    v_mfma_f32_16x16x32_bf16 v[176:179], v[64:67], v[36:39], 0
    s_add_u32 s38, s38, 8192
    v_accvgpr_read_b32 v2, a130
    v_accvgpr_read_b32 v3, a131
    v_mfma_f32_16x16x32_bf16 v[208:211], v[64:67], v[40:43], 0
    s_mov_b32 s40, 0x3e0293ee
    ds_read_b64_tr_b16 v[124:125], v30 offset:8832
    ds_read_b64_tr_b16 v[126:127], v30 offset:9856
    v_mfma_f32_16x16x32_bf16 v[240:243], v[64:67], v[44:47], 0
gated_mix__ssm_conv_h3__compressed_kv_cla__prompt_kernel_pad3:
    s_cbranch_execz gated_mix__ssm_conv_h3__compressed_kv_cla__prompt_kernel_pad7
    s_mov_b32 s16, s94
    v_cvt_pk_bf16_f32 v0, v0, v1
    v_cvt_pk_bf16_f32 v1, v2, v3
    v_mfma_f32_16x16x32_bf16 v[148:151], v[68:71], v[32:35], 0
    s_mov_b32 s17, s95
    v_cvt_pk_bf16_f32 v2, v4, v5
    v_cvt_pk_bf16_f32 v3, v6, v7
    v_mfma_f32_16x16x32_bf16 v[180:183], v[68:71], v[36:39], 0
    buffer_load_dwordx4 v20, s[24:27], s36 offen offset:3072 lds
    v_mfma_f32_16x16x32_bf16 v[212:215], v[68:71], v[40:43], 0
    s_add_u32 s37, s49, 1310720
    v_accvgpr_read_b32 v12, a32
    v_accvgpr_read_b32 v13, a33
    v_mfma_f32_16x16x32_bf16 v[244:247], v[68:71], v[44:47], 0
    s_add_u32 m0, s50, 43520
    v_accvgpr_read_b32 v14, a34
    v_accvgpr_read_b32 v15, a35
    v_mfma_f32_16x16x32_bf16 v[152:155], v[72:75], v[32:35], 0
    buffer_load_dwordx4 v21, s[20:23], s37 offen offset:0 lds
    v_mfma_f32_16x16x32_bf16 v[184:187], v[72:75], v[36:39], 0
    s_mov_b32 s18, 33554432
    v_accvgpr_read_b32 v8, a0
    v_accvgpr_read_b32 v9, a1
    v_mfma_f32_16x16x32_bf16 v[216:219], v[72:75], v[40:43], 0
    v_accvgpr_read_b32 v10, a2
    v_accvgpr_read_b32 v11, a3
    v_mfma_f32_16x16x32_bf16 v[248:251], v[72:75], v[44:47], 0
    buffer_store_dwordx4 v[0:3], v16, s[16:19], s38 offen offset:0
    v_mfma_f32_16x16x32_bf16 v[156:159], v[76:79], v[32:35], 0
    v_mul_f32 v8, s40, v8
    v_mul_f32 v9, s40, v9
    v_mfma_f32_16x16x32_bf16 v[188:191], v[76:79], v[36:39], 0
    v_mul_f32 v10, s40, v10
    v_mul_f32 v11, s40, v11
    v_mfma_f32_16x16x32_bf16 v[220:223], v[76:79], v[40:43], 0
    buffer_load_dwordx4 v22, s[20:23], s37 offen offset:1024 lds
    v_mfma_f32_16x16x32_bf16 v[252:255], v[76:79], v[44:47], 0
    s_waitcnt vmcnt(16) lgkmcnt(0)
    s_barrier
    v_mul_f32 v12, s40, v12
    v_mul_f32 v13, s40, v13
    v_mfma_f32_16x16x32_bf16 v[128:131], v[96:99], v[80:83], v[128:131]
    ds_read_b64_tr_b16 v[48:49], v27 offset:17408
    ds_read_b64_tr_b16 v[50:51], v27 offset:18432
    v_mfma_f32_16x16x32_bf16 v[160:163], v[96:99], v[84:87], v[160:163]
    s_add_u32 s36, s44, 384
    v_mul_f32 v14, s40, v14
    v_mul_f32 v15, s40, v15
    v_mfma_f32_16x16x32_bf16 v[192:195], v[96:99], v[88:91], v[192:195]
    s_add_u32 m0, s42, 65536
    ds_read_b128 v[32:35], v23 offset:0
    ds_read_b128 v[36:39], v23 offset:2048
    v_mfma_f32_16x16x32_bf16 v[224:227], v[96:99], v[92:95], v[224:227]
    buffer_load_dwordx4 v17, s[24:27], s36 offen offset:0 lds
    v_mfma_f32_16x16x32_bf16 v[132:135], v[100:103], v[80:83], v[132:135]
    ds_read_b128 v[40:43], v23 offset:4096
    ds_read_b128 v[44:47], v23 offset:6144
    v_mfma_f32_16x16x32_bf16 v[164:167], v[100:103], v[84:87], v[164:167]
    v_cvt_pk_bf16_f32 v8, v8, v9
    v_cvt_pk_bf16_f32 v9, v10, v11
    v_mfma_f32_16x16x32_bf16 v[196:199], v[100:103], v[88:91], v[196:199]
    ds_read_b64_tr_b16 v[52:53], v28 offset:17408
    ds_read_b64_tr_b16 v[54:55], v28 offset:18432
    v_mfma_f32_16x16x32_bf16 v[228:231], v[100:103], v[92:95], v[228:231]
    buffer_load_dwordx4 v18, s[24:27], s36 offen offset:1024 lds
    v_mfma_f32_16x16x32_bf16 v[136:139], v[104:107], v[80:83], v[136:139]
    ds_read_b64_tr_b16 v[56:57], v29 offset:17408
    ds_read_b64_tr_b16 v[58:59], v29 offset:18432
    v_mfma_f32_16x16x32_bf16 v[168:171], v[104:107], v[84:87], v[168:171]
    v_cvt_pk_bf16_f32 v10, v12, v13
    v_cvt_pk_bf16_f32 v11, v14, v15
    v_mfma_f32_16x16x32_bf16 v[200:203], v[104:107], v[88:91], v[200:203]
    ds_read_b64_tr_b16 v[60:61], v30 offset:17408
    ds_read_b64_tr_b16 v[62:63], v30 offset:18432
    v_mfma_f32_16x16x32_bf16 v[232:235], v[104:107], v[92:95], v[232:235]
    buffer_store_dwordx4 v[8:11], v16, s[16:19], s41 offen offset:0
    v_mfma_f32_16x16x32_bf16 v[140:143], v[108:111], v[80:83], v[140:143]
    ds_read_b64_tr_b16 v[64:65], v27 offset:17536
    ds_read_b64_tr_b16 v[66:67], v27 offset:18560
    v_mfma_f32_16x16x32_bf16 v[172:175], v[108:111], v[84:87], v[172:175]
    v_accvgpr_read_b32 v4, a164
    v_accvgpr_read_b32 v5, a165
    v_mfma_f32_16x16x32_bf16 v[204:207], v[108:111], v[88:91], v[204:207]
    ds_read_b64_tr_b16 v[68:69], v28 offset:17536
    ds_read_b64_tr_b16 v[70:71], v28 offset:18560
    v_mfma_f32_16x16x32_bf16 v[236:239], v[108:111], v[92:95], v[236:239]
    buffer_load_dwordx4 v19, s[24:27], s36 offen offset:2048 lds
    v_mfma_f32_16x16x32_bf16 v[144:147], v[112:115], v[80:83], v[144:147]
    ds_read_b64_tr_b16 v[72:73], v29 offset:17536
    ds_read_b64_tr_b16 v[74:75], v29 offset:18560
    v_mfma_f32_16x16x32_bf16 v[176:179], v[112:115], v[84:87], v[176:179]
    v_accvgpr_read_b32 v6, a166
    v_accvgpr_read_b32 v7, a167
    v_mfma_f32_16x16x32_bf16 v[208:211], v[112:115], v[88:91], v[208:211]
    ds_read_b64_tr_b16 v[76:77], v30 offset:17536
    ds_read_b64_tr_b16 v[78:79], v30 offset:18560
    v_mfma_f32_16x16x32_bf16 v[240:243], v[112:115], v[92:95], v[240:243]
    v_accvgpr_read_b32 v0, a160
    v_accvgpr_read_b32 v1, a161
    v_mfma_f32_16x16x32_bf16 v[148:151], v[116:119], v[80:83], v[148:151]
    v_accvgpr_read_b32 v2, a162
    v_accvgpr_read_b32 v3, a163
    v_mfma_f32_16x16x32_bf16 v[180:183], v[116:119], v[84:87], v[180:183]
    buffer_load_dwordx4 v20, s[24:27], s36 offen offset:3072 lds
    v_mfma_f32_16x16x32_bf16 v[212:215], v[116:119], v[88:91], v[212:215]
    s_add_u32 s37, s49, 1572864
    v_cvt_pk_bf16_f32 v0, v0, v1
    v_cvt_pk_bf16_f32 v1, v2, v3
    v_mfma_f32_16x16x32_bf16 v[244:247], v[116:119], v[92:95], v[244:247]
    s_add_u32 m0, s50, 0
    v_cvt_pk_bf16_f32 v2, v4, v5
    v_cvt_pk_bf16_f32 v3, v6, v7
    v_mfma_f32_16x16x32_bf16 v[152:155], v[120:123], v[80:83], v[152:155]
    buffer_load_dwordx4 v21, s[20:23], s37 offen offset:0 lds
    v_mfma_f32_16x16x32_bf16 v[184:187], v[120:123], v[84:87], v[184:187]
    v_accvgpr_read_b32 v12, a96
    v_accvgpr_read_b32 v13, a97
    v_mfma_f32_16x16x32_bf16 v[216:219], v[120:123], v[88:91], v[216:219]
    v_accvgpr_read_b32 v14, a98
    v_accvgpr_read_b32 v15, a99
    v_mfma_f32_16x16x32_bf16 v[248:251], v[120:123], v[92:95], v[248:251]
    buffer_store_dwordx4 v[0:3], v16, s[16:19], s38 offen offset:1024
    v_mfma_f32_16x16x32_bf16 v[156:159], v[124:127], v[80:83], v[156:159]
    v_accvgpr_read_b32 v8, a64
    v_accvgpr_read_b32 v9, a65
    v_mfma_f32_16x16x32_bf16 v[188:191], v[124:127], v[84:87], v[188:191]
    v_accvgpr_read_b32 v10, a66
    v_accvgpr_read_b32 v11, a67
    v_mfma_f32_16x16x32_bf16 v[220:223], v[124:127], v[88:91], v[220:223]
    buffer_load_dwordx4 v22, s[20:23], s37 offen offset:1024 lds
    v_mfma_f32_16x16x32_bf16 v[252:255], v[124:127], v[92:95], v[252:255]
    s_waitcnt lgkmcnt(0)
    v_mul_f32 v8, s40, v8
    v_mul_f32 v9, s40, v9
    v_mfma_f32_16x16x32_bf16 v[128:131], v[48:51], v[32:35], v[128:131]
    ds_read_b64_tr_b16 v[96:97], v27 offset:26112
    ds_read_b64_tr_b16 v[98:99], v27 offset:27136
    v_mfma_f32_16x16x32_bf16 v[160:163], v[48:51], v[36:39], v[160:163]
    s_add_u32 s36, s45, 384
    v_mul_f32 v10, s40, v10
    v_mul_f32 v11, s40, v11
    v_mfma_f32_16x16x32_bf16 v[192:195], v[48:51], v[40:43], v[192:195]
    s_add_u32 m0, s42, 69632
    ds_read_b128 v[80:83], v24 offset:0
    ds_read_b128 v[84:87], v24 offset:2048
    v_mfma_f32_16x16x32_bf16 v[224:227], v[48:51], v[44:47], v[224:227]
    buffer_load_dwordx4 v17, s[24:27], s36 offen offset:0 lds
    v_mfma_f32_16x16x32_bf16 v[132:135], v[52:55], v[32:35], v[132:135]
    ds_read_b128 v[88:91], v24 offset:4096
    ds_read_b128 v[92:95], v24 offset:6144
    v_mfma_f32_16x16x32_bf16 v[164:167], v[52:55], v[36:39], v[164:167]
    v_mul_f32 v12, s40, v12
    v_mul_f32 v13, s40, v13
    v_mfma_f32_16x16x32_bf16 v[196:199], v[52:55], v[40:43], v[196:199]
    ds_read_b64_tr_b16 v[100:101], v28 offset:26112
    ds_read_b64_tr_b16 v[102:103], v28 offset:27136
    v_mfma_f32_16x16x32_bf16 v[228:231], v[52:55], v[44:47], v[228:231]
    buffer_load_dwordx4 v18, s[24:27], s36 offen offset:1024 lds
    v_mfma_f32_16x16x32_bf16 v[136:139], v[56:59], v[32:35], v[136:139]
    ds_read_b64_tr_b16 v[104:105], v29 offset:26112
    ds_read_b64_tr_b16 v[106:107], v29 offset:27136
    v_mfma_f32_16x16x32_bf16 v[168:171], v[56:59], v[36:39], v[168:171]
    v_mul_f32 v14, s40, v14
    v_mul_f32 v15, s40, v15
    v_mfma_f32_16x16x32_bf16 v[200:203], v[56:59], v[40:43], v[200:203]
    ds_read_b64_tr_b16 v[108:109], v30 offset:26112
    ds_read_b64_tr_b16 v[110:111], v30 offset:27136
    v_mfma_f32_16x16x32_bf16 v[232:235], v[56:59], v[44:47], v[232:235]
    v_mfma_f32_16x16x32_bf16 v[140:143], v[60:63], v[32:35], v[140:143]
    ds_read_b64_tr_b16 v[112:113], v27 offset:26240
    ds_read_b64_tr_b16 v[114:115], v27 offset:27264
    v_mfma_f32_16x16x32_bf16 v[172:175], v[60:63], v[36:39], v[172:175]
    v_cvt_pk_bf16_f32 v8, v8, v9
    v_cvt_pk_bf16_f32 v9, v10, v11
    v_mfma_f32_16x16x32_bf16 v[204:207], v[60:63], v[40:43], v[204:207]
    ds_read_b64_tr_b16 v[116:117], v28 offset:26240
    ds_read_b64_tr_b16 v[118:119], v28 offset:27264
    v_mfma_f32_16x16x32_bf16 v[236:239], v[60:63], v[44:47], v[236:239]
    buffer_load_dwordx4 v19, s[24:27], s36 offen offset:2048 lds
    v_mfma_f32_16x16x32_bf16 v[144:147], v[64:67], v[32:35], v[144:147]
    ds_read_b64_tr_b16 v[120:121], v29 offset:26240
    ds_read_b64_tr_b16 v[122:123], v29 offset:27264
    v_mfma_f32_16x16x32_bf16 v[176:179], v[64:67], v[36:39], v[176:179]
    v_cvt_pk_bf16_f32 v10, v12, v13
    v_cvt_pk_bf16_f32 v11, v14, v15
    v_mfma_f32_16x16x32_bf16 v[208:211], v[64:67], v[40:43], v[208:211]
    ds_read_b64_tr_b16 v[124:125], v30 offset:26240
    ds_read_b64_tr_b16 v[126:127], v30 offset:27264
    v_mfma_f32_16x16x32_bf16 v[240:243], v[64:67], v[44:47], v[240:243]
    v_accvgpr_read_b32 v4, a196
    v_accvgpr_read_b32 v5, a197
    v_mfma_f32_16x16x32_bf16 v[148:151], v[68:71], v[32:35], v[148:151]
    v_accvgpr_read_b32 v6, a198
    v_accvgpr_read_b32 v7, a199
    v_mfma_f32_16x16x32_bf16 v[180:183], v[68:71], v[36:39], v[180:183]
    buffer_load_dwordx4 v20, s[24:27], s36 offen offset:3072 lds
    v_mfma_f32_16x16x32_bf16 v[212:215], v[68:71], v[40:43], v[212:215]
    s_add_u32 s37, s49, 1835008
    v_accvgpr_read_b32 v0, a192
    v_accvgpr_read_b32 v1, a193
    v_mfma_f32_16x16x32_bf16 v[244:247], v[68:71], v[44:47], v[244:247]
    s_add_u32 m0, s50, 8704
    v_accvgpr_read_b32 v2, a194
    v_accvgpr_read_b32 v3, a195
    v_mfma_f32_16x16x32_bf16 v[152:155], v[72:75], v[32:35], v[152:155]
    buffer_load_dwordx4 v21, s[20:23], s37 offen offset:0 lds
    v_mfma_f32_16x16x32_bf16 v[184:187], v[72:75], v[36:39], v[184:187]
    v_cvt_pk_bf16_f32 v0, v0, v1
    v_cvt_pk_bf16_f32 v1, v2, v3
    v_mfma_f32_16x16x32_bf16 v[216:219], v[72:75], v[40:43], v[216:219]
    v_cvt_pk_bf16_f32 v2, v4, v5
    v_cvt_pk_bf16_f32 v3, v6, v7
    v_mfma_f32_16x16x32_bf16 v[248:251], v[72:75], v[44:47], v[248:251]
    buffer_store_dwordx4 v[8:11], v16, s[16:19], s41 offen offset:1024
    v_mfma_f32_16x16x32_bf16 v[156:159], v[76:79], v[32:35], v[156:159]
    s_add_u32 s41, s41, 4096
    v_accvgpr_read_b32 v12, a36
    v_accvgpr_read_b32 v13, a37
    v_mfma_f32_16x16x32_bf16 v[188:191], v[76:79], v[36:39], v[188:191]
    v_accvgpr_read_b32 v14, a38
    v_accvgpr_read_b32 v15, a39
    v_mfma_f32_16x16x32_bf16 v[220:223], v[76:79], v[40:43], v[220:223]
    buffer_load_dwordx4 v22, s[20:23], s37 offen offset:1024 lds
    v_mfma_f32_16x16x32_bf16 v[252:255], v[76:79], v[44:47], v[252:255]
    s_waitcnt vmcnt(15) lgkmcnt(0)
    s_barrier
    v_accvgpr_read_b32 v8, a4
    v_accvgpr_read_b32 v9, a5
    v_mfma_f32_16x16x32_bf16 v[128:131], v[96:99], v[80:83], v[128:131]
    ds_read_b64_tr_b16 v[48:49], v27 offset:34816
    ds_read_b64_tr_b16 v[50:51], v27 offset:35840
    v_mfma_f32_16x16x32_bf16 v[160:163], v[96:99], v[84:87], v[160:163]
    s_add_u32 s36, s44, 512
    v_accvgpr_read_b32 v10, a6
    v_accvgpr_read_b32 v11, a7
    v_mfma_f32_16x16x32_bf16 v[192:195], v[96:99], v[88:91], v[192:195]
    s_add_u32 m0, s42, 0
    ds_read_b128 v[32:35], v23 offset:32768
    ds_read_b128 v[36:39], v23 offset:34816
    v_mfma_f32_16x16x32_bf16 v[224:227], v[96:99], v[92:95], v[224:227]
    buffer_load_dwordx4 v17, s[24:27], s36 offen offset:0 lds
    v_mfma_f32_16x16x32_bf16 v[132:135], v[100:103], v[80:83], v[132:135]
    ds_read_b128 v[40:43], v23 offset:36864
    ds_read_b128 v[44:47], v23 offset:38912
    v_mfma_f32_16x16x32_bf16 v[164:167], v[100:103], v[84:87], v[164:167]
    v_mul_f32 v8, s40, v8
    v_mul_f32 v9, s40, v9
    v_mfma_f32_16x16x32_bf16 v[196:199], v[100:103], v[88:91], v[196:199]
    ds_read_b64_tr_b16 v[52:53], v28 offset:34816
    ds_read_b64_tr_b16 v[54:55], v28 offset:35840
    v_mfma_f32_16x16x32_bf16 v[228:231], v[100:103], v[92:95], v[228:231]
    buffer_load_dwordx4 v18, s[24:27], s36 offen offset:1024 lds
    v_mfma_f32_16x16x32_bf16 v[136:139], v[104:107], v[80:83], v[136:139]
    ds_read_b64_tr_b16 v[56:57], v29 offset:34816
    ds_read_b64_tr_b16 v[58:59], v29 offset:35840
    v_mfma_f32_16x16x32_bf16 v[168:171], v[104:107], v[84:87], v[168:171]
    v_mul_f32 v10, s40, v10
    v_mul_f32 v11, s40, v11
    v_mfma_f32_16x16x32_bf16 v[200:203], v[104:107], v[88:91], v[200:203]
    ds_read_b64_tr_b16 v[60:61], v30 offset:34816
    ds_read_b64_tr_b16 v[62:63], v30 offset:35840
    v_mfma_f32_16x16x32_bf16 v[232:235], v[104:107], v[92:95], v[232:235]
    buffer_store_dwordx4 v[0:3], v16, s[16:19], s38 offen offset:2048
    v_mfma_f32_16x16x32_bf16 v[140:143], v[108:111], v[80:83], v[140:143]
    ds_read_b64_tr_b16 v[64:65], v27 offset:34944
    ds_read_b64_tr_b16 v[66:67], v27 offset:35968
    v_mfma_f32_16x16x32_bf16 v[172:175], v[108:111], v[84:87], v[172:175]
    v_mul_f32 v12, s40, v12
    v_mul_f32 v13, s40, v13
    v_mfma_f32_16x16x32_bf16 v[204:207], v[108:111], v[88:91], v[204:207]
    ds_read_b64_tr_b16 v[68:69], v28 offset:34944
    ds_read_b64_tr_b16 v[70:71], v28 offset:35968
    v_mfma_f32_16x16x32_bf16 v[236:239], v[108:111], v[92:95], v[236:239]
    buffer_load_dwordx4 v19, s[24:27], s36 offen offset:2048 lds
    v_mfma_f32_16x16x32_bf16 v[144:147], v[112:115], v[80:83], v[144:147]
    ds_read_b64_tr_b16 v[72:73], v29 offset:34944
    ds_read_b64_tr_b16 v[74:75], v29 offset:35968
    v_mfma_f32_16x16x32_bf16 v[176:179], v[112:115], v[84:87], v[176:179]
    v_mul_f32 v14, s40, v14
    v_mul_f32 v15, s40, v15
    v_mfma_f32_16x16x32_bf16 v[208:211], v[112:115], v[88:91], v[208:211]
    ds_read_b64_tr_b16 v[76:77], v30 offset:34944
    ds_read_b64_tr_b16 v[78:79], v30 offset:35968
    v_mfma_f32_16x16x32_bf16 v[240:243], v[112:115], v[92:95], v[240:243]
    v_cvt_pk_bf16_f32 v8, v8, v9
    v_cvt_pk_bf16_f32 v9, v10, v11
    v_mfma_f32_16x16x32_bf16 v[148:151], v[116:119], v[80:83], v[148:151]
    v_cvt_pk_bf16_f32 v10, v12, v13
    v_cvt_pk_bf16_f32 v11, v14, v15
    v_mfma_f32_16x16x32_bf16 v[180:183], v[116:119], v[84:87], v[180:183]
    buffer_load_dwordx4 v20, s[24:27], s36 offen offset:3072 lds
    v_mfma_f32_16x16x32_bf16 v[212:215], v[116:119], v[88:91], v[212:215]
    s_add_u32 s37, s49, 2097152
    v_accvgpr_read_b32 v4, a228
    v_accvgpr_read_b32 v5, a229
    v_mfma_f32_16x16x32_bf16 v[244:247], v[116:119], v[92:95], v[244:247]
    s_add_u32 m0, s50, 17408
    v_accvgpr_read_b32 v6, a230
    v_accvgpr_read_b32 v7, a231
    v_mfma_f32_16x16x32_bf16 v[152:155], v[120:123], v[80:83], v[152:155]
    buffer_load_dwordx4 v21, s[20:23], s37 offen offset:0 lds
    v_mfma_f32_16x16x32_bf16 v[184:187], v[120:123], v[84:87], v[184:187]
    v_accvgpr_read_b32 v0, a224
    v_accvgpr_read_b32 v1, a225
    v_mfma_f32_16x16x32_bf16 v[216:219], v[120:123], v[88:91], v[216:219]
    v_accvgpr_read_b32 v2, a226
    v_accvgpr_read_b32 v3, a227
    v_mfma_f32_16x16x32_bf16 v[248:251], v[120:123], v[92:95], v[248:251]
    buffer_store_dwordx4 v[8:11], v16, s[16:19], s41 offen offset:0
    v_mfma_f32_16x16x32_bf16 v[156:159], v[124:127], v[80:83], v[156:159]
    v_cvt_pk_bf16_f32 v0, v0, v1
    v_cvt_pk_bf16_f32 v1, v2, v3
    v_mfma_f32_16x16x32_bf16 v[188:191], v[124:127], v[84:87], v[188:191]
    v_cvt_pk_bf16_f32 v2, v4, v5
    v_cvt_pk_bf16_f32 v3, v6, v7
    v_mfma_f32_16x16x32_bf16 v[220:223], v[124:127], v[88:91], v[220:223]
    buffer_load_dwordx4 v22, s[20:23], s37 offen offset:1024 lds
    v_mfma_f32_16x16x32_bf16 v[252:255], v[124:127], v[92:95], v[252:255]
    s_waitcnt lgkmcnt(0)
    v_accvgpr_read_b32 v12, a100
    v_accvgpr_read_b32 v13, a101
    v_mfma_f32_16x16x32_bf16 v[128:131], v[48:51], v[32:35], v[128:131]
    ds_read_b64_tr_b16 v[96:97], v27 offset:43520
    ds_read_b64_tr_b16 v[98:99], v27 offset:44544
    v_mfma_f32_16x16x32_bf16 v[160:163], v[48:51], v[36:39], v[160:163]
    s_add_u32 s36, s45, 512
    v_accvgpr_read_b32 v14, a102
    v_accvgpr_read_b32 v15, a103
    v_mfma_f32_16x16x32_bf16 v[192:195], v[48:51], v[40:43], v[192:195]
    s_add_u32 m0, s42, 4096
    ds_read_b128 v[80:83], v24 offset:32768
    ds_read_b128 v[84:87], v24 offset:34816
    v_mfma_f32_16x16x32_bf16 v[224:227], v[48:51], v[44:47], v[224:227]
    buffer_load_dwordx4 v17, s[24:27], s36 offen offset:0 lds
    v_mfma_f32_16x16x32_bf16 v[132:135], v[52:55], v[32:35], v[132:135]
    ds_read_b128 v[88:91], v24 offset:36864
    ds_read_b128 v[92:95], v24 offset:38912
    v_mfma_f32_16x16x32_bf16 v[164:167], v[52:55], v[36:39], v[164:167]
    v_accvgpr_read_b32 v8, a68
    v_accvgpr_read_b32 v9, a69
    v_mfma_f32_16x16x32_bf16 v[196:199], v[52:55], v[40:43], v[196:199]
    ds_read_b64_tr_b16 v[100:101], v28 offset:43520
    ds_read_b64_tr_b16 v[102:103], v28 offset:44544
    v_mfma_f32_16x16x32_bf16 v[228:231], v[52:55], v[44:47], v[228:231]
    buffer_load_dwordx4 v18, s[24:27], s36 offen offset:1024 lds
    v_mfma_f32_16x16x32_bf16 v[136:139], v[56:59], v[32:35], v[136:139]
    ds_read_b64_tr_b16 v[104:105], v29 offset:43520
    ds_read_b64_tr_b16 v[106:107], v29 offset:44544
    v_mfma_f32_16x16x32_bf16 v[168:171], v[56:59], v[36:39], v[168:171]
    v_accvgpr_read_b32 v10, a70
    v_accvgpr_read_b32 v11, a71
    v_mfma_f32_16x16x32_bf16 v[200:203], v[56:59], v[40:43], v[200:203]
    ds_read_b64_tr_b16 v[108:109], v30 offset:43520
    ds_read_b64_tr_b16 v[110:111], v30 offset:44544
    v_mfma_f32_16x16x32_bf16 v[232:235], v[56:59], v[44:47], v[232:235]
    buffer_store_dwordx4 v[0:3], v16, s[16:19], s38 offen offset:3072
    v_mfma_f32_16x16x32_bf16 v[140:143], v[60:63], v[32:35], v[140:143]
    s_add_u32 s38, s38, 16384
    ds_read_b64_tr_b16 v[112:113], v27 offset:43648
    ds_read_b64_tr_b16 v[114:115], v27 offset:44672
    v_mfma_f32_16x16x32_bf16 v[172:175], v[60:63], v[36:39], v[172:175]
    v_mul_f32 v8, s40, v8
    v_mul_f32 v9, s40, v9
    v_mfma_f32_16x16x32_bf16 v[204:207], v[60:63], v[40:43], v[204:207]
    ds_read_b64_tr_b16 v[116:117], v28 offset:43648
    ds_read_b64_tr_b16 v[118:119], v28 offset:44672
    v_mfma_f32_16x16x32_bf16 v[236:239], v[60:63], v[44:47], v[236:239]
    buffer_load_dwordx4 v19, s[24:27], s36 offen offset:2048 lds
    v_mfma_f32_16x16x32_bf16 v[144:147], v[64:67], v[32:35], v[144:147]
    ds_read_b64_tr_b16 v[120:121], v29 offset:43648
    ds_read_b64_tr_b16 v[122:123], v29 offset:44672
    v_mfma_f32_16x16x32_bf16 v[176:179], v[64:67], v[36:39], v[176:179]
    v_mul_f32 v10, s40, v10
    v_mul_f32 v11, s40, v11
    v_mfma_f32_16x16x32_bf16 v[208:211], v[64:67], v[40:43], v[208:211]
    ds_read_b64_tr_b16 v[124:125], v30 offset:43648
    ds_read_b64_tr_b16 v[126:127], v30 offset:44672
    v_mfma_f32_16x16x32_bf16 v[240:243], v[64:67], v[44:47], v[240:243]
    v_mul_f32 v12, s40, v12
    v_mul_f32 v13, s40, v13
    v_mfma_f32_16x16x32_bf16 v[148:151], v[68:71], v[32:35], v[148:151]
    v_mul_f32 v14, s40, v14
    v_mul_f32 v15, s40, v15
    v_mfma_f32_16x16x32_bf16 v[180:183], v[68:71], v[36:39], v[180:183]
    buffer_load_dwordx4 v20, s[24:27], s36 offen offset:3072 lds
    v_mfma_f32_16x16x32_bf16 v[212:215], v[68:71], v[40:43], v[212:215]
    s_add_u32 s37, s49, 2359296
    v_cvt_pk_bf16_f32 v8, v8, v9
    v_cvt_pk_bf16_f32 v9, v10, v11
    v_mfma_f32_16x16x32_bf16 v[244:247], v[68:71], v[44:47], v[244:247]
    s_add_u32 m0, s50, 26112
    v_cvt_pk_bf16_f32 v10, v12, v13
    v_cvt_pk_bf16_f32 v11, v14, v15
    v_mfma_f32_16x16x32_bf16 v[152:155], v[72:75], v[32:35], v[152:155]
    buffer_load_dwordx4 v21, s[20:23], s37 offen offset:0 lds
    v_mfma_f32_16x16x32_bf16 v[184:187], v[72:75], v[36:39], v[184:187]
    v_accvgpr_read_b32 v4, a140
    v_accvgpr_read_b32 v5, a141
    v_mfma_f32_16x16x32_bf16 v[216:219], v[72:75], v[40:43], v[216:219]
    v_accvgpr_read_b32 v6, a142
    v_accvgpr_read_b32 v7, a143
    v_mfma_f32_16x16x32_bf16 v[248:251], v[72:75], v[44:47], v[248:251]
    buffer_store_dwordx4 v[8:11], v16, s[16:19], s41 offen offset:1024
    v_mfma_f32_16x16x32_bf16 v[156:159], v[76:79], v[32:35], v[156:159]
    s_add_u32 s41, s41, 12288
    v_accvgpr_read_b32 v0, a136
    v_accvgpr_read_b32 v1, a137
    v_mfma_f32_16x16x32_bf16 v[188:191], v[76:79], v[36:39], v[188:191]
    v_accvgpr_read_b32 v2, a138
    v_accvgpr_read_b32 v3, a139
    v_mfma_f32_16x16x32_bf16 v[220:223], v[76:79], v[40:43], v[220:223]
    buffer_load_dwordx4 v22, s[20:23], s37 offen offset:1024 lds
    v_mfma_f32_16x16x32_bf16 v[252:255], v[76:79], v[44:47], v[252:255]
    s_waitcnt vmcnt(16) lgkmcnt(0)
    s_barrier
    v_cvt_pk_bf16_f32 v0, v0, v1
    v_cvt_pk_bf16_f32 v1, v2, v3
    v_mfma_f32_16x16x32_bf16 v[128:131], v[96:99], v[80:83], v[128:131]
    ds_read_b64_tr_b16 v[48:49], v27 offset:0
    ds_read_b64_tr_b16 v[50:51], v27 offset:1024
    v_mfma_f32_16x16x32_bf16 v[160:163], v[96:99], v[84:87], v[160:163]
    s_add_u32 s36, s44, 640
    v_cvt_pk_bf16_f32 v2, v4, v5
    v_cvt_pk_bf16_f32 v3, v6, v7
    v_mfma_f32_16x16x32_bf16 v[192:195], v[96:99], v[88:91], v[192:195]
    s_add_u32 m0, s42, 32768
    ds_read_b128 v[32:35], v25 offset:0
    ds_read_b128 v[36:39], v25 offset:2048
    v_mfma_f32_16x16x32_bf16 v[224:227], v[96:99], v[92:95], v[224:227]
    buffer_load_dwordx4 v17, s[24:27], s36 offen offset:0 lds
    v_mfma_f32_16x16x32_bf16 v[132:135], v[100:103], v[80:83], v[132:135]
    ds_read_b128 v[40:43], v25 offset:4096
    ds_read_b128 v[44:47], v25 offset:6144
    v_mfma_f32_16x16x32_bf16 v[164:167], v[100:103], v[84:87], v[164:167]
    v_accvgpr_read_b32 v12, a40
    v_accvgpr_read_b32 v13, a41
    v_mfma_f32_16x16x32_bf16 v[196:199], v[100:103], v[88:91], v[196:199]
    ds_read_b64_tr_b16 v[52:53], v28 offset:0
    ds_read_b64_tr_b16 v[54:55], v28 offset:1024
    v_mfma_f32_16x16x32_bf16 v[228:231], v[100:103], v[92:95], v[228:231]
    buffer_load_dwordx4 v18, s[24:27], s36 offen offset:1024 lds
    v_mfma_f32_16x16x32_bf16 v[136:139], v[104:107], v[80:83], v[136:139]
    ds_read_b64_tr_b16 v[56:57], v29 offset:0
    ds_read_b64_tr_b16 v[58:59], v29 offset:1024
    v_mfma_f32_16x16x32_bf16 v[168:171], v[104:107], v[84:87], v[168:171]
    v_accvgpr_read_b32 v14, a42
    v_accvgpr_read_b32 v15, a43
    v_mfma_f32_16x16x32_bf16 v[200:203], v[104:107], v[88:91], v[200:203]
    ds_read_b64_tr_b16 v[60:61], v30 offset:0
    ds_read_b64_tr_b16 v[62:63], v30 offset:1024
    v_mfma_f32_16x16x32_bf16 v[232:235], v[104:107], v[92:95], v[232:235]
    buffer_store_dwordx4 v[0:3], v16, s[16:19], s38 offen offset:0
    v_mfma_f32_16x16x32_bf16 v[140:143], v[108:111], v[80:83], v[140:143]
    ds_read_b64_tr_b16 v[64:65], v27 offset:128
    ds_read_b64_tr_b16 v[66:67], v27 offset:1152
    v_mfma_f32_16x16x32_bf16 v[172:175], v[108:111], v[84:87], v[172:175]
    v_accvgpr_read_b32 v8, a8
    v_accvgpr_read_b32 v9, a9
    v_mfma_f32_16x16x32_bf16 v[204:207], v[108:111], v[88:91], v[204:207]
    ds_read_b64_tr_b16 v[68:69], v28 offset:128
    ds_read_b64_tr_b16 v[70:71], v28 offset:1152
    v_mfma_f32_16x16x32_bf16 v[236:239], v[108:111], v[92:95], v[236:239]
    buffer_load_dwordx4 v19, s[24:27], s36 offen offset:2048 lds
    v_mfma_f32_16x16x32_bf16 v[144:147], v[112:115], v[80:83], v[144:147]
    ds_read_b64_tr_b16 v[72:73], v29 offset:128
    ds_read_b64_tr_b16 v[74:75], v29 offset:1152
    v_mfma_f32_16x16x32_bf16 v[176:179], v[112:115], v[84:87], v[176:179]
    v_accvgpr_read_b32 v10, a10
    v_accvgpr_read_b32 v11, a11
    v_mfma_f32_16x16x32_bf16 v[208:211], v[112:115], v[88:91], v[208:211]
    ds_read_b64_tr_b16 v[76:77], v30 offset:128
    ds_read_b64_tr_b16 v[78:79], v30 offset:1152
    v_mfma_f32_16x16x32_bf16 v[240:243], v[112:115], v[92:95], v[240:243]
    v_mul_f32 v8, s40, v8
    v_mul_f32 v9, s40, v9
    v_mfma_f32_16x16x32_bf16 v[148:151], v[116:119], v[80:83], v[148:151]
    v_mul_f32 v10, s40, v10
    v_mul_f32 v11, s40, v11
    v_mfma_f32_16x16x32_bf16 v[180:183], v[116:119], v[84:87], v[180:183]
    buffer_load_dwordx4 v20, s[24:27], s36 offen offset:3072 lds
    v_mfma_f32_16x16x32_bf16 v[212:215], v[116:119], v[88:91], v[212:215]
    s_add_u32 s37, s49, 2621440
    v_mul_f32 v12, s40, v12
    v_mul_f32 v13, s40, v13
    v_mfma_f32_16x16x32_bf16 v[244:247], v[116:119], v[92:95], v[244:247]
    s_add_u32 m0, s50, 34816
    v_mul_f32 v14, s40, v14
    v_mul_f32 v15, s40, v15
    v_mfma_f32_16x16x32_bf16 v[152:155], v[120:123], v[80:83], v[152:155]
    buffer_load_dwordx4 v21, s[20:23], s37 offen offset:0 lds
    v_mfma_f32_16x16x32_bf16 v[184:187], v[120:123], v[84:87], v[184:187]
    v_cvt_pk_bf16_f32 v8, v8, v9
    v_cvt_pk_bf16_f32 v9, v10, v11
    v_mfma_f32_16x16x32_bf16 v[216:219], v[120:123], v[88:91], v[216:219]
    v_cvt_pk_bf16_f32 v10, v12, v13
    v_cvt_pk_bf16_f32 v11, v14, v15
    v_mfma_f32_16x16x32_bf16 v[248:251], v[120:123], v[92:95], v[248:251]
    buffer_store_dwordx4 v[8:11], v16, s[16:19], s41 offen offset:0
    v_mfma_f32_16x16x32_bf16 v[156:159], v[124:127], v[80:83], v[156:159]
    v_accvgpr_read_b32 v4, a172
    v_accvgpr_read_b32 v5, a173
    v_mfma_f32_16x16x32_bf16 v[188:191], v[124:127], v[84:87], v[188:191]
    v_accvgpr_read_b32 v6, a174
    v_accvgpr_read_b32 v7, a175
    v_mfma_f32_16x16x32_bf16 v[220:223], v[124:127], v[88:91], v[220:223]
    buffer_load_dwordx4 v22, s[20:23], s37 offen offset:1024 lds
    v_mfma_f32_16x16x32_bf16 v[252:255], v[124:127], v[92:95], v[252:255]
    s_waitcnt lgkmcnt(0)
    v_accvgpr_read_b32 v0, a168
    v_accvgpr_read_b32 v1, a169
    v_mfma_f32_16x16x32_bf16 v[128:131], v[48:51], v[32:35], v[128:131]
    ds_read_b64_tr_b16 v[96:97], v27 offset:8704
    ds_read_b64_tr_b16 v[98:99], v27 offset:9728
    v_mfma_f32_16x16x32_bf16 v[160:163], v[48:51], v[36:39], v[160:163]
    s_add_u32 s36, s45, 640
    v_accvgpr_read_b32 v2, a170
    v_accvgpr_read_b32 v3, a171
    v_mfma_f32_16x16x32_bf16 v[192:195], v[48:51], v[40:43], v[192:195]
    s_add_u32 m0, s42, 36864
    ds_read_b128 v[80:83], v26 offset:0
    ds_read_b128 v[84:87], v26 offset:2048
    v_mfma_f32_16x16x32_bf16 v[224:227], v[48:51], v[44:47], v[224:227]
    buffer_load_dwordx4 v17, s[24:27], s36 offen offset:0 lds
    v_mfma_f32_16x16x32_bf16 v[132:135], v[52:55], v[32:35], v[132:135]
    ds_read_b128 v[88:91], v26 offset:4096
    ds_read_b128 v[92:95], v26 offset:6144
    v_mfma_f32_16x16x32_bf16 v[164:167], v[52:55], v[36:39], v[164:167]
    v_cvt_pk_bf16_f32 v0, v0, v1
    v_cvt_pk_bf16_f32 v1, v2, v3
    v_mfma_f32_16x16x32_bf16 v[196:199], v[52:55], v[40:43], v[196:199]
    ds_read_b64_tr_b16 v[100:101], v28 offset:8704
    ds_read_b64_tr_b16 v[102:103], v28 offset:9728
    v_mfma_f32_16x16x32_bf16 v[228:231], v[52:55], v[44:47], v[228:231]
    buffer_load_dwordx4 v18, s[24:27], s36 offen offset:1024 lds
    v_mfma_f32_16x16x32_bf16 v[136:139], v[56:59], v[32:35], v[136:139]
    ds_read_b64_tr_b16 v[104:105], v29 offset:8704
    ds_read_b64_tr_b16 v[106:107], v29 offset:9728
    v_mfma_f32_16x16x32_bf16 v[168:171], v[56:59], v[36:39], v[168:171]
gated_mix__ssm_conv_h3__compressed_kv_cla__prompt_kernel_pad4:
    s_cbranch_execz gated_mix__ssm_conv_h3__compressed_kv_cla__prompt_kernel_pad8
    v_cvt_pk_bf16_f32 v2, v4, v5
    v_cvt_pk_bf16_f32 v3, v6, v7
    v_mfma_f32_16x16x32_bf16 v[200:203], v[56:59], v[40:43], v[200:203]
    ds_read_b64_tr_b16 v[108:109], v30 offset:8704
    ds_read_b64_tr_b16 v[110:111], v30 offset:9728
    v_mfma_f32_16x16x32_bf16 v[232:235], v[56:59], v[44:47], v[232:235]
    buffer_store_dwordx4 v[0:3], v16, s[16:19], s38 offen offset:1024
    v_mfma_f32_16x16x32_bf16 v[140:143], v[60:63], v[32:35], v[140:143]
    ds_read_b64_tr_b16 v[112:113], v27 offset:8832
    ds_read_b64_tr_b16 v[114:115], v27 offset:9856
    v_mfma_f32_16x16x32_bf16 v[172:175], v[60:63], v[36:39], v[172:175]
    v_accvgpr_read_b32 v12, a104
    v_accvgpr_read_b32 v13, a105
    v_mfma_f32_16x16x32_bf16 v[204:207], v[60:63], v[40:43], v[204:207]
    ds_read_b64_tr_b16 v[116:117], v28 offset:8832
    ds_read_b64_tr_b16 v[118:119], v28 offset:9856
    v_mfma_f32_16x16x32_bf16 v[236:239], v[60:63], v[44:47], v[236:239]
    buffer_load_dwordx4 v19, s[24:27], s36 offen offset:2048 lds
    v_mfma_f32_16x16x32_bf16 v[144:147], v[64:67], v[32:35], v[144:147]
    ds_read_b64_tr_b16 v[120:121], v29 offset:8832
    ds_read_b64_tr_b16 v[122:123], v29 offset:9856
    v_mfma_f32_16x16x32_bf16 v[176:179], v[64:67], v[36:39], v[176:179]
    v_accvgpr_read_b32 v14, a106
    v_accvgpr_read_b32 v15, a107
    v_mfma_f32_16x16x32_bf16 v[208:211], v[64:67], v[40:43], v[208:211]
    ds_read_b64_tr_b16 v[124:125], v30 offset:8832
    ds_read_b64_tr_b16 v[126:127], v30 offset:9856
    v_mfma_f32_16x16x32_bf16 v[240:243], v[64:67], v[44:47], v[240:243]
    v_accvgpr_read_b32 v8, a72
    v_accvgpr_read_b32 v9, a73
    v_mfma_f32_16x16x32_bf16 v[148:151], v[68:71], v[32:35], v[148:151]
    v_accvgpr_read_b32 v10, a74
    v_accvgpr_read_b32 v11, a75
    v_mfma_f32_16x16x32_bf16 v[180:183], v[68:71], v[36:39], v[180:183]
    buffer_load_dwordx4 v20, s[24:27], s36 offen offset:3072 lds
    v_mfma_f32_16x16x32_bf16 v[212:215], v[68:71], v[40:43], v[212:215]
    s_add_u32 s37, s49, 2883584
    v_mul_f32 v8, s40, v8
    v_mul_f32 v9, s40, v9
    v_mfma_f32_16x16x32_bf16 v[244:247], v[68:71], v[44:47], v[244:247]
    s_add_u32 m0, s50, 43520
    v_mul_f32 v10, s40, v10
    v_mul_f32 v11, s40, v11
    v_mfma_f32_16x16x32_bf16 v[152:155], v[72:75], v[32:35], v[152:155]
    buffer_load_dwordx4 v21, s[20:23], s37 offen offset:0 lds
    v_mfma_f32_16x16x32_bf16 v[184:187], v[72:75], v[36:39], v[184:187]
    v_mul_f32 v12, s40, v12
    v_mul_f32 v13, s40, v13
    v_mfma_f32_16x16x32_bf16 v[216:219], v[72:75], v[40:43], v[216:219]
    v_mul_f32 v14, s40, v14
    v_mul_f32 v15, s40, v15
    v_mfma_f32_16x16x32_bf16 v[248:251], v[72:75], v[44:47], v[248:251]
    v_mfma_f32_16x16x32_bf16 v[156:159], v[76:79], v[32:35], v[156:159]
    v_cvt_pk_bf16_f32 v8, v8, v9
    v_cvt_pk_bf16_f32 v9, v10, v11
    v_mfma_f32_16x16x32_bf16 v[188:191], v[76:79], v[36:39], v[188:191]
    v_cvt_pk_bf16_f32 v10, v12, v13
    v_cvt_pk_bf16_f32 v11, v14, v15
    v_mfma_f32_16x16x32_bf16 v[220:223], v[76:79], v[40:43], v[220:223]
    buffer_load_dwordx4 v22, s[20:23], s37 offen offset:1024 lds
    v_mfma_f32_16x16x32_bf16 v[252:255], v[76:79], v[44:47], v[252:255]
    s_waitcnt vmcnt(15) lgkmcnt(0)
    s_barrier
    v_accvgpr_read_b32 v4, a204
    v_accvgpr_read_b32 v5, a205
    v_mfma_f32_16x16x32_bf16 v[128:131], v[96:99], v[80:83], v[128:131]
    ds_read_b64_tr_b16 v[48:49], v27 offset:17408
    ds_read_b64_tr_b16 v[50:51], v27 offset:18432
    v_mfma_f32_16x16x32_bf16 v[160:163], v[96:99], v[84:87], v[160:163]
    s_add_u32 s36, s44, 768
    v_accvgpr_read_b32 v6, a206
    v_accvgpr_read_b32 v7, a207
    v_mfma_f32_16x16x32_bf16 v[192:195], v[96:99], v[88:91], v[192:195]
    s_add_u32 m0, s42, 65536
    ds_read_b128 v[32:35], v23 offset:0
    ds_read_b128 v[36:39], v23 offset:2048
    v_mfma_f32_16x16x32_bf16 v[224:227], v[96:99], v[92:95], v[224:227]
    buffer_load_dwordx4 v17, s[24:27], s36 offen offset:0 lds
    v_mfma_f32_16x16x32_bf16 v[132:135], v[100:103], v[80:83], v[132:135]
    ds_read_b128 v[40:43], v23 offset:4096
    ds_read_b128 v[44:47], v23 offset:6144
    v_mfma_f32_16x16x32_bf16 v[164:167], v[100:103], v[84:87], v[164:167]
    v_accvgpr_read_b32 v0, a200
    v_accvgpr_read_b32 v1, a201
    v_mfma_f32_16x16x32_bf16 v[196:199], v[100:103], v[88:91], v[196:199]
    ds_read_b64_tr_b16 v[52:53], v28 offset:17408
    ds_read_b64_tr_b16 v[54:55], v28 offset:18432
    v_mfma_f32_16x16x32_bf16 v[228:231], v[100:103], v[92:95], v[228:231]
    buffer_load_dwordx4 v18, s[24:27], s36 offen offset:1024 lds
    v_mfma_f32_16x16x32_bf16 v[136:139], v[104:107], v[80:83], v[136:139]
    ds_read_b64_tr_b16 v[56:57], v29 offset:17408
    ds_read_b64_tr_b16 v[58:59], v29 offset:18432
    v_mfma_f32_16x16x32_bf16 v[168:171], v[104:107], v[84:87], v[168:171]
    v_accvgpr_read_b32 v2, a202
    v_accvgpr_read_b32 v3, a203
    v_mfma_f32_16x16x32_bf16 v[200:203], v[104:107], v[88:91], v[200:203]
    ds_read_b64_tr_b16 v[60:61], v30 offset:17408
    ds_read_b64_tr_b16 v[62:63], v30 offset:18432
    v_mfma_f32_16x16x32_bf16 v[232:235], v[104:107], v[92:95], v[232:235]
    buffer_store_dwordx4 v[8:11], v16, s[16:19], s41 offen offset:1024
    v_mfma_f32_16x16x32_bf16 v[140:143], v[108:111], v[80:83], v[140:143]
    s_add_u32 s41, s41, 4096
    ds_read_b64_tr_b16 v[64:65], v27 offset:17536
    ds_read_b64_tr_b16 v[66:67], v27 offset:18560
    v_mfma_f32_16x16x32_bf16 v[172:175], v[108:111], v[84:87], v[172:175]
    v_cvt_pk_bf16_f32 v0, v0, v1
    v_cvt_pk_bf16_f32 v1, v2, v3
    v_mfma_f32_16x16x32_bf16 v[204:207], v[108:111], v[88:91], v[204:207]
    ds_read_b64_tr_b16 v[68:69], v28 offset:17536
    ds_read_b64_tr_b16 v[70:71], v28 offset:18560
    v_mfma_f32_16x16x32_bf16 v[236:239], v[108:111], v[92:95], v[236:239]
    buffer_load_dwordx4 v19, s[24:27], s36 offen offset:2048 lds
    v_mfma_f32_16x16x32_bf16 v[144:147], v[112:115], v[80:83], v[144:147]
    ds_read_b64_tr_b16 v[72:73], v29 offset:17536
    ds_read_b64_tr_b16 v[74:75], v29 offset:18560
    v_mfma_f32_16x16x32_bf16 v[176:179], v[112:115], v[84:87], v[176:179]
    v_cvt_pk_bf16_f32 v2, v4, v5
    v_cvt_pk_bf16_f32 v3, v6, v7
    v_mfma_f32_16x16x32_bf16 v[208:211], v[112:115], v[88:91], v[208:211]
    ds_read_b64_tr_b16 v[76:77], v30 offset:17536
    ds_read_b64_tr_b16 v[78:79], v30 offset:18560
    v_mfma_f32_16x16x32_bf16 v[240:243], v[112:115], v[92:95], v[240:243]
    v_accvgpr_read_b32 v12, a44
    v_accvgpr_read_b32 v13, a45
    v_mfma_f32_16x16x32_bf16 v[148:151], v[116:119], v[80:83], v[148:151]
    v_accvgpr_read_b32 v14, a46
    v_accvgpr_read_b32 v15, a47
    v_mfma_f32_16x16x32_bf16 v[180:183], v[116:119], v[84:87], v[180:183]
    buffer_load_dwordx4 v20, s[24:27], s36 offen offset:3072 lds
    v_mfma_f32_16x16x32_bf16 v[212:215], v[116:119], v[88:91], v[212:215]
    s_add_u32 s37, s49, 3145728
    v_accvgpr_read_b32 v8, a12
    v_accvgpr_read_b32 v9, a13
    v_mfma_f32_16x16x32_bf16 v[244:247], v[116:119], v[92:95], v[244:247]
    s_add_u32 m0, s50, 0
    v_accvgpr_read_b32 v10, a14
    v_accvgpr_read_b32 v11, a15
    v_mfma_f32_16x16x32_bf16 v[152:155], v[120:123], v[80:83], v[152:155]
    buffer_load_dwordx4 v21, s[20:23], s37 offen offset:0 lds
    v_mfma_f32_16x16x32_bf16 v[184:187], v[120:123], v[84:87], v[184:187]
    v_mul_f32 v8, s40, v8
    v_mul_f32 v9, s40, v9
    v_mfma_f32_16x16x32_bf16 v[216:219], v[120:123], v[88:91], v[216:219]
    v_mul_f32 v10, s40, v10
    v_mul_f32 v11, s40, v11
    v_mfma_f32_16x16x32_bf16 v[248:251], v[120:123], v[92:95], v[248:251]
    buffer_store_dwordx4 v[0:3], v16, s[16:19], s38 offen offset:2048
    v_mfma_f32_16x16x32_bf16 v[156:159], v[124:127], v[80:83], v[156:159]
    v_mul_f32 v12, s40, v12
    v_mul_f32 v13, s40, v13
    v_mfma_f32_16x16x32_bf16 v[188:191], v[124:127], v[84:87], v[188:191]
    v_mul_f32 v14, s40, v14
    v_mul_f32 v15, s40, v15
    v_mfma_f32_16x16x32_bf16 v[220:223], v[124:127], v[88:91], v[220:223]
    buffer_load_dwordx4 v22, s[20:23], s37 offen offset:1024 lds
    v_mfma_f32_16x16x32_bf16 v[252:255], v[124:127], v[92:95], v[252:255]
    s_waitcnt lgkmcnt(0)
    v_cvt_pk_bf16_f32 v8, v8, v9
    v_cvt_pk_bf16_f32 v9, v10, v11
    v_mfma_f32_16x16x32_bf16 v[128:131], v[48:51], v[32:35], v[128:131]
    ds_read_b64_tr_b16 v[96:97], v27 offset:26112
    ds_read_b64_tr_b16 v[98:99], v27 offset:27136
    v_mfma_f32_16x16x32_bf16 v[160:163], v[48:51], v[36:39], v[160:163]
    s_add_u32 s36, s45, 768
    v_cvt_pk_bf16_f32 v10, v12, v13
    v_cvt_pk_bf16_f32 v11, v14, v15
    v_mfma_f32_16x16x32_bf16 v[192:195], v[48:51], v[40:43], v[192:195]
    s_add_u32 m0, s42, 69632
    ds_read_b128 v[80:83], v24 offset:0
    ds_read_b128 v[84:87], v24 offset:2048
    v_mfma_f32_16x16x32_bf16 v[224:227], v[48:51], v[44:47], v[224:227]
    buffer_load_dwordx4 v17, s[24:27], s36 offen offset:0 lds
    v_mfma_f32_16x16x32_bf16 v[132:135], v[52:55], v[32:35], v[132:135]
    ds_read_b128 v[88:91], v24 offset:4096
    ds_read_b128 v[92:95], v24 offset:6144
    v_mfma_f32_16x16x32_bf16 v[164:167], v[52:55], v[36:39], v[164:167]
    v_accvgpr_read_b32 v4, a236
    v_accvgpr_read_b32 v5, a237
    v_mfma_f32_16x16x32_bf16 v[196:199], v[52:55], v[40:43], v[196:199]
    ds_read_b64_tr_b16 v[100:101], v28 offset:26112
    ds_read_b64_tr_b16 v[102:103], v28 offset:27136
    v_mfma_f32_16x16x32_bf16 v[228:231], v[52:55], v[44:47], v[228:231]
    buffer_load_dwordx4 v18, s[24:27], s36 offen offset:1024 lds
    v_mfma_f32_16x16x32_bf16 v[136:139], v[56:59], v[32:35], v[136:139]
    ds_read_b64_tr_b16 v[104:105], v29 offset:26112
    ds_read_b64_tr_b16 v[106:107], v29 offset:27136
    v_mfma_f32_16x16x32_bf16 v[168:171], v[56:59], v[36:39], v[168:171]
    v_accvgpr_read_b32 v6, a238
    v_accvgpr_read_b32 v7, a239
    v_mfma_f32_16x16x32_bf16 v[200:203], v[56:59], v[40:43], v[200:203]
    ds_read_b64_tr_b16 v[108:109], v30 offset:26112
    ds_read_b64_tr_b16 v[110:111], v30 offset:27136
    v_mfma_f32_16x16x32_bf16 v[232:235], v[56:59], v[44:47], v[232:235]
    buffer_store_dwordx4 v[8:11], v16, s[16:19], s41 offen offset:0
    v_mfma_f32_16x16x32_bf16 v[140:143], v[60:63], v[32:35], v[140:143]
    ds_read_b64_tr_b16 v[112:113], v27 offset:26240
    ds_read_b64_tr_b16 v[114:115], v27 offset:27264
    v_mfma_f32_16x16x32_bf16 v[172:175], v[60:63], v[36:39], v[172:175]
    v_accvgpr_read_b32 v0, a232
    v_accvgpr_read_b32 v1, a233
    v_mfma_f32_16x16x32_bf16 v[204:207], v[60:63], v[40:43], v[204:207]
    ds_read_b64_tr_b16 v[116:117], v28 offset:26240
    ds_read_b64_tr_b16 v[118:119], v28 offset:27264
    v_mfma_f32_16x16x32_bf16 v[236:239], v[60:63], v[44:47], v[236:239]
    buffer_load_dwordx4 v19, s[24:27], s36 offen offset:2048 lds
    v_mfma_f32_16x16x32_bf16 v[144:147], v[64:67], v[32:35], v[144:147]
    ds_read_b64_tr_b16 v[120:121], v29 offset:26240
    ds_read_b64_tr_b16 v[122:123], v29 offset:27264
    v_mfma_f32_16x16x32_bf16 v[176:179], v[64:67], v[36:39], v[176:179]
    v_accvgpr_read_b32 v2, a234
    v_accvgpr_read_b32 v3, a235
    v_mfma_f32_16x16x32_bf16 v[208:211], v[64:67], v[40:43], v[208:211]
    ds_read_b64_tr_b16 v[124:125], v30 offset:26240
    ds_read_b64_tr_b16 v[126:127], v30 offset:27264
    v_mfma_f32_16x16x32_bf16 v[240:243], v[64:67], v[44:47], v[240:243]
    v_cvt_pk_bf16_f32 v0, v0, v1
    v_cvt_pk_bf16_f32 v1, v2, v3
    v_mfma_f32_16x16x32_bf16 v[148:151], v[68:71], v[32:35], v[148:151]
    v_cvt_pk_bf16_f32 v2, v4, v5
    v_cvt_pk_bf16_f32 v3, v6, v7
    v_mfma_f32_16x16x32_bf16 v[180:183], v[68:71], v[36:39], v[180:183]
    buffer_load_dwordx4 v20, s[24:27], s36 offen offset:3072 lds
    v_mfma_f32_16x16x32_bf16 v[212:215], v[68:71], v[40:43], v[212:215]
    s_add_u32 s37, s49, 3407872
    v_accvgpr_read_b32 v12, a108
    v_accvgpr_read_b32 v13, a109
    v_mfma_f32_16x16x32_bf16 v[244:247], v[68:71], v[44:47], v[244:247]
    s_add_u32 m0, s50, 8704
    v_accvgpr_read_b32 v14, a110
    v_accvgpr_read_b32 v15, a111
    v_mfma_f32_16x16x32_bf16 v[152:155], v[72:75], v[32:35], v[152:155]
    buffer_load_dwordx4 v21, s[20:23], s37 offen offset:0 lds
    v_mfma_f32_16x16x32_bf16 v[184:187], v[72:75], v[36:39], v[184:187]
    v_accvgpr_read_b32 v8, a76
    v_accvgpr_read_b32 v9, a77
    v_mfma_f32_16x16x32_bf16 v[216:219], v[72:75], v[40:43], v[216:219]
    v_accvgpr_read_b32 v10, a78
    v_accvgpr_read_b32 v11, a79
    v_mfma_f32_16x16x32_bf16 v[248:251], v[72:75], v[44:47], v[248:251]
    buffer_store_dwordx4 v[0:3], v16, s[16:19], s38 offen offset:3072
    v_mfma_f32_16x16x32_bf16 v[156:159], v[76:79], v[32:35], v[156:159]
    s_add_u32 s38, s38, 16384
    v_mul_f32 v8, s40, v8
    v_mul_f32 v9, s40, v9
    v_mfma_f32_16x16x32_bf16 v[188:191], v[76:79], v[36:39], v[188:191]
    v_mul_f32 v10, s40, v10
    v_mul_f32 v11, s40, v11
    v_mfma_f32_16x16x32_bf16 v[220:223], v[76:79], v[40:43], v[220:223]
    buffer_load_dwordx4 v22, s[20:23], s37 offen offset:1024 lds
    v_mfma_f32_16x16x32_bf16 v[252:255], v[76:79], v[44:47], v[252:255]
    s_waitcnt vmcnt(16) lgkmcnt(0)
    s_barrier
    v_mul_f32 v12, s40, v12
    v_mul_f32 v13, s40, v13
    v_mfma_f32_16x16x32_bf16 v[128:131], v[96:99], v[80:83], v[128:131]
    ds_read_b64_tr_b16 v[48:49], v27 offset:34816
    ds_read_b64_tr_b16 v[50:51], v27 offset:35840
    v_mfma_f32_16x16x32_bf16 v[160:163], v[96:99], v[84:87], v[160:163]
    s_add_u32 s36, s44, 896
    v_mul_f32 v14, s40, v14
    v_mul_f32 v15, s40, v15
    v_mfma_f32_16x16x32_bf16 v[192:195], v[96:99], v[88:91], v[192:195]
    s_add_u32 m0, s42, 0
    ds_read_b128 v[32:35], v23 offset:32768
    ds_read_b128 v[36:39], v23 offset:34816
    v_mfma_f32_16x16x32_bf16 v[224:227], v[96:99], v[92:95], v[224:227]
    buffer_load_dwordx4 v17, s[24:27], s36 offen offset:0 lds
    v_mfma_f32_16x16x32_bf16 v[132:135], v[100:103], v[80:83], v[132:135]
    ds_read_b128 v[40:43], v23 offset:36864
    ds_read_b128 v[44:47], v23 offset:38912
    v_mfma_f32_16x16x32_bf16 v[164:167], v[100:103], v[84:87], v[164:167]
    v_cvt_pk_bf16_f32 v8, v8, v9
    v_cvt_pk_bf16_f32 v9, v10, v11
    v_mfma_f32_16x16x32_bf16 v[196:199], v[100:103], v[88:91], v[196:199]
    ds_read_b64_tr_b16 v[52:53], v28 offset:34816
    ds_read_b64_tr_b16 v[54:55], v28 offset:35840
    v_mfma_f32_16x16x32_bf16 v[228:231], v[100:103], v[92:95], v[228:231]
    buffer_load_dwordx4 v18, s[24:27], s36 offen offset:1024 lds
    v_mfma_f32_16x16x32_bf16 v[136:139], v[104:107], v[80:83], v[136:139]
    ds_read_b64_tr_b16 v[56:57], v29 offset:34816
    ds_read_b64_tr_b16 v[58:59], v29 offset:35840
    v_mfma_f32_16x16x32_bf16 v[168:171], v[104:107], v[84:87], v[168:171]
    v_cvt_pk_bf16_f32 v10, v12, v13
    v_cvt_pk_bf16_f32 v11, v14, v15
    v_mfma_f32_16x16x32_bf16 v[200:203], v[104:107], v[88:91], v[200:203]
    ds_read_b64_tr_b16 v[60:61], v30 offset:34816
    ds_read_b64_tr_b16 v[62:63], v30 offset:35840
    v_mfma_f32_16x16x32_bf16 v[232:235], v[104:107], v[92:95], v[232:235]
    buffer_store_dwordx4 v[8:11], v16, s[16:19], s41 offen offset:1024
    v_mfma_f32_16x16x32_bf16 v[140:143], v[108:111], v[80:83], v[140:143]
    s_add_u32 s41, s41, 12288
    ds_read_b64_tr_b16 v[64:65], v27 offset:34944
    ds_read_b64_tr_b16 v[66:67], v27 offset:35968
    v_mfma_f32_16x16x32_bf16 v[172:175], v[108:111], v[84:87], v[172:175]
    v_accvgpr_read_b32 v4, a148
    v_accvgpr_read_b32 v5, a149
    v_mfma_f32_16x16x32_bf16 v[204:207], v[108:111], v[88:91], v[204:207]
    ds_read_b64_tr_b16 v[68:69], v28 offset:34944
    ds_read_b64_tr_b16 v[70:71], v28 offset:35968
    v_mfma_f32_16x16x32_bf16 v[236:239], v[108:111], v[92:95], v[236:239]
    buffer_load_dwordx4 v19, s[24:27], s36 offen offset:2048 lds
    v_mfma_f32_16x16x32_bf16 v[144:147], v[112:115], v[80:83], v[144:147]
    ds_read_b64_tr_b16 v[72:73], v29 offset:34944
    ds_read_b64_tr_b16 v[74:75], v29 offset:35968
    v_mfma_f32_16x16x32_bf16 v[176:179], v[112:115], v[84:87], v[176:179]
    v_accvgpr_read_b32 v6, a150
    v_accvgpr_read_b32 v7, a151
    v_mfma_f32_16x16x32_bf16 v[208:211], v[112:115], v[88:91], v[208:211]
    ds_read_b64_tr_b16 v[76:77], v30 offset:34944
    ds_read_b64_tr_b16 v[78:79], v30 offset:35968
    v_mfma_f32_16x16x32_bf16 v[240:243], v[112:115], v[92:95], v[240:243]
    v_accvgpr_read_b32 v0, a144
    v_accvgpr_read_b32 v1, a145
    v_mfma_f32_16x16x32_bf16 v[148:151], v[116:119], v[80:83], v[148:151]
    v_accvgpr_read_b32 v2, a146
    v_accvgpr_read_b32 v3, a147
    v_mfma_f32_16x16x32_bf16 v[180:183], v[116:119], v[84:87], v[180:183]
    buffer_load_dwordx4 v20, s[24:27], s36 offen offset:3072 lds
    v_mfma_f32_16x16x32_bf16 v[212:215], v[116:119], v[88:91], v[212:215]
    s_add_u32 s37, s49, 3670016
    v_cvt_pk_bf16_f32 v0, v0, v1
    v_cvt_pk_bf16_f32 v1, v2, v3
    v_mfma_f32_16x16x32_bf16 v[244:247], v[116:119], v[92:95], v[244:247]
    s_add_u32 m0, s50, 17408
    v_cvt_pk_bf16_f32 v2, v4, v5
    v_cvt_pk_bf16_f32 v3, v6, v7
    v_mfma_f32_16x16x32_bf16 v[152:155], v[120:123], v[80:83], v[152:155]
    buffer_load_dwordx4 v21, s[20:23], s37 offen offset:0 lds
    v_mfma_f32_16x16x32_bf16 v[184:187], v[120:123], v[84:87], v[184:187]
    v_accvgpr_read_b32 v12, a48
    v_accvgpr_read_b32 v13, a49
    v_mfma_f32_16x16x32_bf16 v[216:219], v[120:123], v[88:91], v[216:219]
    v_accvgpr_read_b32 v14, a50
    v_accvgpr_read_b32 v15, a51
    v_mfma_f32_16x16x32_bf16 v[248:251], v[120:123], v[92:95], v[248:251]
    buffer_store_dwordx4 v[0:3], v16, s[16:19], s38 offen offset:0
    v_mfma_f32_16x16x32_bf16 v[156:159], v[124:127], v[80:83], v[156:159]
    v_accvgpr_read_b32 v8, a16
    v_accvgpr_read_b32 v9, a17
    v_mfma_f32_16x16x32_bf16 v[188:191], v[124:127], v[84:87], v[188:191]
    v_accvgpr_read_b32 v10, a18
    v_accvgpr_read_b32 v11, a19
    v_mfma_f32_16x16x32_bf16 v[220:223], v[124:127], v[88:91], v[220:223]
    buffer_load_dwordx4 v22, s[20:23], s37 offen offset:1024 lds
    v_mfma_f32_16x16x32_bf16 v[252:255], v[124:127], v[92:95], v[252:255]
    s_waitcnt lgkmcnt(0)
    v_mul_f32 v8, s40, v8
    v_mul_f32 v9, s40, v9
    v_mfma_f32_16x16x32_bf16 v[128:131], v[48:51], v[32:35], v[128:131]
    ds_read_b64_tr_b16 v[96:97], v27 offset:43520
    ds_read_b64_tr_b16 v[98:99], v27 offset:44544
    v_mfma_f32_16x16x32_bf16 v[160:163], v[48:51], v[36:39], v[160:163]
    s_add_u32 s36, s45, 896
    v_mul_f32 v10, s40, v10
    v_mul_f32 v11, s40, v11
    v_mfma_f32_16x16x32_bf16 v[192:195], v[48:51], v[40:43], v[192:195]
    s_add_u32 m0, s42, 4096
    ds_read_b128 v[80:83], v24 offset:32768
    ds_read_b128 v[84:87], v24 offset:34816
    v_mfma_f32_16x16x32_bf16 v[224:227], v[48:51], v[44:47], v[224:227]
    buffer_load_dwordx4 v17, s[24:27], s36 offen offset:0 lds
    v_mfma_f32_16x16x32_bf16 v[132:135], v[52:55], v[32:35], v[132:135]
    ds_read_b128 v[88:91], v24 offset:36864
    ds_read_b128 v[92:95], v24 offset:38912
    v_mfma_f32_16x16x32_bf16 v[164:167], v[52:55], v[36:39], v[164:167]
    v_mul_f32 v12, s40, v12
    v_mul_f32 v13, s40, v13
    v_mfma_f32_16x16x32_bf16 v[196:199], v[52:55], v[40:43], v[196:199]
    ds_read_b64_tr_b16 v[100:101], v28 offset:43520
    ds_read_b64_tr_b16 v[102:103], v28 offset:44544
    v_mfma_f32_16x16x32_bf16 v[228:231], v[52:55], v[44:47], v[228:231]
    buffer_load_dwordx4 v18, s[24:27], s36 offen offset:1024 lds
    v_mfma_f32_16x16x32_bf16 v[136:139], v[56:59], v[32:35], v[136:139]
    ds_read_b64_tr_b16 v[104:105], v29 offset:43520
    ds_read_b64_tr_b16 v[106:107], v29 offset:44544
    v_mfma_f32_16x16x32_bf16 v[168:171], v[56:59], v[36:39], v[168:171]
    v_mul_f32 v14, s40, v14
    v_mul_f32 v15, s40, v15
    v_mfma_f32_16x16x32_bf16 v[200:203], v[56:59], v[40:43], v[200:203]
    ds_read_b64_tr_b16 v[108:109], v30 offset:43520
    ds_read_b64_tr_b16 v[110:111], v30 offset:44544
    v_mfma_f32_16x16x32_bf16 v[232:235], v[56:59], v[44:47], v[232:235]
    v_mfma_f32_16x16x32_bf16 v[140:143], v[60:63], v[32:35], v[140:143]
    ds_read_b64_tr_b16 v[112:113], v27 offset:43648
    ds_read_b64_tr_b16 v[114:115], v27 offset:44672
    v_mfma_f32_16x16x32_bf16 v[172:175], v[60:63], v[36:39], v[172:175]
    v_cvt_pk_bf16_f32 v8, v8, v9
    v_cvt_pk_bf16_f32 v9, v10, v11
    v_mfma_f32_16x16x32_bf16 v[204:207], v[60:63], v[40:43], v[204:207]
    ds_read_b64_tr_b16 v[116:117], v28 offset:43648
    ds_read_b64_tr_b16 v[118:119], v28 offset:44672
    v_mfma_f32_16x16x32_bf16 v[236:239], v[60:63], v[44:47], v[236:239]
    buffer_load_dwordx4 v19, s[24:27], s36 offen offset:2048 lds
    v_mfma_f32_16x16x32_bf16 v[144:147], v[64:67], v[32:35], v[144:147]
    ds_read_b64_tr_b16 v[120:121], v29 offset:43648
    ds_read_b64_tr_b16 v[122:123], v29 offset:44672
    v_mfma_f32_16x16x32_bf16 v[176:179], v[64:67], v[36:39], v[176:179]
    v_cvt_pk_bf16_f32 v10, v12, v13
    v_cvt_pk_bf16_f32 v11, v14, v15
    v_mfma_f32_16x16x32_bf16 v[208:211], v[64:67], v[40:43], v[208:211]
    ds_read_b64_tr_b16 v[124:125], v30 offset:43648
    ds_read_b64_tr_b16 v[126:127], v30 offset:44672
    v_mfma_f32_16x16x32_bf16 v[240:243], v[64:67], v[44:47], v[240:243]
    v_accvgpr_read_b32 v4, a180
    v_accvgpr_read_b32 v5, a181
    v_mfma_f32_16x16x32_bf16 v[148:151], v[68:71], v[32:35], v[148:151]
    v_accvgpr_read_b32 v6, a182
    v_accvgpr_read_b32 v7, a183
    v_mfma_f32_16x16x32_bf16 v[180:183], v[68:71], v[36:39], v[180:183]
    buffer_load_dwordx4 v20, s[24:27], s36 offen offset:3072 lds
    v_mfma_f32_16x16x32_bf16 v[212:215], v[68:71], v[40:43], v[212:215]
    s_add_u32 s37, s49, 3932160
    v_accvgpr_read_b32 v0, a176
    v_accvgpr_read_b32 v1, a177
    v_mfma_f32_16x16x32_bf16 v[244:247], v[68:71], v[44:47], v[244:247]
    s_add_u32 m0, s50, 26112
    v_accvgpr_read_b32 v2, a178
    v_accvgpr_read_b32 v3, a179
    v_mfma_f32_16x16x32_bf16 v[152:155], v[72:75], v[32:35], v[152:155]
    buffer_load_dwordx4 v21, s[20:23], s37 offen offset:0 lds
    v_mfma_f32_16x16x32_bf16 v[184:187], v[72:75], v[36:39], v[184:187]
    v_cvt_pk_bf16_f32 v0, v0, v1
    v_cvt_pk_bf16_f32 v1, v2, v3
    v_mfma_f32_16x16x32_bf16 v[216:219], v[72:75], v[40:43], v[216:219]
    v_cvt_pk_bf16_f32 v2, v4, v5
    v_cvt_pk_bf16_f32 v3, v6, v7
    v_mfma_f32_16x16x32_bf16 v[248:251], v[72:75], v[44:47], v[248:251]
    buffer_store_dwordx4 v[8:11], v16, s[16:19], s41 offen offset:0
    v_mfma_f32_16x16x32_bf16 v[156:159], v[76:79], v[32:35], v[156:159]
    v_accvgpr_read_b32 v12, a112
    v_accvgpr_read_b32 v13, a113
    v_mfma_f32_16x16x32_bf16 v[188:191], v[76:79], v[36:39], v[188:191]
    v_accvgpr_read_b32 v14, a114
    v_accvgpr_read_b32 v15, a115
    v_mfma_f32_16x16x32_bf16 v[220:223], v[76:79], v[40:43], v[220:223]
    buffer_load_dwordx4 v22, s[20:23], s37 offen offset:1024 lds
    v_mfma_f32_16x16x32_bf16 v[252:255], v[76:79], v[44:47], v[252:255]
    s_waitcnt vmcnt(15) lgkmcnt(0)
    s_barrier
    v_accvgpr_read_b32 v8, a80
    v_accvgpr_read_b32 v9, a81
    v_mfma_f32_16x16x32_bf16 v[128:131], v[96:99], v[80:83], v[128:131]
    ds_read_b64_tr_b16 v[48:49], v27 offset:0
    ds_read_b64_tr_b16 v[50:51], v27 offset:1024
    v_mfma_f32_16x16x32_bf16 v[160:163], v[96:99], v[84:87], v[160:163]
    s_add_u32 s36, s44, 1024
    v_accvgpr_read_b32 v10, a82
    v_accvgpr_read_b32 v11, a83
    v_mfma_f32_16x16x32_bf16 v[192:195], v[96:99], v[88:91], v[192:195]
    s_add_u32 m0, s42, 32768
    ds_read_b128 v[32:35], v25 offset:0
    ds_read_b128 v[36:39], v25 offset:2048
    v_mfma_f32_16x16x32_bf16 v[224:227], v[96:99], v[92:95], v[224:227]
    buffer_load_dwordx4 v17, s[24:27], s36 offen offset:0 lds
    v_mfma_f32_16x16x32_bf16 v[132:135], v[100:103], v[80:83], v[132:135]
    ds_read_b128 v[40:43], v25 offset:4096
    ds_read_b128 v[44:47], v25 offset:6144
    v_mfma_f32_16x16x32_bf16 v[164:167], v[100:103], v[84:87], v[164:167]
    v_mul_f32 v8, s40, v8
    v_mul_f32 v9, s40, v9
    v_mfma_f32_16x16x32_bf16 v[196:199], v[100:103], v[88:91], v[196:199]
    ds_read_b64_tr_b16 v[52:53], v28 offset:0
    ds_read_b64_tr_b16 v[54:55], v28 offset:1024
    v_mfma_f32_16x16x32_bf16 v[228:231], v[100:103], v[92:95], v[228:231]
    buffer_load_dwordx4 v18, s[24:27], s36 offen offset:1024 lds
    v_mfma_f32_16x16x32_bf16 v[136:139], v[104:107], v[80:83], v[136:139]
    ds_read_b64_tr_b16 v[56:57], v29 offset:0
    ds_read_b64_tr_b16 v[58:59], v29 offset:1024
    v_mfma_f32_16x16x32_bf16 v[168:171], v[104:107], v[84:87], v[168:171]
    v_mul_f32 v10, s40, v10
    v_mul_f32 v11, s40, v11
    v_mfma_f32_16x16x32_bf16 v[200:203], v[104:107], v[88:91], v[200:203]
    ds_read_b64_tr_b16 v[60:61], v30 offset:0
    ds_read_b64_tr_b16 v[62:63], v30 offset:1024
    v_mfma_f32_16x16x32_bf16 v[232:235], v[104:107], v[92:95], v[232:235]
    buffer_store_dwordx4 v[0:3], v16, s[16:19], s38 offen offset:1024
    v_mfma_f32_16x16x32_bf16 v[140:143], v[108:111], v[80:83], v[140:143]
    ds_read_b64_tr_b16 v[64:65], v27 offset:128
    ds_read_b64_tr_b16 v[66:67], v27 offset:1152
    v_mfma_f32_16x16x32_bf16 v[172:175], v[108:111], v[84:87], v[172:175]
    v_mul_f32 v12, s40, v12
    v_mul_f32 v13, s40, v13
    v_mfma_f32_16x16x32_bf16 v[204:207], v[108:111], v[88:91], v[204:207]
    ds_read_b64_tr_b16 v[68:69], v28 offset:128
    ds_read_b64_tr_b16 v[70:71], v28 offset:1152
    v_mfma_f32_16x16x32_bf16 v[236:239], v[108:111], v[92:95], v[236:239]
    buffer_load_dwordx4 v19, s[24:27], s36 offen offset:2048 lds
    v_mfma_f32_16x16x32_bf16 v[144:147], v[112:115], v[80:83], v[144:147]
    ds_read_b64_tr_b16 v[72:73], v29 offset:128
    ds_read_b64_tr_b16 v[74:75], v29 offset:1152
    v_mfma_f32_16x16x32_bf16 v[176:179], v[112:115], v[84:87], v[176:179]
    v_mul_f32 v14, s40, v14
    v_mul_f32 v15, s40, v15
    v_mfma_f32_16x16x32_bf16 v[208:211], v[112:115], v[88:91], v[208:211]
    ds_read_b64_tr_b16 v[76:77], v30 offset:128
    ds_read_b64_tr_b16 v[78:79], v30 offset:1152
    v_mfma_f32_16x16x32_bf16 v[240:243], v[112:115], v[92:95], v[240:243]
    v_cvt_pk_bf16_f32 v8, v8, v9
    v_cvt_pk_bf16_f32 v9, v10, v11
    v_mfma_f32_16x16x32_bf16 v[148:151], v[116:119], v[80:83], v[148:151]
    v_cvt_pk_bf16_f32 v10, v12, v13
    v_cvt_pk_bf16_f32 v11, v14, v15
    v_mfma_f32_16x16x32_bf16 v[180:183], v[116:119], v[84:87], v[180:183]
    buffer_load_dwordx4 v20, s[24:27], s36 offen offset:3072 lds
    v_mfma_f32_16x16x32_bf16 v[212:215], v[116:119], v[88:91], v[212:215]
    s_add_u32 s37, s49, 4194304
    v_accvgpr_read_b32 v4, a212
    v_accvgpr_read_b32 v5, a213
    v_mfma_f32_16x16x32_bf16 v[244:247], v[116:119], v[92:95], v[244:247]
    s_add_u32 m0, s50, 34816
    v_accvgpr_read_b32 v6, a214
    v_accvgpr_read_b32 v7, a215
    v_mfma_f32_16x16x32_bf16 v[152:155], v[120:123], v[80:83], v[152:155]
    buffer_load_dwordx4 v21, s[20:23], s37 offen offset:0 lds
    v_mfma_f32_16x16x32_bf16 v[184:187], v[120:123], v[84:87], v[184:187]
    v_accvgpr_read_b32 v0, a208
    v_accvgpr_read_b32 v1, a209
    v_mfma_f32_16x16x32_bf16 v[216:219], v[120:123], v[88:91], v[216:219]
    v_accvgpr_read_b32 v2, a210
    v_accvgpr_read_b32 v3, a211
    v_mfma_f32_16x16x32_bf16 v[248:251], v[120:123], v[92:95], v[248:251]
    buffer_store_dwordx4 v[8:11], v16, s[16:19], s41 offen offset:1024
    v_mfma_f32_16x16x32_bf16 v[156:159], v[124:127], v[80:83], v[156:159]
    s_add_u32 s41, s41, 4096
    v_cvt_pk_bf16_f32 v0, v0, v1
    v_cvt_pk_bf16_f32 v1, v2, v3
    v_mfma_f32_16x16x32_bf16 v[188:191], v[124:127], v[84:87], v[188:191]
    v_cvt_pk_bf16_f32 v2, v4, v5
    v_cvt_pk_bf16_f32 v3, v6, v7
    v_mfma_f32_16x16x32_bf16 v[220:223], v[124:127], v[88:91], v[220:223]
    buffer_load_dwordx4 v22, s[20:23], s37 offen offset:1024 lds
    v_mfma_f32_16x16x32_bf16 v[252:255], v[124:127], v[92:95], v[252:255]
    s_waitcnt lgkmcnt(0)
    v_accvgpr_read_b32 v12, a52
    v_accvgpr_read_b32 v13, a53
    v_mfma_f32_16x16x32_bf16 v[128:131], v[48:51], v[32:35], v[128:131]
    ds_read_b64_tr_b16 v[96:97], v27 offset:8704
    ds_read_b64_tr_b16 v[98:99], v27 offset:9728
    v_mfma_f32_16x16x32_bf16 v[160:163], v[48:51], v[36:39], v[160:163]
gated_mix__ssm_conv_h3__compressed_kv_cla__prompt_kernel_pad5:
    s_cbranch_execz gated_mix__ssm_conv_h3__compressed_kv_cla__prompt_kernel_pad9
    s_add_u32 s36, s45, 1024
    v_accvgpr_read_b32 v14, a54
    v_accvgpr_read_b32 v15, a55
    v_mfma_f32_16x16x32_bf16 v[192:195], v[48:51], v[40:43], v[192:195]
    s_add_u32 m0, s42, 36864
    ds_read_b128 v[80:83], v26 offset:0
    ds_read_b128 v[84:87], v26 offset:2048
    v_mfma_f32_16x16x32_bf16 v[224:227], v[48:51], v[44:47], v[224:227]
    buffer_load_dwordx4 v17, s[24:27], s36 offen offset:0 lds
    v_mfma_f32_16x16x32_bf16 v[132:135], v[52:55], v[32:35], v[132:135]
    ds_read_b128 v[88:91], v26 offset:4096
    ds_read_b128 v[92:95], v26 offset:6144
    v_mfma_f32_16x16x32_bf16 v[164:167], v[52:55], v[36:39], v[164:167]
    v_accvgpr_read_b32 v8, a20
    v_accvgpr_read_b32 v9, a21
    v_mfma_f32_16x16x32_bf16 v[196:199], v[52:55], v[40:43], v[196:199]
    ds_read_b64_tr_b16 v[100:101], v28 offset:8704
    ds_read_b64_tr_b16 v[102:103], v28 offset:9728
    v_mfma_f32_16x16x32_bf16 v[228:231], v[52:55], v[44:47], v[228:231]
    buffer_load_dwordx4 v18, s[24:27], s36 offen offset:1024 lds
    v_mfma_f32_16x16x32_bf16 v[136:139], v[56:59], v[32:35], v[136:139]
    ds_read_b64_tr_b16 v[104:105], v29 offset:8704
    ds_read_b64_tr_b16 v[106:107], v29 offset:9728
    v_mfma_f32_16x16x32_bf16 v[168:171], v[56:59], v[36:39], v[168:171]
    v_accvgpr_read_b32 v10, a22
    v_accvgpr_read_b32 v11, a23
    v_mfma_f32_16x16x32_bf16 v[200:203], v[56:59], v[40:43], v[200:203]
    ds_read_b64_tr_b16 v[108:109], v30 offset:8704
    ds_read_b64_tr_b16 v[110:111], v30 offset:9728
    v_mfma_f32_16x16x32_bf16 v[232:235], v[56:59], v[44:47], v[232:235]
    buffer_store_dwordx4 v[0:3], v16, s[16:19], s38 offen offset:2048
    v_mfma_f32_16x16x32_bf16 v[140:143], v[60:63], v[32:35], v[140:143]
    ds_read_b64_tr_b16 v[112:113], v27 offset:8832
    ds_read_b64_tr_b16 v[114:115], v27 offset:9856
    v_mfma_f32_16x16x32_bf16 v[172:175], v[60:63], v[36:39], v[172:175]
    v_mul_f32 v8, s40, v8
    v_mul_f32 v9, s40, v9
    v_mfma_f32_16x16x32_bf16 v[204:207], v[60:63], v[40:43], v[204:207]
    ds_read_b64_tr_b16 v[116:117], v28 offset:8832
    ds_read_b64_tr_b16 v[118:119], v28 offset:9856
    v_mfma_f32_16x16x32_bf16 v[236:239], v[60:63], v[44:47], v[236:239]
    buffer_load_dwordx4 v19, s[24:27], s36 offen offset:2048 lds
    v_mfma_f32_16x16x32_bf16 v[144:147], v[64:67], v[32:35], v[144:147]
    ds_read_b64_tr_b16 v[120:121], v29 offset:8832
    ds_read_b64_tr_b16 v[122:123], v29 offset:9856
    v_mfma_f32_16x16x32_bf16 v[176:179], v[64:67], v[36:39], v[176:179]
    v_mul_f32 v10, s40, v10
    v_mul_f32 v11, s40, v11
    v_mfma_f32_16x16x32_bf16 v[208:211], v[64:67], v[40:43], v[208:211]
    ds_read_b64_tr_b16 v[124:125], v30 offset:8832
    ds_read_b64_tr_b16 v[126:127], v30 offset:9856
    v_mfma_f32_16x16x32_bf16 v[240:243], v[64:67], v[44:47], v[240:243]
    v_mul_f32 v12, s40, v12
    v_mul_f32 v13, s40, v13
    v_mfma_f32_16x16x32_bf16 v[148:151], v[68:71], v[32:35], v[148:151]
    v_mul_f32 v14, s40, v14
    v_mul_f32 v15, s40, v15
    v_mfma_f32_16x16x32_bf16 v[180:183], v[68:71], v[36:39], v[180:183]
    buffer_load_dwordx4 v20, s[24:27], s36 offen offset:3072 lds
    v_mfma_f32_16x16x32_bf16 v[212:215], v[68:71], v[40:43], v[212:215]
    s_add_u32 s37, s49, 4456448
    v_cvt_pk_bf16_f32 v8, v8, v9
    v_cvt_pk_bf16_f32 v9, v10, v11
    v_mfma_f32_16x16x32_bf16 v[244:247], v[68:71], v[44:47], v[244:247]
    s_add_u32 m0, s50, 43520
    v_cvt_pk_bf16_f32 v10, v12, v13
    v_cvt_pk_bf16_f32 v11, v14, v15
    v_mfma_f32_16x16x32_bf16 v[152:155], v[72:75], v[32:35], v[152:155]
    buffer_load_dwordx4 v21, s[20:23], s37 offen offset:0 lds
    v_mfma_f32_16x16x32_bf16 v[184:187], v[72:75], v[36:39], v[184:187]
    v_accvgpr_read_b32 v4, a244
    v_accvgpr_read_b32 v5, a245
    v_mfma_f32_16x16x32_bf16 v[216:219], v[72:75], v[40:43], v[216:219]
    v_accvgpr_read_b32 v6, a246
    v_accvgpr_read_b32 v7, a247
    v_mfma_f32_16x16x32_bf16 v[248:251], v[72:75], v[44:47], v[248:251]
    buffer_store_dwordx4 v[8:11], v16, s[16:19], s41 offen offset:0
    v_mfma_f32_16x16x32_bf16 v[156:159], v[76:79], v[32:35], v[156:159]
    v_accvgpr_read_b32 v0, a240
    v_accvgpr_read_b32 v1, a241
    v_mfma_f32_16x16x32_bf16 v[188:191], v[76:79], v[36:39], v[188:191]
    v_accvgpr_read_b32 v2, a242
    v_accvgpr_read_b32 v3, a243
    v_mfma_f32_16x16x32_bf16 v[220:223], v[76:79], v[40:43], v[220:223]
    buffer_load_dwordx4 v22, s[20:23], s37 offen offset:1024 lds
    v_mfma_f32_16x16x32_bf16 v[252:255], v[76:79], v[44:47], v[252:255]
    s_waitcnt vmcnt(16) lgkmcnt(0)
    s_barrier
    v_cvt_pk_bf16_f32 v0, v0, v1
    v_cvt_pk_bf16_f32 v1, v2, v3
    v_mfma_f32_16x16x32_bf16 v[128:131], v[96:99], v[80:83], v[128:131]
    ds_read_b64_tr_b16 v[48:49], v27 offset:17408
    ds_read_b64_tr_b16 v[50:51], v27 offset:18432
    v_mfma_f32_16x16x32_bf16 v[160:163], v[96:99], v[84:87], v[160:163]
    s_add_u32 s36, s44, 1152
    v_cvt_pk_bf16_f32 v2, v4, v5
    v_cvt_pk_bf16_f32 v3, v6, v7
    v_mfma_f32_16x16x32_bf16 v[192:195], v[96:99], v[88:91], v[192:195]
    s_add_u32 m0, s42, 65536
    ds_read_b128 v[32:35], v23 offset:0
    ds_read_b128 v[36:39], v23 offset:2048
    v_mfma_f32_16x16x32_bf16 v[224:227], v[96:99], v[92:95], v[224:227]
    buffer_load_dwordx4 v17, s[24:27], s36 offen offset:0 lds
    v_mfma_f32_16x16x32_bf16 v[132:135], v[100:103], v[80:83], v[132:135]
    ds_read_b128 v[40:43], v23 offset:4096
    ds_read_b128 v[44:47], v23 offset:6144
    v_mfma_f32_16x16x32_bf16 v[164:167], v[100:103], v[84:87], v[164:167]
    v_accvgpr_read_b32 v12, a116
    v_accvgpr_read_b32 v13, a117
    v_mfma_f32_16x16x32_bf16 v[196:199], v[100:103], v[88:91], v[196:199]
    ds_read_b64_tr_b16 v[52:53], v28 offset:17408
    ds_read_b64_tr_b16 v[54:55], v28 offset:18432
    v_mfma_f32_16x16x32_bf16 v[228:231], v[100:103], v[92:95], v[228:231]
    buffer_load_dwordx4 v18, s[24:27], s36 offen offset:1024 lds
    v_mfma_f32_16x16x32_bf16 v[136:139], v[104:107], v[80:83], v[136:139]
    ds_read_b64_tr_b16 v[56:57], v29 offset:17408
    ds_read_b64_tr_b16 v[58:59], v29 offset:18432
    v_mfma_f32_16x16x32_bf16 v[168:171], v[104:107], v[84:87], v[168:171]
    v_accvgpr_read_b32 v14, a118
    v_accvgpr_read_b32 v15, a119
    v_mfma_f32_16x16x32_bf16 v[200:203], v[104:107], v[88:91], v[200:203]
    ds_read_b64_tr_b16 v[60:61], v30 offset:17408
    ds_read_b64_tr_b16 v[62:63], v30 offset:18432
    v_mfma_f32_16x16x32_bf16 v[232:235], v[104:107], v[92:95], v[232:235]
    buffer_store_dwordx4 v[0:3], v16, s[16:19], s38 offen offset:3072
    v_mfma_f32_16x16x32_bf16 v[140:143], v[108:111], v[80:83], v[140:143]
    s_add_u32 s38, s38, 16384
    ds_read_b64_tr_b16 v[64:65], v27 offset:17536
    ds_read_b64_tr_b16 v[66:67], v27 offset:18560
    v_mfma_f32_16x16x32_bf16 v[172:175], v[108:111], v[84:87], v[172:175]
    v_accvgpr_read_b32 v8, a84
    v_accvgpr_read_b32 v9, a85
    v_mfma_f32_16x16x32_bf16 v[204:207], v[108:111], v[88:91], v[204:207]
    ds_read_b64_tr_b16 v[68:69], v28 offset:17536
    ds_read_b64_tr_b16 v[70:71], v28 offset:18560
    v_mfma_f32_16x16x32_bf16 v[236:239], v[108:111], v[92:95], v[236:239]
    buffer_load_dwordx4 v19, s[24:27], s36 offen offset:2048 lds
    v_mfma_f32_16x16x32_bf16 v[144:147], v[112:115], v[80:83], v[144:147]
    ds_read_b64_tr_b16 v[72:73], v29 offset:17536
    ds_read_b64_tr_b16 v[74:75], v29 offset:18560
    v_mfma_f32_16x16x32_bf16 v[176:179], v[112:115], v[84:87], v[176:179]
    v_accvgpr_read_b32 v10, a86
    v_accvgpr_read_b32 v11, a87
    v_mfma_f32_16x16x32_bf16 v[208:211], v[112:115], v[88:91], v[208:211]
    ds_read_b64_tr_b16 v[76:77], v30 offset:17536
    ds_read_b64_tr_b16 v[78:79], v30 offset:18560
    v_mfma_f32_16x16x32_bf16 v[240:243], v[112:115], v[92:95], v[240:243]
    v_mul_f32 v8, s40, v8
    v_mul_f32 v9, s40, v9
    v_mfma_f32_16x16x32_bf16 v[148:151], v[116:119], v[80:83], v[148:151]
    v_mul_f32 v10, s40, v10
    v_mul_f32 v11, s40, v11
    v_mfma_f32_16x16x32_bf16 v[180:183], v[116:119], v[84:87], v[180:183]
    buffer_load_dwordx4 v20, s[24:27], s36 offen offset:3072 lds
    v_mfma_f32_16x16x32_bf16 v[212:215], v[116:119], v[88:91], v[212:215]
    s_add_u32 s37, s49, 4718592
    v_mul_f32 v12, s40, v12
    v_mul_f32 v13, s40, v13
    v_mfma_f32_16x16x32_bf16 v[244:247], v[116:119], v[92:95], v[244:247]
    s_add_u32 m0, s50, 0
    v_mul_f32 v14, s40, v14
    v_mul_f32 v15, s40, v15
    v_mfma_f32_16x16x32_bf16 v[152:155], v[120:123], v[80:83], v[152:155]
    buffer_load_dwordx4 v21, s[20:23], s37 offen offset:0 lds
    v_mfma_f32_16x16x32_bf16 v[184:187], v[120:123], v[84:87], v[184:187]
    v_cvt_pk_bf16_f32 v8, v8, v9
    v_cvt_pk_bf16_f32 v9, v10, v11
    v_mfma_f32_16x16x32_bf16 v[216:219], v[120:123], v[88:91], v[216:219]
    v_cvt_pk_bf16_f32 v10, v12, v13
    v_cvt_pk_bf16_f32 v11, v14, v15
    v_mfma_f32_16x16x32_bf16 v[248:251], v[120:123], v[92:95], v[248:251]
    buffer_store_dwordx4 v[8:11], v16, s[16:19], s41 offen offset:1024
    v_mfma_f32_16x16x32_bf16 v[156:159], v[124:127], v[80:83], v[156:159]
    s_add_u32 s41, s41, 12288
    v_accvgpr_read_b32 v4, a156
    v_accvgpr_read_b32 v5, a157
    v_mfma_f32_16x16x32_bf16 v[188:191], v[124:127], v[84:87], v[188:191]
    v_accvgpr_read_b32 v6, a158
    v_accvgpr_read_b32 v7, a159
    v_mfma_f32_16x16x32_bf16 v[220:223], v[124:127], v[88:91], v[220:223]
    buffer_load_dwordx4 v22, s[20:23], s37 offen offset:1024 lds
    v_mfma_f32_16x16x32_bf16 v[252:255], v[124:127], v[92:95], v[252:255]
    s_waitcnt lgkmcnt(0)
    v_accvgpr_read_b32 v0, a152
    v_accvgpr_read_b32 v1, a153
    v_mfma_f32_16x16x32_bf16 v[128:131], v[48:51], v[32:35], v[128:131]
    ds_read_b64_tr_b16 v[96:97], v27 offset:26112
    ds_read_b64_tr_b16 v[98:99], v27 offset:27136
    v_mfma_f32_16x16x32_bf16 v[160:163], v[48:51], v[36:39], v[160:163]
    s_add_u32 s36, s45, 1152
    v_accvgpr_read_b32 v2, a154
    v_accvgpr_read_b32 v3, a155
    v_mfma_f32_16x16x32_bf16 v[192:195], v[48:51], v[40:43], v[192:195]
    s_add_u32 m0, s42, 69632
    ds_read_b128 v[80:83], v24 offset:0
    ds_read_b128 v[84:87], v24 offset:2048
    v_mfma_f32_16x16x32_bf16 v[224:227], v[48:51], v[44:47], v[224:227]
    buffer_load_dwordx4 v17, s[24:27], s36 offen offset:0 lds
    v_mfma_f32_16x16x32_bf16 v[132:135], v[52:55], v[32:35], v[132:135]
    ds_read_b128 v[88:91], v24 offset:4096
    ds_read_b128 v[92:95], v24 offset:6144
    v_mfma_f32_16x16x32_bf16 v[164:167], v[52:55], v[36:39], v[164:167]
    v_cvt_pk_bf16_f32 v0, v0, v1
    v_cvt_pk_bf16_f32 v1, v2, v3
    v_mfma_f32_16x16x32_bf16 v[196:199], v[52:55], v[40:43], v[196:199]
    ds_read_b64_tr_b16 v[100:101], v28 offset:26112
    ds_read_b64_tr_b16 v[102:103], v28 offset:27136
    v_mfma_f32_16x16x32_bf16 v[228:231], v[52:55], v[44:47], v[228:231]
    buffer_load_dwordx4 v18, s[24:27], s36 offen offset:1024 lds
    v_mfma_f32_16x16x32_bf16 v[136:139], v[56:59], v[32:35], v[136:139]
    ds_read_b64_tr_b16 v[104:105], v29 offset:26112
    ds_read_b64_tr_b16 v[106:107], v29 offset:27136
    v_mfma_f32_16x16x32_bf16 v[168:171], v[56:59], v[36:39], v[168:171]
    v_cvt_pk_bf16_f32 v2, v4, v5
    v_cvt_pk_bf16_f32 v3, v6, v7
    v_mfma_f32_16x16x32_bf16 v[200:203], v[56:59], v[40:43], v[200:203]
    ds_read_b64_tr_b16 v[108:109], v30 offset:26112
    ds_read_b64_tr_b16 v[110:111], v30 offset:27136
    v_mfma_f32_16x16x32_bf16 v[232:235], v[56:59], v[44:47], v[232:235]
    buffer_store_dwordx4 v[0:3], v16, s[16:19], s38 offen offset:0
    v_mfma_f32_16x16x32_bf16 v[140:143], v[60:63], v[32:35], v[140:143]
    ds_read_b64_tr_b16 v[112:113], v27 offset:26240
    ds_read_b64_tr_b16 v[114:115], v27 offset:27264
    v_mfma_f32_16x16x32_bf16 v[172:175], v[60:63], v[36:39], v[172:175]
    v_accvgpr_read_b32 v12, a56
    v_accvgpr_read_b32 v13, a57
    v_mfma_f32_16x16x32_bf16 v[204:207], v[60:63], v[40:43], v[204:207]
    ds_read_b64_tr_b16 v[116:117], v28 offset:26240
    ds_read_b64_tr_b16 v[118:119], v28 offset:27264
    v_mfma_f32_16x16x32_bf16 v[236:239], v[60:63], v[44:47], v[236:239]
    buffer_load_dwordx4 v19, s[24:27], s36 offen offset:2048 lds
    v_mfma_f32_16x16x32_bf16 v[144:147], v[64:67], v[32:35], v[144:147]
    ds_read_b64_tr_b16 v[120:121], v29 offset:26240
    ds_read_b64_tr_b16 v[122:123], v29 offset:27264
    v_mfma_f32_16x16x32_bf16 v[176:179], v[64:67], v[36:39], v[176:179]
    v_accvgpr_read_b32 v14, a58
    v_accvgpr_read_b32 v15, a59
    v_mfma_f32_16x16x32_bf16 v[208:211], v[64:67], v[40:43], v[208:211]
    ds_read_b64_tr_b16 v[124:125], v30 offset:26240
    ds_read_b64_tr_b16 v[126:127], v30 offset:27264
    v_mfma_f32_16x16x32_bf16 v[240:243], v[64:67], v[44:47], v[240:243]
    v_accvgpr_read_b32 v8, a24
    v_accvgpr_read_b32 v9, a25
    v_mfma_f32_16x16x32_bf16 v[148:151], v[68:71], v[32:35], v[148:151]
    v_accvgpr_read_b32 v10, a26
    v_accvgpr_read_b32 v11, a27
    v_mfma_f32_16x16x32_bf16 v[180:183], v[68:71], v[36:39], v[180:183]
    buffer_load_dwordx4 v20, s[24:27], s36 offen offset:3072 lds
    v_mfma_f32_16x16x32_bf16 v[212:215], v[68:71], v[40:43], v[212:215]
    s_add_u32 s37, s49, 4980736
    v_mul_f32 v8, s40, v8
    v_mul_f32 v9, s40, v9
    v_mfma_f32_16x16x32_bf16 v[244:247], v[68:71], v[44:47], v[244:247]
    s_add_u32 m0, s50, 8704
    v_mul_f32 v10, s40, v10
    v_mul_f32 v11, s40, v11
    v_mfma_f32_16x16x32_bf16 v[152:155], v[72:75], v[32:35], v[152:155]
    buffer_load_dwordx4 v21, s[20:23], s37 offen offset:0 lds
    v_mfma_f32_16x16x32_bf16 v[184:187], v[72:75], v[36:39], v[184:187]
    v_mul_f32 v12, s40, v12
    v_mul_f32 v13, s40, v13
    v_mfma_f32_16x16x32_bf16 v[216:219], v[72:75], v[40:43], v[216:219]
    v_mul_f32 v14, s40, v14
    v_mul_f32 v15, s40, v15
    v_mfma_f32_16x16x32_bf16 v[248:251], v[72:75], v[44:47], v[248:251]
    v_mfma_f32_16x16x32_bf16 v[156:159], v[76:79], v[32:35], v[156:159]
    v_cvt_pk_bf16_f32 v8, v8, v9
    v_cvt_pk_bf16_f32 v9, v10, v11
    v_mfma_f32_16x16x32_bf16 v[188:191], v[76:79], v[36:39], v[188:191]
    v_cvt_pk_bf16_f32 v10, v12, v13
    v_cvt_pk_bf16_f32 v11, v14, v15
    v_mfma_f32_16x16x32_bf16 v[220:223], v[76:79], v[40:43], v[220:223]
    buffer_load_dwordx4 v22, s[20:23], s37 offen offset:1024 lds
    v_mfma_f32_16x16x32_bf16 v[252:255], v[76:79], v[44:47], v[252:255]
    s_waitcnt vmcnt(15) lgkmcnt(0)
    s_barrier
    v_accvgpr_read_b32 v4, a188
    v_accvgpr_read_b32 v5, a189
    v_mfma_f32_16x16x32_bf16 v[128:131], v[96:99], v[80:83], v[128:131]
    ds_read_b64_tr_b16 v[48:49], v27 offset:34816
    ds_read_b64_tr_b16 v[50:51], v27 offset:35840
    v_mfma_f32_16x16x32_bf16 v[160:163], v[96:99], v[84:87], v[160:163]
    s_add_u32 s36, s44, 1280
    v_accvgpr_read_b32 v6, a190
    v_accvgpr_read_b32 v7, a191
    v_mfma_f32_16x16x32_bf16 v[192:195], v[96:99], v[88:91], v[192:195]
    s_add_u32 m0, s42, 0
    ds_read_b128 v[32:35], v23 offset:32768
    ds_read_b128 v[36:39], v23 offset:34816
    v_mfma_f32_16x16x32_bf16 v[224:227], v[96:99], v[92:95], v[224:227]
    buffer_load_dwordx4 v17, s[24:27], s36 offen offset:0 lds
    v_mfma_f32_16x16x32_bf16 v[132:135], v[100:103], v[80:83], v[132:135]
    ds_read_b128 v[40:43], v23 offset:36864
    ds_read_b128 v[44:47], v23 offset:38912
    v_mfma_f32_16x16x32_bf16 v[164:167], v[100:103], v[84:87], v[164:167]
    v_accvgpr_read_b32 v0, a184
    v_accvgpr_read_b32 v1, a185
    v_mfma_f32_16x16x32_bf16 v[196:199], v[100:103], v[88:91], v[196:199]
    ds_read_b64_tr_b16 v[52:53], v28 offset:34816
    ds_read_b64_tr_b16 v[54:55], v28 offset:35840
    v_mfma_f32_16x16x32_bf16 v[228:231], v[100:103], v[92:95], v[228:231]
    buffer_load_dwordx4 v18, s[24:27], s36 offen offset:1024 lds
    v_mfma_f32_16x16x32_bf16 v[136:139], v[104:107], v[80:83], v[136:139]
    ds_read_b64_tr_b16 v[56:57], v29 offset:34816
    ds_read_b64_tr_b16 v[58:59], v29 offset:35840
    v_mfma_f32_16x16x32_bf16 v[168:171], v[104:107], v[84:87], v[168:171]
    v_accvgpr_read_b32 v2, a186
    v_accvgpr_read_b32 v3, a187
    v_mfma_f32_16x16x32_bf16 v[200:203], v[104:107], v[88:91], v[200:203]
    ds_read_b64_tr_b16 v[60:61], v30 offset:34816
    ds_read_b64_tr_b16 v[62:63], v30 offset:35840
    v_mfma_f32_16x16x32_bf16 v[232:235], v[104:107], v[92:95], v[232:235]
    buffer_store_dwordx4 v[8:11], v16, s[16:19], s41 offen offset:0
    v_mfma_f32_16x16x32_bf16 v[140:143], v[108:111], v[80:83], v[140:143]
    ds_read_b64_tr_b16 v[64:65], v27 offset:34944
    ds_read_b64_tr_b16 v[66:67], v27 offset:35968
    v_mfma_f32_16x16x32_bf16 v[172:175], v[108:111], v[84:87], v[172:175]
    v_cvt_pk_bf16_f32 v0, v0, v1
    v_cvt_pk_bf16_f32 v1, v2, v3
    v_mfma_f32_16x16x32_bf16 v[204:207], v[108:111], v[88:91], v[204:207]
    ds_read_b64_tr_b16 v[68:69], v28 offset:34944
    ds_read_b64_tr_b16 v[70:71], v28 offset:35968
    v_mfma_f32_16x16x32_bf16 v[236:239], v[108:111], v[92:95], v[236:239]
    buffer_load_dwordx4 v19, s[24:27], s36 offen offset:2048 lds
    v_mfma_f32_16x16x32_bf16 v[144:147], v[112:115], v[80:83], v[144:147]
    ds_read_b64_tr_b16 v[72:73], v29 offset:34944
    ds_read_b64_tr_b16 v[74:75], v29 offset:35968
    v_mfma_f32_16x16x32_bf16 v[176:179], v[112:115], v[84:87], v[176:179]
    v_cvt_pk_bf16_f32 v2, v4, v5
    v_cvt_pk_bf16_f32 v3, v6, v7
    v_mfma_f32_16x16x32_bf16 v[208:211], v[112:115], v[88:91], v[208:211]
    ds_read_b64_tr_b16 v[76:77], v30 offset:34944
    ds_read_b64_tr_b16 v[78:79], v30 offset:35968
    v_mfma_f32_16x16x32_bf16 v[240:243], v[112:115], v[92:95], v[240:243]
    v_accvgpr_read_b32 v12, a120
    v_accvgpr_read_b32 v13, a121
    v_mfma_f32_16x16x32_bf16 v[148:151], v[116:119], v[80:83], v[148:151]
    v_accvgpr_read_b32 v14, a122
    v_accvgpr_read_b32 v15, a123
    v_mfma_f32_16x16x32_bf16 v[180:183], v[116:119], v[84:87], v[180:183]
    buffer_load_dwordx4 v20, s[24:27], s36 offen offset:3072 lds
    v_mfma_f32_16x16x32_bf16 v[212:215], v[116:119], v[88:91], v[212:215]
    s_add_u32 s37, s49, 5242880
    v_accvgpr_read_b32 v8, a88
    v_accvgpr_read_b32 v9, a89
    v_mfma_f32_16x16x32_bf16 v[244:247], v[116:119], v[92:95], v[244:247]
    s_add_u32 m0, s50, 17408
    v_accvgpr_read_b32 v10, a90
    v_accvgpr_read_b32 v11, a91
    v_mfma_f32_16x16x32_bf16 v[152:155], v[120:123], v[80:83], v[152:155]
    buffer_load_dwordx4 v21, s[20:23], s37 offen offset:0 lds
    v_mfma_f32_16x16x32_bf16 v[184:187], v[120:123], v[84:87], v[184:187]
    v_mul_f32 v8, s40, v8
    v_mul_f32 v9, s40, v9
    v_mfma_f32_16x16x32_bf16 v[216:219], v[120:123], v[88:91], v[216:219]
    v_mul_f32 v10, s40, v10
    v_mul_f32 v11, s40, v11
    v_mfma_f32_16x16x32_bf16 v[248:251], v[120:123], v[92:95], v[248:251]
    buffer_store_dwordx4 v[0:3], v16, s[16:19], s38 offen offset:1024
    v_mfma_f32_16x16x32_bf16 v[156:159], v[124:127], v[80:83], v[156:159]
    v_mul_f32 v12, s40, v12
    v_mul_f32 v13, s40, v13
    v_mfma_f32_16x16x32_bf16 v[188:191], v[124:127], v[84:87], v[188:191]
    v_mul_f32 v14, s40, v14
    v_mul_f32 v15, s40, v15
    v_mfma_f32_16x16x32_bf16 v[220:223], v[124:127], v[88:91], v[220:223]
    buffer_load_dwordx4 v22, s[20:23], s37 offen offset:1024 lds
    v_mfma_f32_16x16x32_bf16 v[252:255], v[124:127], v[92:95], v[252:255]
    s_waitcnt lgkmcnt(0)
    v_cvt_pk_bf16_f32 v8, v8, v9
    v_cvt_pk_bf16_f32 v9, v10, v11
    v_mfma_f32_16x16x32_bf16 v[128:131], v[48:51], v[32:35], v[128:131]
    ds_read_b64_tr_b16 v[96:97], v27 offset:43520
    ds_read_b64_tr_b16 v[98:99], v27 offset:44544
    v_mfma_f32_16x16x32_bf16 v[160:163], v[48:51], v[36:39], v[160:163]
    s_add_u32 s36, s45, 1280
    v_cvt_pk_bf16_f32 v10, v12, v13
    v_cvt_pk_bf16_f32 v11, v14, v15
    v_mfma_f32_16x16x32_bf16 v[192:195], v[48:51], v[40:43], v[192:195]
    s_add_u32 m0, s42, 4096
    ds_read_b128 v[80:83], v24 offset:32768
    ds_read_b128 v[84:87], v24 offset:34816
    v_mfma_f32_16x16x32_bf16 v[224:227], v[48:51], v[44:47], v[224:227]
    buffer_load_dwordx4 v17, s[24:27], s36 offen offset:0 lds
    v_mfma_f32_16x16x32_bf16 v[132:135], v[52:55], v[32:35], v[132:135]
    ds_read_b128 v[88:91], v24 offset:36864
    ds_read_b128 v[92:95], v24 offset:38912
    v_mfma_f32_16x16x32_bf16 v[164:167], v[52:55], v[36:39], v[164:167]
    v_accvgpr_read_b32 v4, a220
    v_accvgpr_read_b32 v5, a221
    v_mfma_f32_16x16x32_bf16 v[196:199], v[52:55], v[40:43], v[196:199]
    ds_read_b64_tr_b16 v[100:101], v28 offset:43520
    ds_read_b64_tr_b16 v[102:103], v28 offset:44544
    v_mfma_f32_16x16x32_bf16 v[228:231], v[52:55], v[44:47], v[228:231]
    buffer_load_dwordx4 v18, s[24:27], s36 offen offset:1024 lds
    v_mfma_f32_16x16x32_bf16 v[136:139], v[56:59], v[32:35], v[136:139]
    ds_read_b64_tr_b16 v[104:105], v29 offset:43520
    ds_read_b64_tr_b16 v[106:107], v29 offset:44544
    v_mfma_f32_16x16x32_bf16 v[168:171], v[56:59], v[36:39], v[168:171]
    v_accvgpr_read_b32 v6, a222
    v_accvgpr_read_b32 v7, a223
    v_mfma_f32_16x16x32_bf16 v[200:203], v[56:59], v[40:43], v[200:203]
    ds_read_b64_tr_b16 v[108:109], v30 offset:43520
    ds_read_b64_tr_b16 v[110:111], v30 offset:44544
    v_mfma_f32_16x16x32_bf16 v[232:235], v[56:59], v[44:47], v[232:235]
    buffer_store_dwordx4 v[8:11], v16, s[16:19], s41 offen offset:1024
    v_mfma_f32_16x16x32_bf16 v[140:143], v[60:63], v[32:35], v[140:143]
    s_add_u32 s41, s41, 4096
    ds_read_b64_tr_b16 v[112:113], v27 offset:43648
    ds_read_b64_tr_b16 v[114:115], v27 offset:44672
    v_mfma_f32_16x16x32_bf16 v[172:175], v[60:63], v[36:39], v[172:175]
    v_accvgpr_read_b32 v0, a216
    v_accvgpr_read_b32 v1, a217
    v_mfma_f32_16x16x32_bf16 v[204:207], v[60:63], v[40:43], v[204:207]
    ds_read_b64_tr_b16 v[116:117], v28 offset:43648
    ds_read_b64_tr_b16 v[118:119], v28 offset:44672
    v_mfma_f32_16x16x32_bf16 v[236:239], v[60:63], v[44:47], v[236:239]
    buffer_load_dwordx4 v19, s[24:27], s36 offen offset:2048 lds
    v_mfma_f32_16x16x32_bf16 v[144:147], v[64:67], v[32:35], v[144:147]
    ds_read_b64_tr_b16 v[120:121], v29 offset:43648
    ds_read_b64_tr_b16 v[122:123], v29 offset:44672
    v_mfma_f32_16x16x32_bf16 v[176:179], v[64:67], v[36:39], v[176:179]
    v_accvgpr_read_b32 v2, a218
    v_accvgpr_read_b32 v3, a219
    v_mfma_f32_16x16x32_bf16 v[208:211], v[64:67], v[40:43], v[208:211]
    ds_read_b64_tr_b16 v[124:125], v30 offset:43648
    ds_read_b64_tr_b16 v[126:127], v30 offset:44672
    v_mfma_f32_16x16x32_bf16 v[240:243], v[64:67], v[44:47], v[240:243]
    v_cvt_pk_bf16_f32 v0, v0, v1
    v_cvt_pk_bf16_f32 v1, v2, v3
    v_mfma_f32_16x16x32_bf16 v[148:151], v[68:71], v[32:35], v[148:151]
    v_cvt_pk_bf16_f32 v2, v4, v5
    v_cvt_pk_bf16_f32 v3, v6, v7
    v_mfma_f32_16x16x32_bf16 v[180:183], v[68:71], v[36:39], v[180:183]
    buffer_load_dwordx4 v20, s[24:27], s36 offen offset:3072 lds
    v_mfma_f32_16x16x32_bf16 v[212:215], v[68:71], v[40:43], v[212:215]
    s_add_u32 s37, s49, 5505024
    v_accvgpr_read_b32 v12, a60
    v_accvgpr_read_b32 v13, a61
    v_mfma_f32_16x16x32_bf16 v[244:247], v[68:71], v[44:47], v[244:247]
    s_add_u32 m0, s50, 26112
    v_accvgpr_read_b32 v14, a62
    v_accvgpr_read_b32 v15, a63
    v_mfma_f32_16x16x32_bf16 v[152:155], v[72:75], v[32:35], v[152:155]
    buffer_load_dwordx4 v21, s[20:23], s37 offen offset:0 lds
    v_mfma_f32_16x16x32_bf16 v[184:187], v[72:75], v[36:39], v[184:187]
    v_accvgpr_read_b32 v8, a28
    v_accvgpr_read_b32 v9, a29
    v_mfma_f32_16x16x32_bf16 v[216:219], v[72:75], v[40:43], v[216:219]
    v_accvgpr_read_b32 v10, a30
    v_accvgpr_read_b32 v11, a31
    v_mfma_f32_16x16x32_bf16 v[248:251], v[72:75], v[44:47], v[248:251]
    buffer_store_dwordx4 v[0:3], v16, s[16:19], s38 offen offset:2048
    v_mfma_f32_16x16x32_bf16 v[156:159], v[76:79], v[32:35], v[156:159]
    v_mul_f32 v8, s40, v8
    v_mul_f32 v9, s40, v9
    v_mfma_f32_16x16x32_bf16 v[188:191], v[76:79], v[36:39], v[188:191]
    v_mul_f32 v10, s40, v10
    v_mul_f32 v11, s40, v11
    v_mfma_f32_16x16x32_bf16 v[220:223], v[76:79], v[40:43], v[220:223]
    buffer_load_dwordx4 v22, s[20:23], s37 offen offset:1024 lds
    v_mfma_f32_16x16x32_bf16 v[252:255], v[76:79], v[44:47], v[252:255]
    s_waitcnt vmcnt(16) lgkmcnt(0)
    s_barrier
    v_mul_f32 v12, s40, v12
    v_mul_f32 v13, s40, v13
    v_mfma_f32_16x16x32_bf16 v[128:131], v[96:99], v[80:83], v[128:131]
    ds_read_b64_tr_b16 v[48:49], v27 offset:0
    ds_read_b64_tr_b16 v[50:51], v27 offset:1024
    v_mfma_f32_16x16x32_bf16 v[160:163], v[96:99], v[84:87], v[160:163]
    s_add_u32 s36, s44, 1408
    v_mul_f32 v14, s40, v14
    v_mul_f32 v15, s40, v15
    v_mfma_f32_16x16x32_bf16 v[192:195], v[96:99], v[88:91], v[192:195]
    s_add_u32 m0, s42, 32768
    ds_read_b128 v[32:35], v25 offset:0
    ds_read_b128 v[36:39], v25 offset:2048
    v_mfma_f32_16x16x32_bf16 v[224:227], v[96:99], v[92:95], v[224:227]
    buffer_load_dwordx4 v17, s[24:27], s36 offen offset:0 lds
    v_mfma_f32_16x16x32_bf16 v[132:135], v[100:103], v[80:83], v[132:135]
    ds_read_b128 v[40:43], v25 offset:4096
    ds_read_b128 v[44:47], v25 offset:6144
    v_mfma_f32_16x16x32_bf16 v[164:167], v[100:103], v[84:87], v[164:167]
    v_cvt_pk_bf16_f32 v8, v8, v9
    v_cvt_pk_bf16_f32 v9, v10, v11
    v_mfma_f32_16x16x32_bf16 v[196:199], v[100:103], v[88:91], v[196:199]
    ds_read_b64_tr_b16 v[52:53], v28 offset:0
    ds_read_b64_tr_b16 v[54:55], v28 offset:1024
    v_mfma_f32_16x16x32_bf16 v[228:231], v[100:103], v[92:95], v[228:231]
    buffer_load_dwordx4 v18, s[24:27], s36 offen offset:1024 lds
    v_mfma_f32_16x16x32_bf16 v[136:139], v[104:107], v[80:83], v[136:139]
    ds_read_b64_tr_b16 v[56:57], v29 offset:0
    ds_read_b64_tr_b16 v[58:59], v29 offset:1024
    v_mfma_f32_16x16x32_bf16 v[168:171], v[104:107], v[84:87], v[168:171]
    v_cvt_pk_bf16_f32 v10, v12, v13
    v_cvt_pk_bf16_f32 v11, v14, v15
    v_mfma_f32_16x16x32_bf16 v[200:203], v[104:107], v[88:91], v[200:203]
    ds_read_b64_tr_b16 v[60:61], v30 offset:0
    ds_read_b64_tr_b16 v[62:63], v30 offset:1024
    v_mfma_f32_16x16x32_bf16 v[232:235], v[104:107], v[92:95], v[232:235]
    buffer_store_dwordx4 v[8:11], v16, s[16:19], s41 offen offset:0
    v_mfma_f32_16x16x32_bf16 v[140:143], v[108:111], v[80:83], v[140:143]
    ds_read_b64_tr_b16 v[64:65], v27 offset:128
    ds_read_b64_tr_b16 v[66:67], v27 offset:1152
    v_mfma_f32_16x16x32_bf16 v[172:175], v[108:111], v[84:87], v[172:175]
    v_accvgpr_read_b32 v4, a252
    v_accvgpr_read_b32 v5, a253
    v_mfma_f32_16x16x32_bf16 v[204:207], v[108:111], v[88:91], v[204:207]
    ds_read_b64_tr_b16 v[68:69], v28 offset:128
    ds_read_b64_tr_b16 v[70:71], v28 offset:1152
    v_mfma_f32_16x16x32_bf16 v[236:239], v[108:111], v[92:95], v[236:239]
    buffer_load_dwordx4 v19, s[24:27], s36 offen offset:2048 lds
    v_mfma_f32_16x16x32_bf16 v[144:147], v[112:115], v[80:83], v[144:147]
    ds_read_b64_tr_b16 v[72:73], v29 offset:128
    ds_read_b64_tr_b16 v[74:75], v29 offset:1152
    v_mfma_f32_16x16x32_bf16 v[176:179], v[112:115], v[84:87], v[176:179]
    v_accvgpr_read_b32 v6, a254
    v_accvgpr_read_b32 v7, a255
    v_mfma_f32_16x16x32_bf16 v[208:211], v[112:115], v[88:91], v[208:211]
    ds_read_b64_tr_b16 v[76:77], v30 offset:128
    ds_read_b64_tr_b16 v[78:79], v30 offset:1152
    v_mfma_f32_16x16x32_bf16 v[240:243], v[112:115], v[92:95], v[240:243]
    v_accvgpr_read_b32 v0, a248
    v_accvgpr_read_b32 v1, a249
    v_mfma_f32_16x16x32_bf16 v[148:151], v[116:119], v[80:83], v[148:151]
    v_accvgpr_read_b32 v2, a250
    v_accvgpr_read_b32 v3, a251
    v_mfma_f32_16x16x32_bf16 v[180:183], v[116:119], v[84:87], v[180:183]
    buffer_load_dwordx4 v20, s[24:27], s36 offen offset:3072 lds
    v_mfma_f32_16x16x32_bf16 v[212:215], v[116:119], v[88:91], v[212:215]
    s_add_u32 s37, s49, 5767168
    v_cvt_pk_bf16_f32 v0, v0, v1
    v_cvt_pk_bf16_f32 v1, v2, v3
    v_mfma_f32_16x16x32_bf16 v[244:247], v[116:119], v[92:95], v[244:247]
gated_mix__ssm_conv_h3__compressed_kv_cla__prompt_kernel_pad6:
    s_cbranch_execz gated_mix__ssm_conv_h3__compressed_kv_cla__prompt_kernel_pad10
    s_add_u32 m0, s50, 34816
    v_cvt_pk_bf16_f32 v2, v4, v5
    v_cvt_pk_bf16_f32 v3, v6, v7
    v_mfma_f32_16x16x32_bf16 v[152:155], v[120:123], v[80:83], v[152:155]
    buffer_load_dwordx4 v21, s[20:23], s37 offen offset:0 lds
    v_mfma_f32_16x16x32_bf16 v[184:187], v[120:123], v[84:87], v[184:187]
    v_accvgpr_read_b32 v12, a124
    v_accvgpr_read_b32 v13, a125
    v_mfma_f32_16x16x32_bf16 v[216:219], v[120:123], v[88:91], v[216:219]
    v_accvgpr_read_b32 v14, a126
    v_accvgpr_read_b32 v15, a127
    v_mfma_f32_16x16x32_bf16 v[248:251], v[120:123], v[92:95], v[248:251]
    buffer_store_dwordx4 v[0:3], v16, s[16:19], s38 offen offset:3072
    v_mfma_f32_16x16x32_bf16 v[156:159], v[124:127], v[80:83], v[156:159]
    s_add_u32 s38, s38, 16384
    v_accvgpr_read_b32 v8, a92
    v_accvgpr_read_b32 v9, a93
    v_mfma_f32_16x16x32_bf16 v[188:191], v[124:127], v[84:87], v[188:191]
    v_accvgpr_read_b32 v10, a94
    v_accvgpr_read_b32 v11, a95
    v_mfma_f32_16x16x32_bf16 v[220:223], v[124:127], v[88:91], v[220:223]
    buffer_load_dwordx4 v22, s[20:23], s37 offen offset:1024 lds
    v_mfma_f32_16x16x32_bf16 v[252:255], v[124:127], v[92:95], v[252:255]
    s_waitcnt lgkmcnt(0)
    v_mul_f32 v8, s40, v8
    v_mul_f32 v9, s40, v9
    v_mfma_f32_16x16x32_bf16 v[128:131], v[48:51], v[32:35], v[128:131]
    ds_read_b64_tr_b16 v[96:97], v27 offset:8704
    ds_read_b64_tr_b16 v[98:99], v27 offset:9728
    v_mfma_f32_16x16x32_bf16 v[160:163], v[48:51], v[36:39], v[160:163]
    s_add_u32 s36, s45, 1408
    v_mul_f32 v10, s40, v10
    v_mul_f32 v11, s40, v11
    v_mfma_f32_16x16x32_bf16 v[192:195], v[48:51], v[40:43], v[192:195]
    s_add_u32 m0, s42, 36864
    ds_read_b128 v[80:83], v26 offset:0
    ds_read_b128 v[84:87], v26 offset:2048
    v_mfma_f32_16x16x32_bf16 v[224:227], v[48:51], v[44:47], v[224:227]
    buffer_load_dwordx4 v17, s[24:27], s36 offen offset:0 lds
    v_mfma_f32_16x16x32_bf16 v[132:135], v[52:55], v[32:35], v[132:135]
    ds_read_b128 v[88:91], v26 offset:4096
    ds_read_b128 v[92:95], v26 offset:6144
    v_mfma_f32_16x16x32_bf16 v[164:167], v[52:55], v[36:39], v[164:167]
    v_mul_f32 v12, s40, v12
    v_mul_f32 v13, s40, v13
    v_mfma_f32_16x16x32_bf16 v[196:199], v[52:55], v[40:43], v[196:199]
    ds_read_b64_tr_b16 v[100:101], v28 offset:8704
    ds_read_b64_tr_b16 v[102:103], v28 offset:9728
    v_mfma_f32_16x16x32_bf16 v[228:231], v[52:55], v[44:47], v[228:231]
    buffer_load_dwordx4 v18, s[24:27], s36 offen offset:1024 lds
    v_mfma_f32_16x16x32_bf16 v[136:139], v[56:59], v[32:35], v[136:139]
    ds_read_b64_tr_b16 v[104:105], v29 offset:8704
    ds_read_b64_tr_b16 v[106:107], v29 offset:9728
    v_mfma_f32_16x16x32_bf16 v[168:171], v[56:59], v[36:39], v[168:171]
    v_mul_f32 v14, s40, v14
    v_mul_f32 v15, s40, v15
    v_mfma_f32_16x16x32_bf16 v[200:203], v[56:59], v[40:43], v[200:203]
    ds_read_b64_tr_b16 v[108:109], v30 offset:8704
    ds_read_b64_tr_b16 v[110:111], v30 offset:9728
    v_mfma_f32_16x16x32_bf16 v[232:235], v[56:59], v[44:47], v[232:235]
    v_mfma_f32_16x16x32_bf16 v[140:143], v[60:63], v[32:35], v[140:143]
    ds_read_b64_tr_b16 v[112:113], v27 offset:8832
    ds_read_b64_tr_b16 v[114:115], v27 offset:9856
    v_mfma_f32_16x16x32_bf16 v[172:175], v[60:63], v[36:39], v[172:175]
    v_cvt_pk_bf16_f32 v8, v8, v9
    v_cvt_pk_bf16_f32 v9, v10, v11
    v_mfma_f32_16x16x32_bf16 v[204:207], v[60:63], v[40:43], v[204:207]
    ds_read_b64_tr_b16 v[116:117], v28 offset:8832
    ds_read_b64_tr_b16 v[118:119], v28 offset:9856
    v_mfma_f32_16x16x32_bf16 v[236:239], v[60:63], v[44:47], v[236:239]
    buffer_load_dwordx4 v19, s[24:27], s36 offen offset:2048 lds
    v_mfma_f32_16x16x32_bf16 v[144:147], v[64:67], v[32:35], v[144:147]
    ds_read_b64_tr_b16 v[120:121], v29 offset:8832
    ds_read_b64_tr_b16 v[122:123], v29 offset:9856
    v_mfma_f32_16x16x32_bf16 v[176:179], v[64:67], v[36:39], v[176:179]
    v_cvt_pk_bf16_f32 v10, v12, v13
    v_cvt_pk_bf16_f32 v11, v14, v15
    v_mfma_f32_16x16x32_bf16 v[208:211], v[64:67], v[40:43], v[208:211]
    ds_read_b64_tr_b16 v[124:125], v30 offset:8832
    ds_read_b64_tr_b16 v[126:127], v30 offset:9856
    v_mfma_f32_16x16x32_bf16 v[240:243], v[64:67], v[44:47], v[240:243]
    v_mfma_f32_16x16x32_bf16 v[148:151], v[68:71], v[32:35], v[148:151]
    v_mfma_f32_16x16x32_bf16 v[180:183], v[68:71], v[36:39], v[180:183]
    buffer_load_dwordx4 v20, s[24:27], s36 offen offset:3072 lds
    v_mfma_f32_16x16x32_bf16 v[212:215], v[68:71], v[40:43], v[212:215]
    s_add_u32 s37, s49, 6029312
    v_mfma_f32_16x16x32_bf16 v[244:247], v[68:71], v[44:47], v[244:247]
    s_add_u32 m0, s50, 43520
    v_mfma_f32_16x16x32_bf16 v[152:155], v[72:75], v[32:35], v[152:155]
    buffer_load_dwordx4 v21, s[20:23], s37 offen offset:0 lds
    v_mfma_f32_16x16x32_bf16 v[184:187], v[72:75], v[36:39], v[184:187]
    v_mfma_f32_16x16x32_bf16 v[216:219], v[72:75], v[40:43], v[216:219]
    v_mfma_f32_16x16x32_bf16 v[248:251], v[72:75], v[44:47], v[248:251]
    buffer_store_dwordx4 v[8:11], v16, s[16:19], s41 offen offset:1024
    v_mfma_f32_16x16x32_bf16 v[156:159], v[76:79], v[32:35], v[156:159]
    s_add_u32 s41, s41, 12288
    v_mfma_f32_16x16x32_bf16 v[188:191], v[76:79], v[36:39], v[188:191]
    v_mov_b32 v1, 1
    v_mov_b32 v0, 0
    v_mfma_f32_16x16x32_bf16 v[220:223], v[76:79], v[40:43], v[220:223]
    buffer_load_dwordx4 v22, s[20:23], s37 offen offset:1024 lds
    v_mfma_f32_16x16x32_bf16 v[252:255], v[76:79], v[44:47], v[252:255]
    s_waitcnt vmcnt(15) lgkmcnt(0)
    s_barrier
    v_bfe_u32 v3, v16, 1, 8
    v_mfma_f32_16x16x32_bf16 v[128:131], v[96:99], v[80:83], v[128:131]
    s_and_b32 s40, s3, 4294967264
    ds_read_b64_tr_b16 v[48:49], v27 offset:17408
    ds_read_b64_tr_b16 v[50:51], v27 offset:18432
    v_mfma_f32_16x16x32_bf16 v[160:163], v[96:99], v[84:87], v[160:163]
    s_add_u32 s36, s44, 1536
    v_mov_b32 v10, 0x0f0f0f0f
    v_mov_b32 v4, 0
    v_mfma_f32_16x16x32_bf16 v[192:195], v[96:99], v[88:91], v[192:195]
    s_add_u32 m0, s42, 65536
    ds_read_b128 v[32:35], v23 offset:0
    ds_read_b128 v[36:39], v23 offset:2048
    v_mfma_f32_16x16x32_bf16 v[224:227], v[96:99], v[92:95], v[224:227]
    buffer_load_dwordx4 v17, s[24:27], s36 offen offset:0 lds
    v_mfma_f32_16x16x32_bf16 v[132:135], v[100:103], v[80:83], v[132:135]
    ds_read_b128 v[40:43], v23 offset:4096
    ds_read_b128 v[44:47], v23 offset:6144
    v_mfma_f32_16x16x32_bf16 v[164:167], v[100:103], v[84:87], v[164:167]
    v_mov_b32 v5, 0
    v_mov_b32 v6, 0
    v_mfma_f32_16x16x32_bf16 v[196:199], v[100:103], v[88:91], v[196:199]
    ds_read_b64_tr_b16 v[52:53], v28 offset:17408
    ds_read_b64_tr_b16 v[54:55], v28 offset:18432
    v_mfma_f32_16x16x32_bf16 v[228:231], v[100:103], v[92:95], v[228:231]
    buffer_load_dwordx4 v18, s[24:27], s36 offen offset:1024 lds
    v_mfma_f32_16x16x32_bf16 v[136:139], v[104:107], v[80:83], v[136:139]
    ds_read_b64_tr_b16 v[56:57], v29 offset:17408
    ds_read_b64_tr_b16 v[58:59], v29 offset:18432
    v_mfma_f32_16x16x32_bf16 v[168:171], v[104:107], v[84:87], v[168:171]
    v_mov_b32 v7, 0
    v_mov_b32 v8, 153600
    v_mfma_f32_16x16x32_bf16 v[200:203], v[104:107], v[88:91], v[200:203]
    ds_read_b64_tr_b16 v[60:61], v30 offset:17408
    ds_read_b64_tr_b16 v[62:63], v30 offset:18432
    v_mfma_f32_16x16x32_bf16 v[232:235], v[104:107], v[92:95], v[232:235]
    buffer_load_dword v9, v3, s[76:79], 0 offen sc1
    v_mfma_f32_16x16x32_bf16 v[140:143], v[108:111], v[80:83], v[140:143]
    ds_read_b64_tr_b16 v[64:65], v27 offset:17536
    ds_read_b64_tr_b16 v[66:67], v27 offset:18560
    v_mfma_f32_16x16x32_bf16 v[172:175], v[108:111], v[84:87], v[172:175]
    ds_write_b128 v8, v[4:7]
    ds_read_b128 a[0:3], v8
    v_mfma_f32_16x16x32_bf16 v[204:207], v[108:111], v[88:91], v[204:207]
    ds_read_b64_tr_b16 v[68:69], v28 offset:17536
    ds_read_b64_tr_b16 v[70:71], v28 offset:18560
    v_mfma_f32_16x16x32_bf16 v[236:239], v[108:111], v[92:95], v[236:239]
    buffer_load_dwordx4 v19, s[24:27], s36 offen offset:2048 lds
    v_mfma_f32_16x16x32_bf16 v[144:147], v[112:115], v[80:83], v[144:147]
    ds_read_b64_tr_b16 v[72:73], v29 offset:17536
    ds_read_b64_tr_b16 v[74:75], v29 offset:18560
    v_mfma_f32_16x16x32_bf16 v[176:179], v[112:115], v[84:87], v[176:179]
    ds_read_b128 a[4:7], v8
    ds_read_b128 a[8:11], v8
    v_mfma_f32_16x16x32_bf16 v[208:211], v[112:115], v[88:91], v[208:211]
    ds_read_b64_tr_b16 v[76:77], v30 offset:17536
    ds_read_b64_tr_b16 v[78:79], v30 offset:18560
    v_mfma_f32_16x16x32_bf16 v[240:243], v[112:115], v[92:95], v[240:243]
    ds_read_b128 a[12:15], v8
    ds_read_b128 a[16:19], v8
    v_mfma_f32_16x16x32_bf16 v[148:151], v[116:119], v[80:83], v[148:151]
    ds_read_b128 a[20:23], v8
    ds_read_b128 a[24:27], v8
    v_mfma_f32_16x16x32_bf16 v[180:183], v[116:119], v[84:87], v[180:183]
    buffer_load_dwordx4 v20, s[24:27], s36 offen offset:3072 lds
    v_mfma_f32_16x16x32_bf16 v[212:215], v[116:119], v[88:91], v[212:215]
    s_add_u32 s37, s49, 6291456
    ds_read_b128 a[28:31], v8
    ds_read_b128 a[32:35], v8
    v_mfma_f32_16x16x32_bf16 v[244:247], v[116:119], v[92:95], v[244:247]
    s_add_u32 m0, s50, 0
    ds_read_b128 a[36:39], v8
    ds_read_b128 a[40:43], v8
    v_mfma_f32_16x16x32_bf16 v[152:155], v[120:123], v[80:83], v[152:155]
    buffer_load_dwordx4 v21, s[20:23], s37 offen offset:0 lds
    v_mfma_f32_16x16x32_bf16 v[184:187], v[120:123], v[84:87], v[184:187]
    ds_read_b128 a[44:47], v8
    ds_read_b128 a[48:51], v8
    v_mfma_f32_16x16x32_bf16 v[216:219], v[120:123], v[88:91], v[216:219]
    ds_read_b128 a[52:55], v8
    ds_read_b128 a[56:59], v8
    v_mfma_f32_16x16x32_bf16 v[248:251], v[120:123], v[92:95], v[248:251]
    v_mfma_f32_16x16x32_bf16 v[156:159], v[124:127], v[80:83], v[156:159]
    v_mfma_f32_16x16x32_bf16 v[188:191], v[124:127], v[84:87], v[188:191]
    v_mfma_f32_16x16x32_bf16 v[220:223], v[124:127], v[88:91], v[220:223]
    buffer_load_dwordx4 v22, s[20:23], s37 offen offset:1024 lds
    v_mfma_f32_16x16x32_bf16 v[252:255], v[124:127], v[92:95], v[252:255]
    s_waitcnt lgkmcnt(0)
    v_mfma_f32_16x16x32_bf16 v[128:131], v[48:51], v[32:35], v[128:131]
    s_getreg_b32 s58, hwreg(HW_REG_XCC_ID, 0, 3)
    ds_read_b64_tr_b16 v[96:97], v27 offset:26112
    ds_read_b64_tr_b16 v[98:99], v27 offset:27136
    v_mfma_f32_16x16x32_bf16 v[160:163], v[48:51], v[36:39], v[160:163]
    s_add_u32 s36, s45, 1536
    ds_read_b128 a[60:63], v8
    ds_read_b128 a[64:67], v8
    v_mfma_f32_16x16x32_bf16 v[192:195], v[48:51], v[40:43], v[192:195]
    s_add_u32 m0, s42, 69632
    ds_read_b128 v[80:83], v24 offset:0
    ds_read_b128 v[84:87], v24 offset:2048
    v_mfma_f32_16x16x32_bf16 v[224:227], v[48:51], v[44:47], v[224:227]
    buffer_load_dwordx4 v17, s[24:27], s36 offen offset:0 lds
    v_mfma_f32_16x16x32_bf16 v[132:135], v[52:55], v[32:35], v[132:135]
    s_lshl_b32 s58, s58, 2
    ds_read_b128 v[88:91], v24 offset:4096
    ds_read_b128 v[92:95], v24 offset:6144
    v_mfma_f32_16x16x32_bf16 v[164:167], v[52:55], v[36:39], v[164:167]
    s_lshl_b32 s58, 8, s58
    ds_read_b128 a[68:71], v8
    ds_read_b128 a[72:75], v8
    v_mfma_f32_16x16x32_bf16 v[196:199], v[52:55], v[40:43], v[196:199]
    ds_read_b64_tr_b16 v[100:101], v28 offset:26112
    ds_read_b64_tr_b16 v[102:103], v28 offset:27136
    v_mfma_f32_16x16x32_bf16 v[228:231], v[52:55], v[44:47], v[228:231]
    buffer_load_dwordx4 v18, s[24:27], s36 offen offset:1024 lds
    v_mfma_f32_16x16x32_bf16 v[136:139], v[56:59], v[32:35], v[136:139]
    ds_read_b64_tr_b16 v[104:105], v29 offset:26112
    ds_read_b64_tr_b16 v[106:107], v29 offset:27136
    v_mfma_f32_16x16x32_bf16 v[168:171], v[56:59], v[36:39], v[168:171]
    ds_read_b128 a[76:79], v8
    ds_read_b128 a[80:83], v8
    v_mfma_f32_16x16x32_bf16 v[200:203], v[56:59], v[40:43], v[200:203]
    ds_read_b64_tr_b16 v[108:109], v30 offset:26112
    ds_read_b64_tr_b16 v[110:111], v30 offset:27136
    v_mfma_f32_16x16x32_bf16 v[232:235], v[56:59], v[44:47], v[232:235]
    v_mfma_f32_16x16x32_bf16 v[140:143], v[60:63], v[32:35], v[140:143]
    ds_read_b64_tr_b16 v[112:113], v27 offset:26240
    ds_read_b64_tr_b16 v[114:115], v27 offset:27264
    v_mfma_f32_16x16x32_bf16 v[172:175], v[60:63], v[36:39], v[172:175]
    ds_read_b128 a[84:87], v8
    ds_read_b128 a[88:91], v8
    v_mfma_f32_16x16x32_bf16 v[204:207], v[60:63], v[40:43], v[204:207]
    ds_read_b64_tr_b16 v[116:117], v28 offset:26240
    ds_read_b64_tr_b16 v[118:119], v28 offset:27264
    v_mfma_f32_16x16x32_bf16 v[236:239], v[60:63], v[44:47], v[236:239]
    buffer_load_dwordx4 v19, s[24:27], s36 offen offset:2048 lds
    v_mfma_f32_16x16x32_bf16 v[144:147], v[64:67], v[32:35], v[144:147]
    ds_read_b64_tr_b16 v[120:121], v29 offset:26240
    ds_read_b64_tr_b16 v[122:123], v29 offset:27264
    v_mfma_f32_16x16x32_bf16 v[176:179], v[64:67], v[36:39], v[176:179]
    ds_read_b128 a[92:95], v8
    ds_read_b128 a[96:99], v8
    v_mfma_f32_16x16x32_bf16 v[208:211], v[64:67], v[40:43], v[208:211]
    ds_read_b64_tr_b16 v[124:125], v30 offset:26240
    ds_read_b64_tr_b16 v[126:127], v30 offset:27264
    v_mfma_f32_16x16x32_bf16 v[240:243], v[64:67], v[44:47], v[240:243]
    ds_read_b128 a[100:103], v8
    ds_read_b128 a[104:107], v8
    v_mfma_f32_16x16x32_bf16 v[148:151], v[68:71], v[32:35], v[148:151]
    ds_read_b128 a[108:111], v8
    ds_read_b128 a[112:115], v8
    v_mfma_f32_16x16x32_bf16 v[180:183], v[68:71], v[36:39], v[180:183]
    buffer_load_dwordx4 v20, s[24:27], s36 offen offset:3072 lds
    v_mfma_f32_16x16x32_bf16 v[212:215], v[68:71], v[40:43], v[212:215]
    s_add_u32 s37, s49, 6553600
    ds_read_b128 a[116:119], v8
    ds_read_b128 a[120:123], v8
    v_mfma_f32_16x16x32_bf16 v[244:247], v[68:71], v[44:47], v[244:247]
    s_add_u32 m0, s50, 8704
    ds_read_b128 a[124:127], v8
    v_mfma_f32_16x16x32_bf16 v[152:155], v[72:75], v[32:35], v[152:155]
    buffer_load_dwordx4 v21, s[20:23], s37 offen offset:0 lds
    v_mfma_f32_16x16x32_bf16 v[184:187], v[72:75], v[36:39], v[184:187]
    v_mfma_f32_16x16x32_bf16 v[216:219], v[72:75], v[40:43], v[216:219]
    v_mfma_f32_16x16x32_bf16 v[248:251], v[72:75], v[44:47], v[248:251]
    v_mfma_f32_16x16x32_bf16 v[156:159], v[76:79], v[32:35], v[156:159]
    v_mfma_f32_16x16x32_bf16 v[188:191], v[76:79], v[36:39], v[188:191]
    v_mfma_f32_16x16x32_bf16 v[220:223], v[76:79], v[40:43], v[220:223]
    buffer_load_dwordx4 v22, s[20:23], s37 offen offset:1024 lds
    v_mfma_f32_16x16x32_bf16 v[252:255], v[76:79], v[44:47], v[252:255]
    s_waitcnt vmcnt(10) lgkmcnt(0)
    s_barrier
    v_readlane_b32 s54, v9, s33
    v_and_b32 v11, v10, v9
    v_mfma_f32_16x16x32_bf16 v[128:131], v[96:99], v[80:83], v[128:131]
    ds_read_b64_tr_b16 v[48:49], v27 offset:34816
    ds_read_b64_tr_b16 v[50:51], v27 offset:35840
    v_mfma_f32_16x16x32_bf16 v[160:163], v[96:99], v[84:87], v[160:163]
    s_add_u32 s36, s44, 1664
    v_lshrrev_b32 v12, 4, v9
    v_and_b32 v12, v10, v12
    v_mfma_f32_16x16x32_bf16 v[192:195], v[96:99], v[88:91], v[192:195]
    s_add_u32 m0, s42, 0
    ds_read_b128 v[32:35], v23 offset:32768
    ds_read_b128 v[36:39], v23 offset:34816
    v_mfma_f32_16x16x32_bf16 v[224:227], v[96:99], v[92:95], v[224:227]
    buffer_load_dwordx4 v17, s[24:27], s36 offen offset:0 lds
    v_mfma_f32_16x16x32_bf16 v[132:135], v[100:103], v[80:83], v[132:135]
    ds_read_b128 v[40:43], v23 offset:36864
    ds_read_b128 v[44:47], v23 offset:38912
    v_mfma_f32_16x16x32_bf16 v[164:167], v[100:103], v[84:87], v[164:167]
    v_sad_u8 v11, v11, 0, 0
    v_sad_u8 v11, v12, 0, v11
    v_mfma_f32_16x16x32_bf16 v[196:199], v[100:103], v[88:91], v[196:199]
    ds_read_b64_tr_b16 v[52:53], v28 offset:34816
    ds_read_b64_tr_b16 v[54:55], v28 offset:35840
    v_mfma_f32_16x16x32_bf16 v[228:231], v[100:103], v[92:95], v[228:231]
    buffer_load_dwordx4 v18, s[24:27], s36 offen offset:1024 lds
    v_mfma_f32_16x16x32_bf16 v[136:139], v[104:107], v[80:83], v[136:139]
    ds_read_b64_tr_b16 v[56:57], v29 offset:34816
    ds_read_b64_tr_b16 v[58:59], v29 offset:35840
    v_mfma_f32_16x16x32_bf16 v[168:171], v[104:107], v[84:87], v[168:171]
    v_cmp_ne_u32 vcc, 8, v11
    v_bfe_u32 v3, v16, 2, 5
    v_mfma_f32_16x16x32_bf16 v[200:203], v[104:107], v[88:91], v[200:203]
    ds_read_b64_tr_b16 v[60:61], v30 offset:34816
    ds_read_b64_tr_b16 v[62:63], v30 offset:35840
    v_mfma_f32_16x16x32_bf16 v[232:235], v[104:107], v[92:95], v[232:235]
    v_mfma_f32_16x16x32_bf16 v[140:143], v[108:111], v[80:83], v[140:143]
    s_cbranch_vccnz gated_mix__ssm_conv_h3__compressed_kv_cla__prompt_kernel_wb
    ds_read_b64_tr_b16 v[64:65], v27 offset:34944
    ds_read_b64_tr_b16 v[66:67], v27 offset:35968
    v_mfma_f32_16x16x32_bf16 v[172:175], v[108:111], v[84:87], v[172:175]
    s_cmp_lg_u32 s54, s58
    s_cbranch_scc1 gated_mix__ssm_conv_h3__compressed_kv_cla__prompt_kernel_wb
gated_mix__ssm_conv_h3__compressed_kv_cla__prompt_kernel_wb_ret:
    v_mfma_f32_16x16x32_bf16 v[204:207], v[108:111], v[88:91], v[204:207]
    ds_read_b64_tr_b16 v[68:69], v28 offset:34944
    ds_read_b64_tr_b16 v[70:71], v28 offset:35968
    v_mfma_f32_16x16x32_bf16 v[236:239], v[108:111], v[92:95], v[236:239]
    buffer_load_dwordx4 v19, s[24:27], s36 offen offset:2048 lds
    v_mfma_f32_16x16x32_bf16 v[144:147], v[112:115], v[80:83], v[144:147]
    ds_read_b64_tr_b16 v[72:73], v29 offset:34944
    ds_read_b64_tr_b16 v[74:75], v29 offset:35968
    v_mfma_f32_16x16x32_bf16 v[176:179], v[112:115], v[84:87], v[176:179]
    v_mfma_f32_16x16x32_bf16 v[208:211], v[112:115], v[88:91], v[208:211]
    ds_read_b64_tr_b16 v[76:77], v30 offset:34944
    ds_read_b64_tr_b16 v[78:79], v30 offset:35968
    v_mfma_f32_16x16x32_bf16 v[240:243], v[112:115], v[92:95], v[240:243]
    v_mfma_f32_16x16x32_bf16 v[148:151], v[116:119], v[80:83], v[148:151]
    v_mfma_f32_16x16x32_bf16 v[180:183], v[116:119], v[84:87], v[180:183]
    buffer_load_dwordx4 v20, s[24:27], s36 offen offset:3072 lds
    v_mfma_f32_16x16x32_bf16 v[212:215], v[116:119], v[88:91], v[212:215]
    s_add_u32 s37, s49, 6815744
    v_mfma_f32_16x16x32_bf16 v[244:247], v[116:119], v[92:95], v[244:247]
    s_add_u32 m0, s50, 17408
    v_mfma_f32_16x16x32_bf16 v[152:155], v[120:123], v[80:83], v[152:155]
    buffer_load_dwordx4 v21, s[20:23], s37 offen offset:0 lds
    v_mfma_f32_16x16x32_bf16 v[184:187], v[120:123], v[84:87], v[184:187]
    v_mfma_f32_16x16x32_bf16 v[216:219], v[120:123], v[88:91], v[216:219]
    v_mfma_f32_16x16x32_bf16 v[248:251], v[120:123], v[92:95], v[248:251]
    buffer_store_dword v1, v0, s[28:31], s3 offen sc1
    v_mfma_f32_16x16x32_bf16 v[156:159], v[124:127], v[80:83], v[156:159]
    v_mfma_f32_16x16x32_bf16 v[188:191], v[124:127], v[84:87], v[188:191]
    v_mfma_f32_16x16x32_bf16 v[220:223], v[124:127], v[88:91], v[220:223]
    buffer_load_dwordx4 v22, s[20:23], s37 offen offset:1024 lds
    v_mfma_f32_16x16x32_bf16 v[252:255], v[124:127], v[92:95], v[252:255]
    s_waitcnt lgkmcnt(0)
    v_mfma_f32_16x16x32_bf16 v[128:131], v[48:51], v[32:35], v[128:131]
    ds_read_b64_tr_b16 v[96:97], v27 offset:43520
    ds_read_b64_tr_b16 v[98:99], v27 offset:44544
    v_mfma_f32_16x16x32_bf16 v[160:163], v[48:51], v[36:39], v[160:163]
    s_add_u32 s36, s45, 1664
    v_mfma_f32_16x16x32_bf16 v[192:195], v[48:51], v[40:43], v[192:195]
    s_add_u32 m0, s42, 4096
    ds_read_b128 v[80:83], v24 offset:32768
    ds_read_b128 v[84:87], v24 offset:34816
    v_mfma_f32_16x16x32_bf16 v[224:227], v[48:51], v[44:47], v[224:227]
    buffer_load_dwordx4 v17, s[24:27], s36 offen offset:0 lds
    v_mfma_f32_16x16x32_bf16 v[132:135], v[52:55], v[32:35], v[132:135]
    ds_read_b128 v[88:91], v24 offset:36864
    ds_read_b128 v[92:95], v24 offset:38912
    v_mfma_f32_16x16x32_bf16 v[164:167], v[52:55], v[36:39], v[164:167]
    v_mfma_f32_16x16x32_bf16 v[196:199], v[52:55], v[40:43], v[196:199]
    ds_read_b64_tr_b16 v[100:101], v28 offset:43520
    ds_read_b64_tr_b16 v[102:103], v28 offset:44544
    v_mfma_f32_16x16x32_bf16 v[228:231], v[52:55], v[44:47], v[228:231]
    buffer_load_dwordx4 v18, s[24:27], s36 offen offset:1024 lds
    v_mfma_f32_16x16x32_bf16 v[136:139], v[56:59], v[32:35], v[136:139]
    ds_read_b64_tr_b16 v[104:105], v29 offset:43520
    ds_read_b64_tr_b16 v[106:107], v29 offset:44544
    v_mfma_f32_16x16x32_bf16 v[168:171], v[56:59], v[36:39], v[168:171]
    v_mfma_f32_16x16x32_bf16 v[200:203], v[56:59], v[40:43], v[200:203]
    ds_read_b64_tr_b16 v[108:109], v30 offset:43520
    ds_read_b64_tr_b16 v[110:111], v30 offset:44544
    v_mfma_f32_16x16x32_bf16 v[232:235], v[56:59], v[44:47], v[232:235]
    v_mfma_f32_16x16x32_bf16 v[140:143], v[60:63], v[32:35], v[140:143]
    ds_read_b64_tr_b16 v[112:113], v27 offset:43648
    ds_read_b64_tr_b16 v[114:115], v27 offset:44672
    v_mfma_f32_16x16x32_bf16 v[172:175], v[60:63], v[36:39], v[172:175]
    v_mfma_f32_16x16x32_bf16 v[204:207], v[60:63], v[40:43], v[204:207]
    ds_read_b64_tr_b16 v[116:117], v28 offset:43648
    ds_read_b64_tr_b16 v[118:119], v28 offset:44672
    v_mfma_f32_16x16x32_bf16 v[236:239], v[60:63], v[44:47], v[236:239]
    buffer_load_dwordx4 v19, s[24:27], s36 offen offset:2048 lds
    v_mfma_f32_16x16x32_bf16 v[144:147], v[64:67], v[32:35], v[144:147]
    ds_read_b64_tr_b16 v[120:121], v29 offset:43648
    ds_read_b64_tr_b16 v[122:123], v29 offset:44672
    v_mfma_f32_16x16x32_bf16 v[176:179], v[64:67], v[36:39], v[176:179]
    v_mfma_f32_16x16x32_bf16 v[208:211], v[64:67], v[40:43], v[208:211]
    ds_read_b64_tr_b16 v[124:125], v30 offset:43648
    ds_read_b64_tr_b16 v[126:127], v30 offset:44672
    v_mfma_f32_16x16x32_bf16 v[240:243], v[64:67], v[44:47], v[240:243]
    v_mfma_f32_16x16x32_bf16 v[148:151], v[68:71], v[32:35], v[148:151]
    v_mfma_f32_16x16x32_bf16 v[180:183], v[68:71], v[36:39], v[180:183]
    buffer_load_dwordx4 v20, s[24:27], s36 offen offset:3072 lds
    v_mfma_f32_16x16x32_bf16 v[212:215], v[68:71], v[40:43], v[212:215]
    s_add_u32 s37, s49, 7077888
    v_mfma_f32_16x16x32_bf16 v[244:247], v[68:71], v[44:47], v[244:247]
    s_add_u32 m0, s50, 26112
    v_mfma_f32_16x16x32_bf16 v[152:155], v[72:75], v[32:35], v[152:155]
    buffer_load_dwordx4 v21, s[20:23], s37 offen offset:0 lds
    v_mfma_f32_16x16x32_bf16 v[184:187], v[72:75], v[36:39], v[184:187]
    v_mfma_f32_16x16x32_bf16 v[216:219], v[72:75], v[40:43], v[216:219]
    v_mfma_f32_16x16x32_bf16 v[248:251], v[72:75], v[44:47], v[248:251]
    v_mfma_f32_16x16x32_bf16 v[156:159], v[76:79], v[32:35], v[156:159]
    v_mfma_f32_16x16x32_bf16 v[188:191], v[76:79], v[36:39], v[188:191]
    v_mfma_f32_16x16x32_bf16 v[220:223], v[76:79], v[40:43], v[220:223]
    buffer_load_dwordx4 v22, s[20:23], s37 offen offset:1024 lds
    v_mfma_f32_16x16x32_bf16 v[252:255], v[76:79], v[44:47], v[252:255]
    s_waitcnt vmcnt(13) lgkmcnt(0)
    s_barrier
    v_mfma_f32_16x16x32_bf16 v[128:131], v[96:99], v[80:83], v[128:131]
    ds_read_b64_tr_b16 v[48:49], v27 offset:0
    ds_read_b64_tr_b16 v[50:51], v27 offset:1024
    v_mfma_f32_16x16x32_bf16 v[160:163], v[96:99], v[84:87], v[160:163]
    s_add_u32 s36, s44, 1792
    v_mfma_f32_16x16x32_bf16 v[192:195], v[96:99], v[88:91], v[192:195]
    s_add_u32 m0, s42, 32768
    ds_read_b128 v[32:35], v25 offset:0
    ds_read_b128 v[36:39], v25 offset:2048
    v_mfma_f32_16x16x32_bf16 v[224:227], v[96:99], v[92:95], v[224:227]
    buffer_load_dwordx4 v17, s[24:27], s36 offen offset:0 lds
    v_mfma_f32_16x16x32_bf16 v[132:135], v[100:103], v[80:83], v[132:135]
    ds_read_b128 v[40:43], v25 offset:4096
    ds_read_b128 v[44:47], v25 offset:6144
    v_mfma_f32_16x16x32_bf16 v[164:167], v[100:103], v[84:87], v[164:167]
    v_mfma_f32_16x16x32_bf16 v[196:199], v[100:103], v[88:91], v[196:199]
    ds_read_b64_tr_b16 v[52:53], v28 offset:0
    ds_read_b64_tr_b16 v[54:55], v28 offset:1024
    v_mfma_f32_16x16x32_bf16 v[228:231], v[100:103], v[92:95], v[228:231]
    buffer_load_dwordx4 v18, s[24:27], s36 offen offset:1024 lds
    v_mfma_f32_16x16x32_bf16 v[136:139], v[104:107], v[80:83], v[136:139]
    ds_read_b64_tr_b16 v[56:57], v29 offset:0
    ds_read_b64_tr_b16 v[58:59], v29 offset:1024
    v_mfma_f32_16x16x32_bf16 v[168:171], v[104:107], v[84:87], v[168:171]
    v_mfma_f32_16x16x32_bf16 v[200:203], v[104:107], v[88:91], v[200:203]
    ds_read_b64_tr_b16 v[60:61], v30 offset:0
    ds_read_b64_tr_b16 v[62:63], v30 offset:1024
    v_mfma_f32_16x16x32_bf16 v[232:235], v[104:107], v[92:95], v[232:235]
    v_mfma_f32_16x16x32_bf16 v[140:143], v[108:111], v[80:83], v[140:143]
    ds_read_b64_tr_b16 v[64:65], v27 offset:128
    ds_read_b64_tr_b16 v[66:67], v27 offset:1152
    v_mfma_f32_16x16x32_bf16 v[172:175], v[108:111], v[84:87], v[172:175]
    v_mfma_f32_16x16x32_bf16 v[204:207], v[108:111], v[88:91], v[204:207]
    ds_read_b64_tr_b16 v[68:69], v28 offset:128
    ds_read_b64_tr_b16 v[70:71], v28 offset:1152
    v_mfma_f32_16x16x32_bf16 v[236:239], v[108:111], v[92:95], v[236:239]
    buffer_load_dwordx4 v19, s[24:27], s36 offen offset:2048 lds
    v_mfma_f32_16x16x32_bf16 v[144:147], v[112:115], v[80:83], v[144:147]
    ds_read_b64_tr_b16 v[72:73], v29 offset:128
    ds_read_b64_tr_b16 v[74:75], v29 offset:1152
    v_mfma_f32_16x16x32_bf16 v[176:179], v[112:115], v[84:87], v[176:179]
    v_mfma_f32_16x16x32_bf16 v[208:211], v[112:115], v[88:91], v[208:211]
    ds_read_b64_tr_b16 v[76:77], v30 offset:128
    ds_read_b64_tr_b16 v[78:79], v30 offset:1152
    v_mfma_f32_16x16x32_bf16 v[240:243], v[112:115], v[92:95], v[240:243]
    v_mfma_f32_16x16x32_bf16 v[148:151], v[116:119], v[80:83], v[148:151]
    v_mfma_f32_16x16x32_bf16 v[180:183], v[116:119], v[84:87], v[180:183]
    buffer_load_dwordx4 v20, s[24:27], s36 offen offset:3072 lds
    v_mfma_f32_16x16x32_bf16 v[212:215], v[116:119], v[88:91], v[212:215]
    s_add_u32 s37, s49, 7340032
    v_mfma_f32_16x16x32_bf16 v[244:247], v[116:119], v[92:95], v[244:247]
    s_add_u32 m0, s50, 34816
    v_mfma_f32_16x16x32_bf16 v[152:155], v[120:123], v[80:83], v[152:155]
    buffer_load_dwordx4 v21, s[20:23], s37 offen offset:0 lds
    v_mfma_f32_16x16x32_bf16 v[184:187], v[120:123], v[84:87], v[184:187]
    v_mfma_f32_16x16x32_bf16 v[216:219], v[120:123], v[88:91], v[216:219]
    v_mfma_f32_16x16x32_bf16 v[248:251], v[120:123], v[92:95], v[248:251]
    v_mfma_f32_16x16x32_bf16 v[156:159], v[124:127], v[80:83], v[156:159]
    v_mfma_f32_16x16x32_bf16 v[188:191], v[124:127], v[84:87], v[188:191]
    v_mfma_f32_16x16x32_bf16 v[220:223], v[124:127], v[88:91], v[220:223]
    buffer_load_dwordx4 v22, s[20:23], s37 offen offset:1024 lds
    v_mfma_f32_16x16x32_bf16 v[252:255], v[124:127], v[92:95], v[252:255]
    s_waitcnt lgkmcnt(0)
    v_mfma_f32_16x16x32_bf16 v[128:131], v[48:51], v[32:35], v[128:131]
    ds_read_b64_tr_b16 v[96:97], v27 offset:8704
    ds_read_b64_tr_b16 v[98:99], v27 offset:9728
    v_mfma_f32_16x16x32_bf16 v[160:163], v[48:51], v[36:39], v[160:163]
    s_add_u32 s36, s45, 1792
    v_mfma_f32_16x16x32_bf16 v[192:195], v[48:51], v[40:43], v[192:195]
    s_add_u32 m0, s42, 36864
    ds_read_b128 v[80:83], v26 offset:0
    ds_read_b128 v[84:87], v26 offset:2048
    v_mfma_f32_16x16x32_bf16 v[224:227], v[48:51], v[44:47], v[224:227]
    buffer_load_dwordx4 v17, s[24:27], s36 offen offset:0 lds
    v_mfma_f32_16x16x32_bf16 v[132:135], v[52:55], v[32:35], v[132:135]
    ds_read_b128 v[88:91], v26 offset:4096
    ds_read_b128 v[92:95], v26 offset:6144
    v_mfma_f32_16x16x32_bf16 v[164:167], v[52:55], v[36:39], v[164:167]
    v_mfma_f32_16x16x32_bf16 v[196:199], v[52:55], v[40:43], v[196:199]
    ds_read_b64_tr_b16 v[100:101], v28 offset:8704
    ds_read_b64_tr_b16 v[102:103], v28 offset:9728
    v_mfma_f32_16x16x32_bf16 v[228:231], v[52:55], v[44:47], v[228:231]
    buffer_load_dwordx4 v18, s[24:27], s36 offen offset:1024 lds
    v_mfma_f32_16x16x32_bf16 v[136:139], v[56:59], v[32:35], v[136:139]
    ds_read_b64_tr_b16 v[104:105], v29 offset:8704
    ds_read_b64_tr_b16 v[106:107], v29 offset:9728
    v_mfma_f32_16x16x32_bf16 v[168:171], v[56:59], v[36:39], v[168:171]
    v_mfma_f32_16x16x32_bf16 v[200:203], v[56:59], v[40:43], v[200:203]
    ds_read_b64_tr_b16 v[108:109], v30 offset:8704
    ds_read_b64_tr_b16 v[110:111], v30 offset:9728
    v_mfma_f32_16x16x32_bf16 v[232:235], v[56:59], v[44:47], v[232:235]
    v_mfma_f32_16x16x32_bf16 v[140:143], v[60:63], v[32:35], v[140:143]
    ds_read_b64_tr_b16 v[112:113], v27 offset:8832
    ds_read_b64_tr_b16 v[114:115], v27 offset:9856
    v_mfma_f32_16x16x32_bf16 v[172:175], v[60:63], v[36:39], v[172:175]
    v_mfma_f32_16x16x32_bf16 v[204:207], v[60:63], v[40:43], v[204:207]
    ds_read_b64_tr_b16 v[116:117], v28 offset:8832
    ds_read_b64_tr_b16 v[118:119], v28 offset:9856
    v_mfma_f32_16x16x32_bf16 v[236:239], v[60:63], v[44:47], v[236:239]
    buffer_load_dwordx4 v19, s[24:27], s36 offen offset:2048 lds
    v_mfma_f32_16x16x32_bf16 v[144:147], v[64:67], v[32:35], v[144:147]
    ds_read_b64_tr_b16 v[120:121], v29 offset:8832
    ds_read_b64_tr_b16 v[122:123], v29 offset:9856
    v_mfma_f32_16x16x32_bf16 v[176:179], v[64:67], v[36:39], v[176:179]
    v_mfma_f32_16x16x32_bf16 v[208:211], v[64:67], v[40:43], v[208:211]
    ds_read_b64_tr_b16 v[124:125], v30 offset:8832
    ds_read_b64_tr_b16 v[126:127], v30 offset:9856
    v_mfma_f32_16x16x32_bf16 v[240:243], v[64:67], v[44:47], v[240:243]
    v_mfma_f32_16x16x32_bf16 v[148:151], v[68:71], v[32:35], v[148:151]
    v_mfma_f32_16x16x32_bf16 v[180:183], v[68:71], v[36:39], v[180:183]
    buffer_load_dwordx4 v20, s[24:27], s36 offen offset:3072 lds
    v_mfma_f32_16x16x32_bf16 v[212:215], v[68:71], v[40:43], v[212:215]
    s_add_u32 s37, s49, 7602176
    v_mfma_f32_16x16x32_bf16 v[244:247], v[68:71], v[44:47], v[244:247]
    s_add_u32 m0, s50, 43520
    v_mfma_f32_16x16x32_bf16 v[152:155], v[72:75], v[32:35], v[152:155]
gated_mix__ssm_conv_h3__compressed_kv_cla__prompt_kernel_pad7:
    s_cbranch_execz gated_mix__ssm_conv_h3__compressed_kv_cla__prompt_kernel_pad11
    buffer_load_dwordx4 v21, s[20:23], s37 offen offset:0 lds
    v_mfma_f32_16x16x32_bf16 v[184:187], v[72:75], v[36:39], v[184:187]
    v_mfma_f32_16x16x32_bf16 v[216:219], v[72:75], v[40:43], v[216:219]
    v_mfma_f32_16x16x32_bf16 v[248:251], v[72:75], v[44:47], v[248:251]
    v_mfma_f32_16x16x32_bf16 v[156:159], v[76:79], v[32:35], v[156:159]
    v_mfma_f32_16x16x32_bf16 v[188:191], v[76:79], v[36:39], v[188:191]
    v_mfma_f32_16x16x32_bf16 v[220:223], v[76:79], v[40:43], v[220:223]
    buffer_load_dwordx4 v22, s[20:23], s37 offen offset:1024 lds
    v_mfma_f32_16x16x32_bf16 v[252:255], v[76:79], v[44:47], v[252:255]
    s_waitcnt vmcnt(12) lgkmcnt(0)
    s_barrier
    v_mfma_f32_16x16x32_bf16 v[128:131], v[96:99], v[80:83], v[128:131]
    s_add_u32 s8, s94, 67108864
    s_addc_u32 s9, s95, 0
    ds_read_b64_tr_b16 v[48:49], v27 offset:17408
    ds_read_b64_tr_b16 v[50:51], v27 offset:18432
    v_mfma_f32_16x16x32_bf16 v[160:163], v[96:99], v[84:87], v[160:163]
    s_add_u32 s36, s44, 1920
    v_mfma_f32_16x16x32_bf16 v[192:195], v[96:99], v[88:91], v[192:195]
    s_add_u32 m0, s42, 65536
    ds_read_b128 v[32:35], v23 offset:0
    ds_read_b128 v[36:39], v23 offset:2048
    v_mfma_f32_16x16x32_bf16 v[224:227], v[96:99], v[92:95], v[224:227]
    buffer_load_dwordx4 v17, s[24:27], s36 offen offset:0 lds
    v_mfma_f32_16x16x32_bf16 v[132:135], v[100:103], v[80:83], v[132:135]
    s_mov_b32 s10, 16777216
    ds_read_b128 v[40:43], v23 offset:4096
    ds_read_b128 v[44:47], v23 offset:6144
    v_mfma_f32_16x16x32_bf16 v[164:167], v[100:103], v[84:87], v[164:167]
    s_lshl_b32 s41, s2, 2
    v_mfma_f32_16x16x32_bf16 v[196:199], v[100:103], v[88:91], v[196:199]
    s_add_u32 s41, s41, s32
    ds_read_b64_tr_b16 v[52:53], v28 offset:17408
    ds_read_b64_tr_b16 v[54:55], v28 offset:18432
    v_mfma_f32_16x16x32_bf16 v[228:231], v[100:103], v[92:95], v[228:231]
    buffer_load_dwordx4 v18, s[24:27], s36 offen offset:1024 lds
    v_mfma_f32_16x16x32_bf16 v[136:139], v[104:107], v[80:83], v[136:139]
    s_lshl_b32 s41, s41, 14
    ds_read_b64_tr_b16 v[56:57], v29 offset:17408
    ds_read_b64_tr_b16 v[58:59], v29 offset:18432
    v_mfma_f32_16x16x32_bf16 v[168:171], v[104:107], v[84:87], v[168:171]
    s_add_u32 s38, s41, 4096
    v_mfma_f32_16x16x32_bf16 v[200:203], v[104:107], v[88:91], v[200:203]
    ds_read_b64_tr_b16 v[60:61], v30 offset:17408
    ds_read_b64_tr_b16 v[62:63], v30 offset:18432
    v_mfma_f32_16x16x32_bf16 v[232:235], v[104:107], v[92:95], v[232:235]
    v_mfma_f32_16x16x32_bf16 v[140:143], v[108:111], v[80:83], v[140:143]
    ds_read_b64_tr_b16 v[64:65], v27 offset:17536
    ds_read_b64_tr_b16 v[66:67], v27 offset:18560
    v_mfma_f32_16x16x32_bf16 v[172:175], v[108:111], v[84:87], v[172:175]
    v_mfma_f32_16x16x32_bf16 v[204:207], v[108:111], v[88:91], v[204:207]
    ds_read_b64_tr_b16 v[68:69], v28 offset:17536
    ds_read_b64_tr_b16 v[70:71], v28 offset:18560
    v_mfma_f32_16x16x32_bf16 v[236:239], v[108:111], v[92:95], v[236:239]
    buffer_load_dwordx4 v19, s[24:27], s36 offen offset:2048 lds
    v_mfma_f32_16x16x32_bf16 v[144:147], v[112:115], v[80:83], v[144:147]
    ds_read_b64_tr_b16 v[72:73], v29 offset:17536
    ds_read_b64_tr_b16 v[74:75], v29 offset:18560
    v_mfma_f32_16x16x32_bf16 v[176:179], v[112:115], v[84:87], v[176:179]
    v_mfma_f32_16x16x32_bf16 v[208:211], v[112:115], v[88:91], v[208:211]
    ds_read_b64_tr_b16 v[76:77], v30 offset:17536
    ds_read_b64_tr_b16 v[78:79], v30 offset:18560
    v_mfma_f32_16x16x32_bf16 v[240:243], v[112:115], v[92:95], v[240:243]
    v_mfma_f32_16x16x32_bf16 v[148:151], v[116:119], v[80:83], v[148:151]
    v_mfma_f32_16x16x32_bf16 v[180:183], v[116:119], v[84:87], v[180:183]
    buffer_load_dwordx4 v20, s[24:27], s36 offen offset:3072 lds
    v_mfma_f32_16x16x32_bf16 v[212:215], v[116:119], v[88:91], v[212:215]
    s_add_u32 s37, s49, 7864320
    v_mfma_f32_16x16x32_bf16 v[244:247], v[116:119], v[92:95], v[244:247]
    s_add_u32 m0, s50, 0
    v_mfma_f32_16x16x32_bf16 v[152:155], v[120:123], v[80:83], v[152:155]
    buffer_load_dwordx4 v21, s[20:23], s37 offen offset:0 lds
    v_mfma_f32_16x16x32_bf16 v[184:187], v[120:123], v[84:87], v[184:187]
    v_mfma_f32_16x16x32_bf16 v[216:219], v[120:123], v[88:91], v[216:219]
    v_mfma_f32_16x16x32_bf16 v[248:251], v[120:123], v[92:95], v[248:251]
    v_mfma_f32_16x16x32_bf16 v[156:159], v[124:127], v[80:83], v[156:159]
    v_mfma_f32_16x16x32_bf16 v[188:191], v[124:127], v[84:87], v[188:191]
    v_mfma_f32_16x16x32_bf16 v[220:223], v[124:127], v[88:91], v[220:223]
    buffer_load_dwordx4 v22, s[20:23], s37 offen offset:1024 lds
    v_mfma_f32_16x16x32_bf16 v[252:255], v[124:127], v[92:95], v[252:255]
    s_waitcnt lgkmcnt(0)
    v_mfma_f32_16x16x32_bf16 v[128:131], v[48:51], v[32:35], v[128:131]
    ds_read_b64_tr_b16 v[96:97], v27 offset:26112
    ds_read_b64_tr_b16 v[98:99], v27 offset:27136
    v_mfma_f32_16x16x32_bf16 v[160:163], v[48:51], v[36:39], v[160:163]
    s_add_u32 s36, s45, 1920
    v_mfma_f32_16x16x32_bf16 v[192:195], v[48:51], v[40:43], v[192:195]
    s_add_u32 m0, s42, 69632
    ds_read_b128 v[80:83], v24 offset:0
    ds_read_b128 v[84:87], v24 offset:2048
    v_mfma_f32_16x16x32_bf16 v[224:227], v[48:51], v[44:47], v[224:227]
    buffer_load_dwordx4 v17, s[24:27], s36 offen offset:0 lds
    v_mfma_f32_16x16x32_bf16 v[132:135], v[52:55], v[32:35], v[132:135]
    ds_read_b128 v[88:91], v24 offset:4096
    ds_read_b128 v[92:95], v24 offset:6144
    v_mfma_f32_16x16x32_bf16 v[164:167], v[52:55], v[36:39], v[164:167]
    v_mfma_f32_16x16x32_bf16 v[196:199], v[52:55], v[40:43], v[196:199]
    ds_read_b64_tr_b16 v[100:101], v28 offset:26112
    ds_read_b64_tr_b16 v[102:103], v28 offset:27136
    v_mfma_f32_16x16x32_bf16 v[228:231], v[52:55], v[44:47], v[228:231]
    buffer_load_dwordx4 v18, s[24:27], s36 offen offset:1024 lds
    v_mfma_f32_16x16x32_bf16 v[136:139], v[56:59], v[32:35], v[136:139]
    ds_read_b64_tr_b16 v[104:105], v29 offset:26112
    ds_read_b64_tr_b16 v[106:107], v29 offset:27136
    v_mfma_f32_16x16x32_bf16 v[168:171], v[56:59], v[36:39], v[168:171]
    v_mfma_f32_16x16x32_bf16 v[200:203], v[56:59], v[40:43], v[200:203]
    ds_read_b64_tr_b16 v[108:109], v30 offset:26112
    ds_read_b64_tr_b16 v[110:111], v30 offset:27136
    v_mfma_f32_16x16x32_bf16 v[232:235], v[56:59], v[44:47], v[232:235]
    v_mfma_f32_16x16x32_bf16 v[140:143], v[60:63], v[32:35], v[140:143]
    ds_read_b64_tr_b16 v[112:113], v27 offset:26240
    ds_read_b64_tr_b16 v[114:115], v27 offset:27264
    v_mfma_f32_16x16x32_bf16 v[172:175], v[60:63], v[36:39], v[172:175]
    v_mfma_f32_16x16x32_bf16 v[204:207], v[60:63], v[40:43], v[204:207]
    ds_read_b64_tr_b16 v[116:117], v28 offset:26240
    ds_read_b64_tr_b16 v[118:119], v28 offset:27264
    v_mfma_f32_16x16x32_bf16 v[236:239], v[60:63], v[44:47], v[236:239]
    buffer_load_dwordx4 v19, s[24:27], s36 offen offset:2048 lds
    v_mfma_f32_16x16x32_bf16 v[144:147], v[64:67], v[32:35], v[144:147]
    ds_read_b64_tr_b16 v[120:121], v29 offset:26240
    ds_read_b64_tr_b16 v[122:123], v29 offset:27264
    v_mfma_f32_16x16x32_bf16 v[176:179], v[64:67], v[36:39], v[176:179]
    v_mfma_f32_16x16x32_bf16 v[208:211], v[64:67], v[40:43], v[208:211]
    ds_read_b64_tr_b16 v[124:125], v30 offset:26240
    ds_read_b64_tr_b16 v[126:127], v30 offset:27264
    v_mfma_f32_16x16x32_bf16 v[240:243], v[64:67], v[44:47], v[240:243]
    v_mfma_f32_16x16x32_bf16 v[148:151], v[68:71], v[32:35], v[148:151]
    v_mov_b32 v12, -1
    v_mov_b32 v13, -1
    v_mfma_f32_16x16x32_bf16 v[180:183], v[68:71], v[36:39], v[180:183]
    buffer_load_dwordx4 v20, s[24:27], s36 offen offset:3072 lds
    v_mfma_f32_16x16x32_bf16 v[212:215], v[68:71], v[40:43], v[212:215]
    s_add_u32 s37, s49, 8126464
    v_mov_b32 v14, -1
    v_mov_b32 v15, -1
    v_mfma_f32_16x16x32_bf16 v[244:247], v[68:71], v[44:47], v[244:247]
    s_add_u32 m0, s50, 8704
    v_mfma_f32_16x16x32_bf16 v[152:155], v[72:75], v[32:35], v[152:155]
    buffer_load_dwordx4 v21, s[20:23], s37 offen offset:0 lds
    v_mfma_f32_16x16x32_bf16 v[184:187], v[72:75], v[36:39], v[184:187]
    v_mfma_f32_16x16x32_bf16 v[216:219], v[72:75], v[40:43], v[216:219]
    v_mfma_f32_16x16x32_bf16 v[248:251], v[72:75], v[44:47], v[248:251]
    v_mfma_f32_16x16x32_bf16 v[156:159], v[76:79], v[32:35], v[156:159]
    v_mfma_f32_16x16x32_bf16 v[188:191], v[76:79], v[36:39], v[188:191]
    v_mfma_f32_16x16x32_bf16 v[220:223], v[76:79], v[40:43], v[220:223]
    buffer_load_dwordx4 v22, s[20:23], s37 offen offset:1024 lds
    v_mfma_f32_16x16x32_bf16 v[252:255], v[76:79], v[44:47], v[252:255]
    s_waitcnt vmcnt(12) lgkmcnt(0)
    s_barrier
    v_mfma_f32_16x16x32_bf16 v[128:131], v[96:99], v[80:83], v[128:131]
    s_lshl_b32 s36, s33, 20
    ds_read_b64_tr_b16 v[48:49], v27 offset:34816
    ds_read_b64_tr_b16 v[50:51], v27 offset:35840
    v_mfma_f32_16x16x32_bf16 v[160:163], v[96:99], v[84:87], v[160:163]
    s_add_u32 s12, s94, s36
    s_addc_u32 s13, s95, 0
    v_mfma_f32_16x16x32_bf16 v[192:195], v[96:99], v[88:91], v[192:195]
    s_lshl_b32 s36, s34, 16
    ds_read_b128 v[32:35], v23 offset:32768
    ds_read_b128 v[36:39], v23 offset:34816
    v_mfma_f32_16x16x32_bf16 v[224:227], v[96:99], v[92:95], v[224:227]
    buffer_store_dwordx4 v[12:15], v16, s[8:11], s41 offen offset:0 sc1
    v_mfma_f32_16x16x32_bf16 v[132:135], v[100:103], v[80:83], v[132:135]
    s_sub_u32 s14, 1048576, s36
    ds_read_b128 v[40:43], v23 offset:36864
    ds_read_b128 v[44:47], v23 offset:38912
    v_mfma_f32_16x16x32_bf16 v[164:167], v[100:103], v[84:87], v[164:167]
    s_lshl_b32 s59, s32, 12
    v_mfma_f32_16x16x32_bf16 v[196:199], v[100:103], v[88:91], v[196:199]
    s_lshl_b32 s36, s34, 1
    ds_read_b64_tr_b16 v[52:53], v28 offset:34816
    ds_read_b64_tr_b16 v[54:55], v28 offset:35840
    v_mfma_f32_16x16x32_bf16 v[228:231], v[100:103], v[92:95], v[228:231]
    v_mfma_f32_16x16x32_bf16 v[136:139], v[104:107], v[80:83], v[136:139]
    s_add_u32 s36, s36, 3
    ds_read_b64_tr_b16 v[56:57], v29 offset:34816
    ds_read_b64_tr_b16 v[58:59], v29 offset:35840
    v_mfma_f32_16x16x32_bf16 v[168:171], v[104:107], v[84:87], v[168:171]
    s_mul_i32 s37, s36, 52
    v_mfma_f32_16x16x32_bf16 v[200:203], v[104:107], v[88:91], v[200:203]
    s_lshr_b32 s37, s37, 8
    ds_read_b64_tr_b16 v[60:61], v30 offset:34816
    ds_read_b64_tr_b16 v[62:63], v30 offset:35840
    v_mfma_f32_16x16x32_bf16 v[232:235], v[104:107], v[92:95], v[232:235]
    buffer_store_dwordx4 v[12:15], v16, s[8:11], s41 offen offset:1024 sc1
    v_mfma_f32_16x16x32_bf16 v[140:143], v[108:111], v[80:83], v[140:143]
    s_mul_i32 s37, s37, 5
    ds_read_b64_tr_b16 v[64:65], v27 offset:34944
    ds_read_b64_tr_b16 v[66:67], v27 offset:35968
    v_mfma_f32_16x16x32_bf16 v[172:175], v[108:111], v[84:87], v[172:175]
    s_sub_u32 s36, s36, s37
    v_mfma_f32_16x16x32_bf16 v[204:207], v[108:111], v[88:91], v[204:207]
    s_lshl_b32 s47, s36, 15
    ds_read_b64_tr_b16 v[68:69], v28 offset:34944
    ds_read_b64_tr_b16 v[70:71], v28 offset:35968
    v_mfma_f32_16x16x32_bf16 v[236:239], v[108:111], v[92:95], v[236:239]
    v_mfma_f32_16x16x32_bf16 v[144:147], v[112:115], v[80:83], v[144:147]
    s_add_u32 s48, s47, 32768
    ds_read_b64_tr_b16 v[72:73], v29 offset:34944
    ds_read_b64_tr_b16 v[74:75], v29 offset:35968
    v_mfma_f32_16x16x32_bf16 v[176:179], v[112:115], v[84:87], v[176:179]
    s_cmp_eq_u32 s48, 163840
    s_cselect_b32 s48, 0, s48
    v_mfma_f32_16x16x32_bf16 v[208:211], v[112:115], v[88:91], v[208:211]
    s_add_u32 s51, s48, 32768
    ds_read_b64_tr_b16 v[76:77], v30 offset:34944
    ds_read_b64_tr_b16 v[78:79], v30 offset:35968
    v_mfma_f32_16x16x32_bf16 v[240:243], v[112:115], v[92:95], v[240:243]
    s_cmp_eq_u32 s51, 163840
    s_cselect_b32 s51, 0, s51
    v_mfma_f32_16x16x32_bf16 v[148:151], v[116:119], v[80:83], v[148:151]
    s_add_u32 s52, s51, 32768
    v_mfma_f32_16x16x32_bf16 v[180:183], v[116:119], v[84:87], v[180:183]
    buffer_store_dwordx4 v[12:15], v16, s[8:11], s41 offen offset:2048 sc1
    v_mfma_f32_16x16x32_bf16 v[212:215], v[116:119], v[88:91], v[212:215]
    s_cmp_eq_u32 s52, 163840
    s_cselect_b32 s52, 0, s52
    v_mfma_f32_16x16x32_bf16 v[244:247], v[116:119], v[92:95], v[244:247]
    s_add_u32 s53, s52, 32768
    v_mfma_f32_16x16x32_bf16 v[152:155], v[120:123], v[80:83], v[152:155]
    v_mfma_f32_16x16x32_bf16 v[184:187], v[120:123], v[84:87], v[184:187]
    s_cmp_eq_u32 s53, 163840
    s_cselect_b32 s53, 0, s53
    v_mfma_f32_16x16x32_bf16 v[216:219], v[120:123], v[88:91], v[216:219]
    v_mfma_f32_16x16x32_bf16 v[248:251], v[120:123], v[92:95], v[248:251]
    buffer_store_dwordx4 v[12:15], v16, s[8:11], s41 offen offset:3072 sc1
    v_mfma_f32_16x16x32_bf16 v[156:159], v[124:127], v[80:83], v[156:159]
    v_mfma_f32_16x16x32_bf16 v[188:191], v[124:127], v[84:87], v[188:191]
    v_mfma_f32_16x16x32_bf16 v[220:223], v[124:127], v[88:91], v[220:223]
    v_mfma_f32_16x16x32_bf16 v[252:255], v[124:127], v[92:95], v[252:255]
    s_waitcnt lgkmcnt(0)
    v_mfma_f32_16x16x32_bf16 v[128:131], v[48:51], v[32:35], v[128:131]
    ds_read_b64_tr_b16 v[96:97], v27 offset:43520
    ds_read_b64_tr_b16 v[98:99], v27 offset:44544
    v_mfma_f32_16x16x32_bf16 v[160:163], v[48:51], v[36:39], v[160:163]
    v_mfma_f32_16x16x32_bf16 v[192:195], v[48:51], v[40:43], v[192:195]
    ds_read_b128 v[80:83], v24 offset:32768
    ds_read_b128 v[84:87], v24 offset:34816
    v_mfma_f32_16x16x32_bf16 v[224:227], v[48:51], v[44:47], v[224:227]
    buffer_store_dwordx4 v[12:15], v16, s[8:11], s38 offen offset:0 sc1
    v_mfma_f32_16x16x32_bf16 v[132:135], v[52:55], v[32:35], v[132:135]
    ds_read_b128 v[88:91], v24 offset:36864
    ds_read_b128 v[92:95], v24 offset:38912
    v_mfma_f32_16x16x32_bf16 v[164:167], v[52:55], v[36:39], v[164:167]
    v_mfma_f32_16x16x32_bf16 v[196:199], v[52:55], v[40:43], v[196:199]
    ds_read_b64_tr_b16 v[100:101], v28 offset:43520
    ds_read_b64_tr_b16 v[102:103], v28 offset:44544
    v_mfma_f32_16x16x32_bf16 v[228:231], v[52:55], v[44:47], v[228:231]
    v_mfma_f32_16x16x32_bf16 v[136:139], v[56:59], v[32:35], v[136:139]
    ds_read_b64_tr_b16 v[104:105], v29 offset:43520
    ds_read_b64_tr_b16 v[106:107], v29 offset:44544
    v_mfma_f32_16x16x32_bf16 v[168:171], v[56:59], v[36:39], v[168:171]
    v_mfma_f32_16x16x32_bf16 v[200:203], v[56:59], v[40:43], v[200:203]
    ds_read_b64_tr_b16 v[108:109], v30 offset:43520
    ds_read_b64_tr_b16 v[110:111], v30 offset:44544
    v_mfma_f32_16x16x32_bf16 v[232:235], v[56:59], v[44:47], v[232:235]
    buffer_store_dwordx4 v[12:15], v16, s[8:11], s38 offen offset:1024 sc1
    v_mfma_f32_16x16x32_bf16 v[140:143], v[60:63], v[32:35], v[140:143]
    ds_read_b64_tr_b16 v[112:113], v27 offset:43648
    ds_read_b64_tr_b16 v[114:115], v27 offset:44672
    v_mfma_f32_16x16x32_bf16 v[172:175], v[60:63], v[36:39], v[172:175]
    v_mfma_f32_16x16x32_bf16 v[204:207], v[60:63], v[40:43], v[204:207]
    ds_read_b64_tr_b16 v[116:117], v28 offset:43648
    ds_read_b64_tr_b16 v[118:119], v28 offset:44672
    v_mfma_f32_16x16x32_bf16 v[236:239], v[60:63], v[44:47], v[236:239]
    v_mfma_f32_16x16x32_bf16 v[144:147], v[64:67], v[32:35], v[144:147]
    ds_read_b64_tr_b16 v[120:121], v29 offset:43648
    ds_read_b64_tr_b16 v[122:123], v29 offset:44672
    v_mfma_f32_16x16x32_bf16 v[176:179], v[64:67], v[36:39], v[176:179]
    v_mfma_f32_16x16x32_bf16 v[208:211], v[64:67], v[40:43], v[208:211]
    ds_read_b64_tr_b16 v[124:125], v30 offset:43648
    ds_read_b64_tr_b16 v[126:127], v30 offset:44672
    v_mfma_f32_16x16x32_bf16 v[240:243], v[64:67], v[44:47], v[240:243]
    v_mfma_f32_16x16x32_bf16 v[148:151], v[68:71], v[32:35], v[148:151]
    v_mfma_f32_16x16x32_bf16 v[180:183], v[68:71], v[36:39], v[180:183]
    buffer_store_dwordx4 v[12:15], v16, s[8:11], s38 offen offset:2048 sc1
    v_mfma_f32_16x16x32_bf16 v[212:215], v[68:71], v[40:43], v[212:215]
    v_mfma_f32_16x16x32_bf16 v[244:247], v[68:71], v[44:47], v[244:247]
    v_mfma_f32_16x16x32_bf16 v[152:155], v[72:75], v[32:35], v[152:155]
    v_mfma_f32_16x16x32_bf16 v[184:187], v[72:75], v[36:39], v[184:187]
    v_mfma_f32_16x16x32_bf16 v[216:219], v[72:75], v[40:43], v[216:219]
    v_mfma_f32_16x16x32_bf16 v[248:251], v[72:75], v[44:47], v[248:251]
    buffer_store_dwordx4 v[12:15], v16, s[8:11], s38 offen offset:3072 sc1
    v_mfma_f32_16x16x32_bf16 v[156:159], v[76:79], v[32:35], v[156:159]
    v_mfma_f32_16x16x32_bf16 v[188:191], v[76:79], v[36:39], v[188:191]
    v_mfma_f32_16x16x32_bf16 v[220:223], v[76:79], v[40:43], v[220:223]
    v_mfma_f32_16x16x32_bf16 v[252:255], v[76:79], v[44:47], v[252:255]
    s_waitcnt vmcnt(8) lgkmcnt(0)
    s_barrier
    v_mfma_f32_16x16x32_bf16 v[128:131], v[96:99], v[80:83], v[128:131]
    s_add_u32 s38, s59, 131072
    ds_read_b64_tr_b16 v[48:49], v27 offset:0
    ds_read_b64_tr_b16 v[50:51], v27 offset:1024
    v_mfma_f32_16x16x32_bf16 v[160:163], v[96:99], v[84:87], v[160:163]
    s_mov_b32 s42, 0x40004000
    v_mfma_f32_16x16x32_bf16 v[192:195], v[96:99], v[88:91], v[192:195]
    s_mov_b32 s39, s47
    ds_read_b128 v[32:35], v25 offset:0
    ds_read_b128 v[36:39], v25 offset:2048
    v_mfma_f32_16x16x32_bf16 v[224:227], v[96:99], v[92:95], v[224:227]
    v_mfma_f32_16x16x32_bf16 v[132:135], v[100:103], v[80:83], v[132:135]
    s_mov_b32 s45, s48
    ds_read_b128 v[40:43], v25 offset:4096
    ds_read_b128 v[44:47], v25 offset:6144
    v_mfma_f32_16x16x32_bf16 v[164:167], v[100:103], v[84:87], v[164:167]
    s_mov_b32 s44, 32768
    v_mfma_f32_16x16x32_bf16 v[196:199], v[100:103], v[88:91], v[196:199]
    s_movk_i32 s49, 16384
    ds_read_b64_tr_b16 v[52:53], v28 offset:0
    ds_read_b64_tr_b16 v[54:55], v28 offset:1024
    v_mfma_f32_16x16x32_bf16 v[228:231], v[100:103], v[92:95], v[228:231]
    v_mfma_f32_16x16x32_bf16 v[136:139], v[104:107], v[80:83], v[136:139]
    s_movk_i32 s50, 16384
    ds_read_b64_tr_b16 v[56:57], v29 offset:0
    ds_read_b64_tr_b16 v[58:59], v29 offset:1024
    v_mfma_f32_16x16x32_bf16 v[168:171], v[104:107], v[84:87], v[168:171]
    s_add_u32 s16, s94, 33554432
    s_addc_u32 s17, s95, 0
    v_mfma_f32_16x16x32_bf16 v[200:203], v[104:107], v[88:91], v[200:203]
    s_mov_b32 s18, 16777216
    ds_read_b64_tr_b16 v[60:61], v30 offset:0
    ds_read_b64_tr_b16 v[62:63], v30 offset:1024
    v_mfma_f32_16x16x32_bf16 v[232:235], v[104:107], v[92:95], v[232:235]
    v_mfma_f32_16x16x32_bf16 v[140:143], v[108:111], v[80:83], v[140:143]
    s_mov_b32 s8, s86
    ds_read_b64_tr_b16 v[64:65], v27 offset:128
    ds_read_b64_tr_b16 v[66:67], v27 offset:1152
    v_mfma_f32_16x16x32_bf16 v[172:175], v[108:111], v[84:87], v[172:175]
    s_mov_b32 s9, s87
    v_mfma_f32_16x16x32_bf16 v[204:207], v[108:111], v[88:91], v[204:207]
    s_mov_b32 s10, 8388608
    ds_read_b64_tr_b16 v[68:69], v28 offset:128
    ds_read_b64_tr_b16 v[70:71], v28 offset:1152
    v_mfma_f32_16x16x32_bf16 v[236:239], v[108:111], v[92:95], v[236:239]
    v_mfma_f32_16x16x32_bf16 v[144:147], v[112:115], v[80:83], v[144:147]
    s_mov_b32 s4, s72
    ds_read_b64_tr_b16 v[72:73], v29 offset:128
    ds_read_b64_tr_b16 v[74:75], v29 offset:1152
    v_mfma_f32_16x16x32_bf16 v[176:179], v[112:115], v[84:87], v[176:179]
    s_mov_b32 s5, s73
    v_mfma_f32_16x16x32_bf16 v[208:211], v[112:115], v[88:91], v[208:211]
    s_mov_b32 s6, 4194304
    ds_read_b64_tr_b16 v[76:77], v30 offset:128
    ds_read_b64_tr_b16 v[78:79], v30 offset:1152
    v_mfma_f32_16x16x32_bf16 v[240:243], v[112:115], v[92:95], v[240:243]
    s_lshl_b32 s58, s2, 2
    v_mfma_f32_16x16x32_bf16 v[148:151], v[116:119], v[80:83], v[148:151]
    s_add_u32 s58, s58, s32
    v_mfma_f32_16x16x32_bf16 v[180:183], v[116:119], v[84:87], v[180:183]
    v_mfma_f32_16x16x32_bf16 v[212:215], v[116:119], v[88:91], v[212:215]
    s_sub_u32 s46, s58, 512
    v_mfma_f32_16x16x32_bf16 v[244:247], v[116:119], v[92:95], v[244:247]
    s_lshl_b32 s46, s46, 11
    v_mfma_f32_16x16x32_bf16 v[152:155], v[120:123], v[80:83], v[152:155]
    v_mfma_f32_16x16x32_bf16 v[184:187], v[120:123], v[84:87], v[184:187]
    s_cmp_lt_u32 s34, 4
    s_cselect_b32 s46, 0x80000000, s46
    v_mfma_f32_16x16x32_bf16 v[216:219], v[120:123], v[88:91], v[216:219]
    v_mfma_f32_16x16x32_bf16 v[248:251], v[120:123], v[92:95], v[248:251]
    v_mfma_f32_16x16x32_bf16 v[156:159], v[124:127], v[80:83], v[156:159]
    v_mfma_f32_16x16x32_bf16 v[188:191], v[124:127], v[84:87], v[188:191]
    v_mfma_f32_16x16x32_bf16 v[220:223], v[124:127], v[88:91], v[220:223]
    v_mfma_f32_16x16x32_bf16 v[252:255], v[124:127], v[92:95], v[252:255]
    s_waitcnt lgkmcnt(0)
    v_mfma_f32_16x16x32_bf16 v[128:131], v[48:51], v[32:35], v[128:131]
    ds_read_b64_tr_b16 v[96:97], v27 offset:8704
    ds_read_b64_tr_b16 v[98:99], v27 offset:9728
    v_mfma_f32_16x16x32_bf16 v[160:163], v[48:51], v[36:39], v[160:163]
    v_mfma_f32_16x16x32_bf16 v[192:195], v[48:51], v[40:43], v[192:195]
    ds_read_b128 v[80:83], v26 offset:0
    ds_read_b128 v[84:87], v26 offset:2048
    v_mfma_f32_16x16x32_bf16 v[224:227], v[48:51], v[44:47], v[224:227]
    buffer_load_dword v2, v3, s[28:31], s40 offen sc1
    v_mfma_f32_16x16x32_bf16 v[132:135], v[52:55], v[32:35], v[132:135]
    ds_read_b128 v[88:91], v26 offset:4096
    ds_read_b128 v[92:95], v26 offset:6144
    v_mfma_f32_16x16x32_bf16 v[164:167], v[52:55], v[36:39], v[164:167]
    v_mfma_f32_16x16x32_bf16 v[196:199], v[52:55], v[40:43], v[196:199]
    ds_read_b64_tr_b16 v[100:101], v28 offset:8704
    ds_read_b64_tr_b16 v[102:103], v28 offset:9728
    v_mfma_f32_16x16x32_bf16 v[228:231], v[52:55], v[44:47], v[228:231]
    v_mfma_f32_16x16x32_bf16 v[136:139], v[56:59], v[32:35], v[136:139]
    ds_read_b64_tr_b16 v[104:105], v29 offset:8704
    ds_read_b64_tr_b16 v[106:107], v29 offset:9728
    v_mfma_f32_16x16x32_bf16 v[168:171], v[56:59], v[36:39], v[168:171]
    v_mfma_f32_16x16x32_bf16 v[200:203], v[56:59], v[40:43], v[200:203]
    ds_read_b64_tr_b16 v[108:109], v30 offset:8704
    ds_read_b64_tr_b16 v[110:111], v30 offset:9728
    v_mfma_f32_16x16x32_bf16 v[232:235], v[56:59], v[44:47], v[232:235]
    v_mfma_f32_16x16x32_bf16 v[140:143], v[60:63], v[32:35], v[140:143]
    ds_read_b64_tr_b16 v[112:113], v27 offset:8832
    ds_read_b64_tr_b16 v[114:115], v27 offset:9856
    v_mfma_f32_16x16x32_bf16 v[172:175], v[60:63], v[36:39], v[172:175]
    v_mfma_f32_16x16x32_bf16 v[204:207], v[60:63], v[40:43], v[204:207]
    ds_read_b64_tr_b16 v[116:117], v28 offset:8832
    ds_read_b64_tr_b16 v[118:119], v28 offset:9856
    v_mfma_f32_16x16x32_bf16 v[236:239], v[60:63], v[44:47], v[236:239]
    v_mfma_f32_16x16x32_bf16 v[144:147], v[64:67], v[32:35], v[144:147]
    ds_read_b64_tr_b16 v[120:121], v29 offset:8832
    ds_read_b64_tr_b16 v[122:123], v29 offset:9856
    v_mfma_f32_16x16x32_bf16 v[176:179], v[64:67], v[36:39], v[176:179]
    v_mfma_f32_16x16x32_bf16 v[208:211], v[64:67], v[40:43], v[208:211]
    ds_read_b64_tr_b16 v[124:125], v30 offset:8832
    ds_read_b64_tr_b16 v[126:127], v30 offset:9856
    v_mfma_f32_16x16x32_bf16 v[240:243], v[64:67], v[44:47], v[240:243]
    v_mfma_f32_16x16x32_bf16 v[148:151], v[68:71], v[32:35], v[148:151]
    v_mfma_f32_16x16x32_bf16 v[180:183], v[68:71], v[36:39], v[180:183]
    v_mfma_f32_16x16x32_bf16 v[212:215], v[68:71], v[40:43], v[212:215]
    v_mfma_f32_16x16x32_bf16 v[244:247], v[68:71], v[44:47], v[244:247]
    v_mfma_f32_16x16x32_bf16 v[152:155], v[72:75], v[32:35], v[152:155]
    v_mfma_f32_16x16x32_bf16 v[184:187], v[72:75], v[36:39], v[184:187]
    v_mfma_f32_16x16x32_bf16 v[216:219], v[72:75], v[40:43], v[216:219]
    v_mfma_f32_16x16x32_bf16 v[248:251], v[72:75], v[44:47], v[248:251]
    v_mfma_f32_16x16x32_bf16 v[156:159], v[76:79], v[32:35], v[156:159]
    v_mfma_f32_16x16x32_bf16 v[188:191], v[76:79], v[36:39], v[188:191]
    v_mfma_f32_16x16x32_bf16 v[220:223], v[76:79], v[40:43], v[220:223]
    v_mfma_f32_16x16x32_bf16 v[252:255], v[76:79], v[44:47], v[252:255]
    s_waitcnt vmcnt(0) lgkmcnt(0)
    s_barrier
    v_cmp_ne_u32 vcc, 1, v2
    v_mfma_f32_16x16x32_bf16 v[128:131], v[96:99], v[80:83], v[128:131]
    s_nop 0
    s_cbranch_vccnz gated_mix__ssm_conv_h3__compressed_kv_cla__prompt_kernel_spin_kv
gated_mix__ssm_conv_h3__compressed_kv_cla__prompt_kernel_spin_kv_ret:
    v_mfma_f32_16x16x32_bf16 v[160:163], v[96:99], v[84:87], v[160:163]
    s_add_u32 s36, s59, 0
    v_bfe_u32 v40, v16, 4, 4
    v_lshrrev_b32 v41, 8, v16
    v_mfma_f32_16x16x32_bf16 v[192:195], v[96:99], v[88:91], v[192:195]
    s_add_u32 s37, s59, s47
    s_mov_b32 m0, s37
    v_sub_u32 v40, v40, v41
    v_cmp_gt_u32 vcc, 256, v16
    v_mfma_f32_16x16x32_bf16 v[224:227], v[96:99], v[92:95], v[224:227]
    buffer_load_dwordx4 v16, s[12:15], s36 offen offset:0 sc1 lds
    v_mfma_f32_16x16x32_bf16 v[132:135], v[100:103], v[80:83], v[132:135]
    s_add_u32 s40, s59, s53
    v_lshl_add_u32 v40, v40, 2, s32
    v_mov_b32 v41, 0xff000000
    v_mfma_f32_16x16x32_bf16 v[164:167], v[100:103], v[84:87], v[164:167]
    s_add_u32 s41, s40, 16384
    v_lshlrev_b32 v15, 3, v16
    v_cndmask_b32 v19, v41, v15, vcc
    v_mfma_f32_16x16x32_bf16 v[196:199], v[100:103], v[88:91], v[196:199]
    s_lshl_b32 s54, s58, 12
    v_cmp_gt_i32 vcc, 0, v40
    v_cmp_gt_i32 s[66:67], 1, v40
    v_mfma_f32_16x16x32_bf16 v[228:231], v[100:103], v[92:95], v[228:231]
    buffer_load_dwordx4 v16, s[12:15], s36 offen offset:1024 sc1 lds
    v_mfma_f32_16x16x32_bf16 v[136:139], v[104:107], v[80:83], v[136:139]
    v_cndmask_b32 v48, 0, v41, vcc
    v_cndmask_b32 v49, 0, v41, s[66:67]
    v_mfma_f32_16x16x32_bf16 v[168:171], v[104:107], v[84:87], v[168:171]
    v_cmp_gt_i32 vcc, 2, v40
    v_cmp_gt_i32 s[66:67], 3, v40
    v_mfma_f32_16x16x32_bf16 v[200:203], v[104:107], v[88:91], v[200:203]
    v_cndmask_b32 v50, 0, v41, vcc
    v_cndmask_b32 v51, 0, v41, s[66:67]
    v_mfma_f32_16x16x32_bf16 v[232:235], v[104:107], v[92:95], v[232:235]
    buffer_load_dwordx4 v16, s[12:15], s36 offen offset:2048 sc1 lds
    v_mfma_f32_16x16x32_bf16 v[140:143], v[108:111], v[80:83], v[140:143]
    v_cmp_gt_i32 vcc, 16, v40
    v_cmp_gt_i32 s[66:67], 17, v40
    v_mfma_f32_16x16x32_bf16 v[172:175], v[108:111], v[84:87], v[172:175]
    v_cndmask_b32 v52, 0, v41, vcc
    v_cndmask_b32 v53, 0, v41, s[66:67]
    v_mfma_f32_16x16x32_bf16 v[204:207], v[108:111], v[88:91], v[204:207]
    v_cmp_gt_i32 vcc, 18, v40
    v_cmp_gt_i32 s[66:67], 19, v40
    v_mfma_f32_16x16x32_bf16 v[236:239], v[108:111], v[92:95], v[236:239]
    buffer_load_dwordx4 v16, s[12:15], s36 offen offset:3072 sc1 lds
    v_mfma_f32_16x16x32_bf16 v[144:147], v[112:115], v[80:83], v[144:147]
    v_cndmask_b32 v54, 0, v41, vcc
    v_cndmask_b32 v55, 0, v41, s[66:67]
    v_mfma_f32_16x16x32_bf16 v[176:179], v[112:115], v[84:87], v[176:179]
    v_cmp_gt_i32 vcc, 32, v40
    v_cmp_gt_i32 s[66:67], 33, v40
    v_mfma_f32_16x16x32_bf16 v[208:211], v[112:115], v[88:91], v[208:211]
    v_cndmask_b32 v56, 0, v41, vcc
    v_cndmask_b32 v57, 0, v41, s[66:67]
    v_mfma_f32_16x16x32_bf16 v[240:243], v[112:115], v[92:95], v[240:243]
    s_add_u32 s36, s59, 16384
    v_cmp_gt_i32 vcc, 34, v40
    v_cmp_gt_i32 s[66:67], 35, v40
    v_mfma_f32_16x16x32_bf16 v[148:151], v[116:119], v[80:83], v[148:151]
    s_add_u32 s37, s59, s47
    s_add_u32 m0, s37, 16384
    v_cndmask_b32 v58, 0, v41, vcc
    v_cndmask_b32 v59, 0, v41, s[66:67]
    v_mfma_f32_16x16x32_bf16 v[180:183], v[116:119], v[84:87], v[180:183]
    buffer_load_dwordx4 v16, s[12:15], s36 offen offset:0 sc1 lds
    v_mfma_f32_16x16x32_bf16 v[212:215], v[116:119], v[88:91], v[212:215]
    v_cmp_gt_i32 vcc, 48, v40
    v_cmp_gt_i32 s[66:67], 49, v40
    v_mfma_f32_16x16x32_bf16 v[244:247], v[116:119], v[92:95], v[244:247]
    v_cndmask_b32 v60, 0, v41, vcc
    v_cndmask_b32 v61, 0, v41, s[66:67]
    v_mfma_f32_16x16x32_bf16 v[152:155], v[120:123], v[80:83], v[152:155]
    buffer_load_dwordx4 v16, s[12:15], s36 offen offset:1024 sc1 lds
    v_mfma_f32_16x16x32_bf16 v[184:187], v[120:123], v[84:87], v[184:187]
    v_cmp_gt_i32 vcc, 50, v40
    v_cmp_gt_i32 s[66:67], 51, v40
    v_mfma_f32_16x16x32_bf16 v[216:219], v[120:123], v[88:91], v[216:219]
    v_cndmask_b32 v62, 0, v41, vcc
    v_cndmask_b32 v63, 0, v41, s[66:67]
    v_mfma_f32_16x16x32_bf16 v[248:251], v[120:123], v[92:95], v[248:251]
    buffer_load_dwordx4 v16, s[12:15], s36 offen offset:2048 sc1 lds
    v_mfma_f32_16x16x32_bf16 v[156:159], v[124:127], v[80:83], v[156:159]
    v_add_u32 v2, s47, v16
    v_add_u32 v3, s47, v16
    v_mfma_f32_16x16x32_bf16 v[188:191], v[124:127], v[84:87], v[188:191]
    v_mov_b32 v24, 0x3f803f80
    v_mov_b32 v25, 0x3f803f80
    v_mfma_f32_16x16x32_bf16 v[220:223], v[124:127], v[88:91], v[220:223]
    buffer_load_dwordx4 v16, s[12:15], s36 offen offset:3072 sc1 lds
    v_mfma_f32_16x16x32_bf16 v[252:255], v[124:127], v[92:95], v[252:255]
    v_mov_b32 v26, 0x3f803f80
    v_mov_b32 v27, 0x3f803f80
    v_cvt_pk_bf16_f32 v80, v128, v129
    v_cvt_pk_bf16_f32 v81, v130, v131
    v_cvt_pk_bf16_f32 v82, v132, v133
    v_cvt_pk_bf16_f32 v83, v134, v135
    v_cvt_pk_bf16_f32 v84, v136, v137
    v_cvt_pk_bf16_f32 v85, v138, v139
    v_cvt_pk_bf16_f32 v86, v140, v141
    v_cvt_pk_bf16_f32 v87, v142, v143
    v_cvt_pk_bf16_f32 v88, v144, v145
    v_cvt_pk_bf16_f32 v89, v146, v147
    v_cvt_pk_bf16_f32 v90, v148, v149
    v_cvt_pk_bf16_f32 v91, v150, v151
    v_cvt_pk_bf16_f32 v92, v152, v153
    v_cvt_pk_bf16_f32 v93, v154, v155
    v_cvt_pk_bf16_f32 v94, v156, v157
    s_add_u32 s36, s59, 32768
    s_add_u32 s37, s59, s48
    s_mov_b32 m0, s37
    s_nop 0
    buffer_load_dwordx4 v16, s[12:15], s36 offen offset:0 sc1 lds
    v_cvt_pk_bf16_f32 v95, v158, v159
    v_cvt_pk_bf16_f32 v96, v160, v161
    v_cvt_pk_bf16_f32 v97, v162, v163
    v_cvt_pk_bf16_f32 v98, v164, v165
    v_cvt_pk_bf16_f32 v99, v166, v167
    v_cvt_pk_bf16_f32 v100, v168, v169
    v_cvt_pk_bf16_f32 v101, v170, v171
    v_cvt_pk_bf16_f32 v102, v172, v173
    v_cvt_pk_bf16_f32 v103, v174, v175
    v_cvt_pk_bf16_f32 v104, v176, v177
    v_cvt_pk_bf16_f32 v105, v178, v179
    v_cvt_pk_bf16_f32 v106, v180, v181
    v_cvt_pk_bf16_f32 v107, v182, v183
    v_cvt_pk_bf16_f32 v108, v184, v185
    v_cvt_pk_bf16_f32 v109, v186, v187
    buffer_load_dwordx4 v16, s[12:15], s36 offen offset:1024 sc1 lds
    v_cvt_pk_bf16_f32 v110, v188, v189
    v_cvt_pk_bf16_f32 v111, v190, v191
    v_cvt_pk_bf16_f32 v112, v192, v193
    v_cvt_pk_bf16_f32 v113, v194, v195
    v_cvt_pk_bf16_f32 v114, v196, v197
    v_cvt_pk_bf16_f32 v115, v198, v199
gated_mix__ssm_conv_h3__compressed_kv_cla__prompt_kernel_pad8:
    s_cbranch_execz gated_mix__ssm_conv_h3__compressed_kv_cla__prompt_kernel_pad12
    v_cvt_pk_bf16_f32 v116, v200, v201
    v_cvt_pk_bf16_f32 v117, v202, v203
    v_cvt_pk_bf16_f32 v118, v204, v205
    v_cvt_pk_bf16_f32 v119, v206, v207
    v_cvt_pk_bf16_f32 v120, v208, v209
    v_cvt_pk_bf16_f32 v121, v210, v211
    v_cvt_pk_bf16_f32 v122, v212, v213
    v_cvt_pk_bf16_f32 v123, v214, v215
    v_cvt_pk_bf16_f32 v124, v216, v217
    buffer_load_dwordx4 v16, s[12:15], s36 offen offset:2048 sc1 lds
    v_cvt_pk_bf16_f32 v125, v218, v219
    v_cvt_pk_bf16_f32 v126, v220, v221
    v_cvt_pk_bf16_f32 v127, v222, v223
    v_cvt_pk_bf16_f32 v128, v224, v225
    v_cvt_pk_bf16_f32 v129, v226, v227
    v_cvt_pk_bf16_f32 v130, v228, v229
    v_cvt_pk_bf16_f32 v131, v230, v231
    v_cvt_pk_bf16_f32 v132, v232, v233
    v_cvt_pk_bf16_f32 v133, v234, v235
    v_cvt_pk_bf16_f32 v134, v236, v237
    v_cvt_pk_bf16_f32 v135, v238, v239
    v_cvt_pk_bf16_f32 v136, v240, v241
    v_cvt_pk_bf16_f32 v137, v242, v243
    v_cvt_pk_bf16_f32 v138, v244, v245
    v_cvt_pk_bf16_f32 v139, v246, v247
    buffer_load_dwordx4 v16, s[12:15], s36 offen offset:3072 sc1 lds
    v_cvt_pk_bf16_f32 v140, v248, v249
    v_cvt_pk_bf16_f32 v141, v250, v251
    v_cvt_pk_bf16_f32 v142, v252, v253
    v_cvt_pk_bf16_f32 v143, v254, v255
    s_waitcnt vmcnt(4)
    s_barrier
    ds_read_b128 a[128:131], v2 offset:0
    ds_read_b128 a[132:135], v2 offset:1024
    ds_read_b128 a[136:139], v2 offset:2048
    ds_read_b128 a[140:143], v2 offset:3072
    ds_read_b128 a[144:147], v2 offset:4096
    ds_read_b128 a[148:151], v2 offset:5120
    ds_read_b128 a[152:155], v2 offset:6144
    ds_read_b128 a[156:159], v2 offset:7168
    v_mov_b32 v240, 0
    v_mov_b32 v241, 0
    v_mov_b32 v242, 0
    s_add_u32 s36, s59, 49152
    s_add_u32 s37, s59, s48
    s_add_u32 m0, s37, 16384
    s_nop 0
    buffer_load_dwordx4 v16, s[12:15], s36 offen offset:0 sc1 lds
    v_mov_b32 v243, 0
    v_mov_b32 v244, 0
    v_mov_b32 v245, 0
    v_mov_b32 v246, 0
    v_mov_b32 v247, 0
    v_mov_b32 v248, 0
    v_mov_b32 v249, 0
    v_mov_b32 v250, 0
    v_mov_b32 v251, 0
    v_mov_b32 v252, 0
    v_mov_b32 v253, 0
    v_mov_b32 v254, 0
    v_mov_b32 v255, 0
    s_waitcnt lgkmcnt(7)
    v_mfma_f32_16x16x32_bf16 v[144:147], a[128:131], v[80:83], 0
    buffer_load_dwordx4 v16, s[12:15], s36 offen offset:1024 sc1 lds
    v_mfma_f32_16x16x32_bf16 v[152:155], a[128:131], v[96:99], 0
    v_mfma_f32_16x16x32_bf16 v[160:163], a[128:131], v[112:115], 0
    v_mfma_f32_16x16x32_bf16 v[168:171], a[128:131], v[128:131], 0
    s_waitcnt lgkmcnt(6)
    v_mfma_f32_16x16x32_bf16 v[144:147], a[132:135], v[84:87], v[144:147]
    buffer_load_dwordx4 v16, s[12:15], s36 offen offset:2048 sc1 lds
    v_mfma_f32_16x16x32_bf16 v[152:155], a[132:135], v[100:103], v[152:155]
    v_mfma_f32_16x16x32_bf16 v[160:163], a[132:135], v[116:119], v[160:163]
    v_mfma_f32_16x16x32_bf16 v[168:171], a[132:135], v[132:135], v[168:171]
    s_waitcnt lgkmcnt(5)
    v_mfma_f32_16x16x32_bf16 v[144:147], a[136:139], v[88:91], v[144:147]
    buffer_load_dwordx4 v16, s[12:15], s36 offen offset:3072 sc1 lds
    v_mfma_f32_16x16x32_bf16 v[152:155], a[136:139], v[104:107], v[152:155]
    v_mfma_f32_16x16x32_bf16 v[160:163], a[136:139], v[120:123], v[160:163]
    v_mfma_f32_16x16x32_bf16 v[168:171], a[136:139], v[136:139], v[168:171]
    s_waitcnt lgkmcnt(4)
    v_mfma_f32_16x16x32_bf16 v[144:147], a[140:143], v[92:95], v[144:147]
    s_add_u32 s36, s59, 65536
    s_add_u32 s37, s59, s51
    s_mov_b32 m0, s37
    s_nop 0
    buffer_load_dwordx4 v16, s[12:15], s36 offen offset:0 sc1 lds
    v_mfma_f32_16x16x32_bf16 v[152:155], a[140:143], v[108:111], v[152:155]
    v_mfma_f32_16x16x32_bf16 v[160:163], a[140:143], v[124:127], v[160:163]
    v_mfma_f32_16x16x32_bf16 v[168:171], a[140:143], v[140:143], v[168:171]
    s_waitcnt lgkmcnt(3)
    v_mfma_f32_16x16x32_bf16 v[148:151], a[144:147], v[80:83], 0
    buffer_load_dwordx4 v16, s[12:15], s36 offen offset:1024 sc1 lds
    v_mfma_f32_16x16x32_bf16 v[156:159], a[144:147], v[96:99], 0
    v_mfma_f32_16x16x32_bf16 v[164:167], a[144:147], v[112:115], 0
    v_mfma_f32_16x16x32_bf16 v[172:175], a[144:147], v[128:131], 0
    s_waitcnt lgkmcnt(2)
    v_mfma_f32_16x16x32_bf16 v[148:151], a[148:151], v[84:87], v[148:151]
    buffer_load_dwordx4 v16, s[12:15], s36 offen offset:2048 sc1 lds
    v_mfma_f32_16x16x32_bf16 v[156:159], a[148:151], v[100:103], v[156:159]
    v_mfma_f32_16x16x32_bf16 v[164:167], a[148:151], v[116:119], v[164:167]
    v_mfma_f32_16x16x32_bf16 v[172:175], a[148:151], v[132:135], v[172:175]
    s_waitcnt lgkmcnt(1)
    v_mfma_f32_16x16x32_bf16 v[148:151], a[152:155], v[88:91], v[148:151]
    buffer_load_dwordx4 v16, s[12:15], s36 offen offset:3072 sc1 lds
    v_mfma_f32_16x16x32_bf16 v[156:159], a[152:155], v[104:107], v[156:159]
    v_mfma_f32_16x16x32_bf16 v[164:167], a[152:155], v[120:123], v[164:167]
    v_mfma_f32_16x16x32_bf16 v[172:175], a[152:155], v[136:139], v[172:175]
    s_waitcnt lgkmcnt(0)
    v_mfma_f32_16x16x32_bf16 v[148:151], a[156:159], v[92:95], v[148:151]
    s_add_u32 s36, s59, 81920
    s_add_u32 s37, s59, s51
    s_add_u32 m0, s37, 16384
    s_nop 0
    buffer_load_dwordx4 v16, s[12:15], s36 offen offset:0 sc1 lds
    v_mfma_f32_16x16x32_bf16 v[156:159], a[156:159], v[108:111], v[156:159]
    v_mfma_f32_16x16x32_bf16 v[164:167], a[156:159], v[124:127], v[164:167]
    v_mfma_f32_16x16x32_bf16 v[172:175], a[156:159], v[140:143], v[172:175]
    ds_read_b128 a[128:131], v2 offset:16384
    ds_read_b128 a[132:135], v2 offset:17408
    ds_read_b128 a[136:139], v2 offset:18432
    ds_read_b128 a[140:143], v2 offset:19456
    ds_read_b128 a[144:147], v2 offset:20480
    ds_read_b128 a[148:151], v2 offset:21504
    ds_read_b128 a[152:155], v2 offset:22528
    ds_read_b128 a[156:159], v2 offset:23552
    ds_read_b128 a[160:163], v2 offset:8192
    ds_read_b128 a[164:167], v2 offset:9216
    ds_read_b128 a[168:171], v2 offset:10240
    ds_read_b128 a[172:175], v2 offset:11264
    s_cmp_lg_u32 s34, 0
    s_cbranch_scc1 gated_mix__ssm_conv_h3__compressed_kv_cla__prompt_kernel_nomask0
    v_add_f32 v144, v48, v144
    v_add_f32 v145, v49, v145
    v_add_f32 v146, v50, v146
    v_add_f32 v147, v51, v147
    v_add_f32 v148, v52, v148
    v_add_f32 v149, v53, v149
    v_add_f32 v150, v54, v150
    v_add_f32 v151, v55, v151
gated_mix__ssm_conv_h3__compressed_kv_cla__prompt_kernel_nomask0:
    v_max3_f32 v32, v144, v145, v146
    v_max3_f32 v32, v147, v148, v32
    v_max3_f32 v32, v149, v150, v32
    buffer_load_dwordx4 v16, s[12:15], s36 offen offset:1024 sc1 lds
    v_max_f32 v32, v151, v32
    v_max3_f32 v34, v152, v153, v154
    v_max3_f32 v34, v155, v156, v34
    v_max3_f32 v34, v157, v158, v34
    v_max_f32 v34, v159, v34
    v_max3_f32 v36, v160, v161, v162
    v_max3_f32 v36, v163, v164, v36
    v_max3_f32 v36, v165, v166, v36
    v_max_f32 v36, v167, v36
    v_max3_f32 v38, v168, v169, v170
    v_max3_f32 v38, v171, v172, v38
    v_max3_f32 v38, v173, v174, v38
    v_max_f32 v38, v175, v38
    v_mov_b32 v33, v32
    v_mov_b32 v35, v34
    buffer_load_dwordx4 v16, s[12:15], s36 offen offset:2048 sc1 lds
    v_mov_b32 v37, v36
    v_mov_b32 v39, v38
    v_permlane16_swap_b32 v32, v33
    v_permlane16_swap_b32 v34, v35
    v_permlane16_swap_b32 v36, v37
    v_permlane16_swap_b32 v38, v39
    v_max_f32 v32, v32, v33
    v_max_f32 v34, v34, v35
    v_max_f32 v36, v36, v37
    v_max_f32 v38, v38, v39
    v_mov_b32 v33, v32
    v_mov_b32 v35, v34
    v_mov_b32 v37, v36
    v_mov_b32 v39, v38
    v_permlane32_swap_b32 v32, v33
    buffer_load_dwordx4 v16, s[12:15], s36 offen offset:3072 sc1 lds
    v_permlane32_swap_b32 v34, v35
    v_permlane32_swap_b32 v36, v37
    v_permlane32_swap_b32 v38, v39
    v_max_f32 v32, v32, v33
    v_max_f32 v34, v34, v35
    v_max_f32 v36, v36, v37
    v_max_f32 v38, v38, v39
    v_add_f32 v32, 0x41c00000, v32
    v_sub_f32 v64, 0, v32
    v_sub_f32 v65, 0, v32
    v_sub_f32 v66, 0, v32
    v_sub_f32 v67, 0, v32
    v_sub_f32 v144, v144, v32
    v_sub_f32 v145, v145, v32
    v_sub_f32 v146, v146, v32
    s_add_u32 s36, s59, 98304
    s_add_u32 s37, s59, s52
    s_mov_b32 m0, s37
    s_nop 0
    buffer_load_dwordx4 v16, s[12:15], s36 offen offset:0 sc1 lds
    v_sub_f32 v147, v147, v32
    v_sub_f32 v148, v148, v32
    v_sub_f32 v149, v149, v32
    v_sub_f32 v150, v150, v32
    v_sub_f32 v151, v151, v32
    v_add_f32 v34, 0x41c00000, v34
    v_sub_f32 v68, 0, v34
    v_sub_f32 v69, 0, v34
    v_sub_f32 v70, 0, v34
    v_sub_f32 v71, 0, v34
    v_sub_f32 v152, v152, v34
    v_sub_f32 v153, v153, v34
    v_sub_f32 v154, v154, v34
    v_sub_f32 v155, v155, v34
    v_sub_f32 v156, v156, v34
    buffer_load_dwordx4 v16, s[12:15], s36 offen offset:1024 sc1 lds
    v_sub_f32 v157, v157, v34
    v_sub_f32 v158, v158, v34
    v_sub_f32 v159, v159, v34
    v_add_f32 v36, 0x41c00000, v36
    v_sub_f32 v72, 0, v36
    v_sub_f32 v73, 0, v36
    v_sub_f32 v74, 0, v36
    v_sub_f32 v75, 0, v36
    v_sub_f32 v160, v160, v36
    v_sub_f32 v161, v161, v36
    v_sub_f32 v162, v162, v36
    v_sub_f32 v163, v163, v36
    v_sub_f32 v164, v164, v36
    v_sub_f32 v165, v165, v36
    v_sub_f32 v166, v166, v36
    buffer_load_dwordx4 v16, s[12:15], s36 offen offset:2048 sc1 lds
    v_sub_f32 v167, v167, v36
    v_add_f32 v38, 0x41c00000, v38
    v_sub_f32 v76, 0, v38
    v_sub_f32 v77, 0, v38
    v_sub_f32 v78, 0, v38
    v_sub_f32 v79, 0, v38
    v_sub_f32 v168, v168, v38
    v_sub_f32 v169, v169, v38
    v_sub_f32 v170, v170, v38
    v_sub_f32 v171, v171, v38
    v_sub_f32 v172, v172, v38
    v_sub_f32 v173, v173, v38
    v_sub_f32 v174, v174, v38
    v_sub_f32 v175, v175, v38
    v_exp_f32 v4, v168
    v_exp_f32 v5, v169
    s_nop 0
    v_cvt_pk_bf16_f32 v220, v4, v5
    buffer_load_dwordx4 v16, s[12:15], s36 offen offset:3072 sc1 lds
    v_exp_f32 v6, v170
    v_exp_f32 v7, v171
    s_nop 0
    v_cvt_pk_bf16_f32 v221, v6, v7
    v_exp_f32 v8, v172
    v_exp_f32 v9, v173
    s_nop 0
    v_cvt_pk_bf16_f32 v222, v8, v9
    v_or3_b32 v12, v220, v221, v222
    v_exp_f32 v10, v174
    v_exp_f32 v11, v175
    s_nop 0
    v_cvt_pk_bf16_f32 v223, v10, v11
    s_add_u32 s36, s59, 114688
    s_add_u32 s37, s59, s52
    s_add_u32 m0, s37, 16384
    s_nop 0
    buffer_load_dwordx4 v16, s[12:15], s36 offen offset:0 sc1 lds
    v_exp_f32 v4, v160
    v_exp_f32 v5, v161
    s_nop 0
    v_cvt_pk_bf16_f32 v216, v4, v5
    v_or3_b32 v12, v12, v223, v216
    v_exp_f32 v6, v162
    v_exp_f32 v7, v163
    s_nop 0
    v_cvt_pk_bf16_f32 v217, v6, v7
    v_exp_f32 v8, v164
    v_exp_f32 v9, v165
    s_nop 0
    v_cvt_pk_bf16_f32 v218, v8, v9
    buffer_load_dwordx4 v16, s[12:15], s36 offen offset:1024 sc1 lds
    v_or3_b32 v12, v12, v217, v218
    v_exp_f32 v10, v166
    v_exp_f32 v11, v167
    s_nop 0
    v_cvt_pk_bf16_f32 v219, v10, v11
    buffer_load_dwordx4 v16, s[12:15], s36 offen offset:2048 sc1 lds
    buffer_load_dwordx4 v16, s[12:15], s36 offen offset:3072 sc1 lds
    s_movk_i32 s47, 12288
    buffer_load_dwordx4 v[28:31], v16, s[28:31], s47 offen sc1
    buffer_load_dword a200, v15, s[4:7], s54 offen
    s_mov_b32 s48, 0
    v_add_u32 v2, s45, v16
    s_waitcnt vmcnt(18) lgkmcnt(0)
    s_barrier
    s_lshl_b32 s35, s34, 1
    s_add_u32 s35, s35, 1
    s_min_u32 s58, s35, 14
    s_cmp_eq_u32 s34, 7
    s_cselect_b32 s58, s58, s35
    s_nop 0
    s_nop 0
    s_nop 0
    s_nop 0
    s_nop 0
    s_nop 0
    s_nop 0
    s_nop 0
    s_nop 0
    s_nop 0
    s_nop 0
    s_nop 0
gated_mix__ssm_conv_h3__compressed_kv_cla__prompt_kernel_b4_loop:
    v_mfma_f32_16x16x32_bf16 v[176:179], a[128:131], v[80:83], v[64:67]
    s_cmp_eq_u32 s35, 1
    v_exp_f32 v4, v152
    v_mfma_f32_16x16x32_bf16 v[184:187], a[128:131], v[96:99], v[68:71]
    s_cbranch_scc1 gated_mix__ssm_conv_h3__compressed_kv_cla__prompt_kernel_b4_m0
gated_mix__ssm_conv_h3__compressed_kv_cla__prompt_kernel_b4_m0_ret:
    ds_read_b128 a[176:179], v3 offset:12288
    ds_read_b128 a[180:183], v3 offset:13312
    v_mfma_f32_16x16x32_bf16 v[192:195], a[128:131], v[112:115], v[72:75]
    s_waitcnt vmcnt(18)
    ds_read_b128 a[184:187], v3 offset:14336
    v_mfma_f32_16x16x32_bf16 v[200:203], a[128:131], v[128:131], v[76:79]
    s_barrier
    ds_read_b128 a[188:191], v3 offset:15360
    v_mfma_f32_16x16x32_bf16 v[176:179], a[132:135], v[84:87], v[176:179]
    s_mov_b32 m0, s40
    v_exp_f32 v5, v153
    v_mfma_f32_16x16x32_bf16 v[184:187], a[132:135], v[100:103], v[184:187]
    s_add_u32 s43, s38, s49
    v_exp_f32 v6, v154
    v_mfma_f32_16x16x32_bf16 v[192:195], a[132:135], v[116:119], v[192:195]
    ds_read_b128 a[128:131], v2 offset:0
    v_cvt_pk_bf16_f32 v212, v4, v5
    v_mfma_f32_16x16x32_bf16 v[200:203], a[132:135], v[132:135], v[200:203]
    ds_read_b128 a[132:135], v2 offset:1024
    v_or3_b32 v12, v12, v219, v212
    v_mfma_f32_16x16x32_bf16 v[176:179], a[136:139], v[88:91], v[176:179]
    v_exp_f32 v7, v155
    v_mfma_f32_16x16x32_bf16 v[184:187], a[136:139], v[104:107], v[184:187]
    v_exp_f32 v8, v156
    v_mfma_f32_16x16x32_bf16 v[192:195], a[136:139], v[120:123], v[192:195]
    v_exp_f32 v9, v157
    v_mfma_f32_16x16x32_bf16 v[200:203], a[136:139], v[136:139], v[200:203]
    ds_read_b128 a[136:139], v2 offset:2048
    v_cvt_pk_bf16_f32 v213, v6, v7
    v_mfma_f32_16x16x32_bf16 v[176:179], a[140:143], v[92:95], v[176:179]
    v_exp_f32 v10, v158
    v_mfma_f32_16x16x32_bf16 v[184:187], a[140:143], v[108:111], v[184:187]
    v_exp_f32 v11, v159
    v_mfma_f32_16x16x32_bf16 v[192:195], a[140:143], v[124:127], v[192:195]
    v_exp_f32 v4, v144
    v_mfma_f32_16x16x32_bf16 v[200:203], a[140:143], v[140:143], v[200:203]
    s_waitcnt lgkmcnt(11)
    ds_read_b128 a[140:143], v2 offset:3072
    v_cvt_pk_bf16_f32 v214, v8, v9
    v_mfma_f32_16x16x32_bf16 v[180:183], a[144:147], v[80:83], v[64:67]
    v_exp_f32 v5, v145
    v_mfma_f32_16x16x32_bf16 v[188:191], a[144:147], v[96:99], v[68:71]
    v_exp_f32 v6, v146
    v_mfma_f32_16x16x32_bf16 v[196:199], a[144:147], v[112:115], v[72:75]
    v_exp_f32 v7, v147
    v_mfma_f32_16x16x32_bf16 v[204:207], a[144:147], v[128:131], v[76:79]
    ds_read_b128 a[144:147], v2 offset:4096
    v_or3_b32 v12, v12, v213, v214
    v_mfma_f32_16x16x32_bf16 v[180:183], a[148:151], v[84:87], v[180:183]
    buffer_load_dword a200, v19, s[8:11], s46 offen
    v_mfma_f32_16x16x32_bf16 v[188:191], a[148:151], v[100:103], v[188:191]
    v_exp_f32 v8, v148
    v_mfma_f32_16x16x32_bf16 v[196:199], a[148:151], v[116:119], v[196:199]
    v_exp_f32 v9, v149
    v_mfma_f32_16x16x32_bf16 v[204:207], a[148:151], v[132:135], v[204:207]
    ds_read_b128 a[148:151], v2 offset:5120
    v_cvt_pk_bf16_f32 v215, v10, v11
    v_mfma_f32_16x16x32_bf16 v[180:183], a[152:155], v[88:91], v[180:183]
    v_exp_f32 v10, v150
    v_mfma_f32_16x16x32_bf16 v[188:191], a[152:155], v[104:107], v[188:191]
    v_exp_f32 v11, v151
    v_mfma_f32_16x16x32_bf16 v[196:199], a[152:155], v[120:123], v[196:199]
    v_cvt_pk_bf16_f32 v208, v4, v5
    v_or3_b32 v12, v12, v215, v208
    v_mfma_f32_16x16x32_bf16 v[204:207], a[152:155], v[136:139], v[204:207]
    v_cvt_pk_bf16_f32 v209, v6, v7
    v_cvt_pk_bf16_f32 v210, v8, v9
    v_mfma_f32_16x16x32_bf16 v[180:183], a[156:159], v[92:95], v[180:183]
    v_or3_b32 v12, v12, v209, v210
    v_cvt_pk_bf16_f32 v211, v10, v11
    v_mfma_f32_16x16x32_bf16 v[188:191], a[156:159], v[108:111], v[188:191]
    v_bitop3_b32 v12, v12, v211, s42 bitop3:0xa8
    v_cmp_ne_u32 vcc, 0, v12
    v_mfma_f32_16x16x32_bf16 v[196:199], a[156:159], v[124:127], v[196:199]
    s_waitcnt lgkmcnt(10)
    ds_read_b128 a[152:155], v2 offset:6144
    v_mfma_f32_16x16x32_bf16 v[204:207], a[156:159], v[140:143], v[204:207]
    s_cbranch_vccnz gated_mix__ssm_conv_h3__compressed_kv_cla__prompt_kernel_b4_r0
gated_mix__ssm_conv_h3__compressed_kv_cla__prompt_kernel_b4_r0_ret:
    ds_read_b128 a[156:159], v2 offset:7168
    v_mfma_f32_16x16x32_bf16 a[0:3], a[160:163], v[208:211], a[0:3]
    v_mfma_f32_16x16x32_bf16 a[32:35], a[160:163], v[212:215], a[32:35]
    v_mfma_f32_16x16x32_bf16 a[64:67], a[160:163], v[216:219], a[64:67]
    buffer_load_dwordx4 v16, s[12:15], s38 offen offset:0 sc1 lds
    v_mfma_f32_16x16x32_bf16 a[96:99], a[160:163], v[220:223], a[96:99]
    s_cmp_eq_u32 s35, 1
    ds_read_b128 a[160:163], v3 offset:24576
    v_mfma_f32_16x16x32_bf16 a[4:7], a[164:167], v[208:211], a[4:7]
    s_cbranch_scc1 gated_mix__ssm_conv_h3__compressed_kv_cla__prompt_kernel_b4_m1
gated_mix__ssm_conv_h3__compressed_kv_cla__prompt_kernel_b4_m1_ret:
    v_mfma_f32_16x16x32_bf16 a[36:39], a[164:167], v[212:215], a[36:39]
    v_mfma_f32_16x16x32_bf16 a[68:71], a[164:167], v[216:219], a[68:71]
    v_mfma_f32_16x16x32_bf16 a[100:103], a[164:167], v[220:223], a[100:103]
    ds_read_b128 a[164:167], v3 offset:25600
    v_mfma_f32_16x16x32_bf16 a[8:11], a[168:171], v[208:211], a[8:11]
    v_mfma_f32_16x16x32_bf16 a[40:43], a[168:171], v[212:215], a[40:43]
    v_mfma_f32_16x16x32_bf16 a[72:75], a[168:171], v[216:219], a[72:75]
    v_exp_f32 v4, v200
    v_mfma_f32_16x16x32_bf16 a[104:107], a[168:171], v[220:223], a[104:107]
    ds_read_b128 a[168:171], v3 offset:26624
    v_mfma_f32_16x16x32_bf16 a[12:15], a[172:175], v[208:211], a[12:15]
    v_exp_f32 v5, v201
    v_mfma_f32_16x16x32_bf16 a[44:47], a[172:175], v[212:215], a[44:47]
    v_exp_f32 v6, v202
    v_mfma_f32_16x16x32_bf16 a[76:79], a[172:175], v[216:219], a[76:79]
    v_exp_f32 v7, v203
    v_mfma_f32_16x16x32_bf16 a[108:111], a[172:175], v[220:223], a[108:111]
    s_waitcnt lgkmcnt(11)
    ds_read_b128 a[172:175], v3 offset:27648
    v_mfma_f32_16x16x32_bf16 a[16:19], a[176:179], v[208:211], a[16:19]
    buffer_load_dwordx4 v16, s[12:15], s38 offen offset:1024 sc1 lds
    v_mfma_f32_16x16x32_bf16 a[48:51], a[176:179], v[212:215], a[48:51]
    v_exp_f32 v8, v204
    v_mfma_f32_16x16x32_bf16 a[80:83], a[176:179], v[216:219], a[80:83]
    v_exp_f32 v9, v205
    v_mfma_f32_16x16x32_bf16 a[112:115], a[176:179], v[220:223], a[112:115]
    ds_read_b128 a[176:179], v3 offset:28672
    v_cvt_pk_bf16_f32 v236, v4, v5
    v_mfma_f32_16x16x32_bf16 a[20:23], a[180:183], v[208:211], a[20:23]
    v_exp_f32 v10, v206
    v_mfma_f32_16x16x32_bf16 a[52:55], a[180:183], v[212:215], a[52:55]
    v_exp_f32 v11, v207
    v_mfma_f32_16x16x32_bf16 a[84:87], a[180:183], v[216:219], a[84:87]
    v_exp_f32 v4, v192
    v_mfma_f32_16x16x32_bf16 a[116:119], a[180:183], v[220:223], a[116:119]
    ds_read_b128 a[180:183], v3 offset:29696
    v_cvt_pk_bf16_f32 v237, v6, v7
    v_mfma_f32_16x16x32_bf16 a[24:27], a[184:187], v[208:211], a[24:27]
    v_exp_f32 v5, v193
    v_mfma_f32_16x16x32_bf16 a[56:59], a[184:187], v[212:215], a[56:59]
    v_exp_f32 v6, v194
    v_mfma_f32_16x16x32_bf16 a[88:91], a[184:187], v[216:219], a[88:91]
    v_exp_f32 v7, v195
    v_mfma_f32_16x16x32_bf16 a[120:123], a[184:187], v[220:223], a[120:123]
    ds_read_b128 a[184:187], v3 offset:30720
    v_cvt_pk_bf16_f32 v238, v8, v9
    v_mfma_f32_16x16x32_bf16 a[28:31], a[188:191], v[208:211], a[28:31]
    v_exp_f32 v8, v196
    v_mfma_f32_16x16x32_bf16 a[60:63], a[188:191], v[212:215], a[60:63]
    v_exp_f32 v9, v197
    v_mfma_f32_16x16x32_bf16 a[92:95], a[188:191], v[216:219], a[92:95]
    buffer_load_dwordx4 v16, s[12:15], s38 offen offset:2048 sc1 lds
    v_mfma_f32_16x16x32_bf16 a[124:127], a[188:191], v[220:223], a[124:127]
    ds_read_b128 a[188:191], v3 offset:31744
    v_or3_b32 v12, v236, v237, v238
    v_mfma_f32_16x16x32_bf16 v[240:243], v[24:27], v[208:211], v[240:243]
    v_cvt_pk_bf16_f32 v239, v10, v11
    v_cvt_pk_bf16_f32 v232, v4, v5
    v_mfma_f32_16x16x32_bf16 v[244:247], v[24:27], v[212:215], v[244:247]
    v_exp_f32 v10, v198
    v_mfma_f32_16x16x32_bf16 v[248:251], v[24:27], v[216:219], v[248:251]
    v_exp_f32 v11, v199
    v_mfma_f32_16x16x32_bf16 v[252:255], v[24:27], v[220:223], v[252:255]
    s_waitcnt lgkmcnt(12)
    v_exp_f32 v4, v184
    v_mfma_f32_16x16x32_bf16 v[144:147], a[128:131], v[80:83], v[64:67]
    v_exp_f32 v5, v185
    v_mfma_f32_16x16x32_bf16 v[152:155], a[128:131], v[96:99], v[68:71]
    v_or3_b32 v12, v12, v239, v232
    v_cvt_pk_bf16_f32 v233, v6, v7
    v_mfma_f32_16x16x32_bf16 v[160:163], a[128:131], v[112:115], v[72:75]
    v_exp_f32 v6, v186
    v_mfma_f32_16x16x32_bf16 v[168:171], a[128:131], v[128:131], v[76:79]
    ds_read_b128 a[128:131], v2 offset:16384
    v_cvt_pk_bf16_f32 v234, v8, v9
    v_mfma_f32_16x16x32_bf16 v[144:147], a[132:135], v[84:87], v[144:147]
    v_exp_f32 v7, v187
    v_mfma_f32_16x16x32_bf16 v[152:155], a[132:135], v[100:103], v[152:155]
    v_exp_f32 v8, v188
    v_mfma_f32_16x16x32_bf16 v[160:163], a[132:135], v[116:119], v[160:163]
    v_exp_f32 v9, v189
    v_mfma_f32_16x16x32_bf16 v[168:171], a[132:135], v[132:135], v[168:171]
    ds_read_b128 a[132:135], v2 offset:17408
    v_or3_b32 v12, v12, v233, v234
    v_mfma_f32_16x16x32_bf16 v[144:147], a[136:139], v[88:91], v[144:147]
    v_cvt_pk_bf16_f32 v235, v10, v11
    v_cvt_pk_bf16_f32 v228, v4, v5
    v_mfma_f32_16x16x32_bf16 v[152:155], a[136:139], v[104:107], v[152:155]
    buffer_load_dwordx4 v16, s[12:15], s38 offen offset:3072 sc1 lds
    v_mfma_f32_16x16x32_bf16 v[160:163], a[136:139], v[120:123], v[160:163]
    s_mov_b32 m0, s41
    v_exp_f32 v10, v190
    v_mfma_f32_16x16x32_bf16 v[168:171], a[136:139], v[136:139], v[168:171]
    ds_read_b128 a[136:139], v2 offset:18432
    v_or3_b32 v12, v12, v235, v228
    v_mfma_f32_16x16x32_bf16 v[144:147], a[140:143], v[92:95], v[144:147]
    v_exp_f32 v11, v191
    v_mfma_f32_16x16x32_bf16 v[152:155], a[140:143], v[108:111], v[152:155]
    v_exp_f32 v4, v176
    v_mfma_f32_16x16x32_bf16 v[160:163], a[140:143], v[124:127], v[160:163]
    v_exp_f32 v5, v177
    v_mfma_f32_16x16x32_bf16 v[168:171], a[140:143], v[140:143], v[168:171]
    s_waitcnt lgkmcnt(11)
    ds_read_b128 a[140:143], v2 offset:19456
    v_cvt_pk_bf16_f32 v229, v6, v7
    v_mfma_f32_16x16x32_bf16 v[148:151], a[144:147], v[80:83], v[64:67]
    v_exp_f32 v6, v178
    v_mfma_f32_16x16x32_bf16 v[156:159], a[144:147], v[96:99], v[68:71]
    v_exp_f32 v7, v179
    v_mfma_f32_16x16x32_bf16 v[164:167], a[144:147], v[112:115], v[72:75]
    v_cvt_pk_bf16_f32 v230, v8, v9
    v_or3_b32 v12, v12, v229, v230
    v_mfma_f32_16x16x32_bf16 v[172:175], a[144:147], v[128:131], v[76:79]
    ds_read_b128 a[144:147], v2 offset:20480
    v_cvt_pk_bf16_f32 v231, v10, v11
    v_mfma_f32_16x16x32_bf16 v[148:151], a[148:151], v[84:87], v[148:151]
    v_exp_f32 v8, v180
    v_mfma_f32_16x16x32_bf16 v[156:159], a[148:151], v[100:103], v[156:159]
    v_exp_f32 v9, v181
    v_mfma_f32_16x16x32_bf16 v[164:167], a[148:151], v[116:119], v[164:167]
    buffer_load_dwordx4 v16, s[12:15], s43 offen offset:0 sc1 lds
    v_mfma_f32_16x16x32_bf16 v[172:175], a[148:151], v[132:135], v[172:175]
    ds_read_b128 a[148:151], v2 offset:21504
    v_cvt_pk_bf16_f32 v224, v4, v5
    v_mfma_f32_16x16x32_bf16 v[148:151], a[152:155], v[88:91], v[148:151]
    v_exp_f32 v10, v182
    v_mfma_f32_16x16x32_bf16 v[156:159], a[152:155], v[104:107], v[156:159]
    v_exp_f32 v11, v183
    v_mfma_f32_16x16x32_bf16 v[164:167], a[152:155], v[120:123], v[164:167]
    v_or3_b32 v12, v12, v231, v224
    v_cvt_pk_bf16_f32 v225, v6, v7
    v_mfma_f32_16x16x32_bf16 v[172:175], a[152:155], v[136:139], v[172:175]
    ds_read_b128 a[152:155], v2 offset:22528
    v_cvt_pk_bf16_f32 v226, v8, v9
    v_mfma_f32_16x16x32_bf16 v[148:151], a[156:159], v[92:95], v[148:151]
    v_or3_b32 v12, v12, v225, v226
    v_cvt_pk_bf16_f32 v227, v10, v11
    v_mfma_f32_16x16x32_bf16 v[156:159], a[156:159], v[108:111], v[156:159]
    v_bitop3_b32 v12, v12, v227, s42 bitop3:0xa8
    v_cmp_ne_u32 vcc, 0, v12
    v_mfma_f32_16x16x32_bf16 v[164:167], a[156:159], v[124:127], v[164:167]
    s_waitcnt lgkmcnt(11)
    v_mfma_f32_16x16x32_bf16 v[172:175], a[156:159], v[140:143], v[172:175]
    s_cbranch_vccnz gated_mix__ssm_conv_h3__compressed_kv_cla__prompt_kernel_b4_r1
gated_mix__ssm_conv_h3__compressed_kv_cla__prompt_kernel_b4_r1_ret:
    ds_read_b128 a[156:159], v2 offset:23552
    v_mfma_f32_16x16x32_bf16 a[0:3], a[160:163], v[224:227], a[0:3]
    v_mfma_f32_16x16x32_bf16 a[32:35], a[160:163], v[228:231], a[32:35]
    s_add_u32 s38, s38, s44
    v_mfma_f32_16x16x32_bf16 a[64:67], a[160:163], v[232:235], a[64:67]
    s_add_u32 s40, s39, s59
    v_mfma_f32_16x16x32_bf16 a[96:99], a[160:163], v[236:239], a[96:99]
    s_add_u32 s41, s40, s50
    ds_read_b128 a[160:163], v2 offset:8192
    v_mfma_f32_16x16x32_bf16 a[4:7], a[164:167], v[224:227], a[4:7]
    s_mov_b32 s39, s45
    v_mfma_f32_16x16x32_bf16 a[36:39], a[164:167], v[228:231], a[36:39]
    buffer_load_dwordx4 v16, s[12:15], s43 offen offset:1024 sc1 lds
    v_mfma_f32_16x16x32_bf16 a[68:71], a[164:167], v[232:235], a[68:71]
    s_add_u32 s59, s59, s48
    v_mfma_f32_16x16x32_bf16 a[100:103], a[164:167], v[236:239], a[100:103]
    s_add_u32 s45, s45, 32768
    ds_read_b128 a[164:167], v2 offset:9216
    v_mfma_f32_16x16x32_bf16 a[8:11], a[168:171], v[224:227], a[8:11]
    s_cmp_eq_u32 s45, 163840
    v_mfma_f32_16x16x32_bf16 a[40:43], a[168:171], v[228:231], a[40:43]
    s_cselect_b32 s45, 0, s45
    v_mfma_f32_16x16x32_bf16 a[72:75], a[168:171], v[232:235], a[72:75]
    s_add_u32 s46, s46, 1048576
    v_exp_f32 v4, v168
    v_mfma_f32_16x16x32_bf16 a[104:107], a[168:171], v[236:239], a[104:107]
    s_sub_u32 s35, s35, 1
    ds_read_b128 a[168:171], v2 offset:10240
    v_mfma_f32_16x16x32_bf16 a[12:15], a[172:175], v[224:227], a[12:15]
    s_sub_u32 s58, s58, 1
    v_exp_f32 v5, v169
    v_mfma_f32_16x16x32_bf16 a[44:47], a[172:175], v[228:231], a[44:47]
    s_cmp_lg_u32 s58, 0
    v_exp_f32 v6, v170
    v_mfma_f32_16x16x32_bf16 a[76:79], a[172:175], v[232:235], a[76:79]
    v_exp_f32 v7, v171
    v_mfma_f32_16x16x32_bf16 a[108:111], a[172:175], v[236:239], a[108:111]
    s_waitcnt lgkmcnt(11)
    ds_read_b128 a[172:175], v2 offset:11264
    v_cvt_pk_bf16_f32 v220, v4, v5
    v_mfma_f32_16x16x32_bf16 a[16:19], a[176:179], v[224:227], a[16:19]
    v_exp_f32 v8, v172
    v_mfma_f32_16x16x32_bf16 a[48:51], a[176:179], v[228:231], a[48:51]
    v_exp_f32 v9, v173
    v_mfma_f32_16x16x32_bf16 a[80:83], a[176:179], v[232:235], a[80:83]
    v_exp_f32 v10, v174
    v_mfma_f32_16x16x32_bf16 a[112:115], a[176:179], v[236:239], a[112:115]
    buffer_load_dwordx4 v16, s[12:15], s43 offen offset:2048 sc1 lds
    v_mfma_f32_16x16x32_bf16 a[20:23], a[180:183], v[224:227], a[20:23]
    v_exp_f32 v11, v175
    v_mfma_f32_16x16x32_bf16 a[52:55], a[180:183], v[228:231], a[52:55]
    v_exp_f32 v4, v160
    v_mfma_f32_16x16x32_bf16 a[84:87], a[180:183], v[232:235], a[84:87]
    v_exp_f32 v5, v161
    v_mfma_f32_16x16x32_bf16 a[116:119], a[180:183], v[236:239], a[116:119]
    v_cvt_pk_bf16_f32 v221, v6, v7
    v_cvt_pk_bf16_f32 v222, v8, v9
    v_mfma_f32_16x16x32_bf16 a[24:27], a[184:187], v[224:227], a[24:27]
    v_exp_f32 v6, v162
    v_mfma_f32_16x16x32_bf16 a[56:59], a[184:187], v[228:231], a[56:59]
    v_exp_f32 v7, v163
    v_mfma_f32_16x16x32_bf16 a[88:91], a[184:187], v[232:235], a[88:91]
    v_exp_f32 v8, v164
    v_mfma_f32_16x16x32_bf16 a[120:123], a[184:187], v[236:239], a[120:123]
    v_exp_f32 v9, v165
    v_mfma_f32_16x16x32_bf16 a[28:31], a[188:191], v[224:227], a[28:31]
    v_or3_b32 v12, v220, v221, v222
    v_cvt_pk_bf16_f32 v223, v10, v11
    v_mfma_f32_16x16x32_bf16 a[60:63], a[188:191], v[228:231], a[60:63]
    v_exp_f32 v10, v166
    v_mfma_f32_16x16x32_bf16 a[92:95], a[188:191], v[232:235], a[92:95]
    v_exp_f32 v11, v167
    v_mfma_f32_16x16x32_bf16 a[124:127], a[188:191], v[236:239], a[124:127]
    v_cvt_pk_bf16_f32 v216, v4, v5
    v_or3_b32 v12, v12, v223, v216
    v_mfma_f32_16x16x32_bf16 v[240:243], v[24:27], v[224:227], v[240:243]
    v_cvt_pk_bf16_f32 v217, v6, v7
    v_cvt_pk_bf16_f32 v218, v8, v9
    v_mfma_f32_16x16x32_bf16 v[244:247], v[24:27], v[228:231], v[244:247]
    v_or3_b32 v12, v12, v217, v218
    v_cvt_pk_bf16_f32 v219, v10, v11
    v_mfma_f32_16x16x32_bf16 v[248:251], v[24:27], v[232:235], v[248:251]
    buffer_load_dwordx4 v16, s[12:15], s43 offen offset:3072 sc1 lds
    v_mfma_f32_16x16x32_bf16 v[252:255], v[24:27], v[236:239], v[252:255]
    s_waitcnt lgkmcnt(8)
    v_mov_b32 v3, v2
    v_add_u32 v2, s45, v16
    s_cbranch_scc1 gated_mix__ssm_conv_h3__compressed_kv_cla__prompt_kernel_b4_loop
    s_cmp_lg_u32 s35, 0
    s_cbranch_scc1 gated_mix__ssm_conv_h3__compressed_kv_cla__prompt_kernel_b4_sw
    s_add_u32 s24, s94, 67108864
    s_addc_u32 s25, s95, 0
    s_mov_b32 s26, 16777216
    s_lshl_b32 s46, s2, 2
    s_add_u32 s46, s46, s32
    s_lshl_b32 s46, s46, 14
    s_add_u32 s46, s46, 8192
    s_nop 4
    v_accvgpr_read_b32 v36, a0
    v_accvgpr_read_b32 v37, a1
    v_accvgpr_read_b32 v38, a2
    v_accvgpr_read_b32 v39, a3
gated_mix__ssm_conv_h3__compressed_kv_cla__prompt_kernel_pad9:
    s_cbranch_execz gated_mix__ssm_conv_h3__compressed_kv_cla__prompt_kernel_pad13
    v_accvgpr_read_b32 v40, a4
    v_accvgpr_read_b32 v41, a5
    v_accvgpr_read_b32 v42, a6
    v_accvgpr_read_b32 v43, a7
    v_rcp_f32 v32, v240
    s_nop 0
    v_mul_f32 v36, v36, v32
    v_mul_f32 v37, v37, v32
    v_mul_f32 v38, v38, v32
    v_mul_f32 v39, v39, v32
    v_mul_f32 v40, v40, v32
    v_mul_f32 v41, v41, v32
    v_mul_f32 v42, v42, v32
    v_mul_f32 v43, v43, v32
    v_cvt_pk_bf16_f32 v44, v36, v37
    v_cvt_pk_bf16_f32 v45, v38, v39
    v_cvt_pk_bf16_f32 v46, v40, v41
    v_cvt_pk_bf16_f32 v47, v42, v43
    buffer_store_dwordx4 v[44:47], v16, s[16:19], s60 offen offset:0 sc1
    v_accvgpr_read_b32 v36, a8
    v_accvgpr_read_b32 v37, a9
    v_accvgpr_read_b32 v38, a10
    v_accvgpr_read_b32 v39, a11
    v_accvgpr_read_b32 v40, a12
    v_accvgpr_read_b32 v41, a13
    v_accvgpr_read_b32 v42, a14
    v_accvgpr_read_b32 v43, a15
    v_mul_f32 v36, v36, v32
    v_mul_f32 v37, v37, v32
    v_mul_f32 v38, v38, v32
    v_mul_f32 v39, v39, v32
    v_mul_f32 v40, v40, v32
    v_mul_f32 v41, v41, v32
    v_mul_f32 v42, v42, v32
    v_mul_f32 v43, v43, v32
    v_cvt_pk_bf16_f32 v20, v36, v37
    v_cvt_pk_bf16_f32 v21, v38, v39
    v_cvt_pk_bf16_f32 v22, v40, v41
    v_cvt_pk_bf16_f32 v23, v42, v43
    buffer_store_dwordx4 v[20:23], v16, s[16:19], s60 offen offset:1024 sc1
    v_accvgpr_read_b32 v36, a16
    v_accvgpr_read_b32 v37, a17
    v_accvgpr_read_b32 v38, a18
    v_accvgpr_read_b32 v39, a19
    v_accvgpr_read_b32 v40, a20
    v_accvgpr_read_b32 v41, a21
    v_accvgpr_read_b32 v42, a22
    v_accvgpr_read_b32 v43, a23
    v_mul_f32 v36, v36, v32
    v_mul_f32 v37, v37, v32
    v_mul_f32 v38, v38, v32
    v_mul_f32 v39, v39, v32
    v_mul_f32 v40, v40, v32
    v_mul_f32 v41, v41, v32
    v_mul_f32 v42, v42, v32
    v_mul_f32 v43, v43, v32
    v_cvt_pk_bf16_f32 v44, v36, v37
    v_cvt_pk_bf16_f32 v45, v38, v39
    v_cvt_pk_bf16_f32 v46, v40, v41
    v_cvt_pk_bf16_f32 v47, v42, v43
    buffer_store_dwordx4 v[44:47], v16, s[16:19], s60 offen offset:2048 sc1
    v_accvgpr_read_b32 v36, a24
    v_accvgpr_read_b32 v37, a25
    v_accvgpr_read_b32 v38, a26
    v_accvgpr_read_b32 v39, a27
    v_accvgpr_read_b32 v40, a28
    v_accvgpr_read_b32 v41, a29
    v_accvgpr_read_b32 v42, a30
    v_accvgpr_read_b32 v43, a31
    v_mul_f32 v36, v36, v32
    v_mul_f32 v37, v37, v32
    v_mul_f32 v38, v38, v32
    v_mul_f32 v39, v39, v32
    v_mul_f32 v40, v40, v32
    v_mul_f32 v41, v41, v32
    v_mul_f32 v42, v42, v32
    v_mul_f32 v43, v43, v32
    v_cvt_pk_bf16_f32 v20, v36, v37
    v_cvt_pk_bf16_f32 v21, v38, v39
    v_cvt_pk_bf16_f32 v22, v40, v41
    v_cvt_pk_bf16_f32 v23, v42, v43
    buffer_store_dwordx4 v[20:23], v16, s[16:19], s60 offen offset:3072 sc1
    v_mfma_f32_16x16x32_bf16 v[184:187], a[128:131], v[96:99], v[68:71]
    ds_read_b128 a[176:179], v3 offset:12288
    ds_read_b128 a[180:183], v3 offset:13312
    v_mfma_f32_16x16x32_bf16 v[192:195], a[128:131], v[112:115], v[72:75]
    v_mov_b32 v20, -1
    v_mov_b32 v21, -1
    v_mfma_f32_16x16x32_bf16 v[200:203], a[128:131], v[128:131], v[76:79]
    s_waitcnt vmcnt(16)
    ds_read_b128 a[184:187], v3 offset:14336
    v_mov_b32 v22, -1
    v_mfma_f32_16x16x32_bf16 v[184:187], a[132:135], v[100:103], v[184:187]
    s_barrier
    ds_read_b128 a[188:191], v3 offset:15360
    v_mov_b32 v23, -1
    v_mfma_f32_16x16x32_bf16 v[192:195], a[132:135], v[116:119], v[192:195]
    s_mov_b32 m0, s40
    v_add_f32 v152, v48, v152
    v_add_f32 v153, v49, v153
    v_mfma_f32_16x16x32_bf16 v[200:203], a[132:135], v[132:135], v[200:203]
    s_add_u32 s43, s38, s49
    v_add_f32 v154, v50, v154
    v_add_f32 v155, v51, v155
    v_mfma_f32_16x16x32_bf16 v[184:187], a[136:139], v[104:107], v[184:187]
    v_add_f32 v156, v52, v156
    v_add_f32 v157, v53, v157
    v_mfma_f32_16x16x32_bf16 v[192:195], a[136:139], v[120:123], v[192:195]
    v_add_f32 v158, v54, v158
    v_add_f32 v159, v55, v159
    v_mfma_f32_16x16x32_bf16 v[200:203], a[136:139], v[136:139], v[200:203]
    v_exp_f32 v4, v152
    v_mfma_f32_16x16x32_bf16 v[184:187], a[140:143], v[108:111], v[184:187]
    v_exp_f32 v5, v153
    v_mfma_f32_16x16x32_bf16 v[192:195], a[140:143], v[124:127], v[192:195]
    v_exp_f32 v6, v154
    v_mfma_f32_16x16x32_bf16 v[200:203], a[140:143], v[140:143], v[200:203]
    s_waitcnt lgkmcnt(8)
    v_exp_f32 v7, v155
    v_mfma_f32_16x16x32_bf16 v[188:191], a[144:147], v[96:99], v[68:71]
    v_exp_f32 v8, v156
    v_mfma_f32_16x16x32_bf16 v[196:199], a[144:147], v[112:115], v[72:75]
    buffer_store_dwordx4 v[20:23], v16, s[24:27], s46 offen offset:0 sc1
    v_mfma_f32_16x16x32_bf16 v[204:207], a[144:147], v[128:131], v[76:79]
    v_exp_f32 v9, v157
    v_mfma_f32_16x16x32_bf16 v[188:191], a[148:151], v[100:103], v[188:191]
    v_exp_f32 v10, v158
    v_mfma_f32_16x16x32_bf16 v[196:199], a[148:151], v[116:119], v[196:199]
    v_exp_f32 v11, v159
    v_mfma_f32_16x16x32_bf16 v[204:207], a[148:151], v[132:135], v[204:207]
    v_cvt_pk_bf16_f32 v212, v4, v5
    v_or3_b32 v12, v12, v219, v212
    v_mfma_f32_16x16x32_bf16 v[188:191], a[152:155], v[104:107], v[188:191]
    v_cvt_pk_bf16_f32 v213, v6, v7
    v_cvt_pk_bf16_f32 v214, v8, v9
    v_mfma_f32_16x16x32_bf16 v[196:199], a[152:155], v[120:123], v[196:199]
    v_or3_b32 v12, v12, v213, v214
    v_cvt_pk_bf16_f32 v215, v10, v11
    v_mfma_f32_16x16x32_bf16 v[204:207], a[152:155], v[136:139], v[204:207]
    v_bitop3_b32 v12, v12, v215, s42 bitop3:0xa8
    v_cmp_ne_u32 vcc, 0, v12
    v_mfma_f32_16x16x32_bf16 v[188:191], a[156:159], v[108:111], v[188:191]
    buffer_store_dwordx4 v[20:23], v16, s[24:27], s46 offen offset:1024 sc1
    v_mfma_f32_16x16x32_bf16 v[196:199], a[156:159], v[124:127], v[196:199]
    s_waitcnt lgkmcnt(4)
    ds_read_b128 a[128:131], v2 offset:0
    ds_read_b128 a[132:135], v2 offset:1024
    v_mfma_f32_16x16x32_bf16 v[204:207], a[156:159], v[140:143], v[204:207]
    s_cbranch_vccnz gated_mix__ssm_conv_h3__compressed_kv_cla__prompt_kernel_b3_r0
gated_mix__ssm_conv_h3__compressed_kv_cla__prompt_kernel_b3_r0_ret:
    ds_read_b128 a[136:139], v2 offset:2048
    ds_read_b128 a[140:143], v2 offset:3072
    v_mfma_f32_16x16x32_bf16 a[32:35], a[160:163], v[212:215], a[32:35]
    ds_read_b128 a[144:147], v2 offset:4096
    ds_read_b128 a[148:151], v2 offset:5120
    v_mfma_f32_16x16x32_bf16 a[64:67], a[160:163], v[216:219], a[64:67]
    ds_read_b128 a[152:155], v2 offset:6144
    ds_read_b128 a[156:159], v2 offset:7168
    v_mfma_f32_16x16x32_bf16 a[96:99], a[160:163], v[220:223], a[96:99]
    v_exp_f32 v4, v200
    v_mfma_f32_16x16x32_bf16 a[36:39], a[164:167], v[212:215], a[36:39]
    v_exp_f32 v5, v201
    v_mfma_f32_16x16x32_bf16 a[68:71], a[164:167], v[216:219], a[68:71]
    v_exp_f32 v6, v202
    v_mfma_f32_16x16x32_bf16 a[100:103], a[164:167], v[220:223], a[100:103]
    buffer_store_dwordx4 v[20:23], v16, s[24:27], s46 offen offset:2048 sc1
    v_mfma_f32_16x16x32_bf16 a[40:43], a[168:171], v[212:215], a[40:43]
    v_exp_f32 v7, v203
    v_mfma_f32_16x16x32_bf16 a[72:75], a[168:171], v[216:219], a[72:75]
    ds_read_b128 a[160:163], v3 offset:24576
    v_cvt_pk_bf16_f32 v236, v4, v5
    v_mfma_f32_16x16x32_bf16 a[104:107], a[168:171], v[220:223], a[104:107]
    v_exp_f32 v8, v204
    v_mfma_f32_16x16x32_bf16 a[44:47], a[172:175], v[212:215], a[44:47]
    v_exp_f32 v9, v205
    v_mfma_f32_16x16x32_bf16 a[76:79], a[172:175], v[216:219], a[76:79]
    ds_read_b128 a[164:167], v3 offset:25600
    v_cvt_pk_bf16_f32 v237, v6, v7
    v_mfma_f32_16x16x32_bf16 a[108:111], a[172:175], v[220:223], a[108:111]
    s_waitcnt lgkmcnt(10)
    ds_read_b128 a[168:171], v3 offset:26624
    v_cvt_pk_bf16_f32 v238, v8, v9
    v_mfma_f32_16x16x32_bf16 a[48:51], a[176:179], v[212:215], a[48:51]
    v_exp_f32 v10, v206
    v_mfma_f32_16x16x32_bf16 a[80:83], a[176:179], v[216:219], a[80:83]
    buffer_store_dwordx4 v[20:23], v16, s[24:27], s46 offen offset:3072 sc1
    v_mfma_f32_16x16x32_bf16 a[112:115], a[176:179], v[220:223], a[112:115]
    v_exp_f32 v11, v207
    v_mfma_f32_16x16x32_bf16 a[52:55], a[180:183], v[212:215], a[52:55]
    ds_read_b128 a[172:175], v3 offset:27648
    v_or3_b32 v12, v236, v237, v238
    v_mfma_f32_16x16x32_bf16 a[84:87], a[180:183], v[216:219], a[84:87]
    v_exp_f32 v4, v192
    v_mfma_f32_16x16x32_bf16 a[116:119], a[180:183], v[220:223], a[116:119]
    v_exp_f32 v5, v193
    v_mfma_f32_16x16x32_bf16 a[56:59], a[184:187], v[212:215], a[56:59]
    ds_read_b128 a[176:179], v3 offset:28672
    v_cvt_pk_bf16_f32 v239, v10, v11
    v_mfma_f32_16x16x32_bf16 a[88:91], a[184:187], v[216:219], a[88:91]
    ds_read_b128 a[180:183], v3 offset:29696
    v_cvt_pk_bf16_f32 v232, v4, v5
    v_mfma_f32_16x16x32_bf16 a[120:123], a[184:187], v[220:223], a[120:123]
    v_exp_f32 v6, v194
    v_mfma_f32_16x16x32_bf16 a[60:63], a[188:191], v[212:215], a[60:63]
    buffer_load_dwordx4 v16, s[12:15], s38 offen offset:0 sc1 lds
    v_mfma_f32_16x16x32_bf16 a[92:95], a[188:191], v[216:219], a[92:95]
    v_exp_f32 v7, v195
    v_mfma_f32_16x16x32_bf16 a[124:127], a[188:191], v[220:223], a[124:127]
    ds_read_b128 a[184:187], v3 offset:30720
    v_or3_b32 v12, v12, v239, v232
    v_mfma_f32_16x16x32_bf16 v[244:247], v[24:27], v[212:215], v[244:247]
    v_exp_f32 v8, v196
    v_mfma_f32_16x16x32_bf16 v[248:251], v[24:27], v[216:219], v[248:251]
    v_exp_f32 v9, v197
    v_mfma_f32_16x16x32_bf16 v[252:255], v[24:27], v[220:223], v[252:255]
    s_waitcnt lgkmcnt(11)
    v_exp_f32 v10, v198
    v_mfma_f32_16x16x32_bf16 v[152:155], a[128:131], v[96:99], v[68:71]
    v_exp_f32 v11, v199
    v_mfma_f32_16x16x32_bf16 v[160:163], a[128:131], v[112:115], v[72:75]
    v_cvt_pk_bf16_f32 v233, v6, v7
    v_cvt_pk_bf16_f32 v234, v8, v9
    v_mfma_f32_16x16x32_bf16 v[168:171], a[128:131], v[128:131], v[76:79]
    buffer_load_dwordx4 v16, s[12:15], s38 offen offset:1024 sc1 lds
    v_mfma_f32_16x16x32_bf16 v[152:155], a[132:135], v[100:103], v[152:155]
    v_or3_b32 v12, v12, v233, v234
    v_cvt_pk_bf16_f32 v235, v10, v11
    v_mfma_f32_16x16x32_bf16 v[160:163], a[132:135], v[116:119], v[160:163]
    v_add_f32 v184, v56, v184
    v_add_f32 v185, v57, v185
    v_mfma_f32_16x16x32_bf16 v[168:171], a[132:135], v[132:135], v[168:171]
    v_add_f32 v186, v58, v186
    v_add_f32 v187, v59, v187
    v_mfma_f32_16x16x32_bf16 v[152:155], a[136:139], v[104:107], v[152:155]
    v_add_f32 v188, v60, v188
    v_add_f32 v189, v61, v189
    v_mfma_f32_16x16x32_bf16 v[160:163], a[136:139], v[120:123], v[160:163]
    v_add_f32 v190, v62, v190
    v_add_f32 v191, v63, v191
    v_mfma_f32_16x16x32_bf16 v[168:171], a[136:139], v[136:139], v[168:171]
    v_exp_f32 v4, v184
    v_mfma_f32_16x16x32_bf16 v[152:155], a[140:143], v[108:111], v[152:155]
    buffer_load_dwordx4 v16, s[12:15], s38 offen offset:2048 sc1 lds
    v_mfma_f32_16x16x32_bf16 v[160:163], a[140:143], v[124:127], v[160:163]
    v_exp_f32 v5, v185
    v_mfma_f32_16x16x32_bf16 v[168:171], a[140:143], v[140:143], v[168:171]
    s_waitcnt lgkmcnt(7)
    v_exp_f32 v6, v186
    v_mfma_f32_16x16x32_bf16 v[156:159], a[144:147], v[96:99], v[68:71]
    v_exp_f32 v7, v187
    v_mfma_f32_16x16x32_bf16 v[164:167], a[144:147], v[112:115], v[72:75]
    v_exp_f32 v8, v188
    v_mfma_f32_16x16x32_bf16 v[172:175], a[144:147], v[128:131], v[76:79]
    v_exp_f32 v9, v189
    v_mfma_f32_16x16x32_bf16 v[156:159], a[148:151], v[100:103], v[156:159]
    v_exp_f32 v10, v190
    v_mfma_f32_16x16x32_bf16 v[164:167], a[148:151], v[116:119], v[164:167]
    v_exp_f32 v11, v191
    v_mfma_f32_16x16x32_bf16 v[172:175], a[148:151], v[132:135], v[172:175]
    buffer_load_dwordx4 v16, s[12:15], s38 offen offset:3072 sc1 lds
    v_mfma_f32_16x16x32_bf16 v[156:159], a[152:155], v[104:107], v[156:159]
    s_mov_b32 m0, s41
    v_cvt_pk_bf16_f32 v228, v4, v5
    v_or3_b32 v12, v12, v235, v228
    v_mfma_f32_16x16x32_bf16 v[164:167], a[152:155], v[120:123], v[164:167]
    v_cvt_pk_bf16_f32 v229, v6, v7
    v_cvt_pk_bf16_f32 v230, v8, v9
    v_mfma_f32_16x16x32_bf16 v[172:175], a[152:155], v[136:139], v[172:175]
    v_or3_b32 v12, v12, v229, v230
    v_cvt_pk_bf16_f32 v231, v10, v11
    v_mfma_f32_16x16x32_bf16 v[156:159], a[156:159], v[108:111], v[156:159]
    v_bitop3_b32 v12, v12, v231, s42 bitop3:0xa8
    v_cmp_ne_u32 vcc, 0, v12
    v_mfma_f32_16x16x32_bf16 v[164:167], a[156:159], v[124:127], v[164:167]
    s_waitcnt lgkmcnt(3)
    ds_read_b128 a[188:191], v3 offset:31744
    v_mfma_f32_16x16x32_bf16 v[172:175], a[156:159], v[140:143], v[172:175]
    s_cbranch_vccnz gated_mix__ssm_conv_h3__compressed_kv_cla__prompt_kernel_b3_r1
gated_mix__ssm_conv_h3__compressed_kv_cla__prompt_kernel_b3_r1_ret:
    ds_read_b128 a[128:131], v2 offset:16384
    v_mfma_f32_16x16x32_bf16 a[32:35], a[160:163], v[228:231], a[32:35]
    ds_read_b128 a[132:135], v2 offset:17408
    v_mfma_f32_16x16x32_bf16 a[64:67], a[160:163], v[232:235], a[64:67]
    buffer_load_dwordx4 v16, s[12:15], s43 offen offset:0 sc1 lds
    v_mfma_f32_16x16x32_bf16 a[96:99], a[160:163], v[236:239], a[96:99]
    s_add_u32 s38, s38, s44
    ds_read_b128 a[136:139], v2 offset:18432
    v_mfma_f32_16x16x32_bf16 a[36:39], a[164:167], v[228:231], a[36:39]
    s_add_u32 s40, s39, s59
    ds_read_b128 a[140:143], v2 offset:19456
    v_mfma_f32_16x16x32_bf16 a[68:71], a[164:167], v[232:235], a[68:71]
    s_add_u32 s41, s40, s50
    ds_read_b128 a[144:147], v2 offset:20480
    v_mfma_f32_16x16x32_bf16 a[100:103], a[164:167], v[236:239], a[100:103]
    s_mov_b32 s39, s45
    ds_read_b128 a[148:151], v2 offset:21504
    v_mfma_f32_16x16x32_bf16 a[40:43], a[168:171], v[228:231], a[40:43]
    s_add_u32 s59, s59, s48
    ds_read_b128 a[152:155], v2 offset:22528
    v_mfma_f32_16x16x32_bf16 a[72:75], a[168:171], v[232:235], a[72:75]
    s_add_u32 s45, s45, 32768
    ds_read_b128 a[156:159], v2 offset:23552
    v_mfma_f32_16x16x32_bf16 a[104:107], a[168:171], v[236:239], a[104:107]
    s_cmp_eq_u32 s45, 163840
    ds_read_b128 a[160:163], v2 offset:8192
    v_mfma_f32_16x16x32_bf16 a[44:47], a[172:175], v[228:231], a[44:47]
    buffer_load_dwordx4 v16, s[12:15], s43 offen offset:1024 sc1 lds
    v_mfma_f32_16x16x32_bf16 a[76:79], a[172:175], v[232:235], a[76:79]
    s_cselect_b32 s45, 0, s45
    ds_read_b128 a[164:167], v2 offset:9216
    v_mfma_f32_16x16x32_bf16 a[108:111], a[172:175], v[236:239], a[108:111]
    s_waitcnt lgkmcnt(10)
    ds_read_b128 a[168:171], v2 offset:10240
    v_mfma_f32_16x16x32_bf16 a[48:51], a[176:179], v[228:231], a[48:51]
    ds_read_b128 a[172:175], v2 offset:11264
    v_mfma_f32_16x16x32_bf16 a[80:83], a[176:179], v[232:235], a[80:83]
    v_exp_f32 v4, v168
    v_mfma_f32_16x16x32_bf16 a[112:115], a[176:179], v[236:239], a[112:115]
    v_exp_f32 v5, v169
    v_mfma_f32_16x16x32_bf16 a[52:55], a[180:183], v[228:231], a[52:55]
    v_exp_f32 v6, v170
    v_mfma_f32_16x16x32_bf16 a[84:87], a[180:183], v[232:235], a[84:87]
    v_exp_f32 v7, v171
    v_mfma_f32_16x16x32_bf16 a[116:119], a[180:183], v[236:239], a[116:119]
    buffer_load_dwordx4 v16, s[12:15], s43 offen offset:2048 sc1 lds
    v_mfma_f32_16x16x32_bf16 a[56:59], a[184:187], v[228:231], a[56:59]
    v_exp_f32 v8, v172
    v_mfma_f32_16x16x32_bf16 a[88:91], a[184:187], v[232:235], a[88:91]
    v_exp_f32 v9, v173
    v_mfma_f32_16x16x32_bf16 a[120:123], a[184:187], v[236:239], a[120:123]
    v_exp_f32 v10, v174
    v_mfma_f32_16x16x32_bf16 a[60:63], a[188:191], v[228:231], a[60:63]
    v_exp_f32 v11, v175
    v_mfma_f32_16x16x32_bf16 a[92:95], a[188:191], v[232:235], a[92:95]
    v_cvt_pk_bf16_f32 v220, v4, v5
    v_mfma_f32_16x16x32_bf16 a[124:127], a[188:191], v[236:239], a[124:127]
    v_cvt_pk_bf16_f32 v221, v6, v7
    v_cvt_pk_bf16_f32 v222, v8, v9
    v_mfma_f32_16x16x32_bf16 v[244:247], v[24:27], v[228:231], v[244:247]
    v_or3_b32 v12, v220, v221, v222
    v_cvt_pk_bf16_f32 v223, v10, v11
    v_mfma_f32_16x16x32_bf16 v[248:251], v[24:27], v[232:235], v[248:251]
    buffer_load_dwordx4 v16, s[12:15], s43 offen offset:3072 sc1 lds
    v_mfma_f32_16x16x32_bf16 v[252:255], v[24:27], v[236:239], v[252:255]
    s_waitcnt lgkmcnt(8)
    v_mov_b32 v3, v2
    v_add_u32 v2, s45, v16
    s_nop 4
    v_accvgpr_read_b32 v36, a32
    v_accvgpr_read_b32 v37, a33
    v_accvgpr_read_b32 v38, a34
    v_accvgpr_read_b32 v39, a35
    v_accvgpr_read_b32 v40, a36
    v_accvgpr_read_b32 v41, a37
    v_accvgpr_read_b32 v42, a38
    v_accvgpr_read_b32 v43, a39
    v_rcp_f32 v32, v244
    s_nop 0
    v_mul_f32 v36, v36, v32
    v_mul_f32 v37, v37, v32
    v_mul_f32 v38, v38, v32
    v_mul_f32 v39, v39, v32
    v_mul_f32 v40, v40, v32
    v_mul_f32 v41, v41, v32
    v_mul_f32 v42, v42, v32
    v_mul_f32 v43, v43, v32
    v_cvt_pk_bf16_f32 v44, v36, v37
    v_cvt_pk_bf16_f32 v45, v38, v39
    v_cvt_pk_bf16_f32 v46, v40, v41
    v_cvt_pk_bf16_f32 v47, v42, v43
    buffer_store_dwordx4 v[44:47], v16, s[16:19], s61 offen offset:0 sc1
    v_accvgpr_read_b32 v36, a40
    v_accvgpr_read_b32 v37, a41
    v_accvgpr_read_b32 v38, a42
    v_accvgpr_read_b32 v39, a43
    v_accvgpr_read_b32 v40, a44
    v_accvgpr_read_b32 v41, a45
    v_accvgpr_read_b32 v42, a46
    v_accvgpr_read_b32 v43, a47
    v_mul_f32 v36, v36, v32
    v_mul_f32 v37, v37, v32
    v_mul_f32 v38, v38, v32
    v_mul_f32 v39, v39, v32
    v_mul_f32 v40, v40, v32
    v_mul_f32 v41, v41, v32
    v_mul_f32 v42, v42, v32
    v_mul_f32 v43, v43, v32
    v_cvt_pk_bf16_f32 v20, v36, v37
    v_cvt_pk_bf16_f32 v21, v38, v39
    v_cvt_pk_bf16_f32 v22, v40, v41
    v_cvt_pk_bf16_f32 v23, v42, v43
    buffer_store_dwordx4 v[20:23], v16, s[16:19], s61 offen offset:1024 sc1
    v_accvgpr_read_b32 v36, a48
    v_accvgpr_read_b32 v37, a49
    v_accvgpr_read_b32 v38, a50
    v_accvgpr_read_b32 v39, a51
    v_accvgpr_read_b32 v40, a52
    v_accvgpr_read_b32 v41, a53
    v_accvgpr_read_b32 v42, a54
    v_accvgpr_read_b32 v43, a55
    v_mul_f32 v36, v36, v32
    v_mul_f32 v37, v37, v32
    v_mul_f32 v38, v38, v32
    v_mul_f32 v39, v39, v32
    v_mul_f32 v40, v40, v32
    v_mul_f32 v41, v41, v32
    v_mul_f32 v42, v42, v32
    v_mul_f32 v43, v43, v32
    v_cvt_pk_bf16_f32 v44, v36, v37
    v_cvt_pk_bf16_f32 v45, v38, v39
    v_cvt_pk_bf16_f32 v46, v40, v41
    v_cvt_pk_bf16_f32 v47, v42, v43
    buffer_store_dwordx4 v[44:47], v16, s[16:19], s61 offen offset:2048 sc1
    v_accvgpr_read_b32 v36, a56
    v_accvgpr_read_b32 v37, a57
    v_accvgpr_read_b32 v38, a58
    v_accvgpr_read_b32 v39, a59
    v_accvgpr_read_b32 v40, a60
    v_accvgpr_read_b32 v41, a61
    v_accvgpr_read_b32 v42, a62
    v_accvgpr_read_b32 v43, a63
    v_mul_f32 v36, v36, v32
    v_mul_f32 v37, v37, v32
    v_mul_f32 v38, v38, v32
    v_mul_f32 v39, v39, v32
    v_mul_f32 v40, v40, v32
    v_mul_f32 v41, v41, v32
    v_mul_f32 v42, v42, v32
    v_mul_f32 v43, v43, v32
    v_cvt_pk_bf16_f32 v20, v36, v37
    v_cvt_pk_bf16_f32 v21, v38, v39
    v_cvt_pk_bf16_f32 v22, v40, v41
    v_cvt_pk_bf16_f32 v23, v42, v43
    buffer_store_dwordx4 v[20:23], v16, s[16:19], s61 offen offset:3072 sc1
    s_lshl_b32 s35, s34, 2
    s_sub_u32 s35, 29, s35
    s_sub_u32 s58, s35, 3
    s_cmp_eq_u32 s34, 7
    s_cselect_b32 s58, s35, s58
    s_nop 0
    s_nop 0
    s_nop 0
    s_nop 0
    s_nop 0
    s_nop 0
gated_mix__ssm_conv_h3__compressed_kv_cla__prompt_kernel_b2_loop:
    v_mfma_f32_16x16x32_bf16 v[192:195], a[128:131], v[112:115], v[72:75]
    s_cmp_eq_u32 s35, 1
    ds_read_b128 a[176:179], v3 offset:12288
    ds_read_b128 a[180:183], v3 offset:13312
    v_mfma_f32_16x16x32_bf16 v[200:203], a[128:131], v[128:131], v[76:79]
    s_cbranch_scc1 gated_mix__ssm_conv_h3__compressed_kv_cla__prompt_kernel_b2_m0
gated_mix__ssm_conv_h3__compressed_kv_cla__prompt_kernel_b2_m0_ret:
    ds_read_b128 a[184:187], v3 offset:14336
    v_exp_f32 v4, v160
    v_mfma_f32_16x16x32_bf16 v[192:195], a[132:135], v[116:119], v[192:195]
    s_waitcnt vmcnt(16)
    ds_read_b128 a[188:191], v3 offset:15360
    v_exp_f32 v5, v161
    v_mfma_f32_16x16x32_bf16 v[200:203], a[132:135], v[132:135], v[200:203]
    s_barrier
    ds_read_b128 a[128:131], v2 offset:0
    v_exp_f32 v6, v162
    v_mfma_f32_16x16x32_bf16 v[192:195], a[136:139], v[120:123], v[192:195]
    s_mov_b32 m0, s40
    v_exp_f32 v7, v163
    v_mfma_f32_16x16x32_bf16 v[200:203], a[136:139], v[136:139], v[200:203]
    s_add_u32 s43, s38, s49
    v_exp_f32 v8, v164
    v_mfma_f32_16x16x32_bf16 v[192:195], a[140:143], v[124:127], v[192:195]
    v_exp_f32 v9, v165
    v_mfma_f32_16x16x32_bf16 v[200:203], a[140:143], v[140:143], v[200:203]
    s_waitcnt lgkmcnt(9)
    ds_read_b128 a[132:135], v2 offset:1024
    v_exp_f32 v10, v166
    v_mfma_f32_16x16x32_bf16 v[196:199], a[144:147], v[112:115], v[72:75]
    v_exp_f32 v11, v167
    v_mfma_f32_16x16x32_bf16 v[204:207], a[144:147], v[128:131], v[76:79]
    v_cvt_pk_bf16_f32 v216, v4, v5
    v_or3_b32 v12, v12, v223, v216
    v_mfma_f32_16x16x32_bf16 v[196:199], a[148:151], v[116:119], v[196:199]
    v_cvt_pk_bf16_f32 v217, v6, v7
    v_cvt_pk_bf16_f32 v218, v8, v9
    v_mfma_f32_16x16x32_bf16 v[204:207], a[148:151], v[132:135], v[204:207]
    v_or3_b32 v12, v12, v217, v218
    v_cvt_pk_bf16_f32 v219, v10, v11
    v_mfma_f32_16x16x32_bf16 v[196:199], a[152:155], v[120:123], v[196:199]
    v_bitop3_b32 v12, v12, v219, s42 bitop3:0xa8
    v_cmp_ne_u32 vcc, 0, v12
    v_mfma_f32_16x16x32_bf16 v[204:207], a[152:155], v[136:139], v[204:207]
    buffer_load_dwordx4 v16, s[12:15], s38 offen offset:0 sc1 lds
    v_mfma_f32_16x16x32_bf16 v[196:199], a[156:159], v[124:127], v[196:199]
    s_waitcnt lgkmcnt(6)
    ds_read_b128 a[136:139], v2 offset:2048
    ds_read_b128 a[140:143], v2 offset:3072
    v_mfma_f32_16x16x32_bf16 v[204:207], a[156:159], v[140:143], v[204:207]
    s_cbranch_vccnz gated_mix__ssm_conv_h3__compressed_kv_cla__prompt_kernel_b2_r0
gated_mix__ssm_conv_h3__compressed_kv_cla__prompt_kernel_b2_r0_ret:
    ds_read_b128 a[144:147], v2 offset:4096
    ds_read_b128 a[148:151], v2 offset:5120
    v_mfma_f32_16x16x32_bf16 a[64:67], a[160:163], v[216:219], a[64:67]
    v_exp_f32 v4, v200
    v_mfma_f32_16x16x32_bf16 a[96:99], a[160:163], v[220:223], a[96:99]
    ds_read_b128 a[152:155], v2 offset:6144
    ds_read_b128 a[156:159], v2 offset:7168
    v_mfma_f32_16x16x32_bf16 a[68:71], a[164:167], v[216:219], a[68:71]
    v_exp_f32 v5, v201
    v_mfma_f32_16x16x32_bf16 a[100:103], a[164:167], v[220:223], a[100:103]
    s_cmp_eq_u32 s35, 1
    ds_read_b128 a[160:163], v3 offset:24576
    ds_read_b128 a[164:167], v3 offset:25600
    v_mfma_f32_16x16x32_bf16 a[72:75], a[168:171], v[216:219], a[72:75]
    s_cbranch_scc1 gated_mix__ssm_conv_h3__compressed_kv_cla__prompt_kernel_b2_m1
gated_mix__ssm_conv_h3__compressed_kv_cla__prompt_kernel_b2_m1_ret:
    v_exp_f32 v6, v202
    v_mfma_f32_16x16x32_bf16 a[104:107], a[168:171], v[220:223], a[104:107]
    buffer_load_dwordx4 v16, s[12:15], s38 offen offset:1024 sc1 lds
    v_mfma_f32_16x16x32_bf16 a[76:79], a[172:175], v[216:219], a[76:79]
    v_exp_f32 v7, v203
    v_mfma_f32_16x16x32_bf16 a[108:111], a[172:175], v[220:223], a[108:111]
    s_waitcnt lgkmcnt(10)
    ds_read_b128 a[168:171], v3 offset:26624
    v_cvt_pk_bf16_f32 v236, v4, v5
    v_mfma_f32_16x16x32_bf16 a[80:83], a[176:179], v[216:219], a[80:83]
    v_exp_f32 v8, v204
    v_mfma_f32_16x16x32_bf16 a[112:115], a[176:179], v[220:223], a[112:115]
    ds_read_b128 a[172:175], v3 offset:27648
    ds_read_b128 a[176:179], v3 offset:28672
    v_mfma_f32_16x16x32_bf16 a[84:87], a[180:183], v[216:219], a[84:87]
    v_exp_f32 v9, v205
    v_mfma_f32_16x16x32_bf16 a[116:119], a[180:183], v[220:223], a[116:119]
    ds_read_b128 a[180:183], v3 offset:29696
    v_cvt_pk_bf16_f32 v237, v6, v7
    v_mfma_f32_16x16x32_bf16 a[88:91], a[184:187], v[216:219], a[88:91]
    buffer_load_dwordx4 v16, s[12:15], s38 offen offset:2048 sc1 lds
    v_mfma_f32_16x16x32_bf16 a[120:123], a[184:187], v[220:223], a[120:123]
    v_exp_f32 v10, v206
    v_mfma_f32_16x16x32_bf16 a[92:95], a[188:191], v[216:219], a[92:95]
    ds_read_b128 a[184:187], v3 offset:30720
    v_cvt_pk_bf16_f32 v238, v8, v9
    v_mfma_f32_16x16x32_bf16 a[124:127], a[188:191], v[220:223], a[124:127]
    ds_read_b128 a[188:191], v3 offset:31744
    v_or3_b32 v12, v236, v237, v238
    v_mfma_f32_16x16x32_bf16 v[248:251], v[24:27], v[216:219], v[248:251]
    v_exp_f32 v11, v207
    v_mfma_f32_16x16x32_bf16 v[252:255], v[24:27], v[220:223], v[252:255]
    s_waitcnt lgkmcnt(12)
    v_exp_f32 v4, v192
    v_mfma_f32_16x16x32_bf16 v[160:163], a[128:131], v[112:115], v[72:75]
    v_exp_f32 v5, v193
    v_mfma_f32_16x16x32_bf16 v[168:171], a[128:131], v[128:131], v[76:79]
    ds_read_b128 a[128:131], v2 offset:16384
    v_cvt_pk_bf16_f32 v239, v10, v11
    v_mfma_f32_16x16x32_bf16 v[160:163], a[132:135], v[116:119], v[160:163]
    buffer_load_dwordx4 v16, s[12:15], s38 offen offset:3072 sc1 lds
    v_mfma_f32_16x16x32_bf16 v[168:171], a[132:135], v[132:135], v[168:171]
    s_mov_b32 m0, s41
    v_exp_f32 v6, v194
    v_mfma_f32_16x16x32_bf16 v[160:163], a[136:139], v[120:123], v[160:163]
    v_exp_f32 v7, v195
    v_mfma_f32_16x16x32_bf16 v[168:171], a[136:139], v[136:139], v[168:171]
    v_exp_f32 v8, v196
    v_mfma_f32_16x16x32_bf16 v[160:163], a[140:143], v[124:127], v[160:163]
    v_exp_f32 v9, v197
    v_mfma_f32_16x16x32_bf16 v[168:171], a[140:143], v[140:143], v[168:171]
    s_waitcnt lgkmcnt(9)
    v_exp_f32 v10, v198
    v_mfma_f32_16x16x32_bf16 v[164:167], a[144:147], v[112:115], v[72:75]
    v_exp_f32 v11, v199
    v_mfma_f32_16x16x32_bf16 v[172:175], a[144:147], v[128:131], v[76:79]
    buffer_load_dwordx4 v16, s[12:15], s43 offen offset:0 sc1 lds
    v_mfma_f32_16x16x32_bf16 v[164:167], a[148:151], v[116:119], v[164:167]
    v_cvt_pk_bf16_f32 v232, v4, v5
    v_or3_b32 v12, v12, v239, v232
    v_mfma_f32_16x16x32_bf16 v[172:175], a[148:151], v[132:135], v[172:175]
    v_cvt_pk_bf16_f32 v233, v6, v7
    v_cvt_pk_bf16_f32 v234, v8, v9
    v_mfma_f32_16x16x32_bf16 v[164:167], a[152:155], v[120:123], v[164:167]
    v_or3_b32 v12, v12, v233, v234
    v_cvt_pk_bf16_f32 v235, v10, v11
    v_mfma_f32_16x16x32_bf16 v[172:175], a[152:155], v[136:139], v[172:175]
    s_cmp_eq_u32 s35, 1
    v_bitop3_b32 v12, v12, v235, s42 bitop3:0xa8
    v_cmp_ne_u32 vcc, 0, v12
    v_mfma_f32_16x16x32_bf16 v[164:167], a[156:159], v[124:127], v[164:167]
    s_waitcnt lgkmcnt(5)
    ds_read_b128 a[132:135], v2 offset:17408
    ds_read_b128 a[136:139], v2 offset:18432
    v_mfma_f32_16x16x32_bf16 v[172:175], a[156:159], v[140:143], v[172:175]
    s_cbranch_vccnz gated_mix__ssm_conv_h3__compressed_kv_cla__prompt_kernel_b2_r1
gated_mix__ssm_conv_h3__compressed_kv_cla__prompt_kernel_b2_r1_ret:
    ds_read_b128 a[140:143], v2 offset:19456
    ds_read_b128 a[144:147], v2 offset:20480
    v_mfma_f32_16x16x32_bf16 a[64:67], a[160:163], v[232:235], a[64:67]
    s_cbranch_scc1 gated_mix__ssm_conv_h3__compressed_kv_cla__prompt_kernel_b2_m2
gated_mix__ssm_conv_h3__compressed_kv_cla__prompt_kernel_b2_m2_ret:
    ds_read_b128 a[148:151], v2 offset:21504
    ds_read_b128 a[152:155], v2 offset:22528
    v_mfma_f32_16x16x32_bf16 a[96:99], a[160:163], v[236:239], a[96:99]
    buffer_load_dwordx4 v16, s[12:15], s43 offen offset:1024 sc1 lds
    v_mfma_f32_16x16x32_bf16 a[68:71], a[164:167], v[232:235], a[68:71]
    s_add_u32 s38, s38, s44
    v_exp_f32 v4, v168
    v_mfma_f32_16x16x32_bf16 a[100:103], a[164:167], v[236:239], a[100:103]
    s_add_u32 s40, s39, s59
    ds_read_b128 a[156:159], v2 offset:23552
    ds_read_b128 a[160:163], v2 offset:8192
    v_mfma_f32_16x16x32_bf16 a[72:75], a[168:171], v[232:235], a[72:75]
    s_add_u32 s41, s40, s50
    v_exp_f32 v5, v169
    v_mfma_f32_16x16x32_bf16 a[104:107], a[168:171], v[236:239], a[104:107]
    s_mov_b32 s39, s45
    ds_read_b128 a[164:167], v2 offset:9216
    v_cvt_pk_bf16_f32 v220, v4, v5
    v_mfma_f32_16x16x32_bf16 a[76:79], a[172:175], v[232:235], a[76:79]
    s_add_u32 s59, s59, s48
    v_exp_f32 v6, v170
    v_mfma_f32_16x16x32_bf16 a[108:111], a[172:175], v[236:239], a[108:111]
    s_waitcnt lgkmcnt(10)
    v_exp_f32 v7, v171
    v_mfma_f32_16x16x32_bf16 a[80:83], a[176:179], v[232:235], a[80:83]
    buffer_load_dwordx4 v16, s[12:15], s43 offen offset:2048 sc1 lds
    v_mfma_f32_16x16x32_bf16 a[112:115], a[176:179], v[236:239], a[112:115]
gated_mix__ssm_conv_h3__compressed_kv_cla__prompt_kernel_pad10:
    s_cbranch_execz gated_mix__ssm_conv_h3__compressed_kv_cla__prompt_kernel_pad14
    s_add_u32 s45, s45, 32768
    ds_read_b128 a[168:171], v2 offset:10240
    v_cvt_pk_bf16_f32 v221, v6, v7
    v_mfma_f32_16x16x32_bf16 a[84:87], a[180:183], v[232:235], a[84:87]
    s_cmp_eq_u32 s45, 163840
    v_exp_f32 v8, v172
    v_mfma_f32_16x16x32_bf16 a[116:119], a[180:183], v[236:239], a[116:119]
    s_cselect_b32 s45, 0, s45
    v_exp_f32 v9, v173
    v_mfma_f32_16x16x32_bf16 a[88:91], a[184:187], v[232:235], a[88:91]
    s_sub_u32 s35, s35, 1
    v_exp_f32 v10, v174
    v_mfma_f32_16x16x32_bf16 a[120:123], a[184:187], v[236:239], a[120:123]
    s_sub_u32 s58, s58, 1
    ds_read_b128 a[172:175], v2 offset:11264
    v_cvt_pk_bf16_f32 v222, v8, v9
    v_mfma_f32_16x16x32_bf16 a[92:95], a[188:191], v[232:235], a[92:95]
    s_cmp_lg_u32 s58, 0
    v_exp_f32 v11, v175
    v_mfma_f32_16x16x32_bf16 a[124:127], a[188:191], v[236:239], a[124:127]
    v_or3_b32 v12, v220, v221, v222
    v_cvt_pk_bf16_f32 v223, v10, v11
    v_mfma_f32_16x16x32_bf16 v[248:251], v[24:27], v[232:235], v[248:251]
    buffer_load_dwordx4 v16, s[12:15], s43 offen offset:3072 sc1 lds
    v_mfma_f32_16x16x32_bf16 v[252:255], v[24:27], v[236:239], v[252:255]
    s_waitcnt lgkmcnt(8)
    v_mov_b32 v3, v2
    v_add_u32 v2, s45, v16
    s_cbranch_scc1 gated_mix__ssm_conv_h3__compressed_kv_cla__prompt_kernel_b2_loop
    s_cmp_lg_u32 s35, 0
    s_cbranch_scc1 gated_mix__ssm_conv_h3__compressed_kv_cla__prompt_kernel_b2_sw
    s_waitcnt vmcnt(8)
    v_mov_b32 v13, 0
    v_mov_b32 v14, 1
    buffer_store_dword v14, v13, s[28:31], s55 offen sc1
    s_nop 4
    v_accvgpr_read_b32 v36, a64
    v_accvgpr_read_b32 v37, a65
    v_accvgpr_read_b32 v38, a66
    v_accvgpr_read_b32 v39, a67
    v_accvgpr_read_b32 v40, a68
    v_accvgpr_read_b32 v41, a69
    v_accvgpr_read_b32 v42, a70
    v_accvgpr_read_b32 v43, a71
    v_rcp_f32 v32, v248
    s_nop 0
    v_mul_f32 v36, v36, v32
    v_mul_f32 v37, v37, v32
    v_mul_f32 v38, v38, v32
    v_mul_f32 v39, v39, v32
    v_mul_f32 v40, v40, v32
    v_mul_f32 v41, v41, v32
    v_mul_f32 v42, v42, v32
    v_mul_f32 v43, v43, v32
    v_cvt_pk_bf16_f32 v44, v36, v37
    v_cvt_pk_bf16_f32 v45, v38, v39
    v_cvt_pk_bf16_f32 v46, v40, v41
    v_cvt_pk_bf16_f32 v47, v42, v43
    buffer_store_dwordx4 v[44:47], v16, s[16:19], s62 offen offset:0 sc1
    v_accvgpr_read_b32 v36, a72
    v_accvgpr_read_b32 v37, a73
    v_accvgpr_read_b32 v38, a74
    v_accvgpr_read_b32 v39, a75
    v_accvgpr_read_b32 v40, a76
    v_accvgpr_read_b32 v41, a77
    v_accvgpr_read_b32 v42, a78
    v_accvgpr_read_b32 v43, a79
    v_mul_f32 v36, v36, v32
    v_mul_f32 v37, v37, v32
    v_mul_f32 v38, v38, v32
    v_mul_f32 v39, v39, v32
    v_mul_f32 v40, v40, v32
    v_mul_f32 v41, v41, v32
    v_mul_f32 v42, v42, v32
    v_mul_f32 v43, v43, v32
    v_cvt_pk_bf16_f32 v20, v36, v37
    v_cvt_pk_bf16_f32 v21, v38, v39
    v_cvt_pk_bf16_f32 v22, v40, v41
    v_cvt_pk_bf16_f32 v23, v42, v43
    buffer_store_dwordx4 v[20:23], v16, s[16:19], s62 offen offset:1024 sc1
    v_accvgpr_read_b32 v36, a80
    v_accvgpr_read_b32 v37, a81
    v_accvgpr_read_b32 v38, a82
    v_accvgpr_read_b32 v39, a83
    v_accvgpr_read_b32 v40, a84
    v_accvgpr_read_b32 v41, a85
    v_accvgpr_read_b32 v42, a86
    v_accvgpr_read_b32 v43, a87
    v_mul_f32 v36, v36, v32
    v_mul_f32 v37, v37, v32
    v_mul_f32 v38, v38, v32
    v_mul_f32 v39, v39, v32
    v_mul_f32 v40, v40, v32
    v_mul_f32 v41, v41, v32
    v_mul_f32 v42, v42, v32
    v_mul_f32 v43, v43, v32
    v_cvt_pk_bf16_f32 v44, v36, v37
    v_cvt_pk_bf16_f32 v45, v38, v39
    v_cvt_pk_bf16_f32 v46, v40, v41
    v_cvt_pk_bf16_f32 v47, v42, v43
    buffer_store_dwordx4 v[44:47], v16, s[16:19], s62 offen offset:2048 sc1
    v_accvgpr_read_b32 v36, a88
    v_accvgpr_read_b32 v37, a89
    v_accvgpr_read_b32 v38, a90
    v_accvgpr_read_b32 v39, a91
    v_accvgpr_read_b32 v40, a92
    v_accvgpr_read_b32 v41, a93
    v_accvgpr_read_b32 v42, a94
    v_accvgpr_read_b32 v43, a95
    v_mul_f32 v36, v36, v32
    v_mul_f32 v37, v37, v32
    v_mul_f32 v38, v38, v32
    v_mul_f32 v39, v39, v32
    v_mul_f32 v40, v40, v32
    v_mul_f32 v41, v41, v32
    v_mul_f32 v42, v42, v32
    v_mul_f32 v43, v43, v32
    v_cvt_pk_bf16_f32 v20, v36, v37
    v_cvt_pk_bf16_f32 v21, v38, v39
    v_cvt_pk_bf16_f32 v22, v40, v41
    v_cvt_pk_bf16_f32 v23, v42, v43
    buffer_store_dwordx4 v[20:23], v16, s[16:19], s62 offen offset:3072 sc1
    s_mov_b32 m0, s40
    s_add_u32 s43, s38, s49
    s_barrier
    v_bitop3_b32 v12, v12, v223, s42 bitop3:0xa8
    v_cmp_ne_u32 vcc, 0, v12
    v_mfma_f32_16x16x32_bf16 v[200:203], a[128:131], v[128:131], v[76:79]
    v_mfma_f32_16x16x32_bf16 v[200:203], a[132:135], v[132:135], v[200:203]
    buffer_load_dwordx4 v16, s[12:15], s38 offen offset:0 sc1 lds
    v_mfma_f32_16x16x32_bf16 v[200:203], a[136:139], v[136:139], v[200:203]
    v_mfma_f32_16x16x32_bf16 v[200:203], a[140:143], v[140:143], v[200:203]
    s_waitcnt lgkmcnt(4)
    buffer_load_dwordx4 v16, s[12:15], s38 offen offset:1024 sc1 lds
    v_mfma_f32_16x16x32_bf16 v[204:207], a[144:147], v[128:131], v[76:79]
    ds_read_b128 a[176:179], v3 offset:12288
    v_mfma_f32_16x16x32_bf16 v[204:207], a[148:151], v[132:135], v[204:207]
    ds_read_b128 a[180:183], v3 offset:13312
    buffer_load_dwordx4 v16, s[12:15], s38 offen offset:2048 sc1 lds
    v_mfma_f32_16x16x32_bf16 v[204:207], a[152:155], v[136:139], v[204:207]
    ds_read_b128 a[184:187], v3 offset:14336
    v_mfma_f32_16x16x32_bf16 v[204:207], a[156:159], v[140:143], v[204:207]
    s_waitcnt lgkmcnt(3)
    ds_read_b128 a[188:191], v3 offset:15360
    buffer_load_dwordx4 v16, s[12:15], s38 offen offset:3072 sc1 lds
    s_mov_b32 m0, s41
    s_cbranch_vccnz gated_mix__ssm_conv_h3__compressed_kv_cla__prompt_kernel_b1_r0
gated_mix__ssm_conv_h3__compressed_kv_cla__prompt_kernel_b1_r0_ret:
    ds_read_b128 a[128:131], v3 offset:24576
    ds_read_b128 a[132:135], v3 offset:25600
    ds_read_b128 a[136:139], v3 offset:26624
    ds_read_b128 a[140:143], v3 offset:27648
    ds_read_b128 a[144:147], v3 offset:28672
    ds_read_b128 a[148:151], v3 offset:29696
    ds_read_b128 a[152:155], v3 offset:30720
    ds_read_b128 a[156:159], v3 offset:31744
    v_mfma_f32_16x16x32_bf16 a[96:99], a[160:163], v[220:223], a[96:99]
    buffer_load_dwordx4 v16, s[12:15], s43 offen offset:0 sc1 lds
    v_mfma_f32_16x16x32_bf16 a[100:103], a[164:167], v[220:223], a[100:103]
    buffer_load_dwordx4 v16, s[12:15], s43 offen offset:1024 sc1 lds
    v_mfma_f32_16x16x32_bf16 a[104:107], a[168:171], v[220:223], a[104:107]
    buffer_load_dwordx4 v16, s[12:15], s43 offen offset:2048 sc1 lds
    v_mfma_f32_16x16x32_bf16 a[108:111], a[172:175], v[220:223], a[108:111]
    s_waitcnt lgkmcnt(8)
    buffer_load_dwordx4 v16, s[12:15], s43 offen offset:3072 sc1 lds
    v_mfma_f32_16x16x32_bf16 a[112:115], a[176:179], v[220:223], a[112:115]
    v_add_f32 v200, v56, v200
    v_add_f32 v201, v57, v201
    v_add_f32 v202, v58, v202
    v_add_f32 v203, v59, v203
    v_add_f32 v204, v60, v204
    v_add_f32 v205, v61, v205
    v_add_f32 v206, v62, v206
    v_add_f32 v207, v63, v207
    v_mfma_f32_16x16x32_bf16 a[116:119], a[180:183], v[220:223], a[116:119]
    v_exp_f32 v4, v200
    v_exp_f32 v5, v201
    s_nop 0
    v_cvt_pk_bf16_f32 v236, v4, v5
    v_mfma_f32_16x16x32_bf16 a[120:123], a[184:187], v[220:223], a[120:123]
    v_exp_f32 v6, v202
    v_exp_f32 v7, v203
    s_nop 0
    v_cvt_pk_bf16_f32 v237, v6, v7
    v_mfma_f32_16x16x32_bf16 a[124:127], a[188:191], v[220:223], a[124:127]
    v_exp_f32 v8, v204
    v_exp_f32 v9, v205
    s_nop 0
    v_cvt_pk_bf16_f32 v238, v8, v9
    v_mfma_f32_16x16x32_bf16 v[252:255], v[24:27], v[220:223], v[252:255]
    s_waitcnt lgkmcnt(4)
    v_or3_b32 v12, v236, v237, v238
    v_exp_f32 v10, v206
    v_exp_f32 v11, v207
    s_nop 0
    v_cvt_pk_bf16_f32 v239, v10, v11
    v_bitop3_b32 v12, v12, v239, s42 bitop3:0xa8
    v_cmp_ne_u32 vcc, 0, v12
    s_cbranch_vccnz gated_mix__ssm_conv_h3__compressed_kv_cla__prompt_kernel_b1_r1
gated_mix__ssm_conv_h3__compressed_kv_cla__prompt_kernel_b1_r1_ret:
    v_mfma_f32_16x16x32_bf16 a[96:99], a[128:131], v[236:239], a[96:99]
    v_mfma_f32_16x16x32_bf16 a[100:103], a[132:135], v[236:239], a[100:103]
    v_mfma_f32_16x16x32_bf16 a[104:107], a[136:139], v[236:239], a[104:107]
    v_mfma_f32_16x16x32_bf16 a[108:111], a[140:143], v[236:239], a[108:111]
    s_waitcnt lgkmcnt(0)
    v_mfma_f32_16x16x32_bf16 a[112:115], a[144:147], v[236:239], a[112:115]
    v_mfma_f32_16x16x32_bf16 a[116:119], a[148:151], v[236:239], a[116:119]
    v_mfma_f32_16x16x32_bf16 a[120:123], a[152:155], v[236:239], a[120:123]
    v_mfma_f32_16x16x32_bf16 a[124:127], a[156:159], v[236:239], a[124:127]
    v_mfma_f32_16x16x32_bf16 v[252:255], v[24:27], v[236:239], v[252:255]
    s_mov_b32 s20, s74
    s_mov_b32 s21, s75
    s_mov_b32 s22, 2048
    s_lshl_b32 s36, s2, 2
    s_add_u32 s36, s36, s32
    s_mul_i32 s43, s32, 27040
    s_lshl_b32 s44, s36, 12
    s_lshl_b32 s47, s36, 1
    s_mul_i32 s59, s32, 2304
    v_mov_b32 v8, 0
    v_mov_b32 v9, 1
    buffer_load_dwordx2 v[10:11], v8, s[4:7], s44 offen
    buffer_load_ushort v12, v8, s[20:23], s47 offen
    s_nop 4
    v_accvgpr_read_b32 v36, a96
    v_accvgpr_read_b32 v37, a97
    v_accvgpr_read_b32 v38, a98
    v_accvgpr_read_b32 v39, a99
    v_accvgpr_read_b32 v40, a100
    v_accvgpr_read_b32 v41, a101
    v_accvgpr_read_b32 v42, a102
    v_accvgpr_read_b32 v43, a103
    v_rcp_f32 v32, v252
    s_nop 0
    v_mul_f32 v36, v36, v32
    v_mul_f32 v37, v37, v32
    v_mul_f32 v38, v38, v32
    v_mul_f32 v39, v39, v32
    v_mul_f32 v40, v40, v32
    v_mul_f32 v41, v41, v32
    v_mul_f32 v42, v42, v32
    v_mul_f32 v43, v43, v32
    v_cvt_pk_bf16_f32 v44, v36, v37
    v_cvt_pk_bf16_f32 v45, v38, v39
    v_cvt_pk_bf16_f32 v46, v40, v41
    v_cvt_pk_bf16_f32 v47, v42, v43
    buffer_store_dwordx4 v[44:47], v16, s[16:19], s63 offen offset:0 sc1
    v_accvgpr_read_b32 v36, a104
    v_accvgpr_read_b32 v37, a105
    v_accvgpr_read_b32 v38, a106
    v_accvgpr_read_b32 v39, a107
    v_accvgpr_read_b32 v40, a108
    v_accvgpr_read_b32 v41, a109
    v_accvgpr_read_b32 v42, a110
    v_accvgpr_read_b32 v43, a111
    v_mul_f32 v36, v36, v32
    v_mul_f32 v37, v37, v32
    v_mul_f32 v38, v38, v32
    v_mul_f32 v39, v39, v32
    v_mul_f32 v40, v40, v32
    v_mul_f32 v41, v41, v32
    v_mul_f32 v42, v42, v32
    v_mul_f32 v43, v43, v32
    v_cvt_pk_bf16_f32 v20, v36, v37
    v_cvt_pk_bf16_f32 v21, v38, v39
    v_cvt_pk_bf16_f32 v22, v40, v41
    v_cvt_pk_bf16_f32 v23, v42, v43
    buffer_store_dwordx4 v[20:23], v16, s[16:19], s63 offen offset:1024 sc1
    v_accvgpr_read_b32 v36, a112
    v_accvgpr_read_b32 v37, a113
    v_accvgpr_read_b32 v38, a114
    v_accvgpr_read_b32 v39, a115
    v_accvgpr_read_b32 v40, a116
    v_accvgpr_read_b32 v41, a117
    v_accvgpr_read_b32 v42, a118
    v_accvgpr_read_b32 v43, a119
    v_mul_f32 v36, v36, v32
    v_mul_f32 v37, v37, v32
    v_mul_f32 v38, v38, v32
    v_mul_f32 v39, v39, v32
    v_mul_f32 v40, v40, v32
    v_mul_f32 v41, v41, v32
    v_mul_f32 v42, v42, v32
    v_mul_f32 v43, v43, v32
    v_cvt_pk_bf16_f32 v44, v36, v37
    v_cvt_pk_bf16_f32 v45, v38, v39
    v_cvt_pk_bf16_f32 v46, v40, v41
    v_cvt_pk_bf16_f32 v47, v42, v43
    buffer_store_dwordx4 v[44:47], v16, s[16:19], s63 offen offset:2048 sc1
    v_accvgpr_read_b32 v36, a120
    v_accvgpr_read_b32 v37, a121
    v_accvgpr_read_b32 v38, a122
    v_accvgpr_read_b32 v39, a123
    v_accvgpr_read_b32 v40, a124
    v_accvgpr_read_b32 v41, a125
    v_accvgpr_read_b32 v42, a126
    v_accvgpr_read_b32 v43, a127
    v_mul_f32 v36, v36, v32
    v_mul_f32 v37, v37, v32
    v_mul_f32 v38, v38, v32
    v_mul_f32 v39, v39, v32
    v_mul_f32 v40, v40, v32
    v_mul_f32 v41, v41, v32
    v_mul_f32 v42, v42, v32
    v_mul_f32 v43, v43, v32
    v_cvt_pk_bf16_f32 v20, v36, v37
    v_cvt_pk_bf16_f32 v21, v38, v39
    v_cvt_pk_bf16_f32 v22, v40, v41
    v_cvt_pk_bf16_f32 v23, v42, v43
    buffer_store_dwordx4 v[20:23], v16, s[16:19], s63 offen offset:3072 sc1
    v_lshrrev_b32 v232, 4, v16
    v_and_b32 v6, 15, v232
    v_lshrrev_b32 v7, 4, v232
    v_and_b32 v233, 1, v6
    v_cmp_eq_u32 vcc, 1, v233
    v_mov_b32 v234, 4240
    v_lshlrev_b32 v235, 4, v7
    v_cndmask_b32 v234, v234, 8, vcc
    v_lshl_add_u32 v234, v6, 3, v234
    v_add3_u32 v3, v234, v235, s43
    v_and_b32 v236, 3, v6
    v_mul_u32_u24 v236, 4640, v236
    v_lshrrev_b32 v234, 2, v6
    v_lshlrev_b32 v234, 7, v234
    v_sub_u32 v236, v236, v234
    v_add3_u32 v4, v236, v235, s43
    v_add_u32 v4, 8864, v4
    v_mov_b32 v20, 0
    v_mov_b32 v21, 0
    v_mov_b32 v22, 0
    v_mov_b32 v23, 0
    v_and_b32 v234, 7, v232
    v_lshlrev_b32 v234, 4, v234
    v_bfe_u32 v235, v232, 3, 1
    v_mul_u32_u24 v235, 4240, v235
    v_add3_u32 v234, v234, v235, s43
    ds_write_b128 v234, v[20:23]
    v_min_u32 v235, 368, v16
    v_add_u32 v235, s43, v235
    ds_write_b128 v235, v[20:23] offset:12576
    ds_write_b128 v235, v[20:23] offset:17216
    ds_write_b128 v235, v[20:23] offset:21856
    ds_write_b128 v235, v[20:23] offset:26496
    v_lshlrev_b32 v236, 2, v6
    v_sub_u32 v236, 60, v236
    v_lshrrev_b32 v236, 3, v236
    v_sub_u32 v236, v236, v7
    v_lshl_add_u32 v236, v233, 4, v236
    s_waitcnt vmcnt(4)
    v_mov_b32 v234, s43
    ds_write_b64 v234, v[10:11] offset:4360
    v_cmp_eq_u32 vcc, 16, v236
    v_mov_b32 v25, 0
    s_nop 0
    v_cndmask_b32 v24, 0, v12, vcc
    v_cmp_eq_u32 vcc, 0, v236
    v_mov_b32 v27, 0
    s_nop 0
    v_cndmask_b32 v26, 0, v12, vcc
    v_cmp_eq_u32 vcc, 20, v236
    v_mov_b32 v29, 0
    s_nop 0
    v_cndmask_b32 v28, 0, v12, vcc
    v_cmp_eq_u32 vcc, 4, v236
    v_mov_b32 v31, 0
    s_nop 0
    v_cndmask_b32 v30, 0, v12, vcc
    s_waitcnt vmcnt(6) lgkmcnt(0)
    s_barrier
    ds_read_b128 v[96:99], v4 offset:3584
    ds_read_b128 v[64:67], v3 offset:0
    ds_read_b128 v[100:103], v4 offset:3072
    ds_read_b128 v[68:71], v3 offset:512
    ds_read_b128 v[104:107], v4 offset:2560
    ds_read_b128 v[72:75], v3 offset:1024
    ds_read_b128 v[108:111], v4 offset:2048
    ds_read_b128 v[76:79], v3 offset:1536
    ds_read_b128 v[112:115], v4 offset:1536
    ds_read_b128 v[80:83], v3 offset:2048
    ds_read_b128 v[116:119], v4 offset:1024
    ds_read_b128 v[84:87], v3 offset:2560
    ds_read_b128 v[120:123], v4 offset:512
    ds_read_b128 v[88:91], v3 offset:3072
    ds_read_b128 v[124:127], v4 offset:0
    ds_read_b128 v[92:95], v3 offset:3584
    s_waitcnt lgkmcnt(0)
    v_mfma_f32_16x16x32_bf16 v[32:35], v[24:27], v[96:99], 0
    s_and_b32 s45, s2, 3
    s_bfe_u32 s38, s2, 0x20003
    v_mfma_f32_16x16x32_bf16 v[36:39], v[24:27], v[100:103], 0
    s_and_b32 s36, s2, 4
    s_add_u32 s38, s38, s36
    v_mfma_f32_16x16x32_bf16 v[40:43], v[24:27], v[104:107], 0
    ds_read_b128 v[160:163], v4 offset:3648
    s_lshr_b32 s39, s2, 5
    s_xor_b32 s37, s45, 3
    v_mfma_f32_16x16x32_bf16 v[44:47], v[24:27], v[108:111], 0
    s_lshl_b32 s37, s37, 2
    v_lshlrev_b32 v233, 1, v7
    v_xor_b32 v233, v233, v6
    v_mfma_f32_16x16x32_bf16 v[48:51], v[24:27], v[112:115], 0
    ds_read_b128 v[128:131], v3 offset:64
    v_xor_b32 v233, s37, v233
    v_mfma_f32_16x16x32_bf16 v[52:55], v[24:27], v[116:119], 0
    v_lshlrev_b32 v233, 4, v233
    v_lshl_add_u32 v0, v7, 11, v233
    v_mfma_f32_16x16x32_bf16 v[56:59], v[24:27], v[120:123], 0
    ds_read_b128 v[164:167], v4 offset:3136
    v_add_u32 v1, 7040, v0
    s_lshl_b32 s40, s45, 21
    s_lshl_b32 s37, s32, 14
    v_mfma_f32_16x16x32_bf16 v[60:63], v[24:27], v[124:127], 0
    s_add_u32 s40, s40, s37
    s_lshl_b32 s37, s39, 8
    v_mfma_f32_16x16x32_bf16 v[32:35], v[64:67], v[96:99], v[32:35]
    ds_read_b128 v[132:135], v3 offset:576
    s_add_u32 s40, s40, s37
    v_mfma_f32_16x16x32_bf16 v[36:39], v[64:67], v[100:103], v[36:39]
    s_lshl_b32 s52, s38, 2
    s_add_u32 s52, s52, s32
    v_mfma_f32_16x16x32_bf16 v[40:43], v[64:67], v[104:107], v[40:43]
    ds_read_b128 v[168:171], v4 offset:2624
    s_lshl_b32 s52, s52, 7
    s_lshl_b32 s37, s45, 5
    v_mfma_f32_16x16x32_bf16 v[44:47], v[64:67], v[108:111], v[44:47]
    s_add_u32 s52, s52, s37
    v_and_b32 v13, 7, v6
    v_lshlrev_b32 v13, 2, v13
    v_mfma_f32_16x16x32_bf16 v[48:51], v[64:67], v[112:115], v[48:51]
    s_add_u32 m0, s59, 108544
    ds_read_b128 v[136:139], v3 offset:1088
    v_add_u32 v2, 524288, v16
    s_lshl_b32 s41, s38, 3
    s_add_u32 s41, s41, s32
    v_mfma_f32_16x16x32_bf16 v[52:55], v[64:67], v[116:119], v[52:55]
    buffer_load_dwordx4 v0, s[8:11], s40 offen offset:0 lds
    v_mfma_f32_16x16x32_bf16 v[56:59], v[64:67], v[120:123], v[56:59]
    ds_read_b128 v[172:175], v4 offset:2112
    s_lshl_b32 s41, s41, 17
    s_lshl_b32 s37, s45, 15
    v_mfma_f32_16x16x32_bf16 v[60:63], v[64:67], v[124:127], v[60:63]
    s_add_u32 s41, s41, s37
    s_add_u32 s42, s41, 8388608
    v_mfma_f32_16x16x32_bf16 v[36:39], v[68:71], v[96:99], v[36:39]
    ds_read_b128 v[140:143], v3 offset:1600
    v_mfma_f32_16x16x32_bf16 v[40:43], v[68:71], v[100:103], v[40:43]
    buffer_load_dwordx4 v1, s[8:11], s40 offen offset:1152 lds
    v_mfma_f32_16x16x32_bf16 v[44:47], v[68:71], v[104:107], v[44:47]
    ds_read_b128 v[176:179], v4 offset:1600
    v_mfma_f32_16x16x32_bf16 v[48:51], v[68:71], v[108:111], v[48:51]
    v_mfma_f32_16x16x32_bf16 v[52:55], v[68:71], v[112:115], v[52:55]
    s_add_u32 s40, s40, 65536
    ds_read_b128 v[144:147], v3 offset:2112
    v_mfma_f32_16x16x32_bf16 v[56:59], v[68:71], v[116:119], v[56:59]
    buffer_load_dword v14, v13, s[28:31], s52 offen sc1
    v_mfma_f32_16x16x32_bf16 v[60:63], v[68:71], v[120:123], v[60:63]
    ds_read_b128 v[180:183], v4 offset:1088
    v_mfma_f32_16x16x32_bf16 v[40:43], v[72:75], v[96:99], v[40:43]
    v_mfma_f32_16x16x32_bf16 v[44:47], v[72:75], v[100:103], v[44:47]
    s_add_u32 m0, s59, 117760
    ds_read_b128 v[148:151], v3 offset:2624
    v_mfma_f32_16x16x32_bf16 v[48:51], v[72:75], v[104:107], v[48:51]
    buffer_load_dwordx4 v0, s[8:11], s40 offen offset:0 lds
    v_mfma_f32_16x16x32_bf16 v[52:55], v[72:75], v[108:111], v[52:55]
    ds_read_b128 v[184:187], v4 offset:576
    v_mfma_f32_16x16x32_bf16 v[56:59], v[72:75], v[112:115], v[56:59]
    v_mfma_f32_16x16x32_bf16 v[60:63], v[72:75], v[116:119], v[60:63]
    ds_read_b128 v[152:155], v3 offset:3136
    v_mfma_f32_16x16x32_bf16 v[44:47], v[76:79], v[96:99], v[44:47]
    buffer_load_dwordx4 v1, s[8:11], s40 offen offset:1152 lds
    v_mfma_f32_16x16x32_bf16 v[48:51], v[76:79], v[100:103], v[48:51]
    ds_read_b128 v[188:191], v4 offset:64
    v_mfma_f32_16x16x32_bf16 v[52:55], v[76:79], v[104:107], v[52:55]
    v_mfma_f32_16x16x32_bf16 v[56:59], v[76:79], v[108:111], v[56:59]
    s_add_u32 s40, s40, 65536
    s_add_u32 m0, s59, 126976
    ds_read_b128 v[156:159], v3 offset:3648
    v_mfma_f32_16x16x32_bf16 v[60:63], v[76:79], v[112:115], v[60:63]
    buffer_load_dwordx4 v0, s[8:11], s40 offen offset:0 lds
    v_mfma_f32_16x16x32_bf16 v[48:51], v[80:83], v[96:99], v[48:51]
    v_mfma_f32_16x16x32_bf16 v[52:55], v[80:83], v[100:103], v[52:55]
    v_mfma_f32_16x16x32_bf16 v[56:59], v[80:83], v[104:107], v[56:59]
    v_mfma_f32_16x16x32_bf16 v[60:63], v[80:83], v[108:111], v[60:63]
    buffer_load_dwordx4 v1, s[8:11], s40 offen offset:1152 lds
    v_mfma_f32_16x16x32_bf16 v[52:55], v[84:87], v[96:99], v[52:55]
    v_mfma_f32_16x16x32_bf16 v[56:59], v[84:87], v[100:103], v[56:59]
    v_mfma_f32_16x16x32_bf16 v[60:63], v[84:87], v[104:107], v[60:63]
    s_add_u32 s40, s40, 65536
    s_add_u32 m0, s59, 136192
    v_mfma_f32_16x16x32_bf16 v[56:59], v[88:91], v[96:99], v[56:59]
    buffer_load_dwordx4 v0, s[8:11], s40 offen offset:0 lds
    v_mfma_f32_16x16x32_bf16 v[60:63], v[88:91], v[100:103], v[60:63]
    v_mfma_f32_16x16x32_bf16 v[60:63], v[92:95], v[96:99], v[60:63]
    s_waitcnt lgkmcnt(0)
    v_mfma_f32_16x16x32_bf16 v[32:35], v[28:31], v[160:163], v[32:35]
    v_mul_u32_u24 v233, 1152, v7
    v_lshrrev_b32 v234, 2, v6
    v_mfma_f32_16x16x32_bf16 v[36:39], v[28:31], v[164:167], v[36:39]
    buffer_load_dwordx4 v1, s[8:11], s40 offen offset:1152 lds
    v_mfma_f32_16x16x32_bf16 v[40:43], v[28:31], v[168:171], v[40:43]
    ds_read_b128 v[96:99], v4 offset:3712
    v_lshl_add_u32 v233, v234, 8, v233
    v_mfma_f32_16x16x32_bf16 v[44:47], v[28:31], v[172:175], v[44:47]
    v_and_b32 v235, 3, v6
    v_lshl_add_u32 v233, v235, 3, v233
    v_mfma_f32_16x16x32_bf16 v[48:51], v[28:31], v[176:179], v[48:51]
    s_add_u32 s40, s40, 65536
    s_waitcnt vmcnt(9)
    ds_read_b128 v[64:67], v3 offset:128
    v_add_u32 v233, 80896, v233
    v_mfma_f32_16x16x32_bf16 v[52:55], v[28:31], v[180:183], v[52:55]
    buffer_store_dword v9, v8, s[28:31], s56 offen sc1
    v_mfma_f32_16x16x32_bf16 v[56:59], v[28:31], v[184:187], v[56:59]
    ds_read_b128 v[100:103], v4 offset:3200
    v_xor_b32 v236, 0, v234
    v_mfma_f32_16x16x32_bf16 v[60:63], v[28:31], v[188:191], v[60:63]
    v_lshl_add_u32 v17, v236, 5, v233
    v_xor_b32 v236, 1, v234
    v_mfma_f32_16x16x32_bf16 v[32:35], v[128:131], v[160:163], v[32:35]
    s_add_u32 m0, s59, 145408
    ds_read_b128 v[68:71], v3 offset:640
    v_lshl_add_u32 v18, v236, 5, v233
    v_mfma_f32_16x16x32_bf16 v[36:39], v[128:131], v[164:167], v[36:39]
    buffer_load_dwordx4 v0, s[8:11], s40 offen offset:0 lds
    v_mfma_f32_16x16x32_bf16 v[40:43], v[128:131], v[168:171], v[40:43]
    ds_read_b128 v[104:107], v4 offset:2688
    v_xor_b32 v236, 2, v234
    v_mfma_f32_16x16x32_bf16 v[44:47], v[128:131], v[172:175], v[44:47]
    v_lshl_add_u32 v19, v236, 5, v233
    v_xor_b32 v236, 3, v234
    v_mfma_f32_16x16x32_bf16 v[48:51], v[128:131], v[176:179], v[48:51]
    ds_read_b128 v[72:75], v3 offset:1152
    v_lshl_add_u32 v20, v236, 5, v233
    v_mfma_f32_16x16x32_bf16 v[52:55], v[128:131], v[180:183], v[52:55]
    buffer_load_dwordx4 v1, s[8:11], s40 offen offset:1152 lds
    v_mfma_f32_16x16x32_bf16 v[56:59], v[128:131], v[184:187], v[56:59]
    ds_read_b128 v[108:111], v4 offset:2176
    v_lshlrev_b32 v236, 3, v7
    v_mfma_f32_16x16x32_bf16 v[60:63], v[128:131], v[188:191], v[60:63]
    v_lshl_add_u32 v5, v6, 5, v236
    v_lshl_add_u32 v21, v6, 13, v236
    v_mfma_f32_16x16x32_bf16 v[36:39], v[132:135], v[160:163], v[36:39]
    s_add_u32 s40, s40, 65536
    s_add_u32 m0, s59, 154624
    ds_read_b128 v[76:79], v3 offset:1664
    v_and_b32 v236, 1, v7
    v_mfma_f32_16x16x32_bf16 v[40:43], v[132:135], v[164:167], v[40:43]
    buffer_load_dwordx4 v0, s[8:11], s40 offen offset:0 lds
    v_mfma_f32_16x16x32_bf16 v[44:47], v[132:135], v[168:171], v[44:47]
    ds_read_b128 v[112:115], v4 offset:1664
    v_mad_u32_u24 v21, v236, 24, v21
    v_mfma_f32_16x16x32_bf16 v[48:51], v[132:135], v[172:175], v[48:51]
    v_mul_u32_u24 v236, 504, v236
    v_add_u32 v5, v5, v236
    v_mfma_f32_16x16x32_bf16 v[52:55], v[132:135], v[176:179], v[52:55]
    ds_read_b128 v[80:83], v3 offset:2176
    v_lshlrev_b32 v10, 11, v7
    v_mfma_f32_16x16x32_bf16 v[56:59], v[132:135], v[180:183], v[56:59]
    buffer_load_dwordx4 v1, s[8:11], s40 offen offset:1152 lds
    v_mfma_f32_16x16x32_bf16 v[60:63], v[132:135], v[184:187], v[60:63]
    ds_read_b128 v[116:119], v4 offset:1152
    v_lshl_add_u32 v10, v6, 4, v10
    v_mfma_f32_16x16x32_bf16 v[40:43], v[136:139], v[160:163], v[40:43]
    v_lshrrev_b32 v236, 2, v232
    v_lshlrev_b32 v236, 9, v236
    v_mfma_f32_16x16x32_bf16 v[44:47], v[136:139], v[164:167], v[44:47]
    s_add_u32 s40, s40, 65536
    ds_read_b128 v[84:87], v3 offset:2688
    v_lshl_add_u32 v236, v235, 3, v236
    s_lshl_b32 s37, s32, 5
    v_mfma_f32_16x16x32_bf16 v[48:51], v[136:139], v[168:171], v[48:51]
    v_add_u32 v22, s37, v236
    v_lshlrev_b32 v23, 4, v6
    s_lshl_b32 s48, s38, 7
    s_add_u32 s48, s48, s32
    v_mfma_f32_16x16x32_bf16 v[52:55], v[136:139], v[172:175], v[52:55]
    ds_read_b128 v[120:123], v4 offset:640
    s_lshl_b32 s50, s48, 2
    s_lshl_b32 s48, s48, 11
    v_mfma_f32_16x16x32_bf16 v[56:59], v[136:139], v[176:179], v[56:59]
    s_lshl_b32 s37, s39, 2
    s_add_u32 s37, s37, s45
    v_mfma_f32_16x16x32_bf16 v[60:63], v[136:139], v[180:183], v[60:63]
    ds_read_b128 v[88:91], v3 offset:3200
    s_lshl_b32 s51, s37, 2
    s_lshl_b32 s37, s37, 6
    v_mfma_f32_16x16x32_bf16 v[44:47], v[140:143], v[160:163], v[44:47]
    s_add_u32 s48, s48, s37
    s_add_u32 s51, s51, s32
    v_mfma_f32_16x16x32_bf16 v[48:51], v[140:143], v[164:167], v[48:51]
    ds_read_b128 v[124:127], v4 offset:128
    s_lshl_b32 s53, s51, 5
    s_add_u32 s53, s53, 8192
    v_mfma_f32_16x16x32_bf16 v[52:55], v[140:143], v[168:171], v[52:55]
    s_lshl_b32 s51, s51, 15
    s_lshl_b32 s37, s38, 8
    v_mfma_f32_16x16x32_bf16 v[56:59], v[140:143], v[172:175], v[56:59]
    ds_read_b128 v[92:95], v3 offset:3712
    s_add_u32 s51, s51, s37
    s_add_u32 s12, s94, 55574528
    s_addc_u32 s13, s95, 0
    v_mfma_f32_16x16x32_bf16 v[60:63], v[140:143], v[176:179], v[60:63]
    s_mov_b32 s14, 4194304
    s_mov_b32 s20, s90
    v_mfma_f32_16x16x32_bf16 v[48:51], v[144:147], v[160:163], v[48:51]
    s_mov_b32 s21, s91
    s_mov_b32 s22, 4194304
    v_mfma_f32_16x16x32_bf16 v[52:55], v[144:147], v[164:167], v[52:55]
    s_add_u32 s4, s94, 59768832
    s_addc_u32 s5, s95, 0
    s_mov_b32 s6, 8192
    v_mfma_f32_16x16x32_bf16 v[56:59], v[144:147], v[168:171], v[56:59]
    s_mov_b32 s24, s64
    s_mov_b32 s25, s65
    v_mfma_f32_16x16x32_bf16 v[60:63], v[144:147], v[172:175], v[60:63]
    s_mov_b32 s26, 4194304
    s_lshl_b32 s46, s44, 2
    v_mfma_f32_16x16x32_bf16 v[52:55], v[148:151], v[160:163], v[52:55]
    v_mfma_f32_16x16x32_bf16 v[56:59], v[148:151], v[164:167], v[56:59]
    v_mfma_f32_16x16x32_bf16 v[60:63], v[148:151], v[168:171], v[60:63]
    s_add_u32 s36, s48, 0
    v_mfma_f32_16x16x32_bf16 v[56:59], v[152:155], v[160:163], v[56:59]
    buffer_load_dwordx4 v[24:27], v21, s[24:27], s36 offen
    v_mfma_f32_16x16x32_bf16 v[60:63], v[152:155], v[164:167], v[60:63]
    v_mfma_f32_16x16x32_bf16 v[60:63], v[156:159], v[160:163], v[60:63]
    s_waitcnt lgkmcnt(0)
    s_waitcnt vmcnt(12)
    v_cmp_ne_u32 vcc, 1, v14
    s_nop 0
    s_cbranch_vccnz gated_mix__ssm_conv_h3__compressed_kv_cla__prompt_kernel_spin_s
gated_mix__ssm_conv_h3__compressed_kv_cla__prompt_kernel_spin_s_ret:
    v_mfma_f32_16x16x32_bf16 v[32:35], v[64:67], v[96:99], v[32:35]
    s_add_u32 s36, s48, 131072
    v_mfma_f32_16x16x32_bf16 v[36:39], v[64:67], v[100:103], v[36:39]
    buffer_load_dwordx4 v[28:31], v21, s[24:27], s36 offen
    v_mfma_f32_16x16x32_bf16 v[40:43], v[64:67], v[104:107], v[40:43]
gated_mix__ssm_conv_h3__compressed_kv_cla__prompt_kernel_pad11:
    s_cbranch_execz gated_mix__ssm_conv_h3__compressed_kv_cla__prompt_kernel_pad15
    ds_read_b128 v[160:163], v4 offset:3776
    v_mfma_f32_16x16x32_bf16 v[44:47], v[64:67], v[108:111], v[44:47]
    v_mfma_f32_16x16x32_bf16 v[48:51], v[64:67], v[112:115], v[48:51]
    s_add_u32 s36, s50, 0
    ds_read_b128 v[128:131], v3 offset:192
    v_mfma_f32_16x16x32_bf16 v[52:55], v[64:67], v[116:119], v[52:55]
    buffer_load_dword v6, v23, s[4:7], s36 offen sc1
    v_mfma_f32_16x16x32_bf16 v[56:59], v[64:67], v[120:123], v[56:59]
    ds_read_b128 v[164:167], v4 offset:3264
    v_mfma_f32_16x16x32_bf16 v[60:63], v[64:67], v[124:127], v[60:63]
    v_mfma_f32_16x16x32_bf16 v[36:39], v[68:71], v[96:99], v[36:39]
    s_add_u32 s36, s50, 256
    ds_read_b128 v[132:135], v3 offset:704
    v_mfma_f32_16x16x32_bf16 v[40:43], v[68:71], v[100:103], v[40:43]
    buffer_load_dword v7, v23, s[4:7], s36 offen sc1
    v_mfma_f32_16x16x32_bf16 v[44:47], v[68:71], v[104:107], v[44:47]
    ds_read_b128 v[168:171], v4 offset:2752
    v_mfma_f32_16x16x32_bf16 v[48:51], v[68:71], v[108:111], v[48:51]
    v_mfma_f32_16x16x32_bf16 v[52:55], v[68:71], v[112:115], v[52:55]
    s_add_u32 s36, s50, 4096
    ds_read_b128 v[136:139], v3 offset:1216
    v_mfma_f32_16x16x32_bf16 v[56:59], v[68:71], v[116:119], v[56:59]
    buffer_load_dword v11, v23, s[4:7], s36 offen sc1
    v_mfma_f32_16x16x32_bf16 v[60:63], v[68:71], v[120:123], v[60:63]
    ds_read_b128 v[172:175], v4 offset:2240
    v_mfma_f32_16x16x32_bf16 v[40:43], v[72:75], v[96:99], v[40:43]
    v_mfma_f32_16x16x32_bf16 v[44:47], v[72:75], v[100:103], v[44:47]
    s_add_u32 s36, s50, 4352
    ds_read_b128 v[140:143], v3 offset:1728
    v_mfma_f32_16x16x32_bf16 v[48:51], v[72:75], v[104:107], v[48:51]
    buffer_load_dword v12, v23, s[4:7], s36 offen sc1
    v_mfma_f32_16x16x32_bf16 v[52:55], v[72:75], v[108:111], v[52:55]
    ds_read_b128 v[176:179], v4 offset:1728
    v_mfma_f32_16x16x32_bf16 v[56:59], v[72:75], v[112:115], v[56:59]
    v_mfma_f32_16x16x32_bf16 v[60:63], v[72:75], v[116:119], v[60:63]
    ds_read_b128 v[144:147], v3 offset:2240
    v_mfma_f32_16x16x32_bf16 v[44:47], v[76:79], v[96:99], v[44:47]
    buffer_load_dwordx4 a[0:3], v16, s[16:19], s41 offen offset:0 sc1
    v_mfma_f32_16x16x32_bf16 v[48:51], v[76:79], v[100:103], v[48:51]
    ds_read_b128 v[180:183], v4 offset:1216
    v_mfma_f32_16x16x32_bf16 v[52:55], v[76:79], v[104:107], v[52:55]
    v_mfma_f32_16x16x32_bf16 v[56:59], v[76:79], v[108:111], v[56:59]
    ds_read_b128 v[148:151], v3 offset:2752
    v_mfma_f32_16x16x32_bf16 v[60:63], v[76:79], v[112:115], v[60:63]
    buffer_load_dwordx4 a[4:7], v2, s[16:19], s41 offen offset:0 sc1
    v_mfma_f32_16x16x32_bf16 v[48:51], v[80:83], v[96:99], v[48:51]
    ds_read_b128 v[184:187], v4 offset:704
    v_mfma_f32_16x16x32_bf16 v[52:55], v[80:83], v[100:103], v[52:55]
    v_mfma_f32_16x16x32_bf16 v[56:59], v[80:83], v[104:107], v[56:59]
    ds_read_b128 v[152:155], v3 offset:3264
    v_mfma_f32_16x16x32_bf16 v[60:63], v[80:83], v[108:111], v[60:63]
    buffer_load_dwordx4 a[8:11], v16, s[16:19], s41 offen offset:1024 sc1
    v_mfma_f32_16x16x32_bf16 v[52:55], v[84:87], v[96:99], v[52:55]
    ds_read_b128 v[188:191], v4 offset:192
    v_mfma_f32_16x16x32_bf16 v[56:59], v[84:87], v[100:103], v[56:59]
    v_mfma_f32_16x16x32_bf16 v[60:63], v[84:87], v[104:107], v[60:63]
    ds_read_b128 v[156:159], v3 offset:3776
    v_mfma_f32_16x16x32_bf16 v[56:59], v[88:91], v[96:99], v[56:59]
    buffer_load_dwordx4 a[12:15], v2, s[16:19], s41 offen offset:1024 sc1
    v_mfma_f32_16x16x32_bf16 v[60:63], v[88:91], v[100:103], v[60:63]
    v_mfma_f32_16x16x32_bf16 v[60:63], v[92:95], v[96:99], v[60:63]
    s_waitcnt lgkmcnt(0)
    v_mfma_f32_16x16x32_bf16 v[32:35], v[128:131], v[160:163], v[32:35]
    v_mfma_f32_16x16x32_bf16 v[36:39], v[128:131], v[164:167], v[36:39]
    buffer_load_dwordx4 a[16:19], v16, s[16:19], s41 offen offset:2048 sc1
    v_mfma_f32_16x16x32_bf16 v[40:43], v[128:131], v[168:171], v[40:43]
    ds_read_b128 v[96:99], v4 offset:3840
    v_mfma_f32_16x16x32_bf16 v[44:47], v[128:131], v[172:175], v[44:47]
    v_mfma_f32_16x16x32_bf16 v[48:51], v[128:131], v[176:179], v[48:51]
    ds_read_b128 v[64:67], v3 offset:256
    v_mfma_f32_16x16x32_bf16 v[52:55], v[128:131], v[180:183], v[52:55]
    buffer_load_dwordx4 a[20:23], v2, s[16:19], s41 offen offset:2048 sc1
    v_mfma_f32_16x16x32_bf16 v[56:59], v[128:131], v[184:187], v[56:59]
    ds_read_b128 v[100:103], v4 offset:3328
    v_mfma_f32_16x16x32_bf16 v[60:63], v[128:131], v[188:191], v[60:63]
    v_mfma_f32_16x16x32_bf16 v[36:39], v[132:135], v[160:163], v[36:39]
    ds_read_b128 v[68:71], v3 offset:768
    v_mfma_f32_16x16x32_bf16 v[40:43], v[132:135], v[164:167], v[40:43]
    buffer_load_dwordx4 a[24:27], v16, s[16:19], s41 offen offset:3072 sc1
    v_mfma_f32_16x16x32_bf16 v[44:47], v[132:135], v[168:171], v[44:47]
    ds_read_b128 v[104:107], v4 offset:2816
    v_mfma_f32_16x16x32_bf16 v[48:51], v[132:135], v[172:175], v[48:51]
    v_mfma_f32_16x16x32_bf16 v[52:55], v[132:135], v[176:179], v[52:55]
    ds_read_b128 v[72:75], v3 offset:1280
    v_mfma_f32_16x16x32_bf16 v[56:59], v[132:135], v[180:183], v[56:59]
    buffer_load_dwordx4 a[28:31], v2, s[16:19], s41 offen offset:3072 sc1
    v_mfma_f32_16x16x32_bf16 v[60:63], v[132:135], v[184:187], v[60:63]
    ds_read_b128 v[108:111], v4 offset:2304
    v_mfma_f32_16x16x32_bf16 v[40:43], v[136:139], v[160:163], v[40:43]
    v_mfma_f32_16x16x32_bf16 v[44:47], v[136:139], v[164:167], v[44:47]
    s_add_u32 s41, s41, 4096
    ds_read_b128 v[76:79], v3 offset:1792
    v_mfma_f32_16x16x32_bf16 v[48:51], v[136:139], v[168:171], v[48:51]
    buffer_load_dwordx4 a[32:35], v16, s[16:19], s41 offen offset:0 sc1
    v_mfma_f32_16x16x32_bf16 v[52:55], v[136:139], v[172:175], v[52:55]
    ds_read_b128 v[112:115], v4 offset:1792
    v_mfma_f32_16x16x32_bf16 v[56:59], v[136:139], v[176:179], v[56:59]
    v_mfma_f32_16x16x32_bf16 v[60:63], v[136:139], v[180:183], v[60:63]
    ds_read_b128 v[80:83], v3 offset:2304
    v_mfma_f32_16x16x32_bf16 v[44:47], v[140:143], v[160:163], v[44:47]
    buffer_load_dwordx4 a[36:39], v2, s[16:19], s41 offen offset:0 sc1
    v_mfma_f32_16x16x32_bf16 v[48:51], v[140:143], v[164:167], v[48:51]
    ds_read_b128 v[116:119], v4 offset:1280
    v_mfma_f32_16x16x32_bf16 v[52:55], v[140:143], v[168:171], v[52:55]
    v_mfma_f32_16x16x32_bf16 v[56:59], v[140:143], v[172:175], v[56:59]
    ds_read_b128 v[84:87], v3 offset:2816
    v_mfma_f32_16x16x32_bf16 v[60:63], v[140:143], v[176:179], v[60:63]
    buffer_load_dwordx4 a[40:43], v16, s[16:19], s41 offen offset:1024 sc1
    v_mfma_f32_16x16x32_bf16 v[48:51], v[144:147], v[160:163], v[48:51]
    ds_read_b128 v[120:123], v4 offset:768
    v_mfma_f32_16x16x32_bf16 v[52:55], v[144:147], v[164:167], v[52:55]
    v_mfma_f32_16x16x32_bf16 v[56:59], v[144:147], v[168:171], v[56:59]
    ds_read_b128 v[88:91], v3 offset:3328
    v_mfma_f32_16x16x32_bf16 v[60:63], v[144:147], v[172:175], v[60:63]
    buffer_load_dwordx4 a[44:47], v2, s[16:19], s41 offen offset:1024 sc1
    v_mfma_f32_16x16x32_bf16 v[52:55], v[148:151], v[160:163], v[52:55]
    ds_read_b128 v[124:127], v4 offset:256
    v_mfma_f32_16x16x32_bf16 v[56:59], v[148:151], v[164:167], v[56:59]
    v_mfma_f32_16x16x32_bf16 v[60:63], v[148:151], v[168:171], v[60:63]
    ds_read_b128 v[92:95], v3 offset:3840
    v_mfma_f32_16x16x32_bf16 v[56:59], v[152:155], v[160:163], v[56:59]
    buffer_load_dwordx4 a[48:51], v16, s[16:19], s41 offen offset:2048 sc1
    v_mfma_f32_16x16x32_bf16 v[60:63], v[152:155], v[164:167], v[60:63]
    v_mfma_f32_16x16x32_bf16 v[60:63], v[156:159], v[160:163], v[60:63]
    s_waitcnt lgkmcnt(0)
    v_mfma_f32_16x16x32_bf16 v[32:35], v[64:67], v[96:99], v[32:35]
    v_mfma_f32_16x16x32_bf16 v[36:39], v[64:67], v[100:103], v[36:39]
    buffer_load_dwordx4 a[52:55], v2, s[16:19], s41 offen offset:2048 sc1
    v_mfma_f32_16x16x32_bf16 v[40:43], v[64:67], v[104:107], v[40:43]
    ds_read_b128 v[160:163], v4 offset:3904
    v_mfma_f32_16x16x32_bf16 v[44:47], v[64:67], v[108:111], v[44:47]
    v_mfma_f32_16x16x32_bf16 v[48:51], v[64:67], v[112:115], v[48:51]
    s_add_u32 s52, s52, 4096
    ds_read_b128 v[128:131], v3 offset:320
    v_mfma_f32_16x16x32_bf16 v[52:55], v[64:67], v[116:119], v[52:55]
    buffer_load_dword v14, v13, s[28:31], s52 offen sc1
    v_mfma_f32_16x16x32_bf16 v[56:59], v[64:67], v[120:123], v[56:59]
    ds_read_b128 v[164:167], v4 offset:3392
    v_mfma_f32_16x16x32_bf16 v[60:63], v[64:67], v[124:127], v[60:63]
    v_mfma_f32_16x16x32_bf16 v[36:39], v[68:71], v[96:99], v[36:39]
    ds_read_b128 v[132:135], v3 offset:832
    v_mfma_f32_16x16x32_bf16 v[40:43], v[68:71], v[100:103], v[40:43]
    buffer_load_dwordx4 a[56:59], v16, s[16:19], s41 offen offset:3072 sc1
    v_mfma_f32_16x16x32_bf16 v[44:47], v[68:71], v[104:107], v[44:47]
    ds_read_b128 v[168:171], v4 offset:2880
    v_mfma_f32_16x16x32_bf16 v[48:51], v[68:71], v[108:111], v[48:51]
    v_mfma_f32_16x16x32_bf16 v[52:55], v[68:71], v[112:115], v[52:55]
    ds_read_b128 v[136:139], v3 offset:1344
    v_mfma_f32_16x16x32_bf16 v[56:59], v[68:71], v[116:119], v[56:59]
    buffer_load_dwordx4 a[60:63], v2, s[16:19], s41 offen offset:3072 sc1
    v_mfma_f32_16x16x32_bf16 v[60:63], v[68:71], v[120:123], v[60:63]
    ds_read_b128 v[172:175], v4 offset:2368
    v_mfma_f32_16x16x32_bf16 v[40:43], v[72:75], v[96:99], v[40:43]
    v_mfma_f32_16x16x32_bf16 v[44:47], v[72:75], v[100:103], v[44:47]
    s_add_u32 s41, s41, 4096
    ds_read_b128 v[140:143], v3 offset:1856
    v_mfma_f32_16x16x32_bf16 v[48:51], v[72:75], v[104:107], v[48:51]
    buffer_load_dwordx4 a[64:67], v16, s[16:19], s41 offen offset:0 sc1
    v_mfma_f32_16x16x32_bf16 v[52:55], v[72:75], v[108:111], v[52:55]
    ds_read_b128 v[176:179], v4 offset:1856
    v_mfma_f32_16x16x32_bf16 v[56:59], v[72:75], v[112:115], v[56:59]
    v_mfma_f32_16x16x32_bf16 v[60:63], v[72:75], v[116:119], v[60:63]
    ds_read_b128 v[144:147], v3 offset:2368
    v_mfma_f32_16x16x32_bf16 v[44:47], v[76:79], v[96:99], v[44:47]
    buffer_load_dwordx4 a[68:71], v2, s[16:19], s41 offen offset:0 sc1
    v_mfma_f32_16x16x32_bf16 v[48:51], v[76:79], v[100:103], v[48:51]
    ds_read_b128 v[180:183], v4 offset:1344
    v_mfma_f32_16x16x32_bf16 v[52:55], v[76:79], v[104:107], v[52:55]
    v_mfma_f32_16x16x32_bf16 v[56:59], v[76:79], v[108:111], v[56:59]
    ds_read_b128 v[148:151], v3 offset:2880
    v_mfma_f32_16x16x32_bf16 v[60:63], v[76:79], v[112:115], v[60:63]
    buffer_load_dwordx4 a[72:75], v16, s[16:19], s41 offen offset:1024 sc1
    v_mfma_f32_16x16x32_bf16 v[48:51], v[80:83], v[96:99], v[48:51]
    ds_read_b128 v[184:187], v4 offset:832
    v_mfma_f32_16x16x32_bf16 v[52:55], v[80:83], v[100:103], v[52:55]
    v_mfma_f32_16x16x32_bf16 v[56:59], v[80:83], v[104:107], v[56:59]
    ds_read_b128 v[152:155], v3 offset:3392
    v_mfma_f32_16x16x32_bf16 v[60:63], v[80:83], v[108:111], v[60:63]
    buffer_load_dwordx4 a[76:79], v2, s[16:19], s41 offen offset:1024 sc1
    v_mfma_f32_16x16x32_bf16 v[52:55], v[84:87], v[96:99], v[52:55]
    ds_read_b128 v[188:191], v4 offset:320
    v_mfma_f32_16x16x32_bf16 v[56:59], v[84:87], v[100:103], v[56:59]
    v_mfma_f32_16x16x32_bf16 v[60:63], v[84:87], v[104:107], v[60:63]
    ds_read_b128 v[156:159], v3 offset:3904
    v_mfma_f32_16x16x32_bf16 v[56:59], v[88:91], v[96:99], v[56:59]
    buffer_load_dwordx4 a[80:83], v16, s[16:19], s41 offen offset:2048 sc1
    v_mfma_f32_16x16x32_bf16 v[60:63], v[88:91], v[100:103], v[60:63]
    v_mfma_f32_16x16x32_bf16 v[60:63], v[92:95], v[96:99], v[60:63]
    s_waitcnt lgkmcnt(0)
    s_waitcnt vmcnt(7)
    v_cmp_ne_u32 vcc, 1, v14
    s_nop 0
    s_cbranch_vccnz gated_mix__ssm_conv_h3__compressed_kv_cla__prompt_kernel_spin_l
gated_mix__ssm_conv_h3__compressed_kv_cla__prompt_kernel_spin_l_ret:
    v_mfma_f32_16x16x32_bf16 v[32:35], v[128:131], v[160:163], v[32:35]
    v_mfma_f32_16x16x32_bf16 v[36:39], v[128:131], v[164:167], v[36:39]
    buffer_load_dwordx4 a[84:87], v2, s[16:19], s41 offen offset:2048 sc1
    v_mfma_f32_16x16x32_bf16 v[40:43], v[128:131], v[168:171], v[40:43]
    ds_read_b128 v[96:99], v4 offset:3968
    v_mfma_f32_16x16x32_bf16 v[44:47], v[128:131], v[172:175], v[44:47]
    v_mfma_f32_16x16x32_bf16 v[48:51], v[128:131], v[176:179], v[48:51]
    ds_read_b128 v[64:67], v3 offset:384
    v_mfma_f32_16x16x32_bf16 v[52:55], v[128:131], v[180:183], v[52:55]
    buffer_load_dwordx4 a[128:131], v16, s[16:19], s42 offen offset:0 sc1
    v_mfma_f32_16x16x32_bf16 v[56:59], v[128:131], v[184:187], v[56:59]
    ds_read_b128 v[100:103], v4 offset:3456
    v_mfma_f32_16x16x32_bf16 v[60:63], v[128:131], v[188:191], v[60:63]
    v_mfma_f32_16x16x32_bf16 v[36:39], v[132:135], v[160:163], v[36:39]
    ds_read_b128 v[68:71], v3 offset:896
    v_mfma_f32_16x16x32_bf16 v[40:43], v[132:135], v[164:167], v[40:43]
    buffer_load_dwordx4 a[132:135], v2, s[16:19], s42 offen offset:0 sc1
    v_mfma_f32_16x16x32_bf16 v[44:47], v[132:135], v[168:171], v[44:47]
    ds_read_b128 v[104:107], v4 offset:2944
    v_mfma_f32_16x16x32_bf16 v[48:51], v[132:135], v[172:175], v[48:51]
    v_mfma_f32_16x16x32_bf16 v[52:55], v[132:135], v[176:179], v[52:55]
    ds_read_b128 v[72:75], v3 offset:1408
    v_mfma_f32_16x16x32_bf16 v[56:59], v[132:135], v[180:183], v[56:59]
    buffer_load_dwordx4 a[136:139], v16, s[16:19], s42 offen offset:1024 sc1
    v_mfma_f32_16x16x32_bf16 v[60:63], v[132:135], v[184:187], v[60:63]
    ds_read_b128 v[108:111], v4 offset:2432
    v_mfma_f32_16x16x32_bf16 v[40:43], v[136:139], v[160:163], v[40:43]
    v_mfma_f32_16x16x32_bf16 v[44:47], v[136:139], v[164:167], v[44:47]
    ds_read_b128 v[76:79], v3 offset:1920
    v_mfma_f32_16x16x32_bf16 v[48:51], v[136:139], v[168:171], v[48:51]
    buffer_load_dwordx4 a[140:143], v2, s[16:19], s42 offen offset:1024 sc1
    v_mfma_f32_16x16x32_bf16 v[52:55], v[136:139], v[172:175], v[52:55]
    ds_read_b128 v[112:115], v4 offset:1920
    v_mfma_f32_16x16x32_bf16 v[56:59], v[136:139], v[176:179], v[56:59]
    v_mfma_f32_16x16x32_bf16 v[60:63], v[136:139], v[180:183], v[60:63]
    ds_read_b128 v[80:83], v3 offset:2432
    v_mfma_f32_16x16x32_bf16 v[44:47], v[140:143], v[160:163], v[44:47]
    buffer_load_dwordx4 a[144:147], v16, s[16:19], s42 offen offset:2048 sc1
    v_mfma_f32_16x16x32_bf16 v[48:51], v[140:143], v[164:167], v[48:51]
    ds_read_b128 v[116:119], v4 offset:1408
    v_mfma_f32_16x16x32_bf16 v[52:55], v[140:143], v[168:171], v[52:55]
    v_mfma_f32_16x16x32_bf16 v[56:59], v[140:143], v[172:175], v[56:59]
    ds_read_b128 v[84:87], v3 offset:2944
    v_mfma_f32_16x16x32_bf16 v[60:63], v[140:143], v[176:179], v[60:63]
    buffer_load_dwordx4 a[148:151], v2, s[16:19], s42 offen offset:2048 sc1
    v_mfma_f32_16x16x32_bf16 v[48:51], v[144:147], v[160:163], v[48:51]
    ds_read_b128 v[120:123], v4 offset:896
    v_mfma_f32_16x16x32_bf16 v[52:55], v[144:147], v[164:167], v[52:55]
    v_mfma_f32_16x16x32_bf16 v[56:59], v[144:147], v[168:171], v[56:59]
    ds_read_b128 v[88:91], v3 offset:3456
    v_mfma_f32_16x16x32_bf16 v[60:63], v[144:147], v[172:175], v[60:63]
    buffer_load_dwordx4 a[152:155], v16, s[16:19], s42 offen offset:3072 sc1
    v_mfma_f32_16x16x32_bf16 v[52:55], v[148:151], v[160:163], v[52:55]
    ds_read_b128 v[124:127], v4 offset:384
    v_mfma_f32_16x16x32_bf16 v[56:59], v[148:151], v[164:167], v[56:59]
    v_mfma_f32_16x16x32_bf16 v[60:63], v[148:151], v[168:171], v[60:63]
    ds_read_b128 v[92:95], v3 offset:3968
    v_mfma_f32_16x16x32_bf16 v[56:59], v[152:155], v[160:163], v[56:59]
    buffer_load_dwordx4 a[156:159], v2, s[16:19], s42 offen offset:3072 sc1
    v_mfma_f32_16x16x32_bf16 v[60:63], v[152:155], v[164:167], v[60:63]
    v_mfma_f32_16x16x32_bf16 v[60:63], v[156:159], v[160:163], v[60:63]
    s_waitcnt lgkmcnt(0)
    v_mfma_f32_16x16x32_bf16 v[32:35], v[64:67], v[96:99], v[32:35]
    s_add_u32 s42, s42, 4096
    v_mfma_f32_16x16x32_bf16 v[36:39], v[64:67], v[100:103], v[36:39]
    buffer_load_dwordx4 a[160:163], v16, s[16:19], s42 offen offset:0 sc1
    v_mfma_f32_16x16x32_bf16 v[40:43], v[64:67], v[104:107], v[40:43]
    ds_read_b128 v[160:163], v4 offset:4032
    v_mfma_f32_16x16x32_bf16 v[44:47], v[64:67], v[108:111], v[44:47]
    v_mfma_f32_16x16x32_bf16 v[48:51], v[64:67], v[112:115], v[48:51]
    ds_read_b128 v[128:131], v3 offset:448
    v_mfma_f32_16x16x32_bf16 v[52:55], v[64:67], v[116:119], v[52:55]
    buffer_load_dwordx4 a[164:167], v2, s[16:19], s42 offen offset:0 sc1
    v_mfma_f32_16x16x32_bf16 v[56:59], v[64:67], v[120:123], v[56:59]
    ds_read_b128 v[164:167], v4 offset:3520
    v_mfma_f32_16x16x32_bf16 v[60:63], v[64:67], v[124:127], v[60:63]
    v_mfma_f32_16x16x32_bf16 v[36:39], v[68:71], v[96:99], v[36:39]
    ds_read_b128 v[132:135], v3 offset:960
    v_mfma_f32_16x16x32_bf16 v[40:43], v[68:71], v[100:103], v[40:43]
    buffer_load_dwordx4 a[168:171], v16, s[16:19], s42 offen offset:1024 sc1
    v_mfma_f32_16x16x32_bf16 v[44:47], v[68:71], v[104:107], v[44:47]
    ds_read_b128 v[168:171], v4 offset:3008
    v_mfma_f32_16x16x32_bf16 v[48:51], v[68:71], v[108:111], v[48:51]
    v_mfma_f32_16x16x32_bf16 v[52:55], v[68:71], v[112:115], v[52:55]
    ds_read_b128 v[136:139], v3 offset:1472
    v_mfma_f32_16x16x32_bf16 v[56:59], v[68:71], v[116:119], v[56:59]
    buffer_load_dwordx4 a[172:175], v2, s[16:19], s42 offen offset:1024 sc1
    v_mfma_f32_16x16x32_bf16 v[60:63], v[68:71], v[120:123], v[60:63]
    ds_read_b128 v[172:175], v4 offset:2496
    v_mfma_f32_16x16x32_bf16 v[40:43], v[72:75], v[96:99], v[40:43]
    v_mfma_f32_16x16x32_bf16 v[44:47], v[72:75], v[100:103], v[44:47]
    ds_read_b128 v[140:143], v3 offset:1984
    v_mfma_f32_16x16x32_bf16 v[48:51], v[72:75], v[104:107], v[48:51]
    buffer_load_dwordx4 a[176:179], v16, s[16:19], s42 offen offset:2048 sc1
    v_mfma_f32_16x16x32_bf16 v[52:55], v[72:75], v[108:111], v[52:55]
    ds_read_b128 v[176:179], v4 offset:1984
    v_mfma_f32_16x16x32_bf16 v[56:59], v[72:75], v[112:115], v[56:59]
    v_mfma_f32_16x16x32_bf16 v[60:63], v[72:75], v[116:119], v[60:63]
    ds_read_b128 v[144:147], v3 offset:2496
    v_mfma_f32_16x16x32_bf16 v[44:47], v[76:79], v[96:99], v[44:47]
    buffer_load_dwordx4 a[180:183], v2, s[16:19], s42 offen offset:2048 sc1
    v_mfma_f32_16x16x32_bf16 v[48:51], v[76:79], v[100:103], v[48:51]
    ds_read_b128 v[180:183], v4 offset:1472
    v_mfma_f32_16x16x32_bf16 v[52:55], v[76:79], v[104:107], v[52:55]
    v_mfma_f32_16x16x32_bf16 v[56:59], v[76:79], v[108:111], v[56:59]
    ds_read_b128 v[148:151], v3 offset:3008
    v_mfma_f32_16x16x32_bf16 v[60:63], v[76:79], v[112:115], v[60:63]
    buffer_load_dwordx4 a[184:187], v16, s[16:19], s42 offen offset:3072 sc1
    v_mfma_f32_16x16x32_bf16 v[48:51], v[80:83], v[96:99], v[48:51]
    ds_read_b128 v[184:187], v4 offset:960
    v_mfma_f32_16x16x32_bf16 v[52:55], v[80:83], v[100:103], v[52:55]
    v_mfma_f32_16x16x32_bf16 v[56:59], v[80:83], v[104:107], v[56:59]
    ds_read_b128 v[152:155], v3 offset:3520
    v_mfma_f32_16x16x32_bf16 v[60:63], v[80:83], v[108:111], v[60:63]
    buffer_load_dwordx4 a[188:191], v2, s[16:19], s42 offen offset:3072 sc1
    v_mfma_f32_16x16x32_bf16 v[52:55], v[84:87], v[96:99], v[52:55]
    ds_read_b128 v[188:191], v4 offset:448
    v_mfma_f32_16x16x32_bf16 v[56:59], v[84:87], v[100:103], v[56:59]
    v_mfma_f32_16x16x32_bf16 v[60:63], v[84:87], v[104:107], v[60:63]
    s_add_u32 s42, s42, 4096
    ds_read_b128 v[156:159], v3 offset:4032
    v_mfma_f32_16x16x32_bf16 v[56:59], v[88:91], v[96:99], v[56:59]
    buffer_load_dwordx4 a[192:195], v16, s[16:19], s42 offen offset:0 sc1
    v_mfma_f32_16x16x32_bf16 v[60:63], v[88:91], v[100:103], v[60:63]
    v_mfma_f32_16x16x32_bf16 v[60:63], v[92:95], v[96:99], v[60:63]
    s_waitcnt lgkmcnt(0)
    s_waitcnt vmcnt(46)
    s_barrier
    v_mfma_f32_16x16x32_bf16 v[32:35], v[128:131], v[160:163], v[32:35]
    ds_read_b64_tr_b16 v[192:193], v17 offset:27648
    ds_read_b64_tr_b16 v[194:195], v17 offset:32256
    v_mfma_f32_16x16x32_bf16 v[36:39], v[128:131], v[164:167], v[36:39]
    buffer_load_dwordx4 a[196:199], v2, s[16:19], s42 offen offset:0 sc1
    v_mfma_f32_16x16x32_bf16 v[40:43], v[128:131], v[168:171], v[40:43]
    ds_read_b64_tr_b16 v[196:197], v18 offset:27648
    ds_read_b64_tr_b16 v[198:199], v18 offset:32256
    v_mfma_f32_16x16x32_bf16 v[44:47], v[128:131], v[172:175], v[44:47]
    ds_read_b64_tr_b16 v[200:201], v19 offset:27648
    ds_read_b64_tr_b16 v[202:203], v19 offset:32256
    v_mfma_f32_16x16x32_bf16 v[48:51], v[128:131], v[176:179], v[48:51]
    s_add_u32 m0, s59, 16384
    ds_read_b64_tr_b16 v[204:205], v20 offset:27648
    ds_read_b64_tr_b16 v[206:207], v20 offset:32256
    v_mfma_f32_16x16x32_bf16 v[52:55], v[128:131], v[180:183], v[52:55]
    buffer_load_dwordx4 v0, s[8:11], s40 offen offset:0 lds
    v_mfma_f32_16x16x32_bf16 v[56:59], v[128:131], v[184:187], v[56:59]
    ds_read_b64_tr_b16 v[208:209], v17 offset:27776
    ds_read_b64_tr_b16 v[210:211], v17 offset:32384
    v_mfma_f32_16x16x32_bf16 v[60:63], v[128:131], v[188:191], v[60:63]
    ds_read_b64_tr_b16 v[212:213], v18 offset:27776
    ds_read_b64_tr_b16 v[214:215], v18 offset:32384
    v_mfma_f32_16x16x32_bf16 v[36:39], v[132:135], v[160:163], v[36:39]
    ds_read_b64_tr_b16 v[216:217], v19 offset:27776
    ds_read_b64_tr_b16 v[218:219], v19 offset:32384
    v_mfma_f32_16x16x32_bf16 v[40:43], v[132:135], v[164:167], v[40:43]
    buffer_load_dwordx4 v1, s[8:11], s40 offen offset:1152 lds
    v_mfma_f32_16x16x32_bf16 v[44:47], v[132:135], v[168:171], v[44:47]
    ds_read_b64_tr_b16 v[220:221], v20 offset:27776
    ds_read_b64_tr_b16 v[222:223], v20 offset:32384
    v_mfma_f32_16x16x32_bf16 v[48:51], v[132:135], v[172:175], v[48:51]
    v_mfma_f32_16x16x32_bf16 v[52:55], v[132:135], v[176:179], v[52:55]
    s_add_u32 s40, s40, 65536
    s_add_u32 m0, s59, 25600
    v_mfma_f32_16x16x32_bf16 v[56:59], v[132:135], v[180:183], v[56:59]
    buffer_load_dwordx4 v0, s[8:11], s40 offen offset:0 lds
    v_mfma_f32_16x16x32_bf16 v[60:63], v[132:135], v[184:187], v[60:63]
    v_mfma_f32_16x16x32_bf16 v[40:43], v[136:139], v[160:163], v[40:43]
    v_mfma_f32_16x16x32_bf16 v[44:47], v[136:139], v[164:167], v[44:47]
    v_mfma_f32_16x16x32_bf16 v[48:51], v[136:139], v[168:171], v[48:51]
    buffer_load_dwordx4 v1, s[8:11], s40 offen offset:1152 lds
    v_mfma_f32_16x16x32_bf16 v[52:55], v[136:139], v[172:175], v[52:55]
    v_mfma_f32_16x16x32_bf16 v[56:59], v[136:139], v[176:179], v[56:59]
    v_mfma_f32_16x16x32_bf16 v[60:63], v[136:139], v[180:183], v[60:63]
    s_add_u32 s40, s40, 65536
    s_add_u32 m0, s59, 34816
    v_mfma_f32_16x16x32_bf16 v[44:47], v[140:143], v[160:163], v[44:47]
    buffer_load_dwordx4 v0, s[8:11], s40 offen offset:0 lds
    v_mfma_f32_16x16x32_bf16 v[48:51], v[140:143], v[164:167], v[48:51]
    v_mfma_f32_16x16x32_bf16 v[52:55], v[140:143], v[168:171], v[52:55]
    v_mfma_f32_16x16x32_bf16 v[56:59], v[140:143], v[172:175], v[56:59]
    v_mfma_f32_16x16x32_bf16 v[60:63], v[140:143], v[176:179], v[60:63]
    buffer_load_dwordx4 v1, s[8:11], s40 offen offset:1152 lds
    v_mfma_f32_16x16x32_bf16 v[48:51], v[144:147], v[160:163], v[48:51]
    v_mfma_f32_16x16x32_bf16 v[52:55], v[144:147], v[164:167], v[52:55]
    v_mfma_f32_16x16x32_bf16 v[56:59], v[144:147], v[168:171], v[56:59]
    s_add_u32 s40, s40, 65536
    s_add_u32 m0, s59, 44032
    v_mfma_f32_16x16x32_bf16 v[60:63], v[144:147], v[172:175], v[60:63]
    buffer_load_dwordx4 v0, s[8:11], s40 offen offset:0 lds
    v_mfma_f32_16x16x32_bf16 v[52:55], v[148:151], v[160:163], v[52:55]
    v_mfma_f32_16x16x32_bf16 v[56:59], v[148:151], v[164:167], v[56:59]
    v_mfma_f32_16x16x32_bf16 v[60:63], v[148:151], v[168:171], v[60:63]
    v_mfma_f32_16x16x32_bf16 v[56:59], v[152:155], v[160:163], v[56:59]
    buffer_load_dwordx4 v1, s[8:11], s40 offen offset:1152 lds
    v_mfma_f32_16x16x32_bf16 v[60:63], v[152:155], v[164:167], v[60:63]
    v_mfma_f32_16x16x32_bf16 v[60:63], v[156:159], v[160:163], v[60:63]
    s_nop 4
    v_cvt_pk_bf16_f32 v32, v32, v33
    v_cvt_pk_bf16_f32 v33, v34, v35
    v_cvt_pk_bf16_f32 v34, v36, v37
    v_cvt_pk_bf16_f32 v35, v38, v39
    v_cvt_pk_bf16_f32 v40, v40, v41
    v_cvt_pk_bf16_f32 v41, v42, v43
    v_cvt_pk_bf16_f32 v42, v44, v45
    v_cvt_pk_bf16_f32 v43, v46, v47
    v_cvt_pk_bf16_f32 v48, v48, v49
    v_cvt_pk_bf16_f32 v49, v50, v51
    v_cvt_pk_bf16_f32 v50, v52, v53
    v_cvt_pk_bf16_f32 v51, v54, v55
    v_cvt_pk_bf16_f32 v56, v56, v57
    v_cvt_pk_bf16_f32 v57, v58, v59
    v_cvt_pk_bf16_f32 v58, v60, v61
    v_cvt_pk_bf16_f32 v59, v62, v63
    v_permlane16_swap_b32 v32, v34
    v_permlane16_swap_b32 v33, v35
    v_permlane16_swap_b32 v40, v42
    v_permlane16_swap_b32 v41, v43
    v_permlane16_swap_b32 v48, v50
    v_permlane16_swap_b32 v49, v51
    v_permlane16_swap_b32 v56, v58
    v_permlane16_swap_b32 v57, v59
    s_waitcnt vmcnt(24) lgkmcnt(0)
    v_mfma_f32_16x16x32_bf16 v[64:67], v[192:195], a[0:3], 0
    v_mfma_f32_16x16x32_bf16 v[68:71], v[192:195], a[4:7], 0
    v_mfma_f32_16x16x32_bf16 v[72:75], v[192:195], a[128:131], 0
    ds_read_b64_tr_b16 v[224:225], v17 offset:36864
    ds_read_b64_tr_b16 v[226:227], v17 offset:41472
    v_mfma_f32_16x16x32_bf16 v[76:79], v[192:195], a[132:135], 0
    s_add_u32 s40, s40, 65536
    ds_read_b64_tr_b16 v[228:229], v18 offset:36864
    ds_read_b64_tr_b16 v[230:231], v18 offset:41472
    v_mfma_f32_16x16x32_bf16 v[80:83], v[196:199], a[0:3], 0
    buffer_store_dwordx4 v[32:35], v5, s[12:15], s44 offen offset:0 sc1
    v_mfma_f32_16x16x32_bf16 v[84:87], v[196:199], a[4:7], 0
    ds_read_b64_tr_b16 v[232:233], v19 offset:36864
    ds_read_b64_tr_b16 v[234:235], v19 offset:41472
    v_mfma_f32_16x16x32_bf16 v[88:91], v[196:199], a[128:131], 0
    ds_read_b64_tr_b16 v[236:237], v20 offset:36864
    ds_read_b64_tr_b16 v[238:239], v20 offset:41472
    v_mfma_f32_16x16x32_bf16 v[92:95], v[196:199], a[132:135], 0
    v_mfma_f32_16x16x32_bf16 v[96:99], v[200:203], a[0:3], 0
    ds_read_b64_tr_b16 v[240:241], v17 offset:36992
    ds_read_b64_tr_b16 v[242:243], v17 offset:41600
    v_mfma_f32_16x16x32_bf16 v[100:103], v[200:203], a[4:7], 0
    buffer_store_dwordx4 v[40:43], v5, s[12:15], s44 offen offset:1024 sc1
    v_mfma_f32_16x16x32_bf16 v[104:107], v[200:203], a[128:131], 0
    ds_read_b64_tr_b16 v[244:245], v18 offset:36992
    ds_read_b64_tr_b16 v[246:247], v18 offset:41600
    v_mfma_f32_16x16x32_bf16 v[108:111], v[200:203], a[132:135], 0
    ds_read_b64_tr_b16 v[248:249], v19 offset:36992
    ds_read_b64_tr_b16 v[250:251], v19 offset:41600
    v_mfma_f32_16x16x32_bf16 v[112:115], v[204:207], a[0:3], 0
    v_mfma_f32_16x16x32_bf16 v[116:119], v[204:207], a[4:7], 0
    ds_read_b64_tr_b16 v[252:253], v20 offset:36992
    ds_read_b64_tr_b16 v[254:255], v20 offset:41600
    v_mfma_f32_16x16x32_bf16 v[120:123], v[204:207], a[128:131], 0
    buffer_store_dwordx4 v[48:51], v5, s[12:15], s44 offen offset:2048 sc1
    v_mfma_f32_16x16x32_bf16 v[124:127], v[204:207], a[132:135], 0
    v_mfma_f32_16x16x32_bf16 v[128:131], v[208:211], a[0:3], 0
    v_mfma_f32_16x16x32_bf16 v[132:135], v[208:211], a[4:7], 0
    v_mfma_f32_16x16x32_bf16 v[136:139], v[208:211], a[128:131], 0
    buffer_store_dwordx4 v[56:59], v5, s[12:15], s44 offen offset:3072 sc1
    v_mfma_f32_16x16x32_bf16 v[140:143], v[208:211], a[132:135], 0
    v_mfma_f32_16x16x32_bf16 v[144:147], v[212:215], a[0:3], 0
    v_mfma_f32_16x16x32_bf16 v[148:151], v[212:215], a[4:7], 0
    v_mfma_f32_16x16x32_bf16 v[152:155], v[212:215], a[128:131], 0
    buffer_load_dwordx4 a[200:203], v16, s[16:19], s42 offen offset:1024 sc1
    v_mfma_f32_16x16x32_bf16 v[156:159], v[212:215], a[132:135], 0
    v_mfma_f32_16x16x32_bf16 v[160:163], v[216:219], a[0:3], 0
    v_mfma_f32_16x16x32_bf16 v[164:167], v[216:219], a[4:7], 0
    v_mfma_f32_16x16x32_bf16 v[168:171], v[216:219], a[128:131], 0
    buffer_load_dwordx4 a[204:207], v2, s[16:19], s42 offen offset:1024 sc1
    v_mfma_f32_16x16x32_bf16 v[172:175], v[216:219], a[132:135], 0
    v_mfma_f32_16x16x32_bf16 v[176:179], v[220:223], a[0:3], 0
    v_mfma_f32_16x16x32_bf16 v[180:183], v[220:223], a[4:7], 0
    s_add_u32 m0, s59, 53248
    v_mfma_f32_16x16x32_bf16 v[184:187], v[220:223], a[128:131], 0
    buffer_load_dwordx4 v0, s[8:11], s40 offen offset:0 lds
    v_mfma_f32_16x16x32_bf16 v[188:191], v[220:223], a[132:135], 0
    buffer_load_dwordx4 v1, s[8:11], s40 offen offset:1152 lds
    s_waitcnt vmcnt(28) lgkmcnt(0)
    s_barrier
    v_mfma_f32_16x16x32_bf16 v[64:67], v[224:227], a[8:11], v[64:67]
    v_mfma_f32_16x16x32_bf16 v[68:71], v[224:227], a[12:15], v[68:71]
    v_mfma_f32_16x16x32_bf16 v[72:75], v[224:227], a[136:139], v[72:75]
    ds_read_b64_tr_b16 v[192:193], v17 offset:46080
    ds_read_b64_tr_b16 v[194:195], v17 offset:50688
    v_mfma_f32_16x16x32_bf16 v[76:79], v[224:227], a[140:143], v[76:79]
    s_add_u32 s40, s40, 65536
    ds_read_b64_tr_b16 v[196:197], v18 offset:46080
    ds_read_b64_tr_b16 v[198:199], v18 offset:50688
    v_mfma_f32_16x16x32_bf16 v[80:83], v[228:231], a[8:11], v[80:83]
    buffer_load_dwordx4 a[208:211], v16, s[16:19], s42 offen offset:2048 sc1
    v_mfma_f32_16x16x32_bf16 v[84:87], v[228:231], a[12:15], v[84:87]
    ds_read_b64_tr_b16 v[200:201], v19 offset:46080
    ds_read_b64_tr_b16 v[202:203], v19 offset:50688
    v_mfma_f32_16x16x32_bf16 v[88:91], v[228:231], a[136:139], v[88:91]
    ds_read_b64_tr_b16 v[204:205], v20 offset:46080
    ds_read_b64_tr_b16 v[206:207], v20 offset:50688
    v_mfma_f32_16x16x32_bf16 v[92:95], v[228:231], a[140:143], v[92:95]
    v_mfma_f32_16x16x32_bf16 v[96:99], v[232:235], a[8:11], v[96:99]
    ds_read_b64_tr_b16 v[208:209], v17 offset:46208
    ds_read_b64_tr_b16 v[210:211], v17 offset:50816
    v_mfma_f32_16x16x32_bf16 v[100:103], v[232:235], a[12:15], v[100:103]
    buffer_load_dwordx4 a[212:215], v2, s[16:19], s42 offen offset:2048 sc1
    v_mfma_f32_16x16x32_bf16 v[104:107], v[232:235], a[136:139], v[104:107]
    ds_read_b64_tr_b16 v[212:213], v18 offset:46208
    ds_read_b64_tr_b16 v[214:215], v18 offset:50816
    v_mfma_f32_16x16x32_bf16 v[108:111], v[232:235], a[140:143], v[108:111]
    ds_read_b64_tr_b16 v[216:217], v19 offset:46208
    ds_read_b64_tr_b16 v[218:219], v19 offset:50816
    v_mfma_f32_16x16x32_bf16 v[112:115], v[236:239], a[8:11], v[112:115]
    v_mfma_f32_16x16x32_bf16 v[116:119], v[236:239], a[12:15], v[116:119]
    s_add_u32 m0, s59, 62464
    ds_read_b64_tr_b16 v[220:221], v20 offset:46208
    ds_read_b64_tr_b16 v[222:223], v20 offset:50816
    v_mfma_f32_16x16x32_bf16 v[120:123], v[236:239], a[136:139], v[120:123]
    buffer_load_dwordx4 v0, s[8:11], s40 offen offset:0 lds
    v_mfma_f32_16x16x32_bf16 v[124:127], v[236:239], a[140:143], v[124:127]
    v_mfma_f32_16x16x32_bf16 v[128:131], v[240:243], a[8:11], v[128:131]
    v_mfma_f32_16x16x32_bf16 v[132:135], v[240:243], a[12:15], v[132:135]
    v_mfma_f32_16x16x32_bf16 v[136:139], v[240:243], a[136:139], v[136:139]
    buffer_load_dwordx4 v1, s[8:11], s40 offen offset:1152 lds
    v_mfma_f32_16x16x32_bf16 v[140:143], v[240:243], a[140:143], v[140:143]
    v_mfma_f32_16x16x32_bf16 v[144:147], v[244:247], a[8:11], v[144:147]
    v_mfma_f32_16x16x32_bf16 v[148:151], v[244:247], a[12:15], v[148:151]
    s_add_u32 s40, s40, 65536
    v_mfma_f32_16x16x32_bf16 v[152:155], v[244:247], a[136:139], v[152:155]
    buffer_load_dwordx4 a[216:219], v16, s[16:19], s42 offen offset:3072 sc1
    v_mfma_f32_16x16x32_bf16 v[156:159], v[244:247], a[140:143], v[156:159]
gated_mix__ssm_conv_h3__compressed_kv_cla__prompt_kernel_pad12:
    s_cbranch_execz gated_mix__ssm_conv_h3__compressed_kv_cla__prompt_kernel_pad16
    v_mfma_f32_16x16x32_bf16 v[160:163], v[248:251], a[8:11], v[160:163]
    v_mfma_f32_16x16x32_bf16 v[164:167], v[248:251], a[12:15], v[164:167]
    v_mfma_f32_16x16x32_bf16 v[168:171], v[248:251], a[136:139], v[168:171]
    buffer_load_dwordx4 a[220:223], v2, s[16:19], s42 offen offset:3072 sc1
    v_mfma_f32_16x16x32_bf16 v[172:175], v[248:251], a[140:143], v[172:175]
    v_mfma_f32_16x16x32_bf16 v[176:179], v[252:255], a[8:11], v[176:179]
    v_mfma_f32_16x16x32_bf16 v[180:183], v[252:255], a[12:15], v[180:183]
    s_add_u32 s42, s42, 4096
    v_mfma_f32_16x16x32_bf16 v[184:187], v[252:255], a[136:139], v[184:187]
    buffer_load_dwordx4 a[88:91], v16, s[16:19], s41 offen offset:3072 sc1
    v_mfma_f32_16x16x32_bf16 v[188:191], v[252:255], a[140:143], v[188:191]
    s_waitcnt lgkmcnt(0)
    v_mfma_f32_16x16x32_bf16 v[64:67], v[192:195], a[16:19], v[64:67]
    v_mfma_f32_16x16x32_bf16 v[68:71], v[192:195], a[20:23], v[68:71]
    v_mfma_f32_16x16x32_bf16 v[72:75], v[192:195], a[144:147], v[72:75]
    ds_read_b64_tr_b16 v[224:225], v17 offset:55296
    ds_read_b64_tr_b16 v[226:227], v17 offset:59904
    v_mfma_f32_16x16x32_bf16 v[76:79], v[192:195], a[148:151], v[76:79]
    ds_read_b64_tr_b16 v[228:229], v18 offset:55296
    ds_read_b64_tr_b16 v[230:231], v18 offset:59904
    v_mfma_f32_16x16x32_bf16 v[80:83], v[196:199], a[16:19], v[80:83]
    buffer_load_dwordx4 a[92:95], v2, s[16:19], s41 offen offset:3072 sc1
    v_mfma_f32_16x16x32_bf16 v[84:87], v[196:199], a[20:23], v[84:87]
    ds_read_b64_tr_b16 v[232:233], v19 offset:55296
    ds_read_b64_tr_b16 v[234:235], v19 offset:59904
    v_mfma_f32_16x16x32_bf16 v[88:91], v[196:199], a[144:147], v[88:91]
    ds_read_b64_tr_b16 v[236:237], v20 offset:55296
    ds_read_b64_tr_b16 v[238:239], v20 offset:59904
    v_mfma_f32_16x16x32_bf16 v[92:95], v[196:199], a[148:151], v[92:95]
    v_mfma_f32_16x16x32_bf16 v[96:99], v[200:203], a[16:19], v[96:99]
    s_add_u32 s41, s41, 4096
    s_add_u32 s36, s48, 2097152
    ds_read_b64_tr_b16 v[240:241], v17 offset:55424
    ds_read_b64_tr_b16 v[242:243], v17 offset:60032
    v_mfma_f32_16x16x32_bf16 v[100:103], v[200:203], a[20:23], v[100:103]
    buffer_load_dwordx4 v[32:35], v21, s[24:27], s36 offen
    v_mfma_f32_16x16x32_bf16 v[104:107], v[200:203], a[144:147], v[104:107]
    ds_read_b64_tr_b16 v[244:245], v18 offset:55424
    ds_read_b64_tr_b16 v[246:247], v18 offset:60032
    v_mfma_f32_16x16x32_bf16 v[108:111], v[200:203], a[148:151], v[108:111]
    ds_read_b64_tr_b16 v[248:249], v19 offset:55424
    ds_read_b64_tr_b16 v[250:251], v19 offset:60032
    v_mfma_f32_16x16x32_bf16 v[112:115], v[204:207], a[16:19], v[112:115]
    v_mfma_f32_16x16x32_bf16 v[116:119], v[204:207], a[20:23], v[116:119]
    s_add_u32 s36, s48, 2228224
    ds_read_b64_tr_b16 v[252:253], v20 offset:55424
    ds_read_b64_tr_b16 v[254:255], v20 offset:60032
    v_mfma_f32_16x16x32_bf16 v[120:123], v[204:207], a[144:147], v[120:123]
    buffer_load_dwordx4 v[36:39], v21, s[24:27], s36 offen
    v_mfma_f32_16x16x32_bf16 v[124:127], v[204:207], a[148:151], v[124:127]
    v_mfma_f32_16x16x32_bf16 v[128:131], v[208:211], a[16:19], v[128:131]
    v_mfma_f32_16x16x32_bf16 v[132:135], v[208:211], a[20:23], v[132:135]
    s_add_u32 m0, s59, 71680
    v_mfma_f32_16x16x32_bf16 v[136:139], v[208:211], a[144:147], v[136:139]
    buffer_load_dwordx4 v0, s[8:11], s40 offen offset:0 lds
    v_mfma_f32_16x16x32_bf16 v[140:143], v[208:211], a[148:151], v[140:143]
    v_mfma_f32_16x16x32_bf16 v[144:147], v[212:215], a[16:19], v[144:147]
    v_mfma_f32_16x16x32_bf16 v[148:151], v[212:215], a[20:23], v[148:151]
    v_mfma_f32_16x16x32_bf16 v[152:155], v[212:215], a[144:147], v[152:155]
    buffer_load_dwordx4 v1, s[8:11], s40 offen offset:1152 lds
    v_mfma_f32_16x16x32_bf16 v[156:159], v[212:215], a[148:151], v[156:159]
    v_mfma_f32_16x16x32_bf16 v[160:163], v[216:219], a[16:19], v[160:163]
    v_mfma_f32_16x16x32_bf16 v[164:167], v[216:219], a[20:23], v[164:167]
    s_add_u32 s40, s40, 65536
    v_mfma_f32_16x16x32_bf16 v[168:171], v[216:219], a[144:147], v[168:171]
    buffer_load_dwordx4 a[224:227], v16, s[16:19], s42 offen offset:0 sc1
    v_mfma_f32_16x16x32_bf16 v[172:175], v[216:219], a[148:151], v[172:175]
    v_mfma_f32_16x16x32_bf16 v[176:179], v[220:223], a[16:19], v[176:179]
    v_mfma_f32_16x16x32_bf16 v[180:183], v[220:223], a[20:23], v[180:183]
    v_mfma_f32_16x16x32_bf16 v[184:187], v[220:223], a[144:147], v[184:187]
    buffer_load_dwordx4 a[228:231], v2, s[16:19], s42 offen offset:0 sc1
    v_mfma_f32_16x16x32_bf16 v[188:191], v[220:223], a[148:151], v[188:191]
    s_waitcnt vmcnt(38) lgkmcnt(0)
    s_barrier
    v_mfma_f32_16x16x32_bf16 v[64:67], v[224:227], a[24:27], v[64:67]
    v_add_u32 v17, 64512, v17
    v_add_u32 v18, 64512, v18
    v_mfma_f32_16x16x32_bf16 v[68:71], v[224:227], a[28:31], v[68:71]
    v_add_u32 v19, 64512, v19
    v_add_u32 v20, 64512, v20
    v_mfma_f32_16x16x32_bf16 v[72:75], v[224:227], a[152:155], v[72:75]
    ds_read_b64_tr_b16 v[192:193], v17 offset:0
    ds_read_b64_tr_b16 v[194:195], v17 offset:4608
    v_mfma_f32_16x16x32_bf16 v[76:79], v[224:227], a[156:159], v[76:79]
    ds_read_b64_tr_b16 v[196:197], v18 offset:0
    ds_read_b64_tr_b16 v[198:199], v18 offset:4608
    v_mfma_f32_16x16x32_bf16 v[80:83], v[228:231], a[24:27], v[80:83]
    buffer_load_dwordx4 a[96:99], v16, s[16:19], s41 offen offset:0 sc1
    v_mfma_f32_16x16x32_bf16 v[84:87], v[228:231], a[28:31], v[84:87]
    ds_read_b64_tr_b16 v[200:201], v19 offset:0
    ds_read_b64_tr_b16 v[202:203], v19 offset:4608
    v_mfma_f32_16x16x32_bf16 v[88:91], v[228:231], a[152:155], v[88:91]
    ds_read_b64_tr_b16 v[204:205], v20 offset:0
    ds_read_b64_tr_b16 v[206:207], v20 offset:4608
    v_mfma_f32_16x16x32_bf16 v[92:95], v[228:231], a[156:159], v[92:95]
    v_mfma_f32_16x16x32_bf16 v[96:99], v[232:235], a[24:27], v[96:99]
    ds_read_b64_tr_b16 v[208:209], v17 offset:128
    ds_read_b64_tr_b16 v[210:211], v17 offset:4736
    v_mfma_f32_16x16x32_bf16 v[100:103], v[232:235], a[28:31], v[100:103]
    buffer_load_dwordx4 a[100:103], v2, s[16:19], s41 offen offset:0 sc1
    v_mfma_f32_16x16x32_bf16 v[104:107], v[232:235], a[152:155], v[104:107]
    ds_read_b64_tr_b16 v[212:213], v18 offset:128
    ds_read_b64_tr_b16 v[214:215], v18 offset:4736
    v_mfma_f32_16x16x32_bf16 v[108:111], v[232:235], a[156:159], v[108:111]
    ds_read_b64_tr_b16 v[216:217], v19 offset:128
    ds_read_b64_tr_b16 v[218:219], v19 offset:4736
    v_mfma_f32_16x16x32_bf16 v[112:115], v[236:239], a[24:27], v[112:115]
    v_mfma_f32_16x16x32_bf16 v[116:119], v[236:239], a[28:31], v[116:119]
    s_add_u32 m0, s59, 80896
    ds_read_b64_tr_b16 v[220:221], v20 offset:128
    ds_read_b64_tr_b16 v[222:223], v20 offset:4736
    v_mfma_f32_16x16x32_bf16 v[120:123], v[236:239], a[152:155], v[120:123]
    buffer_load_dwordx4 v0, s[8:11], s40 offen offset:0 lds
    v_mfma_f32_16x16x32_bf16 v[124:127], v[236:239], a[156:159], v[124:127]
    v_mfma_f32_16x16x32_bf16 v[128:131], v[240:243], a[24:27], v[128:131]
    v_mfma_f32_16x16x32_bf16 v[132:135], v[240:243], a[28:31], v[132:135]
    v_mfma_f32_16x16x32_bf16 v[136:139], v[240:243], a[152:155], v[136:139]
    buffer_load_dwordx4 v1, s[8:11], s40 offen offset:1152 lds
    v_mfma_f32_16x16x32_bf16 v[140:143], v[240:243], a[156:159], v[140:143]
    v_mfma_f32_16x16x32_bf16 v[144:147], v[244:247], a[24:27], v[144:147]
    v_mfma_f32_16x16x32_bf16 v[148:151], v[244:247], a[28:31], v[148:151]
    s_add_u32 s40, s40, 65536
    v_mfma_f32_16x16x32_bf16 v[152:155], v[244:247], a[152:155], v[152:155]
    buffer_load_dwordx4 a[232:235], v16, s[16:19], s42 offen offset:1024 sc1
    v_mfma_f32_16x16x32_bf16 v[156:159], v[244:247], a[156:159], v[156:159]
    v_mfma_f32_16x16x32_bf16 v[160:163], v[248:251], a[24:27], v[160:163]
    v_mfma_f32_16x16x32_bf16 v[164:167], v[248:251], a[28:31], v[164:167]
    v_mfma_f32_16x16x32_bf16 v[168:171], v[248:251], a[152:155], v[168:171]
    buffer_load_dwordx4 a[236:239], v2, s[16:19], s42 offen offset:1024 sc1
    v_mfma_f32_16x16x32_bf16 v[172:175], v[248:251], a[156:159], v[172:175]
    v_mfma_f32_16x16x32_bf16 v[176:179], v[252:255], a[24:27], v[176:179]
    v_mfma_f32_16x16x32_bf16 v[180:183], v[252:255], a[28:31], v[180:183]
    v_mfma_f32_16x16x32_bf16 v[184:187], v[252:255], a[152:155], v[184:187]
    buffer_load_dwordx4 a[104:107], v16, s[16:19], s41 offen offset:1024 sc1
    v_mfma_f32_16x16x32_bf16 v[188:191], v[252:255], a[156:159], v[188:191]
    s_waitcnt lgkmcnt(0)
    v_mfma_f32_16x16x32_bf16 v[64:67], v[192:195], a[32:35], v[64:67]
    v_mfma_f32_16x16x32_bf16 v[68:71], v[192:195], a[36:39], v[68:71]
    v_mfma_f32_16x16x32_bf16 v[72:75], v[192:195], a[160:163], v[72:75]
    ds_read_b64_tr_b16 v[224:225], v17 offset:9216
    ds_read_b64_tr_b16 v[226:227], v17 offset:13824
    v_mfma_f32_16x16x32_bf16 v[76:79], v[192:195], a[164:167], v[76:79]
    ds_read_b64_tr_b16 v[228:229], v18 offset:9216
    ds_read_b64_tr_b16 v[230:231], v18 offset:13824
    v_mfma_f32_16x16x32_bf16 v[80:83], v[196:199], a[32:35], v[80:83]
    buffer_load_dwordx4 a[108:111], v2, s[16:19], s41 offen offset:1024 sc1
    v_mfma_f32_16x16x32_bf16 v[84:87], v[196:199], a[36:39], v[84:87]
    ds_read_b64_tr_b16 v[232:233], v19 offset:9216
    ds_read_b64_tr_b16 v[234:235], v19 offset:13824
    v_mfma_f32_16x16x32_bf16 v[88:91], v[196:199], a[160:163], v[88:91]
    ds_read_b64_tr_b16 v[236:237], v20 offset:9216
    ds_read_b64_tr_b16 v[238:239], v20 offset:13824
    v_mfma_f32_16x16x32_bf16 v[92:95], v[196:199], a[164:167], v[92:95]
    v_mfma_f32_16x16x32_bf16 v[96:99], v[200:203], a[32:35], v[96:99]
    s_waitcnt vmcnt(26)
    ds_read_b64_tr_b16 v[240:241], v17 offset:9344
    ds_read_b64_tr_b16 v[242:243], v17 offset:13952
    v_mfma_f32_16x16x32_bf16 v[100:103], v[200:203], a[36:39], v[100:103]
    buffer_store_dword v9, v8, s[28:31], s57 offen sc1
    v_mfma_f32_16x16x32_bf16 v[104:107], v[200:203], a[160:163], v[104:107]
    ds_read_b64_tr_b16 v[244:245], v18 offset:9344
    ds_read_b64_tr_b16 v[246:247], v18 offset:13952
    v_mfma_f32_16x16x32_bf16 v[108:111], v[200:203], a[164:167], v[108:111]
    ds_read_b64_tr_b16 v[248:249], v19 offset:9344
    ds_read_b64_tr_b16 v[250:251], v19 offset:13952
    v_mfma_f32_16x16x32_bf16 v[112:115], v[204:207], a[32:35], v[112:115]
    v_mfma_f32_16x16x32_bf16 v[116:119], v[204:207], a[36:39], v[116:119]
    s_add_u32 m0, s59, 90112
    ds_read_b64_tr_b16 v[252:253], v20 offset:9344
    ds_read_b64_tr_b16 v[254:255], v20 offset:13952
    v_mfma_f32_16x16x32_bf16 v[120:123], v[204:207], a[160:163], v[120:123]
    buffer_load_dwordx4 v0, s[8:11], s40 offen offset:0 lds
    v_mfma_f32_16x16x32_bf16 v[124:127], v[204:207], a[164:167], v[124:127]
    v_mfma_f32_16x16x32_bf16 v[128:131], v[208:211], a[32:35], v[128:131]
    v_mfma_f32_16x16x32_bf16 v[132:135], v[208:211], a[36:39], v[132:135]
    v_mfma_f32_16x16x32_bf16 v[136:139], v[208:211], a[160:163], v[136:139]
    buffer_load_dwordx4 v1, s[8:11], s40 offen offset:1152 lds
    v_mfma_f32_16x16x32_bf16 v[140:143], v[208:211], a[164:167], v[140:143]
    v_mfma_f32_16x16x32_bf16 v[144:147], v[212:215], a[32:35], v[144:147]
    v_mfma_f32_16x16x32_bf16 v[148:151], v[212:215], a[36:39], v[148:151]
    s_add_u32 s40, s40, 65536
    v_mfma_f32_16x16x32_bf16 v[152:155], v[212:215], a[160:163], v[152:155]
    buffer_load_dwordx4 a[240:243], v16, s[16:19], s42 offen offset:2048 sc1
    v_mfma_f32_16x16x32_bf16 v[156:159], v[212:215], a[164:167], v[156:159]
    v_mfma_f32_16x16x32_bf16 v[160:163], v[216:219], a[32:35], v[160:163]
    v_mfma_f32_16x16x32_bf16 v[164:167], v[216:219], a[36:39], v[164:167]
    v_mfma_f32_16x16x32_bf16 v[168:171], v[216:219], a[160:163], v[168:171]
    buffer_load_dwordx4 a[244:247], v2, s[16:19], s42 offen offset:2048 sc1
    v_mfma_f32_16x16x32_bf16 v[172:175], v[216:219], a[164:167], v[172:175]
    v_mfma_f32_16x16x32_bf16 v[176:179], v[220:223], a[32:35], v[176:179]
    v_mfma_f32_16x16x32_bf16 v[180:183], v[220:223], a[36:39], v[180:183]
    v_mfma_f32_16x16x32_bf16 v[184:187], v[220:223], a[160:163], v[184:187]
    buffer_load_dwordx4 a[112:115], v16, s[16:19], s41 offen offset:2048 sc1
    v_mfma_f32_16x16x32_bf16 v[188:191], v[220:223], a[164:167], v[188:191]
    buffer_load_dwordx4 a[116:119], v2, s[16:19], s41 offen offset:2048 sc1
    s_waitcnt vmcnt(41) lgkmcnt(0)
    s_barrier
    v_mfma_f32_16x16x32_bf16 v[64:67], v[224:227], a[40:43], v[64:67]
    v_add_u32 v17, 4294838272, v17
    v_add_u32 v18, 4294838272, v18
    v_mfma_f32_16x16x32_bf16 v[68:71], v[224:227], a[44:47], v[68:71]
    v_add_u32 v19, 4294838272, v19
    v_add_u32 v20, 4294838272, v20
    v_mfma_f32_16x16x32_bf16 v[72:75], v[224:227], a[168:171], v[72:75]
    ds_read_b64_tr_b16 v[192:193], v17 offset:0
    ds_read_b64_tr_b16 v[194:195], v17 offset:4608
    v_mfma_f32_16x16x32_bf16 v[76:79], v[224:227], a[172:175], v[76:79]
    s_add_u32 m0, s59, 99328
    ds_read_b64_tr_b16 v[196:197], v18 offset:0
    ds_read_b64_tr_b16 v[198:199], v18 offset:4608
    v_mfma_f32_16x16x32_bf16 v[80:83], v[228:231], a[40:43], v[80:83]
    buffer_load_dwordx4 v0, s[8:11], s40 offen offset:0 lds
    v_mfma_f32_16x16x32_bf16 v[84:87], v[228:231], a[44:47], v[84:87]
    ds_read_b64_tr_b16 v[200:201], v19 offset:0
    ds_read_b64_tr_b16 v[202:203], v19 offset:4608
    v_mfma_f32_16x16x32_bf16 v[88:91], v[228:231], a[168:171], v[88:91]
    ds_read_b64_tr_b16 v[204:205], v20 offset:0
    ds_read_b64_tr_b16 v[206:207], v20 offset:4608
    v_mfma_f32_16x16x32_bf16 v[92:95], v[228:231], a[172:175], v[92:95]
    v_mfma_f32_16x16x32_bf16 v[96:99], v[232:235], a[40:43], v[96:99]
    ds_read_b64_tr_b16 v[208:209], v17 offset:128
    ds_read_b64_tr_b16 v[210:211], v17 offset:4736
    v_mfma_f32_16x16x32_bf16 v[100:103], v[232:235], a[44:47], v[100:103]
    buffer_load_dwordx4 v1, s[8:11], s40 offen offset:1152 lds
    v_mfma_f32_16x16x32_bf16 v[104:107], v[232:235], a[168:171], v[104:107]
    ds_read_b64_tr_b16 v[212:213], v18 offset:128
    ds_read_b64_tr_b16 v[214:215], v18 offset:4736
    v_mfma_f32_16x16x32_bf16 v[108:111], v[232:235], a[172:175], v[108:111]
    ds_read_b64_tr_b16 v[216:217], v19 offset:128
    ds_read_b64_tr_b16 v[218:219], v19 offset:4736
    v_mfma_f32_16x16x32_bf16 v[112:115], v[236:239], a[40:43], v[112:115]
    v_mfma_f32_16x16x32_bf16 v[116:119], v[236:239], a[44:47], v[116:119]
    s_add_u32 s40, s40, 65536
    ds_read_b64_tr_b16 v[220:221], v20 offset:128
    ds_read_b64_tr_b16 v[222:223], v20 offset:4736
    v_mfma_f32_16x16x32_bf16 v[120:123], v[236:239], a[168:171], v[120:123]
    buffer_load_dwordx4 a[248:251], v16, s[16:19], s42 offen offset:3072 sc1
    v_mfma_f32_16x16x32_bf16 v[124:127], v[236:239], a[172:175], v[124:127]
    v_mfma_f32_16x16x32_bf16 v[128:131], v[240:243], a[40:43], v[128:131]
    v_mfma_f32_16x16x32_bf16 v[132:135], v[240:243], a[44:47], v[132:135]
    v_mfma_f32_16x16x32_bf16 v[136:139], v[240:243], a[168:171], v[136:139]
    buffer_load_dwordx4 a[252:255], v2, s[16:19], s42 offen offset:3072 sc1
    v_mfma_f32_16x16x32_bf16 v[140:143], v[240:243], a[172:175], v[140:143]
    v_mfma_f32_16x16x32_bf16 v[144:147], v[244:247], a[40:43], v[144:147]
    v_mfma_f32_16x16x32_bf16 v[148:151], v[244:247], a[44:47], v[148:151]
    s_add_u32 s42, s42, 4096
    v_mfma_f32_16x16x32_bf16 v[152:155], v[244:247], a[168:171], v[152:155]
    buffer_load_dwordx4 a[120:123], v16, s[16:19], s41 offen offset:3072 sc1
    v_mfma_f32_16x16x32_bf16 v[156:159], v[244:247], a[172:175], v[156:159]
    v_mfma_f32_16x16x32_bf16 v[160:163], v[248:251], a[40:43], v[160:163]
    v_mfma_f32_16x16x32_bf16 v[164:167], v[248:251], a[44:47], v[164:167]
    v_mfma_f32_16x16x32_bf16 v[168:171], v[248:251], a[168:171], v[168:171]
    buffer_load_dwordx4 a[124:127], v2, s[16:19], s41 offen offset:3072 sc1
    v_mfma_f32_16x16x32_bf16 v[172:175], v[248:251], a[172:175], v[172:175]
    v_mfma_f32_16x16x32_bf16 v[176:179], v[252:255], a[40:43], v[176:179]
    v_mfma_f32_16x16x32_bf16 v[180:183], v[252:255], a[44:47], v[180:183]
    s_add_u32 s41, s41, 4096
    s_add_u32 m0, s59, 108544
    v_mfma_f32_16x16x32_bf16 v[184:187], v[252:255], a[168:171], v[184:187]
    buffer_load_dwordx4 v0, s[8:11], s40 offen offset:0 lds
    v_mfma_f32_16x16x32_bf16 v[188:191], v[252:255], a[172:175], v[188:191]
    s_waitcnt lgkmcnt(0)
    v_mfma_f32_16x16x32_bf16 v[64:67], v[192:195], a[48:51], v[64:67]
    v_mfma_f32_16x16x32_bf16 v[68:71], v[192:195], a[52:55], v[68:71]
    v_mfma_f32_16x16x32_bf16 v[72:75], v[192:195], a[176:179], v[72:75]
    ds_read_b64_tr_b16 v[224:225], v17 offset:9216
    ds_read_b64_tr_b16 v[226:227], v17 offset:13824
    v_mfma_f32_16x16x32_bf16 v[76:79], v[192:195], a[180:183], v[76:79]
    ds_read_b64_tr_b16 v[228:229], v18 offset:9216
    ds_read_b64_tr_b16 v[230:231], v18 offset:13824
    v_mfma_f32_16x16x32_bf16 v[80:83], v[196:199], a[48:51], v[80:83]
    buffer_load_dwordx4 v1, s[8:11], s40 offen offset:1152 lds
    v_mfma_f32_16x16x32_bf16 v[84:87], v[196:199], a[52:55], v[84:87]
    ds_read_b64_tr_b16 v[232:233], v19 offset:9216
    ds_read_b64_tr_b16 v[234:235], v19 offset:13824
    v_mfma_f32_16x16x32_bf16 v[88:91], v[196:199], a[176:179], v[88:91]
    ds_read_b64_tr_b16 v[236:237], v20 offset:9216
    ds_read_b64_tr_b16 v[238:239], v20 offset:13824
    v_mfma_f32_16x16x32_bf16 v[92:95], v[196:199], a[180:183], v[92:95]
    v_mfma_f32_16x16x32_bf16 v[96:99], v[200:203], a[48:51], v[96:99]
    s_add_u32 s40, s40, 65536
    ds_read_b64_tr_b16 v[240:241], v17 offset:9344
    ds_read_b64_tr_b16 v[242:243], v17 offset:13952
    v_mfma_f32_16x16x32_bf16 v[100:103], v[200:203], a[52:55], v[100:103]
    buffer_load_dwordx4 a[128:131], v16, s[16:19], s42 offen offset:0 sc1
    v_mfma_f32_16x16x32_bf16 v[104:107], v[200:203], a[176:179], v[104:107]
    ds_read_b64_tr_b16 v[244:245], v18 offset:9344
    ds_read_b64_tr_b16 v[246:247], v18 offset:13952
    v_mfma_f32_16x16x32_bf16 v[108:111], v[200:203], a[180:183], v[108:111]
    ds_read_b64_tr_b16 v[248:249], v19 offset:9344
    ds_read_b64_tr_b16 v[250:251], v19 offset:13952
    v_mfma_f32_16x16x32_bf16 v[112:115], v[204:207], a[48:51], v[112:115]
    v_mfma_f32_16x16x32_bf16 v[116:119], v[204:207], a[52:55], v[116:119]
    ds_read_b64_tr_b16 v[252:253], v20 offset:9344
    ds_read_b64_tr_b16 v[254:255], v20 offset:13952
    v_mfma_f32_16x16x32_bf16 v[120:123], v[204:207], a[176:179], v[120:123]
    buffer_load_dwordx4 a[132:135], v2, s[16:19], s42 offen offset:0 sc1
    v_mfma_f32_16x16x32_bf16 v[124:127], v[204:207], a[180:183], v[124:127]
    v_mfma_f32_16x16x32_bf16 v[128:131], v[208:211], a[48:51], v[128:131]
    v_mfma_f32_16x16x32_bf16 v[132:135], v[208:211], a[52:55], v[132:135]
    v_mfma_f32_16x16x32_bf16 v[136:139], v[208:211], a[176:179], v[136:139]
    buffer_load_dwordx4 a[0:3], v16, s[16:19], s41 offen offset:0 sc1
    v_mfma_f32_16x16x32_bf16 v[140:143], v[208:211], a[180:183], v[140:143]
    v_mfma_f32_16x16x32_bf16 v[144:147], v[212:215], a[48:51], v[144:147]
    v_mfma_f32_16x16x32_bf16 v[148:151], v[212:215], a[52:55], v[148:151]
    v_mfma_f32_16x16x32_bf16 v[152:155], v[212:215], a[176:179], v[152:155]
    buffer_load_dwordx4 a[4:7], v2, s[16:19], s41 offen offset:0 sc1
    v_mfma_f32_16x16x32_bf16 v[156:159], v[212:215], a[180:183], v[156:159]
    v_mfma_f32_16x16x32_bf16 v[160:163], v[216:219], a[48:51], v[160:163]
    v_mfma_f32_16x16x32_bf16 v[164:167], v[216:219], a[52:55], v[164:167]
    s_add_u32 m0, s59, 117760
    v_mfma_f32_16x16x32_bf16 v[168:171], v[216:219], a[176:179], v[168:171]
    buffer_load_dwordx4 v0, s[8:11], s40 offen offset:0 lds
    v_mfma_f32_16x16x32_bf16 v[172:175], v[216:219], a[180:183], v[172:175]
    v_mfma_f32_16x16x32_bf16 v[176:179], v[220:223], a[48:51], v[176:179]
    v_mfma_f32_16x16x32_bf16 v[180:183], v[220:223], a[52:55], v[180:183]
    v_mfma_f32_16x16x32_bf16 v[184:187], v[220:223], a[176:179], v[184:187]
    buffer_load_dwordx4 v1, s[8:11], s40 offen offset:1152 lds
    v_mfma_f32_16x16x32_bf16 v[188:191], v[220:223], a[180:183], v[188:191]
    s_waitcnt vmcnt(51) lgkmcnt(0)
    s_barrier
    v_mfma_f32_16x16x32_bf16 v[64:67], v[224:227], a[56:59], v[64:67]
    v_mfma_f32_16x16x32_bf16 v[68:71], v[224:227], a[60:63], v[68:71]
    v_mfma_f32_16x16x32_bf16 v[72:75], v[224:227], a[184:187], v[72:75]
    ds_read_b64_tr_b16 v[192:193], v17 offset:18432
    ds_read_b64_tr_b16 v[194:195], v17 offset:23040
    v_mfma_f32_16x16x32_bf16 v[76:79], v[224:227], a[188:191], v[76:79]
    s_add_u32 s40, s40, 65536
    ds_read_b64_tr_b16 v[196:197], v18 offset:18432
    ds_read_b64_tr_b16 v[198:199], v18 offset:23040
    v_mfma_f32_16x16x32_bf16 v[80:83], v[228:231], a[56:59], v[80:83]
    buffer_load_dwordx4 a[136:139], v16, s[16:19], s42 offen offset:1024 sc1
    v_mfma_f32_16x16x32_bf16 v[84:87], v[228:231], a[60:63], v[84:87]
    ds_read_b64_tr_b16 v[200:201], v19 offset:18432
    ds_read_b64_tr_b16 v[202:203], v19 offset:23040
    v_mfma_f32_16x16x32_bf16 v[88:91], v[228:231], a[184:187], v[88:91]
    ds_read_b64_tr_b16 v[204:205], v20 offset:18432
    ds_read_b64_tr_b16 v[206:207], v20 offset:23040
    v_mfma_f32_16x16x32_bf16 v[92:95], v[228:231], a[188:191], v[92:95]
    v_mfma_f32_16x16x32_bf16 v[96:99], v[232:235], a[56:59], v[96:99]
    ds_read_b64_tr_b16 v[208:209], v17 offset:18560
    ds_read_b64_tr_b16 v[210:211], v17 offset:23168
    v_mfma_f32_16x16x32_bf16 v[100:103], v[232:235], a[60:63], v[100:103]
    buffer_load_dwordx4 a[140:143], v2, s[16:19], s42 offen offset:1024 sc1
    v_mfma_f32_16x16x32_bf16 v[104:107], v[232:235], a[184:187], v[104:107]
    ds_read_b64_tr_b16 v[212:213], v18 offset:18560
    ds_read_b64_tr_b16 v[214:215], v18 offset:23168
    v_mfma_f32_16x16x32_bf16 v[108:111], v[232:235], a[188:191], v[108:111]
    ds_read_b64_tr_b16 v[216:217], v19 offset:18560
    ds_read_b64_tr_b16 v[218:219], v19 offset:23168
    v_mfma_f32_16x16x32_bf16 v[112:115], v[236:239], a[56:59], v[112:115]
    v_mfma_f32_16x16x32_bf16 v[116:119], v[236:239], a[60:63], v[116:119]
    ds_read_b64_tr_b16 v[220:221], v20 offset:18560
    ds_read_b64_tr_b16 v[222:223], v20 offset:23168
    v_mfma_f32_16x16x32_bf16 v[120:123], v[236:239], a[184:187], v[120:123]
    buffer_load_dwordx4 a[8:11], v16, s[16:19], s41 offen offset:1024 sc1
    v_mfma_f32_16x16x32_bf16 v[124:127], v[236:239], a[188:191], v[124:127]
    v_mfma_f32_16x16x32_bf16 v[128:131], v[240:243], a[56:59], v[128:131]
    v_mfma_f32_16x16x32_bf16 v[132:135], v[240:243], a[60:63], v[132:135]
    v_mfma_f32_16x16x32_bf16 v[136:139], v[240:243], a[184:187], v[136:139]
    buffer_load_dwordx4 a[12:15], v2, s[16:19], s41 offen offset:1024 sc1
    v_mfma_f32_16x16x32_bf16 v[140:143], v[240:243], a[188:191], v[140:143]
    v_mfma_f32_16x16x32_bf16 v[144:147], v[244:247], a[56:59], v[144:147]
    v_mfma_f32_16x16x32_bf16 v[148:151], v[244:247], a[60:63], v[148:151]
    s_add_u32 m0, s59, 126976
    v_mfma_f32_16x16x32_bf16 v[152:155], v[244:247], a[184:187], v[152:155]
    buffer_load_dwordx4 v0, s[8:11], s40 offen offset:0 lds
    v_mfma_f32_16x16x32_bf16 v[156:159], v[244:247], a[188:191], v[156:159]
    v_mfma_f32_16x16x32_bf16 v[160:163], v[248:251], a[56:59], v[160:163]
    v_mfma_f32_16x16x32_bf16 v[164:167], v[248:251], a[60:63], v[164:167]
    v_mfma_f32_16x16x32_bf16 v[168:171], v[248:251], a[184:187], v[168:171]
    buffer_load_dwordx4 v1, s[8:11], s40 offen offset:1152 lds
    v_mfma_f32_16x16x32_bf16 v[172:175], v[248:251], a[188:191], v[172:175]
    v_mfma_f32_16x16x32_bf16 v[176:179], v[252:255], a[56:59], v[176:179]
    v_mfma_f32_16x16x32_bf16 v[180:183], v[252:255], a[60:63], v[180:183]
    s_add_u32 s40, s40, 65536
    v_mfma_f32_16x16x32_bf16 v[184:187], v[252:255], a[184:187], v[184:187]
    buffer_load_dwordx4 a[144:147], v16, s[16:19], s42 offen offset:2048 sc1
    v_mfma_f32_16x16x32_bf16 v[188:191], v[252:255], a[188:191], v[188:191]
    s_waitcnt lgkmcnt(0)
    v_mfma_f32_16x16x32_bf16 v[64:67], v[192:195], a[64:67], v[64:67]
    v_mfma_f32_16x16x32_bf16 v[68:71], v[192:195], a[68:71], v[68:71]
    v_mfma_f32_16x16x32_bf16 v[72:75], v[192:195], a[192:195], v[72:75]
    ds_read_b64_tr_b16 v[224:225], v17 offset:27648
    ds_read_b64_tr_b16 v[226:227], v17 offset:32256
    v_mfma_f32_16x16x32_bf16 v[76:79], v[192:195], a[196:199], v[76:79]
    ds_read_b64_tr_b16 v[228:229], v18 offset:27648
    ds_read_b64_tr_b16 v[230:231], v18 offset:32256
    v_mfma_f32_16x16x32_bf16 v[80:83], v[196:199], a[64:67], v[80:83]
    buffer_load_dwordx4 a[148:151], v2, s[16:19], s42 offen offset:2048 sc1
    v_mfma_f32_16x16x32_bf16 v[84:87], v[196:199], a[68:71], v[84:87]
    ds_read_b64_tr_b16 v[232:233], v19 offset:27648
    ds_read_b64_tr_b16 v[234:235], v19 offset:32256
    v_mfma_f32_16x16x32_bf16 v[88:91], v[196:199], a[192:195], v[88:91]
    ds_read_b64_tr_b16 v[236:237], v20 offset:27648
    ds_read_b64_tr_b16 v[238:239], v20 offset:32256
    v_mfma_f32_16x16x32_bf16 v[92:95], v[196:199], a[196:199], v[92:95]
    v_mfma_f32_16x16x32_bf16 v[96:99], v[200:203], a[64:67], v[96:99]
    ds_read_b64_tr_b16 v[240:241], v17 offset:27776
    ds_read_b64_tr_b16 v[242:243], v17 offset:32384
    v_mfma_f32_16x16x32_bf16 v[100:103], v[200:203], a[68:71], v[100:103]
    buffer_load_dwordx4 a[16:19], v16, s[16:19], s41 offen offset:2048 sc1
    v_mfma_f32_16x16x32_bf16 v[104:107], v[200:203], a[192:195], v[104:107]
    ds_read_b64_tr_b16 v[244:245], v18 offset:27776
    ds_read_b64_tr_b16 v[246:247], v18 offset:32384
    v_mfma_f32_16x16x32_bf16 v[108:111], v[200:203], a[196:199], v[108:111]
    ds_read_b64_tr_b16 v[248:249], v19 offset:27776
    ds_read_b64_tr_b16 v[250:251], v19 offset:32384
    v_mfma_f32_16x16x32_bf16 v[112:115], v[204:207], a[64:67], v[112:115]
    v_mfma_f32_16x16x32_bf16 v[116:119], v[204:207], a[68:71], v[116:119]
    ds_read_b64_tr_b16 v[252:253], v20 offset:27776
    ds_read_b64_tr_b16 v[254:255], v20 offset:32384
    v_mfma_f32_16x16x32_bf16 v[120:123], v[204:207], a[192:195], v[120:123]
    buffer_load_dwordx4 a[20:23], v2, s[16:19], s41 offen offset:2048 sc1
    v_mfma_f32_16x16x32_bf16 v[124:127], v[204:207], a[196:199], v[124:127]
    v_mfma_f32_16x16x32_bf16 v[128:131], v[208:211], a[64:67], v[128:131]
    v_mfma_f32_16x16x32_bf16 v[132:135], v[208:211], a[68:71], v[132:135]
    s_add_u32 m0, s59, 136192
    v_mfma_f32_16x16x32_bf16 v[136:139], v[208:211], a[192:195], v[136:139]
    buffer_load_dwordx4 v0, s[8:11], s40 offen offset:0 lds
    v_mfma_f32_16x16x32_bf16 v[140:143], v[208:211], a[196:199], v[140:143]
    v_mfma_f32_16x16x32_bf16 v[144:147], v[212:215], a[64:67], v[144:147]
    v_mfma_f32_16x16x32_bf16 v[148:151], v[212:215], a[68:71], v[148:151]
    v_mfma_f32_16x16x32_bf16 v[152:155], v[212:215], a[192:195], v[152:155]
    buffer_load_dwordx4 v1, s[8:11], s40 offen offset:1152 lds
    v_mfma_f32_16x16x32_bf16 v[156:159], v[212:215], a[196:199], v[156:159]
    v_mfma_f32_16x16x32_bf16 v[160:163], v[216:219], a[64:67], v[160:163]
    v_mfma_f32_16x16x32_bf16 v[164:167], v[216:219], a[68:71], v[164:167]
    s_add_u32 s40, s40, 65536
    v_mfma_f32_16x16x32_bf16 v[168:171], v[216:219], a[192:195], v[168:171]
    buffer_load_dwordx4 a[152:155], v16, s[16:19], s42 offen offset:3072 sc1
    v_mfma_f32_16x16x32_bf16 v[172:175], v[216:219], a[196:199], v[172:175]
    v_mfma_f32_16x16x32_bf16 v[176:179], v[220:223], a[64:67], v[176:179]
    v_mfma_f32_16x16x32_bf16 v[180:183], v[220:223], a[68:71], v[180:183]
    v_mfma_f32_16x16x32_bf16 v[184:187], v[220:223], a[192:195], v[184:187]
    buffer_load_dwordx4 a[156:159], v2, s[16:19], s42 offen offset:3072 sc1
    v_mfma_f32_16x16x32_bf16 v[188:191], v[220:223], a[196:199], v[188:191]
    s_waitcnt vmcnt(53) lgkmcnt(0)
    s_barrier
    v_mfma_f32_16x16x32_bf16 v[64:67], v[224:227], a[72:75], v[64:67]
    v_mfma_f32_16x16x32_bf16 v[68:71], v[224:227], a[76:79], v[68:71]
    v_mfma_f32_16x16x32_bf16 v[72:75], v[224:227], a[200:203], v[72:75]
    ds_read_b64_tr_b16 v[192:193], v17 offset:36864
    ds_read_b64_tr_b16 v[194:195], v17 offset:41472
    v_mfma_f32_16x16x32_bf16 v[76:79], v[224:227], a[204:207], v[76:79]
    s_add_u32 s42, s42, 4096
    ds_read_b64_tr_b16 v[196:197], v18 offset:36864
    ds_read_b64_tr_b16 v[198:199], v18 offset:41472
    v_mfma_f32_16x16x32_bf16 v[80:83], v[228:231], a[72:75], v[80:83]
    buffer_load_dwordx4 a[24:27], v16, s[16:19], s41 offen offset:3072 sc1
    v_mfma_f32_16x16x32_bf16 v[84:87], v[228:231], a[76:79], v[84:87]
    ds_read_b64_tr_b16 v[200:201], v19 offset:36864
    ds_read_b64_tr_b16 v[202:203], v19 offset:41472
    v_mfma_f32_16x16x32_bf16 v[88:91], v[228:231], a[200:203], v[88:91]
    ds_read_b64_tr_b16 v[204:205], v20 offset:36864
    ds_read_b64_tr_b16 v[206:207], v20 offset:41472
    v_mfma_f32_16x16x32_bf16 v[92:95], v[228:231], a[204:207], v[92:95]
    v_mfma_f32_16x16x32_bf16 v[96:99], v[232:235], a[72:75], v[96:99]
    ds_read_b64_tr_b16 v[208:209], v17 offset:36992
    ds_read_b64_tr_b16 v[210:211], v17 offset:41600
    v_mfma_f32_16x16x32_bf16 v[100:103], v[232:235], a[76:79], v[100:103]
    buffer_load_dwordx4 a[28:31], v2, s[16:19], s41 offen offset:3072 sc1
    v_mfma_f32_16x16x32_bf16 v[104:107], v[232:235], a[200:203], v[104:107]
    ds_read_b64_tr_b16 v[212:213], v18 offset:36992
    ds_read_b64_tr_b16 v[214:215], v18 offset:41600
    v_mfma_f32_16x16x32_bf16 v[108:111], v[232:235], a[204:207], v[108:111]
    ds_read_b64_tr_b16 v[216:217], v19 offset:36992
    ds_read_b64_tr_b16 v[218:219], v19 offset:41600
    v_mfma_f32_16x16x32_bf16 v[112:115], v[236:239], a[72:75], v[112:115]
    v_mfma_f32_16x16x32_bf16 v[116:119], v[236:239], a[76:79], v[116:119]
    s_add_u32 s41, s41, 4096
    s_add_u32 m0, s59, 145408
    ds_read_b64_tr_b16 v[220:221], v20 offset:36992
    ds_read_b64_tr_b16 v[222:223], v20 offset:41600
    v_mfma_f32_16x16x32_bf16 v[120:123], v[236:239], a[200:203], v[120:123]
    buffer_load_dwordx4 v0, s[8:11], s40 offen offset:0 lds
    v_mfma_f32_16x16x32_bf16 v[124:127], v[236:239], a[204:207], v[124:127]
    v_mfma_f32_16x16x32_bf16 v[128:131], v[240:243], a[72:75], v[128:131]
    v_mfma_f32_16x16x32_bf16 v[132:135], v[240:243], a[76:79], v[132:135]
    v_mfma_f32_16x16x32_bf16 v[136:139], v[240:243], a[200:203], v[136:139]
    buffer_load_dwordx4 v1, s[8:11], s40 offen offset:1152 lds
    v_mfma_f32_16x16x32_bf16 v[140:143], v[240:243], a[204:207], v[140:143]
    v_mfma_f32_16x16x32_bf16 v[144:147], v[244:247], a[72:75], v[144:147]
    v_mfma_f32_16x16x32_bf16 v[148:151], v[244:247], a[76:79], v[148:151]
    s_add_u32 s40, s40, 65536
    v_mfma_f32_16x16x32_bf16 v[152:155], v[244:247], a[200:203], v[152:155]
    buffer_load_dwordx4 a[160:163], v16, s[16:19], s42 offen offset:0 sc1
    v_mfma_f32_16x16x32_bf16 v[156:159], v[244:247], a[204:207], v[156:159]
    v_mfma_f32_16x16x32_bf16 v[160:163], v[248:251], a[72:75], v[160:163]
    v_mfma_f32_16x16x32_bf16 v[164:167], v[248:251], a[76:79], v[164:167]
    v_mfma_f32_16x16x32_bf16 v[168:171], v[248:251], a[200:203], v[168:171]
    buffer_load_dwordx4 a[164:167], v2, s[16:19], s42 offen offset:0 sc1
    v_mfma_f32_16x16x32_bf16 v[172:175], v[248:251], a[204:207], v[172:175]
    v_mfma_f32_16x16x32_bf16 v[176:179], v[252:255], a[72:75], v[176:179]
    v_mfma_f32_16x16x32_bf16 v[180:183], v[252:255], a[76:79], v[180:183]
    v_mfma_f32_16x16x32_bf16 v[184:187], v[252:255], a[200:203], v[184:187]
    buffer_load_dwordx4 a[32:35], v16, s[16:19], s41 offen offset:0 sc1
    v_mfma_f32_16x16x32_bf16 v[188:191], v[252:255], a[204:207], v[188:191]
    s_waitcnt lgkmcnt(0)
    v_mfma_f32_16x16x32_bf16 v[64:67], v[192:195], a[80:83], v[64:67]
    v_mfma_f32_16x16x32_bf16 v[68:71], v[192:195], a[84:87], v[68:71]
    v_mfma_f32_16x16x32_bf16 v[72:75], v[192:195], a[208:211], v[72:75]
    ds_read_b64_tr_b16 v[224:225], v17 offset:46080
    ds_read_b64_tr_b16 v[226:227], v17 offset:50688
    v_mfma_f32_16x16x32_bf16 v[76:79], v[192:195], a[212:215], v[76:79]
    ds_read_b64_tr_b16 v[228:229], v18 offset:46080
    ds_read_b64_tr_b16 v[230:231], v18 offset:50688
    v_mfma_f32_16x16x32_bf16 v[80:83], v[196:199], a[80:83], v[80:83]
    buffer_load_dwordx4 a[36:39], v2, s[16:19], s41 offen offset:0 sc1
    v_mfma_f32_16x16x32_bf16 v[84:87], v[196:199], a[84:87], v[84:87]
    ds_read_b64_tr_b16 v[232:233], v19 offset:46080
    ds_read_b64_tr_b16 v[234:235], v19 offset:50688
    v_mfma_f32_16x16x32_bf16 v[88:91], v[196:199], a[208:211], v[88:91]
    ds_read_b64_tr_b16 v[236:237], v20 offset:46080
    ds_read_b64_tr_b16 v[238:239], v20 offset:50688
    v_mfma_f32_16x16x32_bf16 v[92:95], v[196:199], a[212:215], v[92:95]
    v_mfma_f32_16x16x32_bf16 v[96:99], v[200:203], a[80:83], v[96:99]
    s_add_u32 m0, s59, 154624
    ds_read_b64_tr_b16 v[240:241], v17 offset:46208
    ds_read_b64_tr_b16 v[242:243], v17 offset:50816
    v_mfma_f32_16x16x32_bf16 v[100:103], v[200:203], a[84:87], v[100:103]
gated_mix__ssm_conv_h3__compressed_kv_cla__prompt_kernel_pad13:
    s_cbranch_execz gated_mix__ssm_conv_h3__compressed_kv_cla__prompt_kernel_pad17
    buffer_load_dwordx4 v0, s[8:11], s40 offen offset:0 lds
    v_mfma_f32_16x16x32_bf16 v[104:107], v[200:203], a[208:211], v[104:107]
    ds_read_b64_tr_b16 v[244:245], v18 offset:46208
    ds_read_b64_tr_b16 v[246:247], v18 offset:50816
    v_mfma_f32_16x16x32_bf16 v[108:111], v[200:203], a[212:215], v[108:111]
    ds_read_b64_tr_b16 v[248:249], v19 offset:46208
    ds_read_b64_tr_b16 v[250:251], v19 offset:50816
    v_mfma_f32_16x16x32_bf16 v[112:115], v[204:207], a[80:83], v[112:115]
    v_add_u32 v13, s53, v13
    v_lshrrev_b32 v15, 4, v16
    v_mfma_f32_16x16x32_bf16 v[116:119], v[204:207], a[84:87], v[116:119]
    ds_read_b64_tr_b16 v[252:253], v20 offset:46208
    ds_read_b64_tr_b16 v[254:255], v20 offset:50816
    v_mfma_f32_16x16x32_bf16 v[120:123], v[204:207], a[208:211], v[120:123]
    buffer_load_dwordx4 v1, s[8:11], s40 offen offset:1152 lds
    v_mfma_f32_16x16x32_bf16 v[124:127], v[204:207], a[212:215], v[124:127]
    v_and_b32 v15, 48, v15
    v_cmp_gt_u32 vcc, 256, v16
    v_mfma_f32_16x16x32_bf16 v[128:131], v[208:211], a[80:83], v[128:131]
    v_xor_b32 v15, s57, v15
    v_mfma_f32_16x16x32_bf16 v[132:135], v[208:211], a[84:87], v[132:135]
    s_add_u32 s40, s40, 65536
    v_cndmask_b32 v13, v15, v13, vcc
    v_mfma_f32_16x16x32_bf16 v[136:139], v[208:211], a[208:211], v[136:139]
    buffer_load_dwordx4 a[168:171], v16, s[16:19], s42 offen offset:1024 sc1
    v_mfma_f32_16x16x32_bf16 v[140:143], v[208:211], a[212:215], v[140:143]
    v_mfma_f32_16x16x32_bf16 v[144:147], v[212:215], a[80:83], v[144:147]
    v_mfma_f32_16x16x32_bf16 v[148:151], v[212:215], a[84:87], v[148:151]
    v_mfma_f32_16x16x32_bf16 v[152:155], v[212:215], a[208:211], v[152:155]
    buffer_load_dwordx4 a[172:175], v2, s[16:19], s42 offen offset:1024 sc1
    v_mfma_f32_16x16x32_bf16 v[156:159], v[212:215], a[212:215], v[156:159]
    v_mfma_f32_16x16x32_bf16 v[160:163], v[216:219], a[80:83], v[160:163]
    v_mfma_f32_16x16x32_bf16 v[164:167], v[216:219], a[84:87], v[164:167]
    v_mfma_f32_16x16x32_bf16 v[168:171], v[216:219], a[208:211], v[168:171]
    buffer_load_dwordx4 a[40:43], v16, s[16:19], s41 offen offset:1024 sc1
    v_mfma_f32_16x16x32_bf16 v[172:175], v[216:219], a[212:215], v[172:175]
    v_mfma_f32_16x16x32_bf16 v[176:179], v[220:223], a[80:83], v[176:179]
    v_mfma_f32_16x16x32_bf16 v[180:183], v[220:223], a[84:87], v[180:183]
    v_mfma_f32_16x16x32_bf16 v[184:187], v[220:223], a[208:211], v[184:187]
    buffer_load_dwordx4 a[44:47], v2, s[16:19], s41 offen offset:1024 sc1
    v_mfma_f32_16x16x32_bf16 v[188:191], v[220:223], a[212:215], v[188:191]
    s_waitcnt vmcnt(53) lgkmcnt(0)
    s_barrier
    v_mfma_f32_16x16x32_bf16 v[64:67], v[224:227], a[88:91], v[64:67]
    v_mfma_f32_16x16x32_bf16 v[68:71], v[224:227], a[92:95], v[68:71]
    v_mfma_f32_16x16x32_bf16 v[72:75], v[224:227], a[216:219], v[72:75]
    ds_read_b64_tr_b16 v[192:193], v17 offset:55296
    ds_read_b64_tr_b16 v[194:195], v17 offset:59904
    v_mfma_f32_16x16x32_bf16 v[76:79], v[224:227], a[220:223], v[76:79]
    ds_read_b64_tr_b16 v[196:197], v18 offset:55296
    ds_read_b64_tr_b16 v[198:199], v18 offset:59904
    v_mfma_f32_16x16x32_bf16 v[80:83], v[228:231], a[88:91], v[80:83]
    buffer_load_dword v14, v13, s[28:31], 0 offen sc1
    v_mfma_f32_16x16x32_bf16 v[84:87], v[228:231], a[92:95], v[84:87]
    ds_read_b64_tr_b16 v[200:201], v19 offset:55296
    ds_read_b64_tr_b16 v[202:203], v19 offset:59904
    v_mfma_f32_16x16x32_bf16 v[88:91], v[228:231], a[216:219], v[88:91]
    ds_read_b64_tr_b16 v[204:205], v20 offset:55296
    ds_read_b64_tr_b16 v[206:207], v20 offset:59904
    v_mfma_f32_16x16x32_bf16 v[92:95], v[228:231], a[220:223], v[92:95]
    v_mfma_f32_16x16x32_bf16 v[96:99], v[232:235], a[88:91], v[96:99]
    s_add_u32 m0, s59, 16384
    ds_read_b64_tr_b16 v[208:209], v17 offset:55424
    ds_read_b64_tr_b16 v[210:211], v17 offset:60032
    v_mfma_f32_16x16x32_bf16 v[100:103], v[232:235], a[92:95], v[100:103]
    buffer_load_dwordx4 v0, s[8:11], s40 offen offset:0 lds
    v_mfma_f32_16x16x32_bf16 v[104:107], v[232:235], a[216:219], v[104:107]
    ds_read_b64_tr_b16 v[212:213], v18 offset:55424
    ds_read_b64_tr_b16 v[214:215], v18 offset:60032
    v_mfma_f32_16x16x32_bf16 v[108:111], v[232:235], a[220:223], v[108:111]
    ds_read_b64_tr_b16 v[216:217], v19 offset:55424
    ds_read_b64_tr_b16 v[218:219], v19 offset:60032
    v_mfma_f32_16x16x32_bf16 v[112:115], v[236:239], a[88:91], v[112:115]
    v_mfma_f32_16x16x32_bf16 v[116:119], v[236:239], a[92:95], v[116:119]
    ds_read_b64_tr_b16 v[220:221], v20 offset:55424
    ds_read_b64_tr_b16 v[222:223], v20 offset:60032
    v_mfma_f32_16x16x32_bf16 v[120:123], v[236:239], a[216:219], v[120:123]
    buffer_load_dwordx4 v1, s[8:11], s40 offen offset:1152 lds
    v_mfma_f32_16x16x32_bf16 v[124:127], v[236:239], a[220:223], v[124:127]
    v_mfma_f32_16x16x32_bf16 v[128:131], v[240:243], a[88:91], v[128:131]
    v_mfma_f32_16x16x32_bf16 v[132:135], v[240:243], a[92:95], v[132:135]
    s_add_u32 s40, s40, 65536
    v_mfma_f32_16x16x32_bf16 v[136:139], v[240:243], a[216:219], v[136:139]
    buffer_load_dwordx4 a[176:179], v16, s[16:19], s42 offen offset:2048 sc1
    v_mfma_f32_16x16x32_bf16 v[140:143], v[240:243], a[220:223], v[140:143]
    v_mfma_f32_16x16x32_bf16 v[144:147], v[244:247], a[88:91], v[144:147]
    v_mfma_f32_16x16x32_bf16 v[148:151], v[244:247], a[92:95], v[148:151]
    v_mfma_f32_16x16x32_bf16 v[152:155], v[244:247], a[216:219], v[152:155]
    buffer_load_dwordx4 a[180:183], v2, s[16:19], s42 offen offset:2048 sc1
    v_mfma_f32_16x16x32_bf16 v[156:159], v[244:247], a[220:223], v[156:159]
    v_mfma_f32_16x16x32_bf16 v[160:163], v[248:251], a[88:91], v[160:163]
    v_mfma_f32_16x16x32_bf16 v[164:167], v[248:251], a[92:95], v[164:167]
    v_mfma_f32_16x16x32_bf16 v[168:171], v[248:251], a[216:219], v[168:171]
    buffer_load_dwordx4 a[48:51], v16, s[16:19], s41 offen offset:2048 sc1
    v_mfma_f32_16x16x32_bf16 v[172:175], v[248:251], a[220:223], v[172:175]
    v_mfma_f32_16x16x32_bf16 v[176:179], v[252:255], a[88:91], v[176:179]
    v_mfma_f32_16x16x32_bf16 v[180:183], v[252:255], a[92:95], v[180:183]
    v_mfma_f32_16x16x32_bf16 v[184:187], v[252:255], a[216:219], v[184:187]
    buffer_load_dwordx4 a[52:55], v2, s[16:19], s41 offen offset:2048 sc1
    v_mfma_f32_16x16x32_bf16 v[188:191], v[252:255], a[220:223], v[188:191]
    s_waitcnt lgkmcnt(0)
    v_mfma_f32_16x16x32_bf16 v[64:67], v[192:195], a[96:99], v[64:67]
    v_add_u32 v17, 64512, v17
    v_add_u32 v18, 64512, v18
    v_mfma_f32_16x16x32_bf16 v[68:71], v[192:195], a[100:103], v[68:71]
    v_add_u32 v19, 64512, v19
    v_add_u32 v20, 64512, v20
    v_mfma_f32_16x16x32_bf16 v[72:75], v[192:195], a[224:227], v[72:75]
    ds_read_b64_tr_b16 v[224:225], v17 offset:0
    ds_read_b64_tr_b16 v[226:227], v17 offset:4608
    v_mfma_f32_16x16x32_bf16 v[76:79], v[192:195], a[228:231], v[76:79]
    s_add_u32 m0, s59, 25600
    ds_read_b64_tr_b16 v[228:229], v18 offset:0
    ds_read_b64_tr_b16 v[230:231], v18 offset:4608
    v_mfma_f32_16x16x32_bf16 v[80:83], v[196:199], a[96:99], v[80:83]
    buffer_load_dwordx4 v0, s[8:11], s40 offen offset:0 lds
    v_mfma_f32_16x16x32_bf16 v[84:87], v[196:199], a[100:103], v[84:87]
    ds_read_b64_tr_b16 v[232:233], v19 offset:0
    ds_read_b64_tr_b16 v[234:235], v19 offset:4608
    v_mfma_f32_16x16x32_bf16 v[88:91], v[196:199], a[224:227], v[88:91]
    ds_read_b64_tr_b16 v[236:237], v20 offset:0
    ds_read_b64_tr_b16 v[238:239], v20 offset:4608
    v_mfma_f32_16x16x32_bf16 v[92:95], v[196:199], a[228:231], v[92:95]
    v_mfma_f32_16x16x32_bf16 v[96:99], v[200:203], a[96:99], v[96:99]
    ds_read_b64_tr_b16 v[240:241], v17 offset:128
    ds_read_b64_tr_b16 v[242:243], v17 offset:4736
    v_mfma_f32_16x16x32_bf16 v[100:103], v[200:203], a[100:103], v[100:103]
    buffer_load_dwordx4 v1, s[8:11], s40 offen offset:1152 lds
    v_mfma_f32_16x16x32_bf16 v[104:107], v[200:203], a[224:227], v[104:107]
    ds_read_b64_tr_b16 v[244:245], v18 offset:128
    ds_read_b64_tr_b16 v[246:247], v18 offset:4736
    v_mfma_f32_16x16x32_bf16 v[108:111], v[200:203], a[228:231], v[108:111]
    ds_read_b64_tr_b16 v[248:249], v19 offset:128
    ds_read_b64_tr_b16 v[250:251], v19 offset:4736
    v_mfma_f32_16x16x32_bf16 v[112:115], v[204:207], a[96:99], v[112:115]
    v_mfma_f32_16x16x32_bf16 v[116:119], v[204:207], a[100:103], v[116:119]
    s_add_u32 s40, s40, 65536
    ds_read_b64_tr_b16 v[252:253], v20 offset:128
    ds_read_b64_tr_b16 v[254:255], v20 offset:4736
    v_mfma_f32_16x16x32_bf16 v[120:123], v[204:207], a[224:227], v[120:123]
    buffer_load_dwordx4 a[184:187], v16, s[16:19], s42 offen offset:3072 sc1
    v_mfma_f32_16x16x32_bf16 v[124:127], v[204:207], a[228:231], v[124:127]
    v_mfma_f32_16x16x32_bf16 v[128:131], v[208:211], a[96:99], v[128:131]
    v_mfma_f32_16x16x32_bf16 v[132:135], v[208:211], a[100:103], v[132:135]
    v_mfma_f32_16x16x32_bf16 v[136:139], v[208:211], a[224:227], v[136:139]
    buffer_load_dwordx4 a[188:191], v2, s[16:19], s42 offen offset:3072 sc1
    v_mfma_f32_16x16x32_bf16 v[140:143], v[208:211], a[228:231], v[140:143]
    v_mfma_f32_16x16x32_bf16 v[144:147], v[212:215], a[96:99], v[144:147]
    v_mfma_f32_16x16x32_bf16 v[148:151], v[212:215], a[100:103], v[148:151]
    s_add_u32 s42, s42, 4096
    v_mfma_f32_16x16x32_bf16 v[152:155], v[212:215], a[224:227], v[152:155]
    buffer_load_dwordx4 a[56:59], v16, s[16:19], s41 offen offset:3072 sc1
    v_mfma_f32_16x16x32_bf16 v[156:159], v[212:215], a[228:231], v[156:159]
    v_mfma_f32_16x16x32_bf16 v[160:163], v[216:219], a[96:99], v[160:163]
    v_mfma_f32_16x16x32_bf16 v[164:167], v[216:219], a[100:103], v[164:167]
    v_mfma_f32_16x16x32_bf16 v[168:171], v[216:219], a[224:227], v[168:171]
    buffer_load_dwordx4 a[60:63], v2, s[16:19], s41 offen offset:3072 sc1
    v_mfma_f32_16x16x32_bf16 v[172:175], v[216:219], a[228:231], v[172:175]
    v_mfma_f32_16x16x32_bf16 v[176:179], v[220:223], a[96:99], v[176:179]
    v_mfma_f32_16x16x32_bf16 v[180:183], v[220:223], a[100:103], v[180:183]
    s_add_u32 s41, s41, 4096
    s_add_u32 m0, s59, 34816
    v_mfma_f32_16x16x32_bf16 v[184:187], v[220:223], a[224:227], v[184:187]
    buffer_load_dwordx4 v0, s[8:11], s40 offen offset:0 lds
    v_mfma_f32_16x16x32_bf16 v[188:191], v[220:223], a[228:231], v[188:191]
    buffer_load_dwordx4 v1, s[8:11], s40 offen offset:1152 lds
    s_waitcnt vmcnt(55) lgkmcnt(0)
    s_barrier
    v_mfma_f32_16x16x32_bf16 v[64:67], v[224:227], a[104:107], v[64:67]
    v_mfma_f32_16x16x32_bf16 v[68:71], v[224:227], a[108:111], v[68:71]
    v_mfma_f32_16x16x32_bf16 v[72:75], v[224:227], a[232:235], v[72:75]
    ds_read_b64_tr_b16 v[192:193], v17 offset:9216
    ds_read_b64_tr_b16 v[194:195], v17 offset:13824
    v_mfma_f32_16x16x32_bf16 v[76:79], v[224:227], a[236:239], v[76:79]
    s_add_u32 s40, s40, 65536
    ds_read_b64_tr_b16 v[196:197], v18 offset:9216
    ds_read_b64_tr_b16 v[198:199], v18 offset:13824
    v_mfma_f32_16x16x32_bf16 v[80:83], v[228:231], a[104:107], v[80:83]
    buffer_load_dwordx4 a[192:195], v16, s[16:19], s42 offen offset:0 sc1
    v_mfma_f32_16x16x32_bf16 v[84:87], v[228:231], a[108:111], v[84:87]
    ds_read_b64_tr_b16 v[200:201], v19 offset:9216
    ds_read_b64_tr_b16 v[202:203], v19 offset:13824
    v_mfma_f32_16x16x32_bf16 v[88:91], v[228:231], a[232:235], v[88:91]
    ds_read_b64_tr_b16 v[204:205], v20 offset:9216
    ds_read_b64_tr_b16 v[206:207], v20 offset:13824
    v_mfma_f32_16x16x32_bf16 v[92:95], v[228:231], a[236:239], v[92:95]
    v_mfma_f32_16x16x32_bf16 v[96:99], v[232:235], a[104:107], v[96:99]
    ds_read_b64_tr_b16 v[208:209], v17 offset:9344
    ds_read_b64_tr_b16 v[210:211], v17 offset:13952
    v_mfma_f32_16x16x32_bf16 v[100:103], v[232:235], a[108:111], v[100:103]
    buffer_load_dwordx4 a[196:199], v2, s[16:19], s42 offen offset:0 sc1
    v_mfma_f32_16x16x32_bf16 v[104:107], v[232:235], a[232:235], v[104:107]
    ds_read_b64_tr_b16 v[212:213], v18 offset:9344
    ds_read_b64_tr_b16 v[214:215], v18 offset:13952
    v_mfma_f32_16x16x32_bf16 v[108:111], v[232:235], a[236:239], v[108:111]
    ds_read_b64_tr_b16 v[216:217], v19 offset:9344
    ds_read_b64_tr_b16 v[218:219], v19 offset:13952
    v_mfma_f32_16x16x32_bf16 v[112:115], v[236:239], a[104:107], v[112:115]
    s_waitcnt vmcnt(16)
    v_cmp_ne_u32 vcc, 1, v14
    s_nop 0
    v_mfma_f32_16x16x32_bf16 v[116:119], v[236:239], a[108:111], v[116:119]
    ds_read_b64_tr_b16 v[220:221], v20 offset:9344
    ds_read_b64_tr_b16 v[222:223], v20 offset:13952
    v_mfma_f32_16x16x32_bf16 v[120:123], v[236:239], a[232:235], v[120:123]
    buffer_load_dwordx4 a[64:67], v16, s[16:19], s41 offen offset:0 sc1
    v_mfma_f32_16x16x32_bf16 v[124:127], v[236:239], a[236:239], v[124:127]
    s_cbranch_vccnz gated_mix__ssm_conv_h3__compressed_kv_cla__prompt_kernel_spin_y
gated_mix__ssm_conv_h3__compressed_kv_cla__prompt_kernel_spin_y_ret:
    v_mfma_f32_16x16x32_bf16 v[128:131], v[240:243], a[104:107], v[128:131]
    s_lshl_b32 s53, s32, 12
    v_mfma_f32_16x16x32_bf16 v[132:135], v[240:243], a[108:111], v[132:135]
    v_mfma_f32_16x16x32_bf16 v[136:139], v[240:243], a[232:235], v[136:139]
    buffer_load_dwordx4 a[68:71], v2, s[16:19], s41 offen offset:0 sc1
    v_mfma_f32_16x16x32_bf16 v[140:143], v[240:243], a[236:239], v[140:143]
    v_mfma_f32_16x16x32_bf16 v[144:147], v[244:247], a[104:107], v[144:147]
    v_mfma_f32_16x16x32_bf16 v[148:151], v[244:247], a[108:111], v[148:151]
    s_add_u32 m0, s59, 44032
    v_mfma_f32_16x16x32_bf16 v[152:155], v[244:247], a[232:235], v[152:155]
    buffer_load_dwordx4 v0, s[8:11], s40 offen offset:0 lds
    v_mfma_f32_16x16x32_bf16 v[156:159], v[244:247], a[236:239], v[156:159]
    v_mfma_f32_16x16x32_bf16 v[160:163], v[248:251], a[104:107], v[160:163]
    v_mfma_f32_16x16x32_bf16 v[164:167], v[248:251], a[108:111], v[164:167]
    v_mfma_f32_16x16x32_bf16 v[168:171], v[248:251], a[232:235], v[168:171]
    buffer_load_dwordx4 v1, s[8:11], s40 offen offset:1152 lds
    v_mfma_f32_16x16x32_bf16 v[172:175], v[248:251], a[236:239], v[172:175]
    v_mfma_f32_16x16x32_bf16 v[176:179], v[252:255], a[104:107], v[176:179]
    v_mfma_f32_16x16x32_bf16 v[180:183], v[252:255], a[108:111], v[180:183]
    s_add_u32 s40, s40, 65536
    v_mfma_f32_16x16x32_bf16 v[184:187], v[252:255], a[232:235], v[184:187]
    buffer_load_dwordx4 a[200:203], v16, s[16:19], s42 offen offset:1024 sc1
    v_mfma_f32_16x16x32_bf16 v[188:191], v[252:255], a[236:239], v[188:191]
    s_waitcnt lgkmcnt(0)
    v_mfma_f32_16x16x32_bf16 v[64:67], v[192:195], a[112:115], v[64:67]
    v_mfma_f32_16x16x32_bf16 v[68:71], v[192:195], a[116:119], v[68:71]
    v_mfma_f32_16x16x32_bf16 v[72:75], v[192:195], a[240:243], v[72:75]
    ds_read_b64_tr_b16 v[224:225], v17 offset:18432
    ds_read_b64_tr_b16 v[226:227], v17 offset:23040
    v_mfma_f32_16x16x32_bf16 v[76:79], v[192:195], a[244:247], v[76:79]
    ds_read_b64_tr_b16 v[228:229], v18 offset:18432
    ds_read_b64_tr_b16 v[230:231], v18 offset:23040
    v_mfma_f32_16x16x32_bf16 v[80:83], v[196:199], a[112:115], v[80:83]
    buffer_load_dwordx4 a[204:207], v2, s[16:19], s42 offen offset:1024 sc1
    v_mfma_f32_16x16x32_bf16 v[84:87], v[196:199], a[116:119], v[84:87]
    ds_read_b64_tr_b16 v[232:233], v19 offset:18432
    ds_read_b64_tr_b16 v[234:235], v19 offset:23040
    v_mfma_f32_16x16x32_bf16 v[88:91], v[196:199], a[240:243], v[88:91]
    ds_read_b64_tr_b16 v[236:237], v20 offset:18432
    ds_read_b64_tr_b16 v[238:239], v20 offset:23040
    v_mfma_f32_16x16x32_bf16 v[92:95], v[196:199], a[244:247], v[92:95]
    v_mfma_f32_16x16x32_bf16 v[96:99], v[200:203], a[112:115], v[96:99]
    s_add_u32 m0, s53, 0
    s_add_u32 s36, s51, 0
    ds_read_b64_tr_b16 v[240:241], v17 offset:18560
    ds_read_b64_tr_b16 v[242:243], v17 offset:23168
    v_mfma_f32_16x16x32_bf16 v[100:103], v[200:203], a[116:119], v[100:103]
    buffer_load_dwordx4 v10, s[12:15], s36 offen sc1 lds
    v_mfma_f32_16x16x32_bf16 v[104:107], v[200:203], a[240:243], v[104:107]
    ds_read_b64_tr_b16 v[244:245], v18 offset:18560
    ds_read_b64_tr_b16 v[246:247], v18 offset:23168
    v_mfma_f32_16x16x32_bf16 v[108:111], v[200:203], a[244:247], v[108:111]
    ds_read_b64_tr_b16 v[248:249], v19 offset:18560
    ds_read_b64_tr_b16 v[250:251], v19 offset:23168
    v_mfma_f32_16x16x32_bf16 v[112:115], v[204:207], a[112:115], v[112:115]
    s_mov_b32 s37, 0xffff0000
    s_waitcnt vmcnt(62)
    v_permlane16_swap_b32 v24, v26
    v_mfma_f32_16x16x32_bf16 v[116:119], v[204:207], a[116:119], v[116:119]
    s_add_u32 m0, s53, 1024
    s_add_u32 s36, s51, 8192
    ds_read_b64_tr_b16 v[252:253], v20 offset:18560
    ds_read_b64_tr_b16 v[254:255], v20 offset:23168
    v_mfma_f32_16x16x32_bf16 v[120:123], v[204:207], a[240:243], v[120:123]
    buffer_load_dwordx4 v10, s[12:15], s36 offen sc1 lds
    v_mfma_f32_16x16x32_bf16 v[124:127], v[204:207], a[244:247], v[124:127]
    v_permlane16_swap_b32 v25, v27
    v_mfma_f32_16x16x32_bf16 v[128:131], v[208:211], a[112:115], v[128:131]
    v_permlane16_swap_b32 v28, v30
    v_mfma_f32_16x16x32_bf16 v[132:135], v[208:211], a[116:119], v[132:135]
    s_add_u32 m0, s53, 2048
    s_add_u32 s36, s51, 16384
    v_permlane16_swap_b32 v29, v31
    v_mfma_f32_16x16x32_bf16 v[136:139], v[208:211], a[240:243], v[136:139]
    buffer_load_dwordx4 v10, s[12:15], s36 offen sc1 lds
    v_mfma_f32_16x16x32_bf16 v[140:143], v[208:211], a[244:247], v[140:143]
    v_permlane16_swap_b32 v32, v34
    v_mfma_f32_16x16x32_bf16 v[144:147], v[212:215], a[112:115], v[144:147]
    v_permlane16_swap_b32 v33, v35
    v_mfma_f32_16x16x32_bf16 v[148:151], v[212:215], a[116:119], v[148:151]
    s_add_u32 m0, s53, 3072
    s_add_u32 s36, s51, 24576
    v_permlane16_swap_b32 v36, v38
    v_mfma_f32_16x16x32_bf16 v[152:155], v[212:215], a[240:243], v[152:155]
    buffer_load_dwordx4 v10, s[12:15], s36 offen sc1 lds
    v_mfma_f32_16x16x32_bf16 v[156:159], v[212:215], a[244:247], v[156:159]
    v_permlane16_swap_b32 v37, v39
    v_mfma_f32_16x16x32_bf16 v[160:163], v[216:219], a[112:115], v[160:163]
    v_mfma_f32_16x16x32_bf16 v[164:167], v[216:219], a[116:119], v[164:167]
    v_mfma_f32_16x16x32_bf16 v[168:171], v[216:219], a[240:243], v[168:171]
    buffer_load_dwordx4 a[72:75], v16, s[16:19], s41 offen offset:1024 sc1
    v_mfma_f32_16x16x32_bf16 v[172:175], v[216:219], a[244:247], v[172:175]
    v_mfma_f32_16x16x32_bf16 v[176:179], v[220:223], a[112:115], v[176:179]
    v_mfma_f32_16x16x32_bf16 v[180:183], v[220:223], a[116:119], v[180:183]
    v_mfma_f32_16x16x32_bf16 v[184:187], v[220:223], a[240:243], v[184:187]
    buffer_load_dwordx4 a[76:79], v2, s[16:19], s41 offen offset:1024 sc1
    v_mfma_f32_16x16x32_bf16 v[188:191], v[220:223], a[244:247], v[188:191]
    s_waitcnt vmcnt(57) lgkmcnt(0)
    s_barrier
    v_mfma_f32_16x16x32_bf16 v[64:67], v[224:227], a[120:123], v[64:67]
    v_mfma_f32_16x16x32_bf16 v[68:71], v[224:227], a[124:127], v[68:71]
    v_mfma_f32_16x16x32_bf16 v[72:75], v[224:227], a[248:251], v[72:75]
    ds_read_b64_tr_b16 v[192:193], v17 offset:27648
    ds_read_b64_tr_b16 v[194:195], v17 offset:32256
    v_mfma_f32_16x16x32_bf16 v[76:79], v[224:227], a[252:255], v[76:79]
    s_add_u32 m0, s59, 53248
    ds_read_b64_tr_b16 v[196:197], v18 offset:27648
    ds_read_b64_tr_b16 v[198:199], v18 offset:32256
    v_mfma_f32_16x16x32_bf16 v[80:83], v[228:231], a[120:123], v[80:83]
    buffer_load_dwordx4 v0, s[8:11], s40 offen offset:0 lds
    v_mfma_f32_16x16x32_bf16 v[84:87], v[228:231], a[124:127], v[84:87]
    ds_read_b64_tr_b16 v[200:201], v19 offset:27648
    ds_read_b64_tr_b16 v[202:203], v19 offset:32256
    v_mfma_f32_16x16x32_bf16 v[88:91], v[228:231], a[248:251], v[88:91]
    ds_read_b64_tr_b16 v[204:205], v20 offset:27648
    ds_read_b64_tr_b16 v[206:207], v20 offset:32256
    v_mfma_f32_16x16x32_bf16 v[92:95], v[228:231], a[252:255], v[92:95]
    v_mfma_f32_16x16x32_bf16 v[96:99], v[232:235], a[120:123], v[96:99]
    ds_read_b64_tr_b16 v[208:209], v17 offset:27776
    ds_read_b64_tr_b16 v[210:211], v17 offset:32384
    v_mfma_f32_16x16x32_bf16 v[100:103], v[232:235], a[124:127], v[100:103]
    buffer_load_dwordx4 v1, s[8:11], s40 offen offset:1152 lds
    v_mfma_f32_16x16x32_bf16 v[104:107], v[232:235], a[248:251], v[104:107]
    ds_read_b64_tr_b16 v[212:213], v18 offset:27776
    ds_read_b64_tr_b16 v[214:215], v18 offset:32384
    v_mfma_f32_16x16x32_bf16 v[108:111], v[232:235], a[252:255], v[108:111]
    ds_read_b64_tr_b16 v[216:217], v19 offset:27776
    ds_read_b64_tr_b16 v[218:219], v19 offset:32384
    v_mfma_f32_16x16x32_bf16 v[112:115], v[236:239], a[120:123], v[112:115]
    v_mfma_f32_16x16x32_bf16 v[116:119], v[236:239], a[124:127], v[116:119]
    s_add_u32 s40, s40, 65536
    ds_read_b64_tr_b16 v[220:221], v20 offset:27776
    ds_read_b64_tr_b16 v[222:223], v20 offset:32384
    v_mfma_f32_16x16x32_bf16 v[120:123], v[236:239], a[248:251], v[120:123]
    buffer_load_dwordx4 a[208:211], v16, s[16:19], s42 offen offset:2048 sc1
    v_mfma_f32_16x16x32_bf16 v[124:127], v[236:239], a[252:255], v[124:127]
    v_mfma_f32_16x16x32_bf16 v[128:131], v[240:243], a[120:123], v[128:131]
    v_mfma_f32_16x16x32_bf16 v[132:135], v[240:243], a[124:127], v[132:135]
    v_mfma_f32_16x16x32_bf16 v[136:139], v[240:243], a[248:251], v[136:139]
    buffer_load_dwordx4 a[212:215], v2, s[16:19], s42 offen offset:2048 sc1
    v_mfma_f32_16x16x32_bf16 v[140:143], v[240:243], a[252:255], v[140:143]
    v_mfma_f32_16x16x32_bf16 v[144:147], v[244:247], a[120:123], v[144:147]
    v_mfma_f32_16x16x32_bf16 v[148:151], v[244:247], a[124:127], v[148:151]
    v_mfma_f32_16x16x32_bf16 v[152:155], v[244:247], a[248:251], v[152:155]
    buffer_load_dwordx4 a[80:83], v16, s[16:19], s41 offen offset:2048 sc1
    v_mfma_f32_16x16x32_bf16 v[156:159], v[244:247], a[252:255], v[156:159]
    v_mfma_f32_16x16x32_bf16 v[160:163], v[248:251], a[120:123], v[160:163]
    v_mfma_f32_16x16x32_bf16 v[164:167], v[248:251], a[124:127], v[164:167]
    v_mfma_f32_16x16x32_bf16 v[168:171], v[248:251], a[248:251], v[168:171]
    buffer_load_dwordx4 a[84:87], v2, s[16:19], s41 offen offset:2048 sc1
    v_mfma_f32_16x16x32_bf16 v[172:175], v[248:251], a[252:255], v[172:175]
    v_mfma_f32_16x16x32_bf16 v[176:179], v[252:255], a[120:123], v[176:179]
    v_mfma_f32_16x16x32_bf16 v[180:183], v[252:255], a[124:127], v[180:183]
    s_add_u32 m0, s59, 62464
    v_mfma_f32_16x16x32_bf16 v[184:187], v[252:255], a[248:251], v[184:187]
    buffer_load_dwordx4 v0, s[8:11], s40 offen offset:0 lds
    v_mfma_f32_16x16x32_bf16 v[188:191], v[252:255], a[252:255], v[188:191]
    s_waitcnt lgkmcnt(0)
    v_mfma_f32_16x16x32_bf16 v[64:67], v[192:195], a[0:3], v[64:67]
    ds_read_b64_tr_b16 v[224:225], v17 offset:36864
    ds_read_b64_tr_b16 v[226:227], v17 offset:41472
    v_mfma_f32_16x16x32_bf16 v[68:71], v[192:195], a[4:7], v[68:71]
    buffer_load_dwordx4 v1, s[8:11], s40 offen offset:1152 lds
    v_mfma_f32_16x16x32_bf16 v[72:75], v[192:195], a[128:131], v[72:75]
    ds_read_b64_tr_b16 v[228:229], v18 offset:36864
    ds_read_b64_tr_b16 v[230:231], v18 offset:41472
    v_mfma_f32_16x16x32_bf16 v[76:79], v[192:195], a[132:135], v[76:79]
    v_mfma_f32_16x16x32_bf16 v[80:83], v[196:199], a[0:3], v[80:83]
    v_mfma_f32_16x16x32_bf16 v[84:87], v[196:199], a[4:7], v[84:87]
    s_add_u32 s40, s40, 65536
    buffer_load_dwordx4 a[216:219], v16, s[16:19], s42 offen offset:3072 sc1
    v_mfma_f32_16x16x32_bf16 v[88:91], v[196:199], a[128:131], v[88:91]
    v_mfma_f32_16x16x32_bf16 v[92:95], v[196:199], a[132:135], v[92:95]
    buffer_load_dwordx4 a[220:223], v2, s[16:19], s42 offen offset:3072 sc1
    s_waitcnt vmcnt(12) lgkmcnt(0)
    s_barrier
    v_mfma_f32_16x16x32_bf16 v[64:67], v[224:227], a[8:11], v[64:67]
    ds_read_b64_tr_b16 v[192:193], v17 offset:46080
    ds_read_b64_tr_b16 v[194:195], v17 offset:50688
    v_mfma_f32_16x16x32_bf16 v[68:71], v[224:227], a[12:15], v[68:71]
    s_add_u32 s42, s42, 4096
    buffer_load_dwordx4 a[88:91], v16, s[16:19], s41 offen offset:3072 sc1
    v_mfma_f32_16x16x32_bf16 v[72:75], v[224:227], a[136:139], v[72:75]
    ds_read_b64_tr_b16 v[196:197], v18 offset:46080
    ds_read_b64_tr_b16 v[198:199], v18 offset:50688
    v_mfma_f32_16x16x32_bf16 v[76:79], v[224:227], a[140:143], v[76:79]
    ds_read_b64_tr_b16 v[48:49], v22 offset:0
    ds_read_b64_tr_b16 v[50:51], v22 offset:128
    v_mfma_f32_16x16x32_bf16 v[80:83], v[228:231], a[8:11], v[80:83]
    ds_read_b64_tr_b16 v[52:53], v22 offset:256
    ds_read_b64_tr_b16 v[54:55], v22 offset:384
    v_mfma_f32_16x16x32_bf16 v[84:87], v[228:231], a[12:15], v[84:87]
    buffer_load_dwordx4 a[92:95], v2, s[16:19], s41 offen offset:3072 sc1
    v_mfma_f32_16x16x32_bf16 v[88:91], v[228:231], a[136:139], v[88:91]
    ds_read_b64_tr_b16 v[56:57], v22 offset:8192
    ds_read_b64_tr_b16 v[58:59], v22 offset:8320
    v_mfma_f32_16x16x32_bf16 v[92:95], v[228:231], a[140:143], v[92:95]
    s_waitcnt lgkmcnt(0)
    ds_read_b64_tr_b16 v[60:61], v22 offset:8448
    ds_read_b64_tr_b16 v[62:63], v22 offset:8576
    v_mfma_f32_16x16x32_bf16 v[64:67], v[192:195], a[16:19], v[64:67]
    ds_read_b64_tr_b16 v[224:225], v17 offset:55296
    ds_read_b64_tr_b16 v[226:227], v17 offset:59904
    v_mfma_f32_16x16x32_bf16 v[68:71], v[192:195], a[20:23], v[68:71]
    s_add_u32 s41, s41, 4096
    s_add_u32 m0, s59, 71680
    s_nop 0
    buffer_load_dwordx4 v0, s[8:11], s40 offen offset:0 lds
    v_mfma_f32_16x16x32_bf16 v[72:75], v[192:195], a[144:147], v[72:75]
    ds_read_b64_tr_b16 v[228:229], v18 offset:55296
    ds_read_b64_tr_b16 v[230:231], v18 offset:59904
    v_mfma_f32_16x16x32_bf16 v[76:79], v[192:195], a[148:151], v[76:79]
    v_mfma_f32_16x16x32_bf16 v[80:83], v[196:199], a[16:19], v[80:83]
    v_mfma_f32_16x16x32_bf16 v[84:87], v[196:199], a[20:23], v[84:87]
    buffer_load_dwordx4 v1, s[8:11], s40 offen offset:1152 lds
    v_mfma_f32_16x16x32_bf16 v[88:91], v[196:199], a[144:147], v[88:91]
    v_mfma_f32_16x16x32_bf16 v[92:95], v[196:199], a[148:151], v[92:95]
    s_waitcnt lgkmcnt(0)
    v_lshlrev_b32 v3, 16, v24
    v_lshlrev_b32 v4, 16, v48
    s_waitcnt vmcnt(47) lgkmcnt(0)
    s_barrier
    v_mfma_f32_16x16x32_bf16 v[64:67], v[224:227], a[24:27], v[64:67]
    v_add_u32 v17, 64512, v17
    v_add_u32 v18, 64512, v18
    v_mfma_f32_16x16x32_bf16 v[68:71], v[224:227], a[28:31], v[68:71]
    v_add_u32 v19, 64512, v19
    v_add_u32 v20, 64512, v20
    v_mfma_f32_16x16x32_bf16 v[72:75], v[224:227], a[152:155], v[72:75]
    ds_read_b64_tr_b16 v[192:193], v17 offset:0
    ds_read_b64_tr_b16 v[194:195], v17 offset:4608
    v_mfma_f32_16x16x32_bf16 v[76:79], v[224:227], a[156:159], v[76:79]
    ds_read_b64_tr_b16 v[196:197], v18 offset:0
    ds_read_b64_tr_b16 v[198:199], v18 offset:4608
    v_mfma_f32_16x16x32_bf16 v[80:83], v[228:231], a[24:27], v[80:83]
    s_add_u32 s40, s40, 65536
    buffer_load_dwordx4 a[224:227], v16, s[16:19], s42 offen offset:0 sc1
    v_mfma_f32_16x16x32_bf16 v[84:87], v[228:231], a[28:31], v[84:87]
    buffer_load_dwordx4 a[228:231], v2, s[16:19], s42 offen offset:0 sc1
    v_mfma_f32_16x16x32_bf16 v[88:91], v[228:231], a[152:155], v[88:91]
    v_mul_f32 v3, v3, v4
    v_mul_f32 v40, v6, v3
    v_mfma_f32_16x16x32_bf16 v[92:95], v[228:231], a[156:159], v[92:95]
    s_waitcnt lgkmcnt(0)
    v_and_b32 v3, s37, v24
    v_and_b32 v4, s37, v48
    v_mfma_f32_16x16x32_bf16 v[64:67], v[192:195], a[32:35], v[64:67]
    ds_read_b64_tr_b16 v[224:225], v17 offset:9216
    ds_read_b64_tr_b16 v[226:227], v17 offset:13824
    v_mfma_f32_16x16x32_bf16 v[68:71], v[192:195], a[36:39], v[68:71]
    buffer_load_dwordx4 a[96:99], v16, s[16:19], s41 offen offset:0 sc1
    v_mfma_f32_16x16x32_bf16 v[72:75], v[192:195], a[160:163], v[72:75]
    ds_read_b64_tr_b16 v[228:229], v18 offset:9216
    ds_read_b64_tr_b16 v[230:231], v18 offset:13824
    v_mfma_f32_16x16x32_bf16 v[76:79], v[192:195], a[164:167], v[76:79]
    v_mul_f32 v3, v3, v4
    v_mul_f32 v41, v6, v3
    v_mfma_f32_16x16x32_bf16 v[80:83], v[196:199], a[32:35], v[80:83]
    v_lshlrev_b32 v3, 16, v25
    v_lshlrev_b32 v4, 16, v49
    v_mfma_f32_16x16x32_bf16 v[84:87], v[196:199], a[36:39], v[84:87]
    buffer_load_dwordx4 a[100:103], v2, s[16:19], s41 offen offset:0 sc1
    v_mfma_f32_16x16x32_bf16 v[88:91], v[196:199], a[160:163], v[88:91]
    v_mul_f32 v3, v3, v4
    v_mul_f32 v42, v6, v3
    v_mfma_f32_16x16x32_bf16 v[92:95], v[196:199], a[164:167], v[92:95]
    v_and_b32 v3, s37, v25
    v_and_b32 v4, s37, v49
    s_waitcnt vmcnt(38) lgkmcnt(0)
    s_barrier
    v_mfma_f32_16x16x32_bf16 v[64:67], v[224:227], a[40:43], v[64:67]
    v_add_u32 v17, 4294838272, v17
    v_add_u32 v18, 4294838272, v18
    v_mfma_f32_16x16x32_bf16 v[68:71], v[224:227], a[44:47], v[68:71]
    v_add_u32 v19, 4294838272, v19
    v_add_u32 v20, 4294838272, v20
    v_mfma_f32_16x16x32_bf16 v[72:75], v[224:227], a[168:171], v[72:75]
    ds_read_b64_tr_b16 v[192:193], v17 offset:0
    ds_read_b64_tr_b16 v[194:195], v17 offset:4608
    v_mfma_f32_16x16x32_bf16 v[76:79], v[224:227], a[172:175], v[76:79]
    ds_read_b64_tr_b16 v[196:197], v18 offset:0
    ds_read_b64_tr_b16 v[198:199], v18 offset:4608
    v_mfma_f32_16x16x32_bf16 v[80:83], v[228:231], a[40:43], v[80:83]
    s_add_u32 m0, s59, 80896
    s_nop 0
    buffer_load_dwordx4 v0, s[8:11], s40 offen offset:0 lds
    v_mfma_f32_16x16x32_bf16 v[84:87], v[228:231], a[44:47], v[84:87]
    buffer_load_dwordx4 v1, s[8:11], s40 offen offset:1152 lds
    v_mfma_f32_16x16x32_bf16 v[88:91], v[228:231], a[168:171], v[88:91]
    v_mul_f32 v3, v3, v4
    v_mul_f32 v43, v6, v3
    v_mfma_f32_16x16x32_bf16 v[92:95], v[228:231], a[172:175], v[92:95]
    s_waitcnt lgkmcnt(0)
    v_lshlrev_b32 v3, 16, v28
    v_lshlrev_b32 v4, 16, v50
    v_mfma_f32_16x16x32_bf16 v[64:67], v[192:195], a[48:51], v[64:67]
    ds_read_b64_tr_b16 v[224:225], v17 offset:9216
    ds_read_b64_tr_b16 v[226:227], v17 offset:13824
    v_mfma_f32_16x16x32_bf16 v[68:71], v[192:195], a[52:55], v[68:71]
    s_add_u32 s40, s40, 65536
    buffer_load_dwordx4 a[232:235], v16, s[16:19], s42 offen offset:1024 sc1
    v_mfma_f32_16x16x32_bf16 v[72:75], v[192:195], a[176:179], v[72:75]
    ds_read_b64_tr_b16 v[228:229], v18 offset:9216
    ds_read_b64_tr_b16 v[230:231], v18 offset:13824
    v_mfma_f32_16x16x32_bf16 v[76:79], v[192:195], a[180:183], v[76:79]
    v_mul_f32 v3, v3, v4
    v_mul_f32 v44, v7, v3
    v_mfma_f32_16x16x32_bf16 v[80:83], v[196:199], a[48:51], v[80:83]
    v_and_b32 v3, s37, v28
    v_and_b32 v4, s37, v50
    v_mfma_f32_16x16x32_bf16 v[84:87], v[196:199], a[52:55], v[84:87]
    buffer_load_dwordx4 a[236:239], v2, s[16:19], s42 offen offset:1024 sc1
    v_mfma_f32_16x16x32_bf16 v[88:91], v[196:199], a[176:179], v[88:91]
    v_mul_f32 v3, v3, v4
    v_mul_f32 v45, v7, v3
    v_mfma_f32_16x16x32_bf16 v[92:95], v[196:199], a[180:183], v[92:95]
    v_lshlrev_b32 v3, 16, v29
    v_lshlrev_b32 v4, 16, v51
    s_waitcnt vmcnt(30) lgkmcnt(0)
    s_barrier
    v_mfma_f32_16x16x32_bf16 v[64:67], v[224:227], a[56:59], v[64:67]
    ds_read_b64_tr_b16 v[192:193], v17 offset:18432
    ds_read_b64_tr_b16 v[194:195], v17 offset:23040
    v_mfma_f32_16x16x32_bf16 v[68:71], v[224:227], a[60:63], v[68:71]
    buffer_load_dwordx4 a[104:107], v16, s[16:19], s41 offen offset:1024 sc1
    v_mfma_f32_16x16x32_bf16 v[72:75], v[224:227], a[184:187], v[72:75]
    ds_read_b64_tr_b16 v[196:197], v18 offset:18432
    ds_read_b64_tr_b16 v[198:199], v18 offset:23040
    v_mfma_f32_16x16x32_bf16 v[76:79], v[224:227], a[188:191], v[76:79]
    v_mul_f32 v3, v3, v4
    v_mul_f32 v46, v7, v3
    v_mfma_f32_16x16x32_bf16 v[80:83], v[228:231], a[56:59], v[80:83]
    v_and_b32 v3, s37, v29
    v_and_b32 v4, s37, v51
    v_mfma_f32_16x16x32_bf16 v[84:87], v[228:231], a[60:63], v[84:87]
    buffer_load_dwordx4 a[108:111], v2, s[16:19], s41 offen offset:1024 sc1
    v_mfma_f32_16x16x32_bf16 v[88:91], v[228:231], a[184:187], v[88:91]
gated_mix__ssm_conv_h3__compressed_kv_cla__prompt_kernel_pad14:
    s_cbranch_execz gated_mix__ssm_conv_h3__compressed_kv_cla__prompt_kernel_pad18
    v_mul_f32 v3, v3, v4
    v_mul_f32 v47, v7, v3
    v_mfma_f32_16x16x32_bf16 v[92:95], v[228:231], a[188:191], v[92:95]
    s_waitcnt lgkmcnt(0)
    v_lshlrev_b32 v3, 16, v32
    v_lshlrev_b32 v4, 16, v52
    v_mfma_f32_16x16x32_bf16 v[64:67], v[192:195], a[64:67], v[64:67]
    ds_read_b64_tr_b16 v[224:225], v17 offset:27648
    ds_read_b64_tr_b16 v[226:227], v17 offset:32256
    v_mfma_f32_16x16x32_bf16 v[68:71], v[192:195], a[68:71], v[68:71]
    s_add_u32 m0, s59, 90112
    s_nop 0
    buffer_load_dwordx4 v0, s[8:11], s40 offen offset:0 lds
    v_mfma_f32_16x16x32_bf16 v[72:75], v[192:195], a[192:195], v[72:75]
    ds_read_b64_tr_b16 v[228:229], v18 offset:27648
    ds_read_b64_tr_b16 v[230:231], v18 offset:32256
    v_mfma_f32_16x16x32_bf16 v[76:79], v[192:195], a[196:199], v[76:79]
    v_mul_f32 v3, v3, v4
    v_mul_f32 v48, v11, v3
    v_mfma_f32_16x16x32_bf16 v[80:83], v[196:199], a[64:67], v[80:83]
    v_and_b32 v3, s37, v32
    v_and_b32 v4, s37, v52
    v_mfma_f32_16x16x32_bf16 v[84:87], v[196:199], a[68:71], v[84:87]
    buffer_load_dwordx4 v1, s[8:11], s40 offen offset:1152 lds
    v_mfma_f32_16x16x32_bf16 v[88:91], v[196:199], a[192:195], v[88:91]
    v_mul_f32 v3, v3, v4
    v_mul_f32 v49, v11, v3
    v_mfma_f32_16x16x32_bf16 v[92:95], v[196:199], a[196:199], v[92:95]
    v_lshlrev_b32 v3, 16, v33
    v_lshlrev_b32 v4, 16, v53
    s_waitcnt vmcnt(18) lgkmcnt(0)
    s_barrier
    v_mfma_f32_16x16x32_bf16 v[64:67], v[224:227], a[72:75], v[64:67]
    ds_read_b64_tr_b16 v[192:193], v17 offset:36864
    ds_read_b64_tr_b16 v[194:195], v17 offset:41472
    v_mfma_f32_16x16x32_bf16 v[68:71], v[224:227], a[76:79], v[68:71]
    s_add_u32 s40, s40, 65536
    buffer_load_dwordx4 a[240:243], v16, s[16:19], s42 offen offset:2048 sc1
    v_mfma_f32_16x16x32_bf16 v[72:75], v[224:227], a[200:203], v[72:75]
    ds_read_b64_tr_b16 v[196:197], v18 offset:36864
    ds_read_b64_tr_b16 v[198:199], v18 offset:41472
    v_mfma_f32_16x16x32_bf16 v[76:79], v[224:227], a[204:207], v[76:79]
    v_mul_f32 v3, v3, v4
    v_mul_f32 v50, v11, v3
    v_mfma_f32_16x16x32_bf16 v[80:83], v[228:231], a[72:75], v[80:83]
    v_and_b32 v3, s37, v33
    v_and_b32 v4, s37, v53
    v_mfma_f32_16x16x32_bf16 v[84:87], v[228:231], a[76:79], v[84:87]
    buffer_load_dwordx4 a[244:247], v2, s[16:19], s42 offen offset:2048 sc1
    v_mfma_f32_16x16x32_bf16 v[88:91], v[228:231], a[200:203], v[88:91]
    v_mul_f32 v3, v3, v4
    v_mul_f32 v51, v11, v3
    v_mfma_f32_16x16x32_bf16 v[92:95], v[228:231], a[204:207], v[92:95]
    s_waitcnt lgkmcnt(0)
    v_lshlrev_b32 v3, 16, v36
    v_lshlrev_b32 v4, 16, v54
    v_mfma_f32_16x16x32_bf16 v[64:67], v[192:195], a[80:83], v[64:67]
    ds_read_b64_tr_b16 v[224:225], v17 offset:46080
    ds_read_b64_tr_b16 v[226:227], v17 offset:50688
    v_mfma_f32_16x16x32_bf16 v[68:71], v[192:195], a[84:87], v[68:71]
    buffer_load_dwordx4 a[112:115], v16, s[16:19], s41 offen offset:2048 sc1
    v_mfma_f32_16x16x32_bf16 v[72:75], v[192:195], a[208:211], v[72:75]
    ds_read_b64_tr_b16 v[228:229], v18 offset:46080
    ds_read_b64_tr_b16 v[230:231], v18 offset:50688
    v_mfma_f32_16x16x32_bf16 v[76:79], v[192:195], a[212:215], v[76:79]
    v_mul_f32 v3, v3, v4
    v_mul_f32 v52, v12, v3
    v_mfma_f32_16x16x32_bf16 v[80:83], v[196:199], a[80:83], v[80:83]
    v_and_b32 v3, s37, v36
    v_and_b32 v4, s37, v54
    v_mfma_f32_16x16x32_bf16 v[84:87], v[196:199], a[84:87], v[84:87]
    buffer_load_dwordx4 a[116:119], v2, s[16:19], s41 offen offset:2048 sc1
    v_mfma_f32_16x16x32_bf16 v[88:91], v[196:199], a[208:211], v[88:91]
    v_mul_f32 v3, v3, v4
    v_mul_f32 v53, v12, v3
    v_mfma_f32_16x16x32_bf16 v[92:95], v[196:199], a[212:215], v[92:95]
    v_lshlrev_b32 v3, 16, v37
    v_lshlrev_b32 v4, 16, v55
    s_waitcnt vmcnt(10) lgkmcnt(0)
    s_barrier
    v_mfma_f32_16x16x32_bf16 v[64:67], v[224:227], a[88:91], v[64:67]
    ds_read_b64_tr_b16 v[192:193], v17 offset:55296
    ds_read_b64_tr_b16 v[194:195], v17 offset:59904
    v_mfma_f32_16x16x32_bf16 v[68:71], v[224:227], a[92:95], v[68:71]
    s_add_u32 m0, s59, 99328
    s_nop 0
    buffer_load_dwordx4 v0, s[8:11], s40 offen offset:0 lds
    v_mfma_f32_16x16x32_bf16 v[72:75], v[224:227], a[216:219], v[72:75]
    ds_read_b64_tr_b16 v[196:197], v18 offset:55296
    ds_read_b64_tr_b16 v[198:199], v18 offset:59904
    v_mfma_f32_16x16x32_bf16 v[76:79], v[224:227], a[220:223], v[76:79]
    v_mul_f32 v3, v3, v4
    v_mul_f32 v54, v12, v3
    v_mfma_f32_16x16x32_bf16 v[80:83], v[228:231], a[88:91], v[80:83]
    v_and_b32 v3, s37, v37
    v_and_b32 v4, s37, v55
    v_mfma_f32_16x16x32_bf16 v[84:87], v[228:231], a[92:95], v[84:87]
    buffer_load_dwordx4 v1, s[8:11], s40 offen offset:1152 lds
    v_mfma_f32_16x16x32_bf16 v[88:91], v[228:231], a[216:219], v[88:91]
    v_mul_f32 v3, v3, v4
    v_mul_f32 v55, v12, v3
    v_mfma_f32_16x16x32_bf16 v[92:95], v[228:231], a[220:223], v[92:95]
    s_waitcnt lgkmcnt(0)
    v_lshlrev_b32 v3, 16, v26
    v_lshlrev_b32 v4, 16, v56
    v_mfma_f32_16x16x32_bf16 v[64:67], v[192:195], a[96:99], v[64:67]
    v_add_u32 v17, 64512, v17
    v_add_u32 v18, 64512, v18
    v_mfma_f32_16x16x32_bf16 v[68:71], v[192:195], a[100:103], v[68:71]
    v_add_u32 v19, 64512, v19
    v_add_u32 v20, 64512, v20
    v_mfma_f32_16x16x32_bf16 v[72:75], v[192:195], a[224:227], v[72:75]
    ds_read_b64_tr_b16 v[224:225], v17 offset:0
    ds_read_b64_tr_b16 v[226:227], v17 offset:4608
    v_mfma_f32_16x16x32_bf16 v[76:79], v[192:195], a[228:231], v[76:79]
    ds_read_b64_tr_b16 v[228:229], v18 offset:0
    ds_read_b64_tr_b16 v[230:231], v18 offset:4608
    v_mfma_f32_16x16x32_bf16 v[80:83], v[196:199], a[96:99], v[80:83]
    s_add_u32 s40, s40, 65536
    buffer_load_dwordx4 a[248:251], v16, s[16:19], s42 offen offset:3072 sc1
    v_mfma_f32_16x16x32_bf16 v[84:87], v[196:199], a[100:103], v[84:87]
    buffer_load_dwordx4 a[252:255], v2, s[16:19], s42 offen offset:3072 sc1
    v_mfma_f32_16x16x32_bf16 v[88:91], v[196:199], a[224:227], v[88:91]
    v_mul_f32 v3, v3, v4
    v_mul_f32 v24, v6, v3
    v_mfma_f32_16x16x32_bf16 v[92:95], v[196:199], a[228:231], v[92:95]
    v_and_b32 v3, s37, v26
    v_and_b32 v4, s37, v56
    s_waitcnt vmcnt(2) lgkmcnt(0)
    s_barrier
    v_mfma_f32_16x16x32_bf16 v[64:67], v[224:227], a[104:107], v[64:67]
    ds_read_b64_tr_b16 v[192:193], v17 offset:9216
    ds_read_b64_tr_b16 v[194:195], v17 offset:13824
    v_mfma_f32_16x16x32_bf16 v[68:71], v[224:227], a[108:111], v[68:71]
    s_add_u32 s42, s42, 4096
    buffer_load_dwordx4 a[120:123], v16, s[16:19], s41 offen offset:3072 sc1
    v_mfma_f32_16x16x32_bf16 v[72:75], v[224:227], a[232:235], v[72:75]
    ds_read_b64_tr_b16 v[196:197], v18 offset:9216
    ds_read_b64_tr_b16 v[198:199], v18 offset:13824
    v_mfma_f32_16x16x32_bf16 v[76:79], v[224:227], a[236:239], v[76:79]
    v_mul_f32 v3, v3, v4
    v_mul_f32 v25, v6, v3
    v_mfma_f32_16x16x32_bf16 v[80:83], v[228:231], a[104:107], v[80:83]
    v_lshlrev_b32 v3, 16, v27
    v_lshlrev_b32 v4, 16, v57
    v_mfma_f32_16x16x32_bf16 v[84:87], v[228:231], a[108:111], v[84:87]
    buffer_load_dwordx4 a[124:127], v2, s[16:19], s41 offen offset:3072 sc1
    v_mfma_f32_16x16x32_bf16 v[88:91], v[228:231], a[232:235], v[88:91]
    v_mul_f32 v3, v3, v4
    v_mul_f32 v28, v6, v3
    v_mfma_f32_16x16x32_bf16 v[92:95], v[228:231], a[236:239], v[92:95]
    s_waitcnt lgkmcnt(0)
    v_and_b32 v3, s37, v27
    v_and_b32 v4, s37, v57
    v_mfma_f32_16x16x32_bf16 v[64:67], v[192:195], a[112:115], v[64:67]
    ds_read_b64_tr_b16 v[224:225], v17 offset:18432
    ds_read_b64_tr_b16 v[226:227], v17 offset:23040
    v_mfma_f32_16x16x32_bf16 v[68:71], v[192:195], a[116:119], v[68:71]
    s_add_u32 s41, s41, 4096
    s_add_u32 s16, s94, 67108864
    s_addc_u32 s17, s95, 0
    s_mov_b32 s18, 16777216
    v_mul_f32 v3, v3, v4
    v_mul_f32 v29, v6, v3
    v_mfma_f32_16x16x32_bf16 v[72:75], v[192:195], a[240:243], v[72:75]
    ds_read_b64_tr_b16 v[228:229], v18 offset:18432
    ds_read_b64_tr_b16 v[230:231], v18 offset:23040
    v_mfma_f32_16x16x32_bf16 v[76:79], v[192:195], a[244:247], v[76:79]
    v_lshlrev_b32 v3, 16, v30
    v_lshlrev_b32 v4, 16, v58
    v_mfma_f32_16x16x32_bf16 v[80:83], v[196:199], a[112:115], v[80:83]
    v_mul_f32 v3, v3, v4
    v_mul_f32 v32, v7, v3
    v_mfma_f32_16x16x32_bf16 v[84:87], v[196:199], a[116:119], v[84:87]
    v_and_b32 v3, s37, v30
    v_and_b32 v4, s37, v58
    v_mfma_f32_16x16x32_bf16 v[88:91], v[196:199], a[240:243], v[88:91]
    v_mul_f32 v3, v3, v4
    v_mul_f32 v33, v7, v3
    v_mfma_f32_16x16x32_bf16 v[92:95], v[196:199], a[244:247], v[92:95]
    v_lshlrev_b32 v3, 16, v31
    v_lshlrev_b32 v4, 16, v59
    s_waitcnt vmcnt(0) lgkmcnt(0)
    s_barrier
    v_mfma_f32_16x16x32_bf16 v[64:67], v[224:227], a[120:123], v[64:67]
    v_mfma_f32_16x16x32_bf16 v[68:71], v[224:227], a[124:127], v[68:71]
    v_mul_f32 v3, v3, v4
    v_mul_f32 v36, v7, v3
    v_mfma_f32_16x16x32_bf16 v[72:75], v[224:227], a[248:251], v[72:75]
    v_mfma_f32_16x16x32_bf16 v[76:79], v[224:227], a[252:255], v[76:79]
    v_and_b32 v3, s37, v31
    v_and_b32 v4, s37, v59
    v_mfma_f32_16x16x32_bf16 v[80:83], v[228:231], a[120:123], v[80:83]
    v_mul_f32 v3, v3, v4
    v_mul_f32 v37, v7, v3
    v_mfma_f32_16x16x32_bf16 v[84:87], v[228:231], a[124:127], v[84:87]
    v_lshlrev_b32 v3, 16, v34
    v_lshlrev_b32 v4, 16, v60
    v_mfma_f32_16x16x32_bf16 v[88:91], v[228:231], a[248:251], v[88:91]
    v_mul_f32 v3, v3, v4
    v_mul_f32 v56, v11, v3
    v_mfma_f32_16x16x32_bf16 v[92:95], v[228:231], a[252:255], v[92:95]
    s_waitcnt lgkmcnt(0)
    v_and_b32 v3, s37, v34
    v_and_b32 v4, s37, v60
    v_mfma_f32_16x16x32_bf16 v[96:99], v[200:203], a[0:3], v[96:99]
    ds_read_b64_tr_b16 v[232:233], v19 offset:36864
    ds_read_b64_tr_b16 v[234:235], v19 offset:41472
    v_mfma_f32_16x16x32_bf16 v[100:103], v[200:203], a[4:7], v[100:103]
    v_mfma_f32_16x16x32_bf16 v[104:107], v[200:203], a[128:131], v[104:107]
    ds_read_b64_tr_b16 v[236:237], v20 offset:36864
    ds_read_b64_tr_b16 v[238:239], v20 offset:41472
    v_mfma_f32_16x16x32_bf16 v[108:111], v[200:203], a[132:135], v[108:111]
    v_mfma_f32_16x16x32_bf16 v[112:115], v[204:207], a[0:3], v[112:115]
    v_mfma_f32_16x16x32_bf16 v[116:119], v[204:207], a[4:7], v[116:119]
    v_cvt_pk_bf16_f32 v64, v64, v65
    v_cvt_pk_bf16_f32 v65, v66, v67
    v_mfma_f32_16x16x32_bf16 v[120:123], v[204:207], a[128:131], v[120:123]
    v_cvt_pk_bf16_f32 v66, v68, v69
    v_cvt_pk_bf16_f32 v67, v70, v71
    v_mfma_f32_16x16x32_bf16 v[124:127], v[204:207], a[132:135], v[124:127]
    s_waitcnt lgkmcnt(0)
    v_mfma_f32_16x16x32_bf16 v[96:99], v[232:235], a[8:11], v[96:99]
    ds_read_b64_tr_b16 v[200:201], v19 offset:46080
    ds_read_b64_tr_b16 v[202:203], v19 offset:50688
    v_mfma_f32_16x16x32_bf16 v[100:103], v[232:235], a[12:15], v[100:103]
    buffer_store_dwordx4 v[64:67], v16, s[16:19], s46 offen offset:0 sc1
    v_mfma_f32_16x16x32_bf16 v[104:107], v[232:235], a[136:139], v[104:107]
    ds_read_b64_tr_b16 v[204:205], v20 offset:46080
    ds_read_b64_tr_b16 v[206:207], v20 offset:50688
    v_mfma_f32_16x16x32_bf16 v[108:111], v[232:235], a[140:143], v[108:111]
    v_cvt_pk_bf16_f32 v68, v72, v73
    v_cvt_pk_bf16_f32 v69, v74, v75
    v_mfma_f32_16x16x32_bf16 v[112:115], v[236:239], a[8:11], v[112:115]
    v_cvt_pk_bf16_f32 v70, v76, v77
    v_cvt_pk_bf16_f32 v71, v78, v79
    v_mfma_f32_16x16x32_bf16 v[116:119], v[236:239], a[12:15], v[116:119]
    buffer_store_dwordx4 v[68:71], v16, s[16:19], s46 offen offset:1024 sc1
    v_mfma_f32_16x16x32_bf16 v[120:123], v[236:239], a[136:139], v[120:123]
    v_cvt_pk_bf16_f32 v72, v80, v81
    v_cvt_pk_bf16_f32 v73, v82, v83
    v_mfma_f32_16x16x32_bf16 v[124:127], v[236:239], a[140:143], v[124:127]
    s_waitcnt lgkmcnt(0)
    v_cvt_pk_bf16_f32 v74, v84, v85
    v_cvt_pk_bf16_f32 v75, v86, v87
    v_mfma_f32_16x16x32_bf16 v[96:99], v[200:203], a[16:19], v[96:99]
    ds_read_b64_tr_b16 v[232:233], v19 offset:55296
    ds_read_b64_tr_b16 v[234:235], v19 offset:59904
    v_mfma_f32_16x16x32_bf16 v[100:103], v[200:203], a[20:23], v[100:103]
    buffer_store_dwordx4 v[72:75], v16, s[16:19], s46 offen offset:2048 sc1
    v_mfma_f32_16x16x32_bf16 v[104:107], v[200:203], a[144:147], v[104:107]
    ds_read_b64_tr_b16 v[236:237], v20 offset:55296
    ds_read_b64_tr_b16 v[238:239], v20 offset:59904
    v_mfma_f32_16x16x32_bf16 v[108:111], v[200:203], a[148:151], v[108:111]
    v_cvt_pk_bf16_f32 v76, v88, v89
    v_cvt_pk_bf16_f32 v77, v90, v91
    v_mfma_f32_16x16x32_bf16 v[112:115], v[204:207], a[16:19], v[112:115]
    v_cvt_pk_bf16_f32 v78, v92, v93
    v_cvt_pk_bf16_f32 v79, v94, v95
    v_mfma_f32_16x16x32_bf16 v[116:119], v[204:207], a[20:23], v[116:119]
    buffer_store_dwordx4 v[76:79], v16, s[16:19], s46 offen offset:3072 sc1
    v_mfma_f32_16x16x32_bf16 v[120:123], v[204:207], a[144:147], v[120:123]
    s_add_u32 s46, s46, 4096
    v_mul_f32 v3, v3, v4
    v_mul_f32 v57, v11, v3
    v_mfma_f32_16x16x32_bf16 v[124:127], v[204:207], a[148:151], v[124:127]
    s_waitcnt lgkmcnt(0)
    v_lshlrev_b32 v3, 16, v35
    v_lshlrev_b32 v4, 16, v61
    v_mfma_f32_16x16x32_bf16 v[96:99], v[232:235], a[24:27], v[96:99]
    v_add_u32 v17, 64512, v17
    v_add_u32 v18, 64512, v18
    v_mfma_f32_16x16x32_bf16 v[100:103], v[232:235], a[28:31], v[100:103]
    v_add_u32 v19, 64512, v19
    v_add_u32 v20, 64512, v20
    v_mfma_f32_16x16x32_bf16 v[104:107], v[232:235], a[152:155], v[104:107]
    ds_read_b64_tr_b16 v[200:201], v19 offset:0
    ds_read_b64_tr_b16 v[202:203], v19 offset:4608
    v_mfma_f32_16x16x32_bf16 v[108:111], v[232:235], a[156:159], v[108:111]
    ds_read_b64_tr_b16 v[204:205], v20 offset:0
    ds_read_b64_tr_b16 v[206:207], v20 offset:4608
    v_mfma_f32_16x16x32_bf16 v[112:115], v[236:239], a[24:27], v[112:115]
    v_mul_f32 v3, v3, v4
    v_mul_f32 v58, v11, v3
    v_mfma_f32_16x16x32_bf16 v[116:119], v[236:239], a[28:31], v[116:119]
    v_and_b32 v3, s37, v35
    v_and_b32 v4, s37, v61
    v_mfma_f32_16x16x32_bf16 v[120:123], v[236:239], a[152:155], v[120:123]
    v_mul_f32 v3, v3, v4
    v_mul_f32 v59, v11, v3
    v_mfma_f32_16x16x32_bf16 v[124:127], v[236:239], a[156:159], v[124:127]
    s_waitcnt lgkmcnt(0)
    v_lshlrev_b32 v3, 16, v38
    v_lshlrev_b32 v4, 16, v62
    v_mfma_f32_16x16x32_bf16 v[96:99], v[200:203], a[32:35], v[96:99]
    ds_read_b64_tr_b16 v[232:233], v19 offset:9216
    ds_read_b64_tr_b16 v[234:235], v19 offset:13824
    v_mfma_f32_16x16x32_bf16 v[100:103], v[200:203], a[36:39], v[100:103]
    v_mul_f32 v3, v3, v4
    v_mul_f32 v26, v12, v3
    v_mfma_f32_16x16x32_bf16 v[104:107], v[200:203], a[160:163], v[104:107]
    ds_read_b64_tr_b16 v[236:237], v20 offset:9216
    ds_read_b64_tr_b16 v[238:239], v20 offset:13824
    v_mfma_f32_16x16x32_bf16 v[108:111], v[200:203], a[164:167], v[108:111]
    v_and_b32 v3, s37, v38
    v_and_b32 v4, s37, v62
    v_mfma_f32_16x16x32_bf16 v[112:115], v[204:207], a[32:35], v[112:115]
    v_mul_f32 v3, v3, v4
    v_mul_f32 v27, v12, v3
    v_mfma_f32_16x16x32_bf16 v[116:119], v[204:207], a[36:39], v[116:119]
    v_lshlrev_b32 v3, 16, v39
    v_lshlrev_b32 v4, 16, v63
    v_mfma_f32_16x16x32_bf16 v[120:123], v[204:207], a[160:163], v[120:123]
    v_mul_f32 v3, v3, v4
    v_mul_f32 v30, v12, v3
    v_mfma_f32_16x16x32_bf16 v[124:127], v[204:207], a[164:167], v[124:127]
    s_waitcnt lgkmcnt(0)
    v_and_b32 v3, s37, v39
    v_and_b32 v4, s37, v63
    v_mfma_f32_16x16x32_bf16 v[96:99], v[232:235], a[40:43], v[96:99]
    v_add_u32 v17, 4294838272, v17
    v_add_u32 v18, 4294838272, v18
    v_mfma_f32_16x16x32_bf16 v[100:103], v[232:235], a[44:47], v[100:103]
    v_add_u32 v19, 4294838272, v19
    v_add_u32 v20, 4294838272, v20
    v_mfma_f32_16x16x32_bf16 v[104:107], v[232:235], a[168:171], v[104:107]
    ds_read_b64_tr_b16 v[200:201], v19 offset:0
    ds_read_b64_tr_b16 v[202:203], v19 offset:4608
    v_mfma_f32_16x16x32_bf16 v[108:111], v[232:235], a[172:175], v[108:111]
    ds_read_b64_tr_b16 v[204:205], v20 offset:0
    ds_read_b64_tr_b16 v[206:207], v20 offset:4608
    v_mfma_f32_16x16x32_bf16 v[112:115], v[236:239], a[40:43], v[112:115]
    v_mul_f32 v3, v3, v4
    v_mul_f32 v31, v12, v3
    v_mfma_f32_16x16x32_bf16 v[116:119], v[236:239], a[44:47], v[116:119]
    v_sub_f32 v6, 1.0, v6
    v_sub_f32 v7, 1.0, v7
    v_mfma_f32_16x16x32_bf16 v[120:123], v[236:239], a[168:171], v[120:123]
    v_sub_f32 v11, 1.0, v11
    v_sub_f32 v12, 1.0, v12
    v_mfma_f32_16x16x32_bf16 v[124:127], v[236:239], a[172:175], v[124:127]
    s_waitcnt lgkmcnt(0)
    v_mfma_f32_16x16x32_bf16 v[96:99], v[200:203], a[48:51], v[96:99]
    ds_read_b64_tr_b16 v[232:233], v19 offset:9216
    ds_read_b64_tr_b16 v[234:235], v19 offset:13824
    v_mfma_f32_16x16x32_bf16 v[100:103], v[200:203], a[52:55], v[100:103]
    v_mfma_f32_16x16x32_bf16 v[104:107], v[200:203], a[176:179], v[104:107]
    ds_read_b64_tr_b16 v[236:237], v20 offset:9216
    ds_read_b64_tr_b16 v[238:239], v20 offset:13824
    v_mfma_f32_16x16x32_bf16 v[108:111], v[200:203], a[180:183], v[108:111]
    v_mfma_f32_16x16x32_bf16 v[112:115], v[204:207], a[48:51], v[112:115]
    v_mfma_f32_16x16x32_bf16 v[116:119], v[204:207], a[52:55], v[116:119]
    v_mfma_f32_16x16x32_bf16 v[120:123], v[204:207], a[176:179], v[120:123]
    v_mfma_f32_16x16x32_bf16 v[124:127], v[204:207], a[180:183], v[124:127]
    s_waitcnt lgkmcnt(0)
    v_mfma_f32_16x16x32_bf16 v[96:99], v[232:235], a[56:59], v[96:99]
    ds_read_b64_tr_b16 v[200:201], v19 offset:18432
    ds_read_b64_tr_b16 v[202:203], v19 offset:23040
    v_mfma_f32_16x16x32_bf16 v[100:103], v[232:235], a[60:63], v[100:103]
    v_mfma_f32_16x16x32_bf16 v[104:107], v[232:235], a[184:187], v[104:107]
    ds_read_b64_tr_b16 v[204:205], v20 offset:18432
    ds_read_b64_tr_b16 v[206:207], v20 offset:23040
    v_mfma_f32_16x16x32_bf16 v[108:111], v[232:235], a[188:191], v[108:111]
    v_mfma_f32_16x16x32_bf16 v[112:115], v[236:239], a[56:59], v[112:115]
    v_mfma_f32_16x16x32_bf16 v[116:119], v[236:239], a[60:63], v[116:119]
    v_mfma_f32_16x16x32_bf16 v[120:123], v[236:239], a[184:187], v[120:123]
    v_mfma_f32_16x16x32_bf16 v[124:127], v[236:239], a[188:191], v[124:127]
    s_waitcnt lgkmcnt(0)
    v_mfma_f32_16x16x32_bf16 v[96:99], v[200:203], a[64:67], v[96:99]
    ds_read_b64_tr_b16 v[232:233], v19 offset:27648
    ds_read_b64_tr_b16 v[234:235], v19 offset:32256
    v_mfma_f32_16x16x32_bf16 v[100:103], v[200:203], a[68:71], v[100:103]
    v_mfma_f32_16x16x32_bf16 v[104:107], v[200:203], a[192:195], v[104:107]
    ds_read_b64_tr_b16 v[236:237], v20 offset:27648
    ds_read_b64_tr_b16 v[238:239], v20 offset:32256
    v_mfma_f32_16x16x32_bf16 v[108:111], v[200:203], a[196:199], v[108:111]
    v_mfma_f32_16x16x32_bf16 v[112:115], v[204:207], a[64:67], v[112:115]
    v_mfma_f32_16x16x32_bf16 v[116:119], v[204:207], a[68:71], v[116:119]
    v_mfma_f32_16x16x32_bf16 v[120:123], v[204:207], a[192:195], v[120:123]
    v_mfma_f32_16x16x32_bf16 v[124:127], v[204:207], a[196:199], v[124:127]
    s_waitcnt lgkmcnt(0)
    v_mfma_f32_16x16x32_bf16 v[96:99], v[232:235], a[72:75], v[96:99]
    ds_read_b64_tr_b16 v[200:201], v19 offset:36864
    ds_read_b64_tr_b16 v[202:203], v19 offset:41472
    v_mfma_f32_16x16x32_bf16 v[100:103], v[232:235], a[76:79], v[100:103]
    v_mfma_f32_16x16x32_bf16 v[104:107], v[232:235], a[200:203], v[104:107]
    ds_read_b64_tr_b16 v[204:205], v20 offset:36864
    ds_read_b64_tr_b16 v[206:207], v20 offset:41472
    v_mfma_f32_16x16x32_bf16 v[108:111], v[232:235], a[204:207], v[108:111]
    v_mfma_f32_16x16x32_bf16 v[112:115], v[236:239], a[72:75], v[112:115]
    v_mfma_f32_16x16x32_bf16 v[116:119], v[236:239], a[76:79], v[116:119]
    v_mfma_f32_16x16x32_bf16 v[120:123], v[236:239], a[200:203], v[120:123]
    v_mfma_f32_16x16x32_bf16 v[124:127], v[236:239], a[204:207], v[124:127]
    s_waitcnt lgkmcnt(0)
    v_mfma_f32_16x16x32_bf16 v[96:99], v[200:203], a[80:83], v[96:99]
    ds_read_b64_tr_b16 v[232:233], v19 offset:46080
    ds_read_b64_tr_b16 v[234:235], v19 offset:50688
    v_mfma_f32_16x16x32_bf16 v[100:103], v[200:203], a[84:87], v[100:103]
    v_mfma_f32_16x16x32_bf16 v[104:107], v[200:203], a[208:211], v[104:107]
    ds_read_b64_tr_b16 v[236:237], v20 offset:46080
    ds_read_b64_tr_b16 v[238:239], v20 offset:50688
    v_mfma_f32_16x16x32_bf16 v[108:111], v[200:203], a[212:215], v[108:111]
    v_mfma_f32_16x16x32_bf16 v[112:115], v[204:207], a[80:83], v[112:115]
    v_mfma_f32_16x16x32_bf16 v[116:119], v[204:207], a[84:87], v[116:119]
    v_mfma_f32_16x16x32_bf16 v[120:123], v[204:207], a[208:211], v[120:123]
    v_mfma_f32_16x16x32_bf16 v[124:127], v[204:207], a[212:215], v[124:127]
    s_waitcnt lgkmcnt(0)
    v_mfma_f32_16x16x32_bf16 v[96:99], v[232:235], a[88:91], v[96:99]
    ds_read_b64_tr_b16 v[200:201], v19 offset:55296
    ds_read_b64_tr_b16 v[202:203], v19 offset:59904
    v_mfma_f32_16x16x32_bf16 v[100:103], v[232:235], a[92:95], v[100:103]
    v_mfma_f32_16x16x32_bf16 v[104:107], v[232:235], a[216:219], v[104:107]
    ds_read_b64_tr_b16 v[204:205], v20 offset:55296
    ds_read_b64_tr_b16 v[206:207], v20 offset:59904
    v_mfma_f32_16x16x32_bf16 v[108:111], v[232:235], a[220:223], v[108:111]
    v_mfma_f32_16x16x32_bf16 v[112:115], v[236:239], a[88:91], v[112:115]
    v_mfma_f32_16x16x32_bf16 v[116:119], v[236:239], a[92:95], v[116:119]
    v_mfma_f32_16x16x32_bf16 v[120:123], v[236:239], a[216:219], v[120:123]
    v_mfma_f32_16x16x32_bf16 v[124:127], v[236:239], a[220:223], v[124:127]
    s_waitcnt lgkmcnt(0)
    v_mfma_f32_16x16x32_bf16 v[96:99], v[200:203], a[96:99], v[96:99]
    v_add_u32 v17, 64512, v17
    v_add_u32 v18, 64512, v18
    v_mfma_f32_16x16x32_bf16 v[100:103], v[200:203], a[100:103], v[100:103]
    v_add_u32 v19, 64512, v19
    v_add_u32 v20, 64512, v20
    v_mfma_f32_16x16x32_bf16 v[104:107], v[200:203], a[224:227], v[104:107]
    ds_read_b64_tr_b16 v[232:233], v19 offset:0
    ds_read_b64_tr_b16 v[234:235], v19 offset:4608
    v_mfma_f32_16x16x32_bf16 v[108:111], v[200:203], a[228:231], v[108:111]
    ds_read_b64_tr_b16 v[236:237], v20 offset:0
    ds_read_b64_tr_b16 v[238:239], v20 offset:4608
    v_mfma_f32_16x16x32_bf16 v[112:115], v[204:207], a[96:99], v[112:115]
    v_mfma_f32_16x16x32_bf16 v[116:119], v[204:207], a[100:103], v[116:119]
    v_mfma_f32_16x16x32_bf16 v[120:123], v[204:207], a[224:227], v[120:123]
    v_mfma_f32_16x16x32_bf16 v[124:127], v[204:207], a[228:231], v[124:127]
    s_waitcnt lgkmcnt(0)
    v_mfma_f32_16x16x32_bf16 v[96:99], v[232:235], a[104:107], v[96:99]
    ds_read_b64_tr_b16 v[200:201], v19 offset:9216
    ds_read_b64_tr_b16 v[202:203], v19 offset:13824
    v_mfma_f32_16x16x32_bf16 v[100:103], v[232:235], a[108:111], v[100:103]
    v_mfma_f32_16x16x32_bf16 v[104:107], v[232:235], a[232:235], v[104:107]
    ds_read_b64_tr_b16 v[204:205], v20 offset:9216
    ds_read_b64_tr_b16 v[206:207], v20 offset:13824
    v_mfma_f32_16x16x32_bf16 v[108:111], v[232:235], a[236:239], v[108:111]
    v_mfma_f32_16x16x32_bf16 v[112:115], v[236:239], a[104:107], v[112:115]
    v_mfma_f32_16x16x32_bf16 v[116:119], v[236:239], a[108:111], v[116:119]
    v_mfma_f32_16x16x32_bf16 v[120:123], v[236:239], a[232:235], v[120:123]
    v_mfma_f32_16x16x32_bf16 v[124:127], v[236:239], a[236:239], v[124:127]
    s_waitcnt lgkmcnt(0)
    v_mfma_f32_16x16x32_bf16 v[96:99], v[200:203], a[112:115], v[96:99]
    ds_read_b64_tr_b16 v[232:233], v19 offset:18432
    ds_read_b64_tr_b16 v[234:235], v19 offset:23040
    v_mfma_f32_16x16x32_bf16 v[100:103], v[200:203], a[116:119], v[100:103]
    v_mfma_f32_16x16x32_bf16 v[104:107], v[200:203], a[240:243], v[104:107]
    ds_read_b64_tr_b16 v[236:237], v20 offset:18432
    ds_read_b64_tr_b16 v[238:239], v20 offset:23040
    v_mfma_f32_16x16x32_bf16 v[108:111], v[200:203], a[244:247], v[108:111]
    v_mfma_f32_16x16x32_bf16 v[112:115], v[204:207], a[112:115], v[112:115]
    v_mfma_f32_16x16x32_bf16 v[116:119], v[204:207], a[116:119], v[116:119]
    v_mfma_f32_16x16x32_bf16 v[120:123], v[204:207], a[240:243], v[120:123]
    v_mfma_f32_16x16x32_bf16 v[124:127], v[204:207], a[244:247], v[124:127]
    s_waitcnt lgkmcnt(0)
    v_mfma_f32_16x16x32_bf16 v[96:99], v[232:235], a[120:123], v[96:99]
    v_mfma_f32_16x16x32_bf16 v[100:103], v[232:235], a[124:127], v[100:103]
    s_lshl_b32 s52, s44, 2
    s_xor_b32 s52, s52, 196608
    v_mfma_f32_16x16x32_bf16 v[104:107], v[232:235], a[248:251], v[104:107]
    v_mfma_f32_16x16x32_bf16 v[108:111], v[232:235], a[252:255], v[108:111]
    s_add_u32 s52, s52, 0
    buffer_load_dwordx4 v[80:83], v16, s[16:19], s52 offen offset:0 sc1
    v_mfma_f32_16x16x32_bf16 v[112:115], v[236:239], a[120:123], v[112:115]
    buffer_load_dwordx4 v[84:87], v16, s[16:19], s52 offen offset:1024 sc1
    v_mfma_f32_16x16x32_bf16 v[116:119], v[236:239], a[124:127], v[116:119]
    buffer_load_dwordx4 v[88:91], v16, s[16:19], s52 offen offset:2048 sc1
    v_mfma_f32_16x16x32_bf16 v[120:123], v[236:239], a[248:251], v[120:123]
    buffer_load_dwordx4 v[92:95], v16, s[16:19], s52 offen offset:3072 sc1
    v_mfma_f32_16x16x32_bf16 v[124:127], v[236:239], a[252:255], v[124:127]
    s_waitcnt lgkmcnt(0)
    v_mfma_f32_16x16x32_bf16 v[128:131], v[208:211], a[0:3], v[128:131]
    ds_read_b64_tr_b16 v[240:241], v17 offset:36992
    ds_read_b64_tr_b16 v[242:243], v17 offset:41600
    v_mfma_f32_16x16x32_bf16 v[132:135], v[208:211], a[4:7], v[132:135]
    v_mfma_f32_16x16x32_bf16 v[136:139], v[208:211], a[128:131], v[136:139]
    ds_read_b64_tr_b16 v[244:245], v18 offset:36992
    ds_read_b64_tr_b16 v[246:247], v18 offset:41600
    v_mfma_f32_16x16x32_bf16 v[140:143], v[208:211], a[132:135], v[140:143]
    v_mfma_f32_16x16x32_bf16 v[144:147], v[212:215], a[0:3], v[144:147]
    v_mfma_f32_16x16x32_bf16 v[148:151], v[212:215], a[4:7], v[148:151]
    v_cvt_pk_bf16_f32 v96, v96, v97
    v_cvt_pk_bf16_f32 v97, v98, v99
    v_mfma_f32_16x16x32_bf16 v[152:155], v[212:215], a[128:131], v[152:155]
    v_cvt_pk_bf16_f32 v98, v100, v101
    v_cvt_pk_bf16_f32 v99, v102, v103
    v_mfma_f32_16x16x32_bf16 v[156:159], v[212:215], a[132:135], v[156:159]
    s_waitcnt lgkmcnt(0)
    v_mfma_f32_16x16x32_bf16 v[128:131], v[240:243], a[8:11], v[128:131]
    ds_read_b64_tr_b16 v[208:209], v17 offset:46208
    ds_read_b64_tr_b16 v[210:211], v17 offset:50816
    v_mfma_f32_16x16x32_bf16 v[132:135], v[240:243], a[12:15], v[132:135]
    buffer_store_dwordx4 v[96:99], v16, s[16:19], s46 offen offset:0 sc1
    v_mfma_f32_16x16x32_bf16 v[136:139], v[240:243], a[136:139], v[136:139]
    ds_read_b64_tr_b16 v[212:213], v18 offset:46208
    ds_read_b64_tr_b16 v[214:215], v18 offset:50816
    v_mfma_f32_16x16x32_bf16 v[140:143], v[240:243], a[140:143], v[140:143]
    v_cvt_pk_bf16_f32 v100, v104, v105
    v_cvt_pk_bf16_f32 v101, v106, v107
    v_mfma_f32_16x16x32_bf16 v[144:147], v[244:247], a[8:11], v[144:147]
    v_cvt_pk_bf16_f32 v102, v108, v109
    v_cvt_pk_bf16_f32 v103, v110, v111
    v_mfma_f32_16x16x32_bf16 v[148:151], v[244:247], a[12:15], v[148:151]
    buffer_store_dwordx4 v[100:103], v16, s[16:19], s46 offen offset:1024 sc1
    v_mfma_f32_16x16x32_bf16 v[152:155], v[244:247], a[136:139], v[152:155]
    v_cvt_pk_bf16_f32 v104, v112, v113
    v_cvt_pk_bf16_f32 v105, v114, v115
    v_mfma_f32_16x16x32_bf16 v[156:159], v[244:247], a[140:143], v[156:159]
    s_waitcnt lgkmcnt(0)
    v_cvt_pk_bf16_f32 v106, v116, v117
    v_cvt_pk_bf16_f32 v107, v118, v119
    v_mfma_f32_16x16x32_bf16 v[128:131], v[208:211], a[16:19], v[128:131]
    ds_read_b64_tr_b16 v[240:241], v17 offset:55424
    ds_read_b64_tr_b16 v[242:243], v17 offset:60032
    v_mfma_f32_16x16x32_bf16 v[132:135], v[208:211], a[20:23], v[132:135]
    buffer_store_dwordx4 v[104:107], v16, s[16:19], s46 offen offset:2048 sc1
    v_mfma_f32_16x16x32_bf16 v[136:139], v[208:211], a[144:147], v[136:139]
    ds_read_b64_tr_b16 v[244:245], v18 offset:55424
    ds_read_b64_tr_b16 v[246:247], v18 offset:60032
    v_mfma_f32_16x16x32_bf16 v[140:143], v[208:211], a[148:151], v[140:143]
    v_cvt_pk_bf16_f32 v108, v120, v121
    v_cvt_pk_bf16_f32 v109, v122, v123
    v_mfma_f32_16x16x32_bf16 v[144:147], v[212:215], a[16:19], v[144:147]
    v_cvt_pk_bf16_f32 v110, v124, v125
    v_cvt_pk_bf16_f32 v111, v126, v127
    v_mfma_f32_16x16x32_bf16 v[148:151], v[212:215], a[20:23], v[148:151]
    buffer_store_dwordx4 v[108:111], v16, s[16:19], s46 offen offset:3072 sc1
    v_mfma_f32_16x16x32_bf16 v[152:155], v[212:215], a[144:147], v[152:155]
    s_add_u32 s46, s46, 4096
    v_mfma_f32_16x16x32_bf16 v[156:159], v[212:215], a[148:151], v[156:159]
    s_waitcnt lgkmcnt(0)
    v_mfma_f32_16x16x32_bf16 v[128:131], v[240:243], a[24:27], v[128:131]
    v_add_u32 v17, 64512, v17
    v_add_u32 v18, 64512, v18
    v_mfma_f32_16x16x32_bf16 v[132:135], v[240:243], a[28:31], v[132:135]
    v_add_u32 v19, 64512, v19
    v_add_u32 v20, 64512, v20
    v_mfma_f32_16x16x32_bf16 v[136:139], v[240:243], a[152:155], v[136:139]
    ds_read_b64_tr_b16 v[208:209], v17 offset:128
    ds_read_b64_tr_b16 v[210:211], v17 offset:4736
    v_mfma_f32_16x16x32_bf16 v[140:143], v[240:243], a[156:159], v[140:143]
    ds_read_b64_tr_b16 v[212:213], v18 offset:128
    ds_read_b64_tr_b16 v[214:215], v18 offset:4736
    v_mfma_f32_16x16x32_bf16 v[144:147], v[244:247], a[24:27], v[144:147]
    v_mfma_f32_16x16x32_bf16 v[148:151], v[244:247], a[28:31], v[148:151]
    v_mfma_f32_16x16x32_bf16 v[152:155], v[244:247], a[152:155], v[152:155]
    v_mfma_f32_16x16x32_bf16 v[156:159], v[244:247], a[156:159], v[156:159]
    s_waitcnt lgkmcnt(0)
    v_mfma_f32_16x16x32_bf16 v[128:131], v[208:211], a[32:35], v[128:131]
    ds_read_b64_tr_b16 v[240:241], v17 offset:9344
    ds_read_b64_tr_b16 v[242:243], v17 offset:13952
    v_mfma_f32_16x16x32_bf16 v[132:135], v[208:211], a[36:39], v[132:135]
    v_mfma_f32_16x16x32_bf16 v[136:139], v[208:211], a[160:163], v[136:139]
    ds_read_b64_tr_b16 v[244:245], v18 offset:9344
    ds_read_b64_tr_b16 v[246:247], v18 offset:13952
    v_mfma_f32_16x16x32_bf16 v[140:143], v[208:211], a[164:167], v[140:143]
    v_mfma_f32_16x16x32_bf16 v[144:147], v[212:215], a[32:35], v[144:147]
    v_mfma_f32_16x16x32_bf16 v[148:151], v[212:215], a[36:39], v[148:151]
    v_mfma_f32_16x16x32_bf16 v[152:155], v[212:215], a[160:163], v[152:155]
    v_mfma_f32_16x16x32_bf16 v[156:159], v[212:215], a[164:167], v[156:159]
    s_waitcnt lgkmcnt(0)
    v_mfma_f32_16x16x32_bf16 v[128:131], v[240:243], a[40:43], v[128:131]
    v_add_u32 v17, 4294838272, v17
    v_add_u32 v18, 4294838272, v18
    v_mfma_f32_16x16x32_bf16 v[132:135], v[240:243], a[44:47], v[132:135]
    v_add_u32 v19, 4294838272, v19
    v_add_u32 v20, 4294838272, v20
    v_mfma_f32_16x16x32_bf16 v[136:139], v[240:243], a[168:171], v[136:139]
    ds_read_b64_tr_b16 v[208:209], v17 offset:128
    ds_read_b64_tr_b16 v[210:211], v17 offset:4736
    v_mfma_f32_16x16x32_bf16 v[140:143], v[240:243], a[172:175], v[140:143]
    ds_read_b64_tr_b16 v[212:213], v18 offset:128
    ds_read_b64_tr_b16 v[214:215], v18 offset:4736
    v_mfma_f32_16x16x32_bf16 v[144:147], v[244:247], a[40:43], v[144:147]
gated_mix__ssm_conv_h3__compressed_kv_cla__prompt_kernel_pad15:
    s_cbranch_execz gated_mix__ssm_conv_h3__compressed_kv_cla__prompt_kernel_pad19
    s_waitcnt vmcnt(4)
    v_max3_u32 v15, v80, v81, v82
    v_max3_u32 v15, v15, v83, v84
    v_mfma_f32_16x16x32_bf16 v[148:151], v[244:247], a[44:47], v[148:151]
    v_max3_u32 v15, v15, v85, v86
    v_max3_u32 v15, v15, v87, v88
    v_mfma_f32_16x16x32_bf16 v[152:155], v[244:247], a[168:171], v[152:155]
    v_max3_u32 v15, v15, v89, v90
    v_max3_u32 v15, v15, v91, v92
    v_mfma_f32_16x16x32_bf16 v[156:159], v[244:247], a[172:175], v[156:159]
    s_waitcnt lgkmcnt(0)
    v_max3_u32 v15, v15, v93, v94
    v_max_u32 v15, v15, v95
    v_mfma_f32_16x16x32_bf16 v[128:131], v[208:211], a[48:51], v[128:131]
    ds_read_b64_tr_b16 v[240:241], v17 offset:9344
    ds_read_b64_tr_b16 v[242:243], v17 offset:13952
    v_mfma_f32_16x16x32_bf16 v[132:135], v[208:211], a[52:55], v[132:135]
    v_cmp_eq_u32 vcc, -1, v15
    v_mfma_f32_16x16x32_bf16 v[136:139], v[208:211], a[176:179], v[136:139]
    ds_read_b64_tr_b16 v[244:245], v18 offset:9344
    ds_read_b64_tr_b16 v[246:247], v18 offset:13952
    v_mfma_f32_16x16x32_bf16 v[140:143], v[208:211], a[180:183], v[140:143]
    v_mfma_f32_16x16x32_bf16 v[144:147], v[212:215], a[48:51], v[144:147]
    s_cbranch_vccnz gated_mix__ssm_conv_h3__compressed_kv_cla__prompt_kernel_spin_x3
gated_mix__ssm_conv_h3__compressed_kv_cla__prompt_kernel_spin_x3_ret:
    v_lshlrev_b32 v3, 16, v80
    v_fmac_f32 v40, v6, v3
    v_mfma_f32_16x16x32_bf16 v[148:151], v[212:215], a[52:55], v[148:151]
    v_and_b32 v4, s37, v80
    v_fmac_f32 v41, v6, v4
    v_mfma_f32_16x16x32_bf16 v[152:155], v[212:215], a[176:179], v[152:155]
    v_lshlrev_b32 v3, 16, v81
    v_fmac_f32 v42, v6, v3
    v_mfma_f32_16x16x32_bf16 v[156:159], v[212:215], a[180:183], v[156:159]
    s_waitcnt lgkmcnt(0)
    v_and_b32 v4, s37, v81
    v_fmac_f32 v43, v6, v4
    v_mfma_f32_16x16x32_bf16 v[128:131], v[240:243], a[56:59], v[128:131]
    ds_read_b64_tr_b16 v[208:209], v17 offset:18560
    ds_read_b64_tr_b16 v[210:211], v17 offset:23168
    v_mfma_f32_16x16x32_bf16 v[132:135], v[240:243], a[60:63], v[132:135]
    v_lshlrev_b32 v3, 16, v82
    v_fmac_f32 v44, v7, v3
    v_mfma_f32_16x16x32_bf16 v[136:139], v[240:243], a[184:187], v[136:139]
    ds_read_b64_tr_b16 v[212:213], v18 offset:18560
    ds_read_b64_tr_b16 v[214:215], v18 offset:23168
    v_mfma_f32_16x16x32_bf16 v[140:143], v[240:243], a[188:191], v[140:143]
    v_and_b32 v4, s37, v82
    v_fmac_f32 v45, v7, v4
    v_mfma_f32_16x16x32_bf16 v[144:147], v[244:247], a[56:59], v[144:147]
    v_lshlrev_b32 v3, 16, v83
    v_fmac_f32 v46, v7, v3
    v_mfma_f32_16x16x32_bf16 v[148:151], v[244:247], a[60:63], v[148:151]
    v_and_b32 v4, s37, v83
    v_fmac_f32 v47, v7, v4
    v_mfma_f32_16x16x32_bf16 v[152:155], v[244:247], a[184:187], v[152:155]
    v_lshlrev_b32 v3, 16, v84
    v_fmac_f32 v48, v11, v3
    v_mfma_f32_16x16x32_bf16 v[156:159], v[244:247], a[188:191], v[156:159]
    s_waitcnt lgkmcnt(0)
    v_and_b32 v4, s37, v84
    v_fmac_f32 v49, v11, v4
    v_mfma_f32_16x16x32_bf16 v[128:131], v[208:211], a[64:67], v[128:131]
    ds_read_b64_tr_b16 v[240:241], v17 offset:27776
    ds_read_b64_tr_b16 v[242:243], v17 offset:32384
    v_mfma_f32_16x16x32_bf16 v[132:135], v[208:211], a[68:71], v[132:135]
    v_lshlrev_b32 v3, 16, v85
    v_fmac_f32 v50, v11, v3
    v_mfma_f32_16x16x32_bf16 v[136:139], v[208:211], a[192:195], v[136:139]
    ds_read_b64_tr_b16 v[244:245], v18 offset:27776
    ds_read_b64_tr_b16 v[246:247], v18 offset:32384
    v_mfma_f32_16x16x32_bf16 v[140:143], v[208:211], a[196:199], v[140:143]
    v_and_b32 v4, s37, v85
    v_fmac_f32 v51, v11, v4
    v_mfma_f32_16x16x32_bf16 v[144:147], v[212:215], a[64:67], v[144:147]
    v_lshlrev_b32 v3, 16, v86
    v_fmac_f32 v52, v12, v3
    v_mfma_f32_16x16x32_bf16 v[148:151], v[212:215], a[68:71], v[148:151]
    v_and_b32 v4, s37, v86
    v_fmac_f32 v53, v12, v4
    v_mfma_f32_16x16x32_bf16 v[152:155], v[212:215], a[192:195], v[152:155]
    v_lshlrev_b32 v3, 16, v87
    v_fmac_f32 v54, v12, v3
    v_mfma_f32_16x16x32_bf16 v[156:159], v[212:215], a[196:199], v[156:159]
    s_waitcnt lgkmcnt(0)
    v_and_b32 v4, s37, v87
    v_fmac_f32 v55, v12, v4
    v_mfma_f32_16x16x32_bf16 v[128:131], v[240:243], a[72:75], v[128:131]
    ds_read_b64_tr_b16 v[208:209], v17 offset:36992
    ds_read_b64_tr_b16 v[210:211], v17 offset:41600
    v_mfma_f32_16x16x32_bf16 v[132:135], v[240:243], a[76:79], v[132:135]
    v_lshlrev_b32 v3, 16, v88
    v_fmac_f32 v24, v6, v3
    v_mfma_f32_16x16x32_bf16 v[136:139], v[240:243], a[200:203], v[136:139]
    ds_read_b64_tr_b16 v[212:213], v18 offset:36992
    ds_read_b64_tr_b16 v[214:215], v18 offset:41600
    v_mfma_f32_16x16x32_bf16 v[140:143], v[240:243], a[204:207], v[140:143]
    v_and_b32 v4, s37, v88
    v_fmac_f32 v25, v6, v4
    v_mfma_f32_16x16x32_bf16 v[144:147], v[244:247], a[72:75], v[144:147]
    v_lshlrev_b32 v3, 16, v89
    v_fmac_f32 v28, v6, v3
    v_mfma_f32_16x16x32_bf16 v[148:151], v[244:247], a[76:79], v[148:151]
    v_and_b32 v4, s37, v89
    v_fmac_f32 v29, v6, v4
    v_mfma_f32_16x16x32_bf16 v[152:155], v[244:247], a[200:203], v[152:155]
    v_lshlrev_b32 v3, 16, v90
    v_fmac_f32 v32, v7, v3
    v_mfma_f32_16x16x32_bf16 v[156:159], v[244:247], a[204:207], v[156:159]
    s_waitcnt lgkmcnt(0)
    v_and_b32 v4, s37, v90
    v_fmac_f32 v33, v7, v4
    v_mfma_f32_16x16x32_bf16 v[128:131], v[208:211], a[80:83], v[128:131]
    ds_read_b64_tr_b16 v[240:241], v17 offset:46208
    ds_read_b64_tr_b16 v[242:243], v17 offset:50816
    v_mfma_f32_16x16x32_bf16 v[132:135], v[208:211], a[84:87], v[132:135]
    v_lshlrev_b32 v3, 16, v91
    v_fmac_f32 v36, v7, v3
    v_mfma_f32_16x16x32_bf16 v[136:139], v[208:211], a[208:211], v[136:139]
    ds_read_b64_tr_b16 v[244:245], v18 offset:46208
    ds_read_b64_tr_b16 v[246:247], v18 offset:50816
    v_mfma_f32_16x16x32_bf16 v[140:143], v[208:211], a[212:215], v[140:143]
    v_and_b32 v4, s37, v91
    v_fmac_f32 v37, v7, v4
    v_mfma_f32_16x16x32_bf16 v[144:147], v[212:215], a[80:83], v[144:147]
    v_lshlrev_b32 v3, 16, v92
    v_fmac_f32 v56, v11, v3
    v_mfma_f32_16x16x32_bf16 v[148:151], v[212:215], a[84:87], v[148:151]
    v_and_b32 v4, s37, v92
    v_fmac_f32 v57, v11, v4
    v_mfma_f32_16x16x32_bf16 v[152:155], v[212:215], a[208:211], v[152:155]
    v_lshlrev_b32 v3, 16, v93
    v_fmac_f32 v58, v11, v3
    v_mfma_f32_16x16x32_bf16 v[156:159], v[212:215], a[212:215], v[156:159]
    s_waitcnt lgkmcnt(0)
    v_and_b32 v4, s37, v93
    v_fmac_f32 v59, v11, v4
    v_mfma_f32_16x16x32_bf16 v[128:131], v[240:243], a[88:91], v[128:131]
    ds_read_b64_tr_b16 v[208:209], v17 offset:55424
    ds_read_b64_tr_b16 v[210:211], v17 offset:60032
    v_mfma_f32_16x16x32_bf16 v[132:135], v[240:243], a[92:95], v[132:135]
    v_lshlrev_b32 v3, 16, v94
    v_fmac_f32 v26, v12, v3
    v_mfma_f32_16x16x32_bf16 v[136:139], v[240:243], a[216:219], v[136:139]
    ds_read_b64_tr_b16 v[212:213], v18 offset:55424
    ds_read_b64_tr_b16 v[214:215], v18 offset:60032
    v_mfma_f32_16x16x32_bf16 v[140:143], v[240:243], a[220:223], v[140:143]
    v_and_b32 v4, s37, v94
    v_fmac_f32 v27, v12, v4
    v_mfma_f32_16x16x32_bf16 v[144:147], v[244:247], a[88:91], v[144:147]
    v_lshlrev_b32 v3, 16, v95
    v_fmac_f32 v30, v12, v3
    v_mfma_f32_16x16x32_bf16 v[148:151], v[244:247], a[92:95], v[148:151]
    v_and_b32 v4, s37, v95
    v_fmac_f32 v31, v12, v4
    v_mfma_f32_16x16x32_bf16 v[152:155], v[244:247], a[216:219], v[152:155]
    v_mfma_f32_16x16x32_bf16 v[156:159], v[244:247], a[220:223], v[156:159]
    s_waitcnt lgkmcnt(0)
    v_mfma_f32_16x16x32_bf16 v[128:131], v[208:211], a[96:99], v[128:131]
    v_add_u32 v17, 64512, v17
    v_add_u32 v18, 64512, v18
    v_mfma_f32_16x16x32_bf16 v[132:135], v[208:211], a[100:103], v[132:135]
    v_add_u32 v19, 64512, v19
    v_add_u32 v20, 64512, v20
    v_mfma_f32_16x16x32_bf16 v[136:139], v[208:211], a[224:227], v[136:139]
    ds_read_b64_tr_b16 v[240:241], v17 offset:128
    ds_read_b64_tr_b16 v[242:243], v17 offset:4736
    v_mfma_f32_16x16x32_bf16 v[140:143], v[208:211], a[228:231], v[140:143]
    ds_read_b64_tr_b16 v[244:245], v18 offset:128
    ds_read_b64_tr_b16 v[246:247], v18 offset:4736
    v_mfma_f32_16x16x32_bf16 v[144:147], v[212:215], a[96:99], v[144:147]
    v_mfma_f32_16x16x32_bf16 v[148:151], v[212:215], a[100:103], v[148:151]
    v_mfma_f32_16x16x32_bf16 v[152:155], v[212:215], a[224:227], v[152:155]
    v_mfma_f32_16x16x32_bf16 v[156:159], v[212:215], a[228:231], v[156:159]
    s_waitcnt lgkmcnt(0)
    v_mfma_f32_16x16x32_bf16 v[128:131], v[240:243], a[104:107], v[128:131]
    ds_read_b64_tr_b16 v[208:209], v17 offset:9344
    ds_read_b64_tr_b16 v[210:211], v17 offset:13952
    v_mfma_f32_16x16x32_bf16 v[132:135], v[240:243], a[108:111], v[132:135]
    v_mfma_f32_16x16x32_bf16 v[136:139], v[240:243], a[232:235], v[136:139]
    ds_read_b64_tr_b16 v[212:213], v18 offset:9344
    ds_read_b64_tr_b16 v[214:215], v18 offset:13952
    v_mfma_f32_16x16x32_bf16 v[140:143], v[240:243], a[236:239], v[140:143]
    v_mfma_f32_16x16x32_bf16 v[144:147], v[244:247], a[104:107], v[144:147]
    v_mfma_f32_16x16x32_bf16 v[148:151], v[244:247], a[108:111], v[148:151]
    v_mfma_f32_16x16x32_bf16 v[152:155], v[244:247], a[232:235], v[152:155]
    v_mfma_f32_16x16x32_bf16 v[156:159], v[244:247], a[236:239], v[156:159]
    s_waitcnt lgkmcnt(0)
    v_mfma_f32_16x16x32_bf16 v[128:131], v[208:211], a[112:115], v[128:131]
    ds_read_b64_tr_b16 v[240:241], v17 offset:18560
    ds_read_b64_tr_b16 v[242:243], v17 offset:23168
    v_mfma_f32_16x16x32_bf16 v[132:135], v[208:211], a[116:119], v[132:135]
    v_mfma_f32_16x16x32_bf16 v[136:139], v[208:211], a[240:243], v[136:139]
    ds_read_b64_tr_b16 v[244:245], v18 offset:18560
    ds_read_b64_tr_b16 v[246:247], v18 offset:23168
    v_mfma_f32_16x16x32_bf16 v[140:143], v[208:211], a[244:247], v[140:143]
    v_mfma_f32_16x16x32_bf16 v[144:147], v[212:215], a[112:115], v[144:147]
    v_mfma_f32_16x16x32_bf16 v[148:151], v[212:215], a[116:119], v[148:151]
    v_mfma_f32_16x16x32_bf16 v[152:155], v[212:215], a[240:243], v[152:155]
    v_mfma_f32_16x16x32_bf16 v[156:159], v[212:215], a[244:247], v[156:159]
    s_waitcnt lgkmcnt(0)
    v_mfma_f32_16x16x32_bf16 v[128:131], v[240:243], a[120:123], v[128:131]
    v_mfma_f32_16x16x32_bf16 v[132:135], v[240:243], a[124:127], v[132:135]
    s_lshl_b32 s42, s44, 2
    s_xor_b32 s42, s42, 131072
    v_mfma_f32_16x16x32_bf16 v[136:139], v[240:243], a[248:251], v[136:139]
    v_mfma_f32_16x16x32_bf16 v[140:143], v[240:243], a[252:255], v[140:143]
    s_add_u32 s42, s42, 4096
    buffer_load_dwordx4 v[64:67], v16, s[16:19], s42 offen offset:0 sc1
    v_mfma_f32_16x16x32_bf16 v[144:147], v[244:247], a[120:123], v[144:147]
    buffer_load_dwordx4 v[68:71], v16, s[16:19], s42 offen offset:1024 sc1
    v_mfma_f32_16x16x32_bf16 v[148:151], v[244:247], a[124:127], v[148:151]
    buffer_load_dwordx4 v[72:75], v16, s[16:19], s42 offen offset:2048 sc1
    v_mfma_f32_16x16x32_bf16 v[152:155], v[244:247], a[248:251], v[152:155]
    buffer_load_dwordx4 v[76:79], v16, s[16:19], s42 offen offset:3072 sc1
    v_mfma_f32_16x16x32_bf16 v[156:159], v[244:247], a[252:255], v[156:159]
    s_waitcnt lgkmcnt(0)
    v_mfma_f32_16x16x32_bf16 v[160:163], v[216:219], a[0:3], v[160:163]
    ds_read_b64_tr_b16 v[248:249], v19 offset:36992
    ds_read_b64_tr_b16 v[250:251], v19 offset:41600
    v_mfma_f32_16x16x32_bf16 v[164:167], v[216:219], a[4:7], v[164:167]
    v_mfma_f32_16x16x32_bf16 v[168:171], v[216:219], a[128:131], v[168:171]
    ds_read_b64_tr_b16 v[252:253], v20 offset:36992
    ds_read_b64_tr_b16 v[254:255], v20 offset:41600
    v_mfma_f32_16x16x32_bf16 v[172:175], v[216:219], a[132:135], v[172:175]
    v_mfma_f32_16x16x32_bf16 v[176:179], v[220:223], a[0:3], v[176:179]
    v_mfma_f32_16x16x32_bf16 v[180:183], v[220:223], a[4:7], v[180:183]
    v_cvt_pk_bf16_f32 v128, v128, v129
    v_cvt_pk_bf16_f32 v129, v130, v131
    v_mfma_f32_16x16x32_bf16 v[184:187], v[220:223], a[128:131], v[184:187]
    v_cvt_pk_bf16_f32 v130, v132, v133
    v_cvt_pk_bf16_f32 v131, v134, v135
    v_mfma_f32_16x16x32_bf16 v[188:191], v[220:223], a[132:135], v[188:191]
    s_waitcnt lgkmcnt(0)
    v_mfma_f32_16x16x32_bf16 v[160:163], v[248:251], a[8:11], v[160:163]
    ds_read_b64_tr_b16 v[216:217], v19 offset:46208
    ds_read_b64_tr_b16 v[218:219], v19 offset:50816
    v_mfma_f32_16x16x32_bf16 v[164:167], v[248:251], a[12:15], v[164:167]
    buffer_store_dwordx4 v[128:131], v16, s[16:19], s46 offen offset:0 sc1
    v_mfma_f32_16x16x32_bf16 v[168:171], v[248:251], a[136:139], v[168:171]
    ds_read_b64_tr_b16 v[220:221], v20 offset:46208
    ds_read_b64_tr_b16 v[222:223], v20 offset:50816
    v_mfma_f32_16x16x32_bf16 v[172:175], v[248:251], a[140:143], v[172:175]
    v_cvt_pk_bf16_f32 v132, v136, v137
    v_cvt_pk_bf16_f32 v133, v138, v139
    v_mfma_f32_16x16x32_bf16 v[176:179], v[252:255], a[8:11], v[176:179]
    v_cvt_pk_bf16_f32 v134, v140, v141
    v_cvt_pk_bf16_f32 v135, v142, v143
    v_mfma_f32_16x16x32_bf16 v[180:183], v[252:255], a[12:15], v[180:183]
    buffer_store_dwordx4 v[132:135], v16, s[16:19], s46 offen offset:1024 sc1
    v_mfma_f32_16x16x32_bf16 v[184:187], v[252:255], a[136:139], v[184:187]
    v_cvt_pk_bf16_f32 v136, v144, v145
    v_cvt_pk_bf16_f32 v137, v146, v147
    v_mfma_f32_16x16x32_bf16 v[188:191], v[252:255], a[140:143], v[188:191]
    s_waitcnt lgkmcnt(0)
    v_cvt_pk_bf16_f32 v138, v148, v149
    v_cvt_pk_bf16_f32 v139, v150, v151
    v_mfma_f32_16x16x32_bf16 v[160:163], v[216:219], a[16:19], v[160:163]
    ds_read_b64_tr_b16 v[248:249], v19 offset:55424
    ds_read_b64_tr_b16 v[250:251], v19 offset:60032
    v_mfma_f32_16x16x32_bf16 v[164:167], v[216:219], a[20:23], v[164:167]
    buffer_store_dwordx4 v[136:139], v16, s[16:19], s46 offen offset:2048 sc1
    v_mfma_f32_16x16x32_bf16 v[168:171], v[216:219], a[144:147], v[168:171]
    ds_read_b64_tr_b16 v[252:253], v20 offset:55424
    ds_read_b64_tr_b16 v[254:255], v20 offset:60032
    v_mfma_f32_16x16x32_bf16 v[172:175], v[216:219], a[148:151], v[172:175]
    v_cvt_pk_bf16_f32 v140, v152, v153
    v_cvt_pk_bf16_f32 v141, v154, v155
    v_mfma_f32_16x16x32_bf16 v[176:179], v[220:223], a[16:19], v[176:179]
    v_cvt_pk_bf16_f32 v142, v156, v157
    v_cvt_pk_bf16_f32 v143, v158, v159
    v_mfma_f32_16x16x32_bf16 v[180:183], v[220:223], a[20:23], v[180:183]
    buffer_store_dwordx4 v[140:143], v16, s[16:19], s46 offen offset:3072 sc1
    v_mfma_f32_16x16x32_bf16 v[184:187], v[220:223], a[144:147], v[184:187]
    s_add_u32 s46, s46, 4096
    v_mfma_f32_16x16x32_bf16 v[188:191], v[220:223], a[148:151], v[188:191]
    s_waitcnt lgkmcnt(0)
    v_mfma_f32_16x16x32_bf16 v[160:163], v[248:251], a[24:27], v[160:163]
    v_add_u32 v17, 64512, v17
    v_add_u32 v18, 64512, v18
    v_mfma_f32_16x16x32_bf16 v[164:167], v[248:251], a[28:31], v[164:167]
    v_add_u32 v19, 64512, v19
    v_add_u32 v20, 64512, v20
    v_mfma_f32_16x16x32_bf16 v[168:171], v[248:251], a[152:155], v[168:171]
    ds_read_b64_tr_b16 v[216:217], v19 offset:128
    ds_read_b64_tr_b16 v[218:219], v19 offset:4736
    v_mfma_f32_16x16x32_bf16 v[172:175], v[248:251], a[156:159], v[172:175]
    ds_read_b64_tr_b16 v[220:221], v20 offset:128
    ds_read_b64_tr_b16 v[222:223], v20 offset:4736
    v_mfma_f32_16x16x32_bf16 v[176:179], v[252:255], a[24:27], v[176:179]
    v_mfma_f32_16x16x32_bf16 v[180:183], v[252:255], a[28:31], v[180:183]
    v_mfma_f32_16x16x32_bf16 v[184:187], v[252:255], a[152:155], v[184:187]
    v_mfma_f32_16x16x32_bf16 v[188:191], v[252:255], a[156:159], v[188:191]
    s_waitcnt lgkmcnt(0)
    v_mfma_f32_16x16x32_bf16 v[160:163], v[216:219], a[32:35], v[160:163]
    ds_read_b64_tr_b16 v[248:249], v19 offset:9344
    ds_read_b64_tr_b16 v[250:251], v19 offset:13952
    v_mfma_f32_16x16x32_bf16 v[164:167], v[216:219], a[36:39], v[164:167]
    v_mfma_f32_16x16x32_bf16 v[168:171], v[216:219], a[160:163], v[168:171]
    ds_read_b64_tr_b16 v[252:253], v20 offset:9344
    ds_read_b64_tr_b16 v[254:255], v20 offset:13952
    v_mfma_f32_16x16x32_bf16 v[172:175], v[216:219], a[164:167], v[172:175]
    v_mfma_f32_16x16x32_bf16 v[176:179], v[220:223], a[32:35], v[176:179]
    v_mfma_f32_16x16x32_bf16 v[180:183], v[220:223], a[36:39], v[180:183]
    v_mfma_f32_16x16x32_bf16 v[184:187], v[220:223], a[160:163], v[184:187]
    v_mfma_f32_16x16x32_bf16 v[188:191], v[220:223], a[164:167], v[188:191]
    s_waitcnt lgkmcnt(0)
    v_mfma_f32_16x16x32_bf16 v[160:163], v[248:251], a[40:43], v[160:163]
    v_add_u32 v17, 4294838272, v17
    v_add_u32 v18, 4294838272, v18
    v_mfma_f32_16x16x32_bf16 v[164:167], v[248:251], a[44:47], v[164:167]
    v_add_u32 v19, 4294838272, v19
    v_add_u32 v20, 4294838272, v20
    v_mfma_f32_16x16x32_bf16 v[168:171], v[248:251], a[168:171], v[168:171]
    ds_read_b64_tr_b16 v[216:217], v19 offset:128
    ds_read_b64_tr_b16 v[218:219], v19 offset:4736
    v_mfma_f32_16x16x32_bf16 v[172:175], v[248:251], a[172:175], v[172:175]
    ds_read_b64_tr_b16 v[220:221], v20 offset:128
    ds_read_b64_tr_b16 v[222:223], v20 offset:4736
    v_mfma_f32_16x16x32_bf16 v[176:179], v[252:255], a[40:43], v[176:179]
    s_waitcnt vmcnt(4)
    v_max3_u32 v15, v64, v65, v66
    v_max3_u32 v15, v15, v67, v68
    v_mfma_f32_16x16x32_bf16 v[180:183], v[252:255], a[44:47], v[180:183]
    v_max3_u32 v15, v15, v69, v70
    v_max3_u32 v15, v15, v71, v72
    v_mfma_f32_16x16x32_bf16 v[184:187], v[252:255], a[168:171], v[184:187]
    v_max3_u32 v15, v15, v73, v74
    v_max3_u32 v15, v15, v75, v76
    v_mfma_f32_16x16x32_bf16 v[188:191], v[252:255], a[172:175], v[188:191]
    s_waitcnt lgkmcnt(0)
    v_max3_u32 v15, v15, v77, v78
    v_max_u32 v15, v15, v79
    v_mfma_f32_16x16x32_bf16 v[160:163], v[216:219], a[48:51], v[160:163]
    ds_read_b64_tr_b16 v[248:249], v19 offset:9344
    ds_read_b64_tr_b16 v[250:251], v19 offset:13952
    v_mfma_f32_16x16x32_bf16 v[164:167], v[216:219], a[52:55], v[164:167]
    v_cmp_eq_u32 vcc, -1, v15
    v_mfma_f32_16x16x32_bf16 v[168:171], v[216:219], a[176:179], v[168:171]
    ds_read_b64_tr_b16 v[252:253], v20 offset:9344
    ds_read_b64_tr_b16 v[254:255], v20 offset:13952
    v_mfma_f32_16x16x32_bf16 v[172:175], v[216:219], a[180:183], v[172:175]
    v_mfma_f32_16x16x32_bf16 v[176:179], v[220:223], a[48:51], v[176:179]
    s_cbranch_vccnz gated_mix__ssm_conv_h3__compressed_kv_cla__prompt_kernel_spin_x2
gated_mix__ssm_conv_h3__compressed_kv_cla__prompt_kernel_spin_x2_ret:
    v_lshlrev_b32 v3, 16, v64
    v_fmac_f32 v40, v6, v3
    v_mfma_f32_16x16x32_bf16 v[180:183], v[220:223], a[52:55], v[180:183]
    v_and_b32 v4, s37, v64
    v_fmac_f32 v41, v6, v4
    v_mfma_f32_16x16x32_bf16 v[184:187], v[220:223], a[176:179], v[184:187]
    v_lshlrev_b32 v3, 16, v65
    v_fmac_f32 v42, v6, v3
    v_mfma_f32_16x16x32_bf16 v[188:191], v[220:223], a[180:183], v[188:191]
    s_waitcnt lgkmcnt(0)
    v_and_b32 v4, s37, v65
    v_fmac_f32 v43, v6, v4
    v_mfma_f32_16x16x32_bf16 v[160:163], v[248:251], a[56:59], v[160:163]
    ds_read_b64_tr_b16 v[216:217], v19 offset:18560
    ds_read_b64_tr_b16 v[218:219], v19 offset:23168
    v_mfma_f32_16x16x32_bf16 v[164:167], v[248:251], a[60:63], v[164:167]
    v_lshlrev_b32 v3, 16, v66
    v_fmac_f32 v44, v7, v3
    v_mfma_f32_16x16x32_bf16 v[168:171], v[248:251], a[184:187], v[168:171]
    ds_read_b64_tr_b16 v[220:221], v20 offset:18560
    ds_read_b64_tr_b16 v[222:223], v20 offset:23168
    v_mfma_f32_16x16x32_bf16 v[172:175], v[248:251], a[188:191], v[172:175]
    v_and_b32 v4, s37, v66
    v_fmac_f32 v45, v7, v4
    v_mfma_f32_16x16x32_bf16 v[176:179], v[252:255], a[56:59], v[176:179]
    v_lshlrev_b32 v3, 16, v67
    v_fmac_f32 v46, v7, v3
    v_mfma_f32_16x16x32_bf16 v[180:183], v[252:255], a[60:63], v[180:183]
    v_and_b32 v4, s37, v67
    v_fmac_f32 v47, v7, v4
    v_mfma_f32_16x16x32_bf16 v[184:187], v[252:255], a[184:187], v[184:187]
    v_lshlrev_b32 v3, 16, v68
    v_fmac_f32 v48, v11, v3
    v_mfma_f32_16x16x32_bf16 v[188:191], v[252:255], a[188:191], v[188:191]
    s_waitcnt lgkmcnt(0)
    v_and_b32 v4, s37, v68
    v_fmac_f32 v49, v11, v4
    v_mfma_f32_16x16x32_bf16 v[160:163], v[216:219], a[64:67], v[160:163]
    ds_read_b64_tr_b16 v[248:249], v19 offset:27776
    ds_read_b64_tr_b16 v[250:251], v19 offset:32384
    v_mfma_f32_16x16x32_bf16 v[164:167], v[216:219], a[68:71], v[164:167]
    v_lshlrev_b32 v3, 16, v69
    v_fmac_f32 v50, v11, v3
    v_mfma_f32_16x16x32_bf16 v[168:171], v[216:219], a[192:195], v[168:171]
    ds_read_b64_tr_b16 v[252:253], v20 offset:27776
    ds_read_b64_tr_b16 v[254:255], v20 offset:32384
    v_mfma_f32_16x16x32_bf16 v[172:175], v[216:219], a[196:199], v[172:175]
    v_and_b32 v4, s37, v69
    v_fmac_f32 v51, v11, v4
    v_mfma_f32_16x16x32_bf16 v[176:179], v[220:223], a[64:67], v[176:179]
    v_lshlrev_b32 v3, 16, v70
    v_fmac_f32 v52, v12, v3
    v_mfma_f32_16x16x32_bf16 v[180:183], v[220:223], a[68:71], v[180:183]
    v_and_b32 v4, s37, v70
    v_fmac_f32 v53, v12, v4
    v_mfma_f32_16x16x32_bf16 v[184:187], v[220:223], a[192:195], v[184:187]
    v_lshlrev_b32 v3, 16, v71
    v_fmac_f32 v54, v12, v3
    v_mfma_f32_16x16x32_bf16 v[188:191], v[220:223], a[196:199], v[188:191]
    s_waitcnt lgkmcnt(0)
    v_and_b32 v4, s37, v71
    v_fmac_f32 v55, v12, v4
    v_mfma_f32_16x16x32_bf16 v[160:163], v[248:251], a[72:75], v[160:163]
    ds_read_b64_tr_b16 v[216:217], v19 offset:36992
    ds_read_b64_tr_b16 v[218:219], v19 offset:41600
    v_mfma_f32_16x16x32_bf16 v[164:167], v[248:251], a[76:79], v[164:167]
    v_lshlrev_b32 v3, 16, v72
    v_fmac_f32 v24, v6, v3
    v_mfma_f32_16x16x32_bf16 v[168:171], v[248:251], a[200:203], v[168:171]
    ds_read_b64_tr_b16 v[220:221], v20 offset:36992
    ds_read_b64_tr_b16 v[222:223], v20 offset:41600
    v_mfma_f32_16x16x32_bf16 v[172:175], v[248:251], a[204:207], v[172:175]
    v_and_b32 v4, s37, v72
    v_fmac_f32 v25, v6, v4
    v_mfma_f32_16x16x32_bf16 v[176:179], v[252:255], a[72:75], v[176:179]
    v_lshlrev_b32 v3, 16, v73
    v_fmac_f32 v28, v6, v3
    v_mfma_f32_16x16x32_bf16 v[180:183], v[252:255], a[76:79], v[180:183]
    v_and_b32 v4, s37, v73
    v_fmac_f32 v29, v6, v4
    v_mfma_f32_16x16x32_bf16 v[184:187], v[252:255], a[200:203], v[184:187]
    v_lshlrev_b32 v3, 16, v74
    v_fmac_f32 v32, v7, v3
    v_mfma_f32_16x16x32_bf16 v[188:191], v[252:255], a[204:207], v[188:191]
    s_waitcnt lgkmcnt(0)
    v_and_b32 v4, s37, v74
    v_fmac_f32 v33, v7, v4
    v_mfma_f32_16x16x32_bf16 v[160:163], v[216:219], a[80:83], v[160:163]
    ds_read_b64_tr_b16 v[248:249], v19 offset:46208
    ds_read_b64_tr_b16 v[250:251], v19 offset:50816
    v_mfma_f32_16x16x32_bf16 v[164:167], v[216:219], a[84:87], v[164:167]
    s_lshl_b32 s41, s44, 2
    s_xor_b32 s41, s41, 65536
    v_mfma_f32_16x16x32_bf16 v[168:171], v[216:219], a[208:211], v[168:171]
    ds_read_b64_tr_b16 v[252:253], v20 offset:46208
    ds_read_b64_tr_b16 v[254:255], v20 offset:50816
    v_mfma_f32_16x16x32_bf16 v[172:175], v[216:219], a[212:215], v[172:175]
    s_add_u32 s41, s41, 8192
    buffer_load_dwordx4 v[96:99], v16, s[16:19], s41 offen offset:0 sc1
    v_mfma_f32_16x16x32_bf16 v[176:179], v[220:223], a[80:83], v[176:179]
    buffer_load_dwordx4 v[100:103], v16, s[16:19], s41 offen offset:1024 sc1
    v_mfma_f32_16x16x32_bf16 v[180:183], v[220:223], a[84:87], v[180:183]
    buffer_load_dwordx4 v[104:107], v16, s[16:19], s41 offen offset:2048 sc1
    v_mfma_f32_16x16x32_bf16 v[184:187], v[220:223], a[208:211], v[184:187]
    buffer_load_dwordx4 v[108:111], v16, s[16:19], s41 offen offset:3072 sc1
    v_mfma_f32_16x16x32_bf16 v[188:191], v[220:223], a[212:215], v[188:191]
    s_waitcnt lgkmcnt(0)
    v_lshlrev_b32 v3, 16, v75
    v_fmac_f32 v36, v7, v3
    v_mfma_f32_16x16x32_bf16 v[160:163], v[248:251], a[88:91], v[160:163]
    ds_read_b64_tr_b16 v[216:217], v19 offset:55424
    ds_read_b64_tr_b16 v[218:219], v19 offset:60032
    v_mfma_f32_16x16x32_bf16 v[164:167], v[248:251], a[92:95], v[164:167]
    v_and_b32 v4, s37, v75
    v_fmac_f32 v37, v7, v4
    v_mfma_f32_16x16x32_bf16 v[168:171], v[248:251], a[216:219], v[168:171]
    ds_read_b64_tr_b16 v[220:221], v20 offset:55424
    ds_read_b64_tr_b16 v[222:223], v20 offset:60032
    v_mfma_f32_16x16x32_bf16 v[172:175], v[248:251], a[220:223], v[172:175]
    v_lshlrev_b32 v3, 16, v76
    v_fmac_f32 v56, v11, v3
    v_mfma_f32_16x16x32_bf16 v[176:179], v[252:255], a[88:91], v[176:179]
    v_and_b32 v4, s37, v76
    v_fmac_f32 v57, v11, v4
    v_mfma_f32_16x16x32_bf16 v[180:183], v[252:255], a[92:95], v[180:183]
    v_lshlrev_b32 v3, 16, v77
    v_fmac_f32 v58, v11, v3
    v_mfma_f32_16x16x32_bf16 v[184:187], v[252:255], a[216:219], v[184:187]
    v_and_b32 v4, s37, v77
    v_fmac_f32 v59, v11, v4
    v_mfma_f32_16x16x32_bf16 v[188:191], v[252:255], a[220:223], v[188:191]
    s_waitcnt lgkmcnt(0)
    v_lshlrev_b32 v3, 16, v78
    v_fmac_f32 v26, v12, v3
    v_mfma_f32_16x16x32_bf16 v[160:163], v[216:219], a[96:99], v[160:163]
    v_add_u32 v17, 64512, v17
    v_add_u32 v18, 64512, v18
    v_mfma_f32_16x16x32_bf16 v[164:167], v[216:219], a[100:103], v[164:167]
    v_add_u32 v19, 64512, v19
    v_add_u32 v20, 64512, v20
    v_mfma_f32_16x16x32_bf16 v[168:171], v[216:219], a[224:227], v[168:171]
    ds_read_b64_tr_b16 v[248:249], v19 offset:128
    ds_read_b64_tr_b16 v[250:251], v19 offset:4736
    v_mfma_f32_16x16x32_bf16 v[172:175], v[216:219], a[228:231], v[172:175]
    ds_read_b64_tr_b16 v[252:253], v20 offset:128
    ds_read_b64_tr_b16 v[254:255], v20 offset:4736
    v_mfma_f32_16x16x32_bf16 v[176:179], v[220:223], a[96:99], v[176:179]
    v_and_b32 v4, s37, v78
    v_fmac_f32 v27, v12, v4
    v_mfma_f32_16x16x32_bf16 v[180:183], v[220:223], a[100:103], v[180:183]
    v_lshlrev_b32 v3, 16, v79
    v_fmac_f32 v30, v12, v3
    v_mfma_f32_16x16x32_bf16 v[184:187], v[220:223], a[224:227], v[184:187]
    v_and_b32 v4, s37, v79
    v_fmac_f32 v31, v12, v4
    v_mfma_f32_16x16x32_bf16 v[188:191], v[220:223], a[228:231], v[188:191]
    s_waitcnt lgkmcnt(0)
    v_mfma_f32_16x16x32_bf16 v[160:163], v[248:251], a[104:107], v[160:163]
    ds_read_b64_tr_b16 v[216:217], v19 offset:9344
    ds_read_b64_tr_b16 v[218:219], v19 offset:13952
    v_mfma_f32_16x16x32_bf16 v[164:167], v[248:251], a[108:111], v[164:167]
    v_mfma_f32_16x16x32_bf16 v[168:171], v[248:251], a[232:235], v[168:171]
    ds_read_b64_tr_b16 v[220:221], v20 offset:9344
    ds_read_b64_tr_b16 v[222:223], v20 offset:13952
    v_mfma_f32_16x16x32_bf16 v[172:175], v[248:251], a[236:239], v[172:175]
    v_mfma_f32_16x16x32_bf16 v[176:179], v[252:255], a[104:107], v[176:179]
    v_mfma_f32_16x16x32_bf16 v[180:183], v[252:255], a[108:111], v[180:183]
    v_mfma_f32_16x16x32_bf16 v[184:187], v[252:255], a[232:235], v[184:187]
    v_mfma_f32_16x16x32_bf16 v[188:191], v[252:255], a[236:239], v[188:191]
    s_waitcnt lgkmcnt(0)
    v_mfma_f32_16x16x32_bf16 v[160:163], v[216:219], a[112:115], v[160:163]
    ds_read_b64_tr_b16 v[248:249], v19 offset:18560
    ds_read_b64_tr_b16 v[250:251], v19 offset:23168
    v_mfma_f32_16x16x32_bf16 v[164:167], v[216:219], a[116:119], v[164:167]
    v_mfma_f32_16x16x32_bf16 v[168:171], v[216:219], a[240:243], v[168:171]
    ds_read_b64_tr_b16 v[252:253], v20 offset:18560
    ds_read_b64_tr_b16 v[254:255], v20 offset:23168
    v_mfma_f32_16x16x32_bf16 v[172:175], v[216:219], a[244:247], v[172:175]
    v_mfma_f32_16x16x32_bf16 v[176:179], v[220:223], a[112:115], v[176:179]
    v_mfma_f32_16x16x32_bf16 v[180:183], v[220:223], a[116:119], v[180:183]
    v_mfma_f32_16x16x32_bf16 v[184:187], v[220:223], a[240:243], v[184:187]
    v_mfma_f32_16x16x32_bf16 v[188:191], v[220:223], a[244:247], v[188:191]
    s_waitcnt lgkmcnt(0)
    v_mfma_f32_16x16x32_bf16 v[160:163], v[248:251], a[120:123], v[160:163]
    v_mfma_f32_16x16x32_bf16 v[164:167], v[248:251], a[124:127], v[164:167]
    v_mfma_f32_16x16x32_bf16 v[168:171], v[248:251], a[248:251], v[168:171]
    v_mfma_f32_16x16x32_bf16 v[172:175], v[248:251], a[252:255], v[172:175]
    v_mfma_f32_16x16x32_bf16 v[176:179], v[252:255], a[120:123], v[176:179]
    v_mfma_f32_16x16x32_bf16 v[180:183], v[252:255], a[124:127], v[180:183]
    v_mfma_f32_16x16x32_bf16 v[184:187], v[252:255], a[248:251], v[184:187]
    v_mfma_f32_16x16x32_bf16 v[188:191], v[252:255], a[252:255], v[188:191]
    s_waitcnt lgkmcnt(0)
    s_waitcnt vmcnt(0)
    v_max3_u32 v15, v96, v97, v98
    v_max3_u32 v15, v15, v99, v100
    v_max3_u32 v15, v15, v101, v102
    v_max3_u32 v15, v15, v103, v104
    v_max3_u32 v15, v15, v105, v106
    v_max3_u32 v15, v15, v107, v108
    v_max3_u32 v15, v15, v109, v110
    v_max_u32 v15, v15, v111
    v_cmp_eq_u32 vcc, -1, v15
    s_nop 0
    s_nop 0
    s_cbranch_vccnz gated_mix__ssm_conv_h3__compressed_kv_cla__prompt_kernel_spin_x1
gated_mix__ssm_conv_h3__compressed_kv_cla__prompt_kernel_spin_x1_ret:
    v_lshlrev_b32 v3, 16, v96
    v_add_f32 v160, v160, v3
    v_and_b32 v4, s37, v96
    v_add_f32 v161, v161, v4
    v_lshlrev_b32 v5, 16, v97
    v_add_f32 v162, v162, v5
    v_and_b32 v15, s37, v97
    v_add_f32 v163, v163, v15
    v_fma_f32 v160, v160, v6, v40
    v_fma_f32 v161, v161, v6, v41
    v_fma_f32 v162, v162, v6, v42
    v_fma_f32 v163, v163, v6, v43
    v_cvt_pk_bf16_f32 v112, v160, v161
    v_cvt_pk_bf16_f32 v113, v162, v163
    v_lshlrev_b32 v3, 16, v104
    v_add_f32 v176, v176, v3
    v_and_b32 v4, s37, v104
    v_add_f32 v177, v177, v4
    v_lshlrev_b32 v5, 16, v105
    v_add_f32 v178, v178, v5
    v_and_b32 v15, s37, v105
    v_add_f32 v179, v179, v15
    v_fma_f32 v176, v176, v6, v24
    v_fma_f32 v177, v177, v6, v25
    v_fma_f32 v178, v178, v6, v28
    v_fma_f32 v179, v179, v6, v29
    v_cvt_pk_bf16_f32 v114, v176, v177
    v_cvt_pk_bf16_f32 v115, v178, v179
    s_add_u32 s36, s48, 0
    v_permlane16_swap_b32 v112, v114
    v_permlane16_swap_b32 v113, v115
    buffer_store_dwordx4 v[112:115], v21, s[20:23], s36 offen
    v_lshlrev_b32 v3, 16, v98
    v_add_f32 v164, v164, v3
    v_and_b32 v4, s37, v98
    v_add_f32 v165, v165, v4
    v_lshlrev_b32 v5, 16, v99
    v_add_f32 v166, v166, v5
    v_and_b32 v15, s37, v99
    v_add_f32 v167, v167, v15
    v_fma_f32 v164, v164, v7, v44
    v_fma_f32 v165, v165, v7, v45
    v_fma_f32 v166, v166, v7, v46
    v_fma_f32 v167, v167, v7, v47
    v_cvt_pk_bf16_f32 v116, v164, v165
    v_cvt_pk_bf16_f32 v117, v166, v167
    v_lshlrev_b32 v3, 16, v106
    v_add_f32 v180, v180, v3
    v_and_b32 v4, s37, v106
    v_add_f32 v181, v181, v4
    v_lshlrev_b32 v5, 16, v107
    v_add_f32 v182, v182, v5
    v_and_b32 v15, s37, v107
    v_add_f32 v183, v183, v15
    v_fma_f32 v180, v180, v7, v32
    v_fma_f32 v181, v181, v7, v33
    v_fma_f32 v182, v182, v7, v36
    v_fma_f32 v183, v183, v7, v37
    v_cvt_pk_bf16_f32 v118, v180, v181
    v_cvt_pk_bf16_f32 v119, v182, v183
    s_add_u32 s36, s48, 131072
    v_permlane16_swap_b32 v116, v118
    v_permlane16_swap_b32 v117, v119
    buffer_store_dwordx4 v[116:119], v21, s[20:23], s36 offen
    v_lshlrev_b32 v3, 16, v100
    v_add_f32 v168, v168, v3
    v_and_b32 v4, s37, v100
    v_add_f32 v169, v169, v4
    v_lshlrev_b32 v5, 16, v101
    v_add_f32 v170, v170, v5
    v_and_b32 v15, s37, v101
    v_add_f32 v171, v171, v15
    v_fma_f32 v168, v168, v11, v48
    v_fma_f32 v169, v169, v11, v49
    v_fma_f32 v170, v170, v11, v50
    v_fma_f32 v171, v171, v11, v51
    v_cvt_pk_bf16_f32 v112, v168, v169
    v_cvt_pk_bf16_f32 v113, v170, v171
    v_lshlrev_b32 v3, 16, v108
    v_add_f32 v184, v184, v3
gated_mix__ssm_conv_h3__compressed_kv_cla__prompt_kernel_pad16:
    s_cbranch_execz gated_mix__ssm_conv_h3__compressed_kv_cla__prompt_kernel_pad20
    v_and_b32 v4, s37, v108
    v_add_f32 v185, v185, v4
    v_lshlrev_b32 v5, 16, v109
    v_add_f32 v186, v186, v5
    v_and_b32 v15, s37, v109
    v_add_f32 v187, v187, v15
    v_fma_f32 v184, v184, v11, v56
    v_fma_f32 v185, v185, v11, v57
    v_fma_f32 v186, v186, v11, v58
    v_fma_f32 v187, v187, v11, v59
    v_cvt_pk_bf16_f32 v114, v184, v185
    v_cvt_pk_bf16_f32 v115, v186, v187
    s_add_u32 s36, s48, 2097152
    v_permlane16_swap_b32 v112, v114
    v_permlane16_swap_b32 v113, v115
    buffer_store_dwordx4 v[112:115], v21, s[20:23], s36 offen
    v_lshlrev_b32 v3, 16, v102
    v_add_f32 v172, v172, v3
    v_and_b32 v4, s37, v102
    v_add_f32 v173, v173, v4
    v_lshlrev_b32 v5, 16, v103
    v_add_f32 v174, v174, v5
    v_and_b32 v15, s37, v103
    v_add_f32 v175, v175, v15
    v_fma_f32 v172, v172, v12, v52
    v_fma_f32 v173, v173, v12, v53
    v_fma_f32 v174, v174, v12, v54
    v_fma_f32 v175, v175, v12, v55
    v_cvt_pk_bf16_f32 v116, v172, v173
    v_cvt_pk_bf16_f32 v117, v174, v175
    v_lshlrev_b32 v3, 16, v110
    v_add_f32 v188, v188, v3
    v_and_b32 v4, s37, v110
    v_add_f32 v189, v189, v4
    v_lshlrev_b32 v5, 16, v111
    v_add_f32 v190, v190, v5
    v_and_b32 v15, s37, v111
    v_add_f32 v191, v191, v15
    v_fma_f32 v188, v188, v12, v26
    v_fma_f32 v189, v189, v12, v27
    v_fma_f32 v190, v190, v12, v30
    v_fma_f32 v191, v191, v12, v31
    v_cvt_pk_bf16_f32 v118, v188, v189
    v_cvt_pk_bf16_f32 v119, v190, v191
    s_add_u32 s36, s48, 2228224
    v_permlane16_swap_b32 v116, v118
    v_permlane16_swap_b32 v117, v119
    buffer_store_dwordx4 v[116:119], v21, s[20:23], s36 offen
gated_mix__ssm_conv_h3__compressed_kv_cla__prompt_kernel_end:
    s_endpgm
gated_mix__ssm_conv_h3__compressed_kv_cla__prompt_kernel_wb:
    v_bfe_u32 v3, v16, 1, 8
    s_branch gated_mix__ssm_conv_h3__compressed_kv_cla__prompt_kernel_wbs
gated_mix__ssm_conv_h3__compressed_kv_cla__prompt_kernel_wbs_ret:
    v_bfe_u32 v3, v16, 2, 5
    buffer_wbl2 sc1
    s_waitcnt vmcnt(0)
    s_branch gated_mix__ssm_conv_h3__compressed_kv_cla__prompt_kernel_wb_ret
gated_mix__ssm_conv_h3__compressed_kv_cla__prompt_kernel_wbs:
    s_mov_b32 s54, 0
gated_mix__ssm_conv_h3__compressed_kv_cla__prompt_kernel_wbs_again:
    s_sleep 2
    buffer_load_dword v9, v3, s[76:79], 0 offen sc1
    s_waitcnt vmcnt(0)
    v_and_b32 v11, v10, v9
    v_lshrrev_b32 v12, 4, v9
    v_and_b32 v12, v10, v12
    v_sad_u8 v11, v11, 0, 0
    v_sad_u8 v11, v12, 0, v11
    v_cmp_ne_u32 vcc, 8, v11
    s_add_u32 s54, s54, 1
    s_cmp_gt_u32 s54, 0x40000
    s_cbranch_scc1 gated_mix__ssm_conv_h3__compressed_kv_cla__prompt_kernel_wbs_ret
    s_cbranch_vccnz gated_mix__ssm_conv_h3__compressed_kv_cla__prompt_kernel_wbs_again
    s_branch gated_mix__ssm_conv_h3__compressed_kv_cla__prompt_kernel_wbs_ret
gated_mix__ssm_conv_h3__compressed_kv_cla__prompt_kernel_spin_kv:
    s_mov_b32 s54, 0
gated_mix__ssm_conv_h3__compressed_kv_cla__prompt_kernel_spin_kv_again:
    s_sleep 2
    buffer_load_dword v2, v3, s[28:31], s40 offen sc1
    s_waitcnt vmcnt(0)
    v_cmp_ne_u32 vcc, 1, v2
    s_add_u32 s54, s54, 1
    s_cmp_gt_u32 s54, 0x40000
    s_cbranch_scc1 gated_mix__ssm_conv_h3__compressed_kv_cla__prompt_kernel_spin_kv_ret
    s_cbranch_vccnz gated_mix__ssm_conv_h3__compressed_kv_cla__prompt_kernel_spin_kv_again
    s_branch gated_mix__ssm_conv_h3__compressed_kv_cla__prompt_kernel_spin_kv_ret
gated_mix__ssm_conv_h3__compressed_kv_cla__prompt_kernel_b4_sw:
    s_waitcnt vmcnt(8)
    v_and_b32 v17, v28, v29
    v_and_b32 v18, v30, v31
    v_and_b32 v17, v17, v18
    v_cmp_ne_u32 vcc, 1, v17
    s_mov_b32 s58, s35
    s_cbranch_vccnz gated_mix__ssm_conv_h3__compressed_kv_cla__prompt_kernel_b4_sw_spin
gated_mix__ssm_conv_h3__compressed_kv_cla__prompt_kernel_b4_sw_spin_ret:
    s_lshl_b32 s36, s2, 2
    s_cmp_eq_u32 s32, 0
    s_cbranch_scc1 gated_mix__ssm_conv_h3__compressed_kv_cla__prompt_kernel_b4_sw_h
    s_add_u32 s12, s94, 50331648
    s_addc_u32 s13, s95, 0
    s_mov_b32 s14, 4718592
    s_mov_b32 s15, 0x00020000
    s_mul_i32 s38, s36, 4608
    s_movk_i32 s44, 4608
    s_mov_b32 s49, -2
    s_movk_i32 s50, 4640
    s_lshl_b32 s37, s32, 2
    s_sub_u32 s37, 10, s37
    s_add_u32 s38, s38, s37
    s_mul_i32 s59, s32, 9280
    s_add_u32 s59, s59, 4294966496
    s_cmp_eq_u32 s32, 3
    s_cbranch_scc0 gated_mix__ssm_conv_h3__compressed_kv_cla__prompt_kernel_b4_sw_go
    s_mov_b32 s14, 0
    s_mov_b32 s38, 2
    s_mov_b32 s59, 163840
    s_mov_b32 s50, 0
    s_branch gated_mix__ssm_conv_h3__compressed_kv_cla__prompt_kernel_b4_sw_go
gated_mix__ssm_conv_h3__compressed_kv_cla__prompt_kernel_b4_sw_h:
    s_mov_b32 s12, s72
    s_mov_b32 s13, s73
    s_mov_b32 s14, 4194304
    s_mov_b32 s15, 0x00020000
    s_lshl_b32 s38, s36, 12
    s_movk_i32 s44, 4096
    s_mov_b32 s49, 8
    s_movk_i32 s50, 4240
    s_movk_i32 s59, 128
gated_mix__ssm_conv_h3__compressed_kv_cla__prompt_kernel_b4_sw_go:
    s_mov_b32 s40, s59
    s_add_u32 s41, s59, s50
    s_movk_i32 s48, -5728
    s_add_u32 s59, s59, s48
    s_branch gated_mix__ssm_conv_h3__compressed_kv_cla__prompt_kernel_b4_loop
gated_mix__ssm_conv_h3__compressed_kv_cla__prompt_kernel_b4_sw_spin:
    s_mov_b32 s54, 0
gated_mix__ssm_conv_h3__compressed_kv_cla__prompt_kernel_b4_sw_spin_again:
    s_sleep 2
    buffer_load_dwordx4 v[28:31], v16, s[28:31], s47 offen sc1
    s_waitcnt vmcnt(0)
    v_and_b32 v17, v28, v29
    v_and_b32 v18, v30, v31
    v_and_b32 v17, v17, v18
    v_cmp_ne_u32 vcc, 1, v17
    s_add_u32 s54, s54, 1
    s_cmp_gt_u32 s54, 0x40000
    s_cbranch_scc1 gated_mix__ssm_conv_h3__compressed_kv_cla__prompt_kernel_b4_sw_spin_ret
    s_cbranch_vccnz gated_mix__ssm_conv_h3__compressed_kv_cla__prompt_kernel_b4_sw_spin_again
    s_branch gated_mix__ssm_conv_h3__compressed_kv_cla__prompt_kernel_b4_sw_spin_ret
gated_mix__ssm_conv_h3__compressed_kv_cla__prompt_kernel_b2_sw:
gated_mix__ssm_conv_h3__compressed_kv_cla__prompt_kernel_pad17:
    s_cbranch_execz gated_mix__ssm_conv_h3__compressed_kv_cla__prompt_kernel_pad21
    s_waitcnt vmcnt(8)
    v_and_b32 v17, v28, v29
    v_and_b32 v18, v30, v31
    v_and_b32 v17, v17, v18
    v_cmp_ne_u32 vcc, 1, v17
    s_mov_b32 s58, s35
    s_cbranch_vccnz gated_mix__ssm_conv_h3__compressed_kv_cla__prompt_kernel_b2_sw_spin
gated_mix__ssm_conv_h3__compressed_kv_cla__prompt_kernel_b2_sw_spin_ret:
    v_mov_b32 v13, 0
    v_mov_b32 v14, 1
    buffer_store_dword v14, v13, s[28:31], s55 offen sc1
    s_lshl_b32 s36, s2, 2
    s_cmp_eq_u32 s32, 0
    s_cbranch_scc1 gated_mix__ssm_conv_h3__compressed_kv_cla__prompt_kernel_b2_sw_h
    s_add_u32 s12, s94, 50331648
    s_addc_u32 s13, s95, 0
    s_mov_b32 s14, 4718592
    s_mov_b32 s15, 0x00020000
    s_mul_i32 s38, s36, 4608
    s_movk_i32 s44, 4608
    s_mov_b32 s49, -2
    s_movk_i32 s50, 4640
    s_lshl_b32 s37, s32, 2
    s_sub_u32 s37, 10, s37
    s_add_u32 s38, s38, s37
    s_mul_i32 s59, s32, 9280
    s_add_u32 s59, s59, 4294966496
    s_cmp_eq_u32 s32, 3
    s_cbranch_scc0 gated_mix__ssm_conv_h3__compressed_kv_cla__prompt_kernel_b2_sw_go
    s_mov_b32 s14, 0
    s_mov_b32 s38, 2
    s_mov_b32 s59, 163840
    s_mov_b32 s50, 0
    s_branch gated_mix__ssm_conv_h3__compressed_kv_cla__prompt_kernel_b2_sw_go
gated_mix__ssm_conv_h3__compressed_kv_cla__prompt_kernel_b2_sw_h:
gated_mix__ssm_conv_h3__compressed_kv_cla__prompt_kernel_pad18:
    s_cbranch_execz gated_mix__ssm_conv_h3__compressed_kv_cla__prompt_kernel_pad22
    s_mov_b32 s12, s72
    s_mov_b32 s13, s73
    s_mov_b32 s14, 4194304
    s_mov_b32 s15, 0x00020000
    s_lshl_b32 s38, s36, 12
    s_movk_i32 s44, 4096
    s_mov_b32 s49, 8
    s_movk_i32 s50, 4240
    s_movk_i32 s59, 128
gated_mix__ssm_conv_h3__compressed_kv_cla__prompt_kernel_b2_sw_go:
    s_mov_b32 s40, s59
    s_add_u32 s41, s59, s50
    s_movk_i32 s48, -5728
    s_add_u32 s59, s59, s48
    s_branch gated_mix__ssm_conv_h3__compressed_kv_cla__prompt_kernel_b2_loop
gated_mix__ssm_conv_h3__compressed_kv_cla__prompt_kernel_b2_sw_spin:
    s_mov_b32 s54, 0
gated_mix__ssm_conv_h3__compressed_kv_cla__prompt_kernel_b2_sw_spin_again:
    s_sleep 2
    buffer_load_dwordx4 v[28:31], v16, s[28:31], s47 offen sc1
    s_waitcnt vmcnt(0)
    v_and_b32 v17, v28, v29
    v_and_b32 v18, v30, v31
    v_and_b32 v17, v17, v18
    v_cmp_ne_u32 vcc, 1, v17
    s_add_u32 s54, s54, 1
    s_cmp_gt_u32 s54, 0x40000
    s_cbranch_scc1 gated_mix__ssm_conv_h3__compressed_kv_cla__prompt_kernel_b2_sw_spin_ret
    s_cbranch_vccnz gated_mix__ssm_conv_h3__compressed_kv_cla__prompt_kernel_b2_sw_spin_again
    s_branch gated_mix__ssm_conv_h3__compressed_kv_cla__prompt_kernel_b2_sw_spin_ret
gated_mix__ssm_conv_h3__compressed_kv_cla__prompt_kernel_b4_m0:
gated_mix__ssm_conv_h3__compressed_kv_cla__prompt_kernel_pad19:
    s_cbranch_execz gated_mix__ssm_conv_h3__compressed_kv_cla__prompt_kernel_pad23
    s_nop 7
    v_add_f32 v144, v48, v144
    v_add_f32 v145, v49, v145
    v_add_f32 v146, v50, v146
    v_add_f32 v147, v51, v147
    v_add_f32 v148, v52, v148
    v_add_f32 v149, v53, v149
    v_add_f32 v150, v54, v150
    v_add_f32 v151, v55, v151
    s_branch gated_mix__ssm_conv_h3__compressed_kv_cla__prompt_kernel_b4_m0_ret
gated_mix__ssm_conv_h3__compressed_kv_cla__prompt_kernel_b4_m1:
gated_mix__ssm_conv_h3__compressed_kv_cla__prompt_kernel_pad20:
    s_cbranch_execz gated_mix__ssm_conv_h3__compressed_kv_cla__prompt_kernel_back
    s_nop 7
    v_add_f32 v176, v56, v176
    v_add_f32 v177, v57, v177
    v_add_f32 v178, v58, v178
    v_add_f32 v179, v59, v179
    v_add_f32 v180, v60, v180
    v_add_f32 v181, v61, v181
    v_add_f32 v182, v62, v182
    v_add_f32 v183, v63, v183
    s_branch gated_mix__ssm_conv_h3__compressed_kv_cla__prompt_kernel_b4_m1_ret
gated_mix__ssm_conv_h3__compressed_kv_cla__prompt_kernel_b2_m0:
gated_mix__ssm_conv_h3__compressed_kv_cla__prompt_kernel_pad21:
    s_cbranch_execz gated_mix__ssm_conv_h3__compressed_kv_cla__prompt_kernel_back
    s_nop 7
    v_add_f32 v160, v48, v160
    v_add_f32 v161, v49, v161
    v_add_f32 v162, v50, v162
    v_add_f32 v163, v51, v163
    v_add_f32 v164, v52, v164
    v_add_f32 v165, v53, v165
    v_add_f32 v166, v54, v166
    v_add_f32 v167, v55, v167
    s_branch gated_mix__ssm_conv_h3__compressed_kv_cla__prompt_kernel_b2_m0_ret
gated_mix__ssm_conv_h3__compressed_kv_cla__prompt_kernel_b2_m1:
gated_mix__ssm_conv_h3__compressed_kv_cla__prompt_kernel_pad22:
    s_cbranch_execz gated_mix__ssm_conv_h3__compressed_kv_cla__prompt_kernel_back
    s_nop 7
    v_add_f32 v192, v56, v192
    v_add_f32 v193, v57, v193
    v_add_f32 v194, v58, v194
    v_add_f32 v195, v59, v195
    v_add_f32 v196, v60, v196
    v_add_f32 v197, v61, v197
    v_add_f32 v198, v62, v198
    v_add_f32 v199, v63, v199
    s_branch gated_mix__ssm_conv_h3__compressed_kv_cla__prompt_kernel_b2_m1_ret
gated_mix__ssm_conv_h3__compressed_kv_cla__prompt_kernel_b2_m2:
gated_mix__ssm_conv_h3__compressed_kv_cla__prompt_kernel_pad23:
    s_cbranch_execz gated_mix__ssm_conv_h3__compressed_kv_cla__prompt_kernel_back
    s_nop 7
    v_add_f32 v168, v48, v168
    v_add_f32 v169, v49, v169
    v_add_f32 v170, v50, v170
    v_add_f32 v171, v51, v171
    v_add_f32 v172, v52, v172
    v_add_f32 v173, v53, v173
    v_add_f32 v174, v54, v174
    v_add_f32 v175, v55, v175
    s_branch gated_mix__ssm_conv_h3__compressed_kv_cla__prompt_kernel_b2_m2_ret
gated_mix__ssm_conv_h3__compressed_kv_cla__prompt_kernel_spin_s:
    s_mov_b32 s54, 0
gated_mix__ssm_conv_h3__compressed_kv_cla__prompt_kernel_spin_s_again:
    s_sleep 2
    buffer_load_dword v14, v13, s[28:31], s52 offen sc1
    s_waitcnt vmcnt(0)
    v_cmp_ne_u32 vcc, 1, v14
    s_add_u32 s54, s54, 1
    s_cmp_gt_u32 s54, 0x40000
    s_cbranch_scc1 gated_mix__ssm_conv_h3__compressed_kv_cla__prompt_kernel_spin_s_ret
    s_cbranch_vccnz gated_mix__ssm_conv_h3__compressed_kv_cla__prompt_kernel_spin_s_again
    s_branch gated_mix__ssm_conv_h3__compressed_kv_cla__prompt_kernel_spin_s_ret
gated_mix__ssm_conv_h3__compressed_kv_cla__prompt_kernel_spin_l:
    s_mov_b32 s54, 0
gated_mix__ssm_conv_h3__compressed_kv_cla__prompt_kernel_spin_l_again:
    s_sleep 2
    buffer_load_dword v14, v13, s[28:31], s52 offen sc1
    s_waitcnt vmcnt(0)
    v_cmp_ne_u32 vcc, 1, v14
    s_add_u32 s54, s54, 1
    s_cmp_gt_u32 s54, 0x40000
    s_cbranch_scc1 gated_mix__ssm_conv_h3__compressed_kv_cla__prompt_kernel_spin_l_ret
    s_cbranch_vccnz gated_mix__ssm_conv_h3__compressed_kv_cla__prompt_kernel_spin_l_again
    s_branch gated_mix__ssm_conv_h3__compressed_kv_cla__prompt_kernel_spin_l_ret
gated_mix__ssm_conv_h3__compressed_kv_cla__prompt_kernel_spin_y:
    s_mov_b32 s54, 0
gated_mix__ssm_conv_h3__compressed_kv_cla__prompt_kernel_spin_y_again:
    s_sleep 2
    buffer_load_dword v14, v13, s[28:31], 0 offen sc1
    s_waitcnt vmcnt(0)
    v_cmp_ne_u32 vcc, 1, v14
    s_add_u32 s54, s54, 1
    s_cmp_gt_u32 s54, 0x40000
    s_cbranch_scc1 gated_mix__ssm_conv_h3__compressed_kv_cla__prompt_kernel_spin_y_ret
    s_cbranch_vccnz gated_mix__ssm_conv_h3__compressed_kv_cla__prompt_kernel_spin_y_again
    s_branch gated_mix__ssm_conv_h3__compressed_kv_cla__prompt_kernel_spin_y_ret
gated_mix__ssm_conv_h3__compressed_kv_cla__prompt_kernel_spin_x3:
    s_mov_b32 s54, 0
gated_mix__ssm_conv_h3__compressed_kv_cla__prompt_kernel_spin_x3_again:
    s_sleep 2
    buffer_load_dwordx4 v[80:83], v16, s[16:19], s52 offen offset:0 sc1
    buffer_load_dwordx4 v[84:87], v16, s[16:19], s52 offen offset:1024 sc1
    buffer_load_dwordx4 v[88:91], v16, s[16:19], s52 offen offset:2048 sc1
    buffer_load_dwordx4 v[92:95], v16, s[16:19], s52 offen offset:3072 sc1
    s_waitcnt vmcnt(0)
    v_max3_u32 v15, v80, v81, v82
    v_max3_u32 v15, v15, v83, v84
    v_max3_u32 v15, v15, v85, v86
    v_max3_u32 v15, v15, v87, v88
    v_max3_u32 v15, v15, v89, v90
    v_max3_u32 v15, v15, v91, v92
    v_max3_u32 v15, v15, v93, v94
    v_max_u32 v15, v15, v95
    v_cmp_eq_u32 vcc, -1, v15
    s_add_u32 s54, s54, 1
    s_cmp_gt_u32 s54, 0x40000
    s_cbranch_scc1 gated_mix__ssm_conv_h3__compressed_kv_cla__prompt_kernel_spin_x3_ret
    s_cbranch_vccnz gated_mix__ssm_conv_h3__compressed_kv_cla__prompt_kernel_spin_x3_again
    s_branch gated_mix__ssm_conv_h3__compressed_kv_cla__prompt_kernel_spin_x3_ret
gated_mix__ssm_conv_h3__compressed_kv_cla__prompt_kernel_spin_x2:
    s_mov_b32 s54, 0
gated_mix__ssm_conv_h3__compressed_kv_cla__prompt_kernel_spin_x2_again:
    s_sleep 2
    buffer_load_dwordx4 v[64:67], v16, s[16:19], s42 offen offset:0 sc1
    buffer_load_dwordx4 v[68:71], v16, s[16:19], s42 offen offset:1024 sc1
    buffer_load_dwordx4 v[72:75], v16, s[16:19], s42 offen offset:2048 sc1
    buffer_load_dwordx4 v[76:79], v16, s[16:19], s42 offen offset:3072 sc1
    s_waitcnt vmcnt(0)
    v_max3_u32 v15, v64, v65, v66
    v_max3_u32 v15, v15, v67, v68
    v_max3_u32 v15, v15, v69, v70
    v_max3_u32 v15, v15, v71, v72
    v_max3_u32 v15, v15, v73, v74
    v_max3_u32 v15, v15, v75, v76
    v_max3_u32 v15, v15, v77, v78
    v_max_u32 v15, v15, v79
    v_cmp_eq_u32 vcc, -1, v15
    s_add_u32 s54, s54, 1
    s_cmp_gt_u32 s54, 0x40000
    s_cbranch_scc1 gated_mix__ssm_conv_h3__compressed_kv_cla__prompt_kernel_spin_x2_ret
    s_cbranch_vccnz gated_mix__ssm_conv_h3__compressed_kv_cla__prompt_kernel_spin_x2_again
    s_branch gated_mix__ssm_conv_h3__compressed_kv_cla__prompt_kernel_spin_x2_ret
gated_mix__ssm_conv_h3__compressed_kv_cla__prompt_kernel_spin_x1:
    s_mov_b32 s54, 0
gated_mix__ssm_conv_h3__compressed_kv_cla__prompt_kernel_spin_x1_again:
    s_sleep 2
    buffer_load_dwordx4 v[96:99], v16, s[16:19], s41 offen offset:0 sc1
    buffer_load_dwordx4 v[100:103], v16, s[16:19], s41 offen offset:1024 sc1
    buffer_load_dwordx4 v[104:107], v16, s[16:19], s41 offen offset:2048 sc1
    buffer_load_dwordx4 v[108:111], v16, s[16:19], s41 offen offset:3072 sc1
    s_waitcnt vmcnt(0)
    v_max3_u32 v15, v96, v97, v98
    v_max3_u32 v15, v15, v99, v100
    v_max3_u32 v15, v15, v101, v102
    v_max3_u32 v15, v15, v103, v104
    v_max3_u32 v15, v15, v105, v106
    v_max3_u32 v15, v15, v107, v108
    v_max3_u32 v15, v15, v109, v110
    v_max_u32 v15, v15, v111
    v_cmp_eq_u32 vcc, -1, v15
    s_add_u32 s54, s54, 1
    s_cmp_gt_u32 s54, 0x40000
    s_cbranch_scc1 gated_mix__ssm_conv_h3__compressed_kv_cla__prompt_kernel_spin_x1_ret
    s_cbranch_vccnz gated_mix__ssm_conv_h3__compressed_kv_cla__prompt_kernel_spin_x1_again
    s_branch gated_mix__ssm_conv_h3__compressed_kv_cla__prompt_kernel_spin_x1_ret
gated_mix__ssm_conv_h3__compressed_kv_cla__prompt_kernel_hotend:
gated_mix__ssm_conv_h3__compressed_kv_cla__prompt_kernel_b4_r0:
    s_nop 7
    v_max3_f32 v32, v144, v145, v146
    v_max3_f32 v32, v147, v148, v32
    v_max3_f32 v32, v149, v150, v32
    v_max_f32 v32, v151, v32
    v_mov_b32 v33, v32
    s_nop 1
    v_permlane16_swap_b32 v32, v33
    s_nop 1
    v_max_f32 v32, v32, v33
    v_mov_b32 v33, v32
    s_nop 1
    v_permlane32_swap_b32 v32, v33
    s_nop 1
    v_max_f32 v32, v32, v33
    v_add_f32 v32, 0x41c00000, v32
    v_max_f32 v32, 0, v32
    v_exp_f32 v34, -v32
    v_sub_f32 v64, v64, v32
    v_sub_f32 v65, v65, v32
    v_sub_f32 v66, v66, v32
    v_sub_f32 v67, v67, v32
    v_sub_f32 v144, v144, v32
    v_sub_f32 v145, v145, v32
    v_sub_f32 v146, v146, v32
    v_sub_f32 v147, v147, v32
    v_sub_f32 v148, v148, v32
    v_sub_f32 v149, v149, v32
    v_sub_f32 v150, v150, v32
    v_sub_f32 v151, v151, v32
    v_sub_f32 v176, v176, v32
    v_sub_f32 v177, v177, v32
    v_sub_f32 v178, v178, v32
    v_sub_f32 v179, v179, v32
    v_sub_f32 v180, v180, v32
    v_sub_f32 v181, v181, v32
    v_sub_f32 v182, v182, v32
    v_sub_f32 v183, v183, v32
    v_mul_f32 v240, v240, v34
    v_mul_f32 v241, v241, v34
    v_mul_f32 v242, v242, v34
    v_mul_f32 v243, v243, v34
    v_accvgpr_read_b32 v33, a0
    v_mul_f32 v33, v33, v34
    v_accvgpr_write_b32 a0, v33
    v_accvgpr_read_b32 v33, a1
    v_mul_f32 v33, v33, v34
    v_accvgpr_write_b32 a1, v33
    v_accvgpr_read_b32 v33, a2
    v_mul_f32 v33, v33, v34
    v_accvgpr_write_b32 a2, v33
    v_accvgpr_read_b32 v33, a3
    v_mul_f32 v33, v33, v34
    v_accvgpr_write_b32 a3, v33
    v_accvgpr_read_b32 v33, a4
    v_mul_f32 v33, v33, v34
    v_accvgpr_write_b32 a4, v33
    v_accvgpr_read_b32 v33, a5
    v_mul_f32 v33, v33, v34
    v_accvgpr_write_b32 a5, v33
    v_accvgpr_read_b32 v33, a6
    v_mul_f32 v33, v33, v34
    v_accvgpr_write_b32 a6, v33
    v_accvgpr_read_b32 v33, a7
    v_mul_f32 v33, v33, v34
    v_accvgpr_write_b32 a7, v33
    v_accvgpr_read_b32 v33, a8
    v_mul_f32 v33, v33, v34
    v_accvgpr_write_b32 a8, v33
    v_accvgpr_read_b32 v33, a9
    v_mul_f32 v33, v33, v34
    v_accvgpr_write_b32 a9, v33
    v_accvgpr_read_b32 v33, a10
    v_mul_f32 v33, v33, v34
    v_accvgpr_write_b32 a10, v33
    v_accvgpr_read_b32 v33, a11
    v_mul_f32 v33, v33, v34
    v_accvgpr_write_b32 a11, v33
    v_accvgpr_read_b32 v33, a12
    v_mul_f32 v33, v33, v34
    v_accvgpr_write_b32 a12, v33
    v_accvgpr_read_b32 v33, a13
    v_mul_f32 v33, v33, v34
    v_accvgpr_write_b32 a13, v33
    v_accvgpr_read_b32 v33, a14
    v_mul_f32 v33, v33, v34
    v_accvgpr_write_b32 a14, v33
    v_accvgpr_read_b32 v33, a15
    v_mul_f32 v33, v33, v34
    v_accvgpr_write_b32 a15, v33
    v_accvgpr_read_b32 v33, a16
    v_mul_f32 v33, v33, v34
    v_accvgpr_write_b32 a16, v33
    v_accvgpr_read_b32 v33, a17
    v_mul_f32 v33, v33, v34
    v_accvgpr_write_b32 a17, v33
    v_accvgpr_read_b32 v33, a18
    v_mul_f32 v33, v33, v34
    v_accvgpr_write_b32 a18, v33
    v_accvgpr_read_b32 v33, a19
    v_mul_f32 v33, v33, v34
    v_accvgpr_write_b32 a19, v33
    v_accvgpr_read_b32 v33, a20
    v_mul_f32 v33, v33, v34
    v_accvgpr_write_b32 a20, v33
    v_accvgpr_read_b32 v33, a21
    v_mul_f32 v33, v33, v34
    v_accvgpr_write_b32 a21, v33
    v_accvgpr_read_b32 v33, a22
    v_mul_f32 v33, v33, v34
    v_accvgpr_write_b32 a22, v33
    v_accvgpr_read_b32 v33, a23
    v_mul_f32 v33, v33, v34
    v_accvgpr_write_b32 a23, v33
    v_accvgpr_read_b32 v33, a24
    v_mul_f32 v33, v33, v34
    v_accvgpr_write_b32 a24, v33
    v_accvgpr_read_b32 v33, a25
    v_mul_f32 v33, v33, v34
    v_accvgpr_write_b32 a25, v33
    v_accvgpr_read_b32 v33, a26
    v_mul_f32 v33, v33, v34
    v_accvgpr_write_b32 a26, v33
    v_accvgpr_read_b32 v33, a27
    v_mul_f32 v33, v33, v34
    v_accvgpr_write_b32 a27, v33
    v_accvgpr_read_b32 v33, a28
    v_mul_f32 v33, v33, v34
    v_accvgpr_write_b32 a28, v33
    v_accvgpr_read_b32 v33, a29
    v_mul_f32 v33, v33, v34
    v_accvgpr_write_b32 a29, v33
    v_accvgpr_read_b32 v33, a30
    v_mul_f32 v33, v33, v34
    v_accvgpr_write_b32 a30, v33
    v_accvgpr_read_b32 v33, a31
    v_mul_f32 v33, v33, v34
    v_accvgpr_write_b32 a31, v33
    v_exp_f32 v36, v144
    v_exp_f32 v37, v145
    s_nop 0
    v_cvt_pk_bf16_f32 v208, v36, v37
    v_exp_f32 v36, v146
    v_exp_f32 v37, v147
    s_nop 0
    v_cvt_pk_bf16_f32 v209, v36, v37
    v_exp_f32 v36, v148
    v_exp_f32 v37, v149
    s_nop 0
    v_cvt_pk_bf16_f32 v210, v36, v37
    v_exp_f32 v36, v150
    v_exp_f32 v37, v151
    s_nop 0
    v_cvt_pk_bf16_f32 v211, v36, v37
    v_max3_f32 v32, v152, v153, v154
    v_max3_f32 v32, v155, v156, v32
    v_max3_f32 v32, v157, v158, v32
    v_max_f32 v32, v159, v32
    v_mov_b32 v33, v32
    s_nop 1
    v_permlane16_swap_b32 v32, v33
    s_nop 1
    v_max_f32 v32, v32, v33
    v_mov_b32 v33, v32
    s_nop 1
    v_permlane32_swap_b32 v32, v33
    s_nop 1
    v_max_f32 v32, v32, v33
    v_add_f32 v32, 0x41c00000, v32
    v_max_f32 v32, 0, v32
    v_exp_f32 v34, -v32
    v_sub_f32 v68, v68, v32
    v_sub_f32 v69, v69, v32
    v_sub_f32 v70, v70, v32
    v_sub_f32 v71, v71, v32
    v_sub_f32 v152, v152, v32
    v_sub_f32 v153, v153, v32
    v_sub_f32 v154, v154, v32
    v_sub_f32 v155, v155, v32
    v_sub_f32 v156, v156, v32
    v_sub_f32 v157, v157, v32
    v_sub_f32 v158, v158, v32
    v_sub_f32 v159, v159, v32
    v_sub_f32 v184, v184, v32
    v_sub_f32 v185, v185, v32
    v_sub_f32 v186, v186, v32
    v_sub_f32 v187, v187, v32
    v_sub_f32 v188, v188, v32
    v_sub_f32 v189, v189, v32
    v_sub_f32 v190, v190, v32
    v_sub_f32 v191, v191, v32
    v_mul_f32 v244, v244, v34
    v_mul_f32 v245, v245, v34
    v_mul_f32 v246, v246, v34
    v_mul_f32 v247, v247, v34
    v_accvgpr_read_b32 v33, a32
    v_mul_f32 v33, v33, v34
    v_accvgpr_write_b32 a32, v33
    v_accvgpr_read_b32 v33, a33
    v_mul_f32 v33, v33, v34
    v_accvgpr_write_b32 a33, v33
    v_accvgpr_read_b32 v33, a34
    v_mul_f32 v33, v33, v34
    v_accvgpr_write_b32 a34, v33
    v_accvgpr_read_b32 v33, a35
    v_mul_f32 v33, v33, v34
    v_accvgpr_write_b32 a35, v33
    v_accvgpr_read_b32 v33, a36
    v_mul_f32 v33, v33, v34
    v_accvgpr_write_b32 a36, v33
    v_accvgpr_read_b32 v33, a37
    v_mul_f32 v33, v33, v34
    v_accvgpr_write_b32 a37, v33
    v_accvgpr_read_b32 v33, a38
    v_mul_f32 v33, v33, v34
    v_accvgpr_write_b32 a38, v33
    v_accvgpr_read_b32 v33, a39
    v_mul_f32 v33, v33, v34
    v_accvgpr_write_b32 a39, v33
    v_accvgpr_read_b32 v33, a40
    v_mul_f32 v33, v33, v34
    v_accvgpr_write_b32 a40, v33
    v_accvgpr_read_b32 v33, a41
    v_mul_f32 v33, v33, v34
    v_accvgpr_write_b32 a41, v33
    v_accvgpr_read_b32 v33, a42
    v_mul_f32 v33, v33, v34
    v_accvgpr_write_b32 a42, v33
    v_accvgpr_read_b32 v33, a43
    v_mul_f32 v33, v33, v34
    v_accvgpr_write_b32 a43, v33
    v_accvgpr_read_b32 v33, a44
    v_mul_f32 v33, v33, v34
    v_accvgpr_write_b32 a44, v33
    v_accvgpr_read_b32 v33, a45
    v_mul_f32 v33, v33, v34
    v_accvgpr_write_b32 a45, v33
    v_accvgpr_read_b32 v33, a46
    v_mul_f32 v33, v33, v34
    v_accvgpr_write_b32 a46, v33
    v_accvgpr_read_b32 v33, a47
    v_mul_f32 v33, v33, v34
    v_accvgpr_write_b32 a47, v33
    v_accvgpr_read_b32 v33, a48
    v_mul_f32 v33, v33, v34
    v_accvgpr_write_b32 a48, v33
    v_accvgpr_read_b32 v33, a49
    v_mul_f32 v33, v33, v34
    v_accvgpr_write_b32 a49, v33
    v_accvgpr_read_b32 v33, a50
    v_mul_f32 v33, v33, v34
    v_accvgpr_write_b32 a50, v33
    v_accvgpr_read_b32 v33, a51
    v_mul_f32 v33, v33, v34
    v_accvgpr_write_b32 a51, v33
    v_accvgpr_read_b32 v33, a52
    v_mul_f32 v33, v33, v34
    v_accvgpr_write_b32 a52, v33
    v_accvgpr_read_b32 v33, a53
    v_mul_f32 v33, v33, v34
    v_accvgpr_write_b32 a53, v33
    v_accvgpr_read_b32 v33, a54
    v_mul_f32 v33, v33, v34
    v_accvgpr_write_b32 a54, v33
    v_accvgpr_read_b32 v33, a55
    v_mul_f32 v33, v33, v34
    v_accvgpr_write_b32 a55, v33
    v_accvgpr_read_b32 v33, a56
    v_mul_f32 v33, v33, v34
    v_accvgpr_write_b32 a56, v33
    v_accvgpr_read_b32 v33, a57
    v_mul_f32 v33, v33, v34
    v_accvgpr_write_b32 a57, v33
    v_accvgpr_read_b32 v33, a58
    v_mul_f32 v33, v33, v34
    v_accvgpr_write_b32 a58, v33
    v_accvgpr_read_b32 v33, a59
    v_mul_f32 v33, v33, v34
    v_accvgpr_write_b32 a59, v33
    v_accvgpr_read_b32 v33, a60
    v_mul_f32 v33, v33, v34
    v_accvgpr_write_b32 a60, v33
    v_accvgpr_read_b32 v33, a61
    v_mul_f32 v33, v33, v34
    v_accvgpr_write_b32 a61, v33
    v_accvgpr_read_b32 v33, a62
    v_mul_f32 v33, v33, v34
    v_accvgpr_write_b32 a62, v33
    v_accvgpr_read_b32 v33, a63
    v_mul_f32 v33, v33, v34
    v_accvgpr_write_b32 a63, v33
    v_exp_f32 v36, v152
    v_exp_f32 v37, v153
    s_nop 0
    v_cvt_pk_bf16_f32 v212, v36, v37
    v_exp_f32 v36, v154
    v_exp_f32 v37, v155
    s_nop 0
    v_cvt_pk_bf16_f32 v213, v36, v37
    v_exp_f32 v36, v156
    v_exp_f32 v37, v157
    s_nop 0
    v_cvt_pk_bf16_f32 v214, v36, v37
    v_exp_f32 v36, v158
    v_exp_f32 v37, v159
    s_nop 0
    v_cvt_pk_bf16_f32 v215, v36, v37
    v_max3_f32 v32, v160, v161, v162
    v_max3_f32 v32, v163, v164, v32
    v_max3_f32 v32, v165, v166, v32
    v_max_f32 v32, v167, v32
    v_mov_b32 v33, v32
    s_nop 1
    v_permlane16_swap_b32 v32, v33
    s_nop 1
    v_max_f32 v32, v32, v33
    v_mov_b32 v33, v32
    s_nop 1
    v_permlane32_swap_b32 v32, v33
    s_nop 1
    v_max_f32 v32, v32, v33
    v_add_f32 v32, 0x41c00000, v32
    v_max_f32 v32, 0, v32
    v_exp_f32 v34, -v32
    v_sub_f32 v72, v72, v32
    v_sub_f32 v73, v73, v32
    v_sub_f32 v74, v74, v32
    v_sub_f32 v75, v75, v32
    v_sub_f32 v160, v160, v32
    v_sub_f32 v161, v161, v32
    v_sub_f32 v162, v162, v32
    v_sub_f32 v163, v163, v32
    v_sub_f32 v164, v164, v32
    v_sub_f32 v165, v165, v32
    v_sub_f32 v166, v166, v32
    v_sub_f32 v167, v167, v32
    v_sub_f32 v192, v192, v32
    v_sub_f32 v193, v193, v32
    v_sub_f32 v194, v194, v32
    v_sub_f32 v195, v195, v32
    v_sub_f32 v196, v196, v32
    v_sub_f32 v197, v197, v32
    v_sub_f32 v198, v198, v32
    v_sub_f32 v199, v199, v32
    v_mul_f32 v248, v248, v34
    v_mul_f32 v249, v249, v34
    v_mul_f32 v250, v250, v34
    v_mul_f32 v251, v251, v34
    v_accvgpr_read_b32 v33, a64
    v_mul_f32 v33, v33, v34
    v_accvgpr_write_b32 a64, v33
    v_accvgpr_read_b32 v33, a65
    v_mul_f32 v33, v33, v34
    v_accvgpr_write_b32 a65, v33
    v_accvgpr_read_b32 v33, a66
    v_mul_f32 v33, v33, v34
    v_accvgpr_write_b32 a66, v33
    v_accvgpr_read_b32 v33, a67
    v_mul_f32 v33, v33, v34
    v_accvgpr_write_b32 a67, v33
    v_accvgpr_read_b32 v33, a68
    v_mul_f32 v33, v33, v34
    v_accvgpr_write_b32 a68, v33
    v_accvgpr_read_b32 v33, a69
    v_mul_f32 v33, v33, v34
    v_accvgpr_write_b32 a69, v33
    v_accvgpr_read_b32 v33, a70
    v_mul_f32 v33, v33, v34
    v_accvgpr_write_b32 a70, v33
    v_accvgpr_read_b32 v33, a71
    v_mul_f32 v33, v33, v34
    v_accvgpr_write_b32 a71, v33
    v_accvgpr_read_b32 v33, a72
    v_mul_f32 v33, v33, v34
    v_accvgpr_write_b32 a72, v33
    v_accvgpr_read_b32 v33, a73
    v_mul_f32 v33, v33, v34
    v_accvgpr_write_b32 a73, v33
    v_accvgpr_read_b32 v33, a74
    v_mul_f32 v33, v33, v34
    v_accvgpr_write_b32 a74, v33
    v_accvgpr_read_b32 v33, a75
    v_mul_f32 v33, v33, v34
    v_accvgpr_write_b32 a75, v33
    v_accvgpr_read_b32 v33, a76
    v_mul_f32 v33, v33, v34
    v_accvgpr_write_b32 a76, v33
    v_accvgpr_read_b32 v33, a77
    v_mul_f32 v33, v33, v34
    v_accvgpr_write_b32 a77, v33
    v_accvgpr_read_b32 v33, a78
    v_mul_f32 v33, v33, v34
    v_accvgpr_write_b32 a78, v33
    v_accvgpr_read_b32 v33, a79
    v_mul_f32 v33, v33, v34
    v_accvgpr_write_b32 a79, v33
    v_accvgpr_read_b32 v33, a80
    v_mul_f32 v33, v33, v34
    v_accvgpr_write_b32 a80, v33
    v_accvgpr_read_b32 v33, a81
    v_mul_f32 v33, v33, v34
    v_accvgpr_write_b32 a81, v33
    v_accvgpr_read_b32 v33, a82
    v_mul_f32 v33, v33, v34
    v_accvgpr_write_b32 a82, v33
    v_accvgpr_read_b32 v33, a83
    v_mul_f32 v33, v33, v34
    v_accvgpr_write_b32 a83, v33
    v_accvgpr_read_b32 v33, a84
    v_mul_f32 v33, v33, v34
    v_accvgpr_write_b32 a84, v33
    v_accvgpr_read_b32 v33, a85
    v_mul_f32 v33, v33, v34
    v_accvgpr_write_b32 a85, v33
    v_accvgpr_read_b32 v33, a86
    v_mul_f32 v33, v33, v34
    v_accvgpr_write_b32 a86, v33
    v_accvgpr_read_b32 v33, a87
    v_mul_f32 v33, v33, v34
    v_accvgpr_write_b32 a87, v33
    v_accvgpr_read_b32 v33, a88
    v_mul_f32 v33, v33, v34
    v_accvgpr_write_b32 a88, v33
    v_accvgpr_read_b32 v33, a89
    v_mul_f32 v33, v33, v34
    v_accvgpr_write_b32 a89, v33
    v_accvgpr_read_b32 v33, a90
    v_mul_f32 v33, v33, v34
    v_accvgpr_write_b32 a90, v33
    v_accvgpr_read_b32 v33, a91
    v_mul_f32 v33, v33, v34
    v_accvgpr_write_b32 a91, v33
    v_accvgpr_read_b32 v33, a92
    v_mul_f32 v33, v33, v34
    v_accvgpr_write_b32 a92, v33
    v_accvgpr_read_b32 v33, a93
    v_mul_f32 v33, v33, v34
    v_accvgpr_write_b32 a93, v33
    v_accvgpr_read_b32 v33, a94
    v_mul_f32 v33, v33, v34
    v_accvgpr_write_b32 a94, v33
    v_accvgpr_read_b32 v33, a95
    v_mul_f32 v33, v33, v34
    v_accvgpr_write_b32 a95, v33
    v_exp_f32 v36, v160
    v_exp_f32 v37, v161
    s_nop 0
    v_cvt_pk_bf16_f32 v216, v36, v37
    v_exp_f32 v36, v162
    v_exp_f32 v37, v163
    s_nop 0
    v_cvt_pk_bf16_f32 v217, v36, v37
    v_exp_f32 v36, v164
    v_exp_f32 v37, v165
    s_nop 0
    v_cvt_pk_bf16_f32 v218, v36, v37
    v_exp_f32 v36, v166
    v_exp_f32 v37, v167
    s_nop 0
    v_cvt_pk_bf16_f32 v219, v36, v37
    v_max3_f32 v32, v168, v169, v170
    v_max3_f32 v32, v171, v172, v32
    v_max3_f32 v32, v173, v174, v32
    v_max_f32 v32, v175, v32
    v_mov_b32 v33, v32
    s_nop 1
    v_permlane16_swap_b32 v32, v33
    s_nop 1
    v_max_f32 v32, v32, v33
    v_mov_b32 v33, v32
    s_nop 1
    v_permlane32_swap_b32 v32, v33
    s_nop 1
    v_max_f32 v32, v32, v33
    v_add_f32 v32, 0x41c00000, v32
    v_max_f32 v32, 0, v32
    v_exp_f32 v34, -v32
    v_sub_f32 v76, v76, v32
    v_sub_f32 v77, v77, v32
    v_sub_f32 v78, v78, v32
    v_sub_f32 v79, v79, v32
    v_sub_f32 v168, v168, v32
    v_sub_f32 v169, v169, v32
    v_sub_f32 v170, v170, v32
    v_sub_f32 v171, v171, v32
    v_sub_f32 v172, v172, v32
    v_sub_f32 v173, v173, v32
    v_sub_f32 v174, v174, v32
    v_sub_f32 v175, v175, v32
    v_sub_f32 v200, v200, v32
    v_sub_f32 v201, v201, v32
    v_sub_f32 v202, v202, v32
    v_sub_f32 v203, v203, v32
    v_sub_f32 v204, v204, v32
    v_sub_f32 v205, v205, v32
    v_sub_f32 v206, v206, v32
    v_sub_f32 v207, v207, v32
    v_mul_f32 v252, v252, v34
    v_mul_f32 v253, v253, v34
    v_mul_f32 v254, v254, v34
    v_mul_f32 v255, v255, v34
    v_accvgpr_read_b32 v33, a96
    v_mul_f32 v33, v33, v34
    v_accvgpr_write_b32 a96, v33
    v_accvgpr_read_b32 v33, a97
    v_mul_f32 v33, v33, v34
    v_accvgpr_write_b32 a97, v33
    v_accvgpr_read_b32 v33, a98
    v_mul_f32 v33, v33, v34
    v_accvgpr_write_b32 a98, v33
    v_accvgpr_read_b32 v33, a99
    v_mul_f32 v33, v33, v34
    v_accvgpr_write_b32 a99, v33
    v_accvgpr_read_b32 v33, a100
    v_mul_f32 v33, v33, v34
    v_accvgpr_write_b32 a100, v33
    v_accvgpr_read_b32 v33, a101
    v_mul_f32 v33, v33, v34
    v_accvgpr_write_b32 a101, v33
    v_accvgpr_read_b32 v33, a102
    v_mul_f32 v33, v33, v34
    v_accvgpr_write_b32 a102, v33
    v_accvgpr_read_b32 v33, a103
    v_mul_f32 v33, v33, v34
    v_accvgpr_write_b32 a103, v33
    v_accvgpr_read_b32 v33, a104
    v_mul_f32 v33, v33, v34
    v_accvgpr_write_b32 a104, v33
    v_accvgpr_read_b32 v33, a105
    v_mul_f32 v33, v33, v34
    v_accvgpr_write_b32 a105, v33
    v_accvgpr_read_b32 v33, a106
    v_mul_f32 v33, v33, v34
    v_accvgpr_write_b32 a106, v33
    v_accvgpr_read_b32 v33, a107
    v_mul_f32 v33, v33, v34
    v_accvgpr_write_b32 a107, v33
    v_accvgpr_read_b32 v33, a108
    v_mul_f32 v33, v33, v34
    v_accvgpr_write_b32 a108, v33
    v_accvgpr_read_b32 v33, a109
    v_mul_f32 v33, v33, v34
    v_accvgpr_write_b32 a109, v33
    v_accvgpr_read_b32 v33, a110
    v_mul_f32 v33, v33, v34
    v_accvgpr_write_b32 a110, v33
    v_accvgpr_read_b32 v33, a111
    v_mul_f32 v33, v33, v34
    v_accvgpr_write_b32 a111, v33
    v_accvgpr_read_b32 v33, a112
    v_mul_f32 v33, v33, v34
    v_accvgpr_write_b32 a112, v33
    v_accvgpr_read_b32 v33, a113
    v_mul_f32 v33, v33, v34
    v_accvgpr_write_b32 a113, v33
    v_accvgpr_read_b32 v33, a114
    v_mul_f32 v33, v33, v34
    v_accvgpr_write_b32 a114, v33
    v_accvgpr_read_b32 v33, a115
    v_mul_f32 v33, v33, v34
    v_accvgpr_write_b32 a115, v33
    v_accvgpr_read_b32 v33, a116
    v_mul_f32 v33, v33, v34
    v_accvgpr_write_b32 a116, v33
    v_accvgpr_read_b32 v33, a117
    v_mul_f32 v33, v33, v34
    v_accvgpr_write_b32 a117, v33
    v_accvgpr_read_b32 v33, a118
    v_mul_f32 v33, v33, v34
    v_accvgpr_write_b32 a118, v33
    v_accvgpr_read_b32 v33, a119
    v_mul_f32 v33, v33, v34
    v_accvgpr_write_b32 a119, v33
    v_accvgpr_read_b32 v33, a120
    v_mul_f32 v33, v33, v34
    v_accvgpr_write_b32 a120, v33
    v_accvgpr_read_b32 v33, a121
    v_mul_f32 v33, v33, v34
    v_accvgpr_write_b32 a121, v33
    v_accvgpr_read_b32 v33, a122
    v_mul_f32 v33, v33, v34
    v_accvgpr_write_b32 a122, v33
    v_accvgpr_read_b32 v33, a123
    v_mul_f32 v33, v33, v34
    v_accvgpr_write_b32 a123, v33
    v_accvgpr_read_b32 v33, a124
    v_mul_f32 v33, v33, v34
    v_accvgpr_write_b32 a124, v33
    v_accvgpr_read_b32 v33, a125
    v_mul_f32 v33, v33, v34
    v_accvgpr_write_b32 a125, v33
    v_accvgpr_read_b32 v33, a126
    v_mul_f32 v33, v33, v34
    v_accvgpr_write_b32 a126, v33
    v_accvgpr_read_b32 v33, a127
    v_mul_f32 v33, v33, v34
    v_accvgpr_write_b32 a127, v33
    v_exp_f32 v36, v168
    v_exp_f32 v37, v169
    s_nop 0
    v_cvt_pk_bf16_f32 v220, v36, v37
    v_exp_f32 v36, v170
    v_exp_f32 v37, v171
    s_nop 0
    v_cvt_pk_bf16_f32 v221, v36, v37
    v_exp_f32 v36, v172
    v_exp_f32 v37, v173
    s_nop 0
    v_cvt_pk_bf16_f32 v222, v36, v37
    v_exp_f32 v36, v174
    v_exp_f32 v37, v175
    s_nop 0
    v_cvt_pk_bf16_f32 v223, v36, v37
    s_nop 1
    s_branch gated_mix__ssm_conv_h3__compressed_kv_cla__prompt_kernel_b4_r0_ret
gated_mix__ssm_conv_h3__compressed_kv_cla__prompt_kernel_b4_r1:
    s_nop 7
    v_max3_f32 v32, v176, v177, v178
    v_max3_f32 v32, v179, v180, v32
    v_max3_f32 v32, v181, v182, v32
    v_max_f32 v32, v183, v32
    v_mov_b32 v33, v32
    s_nop 1
    v_permlane16_swap_b32 v32, v33
    s_nop 1
    v_max_f32 v32, v32, v33
    v_mov_b32 v33, v32
    s_nop 1
    v_permlane32_swap_b32 v32, v33
    s_nop 1
    v_max_f32 v32, v32, v33
    v_add_f32 v32, 0x41c00000, v32
    v_max_f32 v32, 0, v32
    v_exp_f32 v34, -v32
    v_sub_f32 v64, v64, v32
    v_sub_f32 v65, v65, v32
    v_sub_f32 v66, v66, v32
    v_sub_f32 v67, v67, v32
    v_sub_f32 v176, v176, v32
    v_sub_f32 v177, v177, v32
    v_sub_f32 v178, v178, v32
    v_sub_f32 v179, v179, v32
    v_sub_f32 v180, v180, v32
    v_sub_f32 v181, v181, v32
    v_sub_f32 v182, v182, v32
    v_sub_f32 v183, v183, v32
    v_sub_f32 v144, v144, v32
    v_sub_f32 v145, v145, v32
    v_sub_f32 v146, v146, v32
    v_sub_f32 v147, v147, v32
    v_sub_f32 v148, v148, v32
    v_sub_f32 v149, v149, v32
    v_sub_f32 v150, v150, v32
    v_sub_f32 v151, v151, v32
    v_mul_f32 v240, v240, v34
    v_mul_f32 v241, v241, v34
    v_mul_f32 v242, v242, v34
    v_mul_f32 v243, v243, v34
    v_accvgpr_read_b32 v33, a0
    v_mul_f32 v33, v33, v34
    v_accvgpr_write_b32 a0, v33
    v_accvgpr_read_b32 v33, a1
    v_mul_f32 v33, v33, v34
    v_accvgpr_write_b32 a1, v33
    v_accvgpr_read_b32 v33, a2
    v_mul_f32 v33, v33, v34
    v_accvgpr_write_b32 a2, v33
    v_accvgpr_read_b32 v33, a3
    v_mul_f32 v33, v33, v34
    v_accvgpr_write_b32 a3, v33
    v_accvgpr_read_b32 v33, a4
    v_mul_f32 v33, v33, v34
    v_accvgpr_write_b32 a4, v33
    v_accvgpr_read_b32 v33, a5
    v_mul_f32 v33, v33, v34
    v_accvgpr_write_b32 a5, v33
    v_accvgpr_read_b32 v33, a6
    v_mul_f32 v33, v33, v34
    v_accvgpr_write_b32 a6, v33
    v_accvgpr_read_b32 v33, a7
    v_mul_f32 v33, v33, v34
    v_accvgpr_write_b32 a7, v33
    v_accvgpr_read_b32 v33, a8
    v_mul_f32 v33, v33, v34
    v_accvgpr_write_b32 a8, v33
    v_accvgpr_read_b32 v33, a9
    v_mul_f32 v33, v33, v34
    v_accvgpr_write_b32 a9, v33
    v_accvgpr_read_b32 v33, a10
    v_mul_f32 v33, v33, v34
    v_accvgpr_write_b32 a10, v33
    v_accvgpr_read_b32 v33, a11
    v_mul_f32 v33, v33, v34
    v_accvgpr_write_b32 a11, v33
    v_accvgpr_read_b32 v33, a12
    v_mul_f32 v33, v33, v34
    v_accvgpr_write_b32 a12, v33
    v_accvgpr_read_b32 v33, a13
    v_mul_f32 v33, v33, v34
    v_accvgpr_write_b32 a13, v33
    v_accvgpr_read_b32 v33, a14
    v_mul_f32 v33, v33, v34
    v_accvgpr_write_b32 a14, v33
    v_accvgpr_read_b32 v33, a15
    v_mul_f32 v33, v33, v34
    v_accvgpr_write_b32 a15, v33
    v_accvgpr_read_b32 v33, a16
    v_mul_f32 v33, v33, v34
    v_accvgpr_write_b32 a16, v33
    v_accvgpr_read_b32 v33, a17
    v_mul_f32 v33, v33, v34
    v_accvgpr_write_b32 a17, v33
    v_accvgpr_read_b32 v33, a18
    v_mul_f32 v33, v33, v34
    v_accvgpr_write_b32 a18, v33
    v_accvgpr_read_b32 v33, a19
    v_mul_f32 v33, v33, v34
    v_accvgpr_write_b32 a19, v33
    v_accvgpr_read_b32 v33, a20
    v_mul_f32 v33, v33, v34
    v_accvgpr_write_b32 a20, v33
    v_accvgpr_read_b32 v33, a21
    v_mul_f32 v33, v33, v34
    v_accvgpr_write_b32 a21, v33
    v_accvgpr_read_b32 v33, a22
    v_mul_f32 v33, v33, v34
    v_accvgpr_write_b32 a22, v33
    v_accvgpr_read_b32 v33, a23
    v_mul_f32 v33, v33, v34
    v_accvgpr_write_b32 a23, v33
    v_accvgpr_read_b32 v33, a24
    v_mul_f32 v33, v33, v34
    v_accvgpr_write_b32 a24, v33
    v_accvgpr_read_b32 v33, a25
    v_mul_f32 v33, v33, v34
    v_accvgpr_write_b32 a25, v33
    v_accvgpr_read_b32 v33, a26
    v_mul_f32 v33, v33, v34
    v_accvgpr_write_b32 a26, v33
    v_accvgpr_read_b32 v33, a27
    v_mul_f32 v33, v33, v34
    v_accvgpr_write_b32 a27, v33
    v_accvgpr_read_b32 v33, a28
    v_mul_f32 v33, v33, v34
    v_accvgpr_write_b32 a28, v33
    v_accvgpr_read_b32 v33, a29
    v_mul_f32 v33, v33, v34
    v_accvgpr_write_b32 a29, v33
    v_accvgpr_read_b32 v33, a30
    v_mul_f32 v33, v33, v34
    v_accvgpr_write_b32 a30, v33
    v_accvgpr_read_b32 v33, a31
    v_mul_f32 v33, v33, v34
    v_accvgpr_write_b32 a31, v33
    v_exp_f32 v36, v176
    v_exp_f32 v37, v177
    s_nop 0
    v_cvt_pk_bf16_f32 v224, v36, v37
    v_exp_f32 v36, v178
    v_exp_f32 v37, v179
    s_nop 0
    v_cvt_pk_bf16_f32 v225, v36, v37
    v_exp_f32 v36, v180
    v_exp_f32 v37, v181
    s_nop 0
    v_cvt_pk_bf16_f32 v226, v36, v37
    v_exp_f32 v36, v182
    v_exp_f32 v37, v183
    s_nop 0
    v_cvt_pk_bf16_f32 v227, v36, v37
    v_max3_f32 v32, v184, v185, v186
    v_max3_f32 v32, v187, v188, v32
    v_max3_f32 v32, v189, v190, v32
    v_max_f32 v32, v191, v32
    v_mov_b32 v33, v32
    s_nop 1
    v_permlane16_swap_b32 v32, v33
    s_nop 1
    v_max_f32 v32, v32, v33
    v_mov_b32 v33, v32
    s_nop 1
    v_permlane32_swap_b32 v32, v33
    s_nop 1
    v_max_f32 v32, v32, v33
    v_add_f32 v32, 0x41c00000, v32
    v_max_f32 v32, 0, v32
    v_exp_f32 v34, -v32
    v_sub_f32 v68, v68, v32
    v_sub_f32 v69, v69, v32
    v_sub_f32 v70, v70, v32
    v_sub_f32 v71, v71, v32
    v_sub_f32 v184, v184, v32
    v_sub_f32 v185, v185, v32
    v_sub_f32 v186, v186, v32
    v_sub_f32 v187, v187, v32
    v_sub_f32 v188, v188, v32
    v_sub_f32 v189, v189, v32
    v_sub_f32 v190, v190, v32
    v_sub_f32 v191, v191, v32
    v_sub_f32 v152, v152, v32
    v_sub_f32 v153, v153, v32
    v_sub_f32 v154, v154, v32
    v_sub_f32 v155, v155, v32
    v_sub_f32 v156, v156, v32
    v_sub_f32 v157, v157, v32
    v_sub_f32 v158, v158, v32
    v_sub_f32 v159, v159, v32
    v_mul_f32 v244, v244, v34
    v_mul_f32 v245, v245, v34
    v_mul_f32 v246, v246, v34
    v_mul_f32 v247, v247, v34
    v_accvgpr_read_b32 v33, a32
    v_mul_f32 v33, v33, v34
    v_accvgpr_write_b32 a32, v33
    v_accvgpr_read_b32 v33, a33
    v_mul_f32 v33, v33, v34
    v_accvgpr_write_b32 a33, v33
    v_accvgpr_read_b32 v33, a34
    v_mul_f32 v33, v33, v34
    v_accvgpr_write_b32 a34, v33
    v_accvgpr_read_b32 v33, a35
    v_mul_f32 v33, v33, v34
    v_accvgpr_write_b32 a35, v33
    v_accvgpr_read_b32 v33, a36
    v_mul_f32 v33, v33, v34
    v_accvgpr_write_b32 a36, v33
    v_accvgpr_read_b32 v33, a37
    v_mul_f32 v33, v33, v34
    v_accvgpr_write_b32 a37, v33
    v_accvgpr_read_b32 v33, a38
    v_mul_f32 v33, v33, v34
    v_accvgpr_write_b32 a38, v33
    v_accvgpr_read_b32 v33, a39
    v_mul_f32 v33, v33, v34
    v_accvgpr_write_b32 a39, v33
    v_accvgpr_read_b32 v33, a40
    v_mul_f32 v33, v33, v34
    v_accvgpr_write_b32 a40, v33
    v_accvgpr_read_b32 v33, a41
    v_mul_f32 v33, v33, v34
    v_accvgpr_write_b32 a41, v33
    v_accvgpr_read_b32 v33, a42
    v_mul_f32 v33, v33, v34
    v_accvgpr_write_b32 a42, v33
    v_accvgpr_read_b32 v33, a43
    v_mul_f32 v33, v33, v34
    v_accvgpr_write_b32 a43, v33
    v_accvgpr_read_b32 v33, a44
    v_mul_f32 v33, v33, v34
    v_accvgpr_write_b32 a44, v33
    v_accvgpr_read_b32 v33, a45
    v_mul_f32 v33, v33, v34
    v_accvgpr_write_b32 a45, v33
    v_accvgpr_read_b32 v33, a46
    v_mul_f32 v33, v33, v34
    v_accvgpr_write_b32 a46, v33
    v_accvgpr_read_b32 v33, a47
    v_mul_f32 v33, v33, v34
    v_accvgpr_write_b32 a47, v33
    v_accvgpr_read_b32 v33, a48
    v_mul_f32 v33, v33, v34
    v_accvgpr_write_b32 a48, v33
    v_accvgpr_read_b32 v33, a49
    v_mul_f32 v33, v33, v34
    v_accvgpr_write_b32 a49, v33
    v_accvgpr_read_b32 v33, a50
    v_mul_f32 v33, v33, v34
    v_accvgpr_write_b32 a50, v33
    v_accvgpr_read_b32 v33, a51
    v_mul_f32 v33, v33, v34
    v_accvgpr_write_b32 a51, v33
    v_accvgpr_read_b32 v33, a52
    v_mul_f32 v33, v33, v34
    v_accvgpr_write_b32 a52, v33
    v_accvgpr_read_b32 v33, a53
    v_mul_f32 v33, v33, v34
    v_accvgpr_write_b32 a53, v33
    v_accvgpr_read_b32 v33, a54
    v_mul_f32 v33, v33, v34
    v_accvgpr_write_b32 a54, v33
    v_accvgpr_read_b32 v33, a55
    v_mul_f32 v33, v33, v34
    v_accvgpr_write_b32 a55, v33
    v_accvgpr_read_b32 v33, a56
    v_mul_f32 v33, v33, v34
    v_accvgpr_write_b32 a56, v33
    v_accvgpr_read_b32 v33, a57
    v_mul_f32 v33, v33, v34
    v_accvgpr_write_b32 a57, v33
    v_accvgpr_read_b32 v33, a58
    v_mul_f32 v33, v33, v34
    v_accvgpr_write_b32 a58, v33
    v_accvgpr_read_b32 v33, a59
    v_mul_f32 v33, v33, v34
    v_accvgpr_write_b32 a59, v33
    v_accvgpr_read_b32 v33, a60
    v_mul_f32 v33, v33, v34
    v_accvgpr_write_b32 a60, v33
    v_accvgpr_read_b32 v33, a61
    v_mul_f32 v33, v33, v34
    v_accvgpr_write_b32 a61, v33
    v_accvgpr_read_b32 v33, a62
    v_mul_f32 v33, v33, v34
    v_accvgpr_write_b32 a62, v33
    v_accvgpr_read_b32 v33, a63
    v_mul_f32 v33, v33, v34
    v_accvgpr_write_b32 a63, v33
    v_exp_f32 v36, v184
    v_exp_f32 v37, v185
    s_nop 0
    v_cvt_pk_bf16_f32 v228, v36, v37
    v_exp_f32 v36, v186
    v_exp_f32 v37, v187
    s_nop 0
    v_cvt_pk_bf16_f32 v229, v36, v37
    v_exp_f32 v36, v188
    v_exp_f32 v37, v189
    s_nop 0
    v_cvt_pk_bf16_f32 v230, v36, v37
    v_exp_f32 v36, v190
    v_exp_f32 v37, v191
    s_nop 0
    v_cvt_pk_bf16_f32 v231, v36, v37
    v_max3_f32 v32, v192, v193, v194
    v_max3_f32 v32, v195, v196, v32
    v_max3_f32 v32, v197, v198, v32
    v_max_f32 v32, v199, v32
    v_mov_b32 v33, v32
    s_nop 1
    v_permlane16_swap_b32 v32, v33
    s_nop 1
    v_max_f32 v32, v32, v33
    v_mov_b32 v33, v32
    s_nop 1
    v_permlane32_swap_b32 v32, v33
    s_nop 1
    v_max_f32 v32, v32, v33
    v_add_f32 v32, 0x41c00000, v32
    v_max_f32 v32, 0, v32
    v_exp_f32 v34, -v32
    v_sub_f32 v72, v72, v32
    v_sub_f32 v73, v73, v32
    v_sub_f32 v74, v74, v32
    v_sub_f32 v75, v75, v32
    v_sub_f32 v192, v192, v32
    v_sub_f32 v193, v193, v32
    v_sub_f32 v194, v194, v32
    v_sub_f32 v195, v195, v32
    v_sub_f32 v196, v196, v32
    v_sub_f32 v197, v197, v32
    v_sub_f32 v198, v198, v32
    v_sub_f32 v199, v199, v32
    v_sub_f32 v160, v160, v32
    v_sub_f32 v161, v161, v32
    v_sub_f32 v162, v162, v32
    v_sub_f32 v163, v163, v32
    v_sub_f32 v164, v164, v32
    v_sub_f32 v165, v165, v32
    v_sub_f32 v166, v166, v32
    v_sub_f32 v167, v167, v32
    v_mul_f32 v248, v248, v34
    v_mul_f32 v249, v249, v34
    v_mul_f32 v250, v250, v34
    v_mul_f32 v251, v251, v34
    v_accvgpr_read_b32 v33, a64
    v_mul_f32 v33, v33, v34
    v_accvgpr_write_b32 a64, v33
    v_accvgpr_read_b32 v33, a65
    v_mul_f32 v33, v33, v34
    v_accvgpr_write_b32 a65, v33
    v_accvgpr_read_b32 v33, a66
    v_mul_f32 v33, v33, v34
    v_accvgpr_write_b32 a66, v33
    v_accvgpr_read_b32 v33, a67
    v_mul_f32 v33, v33, v34
    v_accvgpr_write_b32 a67, v33
    v_accvgpr_read_b32 v33, a68
    v_mul_f32 v33, v33, v34
    v_accvgpr_write_b32 a68, v33
    v_accvgpr_read_b32 v33, a69
    v_mul_f32 v33, v33, v34
    v_accvgpr_write_b32 a69, v33
    v_accvgpr_read_b32 v33, a70
    v_mul_f32 v33, v33, v34
    v_accvgpr_write_b32 a70, v33
    v_accvgpr_read_b32 v33, a71
    v_mul_f32 v33, v33, v34
    v_accvgpr_write_b32 a71, v33
    v_accvgpr_read_b32 v33, a72
    v_mul_f32 v33, v33, v34
    v_accvgpr_write_b32 a72, v33
    v_accvgpr_read_b32 v33, a73
    v_mul_f32 v33, v33, v34
    v_accvgpr_write_b32 a73, v33
    v_accvgpr_read_b32 v33, a74
    v_mul_f32 v33, v33, v34
    v_accvgpr_write_b32 a74, v33
    v_accvgpr_read_b32 v33, a75
    v_mul_f32 v33, v33, v34
    v_accvgpr_write_b32 a75, v33
    v_accvgpr_read_b32 v33, a76
    v_mul_f32 v33, v33, v34
    v_accvgpr_write_b32 a76, v33
    v_accvgpr_read_b32 v33, a77
    v_mul_f32 v33, v33, v34
    v_accvgpr_write_b32 a77, v33
    v_accvgpr_read_b32 v33, a78
    v_mul_f32 v33, v33, v34
    v_accvgpr_write_b32 a78, v33
    v_accvgpr_read_b32 v33, a79
    v_mul_f32 v33, v33, v34
    v_accvgpr_write_b32 a79, v33
    v_accvgpr_read_b32 v33, a80
    v_mul_f32 v33, v33, v34
    v_accvgpr_write_b32 a80, v33
    v_accvgpr_read_b32 v33, a81
    v_mul_f32 v33, v33, v34
    v_accvgpr_write_b32 a81, v33
    v_accvgpr_read_b32 v33, a82
    v_mul_f32 v33, v33, v34
    v_accvgpr_write_b32 a82, v33
    v_accvgpr_read_b32 v33, a83
    v_mul_f32 v33, v33, v34
    v_accvgpr_write_b32 a83, v33
    v_accvgpr_read_b32 v33, a84
    v_mul_f32 v33, v33, v34
    v_accvgpr_write_b32 a84, v33
    v_accvgpr_read_b32 v33, a85
    v_mul_f32 v33, v33, v34
    v_accvgpr_write_b32 a85, v33
    v_accvgpr_read_b32 v33, a86
    v_mul_f32 v33, v33, v34
    v_accvgpr_write_b32 a86, v33
    v_accvgpr_read_b32 v33, a87
    v_mul_f32 v33, v33, v34
    v_accvgpr_write_b32 a87, v33
    v_accvgpr_read_b32 v33, a88
    v_mul_f32 v33, v33, v34
    v_accvgpr_write_b32 a88, v33
    v_accvgpr_read_b32 v33, a89
    v_mul_f32 v33, v33, v34
    v_accvgpr_write_b32 a89, v33
    v_accvgpr_read_b32 v33, a90
    v_mul_f32 v33, v33, v34
    v_accvgpr_write_b32 a90, v33
    v_accvgpr_read_b32 v33, a91
    v_mul_f32 v33, v33, v34
    v_accvgpr_write_b32 a91, v33
    v_accvgpr_read_b32 v33, a92
    v_mul_f32 v33, v33, v34
    v_accvgpr_write_b32 a92, v33
    v_accvgpr_read_b32 v33, a93
    v_mul_f32 v33, v33, v34
    v_accvgpr_write_b32 a93, v33
    v_accvgpr_read_b32 v33, a94
    v_mul_f32 v33, v33, v34
    v_accvgpr_write_b32 a94, v33
    v_accvgpr_read_b32 v33, a95
    v_mul_f32 v33, v33, v34
    v_accvgpr_write_b32 a95, v33
    v_exp_f32 v36, v192
    v_exp_f32 v37, v193
    s_nop 0
    v_cvt_pk_bf16_f32 v232, v36, v37
    v_exp_f32 v36, v194
    v_exp_f32 v37, v195
    s_nop 0
    v_cvt_pk_bf16_f32 v233, v36, v37
    v_exp_f32 v36, v196
    v_exp_f32 v37, v197
    s_nop 0
    v_cvt_pk_bf16_f32 v234, v36, v37
    v_exp_f32 v36, v198
    v_exp_f32 v37, v199
    s_nop 0
    v_cvt_pk_bf16_f32 v235, v36, v37
    v_max3_f32 v32, v200, v201, v202
    v_max3_f32 v32, v203, v204, v32
    v_max3_f32 v32, v205, v206, v32
    v_max_f32 v32, v207, v32
    v_mov_b32 v33, v32
    s_nop 1
    v_permlane16_swap_b32 v32, v33
    s_nop 1
    v_max_f32 v32, v32, v33
    v_mov_b32 v33, v32
    s_nop 1
    v_permlane32_swap_b32 v32, v33
    s_nop 1
    v_max_f32 v32, v32, v33
    v_add_f32 v32, 0x41c00000, v32
    v_max_f32 v32, 0, v32
    v_exp_f32 v34, -v32
    v_sub_f32 v76, v76, v32
    v_sub_f32 v77, v77, v32
    v_sub_f32 v78, v78, v32
    v_sub_f32 v79, v79, v32
    v_sub_f32 v200, v200, v32
    v_sub_f32 v201, v201, v32
    v_sub_f32 v202, v202, v32
    v_sub_f32 v203, v203, v32
    v_sub_f32 v204, v204, v32
    v_sub_f32 v205, v205, v32
    v_sub_f32 v206, v206, v32
    v_sub_f32 v207, v207, v32
    v_sub_f32 v168, v168, v32
    v_sub_f32 v169, v169, v32
    v_sub_f32 v170, v170, v32
    v_sub_f32 v171, v171, v32
    v_sub_f32 v172, v172, v32
    v_sub_f32 v173, v173, v32
    v_sub_f32 v174, v174, v32
    v_sub_f32 v175, v175, v32
    v_mul_f32 v252, v252, v34
    v_mul_f32 v253, v253, v34
    v_mul_f32 v254, v254, v34
    v_mul_f32 v255, v255, v34
    v_accvgpr_read_b32 v33, a96
    v_mul_f32 v33, v33, v34
    v_accvgpr_write_b32 a96, v33
    v_accvgpr_read_b32 v33, a97
    v_mul_f32 v33, v33, v34
    v_accvgpr_write_b32 a97, v33
    v_accvgpr_read_b32 v33, a98
    v_mul_f32 v33, v33, v34
    v_accvgpr_write_b32 a98, v33
    v_accvgpr_read_b32 v33, a99
    v_mul_f32 v33, v33, v34
    v_accvgpr_write_b32 a99, v33
    v_accvgpr_read_b32 v33, a100
    v_mul_f32 v33, v33, v34
    v_accvgpr_write_b32 a100, v33
    v_accvgpr_read_b32 v33, a101
    v_mul_f32 v33, v33, v34
    v_accvgpr_write_b32 a101, v33
    v_accvgpr_read_b32 v33, a102
    v_mul_f32 v33, v33, v34
    v_accvgpr_write_b32 a102, v33
    v_accvgpr_read_b32 v33, a103
    v_mul_f32 v33, v33, v34
    v_accvgpr_write_b32 a103, v33
    v_accvgpr_read_b32 v33, a104
    v_mul_f32 v33, v33, v34
    v_accvgpr_write_b32 a104, v33
    v_accvgpr_read_b32 v33, a105
    v_mul_f32 v33, v33, v34
    v_accvgpr_write_b32 a105, v33
    v_accvgpr_read_b32 v33, a106
    v_mul_f32 v33, v33, v34
    v_accvgpr_write_b32 a106, v33
    v_accvgpr_read_b32 v33, a107
    v_mul_f32 v33, v33, v34
    v_accvgpr_write_b32 a107, v33
    v_accvgpr_read_b32 v33, a108
    v_mul_f32 v33, v33, v34
    v_accvgpr_write_b32 a108, v33
    v_accvgpr_read_b32 v33, a109
    v_mul_f32 v33, v33, v34
    v_accvgpr_write_b32 a109, v33
    v_accvgpr_read_b32 v33, a110
    v_mul_f32 v33, v33, v34
    v_accvgpr_write_b32 a110, v33
    v_accvgpr_read_b32 v33, a111
    v_mul_f32 v33, v33, v34
    v_accvgpr_write_b32 a111, v33
    v_accvgpr_read_b32 v33, a112
    v_mul_f32 v33, v33, v34
    v_accvgpr_write_b32 a112, v33
    v_accvgpr_read_b32 v33, a113
    v_mul_f32 v33, v33, v34
    v_accvgpr_write_b32 a113, v33
    v_accvgpr_read_b32 v33, a114
    v_mul_f32 v33, v33, v34
    v_accvgpr_write_b32 a114, v33
    v_accvgpr_read_b32 v33, a115
    v_mul_f32 v33, v33, v34
    v_accvgpr_write_b32 a115, v33
    v_accvgpr_read_b32 v33, a116
    v_mul_f32 v33, v33, v34
    v_accvgpr_write_b32 a116, v33
    v_accvgpr_read_b32 v33, a117
    v_mul_f32 v33, v33, v34
    v_accvgpr_write_b32 a117, v33
    v_accvgpr_read_b32 v33, a118
    v_mul_f32 v33, v33, v34
    v_accvgpr_write_b32 a118, v33
    v_accvgpr_read_b32 v33, a119
    v_mul_f32 v33, v33, v34
    v_accvgpr_write_b32 a119, v33
    v_accvgpr_read_b32 v33, a120
    v_mul_f32 v33, v33, v34
    v_accvgpr_write_b32 a120, v33
    v_accvgpr_read_b32 v33, a121
    v_mul_f32 v33, v33, v34
    v_accvgpr_write_b32 a121, v33
    v_accvgpr_read_b32 v33, a122
    v_mul_f32 v33, v33, v34
    v_accvgpr_write_b32 a122, v33
    v_accvgpr_read_b32 v33, a123
    v_mul_f32 v33, v33, v34
    v_accvgpr_write_b32 a123, v33
    v_accvgpr_read_b32 v33, a124
    v_mul_f32 v33, v33, v34
    v_accvgpr_write_b32 a124, v33
    v_accvgpr_read_b32 v33, a125
    v_mul_f32 v33, v33, v34
    v_accvgpr_write_b32 a125, v33
    v_accvgpr_read_b32 v33, a126
    v_mul_f32 v33, v33, v34
    v_accvgpr_write_b32 a126, v33
    v_accvgpr_read_b32 v33, a127
    v_mul_f32 v33, v33, v34
    v_accvgpr_write_b32 a127, v33
    v_exp_f32 v36, v200
    v_exp_f32 v37, v201
    s_nop 0
    v_cvt_pk_bf16_f32 v236, v36, v37
    v_exp_f32 v36, v202
    v_exp_f32 v37, v203
    s_nop 0
    v_cvt_pk_bf16_f32 v237, v36, v37
    v_exp_f32 v36, v204
    v_exp_f32 v37, v205
    s_nop 0
    v_cvt_pk_bf16_f32 v238, v36, v37
    v_exp_f32 v36, v206
    v_exp_f32 v37, v207
    s_nop 0
    v_cvt_pk_bf16_f32 v239, v36, v37
    s_nop 1
    s_branch gated_mix__ssm_conv_h3__compressed_kv_cla__prompt_kernel_b4_r1_ret
gated_mix__ssm_conv_h3__compressed_kv_cla__prompt_kernel_b3_r0:
    s_nop 7
    v_max3_f32 v32, v152, v153, v154
    v_max3_f32 v32, v155, v156, v32
    v_max3_f32 v32, v157, v158, v32
    v_max_f32 v32, v159, v32
    v_mov_b32 v33, v32
    s_nop 1
    v_permlane16_swap_b32 v32, v33
    s_nop 1
    v_max_f32 v32, v32, v33
    v_mov_b32 v33, v32
    s_nop 1
    v_permlane32_swap_b32 v32, v33
    s_nop 1
    v_max_f32 v32, v32, v33
    v_add_f32 v32, 0x41c00000, v32
    v_max_f32 v32, 0, v32
    v_exp_f32 v34, -v32
    v_sub_f32 v68, v68, v32
    v_sub_f32 v69, v69, v32
    v_sub_f32 v70, v70, v32
    v_sub_f32 v71, v71, v32
    v_sub_f32 v152, v152, v32
    v_sub_f32 v153, v153, v32
    v_sub_f32 v154, v154, v32
    v_sub_f32 v155, v155, v32
    v_sub_f32 v156, v156, v32
    v_sub_f32 v157, v157, v32
    v_sub_f32 v158, v158, v32
    v_sub_f32 v159, v159, v32
    v_sub_f32 v184, v184, v32
    v_sub_f32 v185, v185, v32
    v_sub_f32 v186, v186, v32
    v_sub_f32 v187, v187, v32
    v_sub_f32 v188, v188, v32
    v_sub_f32 v189, v189, v32
    v_sub_f32 v190, v190, v32
    v_sub_f32 v191, v191, v32
    v_mul_f32 v244, v244, v34
    v_mul_f32 v245, v245, v34
    v_mul_f32 v246, v246, v34
    v_mul_f32 v247, v247, v34
    v_accvgpr_read_b32 v33, a32
    v_mul_f32 v33, v33, v34
    v_accvgpr_write_b32 a32, v33
    v_accvgpr_read_b32 v33, a33
    v_mul_f32 v33, v33, v34
    v_accvgpr_write_b32 a33, v33
    v_accvgpr_read_b32 v33, a34
    v_mul_f32 v33, v33, v34
    v_accvgpr_write_b32 a34, v33
    v_accvgpr_read_b32 v33, a35
    v_mul_f32 v33, v33, v34
    v_accvgpr_write_b32 a35, v33
    v_accvgpr_read_b32 v33, a36
    v_mul_f32 v33, v33, v34
    v_accvgpr_write_b32 a36, v33
    v_accvgpr_read_b32 v33, a37
    v_mul_f32 v33, v33, v34
    v_accvgpr_write_b32 a37, v33
    v_accvgpr_read_b32 v33, a38
    v_mul_f32 v33, v33, v34
    v_accvgpr_write_b32 a38, v33
    v_accvgpr_read_b32 v33, a39
    v_mul_f32 v33, v33, v34
    v_accvgpr_write_b32 a39, v33
    v_accvgpr_read_b32 v33, a40
    v_mul_f32 v33, v33, v34
    v_accvgpr_write_b32 a40, v33
    v_accvgpr_read_b32 v33, a41
    v_mul_f32 v33, v33, v34
    v_accvgpr_write_b32 a41, v33
    v_accvgpr_read_b32 v33, a42
    v_mul_f32 v33, v33, v34
    v_accvgpr_write_b32 a42, v33
    v_accvgpr_read_b32 v33, a43
    v_mul_f32 v33, v33, v34
    v_accvgpr_write_b32 a43, v33
    v_accvgpr_read_b32 v33, a44
    v_mul_f32 v33, v33, v34
    v_accvgpr_write_b32 a44, v33
    v_accvgpr_read_b32 v33, a45
    v_mul_f32 v33, v33, v34
    v_accvgpr_write_b32 a45, v33
    v_accvgpr_read_b32 v33, a46
    v_mul_f32 v33, v33, v34
    v_accvgpr_write_b32 a46, v33
    v_accvgpr_read_b32 v33, a47
    v_mul_f32 v33, v33, v34
    v_accvgpr_write_b32 a47, v33
    v_accvgpr_read_b32 v33, a48
    v_mul_f32 v33, v33, v34
    v_accvgpr_write_b32 a48, v33
    v_accvgpr_read_b32 v33, a49
    v_mul_f32 v33, v33, v34
    v_accvgpr_write_b32 a49, v33
    v_accvgpr_read_b32 v33, a50
    v_mul_f32 v33, v33, v34
    v_accvgpr_write_b32 a50, v33
    v_accvgpr_read_b32 v33, a51
    v_mul_f32 v33, v33, v34
    v_accvgpr_write_b32 a51, v33
    v_accvgpr_read_b32 v33, a52
    v_mul_f32 v33, v33, v34
    v_accvgpr_write_b32 a52, v33
    v_accvgpr_read_b32 v33, a53
    v_mul_f32 v33, v33, v34
    v_accvgpr_write_b32 a53, v33
    v_accvgpr_read_b32 v33, a54
    v_mul_f32 v33, v33, v34
    v_accvgpr_write_b32 a54, v33
    v_accvgpr_read_b32 v33, a55
    v_mul_f32 v33, v33, v34
    v_accvgpr_write_b32 a55, v33
    v_accvgpr_read_b32 v33, a56
    v_mul_f32 v33, v33, v34
    v_accvgpr_write_b32 a56, v33
    v_accvgpr_read_b32 v33, a57
    v_mul_f32 v33, v33, v34
    v_accvgpr_write_b32 a57, v33
    v_accvgpr_read_b32 v33, a58
    v_mul_f32 v33, v33, v34
    v_accvgpr_write_b32 a58, v33
    v_accvgpr_read_b32 v33, a59
    v_mul_f32 v33, v33, v34
    v_accvgpr_write_b32 a59, v33
    v_accvgpr_read_b32 v33, a60
    v_mul_f32 v33, v33, v34
    v_accvgpr_write_b32 a60, v33
    v_accvgpr_read_b32 v33, a61
    v_mul_f32 v33, v33, v34
    v_accvgpr_write_b32 a61, v33
    v_accvgpr_read_b32 v33, a62
    v_mul_f32 v33, v33, v34
    v_accvgpr_write_b32 a62, v33
    v_accvgpr_read_b32 v33, a63
    v_mul_f32 v33, v33, v34
    v_accvgpr_write_b32 a63, v33
    v_exp_f32 v36, v152
    v_exp_f32 v37, v153
    s_nop 0
    v_cvt_pk_bf16_f32 v212, v36, v37
    v_exp_f32 v36, v154
    v_exp_f32 v37, v155
    s_nop 0
    v_cvt_pk_bf16_f32 v213, v36, v37
    v_exp_f32 v36, v156
    v_exp_f32 v37, v157
    s_nop 0
    v_cvt_pk_bf16_f32 v214, v36, v37
    v_exp_f32 v36, v158
    v_exp_f32 v37, v159
    s_nop 0
    v_cvt_pk_bf16_f32 v215, v36, v37
    v_max3_f32 v32, v160, v161, v162
    v_max3_f32 v32, v163, v164, v32
    v_max3_f32 v32, v165, v166, v32
    v_max_f32 v32, v167, v32
    v_mov_b32 v33, v32
    s_nop 1
    v_permlane16_swap_b32 v32, v33
    s_nop 1
    v_max_f32 v32, v32, v33
    v_mov_b32 v33, v32
    s_nop 1
    v_permlane32_swap_b32 v32, v33
    s_nop 1
    v_max_f32 v32, v32, v33
    v_add_f32 v32, 0x41c00000, v32
    v_max_f32 v32, 0, v32
    v_exp_f32 v34, -v32
    v_sub_f32 v72, v72, v32
    v_sub_f32 v73, v73, v32
    v_sub_f32 v74, v74, v32
    v_sub_f32 v75, v75, v32
    v_sub_f32 v160, v160, v32
    v_sub_f32 v161, v161, v32
    v_sub_f32 v162, v162, v32
    v_sub_f32 v163, v163, v32
    v_sub_f32 v164, v164, v32
    v_sub_f32 v165, v165, v32
    v_sub_f32 v166, v166, v32
    v_sub_f32 v167, v167, v32
    v_sub_f32 v192, v192, v32
    v_sub_f32 v193, v193, v32
    v_sub_f32 v194, v194, v32
    v_sub_f32 v195, v195, v32
    v_sub_f32 v196, v196, v32
    v_sub_f32 v197, v197, v32
    v_sub_f32 v198, v198, v32
    v_sub_f32 v199, v199, v32
    v_mul_f32 v248, v248, v34
    v_mul_f32 v249, v249, v34
    v_mul_f32 v250, v250, v34
    v_mul_f32 v251, v251, v34
    v_accvgpr_read_b32 v33, a64
    v_mul_f32 v33, v33, v34
    v_accvgpr_write_b32 a64, v33
    v_accvgpr_read_b32 v33, a65
    v_mul_f32 v33, v33, v34
    v_accvgpr_write_b32 a65, v33
    v_accvgpr_read_b32 v33, a66
    v_mul_f32 v33, v33, v34
    v_accvgpr_write_b32 a66, v33
    v_accvgpr_read_b32 v33, a67
    v_mul_f32 v33, v33, v34
    v_accvgpr_write_b32 a67, v33
    v_accvgpr_read_b32 v33, a68
    v_mul_f32 v33, v33, v34
    v_accvgpr_write_b32 a68, v33
    v_accvgpr_read_b32 v33, a69
    v_mul_f32 v33, v33, v34
    v_accvgpr_write_b32 a69, v33
    v_accvgpr_read_b32 v33, a70
    v_mul_f32 v33, v33, v34
    v_accvgpr_write_b32 a70, v33
    v_accvgpr_read_b32 v33, a71
    v_mul_f32 v33, v33, v34
    v_accvgpr_write_b32 a71, v33
    v_accvgpr_read_b32 v33, a72
    v_mul_f32 v33, v33, v34
    v_accvgpr_write_b32 a72, v33
    v_accvgpr_read_b32 v33, a73
    v_mul_f32 v33, v33, v34
    v_accvgpr_write_b32 a73, v33
    v_accvgpr_read_b32 v33, a74
    v_mul_f32 v33, v33, v34
    v_accvgpr_write_b32 a74, v33
    v_accvgpr_read_b32 v33, a75
    v_mul_f32 v33, v33, v34
    v_accvgpr_write_b32 a75, v33
    v_accvgpr_read_b32 v33, a76
    v_mul_f32 v33, v33, v34
    v_accvgpr_write_b32 a76, v33
    v_accvgpr_read_b32 v33, a77
    v_mul_f32 v33, v33, v34
    v_accvgpr_write_b32 a77, v33
    v_accvgpr_read_b32 v33, a78
    v_mul_f32 v33, v33, v34
    v_accvgpr_write_b32 a78, v33
    v_accvgpr_read_b32 v33, a79
    v_mul_f32 v33, v33, v34
    v_accvgpr_write_b32 a79, v33
    v_accvgpr_read_b32 v33, a80
    v_mul_f32 v33, v33, v34
    v_accvgpr_write_b32 a80, v33
    v_accvgpr_read_b32 v33, a81
    v_mul_f32 v33, v33, v34
    v_accvgpr_write_b32 a81, v33
    v_accvgpr_read_b32 v33, a82
    v_mul_f32 v33, v33, v34
    v_accvgpr_write_b32 a82, v33
    v_accvgpr_read_b32 v33, a83
    v_mul_f32 v33, v33, v34
    v_accvgpr_write_b32 a83, v33
    v_accvgpr_read_b32 v33, a84
    v_mul_f32 v33, v33, v34
    v_accvgpr_write_b32 a84, v33
    v_accvgpr_read_b32 v33, a85
    v_mul_f32 v33, v33, v34
    v_accvgpr_write_b32 a85, v33
    v_accvgpr_read_b32 v33, a86
    v_mul_f32 v33, v33, v34
    v_accvgpr_write_b32 a86, v33
    v_accvgpr_read_b32 v33, a87
    v_mul_f32 v33, v33, v34
    v_accvgpr_write_b32 a87, v33
    v_accvgpr_read_b32 v33, a88
    v_mul_f32 v33, v33, v34
    v_accvgpr_write_b32 a88, v33
    v_accvgpr_read_b32 v33, a89
    v_mul_f32 v33, v33, v34
    v_accvgpr_write_b32 a89, v33
    v_accvgpr_read_b32 v33, a90
    v_mul_f32 v33, v33, v34
    v_accvgpr_write_b32 a90, v33
    v_accvgpr_read_b32 v33, a91
    v_mul_f32 v33, v33, v34
    v_accvgpr_write_b32 a91, v33
    v_accvgpr_read_b32 v33, a92
    v_mul_f32 v33, v33, v34
    v_accvgpr_write_b32 a92, v33
    v_accvgpr_read_b32 v33, a93
    v_mul_f32 v33, v33, v34
    v_accvgpr_write_b32 a93, v33
    v_accvgpr_read_b32 v33, a94
    v_mul_f32 v33, v33, v34
    v_accvgpr_write_b32 a94, v33
    v_accvgpr_read_b32 v33, a95
    v_mul_f32 v33, v33, v34
    v_accvgpr_write_b32 a95, v33
    v_exp_f32 v36, v160
    v_exp_f32 v37, v161
    s_nop 0
    v_cvt_pk_bf16_f32 v216, v36, v37
    v_exp_f32 v36, v162
    v_exp_f32 v37, v163
    s_nop 0
    v_cvt_pk_bf16_f32 v217, v36, v37
    v_exp_f32 v36, v164
    v_exp_f32 v37, v165
    s_nop 0
    v_cvt_pk_bf16_f32 v218, v36, v37
    v_exp_f32 v36, v166
    v_exp_f32 v37, v167
    s_nop 0
    v_cvt_pk_bf16_f32 v219, v36, v37
    v_max3_f32 v32, v168, v169, v170
    v_max3_f32 v32, v171, v172, v32
    v_max3_f32 v32, v173, v174, v32
    v_max_f32 v32, v175, v32
    v_mov_b32 v33, v32
    s_nop 1
    v_permlane16_swap_b32 v32, v33
    s_nop 1
    v_max_f32 v32, v32, v33
    v_mov_b32 v33, v32
    s_nop 1
    v_permlane32_swap_b32 v32, v33
    s_nop 1
    v_max_f32 v32, v32, v33
    v_add_f32 v32, 0x41c00000, v32
    v_max_f32 v32, 0, v32
    v_exp_f32 v34, -v32
    v_sub_f32 v76, v76, v32
    v_sub_f32 v77, v77, v32
    v_sub_f32 v78, v78, v32
    v_sub_f32 v79, v79, v32
    v_sub_f32 v168, v168, v32
    v_sub_f32 v169, v169, v32
    v_sub_f32 v170, v170, v32
    v_sub_f32 v171, v171, v32
    v_sub_f32 v172, v172, v32
    v_sub_f32 v173, v173, v32
    v_sub_f32 v174, v174, v32
    v_sub_f32 v175, v175, v32
    v_sub_f32 v200, v200, v32
    v_sub_f32 v201, v201, v32
    v_sub_f32 v202, v202, v32
    v_sub_f32 v203, v203, v32
    v_sub_f32 v204, v204, v32
    v_sub_f32 v205, v205, v32
    v_sub_f32 v206, v206, v32
    v_sub_f32 v207, v207, v32
    v_mul_f32 v252, v252, v34
    v_mul_f32 v253, v253, v34
    v_mul_f32 v254, v254, v34
    v_mul_f32 v255, v255, v34
    v_accvgpr_read_b32 v33, a96
    v_mul_f32 v33, v33, v34
    v_accvgpr_write_b32 a96, v33
    v_accvgpr_read_b32 v33, a97
    v_mul_f32 v33, v33, v34
    v_accvgpr_write_b32 a97, v33
    v_accvgpr_read_b32 v33, a98
    v_mul_f32 v33, v33, v34
    v_accvgpr_write_b32 a98, v33
    v_accvgpr_read_b32 v33, a99
    v_mul_f32 v33, v33, v34
    v_accvgpr_write_b32 a99, v33
    v_accvgpr_read_b32 v33, a100
    v_mul_f32 v33, v33, v34
    v_accvgpr_write_b32 a100, v33
    v_accvgpr_read_b32 v33, a101
    v_mul_f32 v33, v33, v34
    v_accvgpr_write_b32 a101, v33
    v_accvgpr_read_b32 v33, a102
    v_mul_f32 v33, v33, v34
    v_accvgpr_write_b32 a102, v33
    v_accvgpr_read_b32 v33, a103
    v_mul_f32 v33, v33, v34
    v_accvgpr_write_b32 a103, v33
    v_accvgpr_read_b32 v33, a104
    v_mul_f32 v33, v33, v34
    v_accvgpr_write_b32 a104, v33
    v_accvgpr_read_b32 v33, a105
    v_mul_f32 v33, v33, v34
    v_accvgpr_write_b32 a105, v33
    v_accvgpr_read_b32 v33, a106
    v_mul_f32 v33, v33, v34
    v_accvgpr_write_b32 a106, v33
    v_accvgpr_read_b32 v33, a107
    v_mul_f32 v33, v33, v34
    v_accvgpr_write_b32 a107, v33
    v_accvgpr_read_b32 v33, a108
    v_mul_f32 v33, v33, v34
    v_accvgpr_write_b32 a108, v33
    v_accvgpr_read_b32 v33, a109
    v_mul_f32 v33, v33, v34
    v_accvgpr_write_b32 a109, v33
    v_accvgpr_read_b32 v33, a110
    v_mul_f32 v33, v33, v34
    v_accvgpr_write_b32 a110, v33
    v_accvgpr_read_b32 v33, a111
    v_mul_f32 v33, v33, v34
    v_accvgpr_write_b32 a111, v33
    v_accvgpr_read_b32 v33, a112
    v_mul_f32 v33, v33, v34
    v_accvgpr_write_b32 a112, v33
    v_accvgpr_read_b32 v33, a113
    v_mul_f32 v33, v33, v34
    v_accvgpr_write_b32 a113, v33
    v_accvgpr_read_b32 v33, a114
    v_mul_f32 v33, v33, v34
    v_accvgpr_write_b32 a114, v33
    v_accvgpr_read_b32 v33, a115
    v_mul_f32 v33, v33, v34
    v_accvgpr_write_b32 a115, v33
    v_accvgpr_read_b32 v33, a116
    v_mul_f32 v33, v33, v34
    v_accvgpr_write_b32 a116, v33
    v_accvgpr_read_b32 v33, a117
    v_mul_f32 v33, v33, v34
    v_accvgpr_write_b32 a117, v33
    v_accvgpr_read_b32 v33, a118
    v_mul_f32 v33, v33, v34
    v_accvgpr_write_b32 a118, v33
    v_accvgpr_read_b32 v33, a119
    v_mul_f32 v33, v33, v34
    v_accvgpr_write_b32 a119, v33
    v_accvgpr_read_b32 v33, a120
    v_mul_f32 v33, v33, v34
    v_accvgpr_write_b32 a120, v33
    v_accvgpr_read_b32 v33, a121
    v_mul_f32 v33, v33, v34
    v_accvgpr_write_b32 a121, v33
    v_accvgpr_read_b32 v33, a122
    v_mul_f32 v33, v33, v34
    v_accvgpr_write_b32 a122, v33
    v_accvgpr_read_b32 v33, a123
    v_mul_f32 v33, v33, v34
    v_accvgpr_write_b32 a123, v33
    v_accvgpr_read_b32 v33, a124
    v_mul_f32 v33, v33, v34
    v_accvgpr_write_b32 a124, v33
    v_accvgpr_read_b32 v33, a125
    v_mul_f32 v33, v33, v34
    v_accvgpr_write_b32 a125, v33
    v_accvgpr_read_b32 v33, a126
    v_mul_f32 v33, v33, v34
    v_accvgpr_write_b32 a126, v33
    v_accvgpr_read_b32 v33, a127
    v_mul_f32 v33, v33, v34
    v_accvgpr_write_b32 a127, v33
    v_exp_f32 v36, v168
    v_exp_f32 v37, v169
    s_nop 0
    v_cvt_pk_bf16_f32 v220, v36, v37
    v_exp_f32 v36, v170
    v_exp_f32 v37, v171
    s_nop 0
    v_cvt_pk_bf16_f32 v221, v36, v37
    v_exp_f32 v36, v172
    v_exp_f32 v37, v173
    s_nop 0
    v_cvt_pk_bf16_f32 v222, v36, v37
    v_exp_f32 v36, v174
    v_exp_f32 v37, v175
    s_nop 0
    v_cvt_pk_bf16_f32 v223, v36, v37
    s_nop 1
    s_branch gated_mix__ssm_conv_h3__compressed_kv_cla__prompt_kernel_b3_r0_ret
gated_mix__ssm_conv_h3__compressed_kv_cla__prompt_kernel_b3_r1:
    s_nop 7
    v_max3_f32 v32, v184, v185, v186
    v_max3_f32 v32, v187, v188, v32
    v_max3_f32 v32, v189, v190, v32
    v_max_f32 v32, v191, v32
    v_mov_b32 v33, v32
    s_nop 1
    v_permlane16_swap_b32 v32, v33
    s_nop 1
    v_max_f32 v32, v32, v33
    v_mov_b32 v33, v32
    s_nop 1
    v_permlane32_swap_b32 v32, v33
    s_nop 1
    v_max_f32 v32, v32, v33
    v_add_f32 v32, 0x41c00000, v32
    v_max_f32 v32, 0, v32
    v_exp_f32 v34, -v32
    v_sub_f32 v68, v68, v32
    v_sub_f32 v69, v69, v32
    v_sub_f32 v70, v70, v32
    v_sub_f32 v71, v71, v32
    v_sub_f32 v184, v184, v32
    v_sub_f32 v185, v185, v32
    v_sub_f32 v186, v186, v32
    v_sub_f32 v187, v187, v32
    v_sub_f32 v188, v188, v32
    v_sub_f32 v189, v189, v32
    v_sub_f32 v190, v190, v32
    v_sub_f32 v191, v191, v32
    v_sub_f32 v152, v152, v32
    v_sub_f32 v153, v153, v32
    v_sub_f32 v154, v154, v32
    v_sub_f32 v155, v155, v32
    v_sub_f32 v156, v156, v32
    v_sub_f32 v157, v157, v32
    v_sub_f32 v158, v158, v32
    v_sub_f32 v159, v159, v32
    v_mul_f32 v244, v244, v34
    v_mul_f32 v245, v245, v34
    v_mul_f32 v246, v246, v34
    v_mul_f32 v247, v247, v34
    v_accvgpr_read_b32 v33, a32
    v_mul_f32 v33, v33, v34
    v_accvgpr_write_b32 a32, v33
    v_accvgpr_read_b32 v33, a33
    v_mul_f32 v33, v33, v34
    v_accvgpr_write_b32 a33, v33
    v_accvgpr_read_b32 v33, a34
    v_mul_f32 v33, v33, v34
    v_accvgpr_write_b32 a34, v33
    v_accvgpr_read_b32 v33, a35
    v_mul_f32 v33, v33, v34
    v_accvgpr_write_b32 a35, v33
    v_accvgpr_read_b32 v33, a36
    v_mul_f32 v33, v33, v34
    v_accvgpr_write_b32 a36, v33
    v_accvgpr_read_b32 v33, a37
    v_mul_f32 v33, v33, v34
    v_accvgpr_write_b32 a37, v33
    v_accvgpr_read_b32 v33, a38
    v_mul_f32 v33, v33, v34
    v_accvgpr_write_b32 a38, v33
    v_accvgpr_read_b32 v33, a39
    v_mul_f32 v33, v33, v34
    v_accvgpr_write_b32 a39, v33
    v_accvgpr_read_b32 v33, a40
    v_mul_f32 v33, v33, v34
    v_accvgpr_write_b32 a40, v33
    v_accvgpr_read_b32 v33, a41
    v_mul_f32 v33, v33, v34
    v_accvgpr_write_b32 a41, v33
    v_accvgpr_read_b32 v33, a42
    v_mul_f32 v33, v33, v34
    v_accvgpr_write_b32 a42, v33
    v_accvgpr_read_b32 v33, a43
    v_mul_f32 v33, v33, v34
    v_accvgpr_write_b32 a43, v33
    v_accvgpr_read_b32 v33, a44
    v_mul_f32 v33, v33, v34
    v_accvgpr_write_b32 a44, v33
    v_accvgpr_read_b32 v33, a45
    v_mul_f32 v33, v33, v34
    v_accvgpr_write_b32 a45, v33
    v_accvgpr_read_b32 v33, a46
    v_mul_f32 v33, v33, v34
    v_accvgpr_write_b32 a46, v33
    v_accvgpr_read_b32 v33, a47
    v_mul_f32 v33, v33, v34
    v_accvgpr_write_b32 a47, v33
    v_accvgpr_read_b32 v33, a48
    v_mul_f32 v33, v33, v34
    v_accvgpr_write_b32 a48, v33
    v_accvgpr_read_b32 v33, a49
    v_mul_f32 v33, v33, v34
    v_accvgpr_write_b32 a49, v33
    v_accvgpr_read_b32 v33, a50
    v_mul_f32 v33, v33, v34
    v_accvgpr_write_b32 a50, v33
    v_accvgpr_read_b32 v33, a51
    v_mul_f32 v33, v33, v34
    v_accvgpr_write_b32 a51, v33
    v_accvgpr_read_b32 v33, a52
    v_mul_f32 v33, v33, v34
    v_accvgpr_write_b32 a52, v33
    v_accvgpr_read_b32 v33, a53
    v_mul_f32 v33, v33, v34
    v_accvgpr_write_b32 a53, v33
    v_accvgpr_read_b32 v33, a54
    v_mul_f32 v33, v33, v34
    v_accvgpr_write_b32 a54, v33
    v_accvgpr_read_b32 v33, a55
    v_mul_f32 v33, v33, v34
    v_accvgpr_write_b32 a55, v33
    v_accvgpr_read_b32 v33, a56
    v_mul_f32 v33, v33, v34
    v_accvgpr_write_b32 a56, v33
    v_accvgpr_read_b32 v33, a57
    v_mul_f32 v33, v33, v34
    v_accvgpr_write_b32 a57, v33
    v_accvgpr_read_b32 v33, a58
    v_mul_f32 v33, v33, v34
    v_accvgpr_write_b32 a58, v33
    v_accvgpr_read_b32 v33, a59
    v_mul_f32 v33, v33, v34
    v_accvgpr_write_b32 a59, v33
    v_accvgpr_read_b32 v33, a60
    v_mul_f32 v33, v33, v34
    v_accvgpr_write_b32 a60, v33
    v_accvgpr_read_b32 v33, a61
    v_mul_f32 v33, v33, v34
    v_accvgpr_write_b32 a61, v33
    v_accvgpr_read_b32 v33, a62
    v_mul_f32 v33, v33, v34
    v_accvgpr_write_b32 a62, v33
    v_accvgpr_read_b32 v33, a63
    v_mul_f32 v33, v33, v34
    v_accvgpr_write_b32 a63, v33
    v_exp_f32 v36, v184
    v_exp_f32 v37, v185
    s_nop 0
    v_cvt_pk_bf16_f32 v228, v36, v37
    v_exp_f32 v36, v186
    v_exp_f32 v37, v187
    s_nop 0
    v_cvt_pk_bf16_f32 v229, v36, v37
    v_exp_f32 v36, v188
    v_exp_f32 v37, v189
    s_nop 0
    v_cvt_pk_bf16_f32 v230, v36, v37
    v_exp_f32 v36, v190
    v_exp_f32 v37, v191
    s_nop 0
    v_cvt_pk_bf16_f32 v231, v36, v37
    v_max3_f32 v32, v192, v193, v194
    v_max3_f32 v32, v195, v196, v32
    v_max3_f32 v32, v197, v198, v32
    v_max_f32 v32, v199, v32
    v_mov_b32 v33, v32
    s_nop 1
    v_permlane16_swap_b32 v32, v33
    s_nop 1
    v_max_f32 v32, v32, v33
    v_mov_b32 v33, v32
    s_nop 1
    v_permlane32_swap_b32 v32, v33
    s_nop 1
    v_max_f32 v32, v32, v33
    v_add_f32 v32, 0x41c00000, v32
    v_max_f32 v32, 0, v32
    v_exp_f32 v34, -v32
    v_sub_f32 v72, v72, v32
    v_sub_f32 v73, v73, v32
    v_sub_f32 v74, v74, v32
    v_sub_f32 v75, v75, v32
    v_sub_f32 v192, v192, v32
    v_sub_f32 v193, v193, v32
    v_sub_f32 v194, v194, v32
    v_sub_f32 v195, v195, v32
    v_sub_f32 v196, v196, v32
    v_sub_f32 v197, v197, v32
    v_sub_f32 v198, v198, v32
    v_sub_f32 v199, v199, v32
    v_sub_f32 v160, v160, v32
    v_sub_f32 v161, v161, v32
    v_sub_f32 v162, v162, v32
    v_sub_f32 v163, v163, v32
    v_sub_f32 v164, v164, v32
    v_sub_f32 v165, v165, v32
    v_sub_f32 v166, v166, v32
    v_sub_f32 v167, v167, v32
    v_mul_f32 v248, v248, v34
    v_mul_f32 v249, v249, v34
    v_mul_f32 v250, v250, v34
    v_mul_f32 v251, v251, v34
    v_accvgpr_read_b32 v33, a64
    v_mul_f32 v33, v33, v34
    v_accvgpr_write_b32 a64, v33
    v_accvgpr_read_b32 v33, a65
    v_mul_f32 v33, v33, v34
    v_accvgpr_write_b32 a65, v33
    v_accvgpr_read_b32 v33, a66
    v_mul_f32 v33, v33, v34
    v_accvgpr_write_b32 a66, v33
    v_accvgpr_read_b32 v33, a67
    v_mul_f32 v33, v33, v34
    v_accvgpr_write_b32 a67, v33
    v_accvgpr_read_b32 v33, a68
    v_mul_f32 v33, v33, v34
    v_accvgpr_write_b32 a68, v33
    v_accvgpr_read_b32 v33, a69
    v_mul_f32 v33, v33, v34
    v_accvgpr_write_b32 a69, v33
    v_accvgpr_read_b32 v33, a70
    v_mul_f32 v33, v33, v34
    v_accvgpr_write_b32 a70, v33
    v_accvgpr_read_b32 v33, a71
    v_mul_f32 v33, v33, v34
    v_accvgpr_write_b32 a71, v33
    v_accvgpr_read_b32 v33, a72
    v_mul_f32 v33, v33, v34
    v_accvgpr_write_b32 a72, v33
    v_accvgpr_read_b32 v33, a73
    v_mul_f32 v33, v33, v34
    v_accvgpr_write_b32 a73, v33
    v_accvgpr_read_b32 v33, a74
    v_mul_f32 v33, v33, v34
    v_accvgpr_write_b32 a74, v33
    v_accvgpr_read_b32 v33, a75
    v_mul_f32 v33, v33, v34
    v_accvgpr_write_b32 a75, v33
    v_accvgpr_read_b32 v33, a76
    v_mul_f32 v33, v33, v34
    v_accvgpr_write_b32 a76, v33
    v_accvgpr_read_b32 v33, a77
    v_mul_f32 v33, v33, v34
    v_accvgpr_write_b32 a77, v33
    v_accvgpr_read_b32 v33, a78
    v_mul_f32 v33, v33, v34
    v_accvgpr_write_b32 a78, v33
    v_accvgpr_read_b32 v33, a79
    v_mul_f32 v33, v33, v34
    v_accvgpr_write_b32 a79, v33
    v_accvgpr_read_b32 v33, a80
    v_mul_f32 v33, v33, v34
    v_accvgpr_write_b32 a80, v33
    v_accvgpr_read_b32 v33, a81
    v_mul_f32 v33, v33, v34
    v_accvgpr_write_b32 a81, v33
    v_accvgpr_read_b32 v33, a82
    v_mul_f32 v33, v33, v34
    v_accvgpr_write_b32 a82, v33
    v_accvgpr_read_b32 v33, a83
    v_mul_f32 v33, v33, v34
    v_accvgpr_write_b32 a83, v33
    v_accvgpr_read_b32 v33, a84
    v_mul_f32 v33, v33, v34
    v_accvgpr_write_b32 a84, v33
    v_accvgpr_read_b32 v33, a85
    v_mul_f32 v33, v33, v34
    v_accvgpr_write_b32 a85, v33
    v_accvgpr_read_b32 v33, a86
    v_mul_f32 v33, v33, v34
    v_accvgpr_write_b32 a86, v33
    v_accvgpr_read_b32 v33, a87
    v_mul_f32 v33, v33, v34
    v_accvgpr_write_b32 a87, v33
    v_accvgpr_read_b32 v33, a88
    v_mul_f32 v33, v33, v34
    v_accvgpr_write_b32 a88, v33
    v_accvgpr_read_b32 v33, a89
    v_mul_f32 v33, v33, v34
    v_accvgpr_write_b32 a89, v33
    v_accvgpr_read_b32 v33, a90
    v_mul_f32 v33, v33, v34
    v_accvgpr_write_b32 a90, v33
    v_accvgpr_read_b32 v33, a91
    v_mul_f32 v33, v33, v34
    v_accvgpr_write_b32 a91, v33
    v_accvgpr_read_b32 v33, a92
    v_mul_f32 v33, v33, v34
    v_accvgpr_write_b32 a92, v33
    v_accvgpr_read_b32 v33, a93
    v_mul_f32 v33, v33, v34
    v_accvgpr_write_b32 a93, v33
    v_accvgpr_read_b32 v33, a94
    v_mul_f32 v33, v33, v34
    v_accvgpr_write_b32 a94, v33
    v_accvgpr_read_b32 v33, a95
    v_mul_f32 v33, v33, v34
    v_accvgpr_write_b32 a95, v33
    v_exp_f32 v36, v192
    v_exp_f32 v37, v193
    s_nop 0
    v_cvt_pk_bf16_f32 v232, v36, v37
    v_exp_f32 v36, v194
    v_exp_f32 v37, v195
    s_nop 0
    v_cvt_pk_bf16_f32 v233, v36, v37
    v_exp_f32 v36, v196
    v_exp_f32 v37, v197
    s_nop 0
    v_cvt_pk_bf16_f32 v234, v36, v37
    v_exp_f32 v36, v198
    v_exp_f32 v37, v199
    s_nop 0
    v_cvt_pk_bf16_f32 v235, v36, v37
    v_max3_f32 v32, v200, v201, v202
    v_max3_f32 v32, v203, v204, v32
    v_max3_f32 v32, v205, v206, v32
    v_max_f32 v32, v207, v32
    v_mov_b32 v33, v32
    s_nop 1
    v_permlane16_swap_b32 v32, v33
    s_nop 1
    v_max_f32 v32, v32, v33
    v_mov_b32 v33, v32
    s_nop 1
    v_permlane32_swap_b32 v32, v33
    s_nop 1
    v_max_f32 v32, v32, v33
    v_add_f32 v32, 0x41c00000, v32
    v_max_f32 v32, 0, v32
    v_exp_f32 v34, -v32
    v_sub_f32 v76, v76, v32
    v_sub_f32 v77, v77, v32
    v_sub_f32 v78, v78, v32
    v_sub_f32 v79, v79, v32
    v_sub_f32 v200, v200, v32
    v_sub_f32 v201, v201, v32
    v_sub_f32 v202, v202, v32
    v_sub_f32 v203, v203, v32
    v_sub_f32 v204, v204, v32
    v_sub_f32 v205, v205, v32
    v_sub_f32 v206, v206, v32
    v_sub_f32 v207, v207, v32
    v_sub_f32 v168, v168, v32
    v_sub_f32 v169, v169, v32
    v_sub_f32 v170, v170, v32
    v_sub_f32 v171, v171, v32
    v_sub_f32 v172, v172, v32
    v_sub_f32 v173, v173, v32
    v_sub_f32 v174, v174, v32
    v_sub_f32 v175, v175, v32
    v_mul_f32 v252, v252, v34
    v_mul_f32 v253, v253, v34
    v_mul_f32 v254, v254, v34
    v_mul_f32 v255, v255, v34
    v_accvgpr_read_b32 v33, a96
    v_mul_f32 v33, v33, v34
    v_accvgpr_write_b32 a96, v33
    v_accvgpr_read_b32 v33, a97
    v_mul_f32 v33, v33, v34
    v_accvgpr_write_b32 a97, v33
    v_accvgpr_read_b32 v33, a98
    v_mul_f32 v33, v33, v34
    v_accvgpr_write_b32 a98, v33
    v_accvgpr_read_b32 v33, a99
    v_mul_f32 v33, v33, v34
    v_accvgpr_write_b32 a99, v33
    v_accvgpr_read_b32 v33, a100
    v_mul_f32 v33, v33, v34
    v_accvgpr_write_b32 a100, v33
    v_accvgpr_read_b32 v33, a101
    v_mul_f32 v33, v33, v34
    v_accvgpr_write_b32 a101, v33
    v_accvgpr_read_b32 v33, a102
    v_mul_f32 v33, v33, v34
    v_accvgpr_write_b32 a102, v33
    v_accvgpr_read_b32 v33, a103
    v_mul_f32 v33, v33, v34
    v_accvgpr_write_b32 a103, v33
    v_accvgpr_read_b32 v33, a104
    v_mul_f32 v33, v33, v34
    v_accvgpr_write_b32 a104, v33
    v_accvgpr_read_b32 v33, a105
    v_mul_f32 v33, v33, v34
    v_accvgpr_write_b32 a105, v33
    v_accvgpr_read_b32 v33, a106
    v_mul_f32 v33, v33, v34
    v_accvgpr_write_b32 a106, v33
    v_accvgpr_read_b32 v33, a107
    v_mul_f32 v33, v33, v34
    v_accvgpr_write_b32 a107, v33
    v_accvgpr_read_b32 v33, a108
    v_mul_f32 v33, v33, v34
    v_accvgpr_write_b32 a108, v33
    v_accvgpr_read_b32 v33, a109
    v_mul_f32 v33, v33, v34
    v_accvgpr_write_b32 a109, v33
    v_accvgpr_read_b32 v33, a110
    v_mul_f32 v33, v33, v34
    v_accvgpr_write_b32 a110, v33
    v_accvgpr_read_b32 v33, a111
    v_mul_f32 v33, v33, v34
    v_accvgpr_write_b32 a111, v33
    v_accvgpr_read_b32 v33, a112
    v_mul_f32 v33, v33, v34
    v_accvgpr_write_b32 a112, v33
    v_accvgpr_read_b32 v33, a113
    v_mul_f32 v33, v33, v34
    v_accvgpr_write_b32 a113, v33
    v_accvgpr_read_b32 v33, a114
    v_mul_f32 v33, v33, v34
    v_accvgpr_write_b32 a114, v33
    v_accvgpr_read_b32 v33, a115
    v_mul_f32 v33, v33, v34
    v_accvgpr_write_b32 a115, v33
    v_accvgpr_read_b32 v33, a116
    v_mul_f32 v33, v33, v34
    v_accvgpr_write_b32 a116, v33
    v_accvgpr_read_b32 v33, a117
    v_mul_f32 v33, v33, v34
    v_accvgpr_write_b32 a117, v33
    v_accvgpr_read_b32 v33, a118
    v_mul_f32 v33, v33, v34
    v_accvgpr_write_b32 a118, v33
    v_accvgpr_read_b32 v33, a119
    v_mul_f32 v33, v33, v34
    v_accvgpr_write_b32 a119, v33
    v_accvgpr_read_b32 v33, a120
    v_mul_f32 v33, v33, v34
    v_accvgpr_write_b32 a120, v33
    v_accvgpr_read_b32 v33, a121
    v_mul_f32 v33, v33, v34
    v_accvgpr_write_b32 a121, v33
    v_accvgpr_read_b32 v33, a122
    v_mul_f32 v33, v33, v34
    v_accvgpr_write_b32 a122, v33
    v_accvgpr_read_b32 v33, a123
    v_mul_f32 v33, v33, v34
    v_accvgpr_write_b32 a123, v33
    v_accvgpr_read_b32 v33, a124
    v_mul_f32 v33, v33, v34
    v_accvgpr_write_b32 a124, v33
    v_accvgpr_read_b32 v33, a125
    v_mul_f32 v33, v33, v34
    v_accvgpr_write_b32 a125, v33
    v_accvgpr_read_b32 v33, a126
    v_mul_f32 v33, v33, v34
    v_accvgpr_write_b32 a126, v33
    v_accvgpr_read_b32 v33, a127
    v_mul_f32 v33, v33, v34
    v_accvgpr_write_b32 a127, v33
    v_exp_f32 v36, v200
    v_exp_f32 v37, v201
    s_nop 0
    v_cvt_pk_bf16_f32 v236, v36, v37
    v_exp_f32 v36, v202
    v_exp_f32 v37, v203
    s_nop 0
    v_cvt_pk_bf16_f32 v237, v36, v37
    v_exp_f32 v36, v204
    v_exp_f32 v37, v205
    s_nop 0
    v_cvt_pk_bf16_f32 v238, v36, v37
    v_exp_f32 v36, v206
    v_exp_f32 v37, v207
    s_nop 0
    v_cvt_pk_bf16_f32 v239, v36, v37
    s_nop 1
    s_branch gated_mix__ssm_conv_h3__compressed_kv_cla__prompt_kernel_b3_r1_ret
gated_mix__ssm_conv_h3__compressed_kv_cla__prompt_kernel_b2_r0:
    s_nop 7
    v_max3_f32 v32, v160, v161, v162
    v_max3_f32 v32, v163, v164, v32
    v_max3_f32 v32, v165, v166, v32
    v_max_f32 v32, v167, v32
    v_mov_b32 v33, v32
    s_nop 1
    v_permlane16_swap_b32 v32, v33
    s_nop 1
    v_max_f32 v32, v32, v33
    v_mov_b32 v33, v32
    s_nop 1
    v_permlane32_swap_b32 v32, v33
    s_nop 1
    v_max_f32 v32, v32, v33
    v_add_f32 v32, 0x41c00000, v32
    v_max_f32 v32, 0, v32
    v_exp_f32 v34, -v32
    v_sub_f32 v72, v72, v32
    v_sub_f32 v73, v73, v32
    v_sub_f32 v74, v74, v32
    v_sub_f32 v75, v75, v32
    v_sub_f32 v160, v160, v32
    v_sub_f32 v161, v161, v32
    v_sub_f32 v162, v162, v32
    v_sub_f32 v163, v163, v32
    v_sub_f32 v164, v164, v32
    v_sub_f32 v165, v165, v32
    v_sub_f32 v166, v166, v32
    v_sub_f32 v167, v167, v32
    v_sub_f32 v192, v192, v32
    v_sub_f32 v193, v193, v32
    v_sub_f32 v194, v194, v32
    v_sub_f32 v195, v195, v32
    v_sub_f32 v196, v196, v32
    v_sub_f32 v197, v197, v32
    v_sub_f32 v198, v198, v32
    v_sub_f32 v199, v199, v32
    v_mul_f32 v248, v248, v34
    v_mul_f32 v249, v249, v34
    v_mul_f32 v250, v250, v34
    v_mul_f32 v251, v251, v34
    v_accvgpr_read_b32 v33, a64
    v_mul_f32 v33, v33, v34
    v_accvgpr_write_b32 a64, v33
    v_accvgpr_read_b32 v33, a65
    v_mul_f32 v33, v33, v34
    v_accvgpr_write_b32 a65, v33
    v_accvgpr_read_b32 v33, a66
    v_mul_f32 v33, v33, v34
    v_accvgpr_write_b32 a66, v33
    v_accvgpr_read_b32 v33, a67
    v_mul_f32 v33, v33, v34
    v_accvgpr_write_b32 a67, v33
    v_accvgpr_read_b32 v33, a68
    v_mul_f32 v33, v33, v34
    v_accvgpr_write_b32 a68, v33
    v_accvgpr_read_b32 v33, a69
    v_mul_f32 v33, v33, v34
    v_accvgpr_write_b32 a69, v33
    v_accvgpr_read_b32 v33, a70
    v_mul_f32 v33, v33, v34
    v_accvgpr_write_b32 a70, v33
    v_accvgpr_read_b32 v33, a71
    v_mul_f32 v33, v33, v34
    v_accvgpr_write_b32 a71, v33
    v_accvgpr_read_b32 v33, a72
    v_mul_f32 v33, v33, v34
    v_accvgpr_write_b32 a72, v33
    v_accvgpr_read_b32 v33, a73
    v_mul_f32 v33, v33, v34
    v_accvgpr_write_b32 a73, v33
    v_accvgpr_read_b32 v33, a74
    v_mul_f32 v33, v33, v34
    v_accvgpr_write_b32 a74, v33
    v_accvgpr_read_b32 v33, a75
    v_mul_f32 v33, v33, v34
    v_accvgpr_write_b32 a75, v33
    v_accvgpr_read_b32 v33, a76
    v_mul_f32 v33, v33, v34
    v_accvgpr_write_b32 a76, v33
    v_accvgpr_read_b32 v33, a77
    v_mul_f32 v33, v33, v34
    v_accvgpr_write_b32 a77, v33
    v_accvgpr_read_b32 v33, a78
    v_mul_f32 v33, v33, v34
    v_accvgpr_write_b32 a78, v33
    v_accvgpr_read_b32 v33, a79
    v_mul_f32 v33, v33, v34
    v_accvgpr_write_b32 a79, v33
    v_accvgpr_read_b32 v33, a80
    v_mul_f32 v33, v33, v34
    v_accvgpr_write_b32 a80, v33
    v_accvgpr_read_b32 v33, a81
    v_mul_f32 v33, v33, v34
    v_accvgpr_write_b32 a81, v33
    v_accvgpr_read_b32 v33, a82
    v_mul_f32 v33, v33, v34
    v_accvgpr_write_b32 a82, v33
    v_accvgpr_read_b32 v33, a83
    v_mul_f32 v33, v33, v34
    v_accvgpr_write_b32 a83, v33
    v_accvgpr_read_b32 v33, a84
    v_mul_f32 v33, v33, v34
    v_accvgpr_write_b32 a84, v33
    v_accvgpr_read_b32 v33, a85
    v_mul_f32 v33, v33, v34
    v_accvgpr_write_b32 a85, v33
    v_accvgpr_read_b32 v33, a86
    v_mul_f32 v33, v33, v34
    v_accvgpr_write_b32 a86, v33
    v_accvgpr_read_b32 v33, a87
    v_mul_f32 v33, v33, v34
    v_accvgpr_write_b32 a87, v33
    v_accvgpr_read_b32 v33, a88
    v_mul_f32 v33, v33, v34
    v_accvgpr_write_b32 a88, v33
    v_accvgpr_read_b32 v33, a89
    v_mul_f32 v33, v33, v34
    v_accvgpr_write_b32 a89, v33
    v_accvgpr_read_b32 v33, a90
    v_mul_f32 v33, v33, v34
    v_accvgpr_write_b32 a90, v33
    v_accvgpr_read_b32 v33, a91
    v_mul_f32 v33, v33, v34
    v_accvgpr_write_b32 a91, v33
    v_accvgpr_read_b32 v33, a92
    v_mul_f32 v33, v33, v34
    v_accvgpr_write_b32 a92, v33
    v_accvgpr_read_b32 v33, a93
    v_mul_f32 v33, v33, v34
    v_accvgpr_write_b32 a93, v33
    v_accvgpr_read_b32 v33, a94
    v_mul_f32 v33, v33, v34
    v_accvgpr_write_b32 a94, v33
    v_accvgpr_read_b32 v33, a95
    v_mul_f32 v33, v33, v34
    v_accvgpr_write_b32 a95, v33
    v_exp_f32 v36, v160
    v_exp_f32 v37, v161
    s_nop 0
    v_cvt_pk_bf16_f32 v216, v36, v37
    v_exp_f32 v36, v162
    v_exp_f32 v37, v163
    s_nop 0
    v_cvt_pk_bf16_f32 v217, v36, v37
    v_exp_f32 v36, v164
    v_exp_f32 v37, v165
    s_nop 0
    v_cvt_pk_bf16_f32 v218, v36, v37
    v_exp_f32 v36, v166
    v_exp_f32 v37, v167
    s_nop 0
    v_cvt_pk_bf16_f32 v219, v36, v37
    v_max3_f32 v32, v168, v169, v170
    v_max3_f32 v32, v171, v172, v32
    v_max3_f32 v32, v173, v174, v32
    v_max_f32 v32, v175, v32
    v_mov_b32 v33, v32
    s_nop 1
    v_permlane16_swap_b32 v32, v33
    s_nop 1
    v_max_f32 v32, v32, v33
    v_mov_b32 v33, v32
    s_nop 1
    v_permlane32_swap_b32 v32, v33
    s_nop 1
    v_max_f32 v32, v32, v33
    v_add_f32 v32, 0x41c00000, v32
    v_max_f32 v32, 0, v32
    v_exp_f32 v34, -v32
    v_sub_f32 v76, v76, v32
    v_sub_f32 v77, v77, v32
    v_sub_f32 v78, v78, v32
    v_sub_f32 v79, v79, v32
    v_sub_f32 v168, v168, v32
    v_sub_f32 v169, v169, v32
    v_sub_f32 v170, v170, v32
    v_sub_f32 v171, v171, v32
    v_sub_f32 v172, v172, v32
    v_sub_f32 v173, v173, v32
    v_sub_f32 v174, v174, v32
    v_sub_f32 v175, v175, v32
    v_sub_f32 v200, v200, v32
    v_sub_f32 v201, v201, v32
    v_sub_f32 v202, v202, v32
    v_sub_f32 v203, v203, v32
    v_sub_f32 v204, v204, v32
    v_sub_f32 v205, v205, v32
    v_sub_f32 v206, v206, v32
    v_sub_f32 v207, v207, v32
    v_mul_f32 v252, v252, v34
    v_mul_f32 v253, v253, v34
    v_mul_f32 v254, v254, v34
    v_mul_f32 v255, v255, v34
    v_accvgpr_read_b32 v33, a96
    v_mul_f32 v33, v33, v34
    v_accvgpr_write_b32 a96, v33
    v_accvgpr_read_b32 v33, a97
    v_mul_f32 v33, v33, v34
    v_accvgpr_write_b32 a97, v33
    v_accvgpr_read_b32 v33, a98
    v_mul_f32 v33, v33, v34
    v_accvgpr_write_b32 a98, v33
    v_accvgpr_read_b32 v33, a99
    v_mul_f32 v33, v33, v34
    v_accvgpr_write_b32 a99, v33
    v_accvgpr_read_b32 v33, a100
    v_mul_f32 v33, v33, v34
    v_accvgpr_write_b32 a100, v33
    v_accvgpr_read_b32 v33, a101
    v_mul_f32 v33, v33, v34
    v_accvgpr_write_b32 a101, v33
    v_accvgpr_read_b32 v33, a102
    v_mul_f32 v33, v33, v34
    v_accvgpr_write_b32 a102, v33
    v_accvgpr_read_b32 v33, a103
    v_mul_f32 v33, v33, v34
    v_accvgpr_write_b32 a103, v33
    v_accvgpr_read_b32 v33, a104
    v_mul_f32 v33, v33, v34
    v_accvgpr_write_b32 a104, v33
    v_accvgpr_read_b32 v33, a105
    v_mul_f32 v33, v33, v34
    v_accvgpr_write_b32 a105, v33
    v_accvgpr_read_b32 v33, a106
    v_mul_f32 v33, v33, v34
    v_accvgpr_write_b32 a106, v33
    v_accvgpr_read_b32 v33, a107
    v_mul_f32 v33, v33, v34
    v_accvgpr_write_b32 a107, v33
    v_accvgpr_read_b32 v33, a108
    v_mul_f32 v33, v33, v34
    v_accvgpr_write_b32 a108, v33
    v_accvgpr_read_b32 v33, a109
    v_mul_f32 v33, v33, v34
    v_accvgpr_write_b32 a109, v33
    v_accvgpr_read_b32 v33, a110
    v_mul_f32 v33, v33, v34
    v_accvgpr_write_b32 a110, v33
    v_accvgpr_read_b32 v33, a111
    v_mul_f32 v33, v33, v34
    v_accvgpr_write_b32 a111, v33
    v_accvgpr_read_b32 v33, a112
    v_mul_f32 v33, v33, v34
    v_accvgpr_write_b32 a112, v33
    v_accvgpr_read_b32 v33, a113
    v_mul_f32 v33, v33, v34
    v_accvgpr_write_b32 a113, v33
    v_accvgpr_read_b32 v33, a114
    v_mul_f32 v33, v33, v34
    v_accvgpr_write_b32 a114, v33
    v_accvgpr_read_b32 v33, a115
    v_mul_f32 v33, v33, v34
    v_accvgpr_write_b32 a115, v33
    v_accvgpr_read_b32 v33, a116
    v_mul_f32 v33, v33, v34
    v_accvgpr_write_b32 a116, v33
    v_accvgpr_read_b32 v33, a117
    v_mul_f32 v33, v33, v34
    v_accvgpr_write_b32 a117, v33
    v_accvgpr_read_b32 v33, a118
    v_mul_f32 v33, v33, v34
    v_accvgpr_write_b32 a118, v33
    v_accvgpr_read_b32 v33, a119
    v_mul_f32 v33, v33, v34
    v_accvgpr_write_b32 a119, v33
    v_accvgpr_read_b32 v33, a120
    v_mul_f32 v33, v33, v34
    v_accvgpr_write_b32 a120, v33
    v_accvgpr_read_b32 v33, a121
    v_mul_f32 v33, v33, v34
    v_accvgpr_write_b32 a121, v33
    v_accvgpr_read_b32 v33, a122
    v_mul_f32 v33, v33, v34
    v_accvgpr_write_b32 a122, v33
    v_accvgpr_read_b32 v33, a123
    v_mul_f32 v33, v33, v34
    v_accvgpr_write_b32 a123, v33
    v_accvgpr_read_b32 v33, a124
    v_mul_f32 v33, v33, v34
    v_accvgpr_write_b32 a124, v33
    v_accvgpr_read_b32 v33, a125
    v_mul_f32 v33, v33, v34
    v_accvgpr_write_b32 a125, v33
    v_accvgpr_read_b32 v33, a126
    v_mul_f32 v33, v33, v34
    v_accvgpr_write_b32 a126, v33
    v_accvgpr_read_b32 v33, a127
    v_mul_f32 v33, v33, v34
    v_accvgpr_write_b32 a127, v33
    v_exp_f32 v36, v168
    v_exp_f32 v37, v169
    s_nop 0
    v_cvt_pk_bf16_f32 v220, v36, v37
    v_exp_f32 v36, v170
    v_exp_f32 v37, v171
    s_nop 0
    v_cvt_pk_bf16_f32 v221, v36, v37
    v_exp_f32 v36, v172
    v_exp_f32 v37, v173
    s_nop 0
    v_cvt_pk_bf16_f32 v222, v36, v37
    v_exp_f32 v36, v174
    v_exp_f32 v37, v175
    s_nop 0
    v_cvt_pk_bf16_f32 v223, v36, v37
    s_nop 1
    s_branch gated_mix__ssm_conv_h3__compressed_kv_cla__prompt_kernel_b2_r0_ret
gated_mix__ssm_conv_h3__compressed_kv_cla__prompt_kernel_b2_r1:
    s_nop 7
    v_max3_f32 v32, v192, v193, v194
    v_max3_f32 v32, v195, v196, v32
    v_max3_f32 v32, v197, v198, v32
    v_max_f32 v32, v199, v32
    v_mov_b32 v33, v32
    s_nop 1
    v_permlane16_swap_b32 v32, v33
    s_nop 1
    v_max_f32 v32, v32, v33
    v_mov_b32 v33, v32
    s_nop 1
    v_permlane32_swap_b32 v32, v33
    s_nop 1
    v_max_f32 v32, v32, v33
    v_add_f32 v32, 0x41c00000, v32
    v_max_f32 v32, 0, v32
    v_exp_f32 v34, -v32
    v_sub_f32 v72, v72, v32
    v_sub_f32 v73, v73, v32
    v_sub_f32 v74, v74, v32
    v_sub_f32 v75, v75, v32
    v_sub_f32 v192, v192, v32
    v_sub_f32 v193, v193, v32
    v_sub_f32 v194, v194, v32
    v_sub_f32 v195, v195, v32
    v_sub_f32 v196, v196, v32
    v_sub_f32 v197, v197, v32
    v_sub_f32 v198, v198, v32
    v_sub_f32 v199, v199, v32
    v_sub_f32 v160, v160, v32
    v_sub_f32 v161, v161, v32
    v_sub_f32 v162, v162, v32
    v_sub_f32 v163, v163, v32
    v_sub_f32 v164, v164, v32
    v_sub_f32 v165, v165, v32
    v_sub_f32 v166, v166, v32
    v_sub_f32 v167, v167, v32
    v_mul_f32 v248, v248, v34
    v_mul_f32 v249, v249, v34
    v_mul_f32 v250, v250, v34
    v_mul_f32 v251, v251, v34
    v_accvgpr_read_b32 v33, a64
    v_mul_f32 v33, v33, v34
    v_accvgpr_write_b32 a64, v33
    v_accvgpr_read_b32 v33, a65
    v_mul_f32 v33, v33, v34
    v_accvgpr_write_b32 a65, v33
    v_accvgpr_read_b32 v33, a66
    v_mul_f32 v33, v33, v34
    v_accvgpr_write_b32 a66, v33
    v_accvgpr_read_b32 v33, a67
    v_mul_f32 v33, v33, v34
    v_accvgpr_write_b32 a67, v33
    v_accvgpr_read_b32 v33, a68
    v_mul_f32 v33, v33, v34
    v_accvgpr_write_b32 a68, v33
    v_accvgpr_read_b32 v33, a69
    v_mul_f32 v33, v33, v34
    v_accvgpr_write_b32 a69, v33
    v_accvgpr_read_b32 v33, a70
    v_mul_f32 v33, v33, v34
    v_accvgpr_write_b32 a70, v33
    v_accvgpr_read_b32 v33, a71
    v_mul_f32 v33, v33, v34
    v_accvgpr_write_b32 a71, v33
    v_accvgpr_read_b32 v33, a72
    v_mul_f32 v33, v33, v34
    v_accvgpr_write_b32 a72, v33
    v_accvgpr_read_b32 v33, a73
    v_mul_f32 v33, v33, v34
    v_accvgpr_write_b32 a73, v33
    v_accvgpr_read_b32 v33, a74
    v_mul_f32 v33, v33, v34
    v_accvgpr_write_b32 a74, v33
    v_accvgpr_read_b32 v33, a75
    v_mul_f32 v33, v33, v34
    v_accvgpr_write_b32 a75, v33
    v_accvgpr_read_b32 v33, a76
    v_mul_f32 v33, v33, v34
    v_accvgpr_write_b32 a76, v33
    v_accvgpr_read_b32 v33, a77
    v_mul_f32 v33, v33, v34
    v_accvgpr_write_b32 a77, v33
    v_accvgpr_read_b32 v33, a78
    v_mul_f32 v33, v33, v34
    v_accvgpr_write_b32 a78, v33
    v_accvgpr_read_b32 v33, a79
    v_mul_f32 v33, v33, v34
    v_accvgpr_write_b32 a79, v33
    v_accvgpr_read_b32 v33, a80
    v_mul_f32 v33, v33, v34
    v_accvgpr_write_b32 a80, v33
    v_accvgpr_read_b32 v33, a81
    v_mul_f32 v33, v33, v34
    v_accvgpr_write_b32 a81, v33
    v_accvgpr_read_b32 v33, a82
    v_mul_f32 v33, v33, v34
    v_accvgpr_write_b32 a82, v33
    v_accvgpr_read_b32 v33, a83
    v_mul_f32 v33, v33, v34
    v_accvgpr_write_b32 a83, v33
    v_accvgpr_read_b32 v33, a84
    v_mul_f32 v33, v33, v34
    v_accvgpr_write_b32 a84, v33
    v_accvgpr_read_b32 v33, a85
    v_mul_f32 v33, v33, v34
    v_accvgpr_write_b32 a85, v33
    v_accvgpr_read_b32 v33, a86
    v_mul_f32 v33, v33, v34
    v_accvgpr_write_b32 a86, v33
    v_accvgpr_read_b32 v33, a87
    v_mul_f32 v33, v33, v34
    v_accvgpr_write_b32 a87, v33
    v_accvgpr_read_b32 v33, a88
    v_mul_f32 v33, v33, v34
    v_accvgpr_write_b32 a88, v33
    v_accvgpr_read_b32 v33, a89
    v_mul_f32 v33, v33, v34
    v_accvgpr_write_b32 a89, v33
    v_accvgpr_read_b32 v33, a90
    v_mul_f32 v33, v33, v34
    v_accvgpr_write_b32 a90, v33
    v_accvgpr_read_b32 v33, a91
    v_mul_f32 v33, v33, v34
    v_accvgpr_write_b32 a91, v33
    v_accvgpr_read_b32 v33, a92
    v_mul_f32 v33, v33, v34
    v_accvgpr_write_b32 a92, v33
    v_accvgpr_read_b32 v33, a93
    v_mul_f32 v33, v33, v34
    v_accvgpr_write_b32 a93, v33
    v_accvgpr_read_b32 v33, a94
    v_mul_f32 v33, v33, v34
    v_accvgpr_write_b32 a94, v33
    v_accvgpr_read_b32 v33, a95
    v_mul_f32 v33, v33, v34
    v_accvgpr_write_b32 a95, v33
    v_exp_f32 v36, v192
    v_exp_f32 v37, v193
    s_nop 0
    v_cvt_pk_bf16_f32 v232, v36, v37
    v_exp_f32 v36, v194
    v_exp_f32 v37, v195
    s_nop 0
    v_cvt_pk_bf16_f32 v233, v36, v37
    v_exp_f32 v36, v196
    v_exp_f32 v37, v197
    s_nop 0
    v_cvt_pk_bf16_f32 v234, v36, v37
    v_exp_f32 v36, v198
    v_exp_f32 v37, v199
    s_nop 0
    v_cvt_pk_bf16_f32 v235, v36, v37
    v_max3_f32 v32, v200, v201, v202
    v_max3_f32 v32, v203, v204, v32
    v_max3_f32 v32, v205, v206, v32
    v_max_f32 v32, v207, v32
    v_mov_b32 v33, v32
    s_nop 1
    v_permlane16_swap_b32 v32, v33
    s_nop 1
    v_max_f32 v32, v32, v33
    v_mov_b32 v33, v32
    s_nop 1
    v_permlane32_swap_b32 v32, v33
    s_nop 1
    v_max_f32 v32, v32, v33
    v_add_f32 v32, 0x41c00000, v32
    v_max_f32 v32, 0, v32
    v_exp_f32 v34, -v32
    v_sub_f32 v76, v76, v32
    v_sub_f32 v77, v77, v32
    v_sub_f32 v78, v78, v32
    v_sub_f32 v79, v79, v32
    v_sub_f32 v200, v200, v32
    v_sub_f32 v201, v201, v32
    v_sub_f32 v202, v202, v32
    v_sub_f32 v203, v203, v32
    v_sub_f32 v204, v204, v32
    v_sub_f32 v205, v205, v32
    v_sub_f32 v206, v206, v32
    v_sub_f32 v207, v207, v32
    v_sub_f32 v168, v168, v32
    v_sub_f32 v169, v169, v32
    v_sub_f32 v170, v170, v32
    v_sub_f32 v171, v171, v32
    v_sub_f32 v172, v172, v32
    v_sub_f32 v173, v173, v32
    v_sub_f32 v174, v174, v32
    v_sub_f32 v175, v175, v32
    v_mul_f32 v252, v252, v34
    v_mul_f32 v253, v253, v34
    v_mul_f32 v254, v254, v34
    v_mul_f32 v255, v255, v34
    v_accvgpr_read_b32 v33, a96
    v_mul_f32 v33, v33, v34
    v_accvgpr_write_b32 a96, v33
    v_accvgpr_read_b32 v33, a97
    v_mul_f32 v33, v33, v34
    v_accvgpr_write_b32 a97, v33
    v_accvgpr_read_b32 v33, a98
    v_mul_f32 v33, v33, v34
    v_accvgpr_write_b32 a98, v33
    v_accvgpr_read_b32 v33, a99
    v_mul_f32 v33, v33, v34
    v_accvgpr_write_b32 a99, v33
    v_accvgpr_read_b32 v33, a100
    v_mul_f32 v33, v33, v34
    v_accvgpr_write_b32 a100, v33
    v_accvgpr_read_b32 v33, a101
    v_mul_f32 v33, v33, v34
    v_accvgpr_write_b32 a101, v33
    v_accvgpr_read_b32 v33, a102
    v_mul_f32 v33, v33, v34
    v_accvgpr_write_b32 a102, v33
    v_accvgpr_read_b32 v33, a103
    v_mul_f32 v33, v33, v34
    v_accvgpr_write_b32 a103, v33
    v_accvgpr_read_b32 v33, a104
    v_mul_f32 v33, v33, v34
    v_accvgpr_write_b32 a104, v33
    v_accvgpr_read_b32 v33, a105
    v_mul_f32 v33, v33, v34
    v_accvgpr_write_b32 a105, v33
    v_accvgpr_read_b32 v33, a106
    v_mul_f32 v33, v33, v34
    v_accvgpr_write_b32 a106, v33
    v_accvgpr_read_b32 v33, a107
    v_mul_f32 v33, v33, v34
    v_accvgpr_write_b32 a107, v33
    v_accvgpr_read_b32 v33, a108
    v_mul_f32 v33, v33, v34
    v_accvgpr_write_b32 a108, v33
    v_accvgpr_read_b32 v33, a109
    v_mul_f32 v33, v33, v34
    v_accvgpr_write_b32 a109, v33
    v_accvgpr_read_b32 v33, a110
    v_mul_f32 v33, v33, v34
    v_accvgpr_write_b32 a110, v33
    v_accvgpr_read_b32 v33, a111
    v_mul_f32 v33, v33, v34
    v_accvgpr_write_b32 a111, v33
    v_accvgpr_read_b32 v33, a112
    v_mul_f32 v33, v33, v34
    v_accvgpr_write_b32 a112, v33
    v_accvgpr_read_b32 v33, a113
    v_mul_f32 v33, v33, v34
    v_accvgpr_write_b32 a113, v33
    v_accvgpr_read_b32 v33, a114
    v_mul_f32 v33, v33, v34
    v_accvgpr_write_b32 a114, v33
    v_accvgpr_read_b32 v33, a115
    v_mul_f32 v33, v33, v34
    v_accvgpr_write_b32 a115, v33
    v_accvgpr_read_b32 v33, a116
    v_mul_f32 v33, v33, v34
    v_accvgpr_write_b32 a116, v33
    v_accvgpr_read_b32 v33, a117
    v_mul_f32 v33, v33, v34
    v_accvgpr_write_b32 a117, v33
    v_accvgpr_read_b32 v33, a118
    v_mul_f32 v33, v33, v34
    v_accvgpr_write_b32 a118, v33
    v_accvgpr_read_b32 v33, a119
    v_mul_f32 v33, v33, v34
    v_accvgpr_write_b32 a119, v33
    v_accvgpr_read_b32 v33, a120
    v_mul_f32 v33, v33, v34
    v_accvgpr_write_b32 a120, v33
    v_accvgpr_read_b32 v33, a121
    v_mul_f32 v33, v33, v34
    v_accvgpr_write_b32 a121, v33
    v_accvgpr_read_b32 v33, a122
    v_mul_f32 v33, v33, v34
    v_accvgpr_write_b32 a122, v33
    v_accvgpr_read_b32 v33, a123
    v_mul_f32 v33, v33, v34
    v_accvgpr_write_b32 a123, v33
    v_accvgpr_read_b32 v33, a124
    v_mul_f32 v33, v33, v34
    v_accvgpr_write_b32 a124, v33
    v_accvgpr_read_b32 v33, a125
    v_mul_f32 v33, v33, v34
    v_accvgpr_write_b32 a125, v33
    v_accvgpr_read_b32 v33, a126
    v_mul_f32 v33, v33, v34
    v_accvgpr_write_b32 a126, v33
    v_accvgpr_read_b32 v33, a127
    v_mul_f32 v33, v33, v34
    v_accvgpr_write_b32 a127, v33
    v_exp_f32 v36, v200
    v_exp_f32 v37, v201
    s_nop 0
    v_cvt_pk_bf16_f32 v236, v36, v37
    v_exp_f32 v36, v202
    v_exp_f32 v37, v203
    s_nop 0
    v_cvt_pk_bf16_f32 v237, v36, v37
    v_exp_f32 v36, v204
    v_exp_f32 v37, v205
    s_nop 0
    v_cvt_pk_bf16_f32 v238, v36, v37
    v_exp_f32 v36, v206
    v_exp_f32 v37, v207
    s_nop 0
    v_cvt_pk_bf16_f32 v239, v36, v37
    s_nop 1
    s_branch gated_mix__ssm_conv_h3__compressed_kv_cla__prompt_kernel_b2_r1_ret
gated_mix__ssm_conv_h3__compressed_kv_cla__prompt_kernel_b1_r0:
    s_nop 7
    v_max3_f32 v32, v168, v169, v170
    v_max3_f32 v32, v171, v172, v32
    v_max3_f32 v32, v173, v174, v32
    v_max_f32 v32, v175, v32
    v_mov_b32 v33, v32
    s_nop 1
    v_permlane16_swap_b32 v32, v33
    s_nop 1
    v_max_f32 v32, v32, v33
    v_mov_b32 v33, v32
    s_nop 1
    v_permlane32_swap_b32 v32, v33
    s_nop 1
    v_max_f32 v32, v32, v33
    v_add_f32 v32, 0x41c00000, v32
    v_max_f32 v32, 0, v32
    v_exp_f32 v34, -v32
    v_sub_f32 v76, v76, v32
    v_sub_f32 v77, v77, v32
    v_sub_f32 v78, v78, v32
    v_sub_f32 v79, v79, v32
    v_sub_f32 v168, v168, v32
    v_sub_f32 v169, v169, v32
    v_sub_f32 v170, v170, v32
    v_sub_f32 v171, v171, v32
    v_sub_f32 v172, v172, v32
    v_sub_f32 v173, v173, v32
    v_sub_f32 v174, v174, v32
    v_sub_f32 v175, v175, v32
    v_sub_f32 v200, v200, v32
    v_sub_f32 v201, v201, v32
    v_sub_f32 v202, v202, v32
    v_sub_f32 v203, v203, v32
    v_sub_f32 v204, v204, v32
    v_sub_f32 v205, v205, v32
    v_sub_f32 v206, v206, v32
    v_sub_f32 v207, v207, v32
    v_mul_f32 v252, v252, v34
    v_mul_f32 v253, v253, v34
    v_mul_f32 v254, v254, v34
    v_mul_f32 v255, v255, v34
    v_accvgpr_read_b32 v33, a96
    v_mul_f32 v33, v33, v34
    v_accvgpr_write_b32 a96, v33
    v_accvgpr_read_b32 v33, a97
    v_mul_f32 v33, v33, v34
    v_accvgpr_write_b32 a97, v33
    v_accvgpr_read_b32 v33, a98
    v_mul_f32 v33, v33, v34
    v_accvgpr_write_b32 a98, v33
    v_accvgpr_read_b32 v33, a99
    v_mul_f32 v33, v33, v34
    v_accvgpr_write_b32 a99, v33
    v_accvgpr_read_b32 v33, a100
    v_mul_f32 v33, v33, v34
    v_accvgpr_write_b32 a100, v33
    v_accvgpr_read_b32 v33, a101
    v_mul_f32 v33, v33, v34
    v_accvgpr_write_b32 a101, v33
    v_accvgpr_read_b32 v33, a102
    v_mul_f32 v33, v33, v34
    v_accvgpr_write_b32 a102, v33
    v_accvgpr_read_b32 v33, a103
    v_mul_f32 v33, v33, v34
    v_accvgpr_write_b32 a103, v33
    v_accvgpr_read_b32 v33, a104
    v_mul_f32 v33, v33, v34
    v_accvgpr_write_b32 a104, v33
    v_accvgpr_read_b32 v33, a105
    v_mul_f32 v33, v33, v34
    v_accvgpr_write_b32 a105, v33
    v_accvgpr_read_b32 v33, a106
    v_mul_f32 v33, v33, v34
    v_accvgpr_write_b32 a106, v33
    v_accvgpr_read_b32 v33, a107
    v_mul_f32 v33, v33, v34
    v_accvgpr_write_b32 a107, v33
    v_accvgpr_read_b32 v33, a108
    v_mul_f32 v33, v33, v34
    v_accvgpr_write_b32 a108, v33
    v_accvgpr_read_b32 v33, a109
    v_mul_f32 v33, v33, v34
    v_accvgpr_write_b32 a109, v33
    v_accvgpr_read_b32 v33, a110
    v_mul_f32 v33, v33, v34
    v_accvgpr_write_b32 a110, v33
    v_accvgpr_read_b32 v33, a111
    v_mul_f32 v33, v33, v34
    v_accvgpr_write_b32 a111, v33
    v_accvgpr_read_b32 v33, a112
    v_mul_f32 v33, v33, v34
    v_accvgpr_write_b32 a112, v33
    v_accvgpr_read_b32 v33, a113
    v_mul_f32 v33, v33, v34
    v_accvgpr_write_b32 a113, v33
    v_accvgpr_read_b32 v33, a114
    v_mul_f32 v33, v33, v34
    v_accvgpr_write_b32 a114, v33
    v_accvgpr_read_b32 v33, a115
    v_mul_f32 v33, v33, v34
    v_accvgpr_write_b32 a115, v33
    v_accvgpr_read_b32 v33, a116
    v_mul_f32 v33, v33, v34
    v_accvgpr_write_b32 a116, v33
    v_accvgpr_read_b32 v33, a117
    v_mul_f32 v33, v33, v34
    v_accvgpr_write_b32 a117, v33
    v_accvgpr_read_b32 v33, a118
    v_mul_f32 v33, v33, v34
    v_accvgpr_write_b32 a118, v33
    v_accvgpr_read_b32 v33, a119
    v_mul_f32 v33, v33, v34
    v_accvgpr_write_b32 a119, v33
    v_accvgpr_read_b32 v33, a120
    v_mul_f32 v33, v33, v34
    v_accvgpr_write_b32 a120, v33
    v_accvgpr_read_b32 v33, a121
    v_mul_f32 v33, v33, v34
    v_accvgpr_write_b32 a121, v33
    v_accvgpr_read_b32 v33, a122
    v_mul_f32 v33, v33, v34
    v_accvgpr_write_b32 a122, v33
    v_accvgpr_read_b32 v33, a123
    v_mul_f32 v33, v33, v34
    v_accvgpr_write_b32 a123, v33
    v_accvgpr_read_b32 v33, a124
    v_mul_f32 v33, v33, v34
    v_accvgpr_write_b32 a124, v33
    v_accvgpr_read_b32 v33, a125
    v_mul_f32 v33, v33, v34
    v_accvgpr_write_b32 a125, v33
    v_accvgpr_read_b32 v33, a126
    v_mul_f32 v33, v33, v34
    v_accvgpr_write_b32 a126, v33
    v_accvgpr_read_b32 v33, a127
    v_mul_f32 v33, v33, v34
    v_accvgpr_write_b32 a127, v33
    v_exp_f32 v36, v168
    v_exp_f32 v37, v169
    s_nop 0
    v_cvt_pk_bf16_f32 v220, v36, v37
    v_exp_f32 v36, v170
    v_exp_f32 v37, v171
    s_nop 0
    v_cvt_pk_bf16_f32 v221, v36, v37
    v_exp_f32 v36, v172
    v_exp_f32 v37, v173
    s_nop 0
    v_cvt_pk_bf16_f32 v222, v36, v37
    v_exp_f32 v36, v174
    v_exp_f32 v37, v175
    s_nop 0
    v_cvt_pk_bf16_f32 v223, v36, v37
    s_nop 1
    s_branch gated_mix__ssm_conv_h3__compressed_kv_cla__prompt_kernel_b1_r0_ret
gated_mix__ssm_conv_h3__compressed_kv_cla__prompt_kernel_b1_r1:
    s_nop 7
    v_max3_f32 v32, v200, v201, v202
    v_max3_f32 v32, v203, v204, v32
    v_max3_f32 v32, v205, v206, v32
    v_max_f32 v32, v207, v32
    v_mov_b32 v33, v32
    s_nop 1
    v_permlane16_swap_b32 v32, v33
    s_nop 1
    v_max_f32 v32, v32, v33
    v_mov_b32 v33, v32
    s_nop 1
    v_permlane32_swap_b32 v32, v33
    s_nop 1
    v_max_f32 v32, v32, v33
    v_add_f32 v32, 0x41c00000, v32
    v_max_f32 v32, 0, v32
    v_exp_f32 v34, -v32
    v_sub_f32 v76, v76, v32
    v_sub_f32 v77, v77, v32
    v_sub_f32 v78, v78, v32
    v_sub_f32 v79, v79, v32
    v_sub_f32 v200, v200, v32
    v_sub_f32 v201, v201, v32
    v_sub_f32 v202, v202, v32
    v_sub_f32 v203, v203, v32
    v_sub_f32 v204, v204, v32
    v_sub_f32 v205, v205, v32
    v_sub_f32 v206, v206, v32
    v_sub_f32 v207, v207, v32
    v_mul_f32 v252, v252, v34
    v_mul_f32 v253, v253, v34
    v_mul_f32 v254, v254, v34
    v_mul_f32 v255, v255, v34
    v_accvgpr_read_b32 v33, a96
    v_mul_f32 v33, v33, v34
    v_accvgpr_write_b32 a96, v33
    v_accvgpr_read_b32 v33, a97
    v_mul_f32 v33, v33, v34
    v_accvgpr_write_b32 a97, v33
    v_accvgpr_read_b32 v33, a98
    v_mul_f32 v33, v33, v34
    v_accvgpr_write_b32 a98, v33
    v_accvgpr_read_b32 v33, a99
    v_mul_f32 v33, v33, v34
    v_accvgpr_write_b32 a99, v33
    v_accvgpr_read_b32 v33, a100
    v_mul_f32 v33, v33, v34
    v_accvgpr_write_b32 a100, v33
    v_accvgpr_read_b32 v33, a101
    v_mul_f32 v33, v33, v34
    v_accvgpr_write_b32 a101, v33
    v_accvgpr_read_b32 v33, a102
    v_mul_f32 v33, v33, v34
    v_accvgpr_write_b32 a102, v33
    v_accvgpr_read_b32 v33, a103
    v_mul_f32 v33, v33, v34
    v_accvgpr_write_b32 a103, v33
    v_accvgpr_read_b32 v33, a104
    v_mul_f32 v33, v33, v34
    v_accvgpr_write_b32 a104, v33
    v_accvgpr_read_b32 v33, a105
    v_mul_f32 v33, v33, v34
    v_accvgpr_write_b32 a105, v33
    v_accvgpr_read_b32 v33, a106
    v_mul_f32 v33, v33, v34
    v_accvgpr_write_b32 a106, v33
    v_accvgpr_read_b32 v33, a107
    v_mul_f32 v33, v33, v34
    v_accvgpr_write_b32 a107, v33
    v_accvgpr_read_b32 v33, a108
    v_mul_f32 v33, v33, v34
    v_accvgpr_write_b32 a108, v33
    v_accvgpr_read_b32 v33, a109
    v_mul_f32 v33, v33, v34
    v_accvgpr_write_b32 a109, v33
    v_accvgpr_read_b32 v33, a110
    v_mul_f32 v33, v33, v34
    v_accvgpr_write_b32 a110, v33
    v_accvgpr_read_b32 v33, a111
    v_mul_f32 v33, v33, v34
    v_accvgpr_write_b32 a111, v33
    v_accvgpr_read_b32 v33, a112
    v_mul_f32 v33, v33, v34
    v_accvgpr_write_b32 a112, v33
    v_accvgpr_read_b32 v33, a113
    v_mul_f32 v33, v33, v34
    v_accvgpr_write_b32 a113, v33
    v_accvgpr_read_b32 v33, a114
    v_mul_f32 v33, v33, v34
    v_accvgpr_write_b32 a114, v33
    v_accvgpr_read_b32 v33, a115
    v_mul_f32 v33, v33, v34
    v_accvgpr_write_b32 a115, v33
    v_accvgpr_read_b32 v33, a116
    v_mul_f32 v33, v33, v34
    v_accvgpr_write_b32 a116, v33
    v_accvgpr_read_b32 v33, a117
    v_mul_f32 v33, v33, v34
    v_accvgpr_write_b32 a117, v33
    v_accvgpr_read_b32 v33, a118
    v_mul_f32 v33, v33, v34
    v_accvgpr_write_b32 a118, v33
    v_accvgpr_read_b32 v33, a119
    v_mul_f32 v33, v33, v34
    v_accvgpr_write_b32 a119, v33
    v_accvgpr_read_b32 v33, a120
    v_mul_f32 v33, v33, v34
    v_accvgpr_write_b32 a120, v33
    v_accvgpr_read_b32 v33, a121
    v_mul_f32 v33, v33, v34
    v_accvgpr_write_b32 a121, v33
    v_accvgpr_read_b32 v33, a122
    v_mul_f32 v33, v33, v34
    v_accvgpr_write_b32 a122, v33
    v_accvgpr_read_b32 v33, a123
    v_mul_f32 v33, v33, v34
    v_accvgpr_write_b32 a123, v33
    v_accvgpr_read_b32 v33, a124
    v_mul_f32 v33, v33, v34
    v_accvgpr_write_b32 a124, v33
    v_accvgpr_read_b32 v33, a125
    v_mul_f32 v33, v33, v34
    v_accvgpr_write_b32 a125, v33
    v_accvgpr_read_b32 v33, a126
    v_mul_f32 v33, v33, v34
    v_accvgpr_write_b32 a126, v33
    v_accvgpr_read_b32 v33, a127
    v_mul_f32 v33, v33, v34
    v_accvgpr_write_b32 a127, v33
    v_exp_f32 v36, v200
    v_exp_f32 v37, v201
    s_nop 0
    v_cvt_pk_bf16_f32 v236, v36, v37
    v_exp_f32 v36, v202
    v_exp_f32 v37, v203
    s_nop 0
    v_cvt_pk_bf16_f32 v237, v36, v37
    v_exp_f32 v36, v204
    v_exp_f32 v37, v205
    s_nop 0
    v_cvt_pk_bf16_f32 v238, v36, v37
    v_exp_f32 v36, v206
    v_exp_f32 v37, v207
    s_nop 0
    v_cvt_pk_bf16_f32 v239, v36, v37
    s_nop 1
    s_branch gated_mix__ssm_conv_h3__compressed_kv_cla__prompt_kernel_b1_r1_ret

.section .rodata,"a"
.p2align 6
.amdhsa_kernel gated_mix__ssm_conv_h3__compressed_kv_cla__prompt_kernel
  .amdhsa_next_free_vgpr 512
  .amdhsa_next_free_sgpr 102
  .amdhsa_accum_offset 256
  .amdhsa_group_segment_fixed_size 0
  .amdhsa_kernarg_size 128
  .amdhsa_user_sgpr_count 2
  .amdhsa_user_sgpr_kernarg_segment_ptr 1
  .amdhsa_system_sgpr_workgroup_id_x 1
  .amdhsa_float_denorm_mode_32 3
.end_amdhsa_kernel
```

```asm
; @launch grid=(256,1,1) block=(256,1,1) lds=163840
.amdgcn_target "amdgcn-amd-amdhsa--gfx950"
.text
.globl gated_mix__ssm_conv_h3__compressed_kv_cla__prompt_kernel
.p2align 8
.type gated_mix__ssm_conv_h3__compressed_kv_cla__prompt_kernel,@function
gated_mix__ssm_conv_h3__compressed_kv_cla__prompt_kernel:
    s_cmp_ge_u32 s2, 256
    s_cbranch_scc1 gated_mix__ssm_conv_h3__compressed_kv_cla__prompt_kernel_end
    s_load_dwordx16 s[64:79], s[0:1], 0
    s_load_dwordx16 s[80:95], s[0:1], 64
    s_getpc_b64 s[4:5]
gated_mix__ssm_conv_h3__compressed_kv_cla__prompt_kernel_pc:
    s_lshr_b32 s6, s2, 3
    s_mul_i32 s6, s6, 24
    v_min_u32 v242, 23, v0
    v_add_u32 v242, s6, v242
    v_lshlrev_b32 v242, 7, v242
    v_min_u32 v242, gated_mix__ssm_conv_h3__compressed_kv_cla__prompt_kernel_hotend-gated_mix__ssm_conv_h3__compressed_kv_cla__prompt_kernel_pc, v242
    global_load_dword v255, v242, s[4:5]
    v_lshrrev_b32 v242, 6, v0
    v_and_b32 v240, 63, v0
    v_readfirstlane_b32 s32, v242
    v_lshlrev_b32 v16, 4, v240
    s_and_b32 s36, s2, 7
    s_lshl_b32 s36, s36, 2
    s_bfe_u32 s33, s2, 0x20003
    s_add_u32 s33, s33, s36
    s_lshr_b32 s34, s2, 5
    v_lshrrev_b32 v242, 3, v240
    v_and_b32 v247, 7, v240
    v_lshrrev_b32 v245, 4, v240
    v_xor_b32 v243, v245, v247
    v_lshlrev_b32 v243, 4, v243
    v_xor_b32 v244, 64, v243
    v_lshl_add_u32 v2, v242, 10, v243
    v_lshl_add_u32 v3, v242, 10, v244
    v_add_u32 v3, 7168, v3
    v_add_u32 v4, 14336, v2
    v_add_u32 v5, 14336, v3
    v_and_b32 v246, 15, v240
    v_lshlrev_b32 v247, 1, v245
    v_xor_b32 v247, v247, v246
    v_lshlrev_b32 v247, 4, v247
    v_lshl_add_u32 v21, v245, 13, v247
    s_and_b32 s36, s32, 1
    s_lshl_b32 s36, s36, 7
    v_xor_b32 v6, s36, v21
    v_add_u32 v7, 31744, v6
    s_lshl_b32 s38, s34, 18
    s_lshl_b32 s36, s32, 16
    s_add_u32 s38, s38, s36
    s_lshl_b32 s39, s33, 8
    s_add_u32 s39, s39, s36
    s_lshl_b32 s42, s32, 13
    s_lshl_b32 s43, s32, 12
    s_add_u32 s43, s43, 98304
    s_waitcnt lgkmcnt(0)
    s_mov_b32 s4, s78
    s_mov_b32 s5, s79
    s_mov_b32 s6, 2097152
    s_mov_b32 s7, 0x00020000
    s_mov_b32 s8, s82
    s_mov_b32 s9, s83
    s_mov_b32 s10, 4194304
    s_mov_b32 s11, 0x00020000
    s_mov_b32 s12, s84
    s_mov_b32 s13, s85
    s_mov_b32 s14, 4194304
    s_mov_b32 s15, 0x00020000
    s_add_u32 s35, s2, s34
    s_and_b32 s35, s35, 7
    s_lshl_b32 s58, s35, 19
    s_lshl_b32 s35, s35, 7
    s_add_u32 s59, s38, 32768
    s_add_u32 s36, s35, 0
    s_and_b32 s36, s36, 1023
    s_add_u32 s36, s36, s38
    s_add_u32 m0, s42, 0
    s_nop 0
    buffer_load_dwordx4 v2, s[4:7], s36 offen offset:0 lds
    buffer_load_dwordx4 v3, s[4:7], s36 offen offset:1024 lds
    buffer_load_dwordx4 v4, s[4:7], s36 offen offset:2048 lds
    buffer_load_dwordx4 v5, s[4:7], s36 offen offset:3072 lds
    s_add_u32 s36, s35, 0
    s_and_b32 s36, s36, 1023
    s_add_u32 s36, s36, s59
    s_add_u32 m0, s42, 4096
    s_nop 0
    buffer_load_dwordx4 v2, s[4:7], s36 offen offset:0 lds
    buffer_load_dwordx4 v3, s[4:7], s36 offen offset:1024 lds
    buffer_load_dwordx4 v4, s[4:7], s36 offen offset:2048 lds
    buffer_load_dwordx4 v5, s[4:7], s36 offen offset:3072 lds
    s_add_u32 s37, s58, 0
    s_and_b32 s37, s37, 4194303
    s_add_u32 s37, s37, s39
    s_add_u32 m0, s43, 0
    s_nop 0
    buffer_load_dwordx4 v6, s[8:11], s37 offen offset:0 lds
    buffer_load_dwordx4 v7, s[8:11], s37 offen offset:1024 lds
    s_add_u32 m0, s43, 2048
    s_nop 0
    buffer_load_dwordx4 v6, s[12:15], s37 offen offset:0 lds
    buffer_load_dwordx4 v7, s[12:15], s37 offen offset:1024 lds
    s_add_u32 s37, s58, 262144
    s_and_b32 s37, s37, 4194303
    s_add_u32 s37, s37, s39
    s_add_u32 m0, s43, 16384
    s_nop 0
    buffer_load_dwordx4 v6, s[8:11], s37 offen offset:0 lds
    buffer_load_dwordx4 v7, s[8:11], s37 offen offset:1024 lds
    s_add_u32 m0, s43, 18432
    s_nop 0
    buffer_load_dwordx4 v6, s[12:15], s37 offen offset:0 lds
    buffer_load_dwordx4 v7, s[12:15], s37 offen offset:1024 lds
    s_add_u32 s36, s35, 128
    s_and_b32 s36, s36, 1023
    s_add_u32 s36, s36, s38
    s_add_u32 m0, s42, 32768
    s_nop 0
    buffer_load_dwordx4 v2, s[4:7], s36 offen offset:0 lds
    buffer_load_dwordx4 v3, s[4:7], s36 offen offset:1024 lds
    buffer_load_dwordx4 v4, s[4:7], s36 offen offset:2048 lds
    buffer_load_dwordx4 v5, s[4:7], s36 offen offset:3072 lds
    v_lshrrev_b32 v247, 1, v246
    v_xor_b32 v247, v245, v247
    v_lshlrev_b32 v247, 4, v247
    v_lshl_add_u32 v247, v246, 7, v247
    s_lshr_b32 s36, s32, 1
    s_lshl_b32 s36, s36, 14
    v_add_u32 v8, s36, v247
    v_xor_b32 v9, 64, v8
    v_add_u32 v14, 65536, v8
    v_add_u32 v15, 65536, v9
    v_add_u32 v23, s42, v247
    v_xor_b32 v24, 64, v23
    v_add_u32 v25, 65536, v23
    v_add_u32 v26, 65536, v24
    v_lshrrev_b32 v247, 2, v246
    v_and_b32 v248, 3, v246
    v_lshlrev_b32 v248, 3, v248
    v_lshl_add_u32 v248, v247, 8, v248
    v_add_u32 v248, 98304, v248
    v_lshl_add_u32 v249, v245, 12, v248
    v_mul_u32_u24 v250, 2176, v245
    v_add_u32 v250, v250, v248
    v_xor_b32 v248, s32, v245
    v_and_b32 v248, 1, v248
    v_lshl_add_u32 v249, v248, 7, v249
    v_xor_b32 v248, 0, v247
    v_lshl_add_u32 v10, v248, 5, v249
    v_lshl_add_u32 v27, v248, 5, v250
    v_xor_b32 v248, 1, v247
    v_lshl_add_u32 v11, v248, 5, v249
    v_lshl_add_u32 v28, v248, 5, v250
    v_xor_b32 v248, 2, v247
    v_lshl_add_u32 v12, v248, 5, v249
    v_lshl_add_u32 v29, v248, 5, v250
    v_xor_b32 v248, 3, v247
    v_lshl_add_u32 v13, v248, 5, v249
    v_lshl_add_u32 v30, v248, 5, v250
    v_lshl_add_u32 v17, v242, 13, v243
    v_lshl_add_u32 v18, v242, 13, v244
    v_add_u32 v18, 64512, v18
    v_add_u32 v19, 129024, v17
    v_add_u32 v20, 129024, v18
    v_add_u32 v22, 31744, v21
    s_lshl_b32 s54, s2, 2
    s_add_u32 s54, s54, s32
    v_lshlrev_b32 v254, 7, v240
    s_lshl_b32 s46, s54, 13
    s_sub_u32 s46, s46, 4194304
    s_cselect_b32 s46, 0x80000000, s46
    s_mov_b32 s20, s80
    s_mov_b32 s21, s81
    s_mov_b32 s22, 8388608
    s_mov_b32 s23, 0x00020000
    s_mov_b32 s24, s64
    s_mov_b32 s25, s65
    s_mov_b32 s26, 4194304
    s_mov_b32 s27, 0x00020000
    s_add_u32 s28, s94, 60817408
    s_addc_u32 s29, s95, 0
    s_mov_b32 s30, 524288
    s_mov_b32 s31, 0x00020000
    s_mov_b32 s49, s39
    s_mul_i32 s50, s32, 2176
    s_add_u32 s50, s50, 98304
    s_lshl_b32 s44, s34, 7
    s_add_u32 s44, s44, s32
    s_lshl_b32 s44, s44, 11
    s_lshl_b32 s37, s34, 1
    s_sub_u32 s45, 15, s37
    s_lshl_b32 s45, s45, 18
    s_add_u32 s45, s45, s44
    s_lshl_b32 s57, s54, 2
    s_add_u32 s57, s57, 262144
    s_lshl_b32 s36, s32, 5
    s_add_u32 s36, s36, s33
    s_lshl_b32 s36, s36, 2
    s_lshl_b32 s37, s34, 9
    s_add_u32 s55, s36, s37
    s_sub_u32 s56, 7680, s37
    s_add_u32 s56, s56, s36
    s_lshl_b32 s36, s34, 3
    s_add_u32 s36, s36, 0
    s_add_u32 s36, s36, s32
    s_lshl_b32 s36, s36, 5
    s_add_u32 s36, s36, s33
    s_lshl_b32 s60, s36, 12
    s_lshl_b32 s36, s34, 3
    s_add_u32 s36, s36, 4
    s_add_u32 s36, s36, s32
    s_lshl_b32 s36, s36, 5
    s_add_u32 s36, s36, s33
    s_lshl_b32 s61, s36, 12
    s_lshl_b32 s36, s34, 3
    s_sub_u32 s36, 120, s36
    s_add_u32 s36, s36, s32
    s_lshl_b32 s36, s36, 5
    s_add_u32 s36, s36, s33
    s_lshl_b32 s62, s36, 12
    s_lshl_b32 s36, s34, 3
    s_sub_u32 s36, 124, s36
    s_add_u32 s36, s36, s32
    s_lshl_b32 s36, s36, 5
    s_add_u32 s36, s36, s33
    s_lshl_b32 s63, s36, 12
    s_lshr_b32 s36, s2, 4
    s_lshl_b32 s36, s36, 4
    s_lshl_b32 s37, s32, 2
    s_add_u32 s36, s36, s37
    s_and_b32 s37, s2, 15
    s_lshl_b32 s37, s37, 6
    v_add_u32 v247, s36, v245
    v_lshl_add_u32 v248, v246, 2, s37
    v_lshlrev_b32 v0, 14, v247
    v_lshl_add_u32 v0, v248, 1, v0
    v_subrev_u32 v1, 6144, v0
    v_lshlrev_b32 v232, 3, v248
    v_lshlrev_b32 v233, 4, v240
    v_mul_u32_u24 v234, 4608, v248
    v_lshlrev_b32 v247, 4, v247
    v_sub_u32 v247, 4080, v247
    v_add_u32 v234, v234, v247
    v_add_u32 v235, s37, v240
    v_mul_u32_u24 v235, 4608, v235
    s_movk_i32 s47, 4096
    s_movk_i32 s48, 8192
    s_movk_i32 s51, 12288
    s_mov_b32 s52, 0xffff0000
    s_lshr_b32 s37, s2, 4
    s_or_b32 s37, s37, s32
    s_cmp_eq_u32 s37, 0
    s_cselect_b32 s53, s47, 0x80000000
    s_lshl_b32 s36, s33, 13
    s_add_u32 s40, s44, s36
    s_add_u32 s41, s45, s36
    s_branch gated_mix__ssm_conv_h3__compressed_kv_cla__prompt_kernel_body
.p2align 12
gated_mix__ssm_conv_h3__compressed_kv_cla__prompt_kernel_body:
    s_waitcnt vmcnt(8)
    s_barrier
    ds_read_b64_tr_b16 v[64:65], v10 offset:0
    ds_read_b64_tr_b16 v[66:67], v10 offset:1024
    ds_read_b64_tr_b16 v[68:69], v11 offset:0
    ds_read_b64_tr_b16 v[70:71], v11 offset:1024
    ds_read_b128 v[32:35], v8 offset:0
    ds_read_b64_tr_b16 v[72:73], v12 offset:0
    ds_read_b64_tr_b16 v[74:75], v12 offset:1024
    ds_read_b128 v[36:39], v8 offset:2048
    ds_read_b64_tr_b16 v[76:77], v13 offset:0
    ds_read_b64_tr_b16 v[78:79], v13 offset:1024
    ds_read_b128 v[40:43], v8 offset:4096
    ds_read_b64_tr_b16 v[80:81], v10 offset:2048
    ds_read_b64_tr_b16 v[82:83], v10 offset:3072
    ds_read_b128 v[44:47], v8 offset:6144
    ds_read_b64_tr_b16 v[84:85], v11 offset:2048
    ds_read_b64_tr_b16 v[86:87], v11 offset:3072
    ds_read_b128 v[48:51], v8 offset:8192
    ds_read_b64_tr_b16 v[88:89], v12 offset:2048
    ds_read_b64_tr_b16 v[90:91], v12 offset:3072
    ds_read_b128 v[52:55], v8 offset:10240
    ds_read_b64_tr_b16 v[92:93], v13 offset:2048
    ds_read_b64_tr_b16 v[94:95], v13 offset:3072
    ds_read_b128 v[56:59], v8 offset:12288
    ds_read_b128 v[60:63], v8 offset:14336
    s_waitcnt lgkmcnt(0)
    v_mfma_f32_16x16x32_bf16 a[0:3], v[64:67], v[32:35], 0
    ds_read_b128 v[96:99], v9 offset:0
    v_mfma_f32_16x16x32_bf16 a[4:7], v[64:67], v[36:39], 0
    s_add_u32 s36, s35, 128
    s_and_b32 s36, s36, 1023
    s_add_u32 s36, s36, s59
    v_mfma_f32_16x16x32_bf16 a[8:11], v[64:67], v[40:43], 0
    s_add_u32 m0, s42, 36864
    ds_read_b128 v[100:103], v9 offset:2048
    v_mfma_f32_16x16x32_bf16 a[12:15], v[64:67], v[44:47], 0
    buffer_load_dwordx4 v2, s[4:7], s36 offen offset:0 lds
    v_mfma_f32_16x16x32_bf16 a[16:19], v[64:67], v[48:51], 0
    ds_read_b128 v[104:107], v9 offset:4096
    v_mfma_f32_16x16x32_bf16 a[20:23], v[64:67], v[52:55], 0
    v_mfma_f32_16x16x32_bf16 a[24:27], v[64:67], v[56:59], 0
    ds_read_b128 v[108:111], v9 offset:6144
    v_mfma_f32_16x16x32_bf16 a[28:31], v[64:67], v[60:63], 0
    buffer_load_dwordx4 v3, s[4:7], s36 offen offset:1024 lds
    v_mfma_f32_16x16x32_bf16 a[32:35], v[68:71], v[32:35], 0
    ds_read_b128 v[112:115], v9 offset:8192
    v_mfma_f32_16x16x32_bf16 a[36:39], v[68:71], v[36:39], 0
    v_mfma_f32_16x16x32_bf16 a[40:43], v[68:71], v[40:43], 0
    ds_read_b128 v[116:119], v9 offset:10240
    v_mfma_f32_16x16x32_bf16 a[44:47], v[68:71], v[44:47], 0
    buffer_load_dwordx4 v4, s[4:7], s36 offen offset:2048 lds
    v_mfma_f32_16x16x32_bf16 a[48:51], v[68:71], v[48:51], 0
    ds_read_b128 v[120:123], v9 offset:12288
    v_mfma_f32_16x16x32_bf16 a[52:55], v[68:71], v[52:55], 0
    v_mfma_f32_16x16x32_bf16 a[56:59], v[68:71], v[56:59], 0
    ds_read_b128 v[124:127], v9 offset:14336
    v_mfma_f32_16x16x32_bf16 a[60:63], v[68:71], v[60:63], 0
    buffer_load_dwordx4 v5, s[4:7], s36 offen offset:3072 lds
    v_mfma_f32_16x16x32_bf16 a[64:67], v[72:75], v[32:35], 0
    v_mfma_f32_16x16x32_bf16 a[68:71], v[72:75], v[36:39], 0
    s_add_u32 s37, s58, 524288
    s_and_b32 s37, s37, 4194303
    s_add_u32 s37, s37, s39
    v_mfma_f32_16x16x32_bf16 a[72:75], v[72:75], v[40:43], 0
    s_add_u32 m0, s43, 32768
    v_mfma_f32_16x16x32_bf16 a[76:79], v[72:75], v[44:47], 0
    buffer_load_dwordx4 v6, s[8:11], s37 offen offset:0 lds
    v_mfma_f32_16x16x32_bf16 a[80:83], v[72:75], v[48:51], 0
    v_mfma_f32_16x16x32_bf16 a[84:87], v[72:75], v[52:55], 0
    v_mfma_f32_16x16x32_bf16 a[88:91], v[72:75], v[56:59], 0
    v_mfma_f32_16x16x32_bf16 a[92:95], v[72:75], v[60:63], 0
    buffer_load_dwordx4 v7, s[8:11], s37 offen offset:1024 lds
    v_mfma_f32_16x16x32_bf16 a[96:99], v[76:79], v[32:35], 0
    v_mfma_f32_16x16x32_bf16 a[100:103], v[76:79], v[36:39], 0
    v_mfma_f32_16x16x32_bf16 a[104:107], v[76:79], v[40:43], 0
    s_add_u32 m0, s43, 34816
    v_mfma_f32_16x16x32_bf16 a[108:111], v[76:79], v[44:47], 0
    buffer_load_dwordx4 v6, s[12:15], s37 offen offset:0 lds
    v_mfma_f32_16x16x32_bf16 a[112:115], v[76:79], v[48:51], 0
    v_mfma_f32_16x16x32_bf16 a[116:119], v[76:79], v[52:55], 0
    v_mfma_f32_16x16x32_bf16 a[120:123], v[76:79], v[56:59], 0
    v_mfma_f32_16x16x32_bf16 a[124:127], v[76:79], v[60:63], 0
    buffer_load_dwordx4 v7, s[12:15], s37 offen offset:1024 lds
    v_mfma_f32_16x16x32_bf16 a[128:131], v[32:35], v[80:83], 0
    v_mfma_f32_16x16x32_bf16 a[132:135], v[36:39], v[80:83], 0
    s_add_u32 s37, s58, 786432
    s_and_b32 s37, s37, 4194303
    s_add_u32 s37, s37, s39
    v_mfma_f32_16x16x32_bf16 a[136:139], v[40:43], v[80:83], 0
    s_add_u32 m0, s43, 49152
    v_mfma_f32_16x16x32_bf16 a[140:143], v[44:47], v[80:83], 0
    buffer_load_dwordx4 v6, s[8:11], s37 offen offset:0 lds
    v_mfma_f32_16x16x32_bf16 a[144:147], v[48:51], v[80:83], 0
    s_waitcnt vmcnt(13)
    s_barrier
    v_mfma_f32_16x16x32_bf16 a[148:151], v[52:55], v[80:83], 0
    v_mfma_f32_16x16x32_bf16 a[152:155], v[56:59], v[80:83], 0
    ds_read_b64_tr_b16 v[128:129], v10 offset:16384
    ds_read_b64_tr_b16 v[130:131], v10 offset:17408
    v_mfma_f32_16x16x32_bf16 a[156:159], v[60:63], v[80:83], 0
    buffer_load_dwordx4 v7, s[8:11], s37 offen offset:1024 lds
    v_mfma_f32_16x16x32_bf16 a[160:163], v[32:35], v[84:87], 0
    ds_read_b64_tr_b16 v[132:133], v11 offset:16384
    ds_read_b64_tr_b16 v[134:135], v11 offset:17408
    v_mfma_f32_16x16x32_bf16 a[164:167], v[36:39], v[84:87], 0
    v_mfma_f32_16x16x32_bf16 a[168:171], v[40:43], v[84:87], 0
    s_add_u32 m0, s43, 51200
    ds_read_b64_tr_b16 v[136:137], v12 offset:16384
    ds_read_b64_tr_b16 v[138:139], v12 offset:17408
    v_mfma_f32_16x16x32_bf16 a[172:175], v[44:47], v[84:87], 0
    buffer_load_dwordx4 v6, s[12:15], s37 offen offset:0 lds
    v_mfma_f32_16x16x32_bf16 a[176:179], v[48:51], v[84:87], 0
    ds_read_b64_tr_b16 v[140:141], v13 offset:16384
    ds_read_b64_tr_b16 v[142:143], v13 offset:17408
    v_mfma_f32_16x16x32_bf16 a[180:183], v[52:55], v[84:87], 0
    v_mfma_f32_16x16x32_bf16 a[184:187], v[56:59], v[84:87], 0
    ds_read_b64_tr_b16 v[144:145], v10 offset:18432
    ds_read_b64_tr_b16 v[146:147], v10 offset:19456
    v_mfma_f32_16x16x32_bf16 a[188:191], v[60:63], v[84:87], 0
    buffer_load_dwordx4 v7, s[12:15], s37 offen offset:1024 lds
    v_mfma_f32_16x16x32_bf16 a[192:195], v[32:35], v[88:91], 0
    ds_read_b64_tr_b16 v[148:149], v11 offset:18432
    ds_read_b64_tr_b16 v[150:151], v11 offset:19456
    v_mfma_f32_16x16x32_bf16 a[196:199], v[36:39], v[88:91], 0
    v_mfma_f32_16x16x32_bf16 a[200:203], v[40:43], v[88:91], 0
    ds_read_b64_tr_b16 v[152:153], v12 offset:18432
    ds_read_b64_tr_b16 v[154:155], v12 offset:19456
    v_mfma_f32_16x16x32_bf16 a[204:207], v[44:47], v[88:91], 0
    v_mfma_f32_16x16x32_bf16 a[208:211], v[48:51], v[88:91], 0
    ds_read_b64_tr_b16 v[156:157], v13 offset:18432
    ds_read_b64_tr_b16 v[158:159], v13 offset:19456
    v_mfma_f32_16x16x32_bf16 a[212:215], v[52:55], v[88:91], 0
    v_mfma_f32_16x16x32_bf16 a[216:219], v[56:59], v[88:91], 0
    v_mfma_f32_16x16x32_bf16 a[220:223], v[60:63], v[88:91], 0
    v_mfma_f32_16x16x32_bf16 a[224:227], v[32:35], v[92:95], 0
    v_mfma_f32_16x16x32_bf16 a[228:231], v[36:39], v[92:95], 0
    v_mfma_f32_16x16x32_bf16 a[232:235], v[40:43], v[92:95], 0
    v_mfma_f32_16x16x32_bf16 a[236:239], v[44:47], v[92:95], 0
    v_mfma_f32_16x16x32_bf16 a[240:243], v[48:51], v[92:95], 0
    v_mfma_f32_16x16x32_bf16 a[244:247], v[52:55], v[92:95], 0
    v_mfma_f32_16x16x32_bf16 a[248:251], v[56:59], v[92:95], 0
    s_bfe_u32 s54, s2, 0x10005
    s_lshl_b32 s54, s54, 2
    s_add_u32 s54, s54, s32
    s_mov_b64 exec, 0
    s_cmp_eq_u32 s54, 0
    s_cbranch_scc1 gated_mix__ssm_conv_h3__compressed_kv_cla__prompt_kernel_pad0
    s_cmp_eq_u32 s54, 1
    s_cbranch_scc1 gated_mix__ssm_conv_h3__compressed_kv_cla__prompt_kernel_pad1
    s_cmp_eq_u32 s54, 2
    s_cbranch_scc1 gated_mix__ssm_conv_h3__compressed_kv_cla__prompt_kernel_pad2
    s_cmp_eq_u32 s54, 3
    s_cbranch_scc1 gated_mix__ssm_conv_h3__compressed_kv_cla__prompt_kernel_pad3
    s_cmp_eq_u32 s54, 4
    s_cbranch_scc1 gated_mix__ssm_conv_h3__compressed_kv_cla__prompt_kernel_pad4
    s_cmp_eq_u32 s54, 5
    s_cbranch_scc1 gated_mix__ssm_conv_h3__compressed_kv_cla__prompt_kernel_pad5
    s_cmp_eq_u32 s54, 6
    s_cbranch_scc1 gated_mix__ssm_conv_h3__compressed_kv_cla__prompt_kernel_pad6
    s_cbranch_execz gated_mix__ssm_conv_h3__compressed_kv_cla__prompt_kernel_pad7
gated_mix__ssm_conv_h3__compressed_kv_cla__prompt_kernel_back:
    s_mov_b64 exec, -1
    v_mfma_f32_16x16x32_bf16 a[252:255], v[60:63], v[92:95], 0
    s_waitcnt vmcnt(4) lgkmcnt(0)
    s_barrier
    v_mfma_f32_16x16x32_bf16 a[0:3], v[128:131], v[96:99], a[0:3]
    ds_read_b64_tr_b16 v[64:65], v10 offset:32768
    v_mfma_f32_16x16x32_bf16 a[4:7], v[128:131], v[100:103], a[4:7]
    s_add_u32 s36, s35, 256
    s_and_b32 s36, s36, 1023
    s_add_u32 s36, s36, s38
    v_mfma_f32_16x16x32_bf16 a[8:11], v[128:131], v[104:107], a[8:11]
    s_add_u32 m0, s42, 65536
    ds_read_b64_tr_b16 v[66:67], v10 offset:33792
    v_mfma_f32_16x16x32_bf16 a[12:15], v[128:131], v[108:111], a[12:15]
    buffer_load_dwordx4 v2, s[4:7], s36 offen offset:0 lds
    v_mfma_f32_16x16x32_bf16 a[16:19], v[128:131], v[112:115], a[16:19]
    ds_read_b64_tr_b16 v[68:69], v11 offset:32768
    v_mfma_f32_16x16x32_bf16 a[20:23], v[128:131], v[116:119], a[20:23]
    v_mfma_f32_16x16x32_bf16 a[24:27], v[128:131], v[120:123], a[24:27]
    ds_read_b64_tr_b16 v[70:71], v11 offset:33792
    v_mfma_f32_16x16x32_bf16 a[28:31], v[128:131], v[124:127], a[28:31]
    buffer_load_dwordx4 v3, s[4:7], s36 offen offset:1024 lds
    v_mfma_f32_16x16x32_bf16 a[32:35], v[132:135], v[96:99], a[32:35]
    ds_read_b128 v[32:35], v8 offset:32768
    v_mfma_f32_16x16x32_bf16 a[36:39], v[132:135], v[100:103], a[36:39]
    v_mfma_f32_16x16x32_bf16 a[40:43], v[132:135], v[104:107], a[40:43]
    ds_read_b64_tr_b16 v[72:73], v12 offset:32768
    v_mfma_f32_16x16x32_bf16 a[44:47], v[132:135], v[108:111], a[44:47]
    buffer_load_dwordx4 v4, s[4:7], s36 offen offset:2048 lds
    v_mfma_f32_16x16x32_bf16 a[48:51], v[132:135], v[112:115], a[48:51]
    ds_read_b64_tr_b16 v[74:75], v12 offset:33792
    v_mfma_f32_16x16x32_bf16 a[52:55], v[132:135], v[116:119], a[52:55]
    v_mfma_f32_16x16x32_bf16 a[56:59], v[132:135], v[120:123], a[56:59]
    ds_read_b128 v[36:39], v8 offset:34816
    v_mfma_f32_16x16x32_bf16 a[60:63], v[132:135], v[124:127], a[60:63]
    buffer_load_dwordx4 v5, s[4:7], s36 offen offset:3072 lds
    v_mfma_f32_16x16x32_bf16 a[64:67], v[136:139], v[96:99], a[64:67]
    ds_read_b64_tr_b16 v[76:77], v13 offset:32768
    v_mfma_f32_16x16x32_bf16 a[68:71], v[136:139], v[100:103], a[68:71]
    s_add_u32 s36, s35, 256
    s_and_b32 s36, s36, 1023
    s_add_u32 s36, s36, s59
    v_mfma_f32_16x16x32_bf16 a[72:75], v[136:139], v[104:107], a[72:75]
    s_add_u32 m0, s42, 69632
    ds_read_b64_tr_b16 v[78:79], v13 offset:33792
    v_mfma_f32_16x16x32_bf16 a[76:79], v[136:139], v[108:111], a[76:79]
    buffer_load_dwordx4 v2, s[4:7], s36 offen offset:0 lds
    v_mfma_f32_16x16x32_bf16 a[80:83], v[136:139], v[112:115], a[80:83]
    ds_read_b128 v[40:43], v8 offset:36864
    v_mfma_f32_16x16x32_bf16 a[84:87], v[136:139], v[116:119], a[84:87]
    v_mfma_f32_16x16x32_bf16 a[88:91], v[136:139], v[120:123], a[88:91]
    ds_read_b64_tr_b16 v[80:81], v10 offset:34816
    v_mfma_f32_16x16x32_bf16 a[92:95], v[136:139], v[124:127], a[92:95]
    buffer_load_dwordx4 v3, s[4:7], s36 offen offset:1024 lds
    v_mfma_f32_16x16x32_bf16 a[96:99], v[140:143], v[96:99], a[96:99]
    ds_read_b64_tr_b16 v[82:83], v10 offset:35840
    v_mfma_f32_16x16x32_bf16 a[100:103], v[140:143], v[100:103], a[100:103]
    v_mfma_f32_16x16x32_bf16 a[104:107], v[140:143], v[104:107], a[104:107]
    ds_read_b128 v[44:47], v8 offset:38912
    v_mfma_f32_16x16x32_bf16 a[108:111], v[140:143], v[108:111], a[108:111]
    buffer_load_dwordx4 v4, s[4:7], s36 offen offset:2048 lds
    v_mfma_f32_16x16x32_bf16 a[112:115], v[140:143], v[112:115], a[112:115]
    ds_read_b64_tr_b16 v[84:85], v11 offset:34816
    v_mfma_f32_16x16x32_bf16 a[116:119], v[140:143], v[116:119], a[116:119]
    v_mfma_f32_16x16x32_bf16 a[120:123], v[140:143], v[120:123], a[120:123]
    ds_read_b64_tr_b16 v[86:87], v11 offset:35840
    v_mfma_f32_16x16x32_bf16 a[124:127], v[140:143], v[124:127], a[124:127]
    buffer_load_dwordx4 v5, s[4:7], s36 offen offset:3072 lds
    v_mfma_f32_16x16x32_bf16 a[128:131], v[96:99], v[144:147], a[128:131]
    ds_read_b128 v[48:51], v8 offset:40960
    v_mfma_f32_16x16x32_bf16 a[132:135], v[100:103], v[144:147], a[132:135]
    s_add_u32 s37, s58, 1048576
    s_and_b32 s37, s37, 4194303
    s_add_u32 s37, s37, s39
    v_mfma_f32_16x16x32_bf16 a[136:139], v[104:107], v[144:147], a[136:139]
    s_add_u32 m0, s43, 0
    ds_read_b64_tr_b16 v[88:89], v12 offset:34816
    v_mfma_f32_16x16x32_bf16 a[140:143], v[108:111], v[144:147], a[140:143]
    buffer_load_dwordx4 v6, s[8:11], s37 offen offset:0 lds
    v_mfma_f32_16x16x32_bf16 a[144:147], v[112:115], v[144:147], a[144:147]
    ds_read_b64_tr_b16 v[90:91], v12 offset:35840
    v_mfma_f32_16x16x32_bf16 a[148:151], v[116:119], v[144:147], a[148:151]
    v_mfma_f32_16x16x32_bf16 a[152:155], v[120:123], v[144:147], a[152:155]
    ds_read_b128 v[52:55], v8 offset:43008
    v_mfma_f32_16x16x32_bf16 a[156:159], v[124:127], v[144:147], a[156:159]
    buffer_load_dwordx4 v7, s[8:11], s37 offen offset:1024 lds
    v_mfma_f32_16x16x32_bf16 a[160:163], v[96:99], v[148:151], a[160:163]
    s_lshl_b32 s3, s33, 5
    ds_read_b64_tr_b16 v[92:93], v13 offset:34816
    v_mfma_f32_16x16x32_bf16 a[164:167], v[100:103], v[148:151], a[164:167]
    s_add_u32 s3, s3, s34
    v_mfma_f32_16x16x32_bf16 a[168:171], v[104:107], v[148:151], a[168:171]
    s_add_u32 m0, s43, 2048
    ds_read_b64_tr_b16 v[94:95], v13 offset:35840
    v_mfma_f32_16x16x32_bf16 a[172:175], v[108:111], v[148:151], a[172:175]
    buffer_load_dwordx4 v6, s[12:15], s37 offen offset:0 lds
    v_mfma_f32_16x16x32_bf16 a[176:179], v[112:115], v[148:151], a[176:179]
    s_lshl_b32 s3, s3, 2
    ds_read_b128 v[56:59], v8 offset:45056
    v_mfma_f32_16x16x32_bf16 a[180:183], v[116:119], v[148:151], a[180:183]
    s_add_u32 s3, s3, 393216
    v_mfma_f32_16x16x32_bf16 a[184:187], v[120:123], v[148:151], a[184:187]
    s_cmp_eq_u32 s32, 0
    s_cselect_b32 s3, s3, 0x80000000
    ds_read_b128 v[60:63], v8 offset:47104
    v_mfma_f32_16x16x32_bf16 a[188:191], v[124:127], v[148:151], a[188:191]
    buffer_load_dwordx4 v7, s[12:15], s37 offen offset:1024 lds
    v_mfma_f32_16x16x32_bf16 a[192:195], v[96:99], v[152:155], a[192:195]
    v_mov_b32 v241, 0
    v_mfma_f32_16x16x32_bf16 a[196:199], v[100:103], v[152:155], a[196:199]
    s_mov_b32 s16, s66
    v_mfma_f32_16x16x32_bf16 a[200:203], v[104:107], v[152:155], a[200:203]
    s_mov_b32 s17, s67
    v_mfma_f32_16x16x32_bf16 a[204:207], v[108:111], v[152:155], a[204:207]
    v_mfma_f32_16x16x32_bf16 a[208:211], v[112:115], v[152:155], a[208:211]
    s_mov_b32 s18, 4194304
    v_mfma_f32_16x16x32_bf16 a[212:215], v[116:119], v[152:155], a[212:215]
    s_mov_b32 s19, 0x00020000
    v_mfma_f32_16x16x32_bf16 a[216:219], v[120:123], v[152:155], a[216:219]
    s_mov_b32 s76, s68
    v_mfma_f32_16x16x32_bf16 a[220:223], v[124:127], v[152:155], a[220:223]
    v_mfma_f32_16x16x32_bf16 a[224:227], v[96:99], v[156:159], a[224:227]
    s_mov_b32 s77, s69
    v_mfma_f32_16x16x32_bf16 a[228:231], v[100:103], v[156:159], a[228:231]
    s_mov_b32 s78, 4194304
    v_mfma_f32_16x16x32_bf16 a[232:235], v[104:107], v[156:159], a[232:235]
    s_mov_b32 s79, 0x00020000
    v_mfma_f32_16x16x32_bf16 a[236:239], v[108:111], v[156:159], a[236:239]
    v_mfma_f32_16x16x32_bf16 a[240:243], v[112:115], v[156:159], a[240:243]
    v_mfma_f32_16x16x32_bf16 a[244:247], v[116:119], v[156:159], a[244:247]
    v_mfma_f32_16x16x32_bf16 a[248:251], v[120:123], v[156:159], a[248:251]
    v_mfma_f32_16x16x32_bf16 a[252:255], v[124:127], v[156:159], a[252:255]
    s_waitcnt vmcnt(12) lgkmcnt(0)
    s_barrier
    v_mfma_f32_16x16x32_bf16 a[0:3], v[64:67], v[32:35], a[0:3]
    ds_read_b64_tr_b16 v[128:129], v10 offset:49152
    v_mfma_f32_16x16x32_bf16 a[4:7], v[64:67], v[36:39], a[4:7]
    s_add_u32 s36, s35, 384
    s_and_b32 s36, s36, 1023
    s_add_u32 s36, s36, s38
    v_mfma_f32_16x16x32_bf16 a[8:11], v[64:67], v[40:43], a[8:11]
    s_add_u32 m0, s42, 0
    ds_read_b64_tr_b16 v[130:131], v10 offset:50176
    v_mfma_f32_16x16x32_bf16 a[12:15], v[64:67], v[44:47], a[12:15]
    buffer_load_dwordx4 v2, s[4:7], s36 offen offset:0 lds
    v_mfma_f32_16x16x32_bf16 a[16:19], v[64:67], v[48:51], a[16:19]
    ds_read_b64_tr_b16 v[132:133], v11 offset:49152
    v_mfma_f32_16x16x32_bf16 a[20:23], v[64:67], v[52:55], a[20:23]
    v_mfma_f32_16x16x32_bf16 a[24:27], v[64:67], v[56:59], a[24:27]
    ds_read_b64_tr_b16 v[134:135], v11 offset:50176
    v_mfma_f32_16x16x32_bf16 a[28:31], v[64:67], v[60:63], a[28:31]
    buffer_load_dwordx4 v3, s[4:7], s36 offen offset:1024 lds
    v_mfma_f32_16x16x32_bf16 a[32:35], v[68:71], v[32:35], a[32:35]
    ds_read_b128 v[96:99], v9 offset:32768
    v_mfma_f32_16x16x32_bf16 a[36:39], v[68:71], v[36:39], a[36:39]
    v_mfma_f32_16x16x32_bf16 a[40:43], v[68:71], v[40:43], a[40:43]
    ds_read_b64_tr_b16 v[136:137], v12 offset:49152
    v_mfma_f32_16x16x32_bf16 a[44:47], v[68:71], v[44:47], a[44:47]
    buffer_load_dwordx4 v4, s[4:7], s36 offen offset:2048 lds
    v_mfma_f32_16x16x32_bf16 a[48:51], v[68:71], v[48:51], a[48:51]
    ds_read_b64_tr_b16 v[138:139], v12 offset:50176
    v_mfma_f32_16x16x32_bf16 a[52:55], v[68:71], v[52:55], a[52:55]
    v_mfma_f32_16x16x32_bf16 a[56:59], v[68:71], v[56:59], a[56:59]
    ds_read_b128 v[100:103], v9 offset:34816
    v_mfma_f32_16x16x32_bf16 a[60:63], v[68:71], v[60:63], a[60:63]
    buffer_load_dwordx4 v5, s[4:7], s36 offen offset:3072 lds
    v_mfma_f32_16x16x32_bf16 a[64:67], v[72:75], v[32:35], a[64:67]
    ds_read_b64_tr_b16 v[140:141], v13 offset:49152
    v_mfma_f32_16x16x32_bf16 a[68:71], v[72:75], v[36:39], a[68:71]
    s_add_u32 s37, s58, 1310720
    s_and_b32 s37, s37, 4194303
    s_add_u32 s37, s37, s39
    v_mfma_f32_16x16x32_bf16 a[72:75], v[72:75], v[40:43], a[72:75]
    s_add_u32 m0, s43, 16384
    ds_read_b64_tr_b16 v[142:143], v13 offset:50176
    v_mfma_f32_16x16x32_bf16 a[76:79], v[72:75], v[44:47], a[76:79]
    buffer_load_dwordx4 v6, s[8:11], s37 offen offset:0 lds
    v_mfma_f32_16x16x32_bf16 a[80:83], v[72:75], v[48:51], a[80:83]
    ds_read_b128 v[104:107], v9 offset:36864
    v_mfma_f32_16x16x32_bf16 a[84:87], v[72:75], v[52:55], a[84:87]
    v_mfma_f32_16x16x32_bf16 a[88:91], v[72:75], v[56:59], a[88:91]
    ds_read_b64_tr_b16 v[144:145], v10 offset:51200
    v_mfma_f32_16x16x32_bf16 a[92:95], v[72:75], v[60:63], a[92:95]
    buffer_load_dwordx4 v7, s[8:11], s37 offen offset:1024 lds
    v_mfma_f32_16x16x32_bf16 a[96:99], v[76:79], v[32:35], a[96:99]
    ds_read_b64_tr_b16 v[146:147], v10 offset:52224
    v_mfma_f32_16x16x32_bf16 a[100:103], v[76:79], v[36:39], a[100:103]
    v_mfma_f32_16x16x32_bf16 a[104:107], v[76:79], v[40:43], a[104:107]
    s_add_u32 m0, s43, 18432
    ds_read_b128 v[108:111], v9 offset:38912
    v_mfma_f32_16x16x32_bf16 a[108:111], v[76:79], v[44:47], a[108:111]
    buffer_load_dwordx4 v6, s[12:15], s37 offen offset:0 lds
    v_mfma_f32_16x16x32_bf16 a[112:115], v[76:79], v[48:51], a[112:115]
    ds_read_b64_tr_b16 v[148:149], v11 offset:51200
    v_mfma_f32_16x16x32_bf16 a[116:119], v[76:79], v[52:55], a[116:119]
    v_mfma_f32_16x16x32_bf16 a[120:123], v[76:79], v[56:59], a[120:123]
    ds_read_b64_tr_b16 v[150:151], v11 offset:52224
    v_mfma_f32_16x16x32_bf16 a[124:127], v[76:79], v[60:63], a[124:127]
    buffer_load_dwordx4 v7, s[12:15], s37 offen offset:1024 lds
    v_mfma_f32_16x16x32_bf16 a[128:131], v[32:35], v[80:83], a[128:131]
    ds_read_b128 v[112:115], v9 offset:40960
    v_mfma_f32_16x16x32_bf16 a[132:135], v[36:39], v[80:83], a[132:135]
    s_add_u32 s36, s35, 384
    s_and_b32 s36, s36, 1023
    s_add_u32 s36, s36, s59
    v_mfma_f32_16x16x32_bf16 a[136:139], v[40:43], v[80:83], a[136:139]
    s_add_u32 m0, s42, 4096
    ds_read_b64_tr_b16 v[152:153], v12 offset:51200
    v_mfma_f32_16x16x32_bf16 a[140:143], v[44:47], v[80:83], a[140:143]
    buffer_load_dwordx4 v2, s[4:7], s36 offen offset:0 lds
    v_mfma_f32_16x16x32_bf16 a[144:147], v[48:51], v[80:83], a[144:147]
    ds_read_b64_tr_b16 v[154:155], v12 offset:52224
    v_mfma_f32_16x16x32_bf16 a[148:151], v[52:55], v[80:83], a[148:151]
    v_mfma_f32_16x16x32_bf16 a[152:155], v[56:59], v[80:83], a[152:155]
    ds_read_b128 v[116:119], v9 offset:43008
    v_mfma_f32_16x16x32_bf16 a[156:159], v[60:63], v[80:83], a[156:159]
    buffer_load_dwordx4 v3, s[4:7], s36 offen offset:1024 lds
    v_mfma_f32_16x16x32_bf16 a[160:163], v[32:35], v[84:87], a[160:163]
    ds_read_b64_tr_b16 v[156:157], v13 offset:51200
    v_mfma_f32_16x16x32_bf16 a[164:167], v[36:39], v[84:87], a[164:167]
    v_mfma_f32_16x16x32_bf16 a[168:171], v[40:43], v[84:87], a[168:171]
    ds_read_b64_tr_b16 v[158:159], v13 offset:52224
    v_mfma_f32_16x16x32_bf16 a[172:175], v[44:47], v[84:87], a[172:175]
    buffer_load_dwordx4 v4, s[4:7], s36 offen offset:2048 lds
    v_mfma_f32_16x16x32_bf16 a[176:179], v[48:51], v[84:87], a[176:179]
    ds_read_b128 v[120:123], v9 offset:45056
    v_mfma_f32_16x16x32_bf16 a[180:183], v[52:55], v[84:87], a[180:183]
    v_mfma_f32_16x16x32_bf16 a[184:187], v[56:59], v[84:87], a[184:187]
    ds_read_b128 v[124:127], v9 offset:47104
    v_mfma_f32_16x16x32_bf16 a[188:191], v[60:63], v[84:87], a[188:191]
    buffer_load_dwordx4 v5, s[4:7], s36 offen offset:3072 lds
    v_mfma_f32_16x16x32_bf16 a[192:195], v[32:35], v[88:91], a[192:195]
    v_mfma_f32_16x16x32_bf16 a[196:199], v[36:39], v[88:91], a[196:199]
    v_mfma_f32_16x16x32_bf16 a[200:203], v[40:43], v[88:91], a[200:203]
    v_mfma_f32_16x16x32_bf16 a[204:207], v[44:47], v[88:91], a[204:207]
    v_mfma_f32_16x16x32_bf16 a[208:211], v[48:51], v[88:91], a[208:211]
    v_mfma_f32_16x16x32_bf16 a[212:215], v[52:55], v[88:91], a[212:215]
    v_mfma_f32_16x16x32_bf16 a[216:219], v[56:59], v[88:91], a[216:219]
    v_mfma_f32_16x16x32_bf16 a[220:223], v[60:63], v[88:91], a[220:223]
    v_mfma_f32_16x16x32_bf16 a[224:227], v[32:35], v[92:95], a[224:227]
    v_mfma_f32_16x16x32_bf16 a[228:231], v[36:39], v[92:95], a[228:231]
    v_mfma_f32_16x16x32_bf16 a[232:235], v[40:43], v[92:95], a[232:235]
    v_mfma_f32_16x16x32_bf16 a[236:239], v[44:47], v[92:95], a[236:239]
    v_mfma_f32_16x16x32_bf16 a[240:243], v[48:51], v[92:95], a[240:243]
    v_mfma_f32_16x16x32_bf16 a[244:247], v[52:55], v[92:95], a[244:247]
    v_mfma_f32_16x16x32_bf16 a[248:251], v[56:59], v[92:95], a[248:251]
    v_mfma_f32_16x16x32_bf16 a[252:255], v[60:63], v[92:95], a[252:255]
    s_waitcnt vmcnt(12) lgkmcnt(0)
    s_barrier
    v_mfma_f32_16x16x32_bf16 a[0:3], v[128:131], v[96:99], a[0:3]
    ds_read_b64_tr_b16 v[64:65], v10 offset:0
    v_mfma_f32_16x16x32_bf16 a[4:7], v[128:131], v[100:103], a[4:7]
    s_add_u32 s37, s58, 1572864
    s_and_b32 s37, s37, 4194303
    s_add_u32 s37, s37, s39
    v_mfma_f32_16x16x32_bf16 a[8:11], v[128:131], v[104:107], a[8:11]
    s_add_u32 m0, s43, 32768
    ds_read_b64_tr_b16 v[66:67], v10 offset:1024
    v_mfma_f32_16x16x32_bf16 a[12:15], v[128:131], v[108:111], a[12:15]
    buffer_load_dwordx4 v6, s[8:11], s37 offen offset:0 lds
    v_mfma_f32_16x16x32_bf16 a[16:19], v[128:131], v[112:115], a[16:19]
    ds_read_b64_tr_b16 v[68:69], v11 offset:0
    v_mfma_f32_16x16x32_bf16 a[20:23], v[128:131], v[116:119], a[20:23]
    v_mfma_f32_16x16x32_bf16 a[24:27], v[128:131], v[120:123], a[24:27]
    ds_read_b64_tr_b16 v[70:71], v11 offset:1024
    v_mfma_f32_16x16x32_bf16 a[28:31], v[128:131], v[124:127], a[28:31]
    buffer_load_dwordx4 v7, s[8:11], s37 offen offset:1024 lds
    v_mfma_f32_16x16x32_bf16 a[32:35], v[132:135], v[96:99], a[32:35]
    ds_read_b128 v[32:35], v14 offset:0
    v_mfma_f32_16x16x32_bf16 a[36:39], v[132:135], v[100:103], a[36:39]
    v_mfma_f32_16x16x32_bf16 a[40:43], v[132:135], v[104:107], a[40:43]
    s_add_u32 m0, s43, 34816
    ds_read_b64_tr_b16 v[72:73], v12 offset:0
    v_mfma_f32_16x16x32_bf16 a[44:47], v[132:135], v[108:111], a[44:47]
    buffer_load_dwordx4 v6, s[12:15], s37 offen offset:0 lds
    v_mfma_f32_16x16x32_bf16 a[48:51], v[132:135], v[112:115], a[48:51]
    ds_read_b64_tr_b16 v[74:75], v12 offset:1024
    v_mfma_f32_16x16x32_bf16 a[52:55], v[132:135], v[116:119], a[52:55]
    v_mfma_f32_16x16x32_bf16 a[56:59], v[132:135], v[120:123], a[56:59]
    ds_read_b128 v[36:39], v14 offset:2048
    v_mfma_f32_16x16x32_bf16 a[60:63], v[132:135], v[124:127], a[60:63]
    buffer_load_dwordx4 v7, s[12:15], s37 offen offset:1024 lds
    v_mfma_f32_16x16x32_bf16 a[64:67], v[136:139], v[96:99], a[64:67]
    ds_read_b64_tr_b16 v[76:77], v13 offset:0
    v_mfma_f32_16x16x32_bf16 a[68:71], v[136:139], v[100:103], a[68:71]
    s_add_u32 s36, s35, 512
    s_and_b32 s36, s36, 1023
    s_add_u32 s36, s36, s38
    v_mfma_f32_16x16x32_bf16 a[72:75], v[136:139], v[104:107], a[72:75]
    s_add_u32 m0, s42, 32768
    ds_read_b64_tr_b16 v[78:79], v13 offset:1024
    v_mfma_f32_16x16x32_bf16 a[76:79], v[136:139], v[108:111], a[76:79]
    buffer_load_dwordx4 v2, s[4:7], s36 offen offset:0 lds
    v_mfma_f32_16x16x32_bf16 a[80:83], v[136:139], v[112:115], a[80:83]
    ds_read_b128 v[40:43], v14 offset:4096
    v_mfma_f32_16x16x32_bf16 a[84:87], v[136:139], v[116:119], a[84:87]
    v_mfma_f32_16x16x32_bf16 a[88:91], v[136:139], v[120:123], a[88:91]
    ds_read_b64_tr_b16 v[80:81], v10 offset:2048
    v_mfma_f32_16x16x32_bf16 a[92:95], v[136:139], v[124:127], a[92:95]
    buffer_load_dwordx4 v3, s[4:7], s36 offen offset:1024 lds
    v_mfma_f32_16x16x32_bf16 a[96:99], v[140:143], v[96:99], a[96:99]
    ds_read_b64_tr_b16 v[82:83], v10 offset:3072
    v_mfma_f32_16x16x32_bf16 a[100:103], v[140:143], v[100:103], a[100:103]
    v_mfma_f32_16x16x32_bf16 a[104:107], v[140:143], v[104:107], a[104:107]
    ds_read_b128 v[44:47], v14 offset:6144
    v_mfma_f32_16x16x32_bf16 a[108:111], v[140:143], v[108:111], a[108:111]
    buffer_load_dwordx4 v4, s[4:7], s36 offen offset:2048 lds
    v_mfma_f32_16x16x32_bf16 a[112:115], v[140:143], v[112:115], a[112:115]
    ds_read_b64_tr_b16 v[84:85], v11 offset:2048
    v_mfma_f32_16x16x32_bf16 a[116:119], v[140:143], v[116:119], a[116:119]
    v_mfma_f32_16x16x32_bf16 a[120:123], v[140:143], v[120:123], a[120:123]
    ds_read_b64_tr_b16 v[86:87], v11 offset:3072
    v_mfma_f32_16x16x32_bf16 a[124:127], v[140:143], v[124:127], a[124:127]
    buffer_load_dwordx4 v5, s[4:7], s36 offen offset:3072 lds
    v_mfma_f32_16x16x32_bf16 a[128:131], v[96:99], v[144:147], a[128:131]
    ds_read_b128 v[48:51], v14 offset:8192
    v_mfma_f32_16x16x32_bf16 a[132:135], v[100:103], v[144:147], a[132:135]
    s_add_u32 s37, s58, 1835008
    s_and_b32 s37, s37, 4194303
    s_add_u32 s37, s37, s39
    v_mfma_f32_16x16x32_bf16 a[136:139], v[104:107], v[144:147], a[136:139]
    s_add_u32 m0, s43, 49152
    ds_read_b64_tr_b16 v[88:89], v12 offset:2048
    v_mfma_f32_16x16x32_bf16 a[140:143], v[108:111], v[144:147], a[140:143]
    buffer_load_dwordx4 v6, s[8:11], s37 offen offset:0 lds
    v_mfma_f32_16x16x32_bf16 a[144:147], v[112:115], v[144:147], a[144:147]
    ds_read_b64_tr_b16 v[90:91], v12 offset:3072
    v_mfma_f32_16x16x32_bf16 a[148:151], v[116:119], v[144:147], a[148:151]
    v_mfma_f32_16x16x32_bf16 a[152:155], v[120:123], v[144:147], a[152:155]
    ds_read_b128 v[52:55], v14 offset:10240
    v_mfma_f32_16x16x32_bf16 a[156:159], v[124:127], v[144:147], a[156:159]
    buffer_load_dwordx4 v7, s[8:11], s37 offen offset:1024 lds
    v_mfma_f32_16x16x32_bf16 a[160:163], v[96:99], v[148:151], a[160:163]
    ds_read_b64_tr_b16 v[92:93], v13 offset:2048
    v_mfma_f32_16x16x32_bf16 a[164:167], v[100:103], v[148:151], a[164:167]
    v_mfma_f32_16x16x32_bf16 a[168:171], v[104:107], v[148:151], a[168:171]
    s_add_u32 m0, s43, 51200
    ds_read_b64_tr_b16 v[94:95], v13 offset:3072
    v_mfma_f32_16x16x32_bf16 a[172:175], v[108:111], v[148:151], a[172:175]
    buffer_load_dwordx4 v6, s[12:15], s37 offen offset:0 lds
    v_mfma_f32_16x16x32_bf16 a[176:179], v[112:115], v[148:151], a[176:179]
    ds_read_b128 v[56:59], v14 offset:12288
    v_mfma_f32_16x16x32_bf16 a[180:183], v[116:119], v[148:151], a[180:183]
    v_mfma_f32_16x16x32_bf16 a[184:187], v[120:123], v[148:151], a[184:187]
    ds_read_b128 v[60:63], v14 offset:14336
    v_mfma_f32_16x16x32_bf16 a[188:191], v[124:127], v[148:151], a[188:191]
    buffer_load_dwordx4 v7, s[12:15], s37 offen offset:1024 lds
    v_mfma_f32_16x16x32_bf16 a[192:195], v[96:99], v[152:155], a[192:195]
    v_mfma_f32_16x16x32_bf16 a[196:199], v[100:103], v[152:155], a[196:199]
    v_mfma_f32_16x16x32_bf16 a[200:203], v[104:107], v[152:155], a[200:203]
    v_mfma_f32_16x16x32_bf16 a[204:207], v[108:111], v[152:155], a[204:207]
    v_mfma_f32_16x16x32_bf16 a[208:211], v[112:115], v[152:155], a[208:211]
    v_mfma_f32_16x16x32_bf16 a[212:215], v[116:119], v[152:155], a[212:215]
    v_mfma_f32_16x16x32_bf16 a[216:219], v[120:123], v[152:155], a[216:219]
    v_mfma_f32_16x16x32_bf16 a[220:223], v[124:127], v[152:155], a[220:223]
    v_mfma_f32_16x16x32_bf16 a[224:227], v[96:99], v[156:159], a[224:227]
    v_mfma_f32_16x16x32_bf16 a[228:231], v[100:103], v[156:159], a[228:231]
    v_mfma_f32_16x16x32_bf16 a[232:235], v[104:107], v[156:159], a[232:235]
    v_mfma_f32_16x16x32_bf16 a[236:239], v[108:111], v[156:159], a[236:239]
    v_mfma_f32_16x16x32_bf16 a[240:243], v[112:115], v[156:159], a[240:243]
    v_mfma_f32_16x16x32_bf16 a[244:247], v[116:119], v[156:159], a[244:247]
    v_mfma_f32_16x16x32_bf16 a[248:251], v[120:123], v[156:159], a[248:251]
    v_mfma_f32_16x16x32_bf16 a[252:255], v[124:127], v[156:159], a[252:255]
    s_waitcnt vmcnt(16) lgkmcnt(0)
    s_barrier
    v_mfma_f32_16x16x32_bf16 a[0:3], v[64:67], v[32:35], a[0:3]
    ds_read_b64_tr_b16 v[128:129], v10 offset:16384
    v_mfma_f32_16x16x32_bf16 a[4:7], v[64:67], v[36:39], a[4:7]
    s_add_u32 s36, s35, 512
    s_and_b32 s36, s36, 1023
    s_add_u32 s36, s36, s59
    v_mfma_f32_16x16x32_bf16 a[8:11], v[64:67], v[40:43], a[8:11]
    s_add_u32 m0, s42, 36864
    ds_read_b64_tr_b16 v[130:131], v10 offset:17408
    v_mfma_f32_16x16x32_bf16 a[12:15], v[64:67], v[44:47], a[12:15]
    buffer_load_dwordx4 v2, s[4:7], s36 offen offset:0 lds
    v_mfma_f32_16x16x32_bf16 a[16:19], v[64:67], v[48:51], a[16:19]
    ds_read_b64_tr_b16 v[132:133], v11 offset:16384
    v_mfma_f32_16x16x32_bf16 a[20:23], v[64:67], v[52:55], a[20:23]
gated_mix__ssm_conv_h3__compressed_kv_cla__prompt_kernel_pad0:
    s_cbranch_execz gated_mix__ssm_conv_h3__compressed_kv_cla__prompt_kernel_pad8
    v_mfma_f32_16x16x32_bf16 a[24:27], v[64:67], v[56:59], a[24:27]
    ds_read_b64_tr_b16 v[134:135], v11 offset:17408
    v_mfma_f32_16x16x32_bf16 a[28:31], v[64:67], v[60:63], a[28:31]
    buffer_load_dwordx4 v3, s[4:7], s36 offen offset:1024 lds
    v_mfma_f32_16x16x32_bf16 a[32:35], v[68:71], v[32:35], a[32:35]
    ds_read_b128 v[96:99], v15 offset:0
    v_mfma_f32_16x16x32_bf16 a[36:39], v[68:71], v[36:39], a[36:39]
    v_mfma_f32_16x16x32_bf16 a[40:43], v[68:71], v[40:43], a[40:43]
    ds_read_b64_tr_b16 v[136:137], v12 offset:16384
    v_mfma_f32_16x16x32_bf16 a[44:47], v[68:71], v[44:47], a[44:47]
    buffer_load_dwordx4 v4, s[4:7], s36 offen offset:2048 lds
    v_mfma_f32_16x16x32_bf16 a[48:51], v[68:71], v[48:51], a[48:51]
    ds_read_b64_tr_b16 v[138:139], v12 offset:17408
    v_mfma_f32_16x16x32_bf16 a[52:55], v[68:71], v[52:55], a[52:55]
    v_mfma_f32_16x16x32_bf16 a[56:59], v[68:71], v[56:59], a[56:59]
    ds_read_b128 v[100:103], v15 offset:2048
    v_mfma_f32_16x16x32_bf16 a[60:63], v[68:71], v[60:63], a[60:63]
    buffer_load_dwordx4 v5, s[4:7], s36 offen offset:3072 lds
    v_mfma_f32_16x16x32_bf16 a[64:67], v[72:75], v[32:35], a[64:67]
    ds_read_b64_tr_b16 v[140:141], v13 offset:16384
    v_mfma_f32_16x16x32_bf16 a[68:71], v[72:75], v[36:39], a[68:71]
    s_add_u32 s37, s58, 2097152
    s_and_b32 s37, s37, 4194303
    s_add_u32 s37, s37, s39
    v_mfma_f32_16x16x32_bf16 a[72:75], v[72:75], v[40:43], a[72:75]
    s_add_u32 m0, s43, 0
    ds_read_b64_tr_b16 v[142:143], v13 offset:17408
    v_mfma_f32_16x16x32_bf16 a[76:79], v[72:75], v[44:47], a[76:79]
    buffer_load_dwordx4 v6, s[8:11], s37 offen offset:0 lds
    v_mfma_f32_16x16x32_bf16 a[80:83], v[72:75], v[48:51], a[80:83]
    ds_read_b128 v[104:107], v15 offset:4096
    v_mfma_f32_16x16x32_bf16 a[84:87], v[72:75], v[52:55], a[84:87]
    v_mfma_f32_16x16x32_bf16 a[88:91], v[72:75], v[56:59], a[88:91]
    ds_read_b64_tr_b16 v[144:145], v10 offset:18432
    v_mfma_f32_16x16x32_bf16 a[92:95], v[72:75], v[60:63], a[92:95]
    buffer_load_dwordx4 v7, s[8:11], s37 offen offset:1024 lds
    v_mfma_f32_16x16x32_bf16 a[96:99], v[76:79], v[32:35], a[96:99]
    ds_read_b64_tr_b16 v[146:147], v10 offset:19456
    v_mfma_f32_16x16x32_bf16 a[100:103], v[76:79], v[36:39], a[100:103]
    v_mfma_f32_16x16x32_bf16 a[104:107], v[76:79], v[40:43], a[104:107]
    s_add_u32 m0, s43, 2048
    ds_read_b128 v[108:111], v15 offset:6144
    v_mfma_f32_16x16x32_bf16 a[108:111], v[76:79], v[44:47], a[108:111]
    buffer_load_dwordx4 v6, s[12:15], s37 offen offset:0 lds
    v_mfma_f32_16x16x32_bf16 a[112:115], v[76:79], v[48:51], a[112:115]
    ds_read_b64_tr_b16 v[148:149], v11 offset:18432
    v_mfma_f32_16x16x32_bf16 a[116:119], v[76:79], v[52:55], a[116:119]
    v_mfma_f32_16x16x32_bf16 a[120:123], v[76:79], v[56:59], a[120:123]
    ds_read_b64_tr_b16 v[150:151], v11 offset:19456
    v_mfma_f32_16x16x32_bf16 a[124:127], v[76:79], v[60:63], a[124:127]
    buffer_load_dwordx4 v7, s[12:15], s37 offen offset:1024 lds
    v_mfma_f32_16x16x32_bf16 a[128:131], v[32:35], v[80:83], a[128:131]
    ds_read_b128 v[112:115], v15 offset:8192
    v_mfma_f32_16x16x32_bf16 a[132:135], v[36:39], v[80:83], a[132:135]
    buffer_load_dwordx2 v[160:161], v1, s[16:19], 0 offen offset:0
    v_mfma_f32_16x16x32_bf16 a[136:139], v[40:43], v[80:83], a[136:139]
    ds_read_b64_tr_b16 v[152:153], v12 offset:18432
    v_mfma_f32_16x16x32_bf16 a[140:143], v[44:47], v[80:83], a[140:143]
    buffer_load_dwordx2 v[162:163], v1, s[16:19], 0 offen offset:2048
    v_mfma_f32_16x16x32_bf16 a[144:147], v[48:51], v[80:83], a[144:147]
    ds_read_b64_tr_b16 v[154:155], v12 offset:19456
    v_mfma_f32_16x16x32_bf16 a[148:151], v[52:55], v[80:83], a[148:151]
    buffer_load_dwordx2 v[164:165], v1, s[16:19], s47 offen offset:0
    v_mfma_f32_16x16x32_bf16 a[152:155], v[56:59], v[80:83], a[152:155]
    ds_read_b128 v[116:119], v15 offset:10240
    v_mfma_f32_16x16x32_bf16 a[156:159], v[60:63], v[80:83], a[156:159]
    buffer_load_dwordx2 v[166:167], v0, s[16:19], 0 offen offset:0
    v_mfma_f32_16x16x32_bf16 a[160:163], v[32:35], v[84:87], a[160:163]
    ds_read_b64_tr_b16 v[156:157], v13 offset:18432
    v_mfma_f32_16x16x32_bf16 a[164:167], v[36:39], v[84:87], a[164:167]
    buffer_load_dwordx2 v[168:169], v0, s[16:19], 0 offen offset:2048
    v_mfma_f32_16x16x32_bf16 a[168:171], v[40:43], v[84:87], a[168:171]
    ds_read_b64_tr_b16 v[158:159], v13 offset:19456
    v_mfma_f32_16x16x32_bf16 a[172:175], v[44:47], v[84:87], a[172:175]
    buffer_load_dwordx2 v[170:171], v0, s[16:19], s47 offen offset:0
    v_mfma_f32_16x16x32_bf16 a[176:179], v[48:51], v[84:87], a[176:179]
    ds_read_b128 v[120:123], v15 offset:12288
    v_mfma_f32_16x16x32_bf16 a[180:183], v[52:55], v[84:87], a[180:183]
    buffer_load_dwordx2 v[172:173], v0, s[16:19], s47 offen offset:2048
    v_mfma_f32_16x16x32_bf16 a[184:187], v[56:59], v[84:87], a[184:187]
    ds_read_b128 v[124:127], v15 offset:14336
    v_mfma_f32_16x16x32_bf16 a[188:191], v[60:63], v[84:87], a[188:191]
    buffer_load_dwordx2 v[174:175], v0, s[16:19], s48 offen offset:0
    v_mfma_f32_16x16x32_bf16 a[192:195], v[32:35], v[88:91], a[192:195]
    buffer_load_dwordx2 v[176:177], v0, s[16:19], s48 offen offset:2048
    v_mfma_f32_16x16x32_bf16 a[196:199], v[36:39], v[88:91], a[196:199]
    buffer_load_dwordx2 v[178:179], v0, s[16:19], s51 offen offset:0
    v_mfma_f32_16x16x32_bf16 a[200:203], v[40:43], v[88:91], a[200:203]
    buffer_load_dwordx2 v[180:181], v0, s[16:19], s51 offen offset:2048
    v_mfma_f32_16x16x32_bf16 a[204:207], v[44:47], v[88:91], a[204:207]
    buffer_load_dwordx2 v[182:183], v0, s[76:79], 0 offen offset:0
    v_mfma_f32_16x16x32_bf16 a[208:211], v[48:51], v[88:91], a[208:211]
    buffer_load_dwordx2 v[184:185], v0, s[76:79], 0 offen offset:2048
    v_mfma_f32_16x16x32_bf16 a[212:215], v[52:55], v[88:91], a[212:215]
    buffer_load_dwordx2 v[186:187], v0, s[76:79], s47 offen offset:0
    v_mfma_f32_16x16x32_bf16 a[216:219], v[56:59], v[88:91], a[216:219]
    buffer_load_dwordx2 v[188:189], v0, s[76:79], s47 offen offset:2048
    v_mfma_f32_16x16x32_bf16 a[220:223], v[60:63], v[88:91], a[220:223]
    buffer_load_dwordx2 v[190:191], v0, s[76:79], s48 offen offset:0
    v_mfma_f32_16x16x32_bf16 a[224:227], v[32:35], v[92:95], a[224:227]
    buffer_load_dwordx2 v[192:193], v0, s[76:79], s48 offen offset:2048
    v_mfma_f32_16x16x32_bf16 a[228:231], v[36:39], v[92:95], a[228:231]
    buffer_load_dwordx2 v[194:195], v0, s[76:79], s51 offen offset:0
    v_mfma_f32_16x16x32_bf16 a[232:235], v[40:43], v[92:95], a[232:235]
    buffer_load_dwordx2 v[196:197], v0, s[76:79], s51 offen offset:2048
    v_mfma_f32_16x16x32_bf16 a[236:239], v[44:47], v[92:95], a[236:239]
    v_mfma_f32_16x16x32_bf16 a[240:243], v[48:51], v[92:95], a[240:243]
    v_mfma_f32_16x16x32_bf16 a[244:247], v[52:55], v[92:95], a[244:247]
    v_mfma_f32_16x16x32_bf16 a[248:251], v[56:59], v[92:95], a[248:251]
    v_mfma_f32_16x16x32_bf16 a[252:255], v[60:63], v[92:95], a[252:255]
    s_waitcnt vmcnt(35) lgkmcnt(0)
    s_barrier
    v_mfma_f32_16x16x32_bf16 a[0:3], v[128:131], v[96:99], a[0:3]
    s_mov_b32 s16, s88
    ds_read_b64_tr_b16 v[64:65], v10 offset:32768
    v_mfma_f32_16x16x32_bf16 a[4:7], v[128:131], v[100:103], a[4:7]
    s_add_u32 s36, s35, 640
    s_and_b32 s36, s36, 1023
    s_add_u32 s36, s36, s38
    v_mfma_f32_16x16x32_bf16 a[8:11], v[128:131], v[104:107], a[8:11]
    s_add_u32 m0, s42, 65536
    ds_read_b64_tr_b16 v[66:67], v10 offset:33792
    v_mfma_f32_16x16x32_bf16 a[12:15], v[128:131], v[108:111], a[12:15]
    buffer_load_dwordx4 v2, s[4:7], s36 offen offset:0 lds
    v_mfma_f32_16x16x32_bf16 a[16:19], v[128:131], v[112:115], a[16:19]
    s_mov_b32 s17, s89
    ds_read_b64_tr_b16 v[68:69], v11 offset:32768
    v_mfma_f32_16x16x32_bf16 a[20:23], v[128:131], v[116:119], a[20:23]
    s_mov_b32 s18, 2048
    v_mfma_f32_16x16x32_bf16 a[24:27], v[128:131], v[120:123], a[24:27]
    s_mov_b32 s76, s70
    ds_read_b64_tr_b16 v[70:71], v11 offset:33792
    v_mfma_f32_16x16x32_bf16 a[28:31], v[128:131], v[124:127], a[28:31]
    buffer_load_dwordx4 v3, s[4:7], s36 offen offset:1024 lds
    v_mfma_f32_16x16x32_bf16 a[32:35], v[132:135], v[96:99], a[32:35]
    s_mov_b32 s77, s71
    ds_read_b128 v[32:35], v8 offset:0
    v_mfma_f32_16x16x32_bf16 a[36:39], v[132:135], v[100:103], a[36:39]
    s_mov_b32 s78, 8192
    v_mfma_f32_16x16x32_bf16 a[40:43], v[132:135], v[104:107], a[40:43]
    ds_read_b64_tr_b16 v[72:73], v12 offset:32768
    v_mfma_f32_16x16x32_bf16 a[44:47], v[132:135], v[108:111], a[44:47]
    buffer_load_dwordx4 v4, s[4:7], s36 offen offset:2048 lds
    v_mfma_f32_16x16x32_bf16 a[48:51], v[132:135], v[112:115], a[48:51]
    ds_read_b64_tr_b16 v[74:75], v12 offset:33792
    v_mfma_f32_16x16x32_bf16 a[52:55], v[132:135], v[116:119], a[52:55]
    v_mfma_f32_16x16x32_bf16 a[56:59], v[132:135], v[120:123], a[56:59]
    ds_read_b128 v[36:39], v8 offset:2048
    v_mfma_f32_16x16x32_bf16 a[60:63], v[132:135], v[124:127], a[60:63]
    buffer_load_dwordx4 v5, s[4:7], s36 offen offset:3072 lds
    v_mfma_f32_16x16x32_bf16 a[64:67], v[136:139], v[96:99], a[64:67]
    ds_read_b64_tr_b16 v[76:77], v13 offset:32768
    v_mfma_f32_16x16x32_bf16 a[68:71], v[136:139], v[100:103], a[68:71]
    s_add_u32 s37, s58, 2359296
    s_and_b32 s37, s37, 4194303
    s_add_u32 s37, s37, s39
    v_mfma_f32_16x16x32_bf16 a[72:75], v[136:139], v[104:107], a[72:75]
    s_add_u32 m0, s43, 16384
    ds_read_b64_tr_b16 v[78:79], v13 offset:33792
    v_mfma_f32_16x16x32_bf16 a[76:79], v[136:139], v[108:111], a[76:79]
    buffer_load_dwordx4 v6, s[8:11], s37 offen offset:0 lds
    v_mfma_f32_16x16x32_bf16 a[80:83], v[136:139], v[112:115], a[80:83]
    ds_read_b128 v[40:43], v8 offset:4096
    v_mfma_f32_16x16x32_bf16 a[84:87], v[136:139], v[116:119], a[84:87]
    v_mfma_f32_16x16x32_bf16 a[88:91], v[136:139], v[120:123], a[88:91]
    ds_read_b64_tr_b16 v[80:81], v10 offset:34816
    v_mfma_f32_16x16x32_bf16 a[92:95], v[136:139], v[124:127], a[92:95]
    buffer_load_dwordx4 v7, s[8:11], s37 offen offset:1024 lds
    v_mfma_f32_16x16x32_bf16 a[96:99], v[140:143], v[96:99], a[96:99]
    ds_read_b64_tr_b16 v[82:83], v10 offset:35840
    v_mfma_f32_16x16x32_bf16 a[100:103], v[140:143], v[100:103], a[100:103]
    v_mfma_f32_16x16x32_bf16 a[104:107], v[140:143], v[104:107], a[104:107]
    s_add_u32 m0, s43, 18432
    ds_read_b128 v[44:47], v8 offset:6144
    v_mfma_f32_16x16x32_bf16 a[108:111], v[140:143], v[108:111], a[108:111]
    buffer_load_dwordx4 v6, s[12:15], s37 offen offset:0 lds
    v_mfma_f32_16x16x32_bf16 a[112:115], v[140:143], v[112:115], a[112:115]
    ds_read_b64_tr_b16 v[84:85], v11 offset:34816
    v_mfma_f32_16x16x32_bf16 a[116:119], v[140:143], v[116:119], a[116:119]
    v_mfma_f32_16x16x32_bf16 a[120:123], v[140:143], v[120:123], a[120:123]
    ds_read_b64_tr_b16 v[86:87], v11 offset:35840
    v_mfma_f32_16x16x32_bf16 a[124:127], v[140:143], v[124:127], a[124:127]
    buffer_load_dwordx4 v7, s[12:15], s37 offen offset:1024 lds
    v_mfma_f32_16x16x32_bf16 a[128:131], v[96:99], v[144:147], a[128:131]
    ds_read_b128 v[48:51], v8 offset:8192
    v_mfma_f32_16x16x32_bf16 a[132:135], v[100:103], v[144:147], a[132:135]
    v_mfma_f32_16x16x32_bf16 a[136:139], v[104:107], v[144:147], a[136:139]
    ds_read_b64_tr_b16 v[88:89], v12 offset:34816
    v_mfma_f32_16x16x32_bf16 a[140:143], v[108:111], v[144:147], a[140:143]
    v_mfma_f32_16x16x32_bf16 a[144:147], v[112:115], v[144:147], a[144:147]
    ds_read_b64_tr_b16 v[90:91], v12 offset:35840
    v_mfma_f32_16x16x32_bf16 a[148:151], v[116:119], v[144:147], a[148:151]
    v_mfma_f32_16x16x32_bf16 a[152:155], v[120:123], v[144:147], a[152:155]
    ds_read_b128 v[52:55], v8 offset:10240
    v_mfma_f32_16x16x32_bf16 a[156:159], v[124:127], v[144:147], a[156:159]
    v_mfma_f32_16x16x32_bf16 a[160:163], v[96:99], v[148:151], a[160:163]
    ds_read_b64_tr_b16 v[92:93], v13 offset:34816
    v_mfma_f32_16x16x32_bf16 a[164:167], v[100:103], v[148:151], a[164:167]
    v_mfma_f32_16x16x32_bf16 a[168:171], v[104:107], v[148:151], a[168:171]
    ds_read_b64_tr_b16 v[94:95], v13 offset:35840
    v_mfma_f32_16x16x32_bf16 a[172:175], v[108:111], v[148:151], a[172:175]
    v_mfma_f32_16x16x32_bf16 a[176:179], v[112:115], v[148:151], a[176:179]
    ds_read_b128 v[56:59], v8 offset:12288
    v_mfma_f32_16x16x32_bf16 a[180:183], v[116:119], v[148:151], a[180:183]
    v_mfma_f32_16x16x32_bf16 a[184:187], v[120:123], v[148:151], a[184:187]
    ds_read_b128 v[60:63], v8 offset:14336
    v_mfma_f32_16x16x32_bf16 a[188:191], v[124:127], v[148:151], a[188:191]
    v_mfma_f32_16x16x32_bf16 a[192:195], v[96:99], v[152:155], a[192:195]
    v_mfma_f32_16x16x32_bf16 a[196:199], v[100:103], v[152:155], a[196:199]
    v_mfma_f32_16x16x32_bf16 a[200:203], v[104:107], v[152:155], a[200:203]
    v_mfma_f32_16x16x32_bf16 a[204:207], v[108:111], v[152:155], a[204:207]
    v_mfma_f32_16x16x32_bf16 a[208:211], v[112:115], v[152:155], a[208:211]
    v_mfma_f32_16x16x32_bf16 a[212:215], v[116:119], v[152:155], a[212:215]
    v_mfma_f32_16x16x32_bf16 a[216:219], v[120:123], v[152:155], a[216:219]
    v_mfma_f32_16x16x32_bf16 a[220:223], v[124:127], v[152:155], a[220:223]
    v_mfma_f32_16x16x32_bf16 a[224:227], v[96:99], v[156:159], a[224:227]
    v_mfma_f32_16x16x32_bf16 a[228:231], v[100:103], v[156:159], a[228:231]
    v_mfma_f32_16x16x32_bf16 a[232:235], v[104:107], v[156:159], a[232:235]
    v_mfma_f32_16x16x32_bf16 a[236:239], v[108:111], v[156:159], a[236:239]
    v_mfma_f32_16x16x32_bf16 a[240:243], v[112:115], v[156:159], a[240:243]
    v_mfma_f32_16x16x32_bf16 a[244:247], v[116:119], v[156:159], a[244:247]
    v_mfma_f32_16x16x32_bf16 a[248:251], v[120:123], v[156:159], a[248:251]
    v_mfma_f32_16x16x32_bf16 a[252:255], v[124:127], v[156:159], a[252:255]
    s_waitcnt vmcnt(35) lgkmcnt(0)
    s_barrier
    v_mfma_f32_16x16x32_bf16 a[0:3], v[64:67], v[32:35], a[0:3]
    ds_read_b64_tr_b16 v[128:129], v10 offset:49152
    v_mfma_f32_16x16x32_bf16 a[4:7], v[64:67], v[36:39], a[4:7]
    s_add_u32 s36, s35, 640
    s_and_b32 s36, s36, 1023
    s_add_u32 s36, s36, s59
    v_mfma_f32_16x16x32_bf16 a[8:11], v[64:67], v[40:43], a[8:11]
    s_add_u32 m0, s42, 69632
    ds_read_b64_tr_b16 v[130:131], v10 offset:50176
    v_mfma_f32_16x16x32_bf16 a[12:15], v[64:67], v[44:47], a[12:15]
    buffer_load_dwordx4 v2, s[4:7], s36 offen offset:0 lds
    v_mfma_f32_16x16x32_bf16 a[16:19], v[64:67], v[48:51], a[16:19]
    ds_read_b64_tr_b16 v[132:133], v11 offset:49152
    v_mfma_f32_16x16x32_bf16 a[20:23], v[64:67], v[52:55], a[20:23]
    v_mfma_f32_16x16x32_bf16 a[24:27], v[64:67], v[56:59], a[24:27]
    ds_read_b64_tr_b16 v[134:135], v11 offset:50176
    v_mfma_f32_16x16x32_bf16 a[28:31], v[64:67], v[60:63], a[28:31]
    buffer_load_dwordx4 v3, s[4:7], s36 offen offset:1024 lds
    v_mfma_f32_16x16x32_bf16 a[32:35], v[68:71], v[32:35], a[32:35]
    ds_read_b128 v[96:99], v9 offset:0
    v_mfma_f32_16x16x32_bf16 a[36:39], v[68:71], v[36:39], a[36:39]
    v_mfma_f32_16x16x32_bf16 a[40:43], v[68:71], v[40:43], a[40:43]
    ds_read_b64_tr_b16 v[136:137], v12 offset:49152
    v_mfma_f32_16x16x32_bf16 a[44:47], v[68:71], v[44:47], a[44:47]
    buffer_load_dwordx4 v4, s[4:7], s36 offen offset:2048 lds
    v_mfma_f32_16x16x32_bf16 a[48:51], v[68:71], v[48:51], a[48:51]
    ds_read_b64_tr_b16 v[138:139], v12 offset:50176
    v_mfma_f32_16x16x32_bf16 a[52:55], v[68:71], v[52:55], a[52:55]
    v_mfma_f32_16x16x32_bf16 a[56:59], v[68:71], v[56:59], a[56:59]
    ds_read_b128 v[100:103], v9 offset:2048
    v_mfma_f32_16x16x32_bf16 a[60:63], v[68:71], v[60:63], a[60:63]
    buffer_load_dwordx4 v5, s[4:7], s36 offen offset:3072 lds
    v_mfma_f32_16x16x32_bf16 a[64:67], v[72:75], v[32:35], a[64:67]
    ds_read_b64_tr_b16 v[140:141], v13 offset:49152
    v_mfma_f32_16x16x32_bf16 a[68:71], v[72:75], v[36:39], a[68:71]
    s_add_u32 s37, s58, 2621440
    s_and_b32 s37, s37, 4194303
    s_add_u32 s37, s37, s39
    v_mfma_f32_16x16x32_bf16 a[72:75], v[72:75], v[40:43], a[72:75]
    s_add_u32 m0, s43, 32768
    ds_read_b64_tr_b16 v[142:143], v13 offset:50176
    v_mfma_f32_16x16x32_bf16 a[76:79], v[72:75], v[44:47], a[76:79]
    buffer_load_dwordx4 v6, s[8:11], s37 offen offset:0 lds
    v_mfma_f32_16x16x32_bf16 a[80:83], v[72:75], v[48:51], a[80:83]
    ds_read_b128 v[104:107], v9 offset:4096
    v_mfma_f32_16x16x32_bf16 a[84:87], v[72:75], v[52:55], a[84:87]
    v_mfma_f32_16x16x32_bf16 a[88:91], v[72:75], v[56:59], a[88:91]
    ds_read_b64_tr_b16 v[144:145], v10 offset:51200
    v_mfma_f32_16x16x32_bf16 a[92:95], v[72:75], v[60:63], a[92:95]
    buffer_load_dwordx4 v7, s[8:11], s37 offen offset:1024 lds
    v_mfma_f32_16x16x32_bf16 a[96:99], v[76:79], v[32:35], a[96:99]
    ds_read_b64_tr_b16 v[146:147], v10 offset:52224
    v_mfma_f32_16x16x32_bf16 a[100:103], v[76:79], v[36:39], a[100:103]
    v_mfma_f32_16x16x32_bf16 a[104:107], v[76:79], v[40:43], a[104:107]
    s_add_u32 m0, s43, 34816
    ds_read_b128 v[108:111], v9 offset:6144
    v_mfma_f32_16x16x32_bf16 a[108:111], v[76:79], v[44:47], a[108:111]
    buffer_load_dwordx4 v6, s[12:15], s37 offen offset:0 lds
    v_mfma_f32_16x16x32_bf16 a[112:115], v[76:79], v[48:51], a[112:115]
    ds_read_b64_tr_b16 v[148:149], v11 offset:51200
    v_mfma_f32_16x16x32_bf16 a[116:119], v[76:79], v[52:55], a[116:119]
    v_mfma_f32_16x16x32_bf16 a[120:123], v[76:79], v[56:59], a[120:123]
    ds_read_b64_tr_b16 v[150:151], v11 offset:52224
    v_mfma_f32_16x16x32_bf16 a[124:127], v[76:79], v[60:63], a[124:127]
    buffer_load_dwordx4 v7, s[12:15], s37 offen offset:1024 lds
    v_mfma_f32_16x16x32_bf16 a[128:131], v[32:35], v[80:83], a[128:131]
    ds_read_b128 v[112:115], v9 offset:8192
    v_mfma_f32_16x16x32_bf16 a[132:135], v[36:39], v[80:83], a[132:135]
    v_mfma_f32_16x16x32_bf16 a[136:139], v[40:43], v[80:83], a[136:139]
    ds_read_b64_tr_b16 v[152:153], v12 offset:51200
    v_mfma_f32_16x16x32_bf16 a[140:143], v[44:47], v[80:83], a[140:143]
    v_mfma_f32_16x16x32_bf16 a[144:147], v[48:51], v[80:83], a[144:147]
    ds_read_b64_tr_b16 v[154:155], v12 offset:52224
    v_mfma_f32_16x16x32_bf16 a[148:151], v[52:55], v[80:83], a[148:151]
    v_mfma_f32_16x16x32_bf16 a[152:155], v[56:59], v[80:83], a[152:155]
    ds_read_b128 v[116:119], v9 offset:10240
    v_mfma_f32_16x16x32_bf16 a[156:159], v[60:63], v[80:83], a[156:159]
    v_mfma_f32_16x16x32_bf16 a[160:163], v[32:35], v[84:87], a[160:163]
    ds_read_b64_tr_b16 v[156:157], v13 offset:51200
    v_mfma_f32_16x16x32_bf16 a[164:167], v[36:39], v[84:87], a[164:167]
    v_mfma_f32_16x16x32_bf16 a[168:171], v[40:43], v[84:87], a[168:171]
    ds_read_b64_tr_b16 v[158:159], v13 offset:52224
    v_mfma_f32_16x16x32_bf16 a[172:175], v[44:47], v[84:87], a[172:175]
    v_mfma_f32_16x16x32_bf16 a[176:179], v[48:51], v[84:87], a[176:179]
    ds_read_b128 v[120:123], v9 offset:12288
    v_mfma_f32_16x16x32_bf16 a[180:183], v[52:55], v[84:87], a[180:183]
    v_mfma_f32_16x16x32_bf16 a[184:187], v[56:59], v[84:87], a[184:187]
    ds_read_b128 v[124:127], v9 offset:14336
    v_mfma_f32_16x16x32_bf16 a[188:191], v[60:63], v[84:87], a[188:191]
    v_mfma_f32_16x16x32_bf16 a[192:195], v[32:35], v[88:91], a[192:195]
    v_mfma_f32_16x16x32_bf16 a[196:199], v[36:39], v[88:91], a[196:199]
    v_mfma_f32_16x16x32_bf16 a[200:203], v[40:43], v[88:91], a[200:203]
    v_mfma_f32_16x16x32_bf16 a[204:207], v[44:47], v[88:91], a[204:207]
    v_mfma_f32_16x16x32_bf16 a[208:211], v[48:51], v[88:91], a[208:211]
    v_mfma_f32_16x16x32_bf16 a[212:215], v[52:55], v[88:91], a[212:215]
    v_mfma_f32_16x16x32_bf16 a[216:219], v[56:59], v[88:91], a[216:219]
    v_mfma_f32_16x16x32_bf16 a[220:223], v[60:63], v[88:91], a[220:223]
    v_mfma_f32_16x16x32_bf16 a[224:227], v[32:35], v[92:95], a[224:227]
    v_mfma_f32_16x16x32_bf16 a[228:231], v[36:39], v[92:95], a[228:231]
    v_mfma_f32_16x16x32_bf16 a[232:235], v[40:43], v[92:95], a[232:235]
    v_mfma_f32_16x16x32_bf16 a[236:239], v[44:47], v[92:95], a[236:239]
    v_mfma_f32_16x16x32_bf16 a[240:243], v[48:51], v[92:95], a[240:243]
    v_mfma_f32_16x16x32_bf16 a[244:247], v[52:55], v[92:95], a[244:247]
    v_mfma_f32_16x16x32_bf16 a[248:251], v[56:59], v[92:95], a[248:251]
    v_mfma_f32_16x16x32_bf16 a[252:255], v[60:63], v[92:95], a[252:255]
    s_waitcnt vmcnt(35) lgkmcnt(0)
    s_barrier
    v_mfma_f32_16x16x32_bf16 a[0:3], v[128:131], v[96:99], a[0:3]
    ds_read_b64_tr_b16 v[64:65], v10 offset:0
    v_mfma_f32_16x16x32_bf16 a[4:7], v[128:131], v[100:103], a[4:7]
    s_add_u32 s36, s35, 768
    s_and_b32 s36, s36, 1023
    s_add_u32 s36, s36, s38
    v_mfma_f32_16x16x32_bf16 a[8:11], v[128:131], v[104:107], a[8:11]
    s_add_u32 m0, s42, 0
    ds_read_b64_tr_b16 v[66:67], v10 offset:1024
    v_mfma_f32_16x16x32_bf16 a[12:15], v[128:131], v[108:111], a[12:15]
    buffer_load_dwordx4 v2, s[4:7], s36 offen offset:0 lds
    v_mfma_f32_16x16x32_bf16 a[16:19], v[128:131], v[112:115], a[16:19]
    ds_read_b64_tr_b16 v[68:69], v11 offset:0
    v_mfma_f32_16x16x32_bf16 a[20:23], v[128:131], v[116:119], a[20:23]
    v_mfma_f32_16x16x32_bf16 a[24:27], v[128:131], v[120:123], a[24:27]
    ds_read_b64_tr_b16 v[70:71], v11 offset:1024
    v_mfma_f32_16x16x32_bf16 a[28:31], v[128:131], v[124:127], a[28:31]
    buffer_load_dwordx4 v3, s[4:7], s36 offen offset:1024 lds
    v_mfma_f32_16x16x32_bf16 a[32:35], v[132:135], v[96:99], a[32:35]
    ds_read_b128 v[32:35], v8 offset:32768
    v_mfma_f32_16x16x32_bf16 a[36:39], v[132:135], v[100:103], a[36:39]
    v_mfma_f32_16x16x32_bf16 a[40:43], v[132:135], v[104:107], a[40:43]
    ds_read_b64_tr_b16 v[72:73], v12 offset:0
    v_mfma_f32_16x16x32_bf16 a[44:47], v[132:135], v[108:111], a[44:47]
    buffer_load_dwordx4 v4, s[4:7], s36 offen offset:2048 lds
    v_mfma_f32_16x16x32_bf16 a[48:51], v[132:135], v[112:115], a[48:51]
    ds_read_b64_tr_b16 v[74:75], v12 offset:1024
    v_mfma_f32_16x16x32_bf16 a[52:55], v[132:135], v[116:119], a[52:55]
    v_mfma_f32_16x16x32_bf16 a[56:59], v[132:135], v[120:123], a[56:59]
    ds_read_b128 v[36:39], v8 offset:34816
    v_mfma_f32_16x16x32_bf16 a[60:63], v[132:135], v[124:127], a[60:63]
    buffer_load_dwordx4 v5, s[4:7], s36 offen offset:3072 lds
    v_mfma_f32_16x16x32_bf16 a[64:67], v[136:139], v[96:99], a[64:67]
    ds_read_b64_tr_b16 v[76:77], v13 offset:0
    v_mfma_f32_16x16x32_bf16 a[68:71], v[136:139], v[100:103], a[68:71]
    s_add_u32 s37, s58, 2883584
    s_and_b32 s37, s37, 4194303
    s_add_u32 s37, s37, s39
    v_mfma_f32_16x16x32_bf16 a[72:75], v[136:139], v[104:107], a[72:75]
    s_add_u32 m0, s43, 49152
    ds_read_b64_tr_b16 v[78:79], v13 offset:1024
    v_mfma_f32_16x16x32_bf16 a[76:79], v[136:139], v[108:111], a[76:79]
    buffer_load_dwordx4 v6, s[8:11], s37 offen offset:0 lds
    v_mfma_f32_16x16x32_bf16 a[80:83], v[136:139], v[112:115], a[80:83]
    ds_read_b128 v[40:43], v8 offset:36864
    v_mfma_f32_16x16x32_bf16 a[84:87], v[136:139], v[116:119], a[84:87]
    v_mfma_f32_16x16x32_bf16 a[88:91], v[136:139], v[120:123], a[88:91]
    ds_read_b64_tr_b16 v[80:81], v10 offset:2048
    v_mfma_f32_16x16x32_bf16 a[92:95], v[136:139], v[124:127], a[92:95]
    buffer_load_dwordx4 v7, s[8:11], s37 offen offset:1024 lds
    v_mfma_f32_16x16x32_bf16 a[96:99], v[140:143], v[96:99], a[96:99]
    ds_read_b64_tr_b16 v[82:83], v10 offset:3072
    v_mfma_f32_16x16x32_bf16 a[100:103], v[140:143], v[100:103], a[100:103]
    v_mfma_f32_16x16x32_bf16 a[104:107], v[140:143], v[104:107], a[104:107]
    s_add_u32 m0, s43, 51200
    ds_read_b128 v[44:47], v8 offset:38912
    v_mfma_f32_16x16x32_bf16 a[108:111], v[140:143], v[108:111], a[108:111]
    buffer_load_dwordx4 v6, s[12:15], s37 offen offset:0 lds
    v_mfma_f32_16x16x32_bf16 a[112:115], v[140:143], v[112:115], a[112:115]
    ds_read_b64_tr_b16 v[84:85], v11 offset:2048
    v_mfma_f32_16x16x32_bf16 a[116:119], v[140:143], v[116:119], a[116:119]
    v_mfma_f32_16x16x32_bf16 a[120:123], v[140:143], v[120:123], a[120:123]
    ds_read_b64_tr_b16 v[86:87], v11 offset:3072
    v_mfma_f32_16x16x32_bf16 a[124:127], v[140:143], v[124:127], a[124:127]
    buffer_load_dwordx4 v7, s[12:15], s37 offen offset:1024 lds
    v_mfma_f32_16x16x32_bf16 a[128:131], v[96:99], v[144:147], a[128:131]
    ds_read_b128 v[48:51], v8 offset:40960
    v_mfma_f32_16x16x32_bf16 a[132:135], v[100:103], v[144:147], a[132:135]
    buffer_load_dwordx4 v[206:209], v233, s[24:27], s40 offen offset:0
    v_mfma_f32_16x16x32_bf16 a[136:139], v[104:107], v[144:147], a[136:139]
    ds_read_b64_tr_b16 v[88:89], v12 offset:2048
    v_mfma_f32_16x16x32_bf16 a[140:143], v[108:111], v[144:147], a[140:143]
    buffer_load_dwordx4 v[210:213], v233, s[24:27], s40 offen offset:1024
    v_mfma_f32_16x16x32_bf16 a[144:147], v[112:115], v[144:147], a[144:147]
    ds_read_b64_tr_b16 v[90:91], v12 offset:3072
    v_mfma_f32_16x16x32_bf16 a[148:151], v[116:119], v[144:147], a[148:151]
    buffer_load_dwordx4 v[214:217], v233, s[24:27], s41 offen offset:0
    v_mfma_f32_16x16x32_bf16 a[152:155], v[120:123], v[144:147], a[152:155]
    ds_read_b128 v[52:55], v8 offset:43008
    v_mfma_f32_16x16x32_bf16 a[156:159], v[124:127], v[144:147], a[156:159]
    buffer_load_dwordx4 v[218:221], v233, s[24:27], s41 offen offset:1024
    v_mfma_f32_16x16x32_bf16 a[160:163], v[96:99], v[148:151], a[160:163]
    ds_read_b64_tr_b16 v[92:93], v13 offset:2048
    v_mfma_f32_16x16x32_bf16 a[164:167], v[100:103], v[148:151], a[164:167]
    buffer_load_dwordx4 v[222:225], v233, s[16:19], 0 offen offset:0
    v_mfma_f32_16x16x32_bf16 a[168:171], v[104:107], v[148:151], a[168:171]
    ds_read_b64_tr_b16 v[94:95], v13 offset:3072
    v_mfma_f32_16x16x32_bf16 a[172:175], v[108:111], v[148:151], a[172:175]
    buffer_load_dwordx4 v[226:229], v233, s[16:19], 0 offen offset:1024
    v_mfma_f32_16x16x32_bf16 a[176:179], v[112:115], v[148:151], a[176:179]
    ds_read_b128 v[56:59], v8 offset:45056
    v_mfma_f32_16x16x32_bf16 a[180:183], v[116:119], v[148:151], a[180:183]
    buffer_load_dwordx4 v[198:201], v232, s[76:79], 0 offen offset:0
    v_mfma_f32_16x16x32_bf16 a[184:187], v[120:123], v[148:151], a[184:187]
    ds_read_b128 v[60:63], v8 offset:47104
    v_mfma_f32_16x16x32_bf16 a[188:191], v[124:127], v[148:151], a[188:191]
    buffer_load_dwordx4 v[202:205], v232, s[76:79], 0 offen offset:16
    v_mfma_f32_16x16x32_bf16 a[192:195], v[96:99], v[152:155], a[192:195]
    buffer_store_dword v241, v241, s[28:31], s55 offen sc1
    v_mfma_f32_16x16x32_bf16 a[196:199], v[100:103], v[152:155], a[196:199]
    buffer_store_dword v241, v241, s[28:31], s56 offen sc1
    v_mfma_f32_16x16x32_bf16 a[200:203], v[104:107], v[152:155], a[200:203]
    buffer_store_dword v241, v241, s[28:31], s57 offen sc1
    v_mfma_f32_16x16x32_bf16 a[204:207], v[108:111], v[152:155], a[204:207]
    buffer_store_dword v241, v241, s[28:31], s3 offen sc1
    v_mfma_f32_16x16x32_bf16 a[208:211], v[112:115], v[152:155], a[208:211]
    v_mfma_f32_16x16x32_bf16 a[212:215], v[116:119], v[152:155], a[212:215]
    v_mfma_f32_16x16x32_bf16 a[216:219], v[120:123], v[152:155], a[216:219]
    v_mfma_f32_16x16x32_bf16 a[220:223], v[124:127], v[152:155], a[220:223]
    v_mfma_f32_16x16x32_bf16 a[224:227], v[96:99], v[156:159], a[224:227]
    v_mfma_f32_16x16x32_bf16 a[228:231], v[100:103], v[156:159], a[228:231]
    v_mfma_f32_16x16x32_bf16 a[232:235], v[104:107], v[156:159], a[232:235]
    v_mfma_f32_16x16x32_bf16 a[236:239], v[108:111], v[156:159], a[236:239]
    v_mfma_f32_16x16x32_bf16 a[240:243], v[112:115], v[156:159], a[240:243]
    v_mfma_f32_16x16x32_bf16 a[244:247], v[116:119], v[156:159], a[244:247]
    v_mfma_f32_16x16x32_bf16 a[248:251], v[120:123], v[156:159], a[248:251]
    v_mfma_f32_16x16x32_bf16 a[252:255], v[124:127], v[156:159], a[252:255]
    s_waitcnt vmcnt(28) lgkmcnt(0)
    s_barrier
    v_mfma_f32_16x16x32_bf16 a[0:3], v[64:67], v[32:35], a[0:3]
    ds_read_b64_tr_b16 v[128:129], v10 offset:16384
    v_mfma_f32_16x16x32_bf16 a[4:7], v[64:67], v[36:39], a[4:7]
    s_add_u32 s36, s35, 768
    s_and_b32 s36, s36, 1023
    s_add_u32 s36, s36, s59
    v_mfma_f32_16x16x32_bf16 a[8:11], v[64:67], v[40:43], a[8:11]
    s_add_u32 m0, s42, 4096
    ds_read_b64_tr_b16 v[130:131], v10 offset:17408
    v_mfma_f32_16x16x32_bf16 a[12:15], v[64:67], v[44:47], a[12:15]
    buffer_load_dwordx4 v2, s[4:7], s36 offen offset:0 lds
    v_mfma_f32_16x16x32_bf16 a[16:19], v[64:67], v[48:51], a[16:19]
    ds_read_b64_tr_b16 v[132:133], v11 offset:16384
    v_mfma_f32_16x16x32_bf16 a[20:23], v[64:67], v[52:55], a[20:23]
    v_mfma_f32_16x16x32_bf16 a[24:27], v[64:67], v[56:59], a[24:27]
    ds_read_b64_tr_b16 v[134:135], v11 offset:17408
    v_mfma_f32_16x16x32_bf16 a[28:31], v[64:67], v[60:63], a[28:31]
    buffer_load_dwordx4 v3, s[4:7], s36 offen offset:1024 lds
    v_mfma_f32_16x16x32_bf16 a[32:35], v[68:71], v[32:35], a[32:35]
    ds_read_b128 v[96:99], v9 offset:32768
    v_mfma_f32_16x16x32_bf16 a[36:39], v[68:71], v[36:39], a[36:39]
    v_mfma_f32_16x16x32_bf16 a[40:43], v[68:71], v[40:43], a[40:43]
    ds_read_b64_tr_b16 v[136:137], v12 offset:16384
    v_mfma_f32_16x16x32_bf16 a[44:47], v[68:71], v[44:47], a[44:47]
    buffer_load_dwordx4 v4, s[4:7], s36 offen offset:2048 lds
    v_mfma_f32_16x16x32_bf16 a[48:51], v[68:71], v[48:51], a[48:51]
    ds_read_b64_tr_b16 v[138:139], v12 offset:17408
    v_mfma_f32_16x16x32_bf16 a[52:55], v[68:71], v[52:55], a[52:55]
    v_mfma_f32_16x16x32_bf16 a[56:59], v[68:71], v[56:59], a[56:59]
    ds_read_b128 v[100:103], v9 offset:34816
    v_mfma_f32_16x16x32_bf16 a[60:63], v[68:71], v[60:63], a[60:63]
    buffer_load_dwordx4 v5, s[4:7], s36 offen offset:3072 lds
    v_mfma_f32_16x16x32_bf16 a[64:67], v[72:75], v[32:35], a[64:67]
    ds_read_b64_tr_b16 v[140:141], v13 offset:16384
    v_mfma_f32_16x16x32_bf16 a[68:71], v[72:75], v[36:39], a[68:71]
    s_add_u32 s37, s58, 3145728
    s_and_b32 s37, s37, 4194303
    s_add_u32 s37, s37, s39
    v_mfma_f32_16x16x32_bf16 a[72:75], v[72:75], v[40:43], a[72:75]
    s_add_u32 m0, s43, 0
    ds_read_b64_tr_b16 v[142:143], v13 offset:17408
    v_mfma_f32_16x16x32_bf16 a[76:79], v[72:75], v[44:47], a[76:79]
    buffer_load_dwordx4 v6, s[8:11], s37 offen offset:0 lds
    v_mfma_f32_16x16x32_bf16 a[80:83], v[72:75], v[48:51], a[80:83]
    ds_read_b128 v[104:107], v9 offset:36864
    v_mfma_f32_16x16x32_bf16 a[84:87], v[72:75], v[52:55], a[84:87]
    v_mfma_f32_16x16x32_bf16 a[88:91], v[72:75], v[56:59], a[88:91]
    ds_read_b64_tr_b16 v[144:145], v10 offset:18432
    v_mfma_f32_16x16x32_bf16 a[92:95], v[72:75], v[60:63], a[92:95]
    buffer_load_dwordx4 v7, s[8:11], s37 offen offset:1024 lds
    v_mfma_f32_16x16x32_bf16 a[96:99], v[76:79], v[32:35], a[96:99]
    ds_read_b64_tr_b16 v[146:147], v10 offset:19456
    v_mfma_f32_16x16x32_bf16 a[100:103], v[76:79], v[36:39], a[100:103]
    v_mfma_f32_16x16x32_bf16 a[104:107], v[76:79], v[40:43], a[104:107]
    s_add_u32 m0, s43, 2048
    ds_read_b128 v[108:111], v9 offset:38912
    v_mfma_f32_16x16x32_bf16 a[108:111], v[76:79], v[44:47], a[108:111]
    buffer_load_dwordx4 v6, s[12:15], s37 offen offset:0 lds
    v_mfma_f32_16x16x32_bf16 a[112:115], v[76:79], v[48:51], a[112:115]
    ds_read_b64_tr_b16 v[148:149], v11 offset:18432
    v_mfma_f32_16x16x32_bf16 a[116:119], v[76:79], v[52:55], a[116:119]
    v_mfma_f32_16x16x32_bf16 a[120:123], v[76:79], v[56:59], a[120:123]
    ds_read_b64_tr_b16 v[150:151], v11 offset:19456
    v_mfma_f32_16x16x32_bf16 a[124:127], v[76:79], v[60:63], a[124:127]
    buffer_load_dwordx4 v7, s[12:15], s37 offen offset:1024 lds
    v_mfma_f32_16x16x32_bf16 a[128:131], v[32:35], v[80:83], a[128:131]
    ds_read_b128 v[112:115], v9 offset:40960
    v_mfma_f32_16x16x32_bf16 a[132:135], v[36:39], v[80:83], a[132:135]
    v_mfma_f32_16x16x32_bf16 a[136:139], v[40:43], v[80:83], a[136:139]
    ds_read_b64_tr_b16 v[152:153], v12 offset:18432
    v_mfma_f32_16x16x32_bf16 a[140:143], v[44:47], v[80:83], a[140:143]
    v_mfma_f32_16x16x32_bf16 a[144:147], v[48:51], v[80:83], a[144:147]
    ds_read_b64_tr_b16 v[154:155], v12 offset:19456
    v_mfma_f32_16x16x32_bf16 a[148:151], v[52:55], v[80:83], a[148:151]
gated_mix__ssm_conv_h3__compressed_kv_cla__prompt_kernel_pad1:
    s_cbranch_execz gated_mix__ssm_conv_h3__compressed_kv_cla__prompt_kernel_pad9
    v_mfma_f32_16x16x32_bf16 a[152:155], v[56:59], v[80:83], a[152:155]
    ds_read_b128 v[116:119], v9 offset:43008
    v_mfma_f32_16x16x32_bf16 a[156:159], v[60:63], v[80:83], a[156:159]
    v_mfma_f32_16x16x32_bf16 a[160:163], v[32:35], v[84:87], a[160:163]
    ds_read_b64_tr_b16 v[156:157], v13 offset:18432
    v_mfma_f32_16x16x32_bf16 a[164:167], v[36:39], v[84:87], a[164:167]
    v_mfma_f32_16x16x32_bf16 a[168:171], v[40:43], v[84:87], a[168:171]
    ds_read_b64_tr_b16 v[158:159], v13 offset:19456
    v_mfma_f32_16x16x32_bf16 a[172:175], v[44:47], v[84:87], a[172:175]
    v_mfma_f32_16x16x32_bf16 a[176:179], v[48:51], v[84:87], a[176:179]
    ds_read_b128 v[120:123], v9 offset:45056
    v_mfma_f32_16x16x32_bf16 a[180:183], v[52:55], v[84:87], a[180:183]
    v_mfma_f32_16x16x32_bf16 a[184:187], v[56:59], v[84:87], a[184:187]
    ds_read_b128 v[124:127], v9 offset:47104
    v_mfma_f32_16x16x32_bf16 a[188:191], v[60:63], v[84:87], a[188:191]
    v_mfma_f32_16x16x32_bf16 a[192:195], v[32:35], v[88:91], a[192:195]
    v_mfma_f32_16x16x32_bf16 a[196:199], v[36:39], v[88:91], a[196:199]
    v_mfma_f32_16x16x32_bf16 a[200:203], v[40:43], v[88:91], a[200:203]
    v_mfma_f32_16x16x32_bf16 a[204:207], v[44:47], v[88:91], a[204:207]
    v_mfma_f32_16x16x32_bf16 a[208:211], v[48:51], v[88:91], a[208:211]
    v_mfma_f32_16x16x32_bf16 a[212:215], v[52:55], v[88:91], a[212:215]
    v_mfma_f32_16x16x32_bf16 a[216:219], v[56:59], v[88:91], a[216:219]
    v_mfma_f32_16x16x32_bf16 a[220:223], v[60:63], v[88:91], a[220:223]
    v_mfma_f32_16x16x32_bf16 a[224:227], v[32:35], v[92:95], a[224:227]
    v_mfma_f32_16x16x32_bf16 a[228:231], v[36:39], v[92:95], a[228:231]
    v_mfma_f32_16x16x32_bf16 a[232:235], v[40:43], v[92:95], a[232:235]
    v_mfma_f32_16x16x32_bf16 a[236:239], v[44:47], v[92:95], a[236:239]
    v_mfma_f32_16x16x32_bf16 a[240:243], v[48:51], v[92:95], a[240:243]
    v_mfma_f32_16x16x32_bf16 a[244:247], v[52:55], v[92:95], a[244:247]
    v_mfma_f32_16x16x32_bf16 a[248:251], v[56:59], v[92:95], a[248:251]
    v_mfma_f32_16x16x32_bf16 a[252:255], v[60:63], v[92:95], a[252:255]
    s_waitcnt vmcnt(28) lgkmcnt(0)
    s_barrier
    v_mfma_f32_16x16x32_bf16 a[0:3], v[128:131], v[96:99], a[0:3]
    s_mov_b32 s76, s92
    ds_read_b64_tr_b16 v[64:65], v10 offset:32768
    v_mfma_f32_16x16x32_bf16 a[4:7], v[128:131], v[100:103], a[4:7]
    s_add_u32 s36, s35, 896
    s_and_b32 s36, s36, 1023
    s_add_u32 s36, s36, s38
    v_mfma_f32_16x16x32_bf16 a[8:11], v[128:131], v[104:107], a[8:11]
    s_add_u32 m0, s42, 32768
    ds_read_b64_tr_b16 v[66:67], v10 offset:33792
    v_mfma_f32_16x16x32_bf16 a[12:15], v[128:131], v[108:111], a[12:15]
    buffer_load_dwordx4 v2, s[4:7], s36 offen offset:0 lds
    v_mfma_f32_16x16x32_bf16 a[16:19], v[128:131], v[112:115], a[16:19]
    s_mov_b32 s77, s93
    ds_read_b64_tr_b16 v[68:69], v11 offset:32768
    v_mfma_f32_16x16x32_bf16 a[20:23], v[128:131], v[116:119], a[20:23]
    s_mov_b32 s78, 256
    v_mfma_f32_16x16x32_bf16 a[24:27], v[128:131], v[120:123], a[24:27]
    s_mov_b32 s79, 0x00020000
    ds_read_b64_tr_b16 v[70:71], v11 offset:33792
    v_mfma_f32_16x16x32_bf16 a[28:31], v[128:131], v[124:127], a[28:31]
    buffer_load_dwordx4 v3, s[4:7], s36 offen offset:1024 lds
    v_mfma_f32_16x16x32_bf16 a[32:35], v[132:135], v[96:99], a[32:35]
    s_getreg_b32 s88, hwreg(HW_REG_XCC_ID, 0, 3)
    ds_read_b128 v[32:35], v14 offset:0
    v_mfma_f32_16x16x32_bf16 a[36:39], v[132:135], v[100:103], a[36:39]
    s_lshl_b32 s88, s88, 2
    v_mfma_f32_16x16x32_bf16 a[40:43], v[132:135], v[104:107], a[40:43]
    s_lshl_b32 s88, 1, s88
    ds_read_b64_tr_b16 v[72:73], v12 offset:32768
    v_mfma_f32_16x16x32_bf16 a[44:47], v[132:135], v[108:111], a[44:47]
    buffer_load_dwordx4 v4, s[4:7], s36 offen offset:2048 lds
    v_mfma_f32_16x16x32_bf16 a[48:51], v[132:135], v[112:115], a[48:51]
    ds_read_b64_tr_b16 v[74:75], v12 offset:33792
    v_or_b32 v242, s32, v16
    v_mfma_f32_16x16x32_bf16 a[52:55], v[132:135], v[116:119], a[52:55]
    v_mov_b32 v243, 0x80000000
    v_cmp_eq_u32 vcc, 0, v242
    v_mfma_f32_16x16x32_bf16 a[56:59], v[132:135], v[120:123], a[56:59]
    ds_read_b128 v[36:39], v14 offset:2048
    v_mov_b32 v241, s88
    v_mfma_f32_16x16x32_bf16 a[60:63], v[132:135], v[124:127], a[60:63]
    buffer_load_dwordx4 v5, s[4:7], s36 offen offset:3072 lds
    v_mfma_f32_16x16x32_bf16 a[64:67], v[136:139], v[96:99], a[64:67]
    s_lshl_b32 s88, s33, 3
    ds_read_b64_tr_b16 v[76:77], v13 offset:32768
    v_mfma_f32_16x16x32_bf16 a[68:71], v[136:139], v[100:103], a[68:71]
    s_add_u32 s37, s58, 3407872
    s_and_b32 s37, s37, 4194303
    s_add_u32 s37, s37, s39
    v_mfma_f32_16x16x32_bf16 a[72:75], v[136:139], v[104:107], a[72:75]
    s_add_u32 m0, s43, 16384
    ds_read_b64_tr_b16 v[78:79], v13 offset:33792
    v_cndmask_b32 v242, v243, v242, vcc
    v_mfma_f32_16x16x32_bf16 a[76:79], v[136:139], v[108:111], a[76:79]
    buffer_load_dwordx4 v6, s[8:11], s37 offen offset:0 lds
    v_mfma_f32_16x16x32_bf16 a[80:83], v[136:139], v[112:115], a[80:83]
    ds_read_b128 v[40:43], v14 offset:4096
    v_mfma_f32_16x16x32_bf16 a[84:87], v[136:139], v[116:119], a[84:87]
    v_mfma_f32_16x16x32_bf16 a[88:91], v[136:139], v[120:123], a[88:91]
    ds_read_b64_tr_b16 v[80:81], v10 offset:34816
    v_mfma_f32_16x16x32_bf16 a[92:95], v[136:139], v[124:127], a[92:95]
    buffer_load_dwordx4 v7, s[8:11], s37 offen offset:1024 lds
    v_mfma_f32_16x16x32_bf16 a[96:99], v[140:143], v[96:99], a[96:99]
    ds_read_b64_tr_b16 v[82:83], v10 offset:35840
    v_mfma_f32_16x16x32_bf16 a[100:103], v[140:143], v[100:103], a[100:103]
    v_mfma_f32_16x16x32_bf16 a[104:107], v[140:143], v[104:107], a[104:107]
    s_add_u32 m0, s43, 18432
    ds_read_b128 v[44:47], v14 offset:6144
    v_mfma_f32_16x16x32_bf16 a[108:111], v[140:143], v[108:111], a[108:111]
    buffer_load_dwordx4 v6, s[12:15], s37 offen offset:0 lds
    v_mfma_f32_16x16x32_bf16 a[112:115], v[140:143], v[112:115], a[112:115]
    ds_read_b64_tr_b16 v[84:85], v11 offset:34816
    v_mfma_f32_16x16x32_bf16 a[116:119], v[140:143], v[116:119], a[116:119]
    v_mfma_f32_16x16x32_bf16 a[120:123], v[140:143], v[120:123], a[120:123]
    ds_read_b64_tr_b16 v[86:87], v11 offset:35840
    v_mfma_f32_16x16x32_bf16 a[124:127], v[140:143], v[124:127], a[124:127]
    buffer_load_dwordx4 v7, s[12:15], s37 offen offset:1024 lds
    v_mfma_f32_16x16x32_bf16 a[128:131], v[96:99], v[144:147], a[128:131]
    ds_read_b128 v[48:51], v14 offset:8192
    v_mfma_f32_16x16x32_bf16 a[132:135], v[100:103], v[144:147], a[132:135]
    v_mfma_f32_16x16x32_bf16 a[136:139], v[104:107], v[144:147], a[136:139]
    ds_read_b64_tr_b16 v[88:89], v12 offset:34816
    v_mfma_f32_16x16x32_bf16 a[140:143], v[108:111], v[144:147], a[140:143]
    v_mfma_f32_16x16x32_bf16 a[144:147], v[112:115], v[144:147], a[144:147]
    ds_read_b64_tr_b16 v[90:91], v12 offset:35840
    v_mfma_f32_16x16x32_bf16 a[148:151], v[116:119], v[144:147], a[148:151]
    v_mfma_f32_16x16x32_bf16 a[152:155], v[120:123], v[144:147], a[152:155]
    ds_read_b128 v[52:55], v14 offset:10240
    v_mfma_f32_16x16x32_bf16 a[156:159], v[124:127], v[144:147], a[156:159]
    v_mfma_f32_16x16x32_bf16 a[160:163], v[96:99], v[148:151], a[160:163]
    ds_read_b64_tr_b16 v[92:93], v13 offset:34816
    v_mfma_f32_16x16x32_bf16 a[164:167], v[100:103], v[148:151], a[164:167]
    v_mfma_f32_16x16x32_bf16 a[168:171], v[104:107], v[148:151], a[168:171]
    ds_read_b64_tr_b16 v[94:95], v13 offset:35840
    v_mfma_f32_16x16x32_bf16 a[172:175], v[108:111], v[148:151], a[172:175]
    v_mfma_f32_16x16x32_bf16 a[176:179], v[112:115], v[148:151], a[176:179]
    ds_read_b128 v[56:59], v14 offset:12288
    v_mfma_f32_16x16x32_bf16 a[180:183], v[116:119], v[148:151], a[180:183]
    v_mfma_f32_16x16x32_bf16 a[184:187], v[120:123], v[148:151], a[184:187]
    ds_read_b128 v[60:63], v14 offset:14336
    v_mfma_f32_16x16x32_bf16 a[188:191], v[124:127], v[148:151], a[188:191]
    v_mfma_f32_16x16x32_bf16 a[192:195], v[96:99], v[152:155], a[192:195]
    v_mfma_f32_16x16x32_bf16 a[196:199], v[100:103], v[152:155], a[196:199]
    v_mfma_f32_16x16x32_bf16 a[200:203], v[104:107], v[152:155], a[200:203]
    v_mfma_f32_16x16x32_bf16 a[204:207], v[108:111], v[152:155], a[204:207]
    v_mfma_f32_16x16x32_bf16 a[208:211], v[112:115], v[152:155], a[208:211]
    v_mfma_f32_16x16x32_bf16 a[212:215], v[116:119], v[152:155], a[212:215]
    v_mfma_f32_16x16x32_bf16 a[216:219], v[120:123], v[152:155], a[216:219]
    v_mfma_f32_16x16x32_bf16 a[220:223], v[124:127], v[152:155], a[220:223]
    v_mfma_f32_16x16x32_bf16 a[224:227], v[96:99], v[156:159], a[224:227]
    v_mfma_f32_16x16x32_bf16 a[228:231], v[100:103], v[156:159], a[228:231]
    v_mfma_f32_16x16x32_bf16 a[232:235], v[104:107], v[156:159], a[232:235]
    v_mfma_f32_16x16x32_bf16 a[236:239], v[108:111], v[156:159], a[236:239]
    v_mfma_f32_16x16x32_bf16 a[240:243], v[112:115], v[156:159], a[240:243]
    v_mfma_f32_16x16x32_bf16 a[244:247], v[116:119], v[156:159], a[244:247]
    v_mfma_f32_16x16x32_bf16 a[248:251], v[120:123], v[156:159], a[248:251]
    v_mfma_f32_16x16x32_bf16 a[252:255], v[124:127], v[156:159], a[252:255]
    s_waitcnt vmcnt(16) lgkmcnt(0)
    s_barrier
    v_mfma_f32_16x16x32_bf16 a[0:3], v[64:67], v[32:35], a[0:3]
    ds_read_b64_tr_b16 v[128:129], v10 offset:49152
    v_lshlrev_b32 v240, 16, v222
    v_mfma_f32_16x16x32_bf16 a[4:7], v[64:67], v[36:39], a[4:7]
    s_add_u32 s36, s35, 896
    s_and_b32 s36, s36, 1023
    s_add_u32 s36, s36, s59
    v_lshlrev_b32 v238, 16, v206
    v_lshlrev_b32 v239, 16, v214
    v_mfma_f32_16x16x32_bf16 a[8:11], v[64:67], v[40:43], a[8:11]
    s_add_u32 m0, s42, 36864
    ds_read_b64_tr_b16 v[130:131], v10 offset:50176
    v_mul_f32 v236, v238, v240
    v_mfma_f32_16x16x32_bf16 a[12:15], v[64:67], v[44:47], a[12:15]
    buffer_load_dwordx4 v2, s[4:7], s36 offen offset:0 lds
    v_mfma_f32_16x16x32_bf16 a[16:19], v[64:67], v[48:51], a[16:19]
    ds_read_b64_tr_b16 v[132:133], v11 offset:49152
    v_mul_f32 v237, v239, v240
    v_mfma_f32_16x16x32_bf16 a[20:23], v[64:67], v[52:55], a[20:23]
    v_and_b32 v240, s52, v222
    v_and_b32 v238, s52, v206
    v_mfma_f32_16x16x32_bf16 a[24:27], v[64:67], v[56:59], a[24:27]
    ds_read_b64_tr_b16 v[134:135], v11 offset:50176
    v_and_b32 v239, s52, v214
    v_mfma_f32_16x16x32_bf16 a[28:31], v[64:67], v[60:63], a[28:31]
    buffer_load_dwordx4 v3, s[4:7], s36 offen offset:1024 lds
    v_mfma_f32_16x16x32_bf16 a[32:35], v[68:71], v[32:35], a[32:35]
    ds_read_b128 v[96:99], v15 offset:0
    v_fmac_f32 v236, v238, v240
    v_mfma_f32_16x16x32_bf16 a[36:39], v[68:71], v[36:39], a[36:39]
    v_fmac_f32 v237, v239, v240
    v_lshlrev_b32 v240, 16, v223
    v_mfma_f32_16x16x32_bf16 a[40:43], v[68:71], v[40:43], a[40:43]
    ds_read_b64_tr_b16 v[136:137], v12 offset:49152
    v_lshlrev_b32 v238, 16, v207
    v_mfma_f32_16x16x32_bf16 a[44:47], v[68:71], v[44:47], a[44:47]
    buffer_load_dwordx4 v4, s[4:7], s36 offen offset:2048 lds
    v_mfma_f32_16x16x32_bf16 a[48:51], v[68:71], v[48:51], a[48:51]
    ds_read_b64_tr_b16 v[138:139], v12 offset:50176
    v_lshlrev_b32 v239, 16, v215
    v_mfma_f32_16x16x32_bf16 a[52:55], v[68:71], v[52:55], a[52:55]
    v_fmac_f32 v236, v238, v240
    v_fmac_f32 v237, v239, v240
    v_mfma_f32_16x16x32_bf16 a[56:59], v[68:71], v[56:59], a[56:59]
    ds_read_b128 v[100:103], v15 offset:2048
    v_and_b32 v240, s52, v223
    v_mfma_f32_16x16x32_bf16 a[60:63], v[68:71], v[60:63], a[60:63]
    buffer_load_dwordx4 v5, s[4:7], s36 offen offset:3072 lds
    v_mfma_f32_16x16x32_bf16 a[64:67], v[72:75], v[32:35], a[64:67]
    ds_read_b64_tr_b16 v[140:141], v13 offset:49152
    v_and_b32 v238, s52, v207
    v_mfma_f32_16x16x32_bf16 a[68:71], v[72:75], v[36:39], a[68:71]
    s_add_u32 s37, s58, 3670016
    s_and_b32 s37, s37, 4194303
    s_add_u32 s37, s37, s39
    v_and_b32 v239, s52, v215
    v_fmac_f32 v236, v238, v240
    v_mfma_f32_16x16x32_bf16 a[72:75], v[72:75], v[40:43], a[72:75]
    s_add_u32 m0, s43, 32768
    ds_read_b64_tr_b16 v[142:143], v13 offset:50176
    v_fmac_f32 v237, v239, v240
    v_mfma_f32_16x16x32_bf16 a[76:79], v[72:75], v[44:47], a[76:79]
    buffer_load_dwordx4 v6, s[8:11], s37 offen offset:0 lds
    v_mfma_f32_16x16x32_bf16 a[80:83], v[72:75], v[48:51], a[80:83]
    ds_read_b128 v[104:107], v15 offset:4096
    v_lshlrev_b32 v240, 16, v224
    v_mfma_f32_16x16x32_bf16 a[84:87], v[72:75], v[52:55], a[84:87]
    v_lshlrev_b32 v238, 16, v208
    v_lshlrev_b32 v239, 16, v216
    v_mfma_f32_16x16x32_bf16 a[88:91], v[72:75], v[56:59], a[88:91]
    ds_read_b64_tr_b16 v[144:145], v10 offset:51200
    v_fmac_f32 v236, v238, v240
    v_mfma_f32_16x16x32_bf16 a[92:95], v[72:75], v[60:63], a[92:95]
    buffer_load_dwordx4 v7, s[8:11], s37 offen offset:1024 lds
    v_mfma_f32_16x16x32_bf16 a[96:99], v[76:79], v[32:35], a[96:99]
    ds_read_b64_tr_b16 v[146:147], v10 offset:52224
    v_fmac_f32 v237, v239, v240
    v_mfma_f32_16x16x32_bf16 a[100:103], v[76:79], v[36:39], a[100:103]
    v_and_b32 v240, s52, v224
    v_and_b32 v238, s52, v208
    v_mfma_f32_16x16x32_bf16 a[104:107], v[76:79], v[40:43], a[104:107]
    s_add_u32 m0, s43, 34816
    ds_read_b128 v[108:111], v15 offset:6144
    v_and_b32 v239, s52, v216
    v_mfma_f32_16x16x32_bf16 a[108:111], v[76:79], v[44:47], a[108:111]
    buffer_load_dwordx4 v6, s[12:15], s37 offen offset:0 lds
    v_mfma_f32_16x16x32_bf16 a[112:115], v[76:79], v[48:51], a[112:115]
    ds_read_b64_tr_b16 v[148:149], v11 offset:51200
    v_fmac_f32 v236, v238, v240
    v_mfma_f32_16x16x32_bf16 a[116:119], v[76:79], v[52:55], a[116:119]
    v_fmac_f32 v237, v239, v240
    v_lshlrev_b32 v240, 16, v225
    v_mfma_f32_16x16x32_bf16 a[120:123], v[76:79], v[56:59], a[120:123]
    ds_read_b64_tr_b16 v[150:151], v11 offset:52224
    v_lshlrev_b32 v238, 16, v209
    v_mfma_f32_16x16x32_bf16 a[124:127], v[76:79], v[60:63], a[124:127]
    buffer_load_dwordx4 v7, s[12:15], s37 offen offset:1024 lds
    v_mfma_f32_16x16x32_bf16 a[128:131], v[32:35], v[80:83], a[128:131]
    ds_read_b128 v[112:115], v15 offset:8192
    v_lshlrev_b32 v239, 16, v217
    v_mfma_f32_16x16x32_bf16 a[132:135], v[36:39], v[80:83], a[132:135]
    buffer_load_dword v31, v254, s[20:23], s46 offen
    v_mfma_f32_16x16x32_bf16 a[136:139], v[40:43], v[80:83], a[136:139]
    s_add_u32 s46, s46, 4194304
    ds_read_b64_tr_b16 v[152:153], v12 offset:51200
    v_fmac_f32 v236, v238, v240
    v_mfma_f32_16x16x32_bf16 a[140:143], v[44:47], v[80:83], a[140:143]
    buffer_load_dword v31, v254, s[20:23], s46 offen
    v_mfma_f32_16x16x32_bf16 a[144:147], v[48:51], v[80:83], a[144:147]
    ds_read_b64_tr_b16 v[154:155], v12 offset:52224
    v_fmac_f32 v237, v239, v240
    v_mfma_f32_16x16x32_bf16 a[148:151], v[52:55], v[80:83], a[148:151]
    v_and_b32 v240, s52, v225
    v_and_b32 v238, s52, v209
    v_mfma_f32_16x16x32_bf16 a[152:155], v[56:59], v[80:83], a[152:155]
    ds_read_b128 v[116:119], v15 offset:10240
    v_and_b32 v239, s52, v217
    v_mfma_f32_16x16x32_bf16 a[156:159], v[60:63], v[80:83], a[156:159]
    buffer_atomic_add v241, v242, s[76:79], s88 offen sc1
    v_mfma_f32_16x16x32_bf16 a[160:163], v[32:35], v[84:87], a[160:163]
    ds_read_b64_tr_b16 v[156:157], v13 offset:51200
    v_fmac_f32 v236, v238, v240
    v_mfma_f32_16x16x32_bf16 a[164:167], v[36:39], v[84:87], a[164:167]
    v_fmac_f32 v237, v239, v240
    v_lshlrev_b32 v240, 16, v226
    v_mfma_f32_16x16x32_bf16 a[168:171], v[40:43], v[84:87], a[168:171]
    ds_read_b64_tr_b16 v[158:159], v13 offset:52224
    v_lshlrev_b32 v238, 16, v210
    v_mfma_f32_16x16x32_bf16 a[172:175], v[44:47], v[84:87], a[172:175]
    v_mfma_f32_16x16x32_bf16 a[176:179], v[48:51], v[84:87], a[176:179]
    ds_read_b128 v[120:123], v15 offset:12288
    v_lshlrev_b32 v239, 16, v218
    v_mfma_f32_16x16x32_bf16 a[180:183], v[52:55], v[84:87], a[180:183]
    v_fmac_f32 v236, v238, v240
    v_fmac_f32 v237, v239, v240
    v_mfma_f32_16x16x32_bf16 a[184:187], v[56:59], v[84:87], a[184:187]
    ds_read_b128 v[124:127], v15 offset:14336
    v_and_b32 v240, s52, v226
    v_mfma_f32_16x16x32_bf16 a[188:191], v[60:63], v[84:87], a[188:191]
    v_mfma_f32_16x16x32_bf16 a[192:195], v[32:35], v[88:91], a[192:195]
    v_and_b32 v238, s52, v210
    v_and_b32 v239, s52, v218
    v_mfma_f32_16x16x32_bf16 a[196:199], v[36:39], v[88:91], a[196:199]
    v_fmac_f32 v236, v238, v240
    v_fmac_f32 v237, v239, v240
    v_mfma_f32_16x16x32_bf16 a[200:203], v[40:43], v[88:91], a[200:203]
    v_lshlrev_b32 v240, 16, v227
    v_lshlrev_b32 v238, 16, v211
    v_mfma_f32_16x16x32_bf16 a[204:207], v[44:47], v[88:91], a[204:207]
    v_mfma_f32_16x16x32_bf16 a[208:211], v[48:51], v[88:91], a[208:211]
    v_lshlrev_b32 v239, 16, v219
    v_fmac_f32 v236, v238, v240
    v_mfma_f32_16x16x32_bf16 a[212:215], v[52:55], v[88:91], a[212:215]
    v_fmac_f32 v237, v239, v240
    v_and_b32 v240, s52, v227
    v_mfma_f32_16x16x32_bf16 a[216:219], v[56:59], v[88:91], a[216:219]
    v_and_b32 v238, s52, v211
    v_and_b32 v239, s52, v219
    v_mfma_f32_16x16x32_bf16 a[220:223], v[60:63], v[88:91], a[220:223]
    v_mfma_f32_16x16x32_bf16 a[224:227], v[32:35], v[92:95], a[224:227]
    v_fmac_f32 v236, v238, v240
    v_fmac_f32 v237, v239, v240
    v_mfma_f32_16x16x32_bf16 a[228:231], v[36:39], v[92:95], a[228:231]
    v_lshlrev_b32 v240, 16, v228
    v_lshlrev_b32 v238, 16, v212
    v_mfma_f32_16x16x32_bf16 a[232:235], v[40:43], v[92:95], a[232:235]
    v_lshlrev_b32 v239, 16, v220
    v_fmac_f32 v236, v238, v240
    v_mfma_f32_16x16x32_bf16 a[236:239], v[44:47], v[92:95], a[236:239]
    v_mfma_f32_16x16x32_bf16 a[240:243], v[48:51], v[92:95], a[240:243]
    v_fmac_f32 v237, v239, v240
    v_and_b32 v240, s52, v228
    v_mfma_f32_16x16x32_bf16 a[244:247], v[52:55], v[92:95], a[244:247]
    v_and_b32 v238, s52, v212
    v_and_b32 v239, s52, v220
    v_mfma_f32_16x16x32_bf16 a[248:251], v[56:59], v[92:95], a[248:251]
    v_fmac_f32 v236, v238, v240
    v_fmac_f32 v237, v239, v240
    v_mfma_f32_16x16x32_bf16 a[252:255], v[60:63], v[92:95], a[252:255]
    s_waitcnt vmcnt(19) lgkmcnt(0)
    s_barrier
    v_lshlrev_b32 v240, 16, v229
    v_lshlrev_b32 v238, 16, v213
    v_mfma_f32_16x16x32_bf16 a[0:3], v[128:131], v[96:99], a[0:3]
    ds_read_b64_tr_b16 v[64:65], v10 offset:0
    v_lshlrev_b32 v239, 16, v221
    v_mfma_f32_16x16x32_bf16 a[4:7], v[128:131], v[100:103], a[4:7]
    s_add_u32 s36, s44, 0
    v_fmac_f32 v236, v238, v240
    v_fmac_f32 v237, v239, v240
    v_mfma_f32_16x16x32_bf16 a[8:11], v[128:131], v[104:107], a[8:11]
    s_add_u32 m0, s42, 65536
    ds_read_b64_tr_b16 v[66:67], v10 offset:1024
    v_and_b32 v240, s52, v229
    v_mfma_f32_16x16x32_bf16 a[12:15], v[128:131], v[108:111], a[12:15]
    buffer_load_dwordx4 v17, s[24:27], s36 offen offset:0 lds
    v_mfma_f32_16x16x32_bf16 a[16:19], v[128:131], v[112:115], a[16:19]
    ds_read_b64_tr_b16 v[68:69], v11 offset:0
    v_and_b32 v238, s52, v213
    v_mfma_f32_16x16x32_bf16 a[20:23], v[128:131], v[116:119], a[20:23]
    v_and_b32 v239, s52, v221
    v_fmac_f32 v236, v238, v240
    v_mfma_f32_16x16x32_bf16 a[24:27], v[128:131], v[120:123], a[24:27]
    ds_read_b64_tr_b16 v[70:71], v11 offset:1024
    v_fmac_f32 v237, v239, v240
    v_mfma_f32_16x16x32_bf16 a[28:31], v[128:131], v[124:127], a[28:31]
    buffer_load_dwordx4 v18, s[24:27], s36 offen offset:1024 lds
    v_mfma_f32_16x16x32_bf16 a[32:35], v[132:135], v[96:99], a[32:35]
    ds_read_b128 v[32:35], v8 offset:0
    v_add_f32_dpp v236, v236, v236 quad_perm:[1,0,3,2] row_mask:0xf bank_mask:0xf
    v_mfma_f32_16x16x32_bf16 a[36:39], v[132:135], v[100:103], a[36:39]
    v_add_f32_dpp v237, v237, v237 quad_perm:[1,0,3,2] row_mask:0xf bank_mask:0xf
    v_mfma_f32_16x16x32_bf16 a[40:43], v[132:135], v[104:107], a[40:43]
    ds_read_b64_tr_b16 v[72:73], v12 offset:0
    v_mfma_f32_16x16x32_bf16 a[44:47], v[132:135], v[108:111], a[44:47]
    buffer_load_dwordx4 v19, s[24:27], s36 offen offset:2048 lds
    v_mfma_f32_16x16x32_bf16 a[48:51], v[132:135], v[112:115], a[48:51]
    ds_read_b64_tr_b16 v[74:75], v12 offset:1024
    v_add_f32_dpp v236, v236, v236 quad_perm:[2,3,0,1] row_mask:0xf bank_mask:0xf
    v_mfma_f32_16x16x32_bf16 a[52:55], v[132:135], v[116:119], a[52:55]
    v_add_f32_dpp v237, v237, v237 quad_perm:[2,3,0,1] row_mask:0xf bank_mask:0xf
    v_mfma_f32_16x16x32_bf16 a[56:59], v[132:135], v[120:123], a[56:59]
    ds_read_b128 v[36:39], v8 offset:2048
    v_mfma_f32_16x16x32_bf16 a[60:63], v[132:135], v[124:127], a[60:63]
    buffer_load_dwordx4 v20, s[24:27], s36 offen offset:3072 lds
    v_mfma_f32_16x16x32_bf16 a[64:67], v[136:139], v[96:99], a[64:67]
    ds_read_b64_tr_b16 v[76:77], v13 offset:0
    v_add_f32_dpp v236, v236, v236 row_half_mirror row_mask:0xf bank_mask:0xf
    v_mfma_f32_16x16x32_bf16 a[68:71], v[136:139], v[100:103], a[68:71]
    s_add_u32 s37, s58, 3932160
    s_and_b32 s37, s37, 4194303
    s_add_u32 s37, s37, s39
    v_add_f32_dpp v237, v237, v237 row_half_mirror row_mask:0xf bank_mask:0xf
    v_mfma_f32_16x16x32_bf16 a[72:75], v[136:139], v[104:107], a[72:75]
    s_add_u32 m0, s43, 49152
    ds_read_b64_tr_b16 v[78:79], v13 offset:1024
    v_mfma_f32_16x16x32_bf16 a[76:79], v[136:139], v[108:111], a[76:79]
    buffer_load_dwordx4 v6, s[8:11], s37 offen offset:0 lds
    v_mfma_f32_16x16x32_bf16 a[80:83], v[136:139], v[112:115], a[80:83]
    ds_read_b128 v[40:43], v8 offset:4096
    v_add_f32_dpp v236, v236, v236 row_mirror row_mask:0xf bank_mask:0xf
    v_mfma_f32_16x16x32_bf16 a[84:87], v[136:139], v[116:119], a[84:87]
    v_add_f32_dpp v237, v237, v237 row_mirror row_mask:0xf bank_mask:0xf
    v_mov_b32 v238, v236
    v_mfma_f32_16x16x32_bf16 a[88:91], v[136:139], v[120:123], a[88:91]
    ds_read_b64_tr_b16 v[80:81], v10 offset:2048
    v_mov_b32 v239, v237
    v_mfma_f32_16x16x32_bf16 a[92:95], v[136:139], v[124:127], a[92:95]
    buffer_load_dwordx4 v7, s[8:11], s37 offen offset:1024 lds
    v_mfma_f32_16x16x32_bf16 a[96:99], v[140:143], v[96:99], a[96:99]
    ds_read_b64_tr_b16 v[82:83], v10 offset:3072
    v_permlane16_swap_b32 v236, v238
    v_mfma_f32_16x16x32_bf16 a[100:103], v[140:143], v[100:103], a[100:103]
    v_permlane16_swap_b32 v237, v239
    v_mfma_f32_16x16x32_bf16 a[104:107], v[140:143], v[104:107], a[104:107]
    s_add_u32 m0, s43, 51200
    ds_read_b128 v[44:47], v8 offset:6144
    v_add_f32 v236, v236, v238
    v_mfma_f32_16x16x32_bf16 a[108:111], v[140:143], v[108:111], a[108:111]
    buffer_load_dwordx4 v6, s[12:15], s37 offen offset:0 lds
    v_mfma_f32_16x16x32_bf16 a[112:115], v[140:143], v[112:115], a[112:115]
    ds_read_b64_tr_b16 v[84:85], v11 offset:2048
    v_add_f32 v237, v237, v239
    v_mfma_f32_16x16x32_bf16 a[116:119], v[140:143], v[116:119], a[116:119]
    v_mov_b32 v238, v236
    v_mov_b32 v239, v237
    v_mfma_f32_16x16x32_bf16 a[120:123], v[140:143], v[120:123], a[120:123]
    ds_read_b64_tr_b16 v[86:87], v11 offset:3072
    v_mfma_f32_16x16x32_bf16 a[124:127], v[140:143], v[124:127], a[124:127]
    buffer_load_dwordx4 v7, s[12:15], s37 offen offset:1024 lds
    v_mfma_f32_16x16x32_bf16 a[128:131], v[96:99], v[144:147], a[128:131]
    ds_read_b128 v[48:51], v8 offset:8192
    v_permlane32_swap_b32 v236, v238
    v_mfma_f32_16x16x32_bf16 a[132:135], v[100:103], v[144:147], a[132:135]
    v_permlane32_swap_b32 v237, v239
    v_mfma_f32_16x16x32_bf16 a[136:139], v[104:107], v[144:147], a[136:139]
    ds_read_b64_tr_b16 v[88:89], v12 offset:2048
    v_add_f32 v236, v236, v238
    v_mfma_f32_16x16x32_bf16 a[140:143], v[108:111], v[144:147], a[140:143]
    v_mfma_f32_16x16x32_bf16 a[144:147], v[112:115], v[144:147], a[144:147]
    ds_read_b64_tr_b16 v[90:91], v12 offset:3072
    v_add_f32 v237, v237, v239
    v_mfma_f32_16x16x32_bf16 a[148:151], v[116:119], v[144:147], a[148:151]
    v_mul_f32 v236, 0xbfb8aa3b, v236
    v_mul_f32 v237, 0xbfb8aa3b, v237
    v_mfma_f32_16x16x32_bf16 a[152:155], v[120:123], v[144:147], a[152:155]
    ds_read_b128 v[52:55], v8 offset:10240
    v_exp_f32 v236, v236
    v_mfma_f32_16x16x32_bf16 a[156:159], v[124:127], v[144:147], a[156:159]
    v_mfma_f32_16x16x32_bf16 a[160:163], v[96:99], v[148:151], a[160:163]
    ds_read_b64_tr_b16 v[92:93], v13 offset:2048
    v_exp_f32 v237, v237
    v_mfma_f32_16x16x32_bf16 a[164:167], v[100:103], v[148:151], a[164:167]
    v_mov_b32 v238, 0
    v_add_f32 v236, 1.0, v236
    v_mfma_f32_16x16x32_bf16 a[168:171], v[104:107], v[148:151], a[168:171]
    ds_read_b64_tr_b16 v[94:95], v13 offset:3072
    v_add_f32 v237, 1.0, v237
    v_mfma_f32_16x16x32_bf16 a[172:175], v[108:111], v[148:151], a[172:175]
    v_mfma_f32_16x16x32_bf16 a[176:179], v[112:115], v[148:151], a[176:179]
    ds_read_b128 v[56:59], v8 offset:12288
    v_rcp_f32 v236, v236
    v_mfma_f32_16x16x32_bf16 a[180:183], v[116:119], v[148:151], a[180:183]
    v_rcp_f32 v237, v237
    v_mfma_f32_16x16x32_bf16 a[184:187], v[120:123], v[148:151], a[184:187]
    s_add_u32 s16, s94, 59768832
    s_addc_u32 s17, s95, 0
    ds_read_b128 v[60:63], v8 offset:14336
    v_mfma_f32_16x16x32_bf16 a[188:191], v[124:127], v[148:151], a[188:191]
    v_mfma_f32_16x16x32_bf16 a[192:195], v[96:99], v[152:155], a[192:195]
    s_mov_b32 s18, 8192
    v_mfma_f32_16x16x32_bf16 a[196:199], v[100:103], v[152:155], a[196:199]
    s_lshr_b32 s40, s40, 9
    v_mfma_f32_16x16x32_bf16 a[200:203], v[104:107], v[152:155], a[200:203]
    s_lshr_b32 s41, s41, 9
    v_mfma_f32_16x16x32_bf16 a[204:207], v[108:111], v[152:155], a[204:207]
    buffer_store_dword v236, v238, s[16:19], s40 offen sc1
    v_mfma_f32_16x16x32_bf16 a[208:211], v[112:115], v[152:155], a[208:211]
    v_mfma_f32_16x16x32_bf16 a[212:215], v[116:119], v[152:155], a[212:215]
    v_mfma_f32_16x16x32_bf16 a[216:219], v[120:123], v[152:155], a[216:219]
    v_mfma_f32_16x16x32_bf16 a[220:223], v[124:127], v[152:155], a[220:223]
    buffer_store_dword v237, v238, s[16:19], s41 offen sc1
    v_mfma_f32_16x16x32_bf16 a[224:227], v[96:99], v[156:159], a[224:227]
    s_add_u32 s16, s94, 50331648
    s_addc_u32 s17, s95, 0
    v_mfma_f32_16x16x32_bf16 a[228:231], v[100:103], v[156:159], a[228:231]
    s_mov_b32 s18, 4718592
    v_mfma_f32_16x16x32_bf16 a[232:235], v[104:107], v[156:159], a[232:235]
    v_mfma_f32_16x16x32_bf16 a[236:239], v[108:111], v[156:159], a[236:239]
    v_mfma_f32_16x16x32_bf16 a[240:243], v[112:115], v[156:159], a[240:243]
    v_mfma_f32_16x16x32_bf16 a[244:247], v[116:119], v[156:159], a[244:247]
    v_mfma_f32_16x16x32_bf16 a[248:251], v[120:123], v[156:159], a[248:251]
    v_mfma_f32_16x16x32_bf16 a[252:255], v[124:127], v[156:159], a[252:255]
    s_waitcnt vmcnt(21) lgkmcnt(0)
    s_barrier
    v_mfma_f32_16x16x32_bf16 a[0:3], v[64:67], v[32:35], a[0:3]
    ds_read_b64_tr_b16 v[128:129], v10 offset:16384
    v_lshlrev_b32 v206, 16, v160
    v_mfma_f32_16x16x32_bf16 a[4:7], v[64:67], v[36:39], a[4:7]
    s_add_u32 s36, s45, 0
    v_lshlrev_b32 v207, 16, v162
    v_lshlrev_b32 v208, 16, v164
    v_mfma_f32_16x16x32_bf16 a[8:11], v[64:67], v[40:43], a[8:11]
    s_add_u32 m0, s42, 69632
    ds_read_b64_tr_b16 v[130:131], v10 offset:17408
    v_lshlrev_b32 v209, 16, v166
    v_mfma_f32_16x16x32_bf16 a[12:15], v[64:67], v[44:47], a[12:15]
    buffer_load_dwordx4 v17, s[24:27], s36 offen offset:0 lds
    v_mfma_f32_16x16x32_bf16 a[16:19], v[64:67], v[48:51], a[16:19]
    ds_read_b64_tr_b16 v[132:133], v11 offset:16384
    v_lshlrev_b32 v210, 16, v168
    v_mfma_f32_16x16x32_bf16 a[20:23], v[64:67], v[52:55], a[20:23]
    v_lshlrev_b32 v211, 16, v170
    v_lshlrev_b32 v212, 16, v172
    v_mfma_f32_16x16x32_bf16 a[24:27], v[64:67], v[56:59], a[24:27]
    ds_read_b64_tr_b16 v[134:135], v11 offset:17408
    v_lshlrev_b32 v213, 16, v174
    v_mfma_f32_16x16x32_bf16 a[28:31], v[64:67], v[60:63], a[28:31]
    buffer_load_dwordx4 v18, s[24:27], s36 offen offset:1024 lds
    v_mfma_f32_16x16x32_bf16 a[32:35], v[68:71], v[32:35], a[32:35]
    ds_read_b128 v[96:99], v9 offset:0
    v_lshlrev_b32 v214, 16, v176
    v_mfma_f32_16x16x32_bf16 a[36:39], v[68:71], v[36:39], a[36:39]
    v_lshlrev_b32 v215, 16, v178
    v_lshlrev_b32 v216, 16, v180
    v_mfma_f32_16x16x32_bf16 a[40:43], v[68:71], v[40:43], a[40:43]
    ds_read_b64_tr_b16 v[136:137], v12 offset:16384
    v_lshlrev_b32 v217, 16, v198
    v_mfma_f32_16x16x32_bf16 a[44:47], v[68:71], v[44:47], a[44:47]
    buffer_load_dwordx4 v19, s[24:27], s36 offen offset:2048 lds
    v_mfma_f32_16x16x32_bf16 a[48:51], v[68:71], v[48:51], a[48:51]
    ds_read_b64_tr_b16 v[138:139], v12 offset:17408
    v_and_b32 v218, s52, v198
    v_mfma_f32_16x16x32_bf16 a[52:55], v[68:71], v[52:55], a[52:55]
    v_lshlrev_b32 v219, 16, v199
    v_and_b32 v220, s52, v199
    v_mfma_f32_16x16x32_bf16 a[56:59], v[68:71], v[56:59], a[56:59]
    ds_read_b128 v[100:103], v9 offset:2048
    v_mul_f32 v221, v209, v217
    v_mfma_f32_16x16x32_bf16 a[60:63], v[68:71], v[60:63], a[60:63]
    buffer_load_dwordx4 v20, s[24:27], s36 offen offset:3072 lds
    v_mfma_f32_16x16x32_bf16 a[64:67], v[72:75], v[32:35], a[64:67]
    ds_read_b64_tr_b16 v[140:141], v13 offset:16384
    v_mul_f32 v222, v210, v217
    v_mfma_f32_16x16x32_bf16 a[68:71], v[72:75], v[36:39], a[68:71]
    s_add_u32 s37, s49, 0
    v_mul_f32 v223, v211, v217
    v_mul_f32 v224, v212, v217
    v_mfma_f32_16x16x32_bf16 a[72:75], v[72:75], v[40:43], a[72:75]
    s_add_u32 m0, s50, 0
    ds_read_b64_tr_b16 v[142:143], v13 offset:17408
    v_mul_f32 v225, v213, v217
    v_mfma_f32_16x16x32_bf16 a[76:79], v[72:75], v[44:47], a[76:79]
    buffer_load_dwordx4 v21, s[20:23], s37 offen offset:0 lds
    v_mfma_f32_16x16x32_bf16 a[80:83], v[72:75], v[48:51], a[80:83]
    ds_read_b128 v[104:107], v9 offset:4096
    v_mul_f32 v226, v214, v217
    v_mfma_f32_16x16x32_bf16 a[84:87], v[72:75], v[52:55], a[84:87]
    v_mul_f32 v227, v215, v217
    v_mul_f32 v228, v216, v217
    v_mfma_f32_16x16x32_bf16 a[88:91], v[72:75], v[56:59], a[88:91]
    ds_read_b64_tr_b16 v[144:145], v10 offset:18432
    v_fmac_f32 v221, v208, v218
    v_mfma_f32_16x16x32_bf16 a[92:95], v[72:75], v[60:63], a[92:95]
    buffer_load_dwordx4 v22, s[20:23], s37 offen offset:1024 lds
    v_mfma_f32_16x16x32_bf16 a[96:99], v[76:79], v[32:35], a[96:99]
    ds_read_b64_tr_b16 v[146:147], v10 offset:19456
    v_fmac_f32 v222, v209, v218
    v_mfma_f32_16x16x32_bf16 a[100:103], v[76:79], v[36:39], a[100:103]
    v_fmac_f32 v223, v210, v218
    v_fmac_f32 v224, v211, v218
    v_mfma_f32_16x16x32_bf16 a[104:107], v[76:79], v[40:43], a[104:107]
    ds_read_b128 v[108:111], v9 offset:6144
    v_fmac_f32 v225, v212, v218
    v_mfma_f32_16x16x32_bf16 a[108:111], v[76:79], v[44:47], a[108:111]
    v_mfma_f32_16x16x32_bf16 a[112:115], v[76:79], v[48:51], a[112:115]
    ds_read_b64_tr_b16 v[148:149], v11 offset:18432
    v_fmac_f32 v226, v213, v218
    v_mfma_f32_16x16x32_bf16 a[116:119], v[76:79], v[52:55], a[116:119]
    v_fmac_f32 v227, v214, v218
    v_fmac_f32 v228, v215, v218
    v_mfma_f32_16x16x32_bf16 a[120:123], v[76:79], v[56:59], a[120:123]
    ds_read_b64_tr_b16 v[150:151], v11 offset:19456
    v_fmac_f32 v221, v207, v219
    v_mfma_f32_16x16x32_bf16 a[124:127], v[76:79], v[60:63], a[124:127]
    v_mfma_f32_16x16x32_bf16 a[128:131], v[32:35], v[80:83], a[128:131]
    ds_read_b128 v[112:115], v9 offset:8192
    v_fmac_f32 v222, v208, v219
    v_mfma_f32_16x16x32_bf16 a[132:135], v[36:39], v[80:83], a[132:135]
    v_fmac_f32 v223, v209, v219
    v_fmac_f32 v224, v210, v219
    v_mfma_f32_16x16x32_bf16 a[136:139], v[40:43], v[80:83], a[136:139]
    ds_read_b64_tr_b16 v[152:153], v12 offset:18432
    v_fmac_f32 v225, v211, v219
    v_mfma_f32_16x16x32_bf16 a[140:143], v[44:47], v[80:83], a[140:143]
    v_mfma_f32_16x16x32_bf16 a[144:147], v[48:51], v[80:83], a[144:147]
    ds_read_b64_tr_b16 v[154:155], v12 offset:19456
    v_fmac_f32 v226, v212, v219
    v_mfma_f32_16x16x32_bf16 a[148:151], v[52:55], v[80:83], a[148:151]
    v_fmac_f32 v227, v213, v219
    v_fmac_f32 v228, v214, v219
    v_mfma_f32_16x16x32_bf16 a[152:155], v[56:59], v[80:83], a[152:155]
gated_mix__ssm_conv_h3__compressed_kv_cla__prompt_kernel_pad2:
    s_cbranch_execz gated_mix__ssm_conv_h3__compressed_kv_cla__prompt_kernel_pad10
    ds_read_b128 v[116:119], v9 offset:10240
    v_fmac_f32 v221, v206, v220
    v_mfma_f32_16x16x32_bf16 a[156:159], v[60:63], v[80:83], a[156:159]
    v_mfma_f32_16x16x32_bf16 a[160:163], v[32:35], v[84:87], a[160:163]
    ds_read_b64_tr_b16 v[156:157], v13 offset:18432
    v_fmac_f32 v222, v207, v220
    v_mfma_f32_16x16x32_bf16 a[164:167], v[36:39], v[84:87], a[164:167]
    v_fmac_f32 v223, v208, v220
    v_fmac_f32 v224, v209, v220
    v_mfma_f32_16x16x32_bf16 a[168:171], v[40:43], v[84:87], a[168:171]
    ds_read_b64_tr_b16 v[158:159], v13 offset:19456
    v_fmac_f32 v225, v210, v220
    v_mfma_f32_16x16x32_bf16 a[172:175], v[44:47], v[84:87], a[172:175]
    v_mfma_f32_16x16x32_bf16 a[176:179], v[48:51], v[84:87], a[176:179]
    ds_read_b128 v[120:123], v9 offset:12288
    v_fmac_f32 v226, v211, v220
    v_mfma_f32_16x16x32_bf16 a[180:183], v[52:55], v[84:87], a[180:183]
    v_fmac_f32 v227, v212, v220
    v_fmac_f32 v228, v213, v220
    v_mfma_f32_16x16x32_bf16 a[184:187], v[56:59], v[84:87], a[184:187]
    ds_read_b128 v[124:127], v9 offset:14336
    v_lshlrev_b32 v206, 16, v182
    v_mfma_f32_16x16x32_bf16 a[188:191], v[60:63], v[84:87], a[188:191]
    v_mfma_f32_16x16x32_bf16 a[192:195], v[32:35], v[88:91], a[192:195]
    v_lshlrev_b32 v207, 16, v184
    v_lshlrev_b32 v208, 16, v186
    v_mfma_f32_16x16x32_bf16 a[196:199], v[36:39], v[88:91], a[196:199]
    v_lshlrev_b32 v209, 16, v188
    v_lshlrev_b32 v210, 16, v190
    v_mfma_f32_16x16x32_bf16 a[200:203], v[40:43], v[88:91], a[200:203]
    v_lshlrev_b32 v211, 16, v192
    v_lshlrev_b32 v212, 16, v194
    v_mfma_f32_16x16x32_bf16 a[204:207], v[44:47], v[88:91], a[204:207]
    v_mfma_f32_16x16x32_bf16 a[208:211], v[48:51], v[88:91], a[208:211]
    v_lshlrev_b32 v213, 16, v196
    v_mul_f32 v221, v221, v206
    v_mfma_f32_16x16x32_bf16 a[212:215], v[52:55], v[88:91], a[212:215]
    v_mul_f32 v222, v222, v207
    v_mul_f32 v223, v223, v208
    v_mfma_f32_16x16x32_bf16 a[216:219], v[56:59], v[88:91], a[216:219]
    v_mul_f32 v224, v224, v209
    v_mul_f32 v225, v225, v210
    v_mfma_f32_16x16x32_bf16 a[220:223], v[60:63], v[88:91], a[220:223]
    v_mfma_f32_16x16x32_bf16 a[224:227], v[32:35], v[92:95], a[224:227]
    v_mul_f32 v226, v226, v211
    v_mul_f32 v227, v227, v212
    v_mfma_f32_16x16x32_bf16 a[228:231], v[36:39], v[92:95], a[228:231]
    v_mul_f32 v228, v228, v213
    v_cvt_pk_bf16_f32 v244, v228, v227
    v_mfma_f32_16x16x32_bf16 a[232:235], v[40:43], v[92:95], a[232:235]
    v_cvt_pk_bf16_f32 v245, v226, v225
    v_cvt_pk_bf16_f32 v246, v224, v223
    v_mfma_f32_16x16x32_bf16 a[236:239], v[44:47], v[92:95], a[236:239]
    v_mfma_f32_16x16x32_bf16 a[240:243], v[48:51], v[92:95], a[240:243]
    v_cvt_pk_bf16_f32 v247, v222, v221
    v_and_b32 v206, s52, v160
    v_mfma_f32_16x16x32_bf16 a[244:247], v[52:55], v[92:95], a[244:247]
    v_and_b32 v207, s52, v162
    v_and_b32 v208, s52, v164
    v_mfma_f32_16x16x32_bf16 a[248:251], v[56:59], v[92:95], a[248:251]
    v_and_b32 v209, s52, v166
    v_and_b32 v210, s52, v168
    v_mfma_f32_16x16x32_bf16 a[252:255], v[60:63], v[92:95], a[252:255]
    s_waitcnt vmcnt(19) lgkmcnt(0)
    s_barrier
    v_and_b32 v211, s52, v170
    v_and_b32 v212, s52, v172
    v_mfma_f32_16x16x32_bf16 a[0:3], v[128:131], v[96:99], a[0:3]
    ds_read_b64_tr_b16 v[64:65], v10 offset:32768
    v_and_b32 v213, s52, v174
    v_mfma_f32_16x16x32_bf16 a[4:7], v[128:131], v[100:103], a[4:7]
    s_add_u32 s36, s44, 128
    v_and_b32 v214, s52, v176
    v_and_b32 v215, s52, v178
    v_mfma_f32_16x16x32_bf16 a[8:11], v[128:131], v[104:107], a[8:11]
    s_add_u32 m0, s42, 0
    ds_read_b64_tr_b16 v[66:67], v10 offset:33792
    v_and_b32 v216, s52, v180
    v_mfma_f32_16x16x32_bf16 a[12:15], v[128:131], v[108:111], a[12:15]
    buffer_load_dwordx4 v17, s[24:27], s36 offen offset:0 lds
    v_mfma_f32_16x16x32_bf16 a[16:19], v[128:131], v[112:115], a[16:19]
    ds_read_b64_tr_b16 v[68:69], v11 offset:32768
    v_lshlrev_b32 v217, 16, v200
    v_mfma_f32_16x16x32_bf16 a[20:23], v[128:131], v[116:119], a[20:23]
    v_and_b32 v218, s52, v200
    v_lshlrev_b32 v219, 16, v201
    v_mfma_f32_16x16x32_bf16 a[24:27], v[128:131], v[120:123], a[24:27]
    ds_read_b64_tr_b16 v[70:71], v11 offset:33792
    v_and_b32 v220, s52, v201
    v_mfma_f32_16x16x32_bf16 a[28:31], v[128:131], v[124:127], a[28:31]
    buffer_load_dwordx4 v18, s[24:27], s36 offen offset:1024 lds
    v_mfma_f32_16x16x32_bf16 a[32:35], v[132:135], v[96:99], a[32:35]
    ds_read_b128 v[32:35], v8 offset:32768
    v_mul_f32 v221, v209, v217
    v_mfma_f32_16x16x32_bf16 a[36:39], v[132:135], v[100:103], a[36:39]
    v_mul_f32 v222, v210, v217
    v_mul_f32 v223, v211, v217
    v_mfma_f32_16x16x32_bf16 a[40:43], v[132:135], v[104:107], a[40:43]
    ds_read_b64_tr_b16 v[72:73], v12 offset:32768
    v_mul_f32 v224, v212, v217
    v_mfma_f32_16x16x32_bf16 a[44:47], v[132:135], v[108:111], a[44:47]
    buffer_load_dwordx4 v19, s[24:27], s36 offen offset:2048 lds
    v_mfma_f32_16x16x32_bf16 a[48:51], v[132:135], v[112:115], a[48:51]
    ds_read_b64_tr_b16 v[74:75], v12 offset:33792
    v_mul_f32 v225, v213, v217
    v_mfma_f32_16x16x32_bf16 a[52:55], v[132:135], v[116:119], a[52:55]
    v_mul_f32 v226, v214, v217
    v_mul_f32 v227, v215, v217
    v_mfma_f32_16x16x32_bf16 a[56:59], v[132:135], v[120:123], a[56:59]
    ds_read_b128 v[36:39], v8 offset:34816
    v_mul_f32 v228, v216, v217
    v_mfma_f32_16x16x32_bf16 a[60:63], v[132:135], v[124:127], a[60:63]
    buffer_load_dwordx4 v20, s[24:27], s36 offen offset:3072 lds
    v_mfma_f32_16x16x32_bf16 a[64:67], v[136:139], v[96:99], a[64:67]
    ds_read_b64_tr_b16 v[76:77], v13 offset:32768
    v_fmac_f32 v221, v208, v218
    v_mfma_f32_16x16x32_bf16 a[68:71], v[136:139], v[100:103], a[68:71]
    s_add_u32 s37, s49, 262144
    v_fmac_f32 v222, v209, v218
    v_fmac_f32 v223, v210, v218
    v_mfma_f32_16x16x32_bf16 a[72:75], v[136:139], v[104:107], a[72:75]
    s_add_u32 m0, s50, 8704
    ds_read_b64_tr_b16 v[78:79], v13 offset:33792
    v_fmac_f32 v224, v211, v218
    v_mfma_f32_16x16x32_bf16 a[76:79], v[136:139], v[108:111], a[76:79]
    buffer_load_dwordx4 v21, s[20:23], s37 offen offset:0 lds
    v_mfma_f32_16x16x32_bf16 a[80:83], v[136:139], v[112:115], a[80:83]
    ds_read_b128 v[40:43], v8 offset:36864
    v_fmac_f32 v225, v212, v218
    v_mfma_f32_16x16x32_bf16 a[84:87], v[136:139], v[116:119], a[84:87]
    v_fmac_f32 v226, v213, v218
    v_fmac_f32 v227, v214, v218
    v_mfma_f32_16x16x32_bf16 a[88:91], v[136:139], v[120:123], a[88:91]
    ds_read_b64_tr_b16 v[80:81], v10 offset:34816
    v_fmac_f32 v228, v215, v218
    v_mfma_f32_16x16x32_bf16 a[92:95], v[136:139], v[124:127], a[92:95]
    buffer_load_dwordx4 v22, s[20:23], s37 offen offset:1024 lds
    v_mfma_f32_16x16x32_bf16 a[96:99], v[140:143], v[96:99], a[96:99]
    ds_read_b64_tr_b16 v[82:83], v10 offset:35840
    v_fmac_f32 v221, v207, v219
    v_mfma_f32_16x16x32_bf16 a[100:103], v[140:143], v[100:103], a[100:103]
    s_add_u32 s37, s49, 524288
    v_fmac_f32 v222, v208, v219
    v_fmac_f32 v223, v209, v219
    v_mfma_f32_16x16x32_bf16 a[104:107], v[140:143], v[104:107], a[104:107]
    s_add_u32 m0, s50, 17408
    ds_read_b128 v[44:47], v8 offset:38912
    v_fmac_f32 v224, v210, v219
    v_mfma_f32_16x16x32_bf16 a[108:111], v[140:143], v[108:111], a[108:111]
    buffer_load_dwordx4 v21, s[20:23], s37 offen offset:0 lds
    v_mfma_f32_16x16x32_bf16 a[112:115], v[140:143], v[112:115], a[112:115]
    ds_read_b64_tr_b16 v[84:85], v11 offset:34816
    v_fmac_f32 v225, v211, v219
    v_mfma_f32_16x16x32_bf16 a[116:119], v[140:143], v[116:119], a[116:119]
    v_fmac_f32 v226, v212, v219
    v_fmac_f32 v227, v213, v219
    v_mfma_f32_16x16x32_bf16 a[120:123], v[140:143], v[120:123], a[120:123]
    ds_read_b64_tr_b16 v[86:87], v11 offset:35840
    v_fmac_f32 v228, v214, v219
    v_mfma_f32_16x16x32_bf16 a[124:127], v[140:143], v[124:127], a[124:127]
    buffer_load_dwordx4 v22, s[20:23], s37 offen offset:1024 lds
    v_mfma_f32_16x16x32_bf16 a[128:131], v[96:99], v[144:147], a[128:131]
    ds_read_b128 v[48:51], v8 offset:40960
    v_fmac_f32 v221, v206, v220
    v_mfma_f32_16x16x32_bf16 a[132:135], v[100:103], v[144:147], a[132:135]
    v_fmac_f32 v222, v207, v220
    v_fmac_f32 v223, v208, v220
    v_mfma_f32_16x16x32_bf16 a[136:139], v[104:107], v[144:147], a[136:139]
    ds_read_b64_tr_b16 v[88:89], v12 offset:34816
    v_fmac_f32 v224, v209, v220
    v_mfma_f32_16x16x32_bf16 a[140:143], v[108:111], v[144:147], a[140:143]
    buffer_store_dwordx4 v[244:247], v234, s[16:19], 0 offen sc1
    v_mfma_f32_16x16x32_bf16 a[144:147], v[112:115], v[144:147], a[144:147]
    s_movk_i32 s54, 4608
    ds_read_b64_tr_b16 v[90:91], v12 offset:35840
    v_fmac_f32 v225, v210, v220
    v_mfma_f32_16x16x32_bf16 a[148:151], v[116:119], v[144:147], a[148:151]
    v_fmac_f32 v226, v211, v220
    v_fmac_f32 v227, v212, v220
    v_mfma_f32_16x16x32_bf16 a[152:155], v[120:123], v[144:147], a[152:155]
    ds_read_b128 v[52:55], v8 offset:43008
    v_fmac_f32 v228, v213, v220
    v_mfma_f32_16x16x32_bf16 a[156:159], v[124:127], v[144:147], a[156:159]
    v_mfma_f32_16x16x32_bf16 a[160:163], v[96:99], v[148:151], a[160:163]
    ds_read_b64_tr_b16 v[92:93], v13 offset:34816
    v_and_b32 v206, s52, v182
    v_mfma_f32_16x16x32_bf16 a[164:167], v[100:103], v[148:151], a[164:167]
    v_and_b32 v207, s52, v184
    v_and_b32 v208, s52, v186
    v_mfma_f32_16x16x32_bf16 a[168:171], v[104:107], v[148:151], a[168:171]
    ds_read_b64_tr_b16 v[94:95], v13 offset:35840
    v_and_b32 v209, s52, v188
    v_mfma_f32_16x16x32_bf16 a[172:175], v[108:111], v[148:151], a[172:175]
    v_mfma_f32_16x16x32_bf16 a[176:179], v[112:115], v[148:151], a[176:179]
    ds_read_b128 v[56:59], v8 offset:45056
    v_and_b32 v210, s52, v190
    v_mfma_f32_16x16x32_bf16 a[180:183], v[116:119], v[148:151], a[180:183]
    v_and_b32 v211, s52, v192
    v_and_b32 v212, s52, v194
    v_mfma_f32_16x16x32_bf16 a[184:187], v[120:123], v[148:151], a[184:187]
    ds_read_b128 v[60:63], v8 offset:47104
    v_and_b32 v213, s52, v196
    v_mfma_f32_16x16x32_bf16 a[188:191], v[124:127], v[148:151], a[188:191]
    v_mfma_f32_16x16x32_bf16 a[192:195], v[96:99], v[152:155], a[192:195]
    v_mul_f32 v221, v221, v206
    v_mul_f32 v222, v222, v207
    v_mfma_f32_16x16x32_bf16 a[196:199], v[100:103], v[152:155], a[196:199]
    v_mul_f32 v223, v223, v208
    v_mul_f32 v224, v224, v209
    v_mfma_f32_16x16x32_bf16 a[200:203], v[104:107], v[152:155], a[200:203]
    v_mul_f32 v225, v225, v210
    v_mul_f32 v226, v226, v211
    v_mfma_f32_16x16x32_bf16 a[204:207], v[108:111], v[152:155], a[204:207]
    v_mfma_f32_16x16x32_bf16 a[208:211], v[112:115], v[152:155], a[208:211]
    v_mul_f32 v227, v227, v212
    v_mul_f32 v228, v228, v213
    v_mfma_f32_16x16x32_bf16 a[212:215], v[116:119], v[152:155], a[212:215]
    v_cvt_pk_bf16_f32 v248, v228, v227
    v_cvt_pk_bf16_f32 v249, v226, v225
    v_mfma_f32_16x16x32_bf16 a[216:219], v[120:123], v[152:155], a[216:219]
    v_cvt_pk_bf16_f32 v250, v224, v223
    v_cvt_pk_bf16_f32 v251, v222, v221
    v_mfma_f32_16x16x32_bf16 a[220:223], v[124:127], v[152:155], a[220:223]
    buffer_store_dwordx4 v[248:251], v234, s[16:19], s54 offen sc1
    v_mfma_f32_16x16x32_bf16 a[224:227], v[96:99], v[156:159], a[224:227]
    s_movk_i32 s54, 9216
    v_lshlrev_b32 v206, 16, v161
    v_lshlrev_b32 v207, 16, v163
    v_mfma_f32_16x16x32_bf16 a[228:231], v[100:103], v[156:159], a[228:231]
    v_lshlrev_b32 v208, 16, v165
    v_lshlrev_b32 v209, 16, v167
    v_mfma_f32_16x16x32_bf16 a[232:235], v[104:107], v[156:159], a[232:235]
    v_lshlrev_b32 v210, 16, v169
    v_lshlrev_b32 v211, 16, v171
    v_mfma_f32_16x16x32_bf16 a[236:239], v[108:111], v[156:159], a[236:239]
    v_mfma_f32_16x16x32_bf16 a[240:243], v[112:115], v[156:159], a[240:243]
    v_lshlrev_b32 v212, 16, v173
    v_lshlrev_b32 v213, 16, v175
    v_mfma_f32_16x16x32_bf16 a[244:247], v[116:119], v[156:159], a[244:247]
    v_lshlrev_b32 v214, 16, v177
    v_lshlrev_b32 v215, 16, v179
    v_mfma_f32_16x16x32_bf16 a[248:251], v[120:123], v[156:159], a[248:251]
    v_lshlrev_b32 v216, 16, v181
    v_lshlrev_b32 v217, 16, v202
    v_mfma_f32_16x16x32_bf16 a[252:255], v[124:127], v[156:159], a[252:255]
    s_waitcnt vmcnt(18) lgkmcnt(0)
    s_barrier
    v_and_b32 v218, s52, v202
    v_lshlrev_b32 v219, 16, v203
    v_mfma_f32_16x16x32_bf16 a[0:3], v[64:67], v[32:35], a[0:3]
    ds_read_b64_tr_b16 v[128:129], v10 offset:49152
    v_and_b32 v220, s52, v203
    v_mfma_f32_16x16x32_bf16 a[4:7], v[64:67], v[36:39], a[4:7]
    s_add_u32 s36, s45, 128
    v_mul_f32 v221, v209, v217
    v_mul_f32 v222, v210, v217
    v_mfma_f32_16x16x32_bf16 a[8:11], v[64:67], v[40:43], a[8:11]
    s_add_u32 m0, s42, 4096
    ds_read_b64_tr_b16 v[130:131], v10 offset:50176
    v_mul_f32 v223, v211, v217
    v_mfma_f32_16x16x32_bf16 a[12:15], v[64:67], v[44:47], a[12:15]
    buffer_load_dwordx4 v17, s[24:27], s36 offen offset:0 lds
    v_mfma_f32_16x16x32_bf16 a[16:19], v[64:67], v[48:51], a[16:19]
    ds_read_b64_tr_b16 v[132:133], v11 offset:49152
    v_mul_f32 v224, v212, v217
    v_mfma_f32_16x16x32_bf16 a[20:23], v[64:67], v[52:55], a[20:23]
    v_mul_f32 v225, v213, v217
    v_mul_f32 v226, v214, v217
    v_mfma_f32_16x16x32_bf16 a[24:27], v[64:67], v[56:59], a[24:27]
    ds_read_b64_tr_b16 v[134:135], v11 offset:50176
    v_mul_f32 v227, v215, v217
    v_mfma_f32_16x16x32_bf16 a[28:31], v[64:67], v[60:63], a[28:31]
    buffer_load_dwordx4 v18, s[24:27], s36 offen offset:1024 lds
    v_mfma_f32_16x16x32_bf16 a[32:35], v[68:71], v[32:35], a[32:35]
    ds_read_b128 v[96:99], v9 offset:32768
    v_mul_f32 v228, v216, v217
    v_mfma_f32_16x16x32_bf16 a[36:39], v[68:71], v[36:39], a[36:39]
    v_fmac_f32 v221, v208, v218
    v_fmac_f32 v222, v209, v218
    v_mfma_f32_16x16x32_bf16 a[40:43], v[68:71], v[40:43], a[40:43]
    ds_read_b64_tr_b16 v[136:137], v12 offset:49152
    v_fmac_f32 v223, v210, v218
    v_mfma_f32_16x16x32_bf16 a[44:47], v[68:71], v[44:47], a[44:47]
    buffer_load_dwordx4 v19, s[24:27], s36 offen offset:2048 lds
    v_mfma_f32_16x16x32_bf16 a[48:51], v[68:71], v[48:51], a[48:51]
    ds_read_b64_tr_b16 v[138:139], v12 offset:50176
    v_fmac_f32 v224, v211, v218
    v_mfma_f32_16x16x32_bf16 a[52:55], v[68:71], v[52:55], a[52:55]
    v_fmac_f32 v225, v212, v218
    v_fmac_f32 v226, v213, v218
    v_mfma_f32_16x16x32_bf16 a[56:59], v[68:71], v[56:59], a[56:59]
    ds_read_b128 v[100:103], v9 offset:34816
    v_fmac_f32 v227, v214, v218
    v_mfma_f32_16x16x32_bf16 a[60:63], v[68:71], v[60:63], a[60:63]
    buffer_load_dwordx4 v20, s[24:27], s36 offen offset:3072 lds
    v_mfma_f32_16x16x32_bf16 a[64:67], v[72:75], v[32:35], a[64:67]
    ds_read_b64_tr_b16 v[140:141], v13 offset:49152
    v_fmac_f32 v228, v215, v218
    v_mfma_f32_16x16x32_bf16 a[68:71], v[72:75], v[36:39], a[68:71]
    s_add_u32 s37, s49, 786432
    v_fmac_f32 v221, v207, v219
    v_fmac_f32 v222, v208, v219
    v_mfma_f32_16x16x32_bf16 a[72:75], v[72:75], v[40:43], a[72:75]
    s_add_u32 m0, s50, 26112
    ds_read_b64_tr_b16 v[142:143], v13 offset:50176
    v_fmac_f32 v223, v209, v219
    v_mfma_f32_16x16x32_bf16 a[76:79], v[72:75], v[44:47], a[76:79]
    buffer_load_dwordx4 v21, s[20:23], s37 offen offset:0 lds
    v_mfma_f32_16x16x32_bf16 a[80:83], v[72:75], v[48:51], a[80:83]
    ds_read_b128 v[104:107], v9 offset:36864
    v_fmac_f32 v224, v210, v219
    v_mfma_f32_16x16x32_bf16 a[84:87], v[72:75], v[52:55], a[84:87]
    v_fmac_f32 v225, v211, v219
    v_fmac_f32 v226, v212, v219
    v_mfma_f32_16x16x32_bf16 a[88:91], v[72:75], v[56:59], a[88:91]
    ds_read_b64_tr_b16 v[144:145], v10 offset:51200
    v_fmac_f32 v227, v213, v219
    v_mfma_f32_16x16x32_bf16 a[92:95], v[72:75], v[60:63], a[92:95]
    buffer_load_dwordx4 v22, s[20:23], s37 offen offset:1024 lds
    v_mfma_f32_16x16x32_bf16 a[96:99], v[76:79], v[32:35], a[96:99]
    ds_read_b64_tr_b16 v[146:147], v10 offset:52224
    v_fmac_f32 v228, v214, v219
    v_mfma_f32_16x16x32_bf16 a[100:103], v[76:79], v[36:39], a[100:103]
    s_add_u32 s37, s49, 1048576
    v_fmac_f32 v221, v206, v220
    v_fmac_f32 v222, v207, v220
    v_mfma_f32_16x16x32_bf16 a[104:107], v[76:79], v[40:43], a[104:107]
    s_add_u32 m0, s50, 34816
    ds_read_b128 v[108:111], v9 offset:38912
    v_fmac_f32 v223, v208, v220
    v_mfma_f32_16x16x32_bf16 a[108:111], v[76:79], v[44:47], a[108:111]
    buffer_load_dwordx4 v21, s[20:23], s37 offen offset:0 lds
    v_mfma_f32_16x16x32_bf16 a[112:115], v[76:79], v[48:51], a[112:115]
    ds_read_b64_tr_b16 v[148:149], v11 offset:51200
    v_fmac_f32 v224, v209, v220
    v_mfma_f32_16x16x32_bf16 a[116:119], v[76:79], v[52:55], a[116:119]
    v_fmac_f32 v225, v210, v220
    v_fmac_f32 v226, v211, v220
    v_mfma_f32_16x16x32_bf16 a[120:123], v[76:79], v[56:59], a[120:123]
    ds_read_b64_tr_b16 v[150:151], v11 offset:52224
    v_fmac_f32 v227, v212, v220
    v_mfma_f32_16x16x32_bf16 a[124:127], v[76:79], v[60:63], a[124:127]
    buffer_load_dwordx4 v22, s[20:23], s37 offen offset:1024 lds
    v_mfma_f32_16x16x32_bf16 a[128:131], v[32:35], v[80:83], a[128:131]
    ds_read_b128 v[112:115], v9 offset:40960
    v_fmac_f32 v228, v213, v220
    v_mfma_f32_16x16x32_bf16 a[132:135], v[36:39], v[80:83], a[132:135]
    v_lshlrev_b32 v206, 16, v183
    v_lshlrev_b32 v207, 16, v185
    v_mfma_f32_16x16x32_bf16 a[136:139], v[40:43], v[80:83], a[136:139]
    ds_read_b64_tr_b16 v[152:153], v12 offset:51200
    v_lshlrev_b32 v208, 16, v187
    v_mfma_f32_16x16x32_bf16 a[140:143], v[44:47], v[80:83], a[140:143]
    v_mfma_f32_16x16x32_bf16 a[144:147], v[48:51], v[80:83], a[144:147]
    ds_read_b64_tr_b16 v[154:155], v12 offset:52224
    v_lshlrev_b32 v209, 16, v189
    v_mfma_f32_16x16x32_bf16 a[148:151], v[52:55], v[80:83], a[148:151]
    v_lshlrev_b32 v210, 16, v191
    v_lshlrev_b32 v211, 16, v193
    v_mfma_f32_16x16x32_bf16 a[152:155], v[56:59], v[80:83], a[152:155]
    ds_read_b128 v[116:119], v9 offset:43008
    v_lshlrev_b32 v212, 16, v195
    v_mfma_f32_16x16x32_bf16 a[156:159], v[60:63], v[80:83], a[156:159]
    v_mfma_f32_16x16x32_bf16 a[160:163], v[32:35], v[84:87], a[160:163]
    ds_read_b64_tr_b16 v[156:157], v13 offset:51200
    v_lshlrev_b32 v213, 16, v197
    v_mfma_f32_16x16x32_bf16 a[164:167], v[36:39], v[84:87], a[164:167]
    v_mul_f32 v221, v221, v206
    v_mul_f32 v222, v222, v207
    v_mfma_f32_16x16x32_bf16 a[168:171], v[40:43], v[84:87], a[168:171]
    ds_read_b64_tr_b16 v[158:159], v13 offset:52224
    v_mul_f32 v223, v223, v208
    v_mfma_f32_16x16x32_bf16 a[172:175], v[44:47], v[84:87], a[172:175]
    v_mfma_f32_16x16x32_bf16 a[176:179], v[48:51], v[84:87], a[176:179]
    ds_read_b128 v[120:123], v9 offset:45056
    v_mul_f32 v224, v224, v209
    v_mfma_f32_16x16x32_bf16 a[180:183], v[52:55], v[84:87], a[180:183]
    v_mul_f32 v225, v225, v210
    v_mul_f32 v226, v226, v211
    v_mfma_f32_16x16x32_bf16 a[184:187], v[56:59], v[84:87], a[184:187]
    ds_read_b128 v[124:127], v9 offset:47104
    v_mul_f32 v227, v227, v212
    v_mfma_f32_16x16x32_bf16 a[188:191], v[60:63], v[84:87], a[188:191]
    v_mfma_f32_16x16x32_bf16 a[192:195], v[32:35], v[88:91], a[192:195]
    v_mul_f32 v228, v228, v213
    v_cvt_pk_bf16_f32 v244, v228, v227
    v_mfma_f32_16x16x32_bf16 a[196:199], v[36:39], v[88:91], a[196:199]
    v_cvt_pk_bf16_f32 v245, v226, v225
    v_cvt_pk_bf16_f32 v246, v224, v223
    v_mfma_f32_16x16x32_bf16 a[200:203], v[40:43], v[88:91], a[200:203]
    v_cvt_pk_bf16_f32 v247, v222, v221
    v_and_b32 v206, s52, v161
    v_mfma_f32_16x16x32_bf16 a[204:207], v[44:47], v[88:91], a[204:207]
    buffer_store_dwordx4 v[244:247], v234, s[16:19], s54 offen sc1
    v_mfma_f32_16x16x32_bf16 a[208:211], v[48:51], v[88:91], a[208:211]
    s_movk_i32 s54, 13824
    v_and_b32 v207, s52, v163
    v_and_b32 v208, s52, v165
    v_mfma_f32_16x16x32_bf16 a[212:215], v[52:55], v[88:91], a[212:215]
    v_and_b32 v209, s52, v167
    v_and_b32 v210, s52, v169
    v_mfma_f32_16x16x32_bf16 a[216:219], v[56:59], v[88:91], a[216:219]
    v_and_b32 v211, s52, v171
    v_and_b32 v212, s52, v173
    v_mfma_f32_16x16x32_bf16 a[220:223], v[60:63], v[88:91], a[220:223]
    v_mfma_f32_16x16x32_bf16 a[224:227], v[32:35], v[92:95], a[224:227]
    v_and_b32 v213, s52, v175
    v_and_b32 v214, s52, v177
    v_mfma_f32_16x16x32_bf16 a[228:231], v[36:39], v[92:95], a[228:231]
    v_and_b32 v215, s52, v179
    v_and_b32 v216, s52, v181
    v_mfma_f32_16x16x32_bf16 a[232:235], v[40:43], v[92:95], a[232:235]
    v_lshlrev_b32 v217, 16, v204
    v_and_b32 v218, s52, v204
    v_mfma_f32_16x16x32_bf16 a[236:239], v[44:47], v[92:95], a[236:239]
    v_mfma_f32_16x16x32_bf16 a[240:243], v[48:51], v[92:95], a[240:243]
    v_lshlrev_b32 v219, 16, v205
    v_and_b32 v220, s52, v205
    v_mfma_f32_16x16x32_bf16 a[244:247], v[52:55], v[92:95], a[244:247]
    v_mul_f32 v221, v209, v217
    v_mul_f32 v222, v210, v217
    v_mfma_f32_16x16x32_bf16 a[248:251], v[56:59], v[92:95], a[248:251]
    v_mul_f32 v223, v211, v217
    v_mul_f32 v224, v212, v217
    v_mfma_f32_16x16x32_bf16 a[252:255], v[60:63], v[92:95], a[252:255]
    s_waitcnt vmcnt(19) lgkmcnt(0)
    s_barrier
    v_mul_f32 v225, v213, v217
    v_mul_f32 v226, v214, v217
    v_mfma_f32_16x16x32_bf16 a[0:3], v[128:131], v[96:99], a[0:3]
    ds_read_b64_tr_b16 v[48:49], v27 offset:0
    v_mul_f32 v227, v215, v217
    v_mfma_f32_16x16x32_bf16 a[4:7], v[128:131], v[100:103], a[4:7]
    s_add_u32 s36, s44, 256
    v_mul_f32 v228, v216, v217
    v_fmac_f32 v221, v208, v218
    v_mfma_f32_16x16x32_bf16 a[8:11], v[128:131], v[104:107], a[8:11]
    s_add_u32 m0, s42, 32768
    ds_read_b64_tr_b16 v[50:51], v27 offset:1024
    v_fmac_f32 v222, v209, v218
    v_mfma_f32_16x16x32_bf16 a[12:15], v[128:131], v[108:111], a[12:15]
    buffer_load_dwordx4 v17, s[24:27], s36 offen offset:0 lds
    v_mfma_f32_16x16x32_bf16 a[16:19], v[128:131], v[112:115], a[16:19]
    ds_read_b128 v[32:35], v25 offset:0
    v_fmac_f32 v223, v210, v218
    v_mfma_f32_16x16x32_bf16 a[20:23], v[128:131], v[116:119], a[20:23]
    v_fmac_f32 v224, v211, v218
    v_fmac_f32 v225, v212, v218
    v_mfma_f32_16x16x32_bf16 a[24:27], v[128:131], v[120:123], a[24:27]
    ds_read_b128 v[36:39], v25 offset:2048
    v_fmac_f32 v226, v213, v218
    v_mfma_f32_16x16x32_bf16 a[28:31], v[128:131], v[124:127], a[28:31]
    buffer_load_dwordx4 v18, s[24:27], s36 offen offset:1024 lds
    v_mfma_f32_16x16x32_bf16 a[32:35], v[132:135], v[96:99], a[32:35]
    ds_read_b128 v[40:43], v25 offset:4096
    v_fmac_f32 v227, v214, v218
    v_mfma_f32_16x16x32_bf16 a[36:39], v[132:135], v[100:103], a[36:39]
    v_fmac_f32 v228, v215, v218
    v_fmac_f32 v221, v207, v219
    v_mfma_f32_16x16x32_bf16 a[40:43], v[132:135], v[104:107], a[40:43]
    ds_read_b128 v[44:47], v25 offset:6144
    v_fmac_f32 v222, v208, v219
    v_mfma_f32_16x16x32_bf16 a[44:47], v[132:135], v[108:111], a[44:47]
    buffer_load_dwordx4 v19, s[24:27], s36 offen offset:2048 lds
    v_mfma_f32_16x16x32_bf16 a[48:51], v[132:135], v[112:115], a[48:51]
    ds_read_b64_tr_b16 v[52:53], v28 offset:0
    v_fmac_f32 v223, v209, v219
    v_mfma_f32_16x16x32_bf16 a[52:55], v[132:135], v[116:119], a[52:55]
    v_fmac_f32 v224, v210, v219
    v_fmac_f32 v225, v211, v219
    v_mfma_f32_16x16x32_bf16 a[56:59], v[132:135], v[120:123], a[56:59]
    ds_read_b64_tr_b16 v[54:55], v28 offset:1024
    v_fmac_f32 v226, v212, v219
    v_mfma_f32_16x16x32_bf16 a[60:63], v[132:135], v[124:127], a[60:63]
    buffer_load_dwordx4 v20, s[24:27], s36 offen offset:3072 lds
    v_mfma_f32_16x16x32_bf16 a[64:67], v[136:139], v[96:99], a[64:67]
    ds_read_b64_tr_b16 v[56:57], v29 offset:0
    v_fmac_f32 v227, v213, v219
    v_mfma_f32_16x16x32_bf16 a[68:71], v[136:139], v[100:103], a[68:71]
    v_fmac_f32 v228, v214, v219
    v_fmac_f32 v221, v206, v220
    v_mfma_f32_16x16x32_bf16 a[72:75], v[136:139], v[104:107], a[72:75]
    ds_read_b64_tr_b16 v[58:59], v29 offset:1024
    v_fmac_f32 v222, v207, v220
    v_mfma_f32_16x16x32_bf16 a[76:79], v[136:139], v[108:111], a[76:79]
    v_mfma_f32_16x16x32_bf16 a[80:83], v[136:139], v[112:115], a[80:83]
    ds_read_b64_tr_b16 v[60:61], v30 offset:0
    v_fmac_f32 v223, v208, v220
    v_mfma_f32_16x16x32_bf16 a[84:87], v[136:139], v[116:119], a[84:87]
    v_fmac_f32 v224, v209, v220
    v_fmac_f32 v225, v210, v220
    v_mfma_f32_16x16x32_bf16 a[88:91], v[136:139], v[120:123], a[88:91]
    ds_read_b64_tr_b16 v[62:63], v30 offset:1024
    v_fmac_f32 v226, v211, v220
    v_mfma_f32_16x16x32_bf16 a[92:95], v[136:139], v[124:127], a[92:95]
    v_mfma_f32_16x16x32_bf16 a[96:99], v[140:143], v[96:99], a[96:99]
    ds_read_b64_tr_b16 v[64:65], v27 offset:128
    v_fmac_f32 v227, v212, v220
    v_mfma_f32_16x16x32_bf16 a[100:103], v[140:143], v[100:103], a[100:103]
    v_fmac_f32 v228, v213, v220
    v_and_b32 v206, s52, v183
    v_mfma_f32_16x16x32_bf16 a[104:107], v[140:143], v[104:107], a[104:107]
    ds_read_b64_tr_b16 v[66:67], v27 offset:1152
    v_and_b32 v207, s52, v185
    v_mfma_f32_16x16x32_bf16 a[108:111], v[140:143], v[108:111], a[108:111]
    v_mfma_f32_16x16x32_bf16 a[112:115], v[140:143], v[112:115], a[112:115]
    ds_read_b64_tr_b16 v[68:69], v28 offset:128
    v_and_b32 v208, s52, v187
    v_mfma_f32_16x16x32_bf16 a[116:119], v[140:143], v[116:119], a[116:119]
    v_and_b32 v209, s52, v189
    v_and_b32 v210, s52, v191
    v_mfma_f32_16x16x32_bf16 a[120:123], v[140:143], v[120:123], a[120:123]
    ds_read_b64_tr_b16 v[70:71], v28 offset:1152
    v_and_b32 v211, s52, v193
    v_mfma_f32_16x16x32_bf16 a[124:127], v[140:143], v[124:127], a[124:127]
    v_mfma_f32_16x16x32_bf16 a[128:131], v[96:99], v[144:147], a[128:131]
    ds_read_b64_tr_b16 v[72:73], v29 offset:128
    v_and_b32 v212, s52, v195
    v_mfma_f32_16x16x32_bf16 a[132:135], v[100:103], v[144:147], a[132:135]
    v_and_b32 v213, s52, v197
    v_mul_f32 v221, v221, v206
    v_mfma_f32_16x16x32_bf16 a[136:139], v[104:107], v[144:147], a[136:139]
    ds_read_b64_tr_b16 v[74:75], v29 offset:1152
    v_mul_f32 v222, v222, v207
    v_mfma_f32_16x16x32_bf16 a[140:143], v[108:111], v[144:147], a[140:143]
    v_mfma_f32_16x16x32_bf16 a[144:147], v[112:115], v[144:147], a[144:147]
    ds_read_b64_tr_b16 v[76:77], v30 offset:128
    v_mul_f32 v223, v223, v208
    v_mfma_f32_16x16x32_bf16 a[148:151], v[116:119], v[144:147], a[148:151]
    v_mul_f32 v224, v224, v209
    v_mul_f32 v225, v225, v210
    v_mfma_f32_16x16x32_bf16 a[152:155], v[120:123], v[144:147], a[152:155]
    ds_read_b64_tr_b16 v[78:79], v30 offset:1152
    v_mul_f32 v226, v226, v211
    v_mfma_f32_16x16x32_bf16 a[156:159], v[124:127], v[144:147], a[156:159]
    v_mfma_f32_16x16x32_bf16 a[160:163], v[96:99], v[148:151], a[160:163]
    v_mul_f32 v227, v227, v212
    v_mul_f32 v228, v228, v213
    v_mfma_f32_16x16x32_bf16 a[164:167], v[100:103], v[148:151], a[164:167]
    v_cvt_pk_bf16_f32 v248, v228, v227
    v_cvt_pk_bf16_f32 v249, v226, v225
    v_mfma_f32_16x16x32_bf16 a[168:171], v[104:107], v[148:151], a[168:171]
    v_cvt_pk_bf16_f32 v250, v224, v223
    v_cvt_pk_bf16_f32 v251, v222, v221
    v_mfma_f32_16x16x32_bf16 a[172:175], v[108:111], v[148:151], a[172:175]
    buffer_store_dwordx4 v[248:251], v234, s[16:19], s54 offen sc1
    v_mfma_f32_16x16x32_bf16 a[176:179], v[112:115], v[148:151], a[176:179]
    v_mov_b32 v160, 0
    v_mov_b32 v161, 0
    v_mfma_f32_16x16x32_bf16 a[180:183], v[116:119], v[148:151], a[180:183]
    v_mov_b32 v162, 0
    v_mov_b32 v163, 0
    v_mfma_f32_16x16x32_bf16 a[184:187], v[120:123], v[148:151], a[184:187]
    v_mfma_f32_16x16x32_bf16 a[188:191], v[124:127], v[148:151], a[188:191]
    buffer_store_dwordx4 v[160:163], v235, s[16:19], s53 offen sc1
    v_mfma_f32_16x16x32_bf16 a[192:195], v[96:99], v[152:155], a[192:195]
    v_mfma_f32_16x16x32_bf16 a[196:199], v[100:103], v[152:155], a[196:199]
    v_mfma_f32_16x16x32_bf16 a[200:203], v[104:107], v[152:155], a[200:203]
    v_mfma_f32_16x16x32_bf16 a[204:207], v[108:111], v[152:155], a[204:207]
    v_mfma_f32_16x16x32_bf16 a[208:211], v[112:115], v[152:155], a[208:211]
    v_mfma_f32_16x16x32_bf16 a[212:215], v[116:119], v[152:155], a[212:215]
    v_mfma_f32_16x16x32_bf16 a[216:219], v[120:123], v[152:155], a[216:219]
    v_mfma_f32_16x16x32_bf16 a[220:223], v[124:127], v[152:155], a[220:223]
    v_mfma_f32_16x16x32_bf16 a[224:227], v[96:99], v[156:159], a[224:227]
    v_mfma_f32_16x16x32_bf16 a[228:231], v[100:103], v[156:159], a[228:231]
    v_mfma_f32_16x16x32_bf16 a[232:235], v[104:107], v[156:159], a[232:235]
    v_mfma_f32_16x16x32_bf16 a[236:239], v[108:111], v[156:159], a[236:239]
    v_mfma_f32_16x16x32_bf16 a[240:243], v[112:115], v[156:159], a[240:243]
    v_mfma_f32_16x16x32_bf16 a[244:247], v[116:119], v[156:159], a[244:247]
    v_mfma_f32_16x16x32_bf16 a[248:251], v[120:123], v[156:159], a[248:251]
    v_mfma_f32_16x16x32_bf16 a[252:255], v[124:127], v[156:159], a[252:255]
    s_waitcnt vmcnt(19) lgkmcnt(0)
    s_barrier
    v_mfma_f32_16x16x32_bf16 v[128:131], v[48:51], v[32:35], 0
    s_lshl_b32 s38, s33, 6
    ds_read_b64_tr_b16 v[96:97], v27 offset:8704
    ds_read_b64_tr_b16 v[98:99], v27 offset:9728
    v_mfma_f32_16x16x32_bf16 v[160:163], v[48:51], v[36:39], 0
    s_add_u32 s36, s45, 256
    v_mfma_f32_16x16x32_bf16 v[192:195], v[48:51], v[40:43], 0
    s_add_u32 m0, s42, 36864
    ds_read_b128 v[80:83], v26 offset:0
    ds_read_b128 v[84:87], v26 offset:2048
    v_mfma_f32_16x16x32_bf16 v[224:227], v[48:51], v[44:47], 0
    buffer_load_dwordx4 v17, s[24:27], s36 offen offset:0 lds
    v_mfma_f32_16x16x32_bf16 v[132:135], v[52:55], v[32:35], 0
    s_lshl_b32 s54, s34, 3
    ds_read_b128 v[88:91], v26 offset:4096
    ds_read_b128 v[92:95], v26 offset:6144
    v_mfma_f32_16x16x32_bf16 v[164:167], v[52:55], v[36:39], 0
    s_add_u32 s38, s38, s54
    v_accvgpr_read_b32 v4, a132
    v_accvgpr_read_b32 v5, a133
    v_mfma_f32_16x16x32_bf16 v[196:199], v[52:55], v[40:43], 0
    s_lshr_b32 s54, s32, 1
    ds_read_b64_tr_b16 v[100:101], v28 offset:8704
    ds_read_b64_tr_b16 v[102:103], v28 offset:9728
    v_mfma_f32_16x16x32_bf16 v[228:231], v[52:55], v[44:47], 0
    buffer_load_dwordx4 v18, s[24:27], s36 offen offset:1024 lds
    v_mfma_f32_16x16x32_bf16 v[136:139], v[56:59], v[32:35], 0
    s_lshl_b32 s54, s54, 2
    ds_read_b64_tr_b16 v[104:105], v29 offset:8704
    ds_read_b64_tr_b16 v[106:107], v29 offset:9728
    v_mfma_f32_16x16x32_bf16 v[168:171], v[56:59], v[36:39], 0
    s_add_u32 s38, s38, s54
    v_accvgpr_read_b32 v6, a134
    v_accvgpr_read_b32 v7, a135
    v_mfma_f32_16x16x32_bf16 v[200:203], v[56:59], v[40:43], 0
    s_lshl_b32 s38, s38, 14
    ds_read_b64_tr_b16 v[108:109], v30 offset:8704
    ds_read_b64_tr_b16 v[110:111], v30 offset:9728
    v_mfma_f32_16x16x32_bf16 v[232:235], v[56:59], v[44:47], 0
    v_mfma_f32_16x16x32_bf16 v[140:143], v[60:63], v[32:35], 0
    s_and_b32 s54, s32, 1
    ds_read_b64_tr_b16 v[112:113], v27 offset:8832
    ds_read_b64_tr_b16 v[114:115], v27 offset:9856
    v_mfma_f32_16x16x32_bf16 v[172:175], v[60:63], v[36:39], 0
    s_lshl_b32 s54, s54, 11
    v_accvgpr_read_b32 v0, a128
    v_accvgpr_read_b32 v1, a129
    v_mfma_f32_16x16x32_bf16 v[204:207], v[60:63], v[40:43], 0
    s_add_u32 s41, s38, s54
    ds_read_b64_tr_b16 v[116:117], v28 offset:8832
    ds_read_b64_tr_b16 v[118:119], v28 offset:9856
    v_mfma_f32_16x16x32_bf16 v[236:239], v[60:63], v[44:47], 0
    buffer_load_dwordx4 v19, s[24:27], s36 offen offset:2048 lds
    v_mfma_f32_16x16x32_bf16 v[144:147], v[64:67], v[32:35], 0
    s_add_u32 s38, s41, s54
    ds_read_b64_tr_b16 v[120:121], v29 offset:8832
    ds_read_b64_tr_b16 v[122:123], v29 offset:9856
    v_mfma_f32_16x16x32_bf16 v[176:179], v[64:67], v[36:39], 0
gated_mix__ssm_conv_h3__compressed_kv_cla__prompt_kernel_pad3:
    s_cbranch_execz gated_mix__ssm_conv_h3__compressed_kv_cla__prompt_kernel_pad11
    s_add_u32 s38, s38, 8192
    v_accvgpr_read_b32 v2, a130
    v_accvgpr_read_b32 v3, a131
    v_mfma_f32_16x16x32_bf16 v[208:211], v[64:67], v[40:43], 0
    s_mov_b32 s40, 0x3e0293ee
    ds_read_b64_tr_b16 v[124:125], v30 offset:8832
    ds_read_b64_tr_b16 v[126:127], v30 offset:9856
    v_mfma_f32_16x16x32_bf16 v[240:243], v[64:67], v[44:47], 0
    s_mov_b32 s16, s94
    v_cvt_pk_bf16_f32 v0, v0, v1
    v_cvt_pk_bf16_f32 v1, v2, v3
    v_mfma_f32_16x16x32_bf16 v[148:151], v[68:71], v[32:35], 0
    s_mov_b32 s17, s95
    v_cvt_pk_bf16_f32 v2, v4, v5
    v_cvt_pk_bf16_f32 v3, v6, v7
    v_mfma_f32_16x16x32_bf16 v[180:183], v[68:71], v[36:39], 0
    buffer_load_dwordx4 v20, s[24:27], s36 offen offset:3072 lds
    v_mfma_f32_16x16x32_bf16 v[212:215], v[68:71], v[40:43], 0
    s_add_u32 s37, s49, 1310720
    v_accvgpr_read_b32 v12, a32
    v_accvgpr_read_b32 v13, a33
    v_mfma_f32_16x16x32_bf16 v[244:247], v[68:71], v[44:47], 0
    s_add_u32 m0, s50, 43520
    v_accvgpr_read_b32 v14, a34
    v_accvgpr_read_b32 v15, a35
    v_mfma_f32_16x16x32_bf16 v[152:155], v[72:75], v[32:35], 0
    buffer_load_dwordx4 v21, s[20:23], s37 offen offset:0 lds
    v_mfma_f32_16x16x32_bf16 v[184:187], v[72:75], v[36:39], 0
    s_mov_b32 s18, 33554432
    v_accvgpr_read_b32 v8, a0
    v_accvgpr_read_b32 v9, a1
    v_mfma_f32_16x16x32_bf16 v[216:219], v[72:75], v[40:43], 0
    v_accvgpr_read_b32 v10, a2
    v_accvgpr_read_b32 v11, a3
    v_mfma_f32_16x16x32_bf16 v[248:251], v[72:75], v[44:47], 0
    buffer_store_dwordx4 v[0:3], v16, s[16:19], s38 offen offset:0
    v_mfma_f32_16x16x32_bf16 v[156:159], v[76:79], v[32:35], 0
    v_mul_f32 v8, s40, v8
    v_mul_f32 v9, s40, v9
    v_mfma_f32_16x16x32_bf16 v[188:191], v[76:79], v[36:39], 0
    v_mul_f32 v10, s40, v10
    v_mul_f32 v11, s40, v11
    v_mfma_f32_16x16x32_bf16 v[220:223], v[76:79], v[40:43], 0
    buffer_load_dwordx4 v22, s[20:23], s37 offen offset:1024 lds
    v_mfma_f32_16x16x32_bf16 v[252:255], v[76:79], v[44:47], 0
    s_waitcnt vmcnt(16) lgkmcnt(0)
    s_barrier
    v_mul_f32 v12, s40, v12
    v_mul_f32 v13, s40, v13
    v_mfma_f32_16x16x32_bf16 v[128:131], v[96:99], v[80:83], v[128:131]
    ds_read_b64_tr_b16 v[48:49], v27 offset:17408
    ds_read_b64_tr_b16 v[50:51], v27 offset:18432
    v_mfma_f32_16x16x32_bf16 v[160:163], v[96:99], v[84:87], v[160:163]
    s_add_u32 s36, s44, 384
    v_mul_f32 v14, s40, v14
    v_mul_f32 v15, s40, v15
    v_mfma_f32_16x16x32_bf16 v[192:195], v[96:99], v[88:91], v[192:195]
    s_add_u32 m0, s42, 65536
    ds_read_b128 v[32:35], v23 offset:0
    ds_read_b128 v[36:39], v23 offset:2048
    v_mfma_f32_16x16x32_bf16 v[224:227], v[96:99], v[92:95], v[224:227]
    buffer_load_dwordx4 v17, s[24:27], s36 offen offset:0 lds
    v_mfma_f32_16x16x32_bf16 v[132:135], v[100:103], v[80:83], v[132:135]
    ds_read_b128 v[40:43], v23 offset:4096
    ds_read_b128 v[44:47], v23 offset:6144
    v_mfma_f32_16x16x32_bf16 v[164:167], v[100:103], v[84:87], v[164:167]
    v_cvt_pk_bf16_f32 v8, v8, v9
    v_cvt_pk_bf16_f32 v9, v10, v11
    v_mfma_f32_16x16x32_bf16 v[196:199], v[100:103], v[88:91], v[196:199]
    ds_read_b64_tr_b16 v[52:53], v28 offset:17408
    ds_read_b64_tr_b16 v[54:55], v28 offset:18432
    v_mfma_f32_16x16x32_bf16 v[228:231], v[100:103], v[92:95], v[228:231]
    buffer_load_dwordx4 v18, s[24:27], s36 offen offset:1024 lds
    v_mfma_f32_16x16x32_bf16 v[136:139], v[104:107], v[80:83], v[136:139]
    ds_read_b64_tr_b16 v[56:57], v29 offset:17408
    ds_read_b64_tr_b16 v[58:59], v29 offset:18432
    v_mfma_f32_16x16x32_bf16 v[168:171], v[104:107], v[84:87], v[168:171]
    v_cvt_pk_bf16_f32 v10, v12, v13
    v_cvt_pk_bf16_f32 v11, v14, v15
    v_mfma_f32_16x16x32_bf16 v[200:203], v[104:107], v[88:91], v[200:203]
    ds_read_b64_tr_b16 v[60:61], v30 offset:17408
    ds_read_b64_tr_b16 v[62:63], v30 offset:18432
    v_mfma_f32_16x16x32_bf16 v[232:235], v[104:107], v[92:95], v[232:235]
    buffer_store_dwordx4 v[8:11], v16, s[16:19], s41 offen offset:0
    v_mfma_f32_16x16x32_bf16 v[140:143], v[108:111], v[80:83], v[140:143]
    ds_read_b64_tr_b16 v[64:65], v27 offset:17536
    ds_read_b64_tr_b16 v[66:67], v27 offset:18560
    v_mfma_f32_16x16x32_bf16 v[172:175], v[108:111], v[84:87], v[172:175]
    v_accvgpr_read_b32 v4, a164
    v_accvgpr_read_b32 v5, a165
    v_mfma_f32_16x16x32_bf16 v[204:207], v[108:111], v[88:91], v[204:207]
    ds_read_b64_tr_b16 v[68:69], v28 offset:17536
    ds_read_b64_tr_b16 v[70:71], v28 offset:18560
    v_mfma_f32_16x16x32_bf16 v[236:239], v[108:111], v[92:95], v[236:239]
    buffer_load_dwordx4 v19, s[24:27], s36 offen offset:2048 lds
    v_mfma_f32_16x16x32_bf16 v[144:147], v[112:115], v[80:83], v[144:147]
    ds_read_b64_tr_b16 v[72:73], v29 offset:17536
    ds_read_b64_tr_b16 v[74:75], v29 offset:18560
    v_mfma_f32_16x16x32_bf16 v[176:179], v[112:115], v[84:87], v[176:179]
    v_accvgpr_read_b32 v6, a166
    v_accvgpr_read_b32 v7, a167
    v_mfma_f32_16x16x32_bf16 v[208:211], v[112:115], v[88:91], v[208:211]
    ds_read_b64_tr_b16 v[76:77], v30 offset:17536
    ds_read_b64_tr_b16 v[78:79], v30 offset:18560
    v_mfma_f32_16x16x32_bf16 v[240:243], v[112:115], v[92:95], v[240:243]
    v_accvgpr_read_b32 v0, a160
    v_accvgpr_read_b32 v1, a161
    v_mfma_f32_16x16x32_bf16 v[148:151], v[116:119], v[80:83], v[148:151]
    v_accvgpr_read_b32 v2, a162
    v_accvgpr_read_b32 v3, a163
    v_mfma_f32_16x16x32_bf16 v[180:183], v[116:119], v[84:87], v[180:183]
    buffer_load_dwordx4 v20, s[24:27], s36 offen offset:3072 lds
    v_mfma_f32_16x16x32_bf16 v[212:215], v[116:119], v[88:91], v[212:215]
    s_add_u32 s37, s49, 1572864
    v_cvt_pk_bf16_f32 v0, v0, v1
    v_cvt_pk_bf16_f32 v1, v2, v3
    v_mfma_f32_16x16x32_bf16 v[244:247], v[116:119], v[92:95], v[244:247]
    s_add_u32 m0, s50, 0
    v_cvt_pk_bf16_f32 v2, v4, v5
    v_cvt_pk_bf16_f32 v3, v6, v7
    v_mfma_f32_16x16x32_bf16 v[152:155], v[120:123], v[80:83], v[152:155]
    buffer_load_dwordx4 v21, s[20:23], s37 offen offset:0 lds
    v_mfma_f32_16x16x32_bf16 v[184:187], v[120:123], v[84:87], v[184:187]
    v_accvgpr_read_b32 v12, a96
    v_accvgpr_read_b32 v13, a97
    v_mfma_f32_16x16x32_bf16 v[216:219], v[120:123], v[88:91], v[216:219]
    v_accvgpr_read_b32 v14, a98
    v_accvgpr_read_b32 v15, a99
    v_mfma_f32_16x16x32_bf16 v[248:251], v[120:123], v[92:95], v[248:251]
    buffer_store_dwordx4 v[0:3], v16, s[16:19], s38 offen offset:1024
    v_mfma_f32_16x16x32_bf16 v[156:159], v[124:127], v[80:83], v[156:159]
    v_accvgpr_read_b32 v8, a64
    v_accvgpr_read_b32 v9, a65
    v_mfma_f32_16x16x32_bf16 v[188:191], v[124:127], v[84:87], v[188:191]
    v_accvgpr_read_b32 v10, a66
    v_accvgpr_read_b32 v11, a67
    v_mfma_f32_16x16x32_bf16 v[220:223], v[124:127], v[88:91], v[220:223]
    buffer_load_dwordx4 v22, s[20:23], s37 offen offset:1024 lds
    v_mfma_f32_16x16x32_bf16 v[252:255], v[124:127], v[92:95], v[252:255]
    s_waitcnt lgkmcnt(0)
    v_mul_f32 v8, s40, v8
    v_mul_f32 v9, s40, v9
    v_mfma_f32_16x16x32_bf16 v[128:131], v[48:51], v[32:35], v[128:131]
    ds_read_b64_tr_b16 v[96:97], v27 offset:26112
    ds_read_b64_tr_b16 v[98:99], v27 offset:27136
    v_mfma_f32_16x16x32_bf16 v[160:163], v[48:51], v[36:39], v[160:163]
    s_add_u32 s36, s45, 384
    v_mul_f32 v10, s40, v10
    v_mul_f32 v11, s40, v11
    v_mfma_f32_16x16x32_bf16 v[192:195], v[48:51], v[40:43], v[192:195]
    s_add_u32 m0, s42, 69632
    ds_read_b128 v[80:83], v24 offset:0
    ds_read_b128 v[84:87], v24 offset:2048
    v_mfma_f32_16x16x32_bf16 v[224:227], v[48:51], v[44:47], v[224:227]
    buffer_load_dwordx4 v17, s[24:27], s36 offen offset:0 lds
    v_mfma_f32_16x16x32_bf16 v[132:135], v[52:55], v[32:35], v[132:135]
    ds_read_b128 v[88:91], v24 offset:4096
    ds_read_b128 v[92:95], v24 offset:6144
    v_mfma_f32_16x16x32_bf16 v[164:167], v[52:55], v[36:39], v[164:167]
    v_mul_f32 v12, s40, v12
    v_mul_f32 v13, s40, v13
    v_mfma_f32_16x16x32_bf16 v[196:199], v[52:55], v[40:43], v[196:199]
    ds_read_b64_tr_b16 v[100:101], v28 offset:26112
    ds_read_b64_tr_b16 v[102:103], v28 offset:27136
    v_mfma_f32_16x16x32_bf16 v[228:231], v[52:55], v[44:47], v[228:231]
    buffer_load_dwordx4 v18, s[24:27], s36 offen offset:1024 lds
    v_mfma_f32_16x16x32_bf16 v[136:139], v[56:59], v[32:35], v[136:139]
    ds_read_b64_tr_b16 v[104:105], v29 offset:26112
    ds_read_b64_tr_b16 v[106:107], v29 offset:27136
    v_mfma_f32_16x16x32_bf16 v[168:171], v[56:59], v[36:39], v[168:171]
    v_mul_f32 v14, s40, v14
    v_mul_f32 v15, s40, v15
    v_mfma_f32_16x16x32_bf16 v[200:203], v[56:59], v[40:43], v[200:203]
    ds_read_b64_tr_b16 v[108:109], v30 offset:26112
    ds_read_b64_tr_b16 v[110:111], v30 offset:27136
    v_mfma_f32_16x16x32_bf16 v[232:235], v[56:59], v[44:47], v[232:235]
    v_mfma_f32_16x16x32_bf16 v[140:143], v[60:63], v[32:35], v[140:143]
    ds_read_b64_tr_b16 v[112:113], v27 offset:26240
    ds_read_b64_tr_b16 v[114:115], v27 offset:27264
    v_mfma_f32_16x16x32_bf16 v[172:175], v[60:63], v[36:39], v[172:175]
    v_cvt_pk_bf16_f32 v8, v8, v9
    v_cvt_pk_bf16_f32 v9, v10, v11
    v_mfma_f32_16x16x32_bf16 v[204:207], v[60:63], v[40:43], v[204:207]
    ds_read_b64_tr_b16 v[116:117], v28 offset:26240
    ds_read_b64_tr_b16 v[118:119], v28 offset:27264
    v_mfma_f32_16x16x32_bf16 v[236:239], v[60:63], v[44:47], v[236:239]
    buffer_load_dwordx4 v19, s[24:27], s36 offen offset:2048 lds
    v_mfma_f32_16x16x32_bf16 v[144:147], v[64:67], v[32:35], v[144:147]
    ds_read_b64_tr_b16 v[120:121], v29 offset:26240
    ds_read_b64_tr_b16 v[122:123], v29 offset:27264
    v_mfma_f32_16x16x32_bf16 v[176:179], v[64:67], v[36:39], v[176:179]
    v_cvt_pk_bf16_f32 v10, v12, v13
    v_cvt_pk_bf16_f32 v11, v14, v15
    v_mfma_f32_16x16x32_bf16 v[208:211], v[64:67], v[40:43], v[208:211]
    ds_read_b64_tr_b16 v[124:125], v30 offset:26240
    ds_read_b64_tr_b16 v[126:127], v30 offset:27264
    v_mfma_f32_16x16x32_bf16 v[240:243], v[64:67], v[44:47], v[240:243]
    v_accvgpr_read_b32 v4, a196
    v_accvgpr_read_b32 v5, a197
    v_mfma_f32_16x16x32_bf16 v[148:151], v[68:71], v[32:35], v[148:151]
    v_accvgpr_read_b32 v6, a198
    v_accvgpr_read_b32 v7, a199
    v_mfma_f32_16x16x32_bf16 v[180:183], v[68:71], v[36:39], v[180:183]
    buffer_load_dwordx4 v20, s[24:27], s36 offen offset:3072 lds
    v_mfma_f32_16x16x32_bf16 v[212:215], v[68:71], v[40:43], v[212:215]
    s_add_u32 s37, s49, 1835008
    v_accvgpr_read_b32 v0, a192
    v_accvgpr_read_b32 v1, a193
    v_mfma_f32_16x16x32_bf16 v[244:247], v[68:71], v[44:47], v[244:247]
    s_add_u32 m0, s50, 8704
    v_accvgpr_read_b32 v2, a194
    v_accvgpr_read_b32 v3, a195
    v_mfma_f32_16x16x32_bf16 v[152:155], v[72:75], v[32:35], v[152:155]
    buffer_load_dwordx4 v21, s[20:23], s37 offen offset:0 lds
    v_mfma_f32_16x16x32_bf16 v[184:187], v[72:75], v[36:39], v[184:187]
    v_cvt_pk_bf16_f32 v0, v0, v1
    v_cvt_pk_bf16_f32 v1, v2, v3
    v_mfma_f32_16x16x32_bf16 v[216:219], v[72:75], v[40:43], v[216:219]
    v_cvt_pk_bf16_f32 v2, v4, v5
    v_cvt_pk_bf16_f32 v3, v6, v7
    v_mfma_f32_16x16x32_bf16 v[248:251], v[72:75], v[44:47], v[248:251]
    buffer_store_dwordx4 v[8:11], v16, s[16:19], s41 offen offset:1024
    v_mfma_f32_16x16x32_bf16 v[156:159], v[76:79], v[32:35], v[156:159]
    s_add_u32 s41, s41, 4096
    v_accvgpr_read_b32 v12, a36
    v_accvgpr_read_b32 v13, a37
    v_mfma_f32_16x16x32_bf16 v[188:191], v[76:79], v[36:39], v[188:191]
    v_accvgpr_read_b32 v14, a38
    v_accvgpr_read_b32 v15, a39
    v_mfma_f32_16x16x32_bf16 v[220:223], v[76:79], v[40:43], v[220:223]
    buffer_load_dwordx4 v22, s[20:23], s37 offen offset:1024 lds
    v_mfma_f32_16x16x32_bf16 v[252:255], v[76:79], v[44:47], v[252:255]
    s_waitcnt vmcnt(15) lgkmcnt(0)
    s_barrier
    v_accvgpr_read_b32 v8, a4
    v_accvgpr_read_b32 v9, a5
    v_mfma_f32_16x16x32_bf16 v[128:131], v[96:99], v[80:83], v[128:131]
    ds_read_b64_tr_b16 v[48:49], v27 offset:34816
    ds_read_b64_tr_b16 v[50:51], v27 offset:35840
    v_mfma_f32_16x16x32_bf16 v[160:163], v[96:99], v[84:87], v[160:163]
    s_add_u32 s36, s44, 512
    v_accvgpr_read_b32 v10, a6
    v_accvgpr_read_b32 v11, a7
    v_mfma_f32_16x16x32_bf16 v[192:195], v[96:99], v[88:91], v[192:195]
    s_add_u32 m0, s42, 0
    ds_read_b128 v[32:35], v23 offset:32768
    ds_read_b128 v[36:39], v23 offset:34816
    v_mfma_f32_16x16x32_bf16 v[224:227], v[96:99], v[92:95], v[224:227]
    buffer_load_dwordx4 v17, s[24:27], s36 offen offset:0 lds
    v_mfma_f32_16x16x32_bf16 v[132:135], v[100:103], v[80:83], v[132:135]
    ds_read_b128 v[40:43], v23 offset:36864
    ds_read_b128 v[44:47], v23 offset:38912
    v_mfma_f32_16x16x32_bf16 v[164:167], v[100:103], v[84:87], v[164:167]
    v_mul_f32 v8, s40, v8
    v_mul_f32 v9, s40, v9
    v_mfma_f32_16x16x32_bf16 v[196:199], v[100:103], v[88:91], v[196:199]
    ds_read_b64_tr_b16 v[52:53], v28 offset:34816
    ds_read_b64_tr_b16 v[54:55], v28 offset:35840
    v_mfma_f32_16x16x32_bf16 v[228:231], v[100:103], v[92:95], v[228:231]
    buffer_load_dwordx4 v18, s[24:27], s36 offen offset:1024 lds
    v_mfma_f32_16x16x32_bf16 v[136:139], v[104:107], v[80:83], v[136:139]
    ds_read_b64_tr_b16 v[56:57], v29 offset:34816
    ds_read_b64_tr_b16 v[58:59], v29 offset:35840
    v_mfma_f32_16x16x32_bf16 v[168:171], v[104:107], v[84:87], v[168:171]
    v_mul_f32 v10, s40, v10
    v_mul_f32 v11, s40, v11
    v_mfma_f32_16x16x32_bf16 v[200:203], v[104:107], v[88:91], v[200:203]
    ds_read_b64_tr_b16 v[60:61], v30 offset:34816
    ds_read_b64_tr_b16 v[62:63], v30 offset:35840
    v_mfma_f32_16x16x32_bf16 v[232:235], v[104:107], v[92:95], v[232:235]
    buffer_store_dwordx4 v[0:3], v16, s[16:19], s38 offen offset:2048
    v_mfma_f32_16x16x32_bf16 v[140:143], v[108:111], v[80:83], v[140:143]
    ds_read_b64_tr_b16 v[64:65], v27 offset:34944
    ds_read_b64_tr_b16 v[66:67], v27 offset:35968
    v_mfma_f32_16x16x32_bf16 v[172:175], v[108:111], v[84:87], v[172:175]
    v_mul_f32 v12, s40, v12
    v_mul_f32 v13, s40, v13
    v_mfma_f32_16x16x32_bf16 v[204:207], v[108:111], v[88:91], v[204:207]
    ds_read_b64_tr_b16 v[68:69], v28 offset:34944
    ds_read_b64_tr_b16 v[70:71], v28 offset:35968
    v_mfma_f32_16x16x32_bf16 v[236:239], v[108:111], v[92:95], v[236:239]
    buffer_load_dwordx4 v19, s[24:27], s36 offen offset:2048 lds
    v_mfma_f32_16x16x32_bf16 v[144:147], v[112:115], v[80:83], v[144:147]
    ds_read_b64_tr_b16 v[72:73], v29 offset:34944
    ds_read_b64_tr_b16 v[74:75], v29 offset:35968
    v_mfma_f32_16x16x32_bf16 v[176:179], v[112:115], v[84:87], v[176:179]
    v_mul_f32 v14, s40, v14
    v_mul_f32 v15, s40, v15
    v_mfma_f32_16x16x32_bf16 v[208:211], v[112:115], v[88:91], v[208:211]
    ds_read_b64_tr_b16 v[76:77], v30 offset:34944
    ds_read_b64_tr_b16 v[78:79], v30 offset:35968
    v_mfma_f32_16x16x32_bf16 v[240:243], v[112:115], v[92:95], v[240:243]
    v_cvt_pk_bf16_f32 v8, v8, v9
    v_cvt_pk_bf16_f32 v9, v10, v11
    v_mfma_f32_16x16x32_bf16 v[148:151], v[116:119], v[80:83], v[148:151]
    v_cvt_pk_bf16_f32 v10, v12, v13
    v_cvt_pk_bf16_f32 v11, v14, v15
    v_mfma_f32_16x16x32_bf16 v[180:183], v[116:119], v[84:87], v[180:183]
    buffer_load_dwordx4 v20, s[24:27], s36 offen offset:3072 lds
    v_mfma_f32_16x16x32_bf16 v[212:215], v[116:119], v[88:91], v[212:215]
    s_add_u32 s37, s49, 2097152
    v_accvgpr_read_b32 v4, a228
    v_accvgpr_read_b32 v5, a229
    v_mfma_f32_16x16x32_bf16 v[244:247], v[116:119], v[92:95], v[244:247]
    s_add_u32 m0, s50, 17408
    v_accvgpr_read_b32 v6, a230
    v_accvgpr_read_b32 v7, a231
    v_mfma_f32_16x16x32_bf16 v[152:155], v[120:123], v[80:83], v[152:155]
    buffer_load_dwordx4 v21, s[20:23], s37 offen offset:0 lds
    v_mfma_f32_16x16x32_bf16 v[184:187], v[120:123], v[84:87], v[184:187]
    v_accvgpr_read_b32 v0, a224
    v_accvgpr_read_b32 v1, a225
    v_mfma_f32_16x16x32_bf16 v[216:219], v[120:123], v[88:91], v[216:219]
    v_accvgpr_read_b32 v2, a226
    v_accvgpr_read_b32 v3, a227
    v_mfma_f32_16x16x32_bf16 v[248:251], v[120:123], v[92:95], v[248:251]
    buffer_store_dwordx4 v[8:11], v16, s[16:19], s41 offen offset:0
    v_mfma_f32_16x16x32_bf16 v[156:159], v[124:127], v[80:83], v[156:159]
    v_cvt_pk_bf16_f32 v0, v0, v1
    v_cvt_pk_bf16_f32 v1, v2, v3
    v_mfma_f32_16x16x32_bf16 v[188:191], v[124:127], v[84:87], v[188:191]
    v_cvt_pk_bf16_f32 v2, v4, v5
    v_cvt_pk_bf16_f32 v3, v6, v7
    v_mfma_f32_16x16x32_bf16 v[220:223], v[124:127], v[88:91], v[220:223]
    buffer_load_dwordx4 v22, s[20:23], s37 offen offset:1024 lds
    v_mfma_f32_16x16x32_bf16 v[252:255], v[124:127], v[92:95], v[252:255]
    s_waitcnt lgkmcnt(0)
    v_accvgpr_read_b32 v12, a100
    v_accvgpr_read_b32 v13, a101
    v_mfma_f32_16x16x32_bf16 v[128:131], v[48:51], v[32:35], v[128:131]
    ds_read_b64_tr_b16 v[96:97], v27 offset:43520
    ds_read_b64_tr_b16 v[98:99], v27 offset:44544
    v_mfma_f32_16x16x32_bf16 v[160:163], v[48:51], v[36:39], v[160:163]
    s_add_u32 s36, s45, 512
    v_accvgpr_read_b32 v14, a102
    v_accvgpr_read_b32 v15, a103
    v_mfma_f32_16x16x32_bf16 v[192:195], v[48:51], v[40:43], v[192:195]
    s_add_u32 m0, s42, 4096
    ds_read_b128 v[80:83], v24 offset:32768
    ds_read_b128 v[84:87], v24 offset:34816
    v_mfma_f32_16x16x32_bf16 v[224:227], v[48:51], v[44:47], v[224:227]
    buffer_load_dwordx4 v17, s[24:27], s36 offen offset:0 lds
    v_mfma_f32_16x16x32_bf16 v[132:135], v[52:55], v[32:35], v[132:135]
    ds_read_b128 v[88:91], v24 offset:36864
    ds_read_b128 v[92:95], v24 offset:38912
    v_mfma_f32_16x16x32_bf16 v[164:167], v[52:55], v[36:39], v[164:167]
    v_accvgpr_read_b32 v8, a68
    v_accvgpr_read_b32 v9, a69
    v_mfma_f32_16x16x32_bf16 v[196:199], v[52:55], v[40:43], v[196:199]
    ds_read_b64_tr_b16 v[100:101], v28 offset:43520
    ds_read_b64_tr_b16 v[102:103], v28 offset:44544
    v_mfma_f32_16x16x32_bf16 v[228:231], v[52:55], v[44:47], v[228:231]
    buffer_load_dwordx4 v18, s[24:27], s36 offen offset:1024 lds
    v_mfma_f32_16x16x32_bf16 v[136:139], v[56:59], v[32:35], v[136:139]
    ds_read_b64_tr_b16 v[104:105], v29 offset:43520
    ds_read_b64_tr_b16 v[106:107], v29 offset:44544
    v_mfma_f32_16x16x32_bf16 v[168:171], v[56:59], v[36:39], v[168:171]
    v_accvgpr_read_b32 v10, a70
    v_accvgpr_read_b32 v11, a71
    v_mfma_f32_16x16x32_bf16 v[200:203], v[56:59], v[40:43], v[200:203]
    ds_read_b64_tr_b16 v[108:109], v30 offset:43520
    ds_read_b64_tr_b16 v[110:111], v30 offset:44544
    v_mfma_f32_16x16x32_bf16 v[232:235], v[56:59], v[44:47], v[232:235]
    buffer_store_dwordx4 v[0:3], v16, s[16:19], s38 offen offset:3072
    v_mfma_f32_16x16x32_bf16 v[140:143], v[60:63], v[32:35], v[140:143]
    s_add_u32 s38, s38, 16384
    ds_read_b64_tr_b16 v[112:113], v27 offset:43648
    ds_read_b64_tr_b16 v[114:115], v27 offset:44672
    v_mfma_f32_16x16x32_bf16 v[172:175], v[60:63], v[36:39], v[172:175]
    v_mul_f32 v8, s40, v8
    v_mul_f32 v9, s40, v9
    v_mfma_f32_16x16x32_bf16 v[204:207], v[60:63], v[40:43], v[204:207]
    ds_read_b64_tr_b16 v[116:117], v28 offset:43648
    ds_read_b64_tr_b16 v[118:119], v28 offset:44672
    v_mfma_f32_16x16x32_bf16 v[236:239], v[60:63], v[44:47], v[236:239]
    buffer_load_dwordx4 v19, s[24:27], s36 offen offset:2048 lds
    v_mfma_f32_16x16x32_bf16 v[144:147], v[64:67], v[32:35], v[144:147]
    ds_read_b64_tr_b16 v[120:121], v29 offset:43648
    ds_read_b64_tr_b16 v[122:123], v29 offset:44672
    v_mfma_f32_16x16x32_bf16 v[176:179], v[64:67], v[36:39], v[176:179]
    v_mul_f32 v10, s40, v10
    v_mul_f32 v11, s40, v11
    v_mfma_f32_16x16x32_bf16 v[208:211], v[64:67], v[40:43], v[208:211]
    ds_read_b64_tr_b16 v[124:125], v30 offset:43648
    ds_read_b64_tr_b16 v[126:127], v30 offset:44672
    v_mfma_f32_16x16x32_bf16 v[240:243], v[64:67], v[44:47], v[240:243]
    v_mul_f32 v12, s40, v12
    v_mul_f32 v13, s40, v13
    v_mfma_f32_16x16x32_bf16 v[148:151], v[68:71], v[32:35], v[148:151]
    v_mul_f32 v14, s40, v14
    v_mul_f32 v15, s40, v15
    v_mfma_f32_16x16x32_bf16 v[180:183], v[68:71], v[36:39], v[180:183]
    buffer_load_dwordx4 v20, s[24:27], s36 offen offset:3072 lds
    v_mfma_f32_16x16x32_bf16 v[212:215], v[68:71], v[40:43], v[212:215]
    s_add_u32 s37, s49, 2359296
    v_cvt_pk_bf16_f32 v8, v8, v9
    v_cvt_pk_bf16_f32 v9, v10, v11
    v_mfma_f32_16x16x32_bf16 v[244:247], v[68:71], v[44:47], v[244:247]
    s_add_u32 m0, s50, 26112
    v_cvt_pk_bf16_f32 v10, v12, v13
    v_cvt_pk_bf16_f32 v11, v14, v15
    v_mfma_f32_16x16x32_bf16 v[152:155], v[72:75], v[32:35], v[152:155]
    buffer_load_dwordx4 v21, s[20:23], s37 offen offset:0 lds
    v_mfma_f32_16x16x32_bf16 v[184:187], v[72:75], v[36:39], v[184:187]
    v_accvgpr_read_b32 v4, a140
    v_accvgpr_read_b32 v5, a141
    v_mfma_f32_16x16x32_bf16 v[216:219], v[72:75], v[40:43], v[216:219]
    v_accvgpr_read_b32 v6, a142
    v_accvgpr_read_b32 v7, a143
    v_mfma_f32_16x16x32_bf16 v[248:251], v[72:75], v[44:47], v[248:251]
    buffer_store_dwordx4 v[8:11], v16, s[16:19], s41 offen offset:1024
    v_mfma_f32_16x16x32_bf16 v[156:159], v[76:79], v[32:35], v[156:159]
    s_add_u32 s41, s41, 12288
    v_accvgpr_read_b32 v0, a136
    v_accvgpr_read_b32 v1, a137
    v_mfma_f32_16x16x32_bf16 v[188:191], v[76:79], v[36:39], v[188:191]
    v_accvgpr_read_b32 v2, a138
    v_accvgpr_read_b32 v3, a139
    v_mfma_f32_16x16x32_bf16 v[220:223], v[76:79], v[40:43], v[220:223]
    buffer_load_dwordx4 v22, s[20:23], s37 offen offset:1024 lds
    v_mfma_f32_16x16x32_bf16 v[252:255], v[76:79], v[44:47], v[252:255]
    s_waitcnt vmcnt(16) lgkmcnt(0)
    s_barrier
    v_cvt_pk_bf16_f32 v0, v0, v1
    v_cvt_pk_bf16_f32 v1, v2, v3
    v_mfma_f32_16x16x32_bf16 v[128:131], v[96:99], v[80:83], v[128:131]
    ds_read_b64_tr_b16 v[48:49], v27 offset:0
    ds_read_b64_tr_b16 v[50:51], v27 offset:1024
    v_mfma_f32_16x16x32_bf16 v[160:163], v[96:99], v[84:87], v[160:163]
    s_add_u32 s36, s44, 640
    v_cvt_pk_bf16_f32 v2, v4, v5
    v_cvt_pk_bf16_f32 v3, v6, v7
    v_mfma_f32_16x16x32_bf16 v[192:195], v[96:99], v[88:91], v[192:195]
    s_add_u32 m0, s42, 32768
    ds_read_b128 v[32:35], v25 offset:0
    ds_read_b128 v[36:39], v25 offset:2048
    v_mfma_f32_16x16x32_bf16 v[224:227], v[96:99], v[92:95], v[224:227]
    buffer_load_dwordx4 v17, s[24:27], s36 offen offset:0 lds
    v_mfma_f32_16x16x32_bf16 v[132:135], v[100:103], v[80:83], v[132:135]
    ds_read_b128 v[40:43], v25 offset:4096
    ds_read_b128 v[44:47], v25 offset:6144
    v_mfma_f32_16x16x32_bf16 v[164:167], v[100:103], v[84:87], v[164:167]
    v_accvgpr_read_b32 v12, a40
    v_accvgpr_read_b32 v13, a41
    v_mfma_f32_16x16x32_bf16 v[196:199], v[100:103], v[88:91], v[196:199]
    ds_read_b64_tr_b16 v[52:53], v28 offset:0
    ds_read_b64_tr_b16 v[54:55], v28 offset:1024
    v_mfma_f32_16x16x32_bf16 v[228:231], v[100:103], v[92:95], v[228:231]
    buffer_load_dwordx4 v18, s[24:27], s36 offen offset:1024 lds
    v_mfma_f32_16x16x32_bf16 v[136:139], v[104:107], v[80:83], v[136:139]
    ds_read_b64_tr_b16 v[56:57], v29 offset:0
    ds_read_b64_tr_b16 v[58:59], v29 offset:1024
    v_mfma_f32_16x16x32_bf16 v[168:171], v[104:107], v[84:87], v[168:171]
    v_accvgpr_read_b32 v14, a42
    v_accvgpr_read_b32 v15, a43
    v_mfma_f32_16x16x32_bf16 v[200:203], v[104:107], v[88:91], v[200:203]
    ds_read_b64_tr_b16 v[60:61], v30 offset:0
    ds_read_b64_tr_b16 v[62:63], v30 offset:1024
    v_mfma_f32_16x16x32_bf16 v[232:235], v[104:107], v[92:95], v[232:235]
    buffer_store_dwordx4 v[0:3], v16, s[16:19], s38 offen offset:0
    v_mfma_f32_16x16x32_bf16 v[140:143], v[108:111], v[80:83], v[140:143]
    ds_read_b64_tr_b16 v[64:65], v27 offset:128
    ds_read_b64_tr_b16 v[66:67], v27 offset:1152
    v_mfma_f32_16x16x32_bf16 v[172:175], v[108:111], v[84:87], v[172:175]
    v_accvgpr_read_b32 v8, a8
    v_accvgpr_read_b32 v9, a9
    v_mfma_f32_16x16x32_bf16 v[204:207], v[108:111], v[88:91], v[204:207]
    ds_read_b64_tr_b16 v[68:69], v28 offset:128
    ds_read_b64_tr_b16 v[70:71], v28 offset:1152
    v_mfma_f32_16x16x32_bf16 v[236:239], v[108:111], v[92:95], v[236:239]
    buffer_load_dwordx4 v19, s[24:27], s36 offen offset:2048 lds
    v_mfma_f32_16x16x32_bf16 v[144:147], v[112:115], v[80:83], v[144:147]
    ds_read_b64_tr_b16 v[72:73], v29 offset:128
    ds_read_b64_tr_b16 v[74:75], v29 offset:1152
    v_mfma_f32_16x16x32_bf16 v[176:179], v[112:115], v[84:87], v[176:179]
    v_accvgpr_read_b32 v10, a10
    v_accvgpr_read_b32 v11, a11
    v_mfma_f32_16x16x32_bf16 v[208:211], v[112:115], v[88:91], v[208:211]
    ds_read_b64_tr_b16 v[76:77], v30 offset:128
    ds_read_b64_tr_b16 v[78:79], v30 offset:1152
    v_mfma_f32_16x16x32_bf16 v[240:243], v[112:115], v[92:95], v[240:243]
    v_mul_f32 v8, s40, v8
    v_mul_f32 v9, s40, v9
    v_mfma_f32_16x16x32_bf16 v[148:151], v[116:119], v[80:83], v[148:151]
    v_mul_f32 v10, s40, v10
    v_mul_f32 v11, s40, v11
    v_mfma_f32_16x16x32_bf16 v[180:183], v[116:119], v[84:87], v[180:183]
    buffer_load_dwordx4 v20, s[24:27], s36 offen offset:3072 lds
    v_mfma_f32_16x16x32_bf16 v[212:215], v[116:119], v[88:91], v[212:215]
    s_add_u32 s37, s49, 2621440
    v_mul_f32 v12, s40, v12
    v_mul_f32 v13, s40, v13
    v_mfma_f32_16x16x32_bf16 v[244:247], v[116:119], v[92:95], v[244:247]
    s_add_u32 m0, s50, 34816
    v_mul_f32 v14, s40, v14
    v_mul_f32 v15, s40, v15
    v_mfma_f32_16x16x32_bf16 v[152:155], v[120:123], v[80:83], v[152:155]
    buffer_load_dwordx4 v21, s[20:23], s37 offen offset:0 lds
    v_mfma_f32_16x16x32_bf16 v[184:187], v[120:123], v[84:87], v[184:187]
    v_cvt_pk_bf16_f32 v8, v8, v9
    v_cvt_pk_bf16_f32 v9, v10, v11
    v_mfma_f32_16x16x32_bf16 v[216:219], v[120:123], v[88:91], v[216:219]
    v_cvt_pk_bf16_f32 v10, v12, v13
    v_cvt_pk_bf16_f32 v11, v14, v15
    v_mfma_f32_16x16x32_bf16 v[248:251], v[120:123], v[92:95], v[248:251]
    buffer_store_dwordx4 v[8:11], v16, s[16:19], s41 offen offset:0
    v_mfma_f32_16x16x32_bf16 v[156:159], v[124:127], v[80:83], v[156:159]
    v_accvgpr_read_b32 v4, a172
    v_accvgpr_read_b32 v5, a173
    v_mfma_f32_16x16x32_bf16 v[188:191], v[124:127], v[84:87], v[188:191]
    v_accvgpr_read_b32 v6, a174
    v_accvgpr_read_b32 v7, a175
    v_mfma_f32_16x16x32_bf16 v[220:223], v[124:127], v[88:91], v[220:223]
    buffer_load_dwordx4 v22, s[20:23], s37 offen offset:1024 lds
    v_mfma_f32_16x16x32_bf16 v[252:255], v[124:127], v[92:95], v[252:255]
    s_waitcnt lgkmcnt(0)
    v_accvgpr_read_b32 v0, a168
    v_accvgpr_read_b32 v1, a169
    v_mfma_f32_16x16x32_bf16 v[128:131], v[48:51], v[32:35], v[128:131]
    ds_read_b64_tr_b16 v[96:97], v27 offset:8704
    ds_read_b64_tr_b16 v[98:99], v27 offset:9728
    v_mfma_f32_16x16x32_bf16 v[160:163], v[48:51], v[36:39], v[160:163]
    s_add_u32 s36, s45, 640
    v_accvgpr_read_b32 v2, a170
    v_accvgpr_read_b32 v3, a171
    v_mfma_f32_16x16x32_bf16 v[192:195], v[48:51], v[40:43], v[192:195]
    s_add_u32 m0, s42, 36864
    ds_read_b128 v[80:83], v26 offset:0
    ds_read_b128 v[84:87], v26 offset:2048
    v_mfma_f32_16x16x32_bf16 v[224:227], v[48:51], v[44:47], v[224:227]
    buffer_load_dwordx4 v17, s[24:27], s36 offen offset:0 lds
    v_mfma_f32_16x16x32_bf16 v[132:135], v[52:55], v[32:35], v[132:135]
    ds_read_b128 v[88:91], v26 offset:4096
    ds_read_b128 v[92:95], v26 offset:6144
    v_mfma_f32_16x16x32_bf16 v[164:167], v[52:55], v[36:39], v[164:167]
    v_cvt_pk_bf16_f32 v0, v0, v1
    v_cvt_pk_bf16_f32 v1, v2, v3
    v_mfma_f32_16x16x32_bf16 v[196:199], v[52:55], v[40:43], v[196:199]
gated_mix__ssm_conv_h3__compressed_kv_cla__prompt_kernel_pad4:
    s_cbranch_execz gated_mix__ssm_conv_h3__compressed_kv_cla__prompt_kernel_pad12
    ds_read_b64_tr_b16 v[100:101], v28 offset:8704
    ds_read_b64_tr_b16 v[102:103], v28 offset:9728
    v_mfma_f32_16x16x32_bf16 v[228:231], v[52:55], v[44:47], v[228:231]
    buffer_load_dwordx4 v18, s[24:27], s36 offen offset:1024 lds
    v_mfma_f32_16x16x32_bf16 v[136:139], v[56:59], v[32:35], v[136:139]
    ds_read_b64_tr_b16 v[104:105], v29 offset:8704
    ds_read_b64_tr_b16 v[106:107], v29 offset:9728
    v_mfma_f32_16x16x32_bf16 v[168:171], v[56:59], v[36:39], v[168:171]
    v_cvt_pk_bf16_f32 v2, v4, v5
    v_cvt_pk_bf16_f32 v3, v6, v7
    v_mfma_f32_16x16x32_bf16 v[200:203], v[56:59], v[40:43], v[200:203]
    ds_read_b64_tr_b16 v[108:109], v30 offset:8704
    ds_read_b64_tr_b16 v[110:111], v30 offset:9728
    v_mfma_f32_16x16x32_bf16 v[232:235], v[56:59], v[44:47], v[232:235]
    buffer_store_dwordx4 v[0:3], v16, s[16:19], s38 offen offset:1024
    v_mfma_f32_16x16x32_bf16 v[140:143], v[60:63], v[32:35], v[140:143]
    ds_read_b64_tr_b16 v[112:113], v27 offset:8832
    ds_read_b64_tr_b16 v[114:115], v27 offset:9856
    v_mfma_f32_16x16x32_bf16 v[172:175], v[60:63], v[36:39], v[172:175]
    v_accvgpr_read_b32 v12, a104
    v_accvgpr_read_b32 v13, a105
    v_mfma_f32_16x16x32_bf16 v[204:207], v[60:63], v[40:43], v[204:207]
    ds_read_b64_tr_b16 v[116:117], v28 offset:8832
    ds_read_b64_tr_b16 v[118:119], v28 offset:9856
    v_mfma_f32_16x16x32_bf16 v[236:239], v[60:63], v[44:47], v[236:239]
    buffer_load_dwordx4 v19, s[24:27], s36 offen offset:2048 lds
    v_mfma_f32_16x16x32_bf16 v[144:147], v[64:67], v[32:35], v[144:147]
    ds_read_b64_tr_b16 v[120:121], v29 offset:8832
    ds_read_b64_tr_b16 v[122:123], v29 offset:9856
    v_mfma_f32_16x16x32_bf16 v[176:179], v[64:67], v[36:39], v[176:179]
    v_accvgpr_read_b32 v14, a106
    v_accvgpr_read_b32 v15, a107
    v_mfma_f32_16x16x32_bf16 v[208:211], v[64:67], v[40:43], v[208:211]
    ds_read_b64_tr_b16 v[124:125], v30 offset:8832
    ds_read_b64_tr_b16 v[126:127], v30 offset:9856
    v_mfma_f32_16x16x32_bf16 v[240:243], v[64:67], v[44:47], v[240:243]
    v_accvgpr_read_b32 v8, a72
    v_accvgpr_read_b32 v9, a73
    v_mfma_f32_16x16x32_bf16 v[148:151], v[68:71], v[32:35], v[148:151]
    v_accvgpr_read_b32 v10, a74
    v_accvgpr_read_b32 v11, a75
    v_mfma_f32_16x16x32_bf16 v[180:183], v[68:71], v[36:39], v[180:183]
    buffer_load_dwordx4 v20, s[24:27], s36 offen offset:3072 lds
    v_mfma_f32_16x16x32_bf16 v[212:215], v[68:71], v[40:43], v[212:215]
    s_add_u32 s37, s49, 2883584
    v_mul_f32 v8, s40, v8
    v_mul_f32 v9, s40, v9
    v_mfma_f32_16x16x32_bf16 v[244:247], v[68:71], v[44:47], v[244:247]
    s_add_u32 m0, s50, 43520
    v_mul_f32 v10, s40, v10
    v_mul_f32 v11, s40, v11
    v_mfma_f32_16x16x32_bf16 v[152:155], v[72:75], v[32:35], v[152:155]
    buffer_load_dwordx4 v21, s[20:23], s37 offen offset:0 lds
    v_mfma_f32_16x16x32_bf16 v[184:187], v[72:75], v[36:39], v[184:187]
    v_mul_f32 v12, s40, v12
    v_mul_f32 v13, s40, v13
    v_mfma_f32_16x16x32_bf16 v[216:219], v[72:75], v[40:43], v[216:219]
    v_mul_f32 v14, s40, v14
    v_mul_f32 v15, s40, v15
    v_mfma_f32_16x16x32_bf16 v[248:251], v[72:75], v[44:47], v[248:251]
    v_mfma_f32_16x16x32_bf16 v[156:159], v[76:79], v[32:35], v[156:159]
    v_cvt_pk_bf16_f32 v8, v8, v9
    v_cvt_pk_bf16_f32 v9, v10, v11
    v_mfma_f32_16x16x32_bf16 v[188:191], v[76:79], v[36:39], v[188:191]
    v_cvt_pk_bf16_f32 v10, v12, v13
    v_cvt_pk_bf16_f32 v11, v14, v15
    v_mfma_f32_16x16x32_bf16 v[220:223], v[76:79], v[40:43], v[220:223]
    buffer_load_dwordx4 v22, s[20:23], s37 offen offset:1024 lds
    v_mfma_f32_16x16x32_bf16 v[252:255], v[76:79], v[44:47], v[252:255]
    s_waitcnt vmcnt(15) lgkmcnt(0)
    s_barrier
    v_accvgpr_read_b32 v4, a204
    v_accvgpr_read_b32 v5, a205
    v_mfma_f32_16x16x32_bf16 v[128:131], v[96:99], v[80:83], v[128:131]
    ds_read_b64_tr_b16 v[48:49], v27 offset:17408
    ds_read_b64_tr_b16 v[50:51], v27 offset:18432
    v_mfma_f32_16x16x32_bf16 v[160:163], v[96:99], v[84:87], v[160:163]
    s_add_u32 s36, s44, 768
    v_accvgpr_read_b32 v6, a206
    v_accvgpr_read_b32 v7, a207
    v_mfma_f32_16x16x32_bf16 v[192:195], v[96:99], v[88:91], v[192:195]
    s_add_u32 m0, s42, 65536
    ds_read_b128 v[32:35], v23 offset:0
    ds_read_b128 v[36:39], v23 offset:2048
    v_mfma_f32_16x16x32_bf16 v[224:227], v[96:99], v[92:95], v[224:227]
    buffer_load_dwordx4 v17, s[24:27], s36 offen offset:0 lds
    v_mfma_f32_16x16x32_bf16 v[132:135], v[100:103], v[80:83], v[132:135]
    ds_read_b128 v[40:43], v23 offset:4096
    ds_read_b128 v[44:47], v23 offset:6144
    v_mfma_f32_16x16x32_bf16 v[164:167], v[100:103], v[84:87], v[164:167]
    v_accvgpr_read_b32 v0, a200
    v_accvgpr_read_b32 v1, a201
    v_mfma_f32_16x16x32_bf16 v[196:199], v[100:103], v[88:91], v[196:199]
    ds_read_b64_tr_b16 v[52:53], v28 offset:17408
    ds_read_b64_tr_b16 v[54:55], v28 offset:18432
    v_mfma_f32_16x16x32_bf16 v[228:231], v[100:103], v[92:95], v[228:231]
    buffer_load_dwordx4 v18, s[24:27], s36 offen offset:1024 lds
    v_mfma_f32_16x16x32_bf16 v[136:139], v[104:107], v[80:83], v[136:139]
    ds_read_b64_tr_b16 v[56:57], v29 offset:17408
    ds_read_b64_tr_b16 v[58:59], v29 offset:18432
    v_mfma_f32_16x16x32_bf16 v[168:171], v[104:107], v[84:87], v[168:171]
    v_accvgpr_read_b32 v2, a202
    v_accvgpr_read_b32 v3, a203
    v_mfma_f32_16x16x32_bf16 v[200:203], v[104:107], v[88:91], v[200:203]
    ds_read_b64_tr_b16 v[60:61], v30 offset:17408
    ds_read_b64_tr_b16 v[62:63], v30 offset:18432
    v_mfma_f32_16x16x32_bf16 v[232:235], v[104:107], v[92:95], v[232:235]
    buffer_store_dwordx4 v[8:11], v16, s[16:19], s41 offen offset:1024
    v_mfma_f32_16x16x32_bf16 v[140:143], v[108:111], v[80:83], v[140:143]
    s_add_u32 s41, s41, 4096
    ds_read_b64_tr_b16 v[64:65], v27 offset:17536
    ds_read_b64_tr_b16 v[66:67], v27 offset:18560
    v_mfma_f32_16x16x32_bf16 v[172:175], v[108:111], v[84:87], v[172:175]
    v_cvt_pk_bf16_f32 v0, v0, v1
    v_cvt_pk_bf16_f32 v1, v2, v3
    v_mfma_f32_16x16x32_bf16 v[204:207], v[108:111], v[88:91], v[204:207]
    ds_read_b64_tr_b16 v[68:69], v28 offset:17536
    ds_read_b64_tr_b16 v[70:71], v28 offset:18560
    v_mfma_f32_16x16x32_bf16 v[236:239], v[108:111], v[92:95], v[236:239]
    buffer_load_dwordx4 v19, s[24:27], s36 offen offset:2048 lds
    v_mfma_f32_16x16x32_bf16 v[144:147], v[112:115], v[80:83], v[144:147]
    ds_read_b64_tr_b16 v[72:73], v29 offset:17536
    ds_read_b64_tr_b16 v[74:75], v29 offset:18560
    v_mfma_f32_16x16x32_bf16 v[176:179], v[112:115], v[84:87], v[176:179]
    v_cvt_pk_bf16_f32 v2, v4, v5
    v_cvt_pk_bf16_f32 v3, v6, v7
    v_mfma_f32_16x16x32_bf16 v[208:211], v[112:115], v[88:91], v[208:211]
    ds_read_b64_tr_b16 v[76:77], v30 offset:17536
    ds_read_b64_tr_b16 v[78:79], v30 offset:18560
    v_mfma_f32_16x16x32_bf16 v[240:243], v[112:115], v[92:95], v[240:243]
    v_accvgpr_read_b32 v12, a44
    v_accvgpr_read_b32 v13, a45
    v_mfma_f32_16x16x32_bf16 v[148:151], v[116:119], v[80:83], v[148:151]
    v_accvgpr_read_b32 v14, a46
    v_accvgpr_read_b32 v15, a47
    v_mfma_f32_16x16x32_bf16 v[180:183], v[116:119], v[84:87], v[180:183]
    buffer_load_dwordx4 v20, s[24:27], s36 offen offset:3072 lds
    v_mfma_f32_16x16x32_bf16 v[212:215], v[116:119], v[88:91], v[212:215]
    s_add_u32 s37, s49, 3145728
    v_accvgpr_read_b32 v8, a12
    v_accvgpr_read_b32 v9, a13
    v_mfma_f32_16x16x32_bf16 v[244:247], v[116:119], v[92:95], v[244:247]
    s_add_u32 m0, s50, 0
    v_accvgpr_read_b32 v10, a14
    v_accvgpr_read_b32 v11, a15
    v_mfma_f32_16x16x32_bf16 v[152:155], v[120:123], v[80:83], v[152:155]
    buffer_load_dwordx4 v21, s[20:23], s37 offen offset:0 lds
    v_mfma_f32_16x16x32_bf16 v[184:187], v[120:123], v[84:87], v[184:187]
    v_mul_f32 v8, s40, v8
    v_mul_f32 v9, s40, v9
    v_mfma_f32_16x16x32_bf16 v[216:219], v[120:123], v[88:91], v[216:219]
    v_mul_f32 v10, s40, v10
    v_mul_f32 v11, s40, v11
    v_mfma_f32_16x16x32_bf16 v[248:251], v[120:123], v[92:95], v[248:251]
    buffer_store_dwordx4 v[0:3], v16, s[16:19], s38 offen offset:2048
    v_mfma_f32_16x16x32_bf16 v[156:159], v[124:127], v[80:83], v[156:159]
    v_mul_f32 v12, s40, v12
    v_mul_f32 v13, s40, v13
    v_mfma_f32_16x16x32_bf16 v[188:191], v[124:127], v[84:87], v[188:191]
    v_mul_f32 v14, s40, v14
    v_mul_f32 v15, s40, v15
    v_mfma_f32_16x16x32_bf16 v[220:223], v[124:127], v[88:91], v[220:223]
    buffer_load_dwordx4 v22, s[20:23], s37 offen offset:1024 lds
    v_mfma_f32_16x16x32_bf16 v[252:255], v[124:127], v[92:95], v[252:255]
    s_waitcnt lgkmcnt(0)
    v_cvt_pk_bf16_f32 v8, v8, v9
    v_cvt_pk_bf16_f32 v9, v10, v11
    v_mfma_f32_16x16x32_bf16 v[128:131], v[48:51], v[32:35], v[128:131]
    ds_read_b64_tr_b16 v[96:97], v27 offset:26112
    ds_read_b64_tr_b16 v[98:99], v27 offset:27136
    v_mfma_f32_16x16x32_bf16 v[160:163], v[48:51], v[36:39], v[160:163]
    s_add_u32 s36, s45, 768
    v_cvt_pk_bf16_f32 v10, v12, v13
    v_cvt_pk_bf16_f32 v11, v14, v15
    v_mfma_f32_16x16x32_bf16 v[192:195], v[48:51], v[40:43], v[192:195]
    s_add_u32 m0, s42, 69632
    ds_read_b128 v[80:83], v24 offset:0
    ds_read_b128 v[84:87], v24 offset:2048
    v_mfma_f32_16x16x32_bf16 v[224:227], v[48:51], v[44:47], v[224:227]
    buffer_load_dwordx4 v17, s[24:27], s36 offen offset:0 lds
    v_mfma_f32_16x16x32_bf16 v[132:135], v[52:55], v[32:35], v[132:135]
    ds_read_b128 v[88:91], v24 offset:4096
    ds_read_b128 v[92:95], v24 offset:6144
    v_mfma_f32_16x16x32_bf16 v[164:167], v[52:55], v[36:39], v[164:167]
    v_accvgpr_read_b32 v4, a236
    v_accvgpr_read_b32 v5, a237
    v_mfma_f32_16x16x32_bf16 v[196:199], v[52:55], v[40:43], v[196:199]
    ds_read_b64_tr_b16 v[100:101], v28 offset:26112
    ds_read_b64_tr_b16 v[102:103], v28 offset:27136
    v_mfma_f32_16x16x32_bf16 v[228:231], v[52:55], v[44:47], v[228:231]
    buffer_load_dwordx4 v18, s[24:27], s36 offen offset:1024 lds
    v_mfma_f32_16x16x32_bf16 v[136:139], v[56:59], v[32:35], v[136:139]
    ds_read_b64_tr_b16 v[104:105], v29 offset:26112
    ds_read_b64_tr_b16 v[106:107], v29 offset:27136
    v_mfma_f32_16x16x32_bf16 v[168:171], v[56:59], v[36:39], v[168:171]
    v_accvgpr_read_b32 v6, a238
    v_accvgpr_read_b32 v7, a239
    v_mfma_f32_16x16x32_bf16 v[200:203], v[56:59], v[40:43], v[200:203]
    ds_read_b64_tr_b16 v[108:109], v30 offset:26112
    ds_read_b64_tr_b16 v[110:111], v30 offset:27136
    v_mfma_f32_16x16x32_bf16 v[232:235], v[56:59], v[44:47], v[232:235]
    buffer_store_dwordx4 v[8:11], v16, s[16:19], s41 offen offset:0
    v_mfma_f32_16x16x32_bf16 v[140:143], v[60:63], v[32:35], v[140:143]
    ds_read_b64_tr_b16 v[112:113], v27 offset:26240
    ds_read_b64_tr_b16 v[114:115], v27 offset:27264
    v_mfma_f32_16x16x32_bf16 v[172:175], v[60:63], v[36:39], v[172:175]
    v_accvgpr_read_b32 v0, a232
    v_accvgpr_read_b32 v1, a233
    v_mfma_f32_16x16x32_bf16 v[204:207], v[60:63], v[40:43], v[204:207]
    ds_read_b64_tr_b16 v[116:117], v28 offset:26240
    ds_read_b64_tr_b16 v[118:119], v28 offset:27264
    v_mfma_f32_16x16x32_bf16 v[236:239], v[60:63], v[44:47], v[236:239]
    buffer_load_dwordx4 v19, s[24:27], s36 offen offset:2048 lds
    v_mfma_f32_16x16x32_bf16 v[144:147], v[64:67], v[32:35], v[144:147]
    ds_read_b64_tr_b16 v[120:121], v29 offset:26240
    ds_read_b64_tr_b16 v[122:123], v29 offset:27264
    v_mfma_f32_16x16x32_bf16 v[176:179], v[64:67], v[36:39], v[176:179]
    v_accvgpr_read_b32 v2, a234
    v_accvgpr_read_b32 v3, a235
    v_mfma_f32_16x16x32_bf16 v[208:211], v[64:67], v[40:43], v[208:211]
    ds_read_b64_tr_b16 v[124:125], v30 offset:26240
    ds_read_b64_tr_b16 v[126:127], v30 offset:27264
    v_mfma_f32_16x16x32_bf16 v[240:243], v[64:67], v[44:47], v[240:243]
    v_cvt_pk_bf16_f32 v0, v0, v1
    v_cvt_pk_bf16_f32 v1, v2, v3
    v_mfma_f32_16x16x32_bf16 v[148:151], v[68:71], v[32:35], v[148:151]
    v_cvt_pk_bf16_f32 v2, v4, v5
    v_cvt_pk_bf16_f32 v3, v6, v7
    v_mfma_f32_16x16x32_bf16 v[180:183], v[68:71], v[36:39], v[180:183]
    buffer_load_dwordx4 v20, s[24:27], s36 offen offset:3072 lds
    v_mfma_f32_16x16x32_bf16 v[212:215], v[68:71], v[40:43], v[212:215]
    s_add_u32 s37, s49, 3407872
    v_accvgpr_read_b32 v12, a108
    v_accvgpr_read_b32 v13, a109
    v_mfma_f32_16x16x32_bf16 v[244:247], v[68:71], v[44:47], v[244:247]
    s_add_u32 m0, s50, 8704
    v_accvgpr_read_b32 v14, a110
    v_accvgpr_read_b32 v15, a111
    v_mfma_f32_16x16x32_bf16 v[152:155], v[72:75], v[32:35], v[152:155]
    buffer_load_dwordx4 v21, s[20:23], s37 offen offset:0 lds
    v_mfma_f32_16x16x32_bf16 v[184:187], v[72:75], v[36:39], v[184:187]
    v_accvgpr_read_b32 v8, a76
    v_accvgpr_read_b32 v9, a77
    v_mfma_f32_16x16x32_bf16 v[216:219], v[72:75], v[40:43], v[216:219]
    v_accvgpr_read_b32 v10, a78
    v_accvgpr_read_b32 v11, a79
    v_mfma_f32_16x16x32_bf16 v[248:251], v[72:75], v[44:47], v[248:251]
    buffer_store_dwordx4 v[0:3], v16, s[16:19], s38 offen offset:3072
    v_mfma_f32_16x16x32_bf16 v[156:159], v[76:79], v[32:35], v[156:159]
    s_add_u32 s38, s38, 16384
    v_mul_f32 v8, s40, v8
    v_mul_f32 v9, s40, v9
    v_mfma_f32_16x16x32_bf16 v[188:191], v[76:79], v[36:39], v[188:191]
    v_mul_f32 v10, s40, v10
    v_mul_f32 v11, s40, v11
    v_mfma_f32_16x16x32_bf16 v[220:223], v[76:79], v[40:43], v[220:223]
    buffer_load_dwordx4 v22, s[20:23], s37 offen offset:1024 lds
    v_mfma_f32_16x16x32_bf16 v[252:255], v[76:79], v[44:47], v[252:255]
    s_waitcnt vmcnt(16) lgkmcnt(0)
    s_barrier
    v_mul_f32 v12, s40, v12
    v_mul_f32 v13, s40, v13
    v_mfma_f32_16x16x32_bf16 v[128:131], v[96:99], v[80:83], v[128:131]
    ds_read_b64_tr_b16 v[48:49], v27 offset:34816
    ds_read_b64_tr_b16 v[50:51], v27 offset:35840
    v_mfma_f32_16x16x32_bf16 v[160:163], v[96:99], v[84:87], v[160:163]
    s_add_u32 s36, s44, 896
    v_mul_f32 v14, s40, v14
    v_mul_f32 v15, s40, v15
    v_mfma_f32_16x16x32_bf16 v[192:195], v[96:99], v[88:91], v[192:195]
    s_add_u32 m0, s42, 0
    ds_read_b128 v[32:35], v23 offset:32768
    ds_read_b128 v[36:39], v23 offset:34816
    v_mfma_f32_16x16x32_bf16 v[224:227], v[96:99], v[92:95], v[224:227]
    buffer_load_dwordx4 v17, s[24:27], s36 offen offset:0 lds
    v_mfma_f32_16x16x32_bf16 v[132:135], v[100:103], v[80:83], v[132:135]
    ds_read_b128 v[40:43], v23 offset:36864
    ds_read_b128 v[44:47], v23 offset:38912
    v_mfma_f32_16x16x32_bf16 v[164:167], v[100:103], v[84:87], v[164:167]
    v_cvt_pk_bf16_f32 v8, v8, v9
    v_cvt_pk_bf16_f32 v9, v10, v11
    v_mfma_f32_16x16x32_bf16 v[196:199], v[100:103], v[88:91], v[196:199]
    ds_read_b64_tr_b16 v[52:53], v28 offset:34816
    ds_read_b64_tr_b16 v[54:55], v28 offset:35840
    v_mfma_f32_16x16x32_bf16 v[228:231], v[100:103], v[92:95], v[228:231]
    buffer_load_dwordx4 v18, s[24:27], s36 offen offset:1024 lds
    v_mfma_f32_16x16x32_bf16 v[136:139], v[104:107], v[80:83], v[136:139]
    ds_read_b64_tr_b16 v[56:57], v29 offset:34816
    ds_read_b64_tr_b16 v[58:59], v29 offset:35840
    v_mfma_f32_16x16x32_bf16 v[168:171], v[104:107], v[84:87], v[168:171]
    v_cvt_pk_bf16_f32 v10, v12, v13
    v_cvt_pk_bf16_f32 v11, v14, v15
    v_mfma_f32_16x16x32_bf16 v[200:203], v[104:107], v[88:91], v[200:203]
    ds_read_b64_tr_b16 v[60:61], v30 offset:34816
    ds_read_b64_tr_b16 v[62:63], v30 offset:35840
    v_mfma_f32_16x16x32_bf16 v[232:235], v[104:107], v[92:95], v[232:235]
    buffer_store_dwordx4 v[8:11], v16, s[16:19], s41 offen offset:1024
    v_mfma_f32_16x16x32_bf16 v[140:143], v[108:111], v[80:83], v[140:143]
    s_add_u32 s41, s41, 12288
    ds_read_b64_tr_b16 v[64:65], v27 offset:34944
    ds_read_b64_tr_b16 v[66:67], v27 offset:35968
    v_mfma_f32_16x16x32_bf16 v[172:175], v[108:111], v[84:87], v[172:175]
    v_accvgpr_read_b32 v4, a148
    v_accvgpr_read_b32 v5, a149
    v_mfma_f32_16x16x32_bf16 v[204:207], v[108:111], v[88:91], v[204:207]
    ds_read_b64_tr_b16 v[68:69], v28 offset:34944
    ds_read_b64_tr_b16 v[70:71], v28 offset:35968
    v_mfma_f32_16x16x32_bf16 v[236:239], v[108:111], v[92:95], v[236:239]
    buffer_load_dwordx4 v19, s[24:27], s36 offen offset:2048 lds
    v_mfma_f32_16x16x32_bf16 v[144:147], v[112:115], v[80:83], v[144:147]
    ds_read_b64_tr_b16 v[72:73], v29 offset:34944
    ds_read_b64_tr_b16 v[74:75], v29 offset:35968
    v_mfma_f32_16x16x32_bf16 v[176:179], v[112:115], v[84:87], v[176:179]
    v_accvgpr_read_b32 v6, a150
    v_accvgpr_read_b32 v7, a151
    v_mfma_f32_16x16x32_bf16 v[208:211], v[112:115], v[88:91], v[208:211]
    ds_read_b64_tr_b16 v[76:77], v30 offset:34944
    ds_read_b64_tr_b16 v[78:79], v30 offset:35968
    v_mfma_f32_16x16x32_bf16 v[240:243], v[112:115], v[92:95], v[240:243]
    v_accvgpr_read_b32 v0, a144
    v_accvgpr_read_b32 v1, a145
    v_mfma_f32_16x16x32_bf16 v[148:151], v[116:119], v[80:83], v[148:151]
    v_accvgpr_read_b32 v2, a146
    v_accvgpr_read_b32 v3, a147
    v_mfma_f32_16x16x32_bf16 v[180:183], v[116:119], v[84:87], v[180:183]
    buffer_load_dwordx4 v20, s[24:27], s36 offen offset:3072 lds
    v_mfma_f32_16x16x32_bf16 v[212:215], v[116:119], v[88:91], v[212:215]
    s_add_u32 s37, s49, 3670016
    v_cvt_pk_bf16_f32 v0, v0, v1
    v_cvt_pk_bf16_f32 v1, v2, v3
    v_mfma_f32_16x16x32_bf16 v[244:247], v[116:119], v[92:95], v[244:247]
    s_add_u32 m0, s50, 17408
    v_cvt_pk_bf16_f32 v2, v4, v5
    v_cvt_pk_bf16_f32 v3, v6, v7
    v_mfma_f32_16x16x32_bf16 v[152:155], v[120:123], v[80:83], v[152:155]
    buffer_load_dwordx4 v21, s[20:23], s37 offen offset:0 lds
    v_mfma_f32_16x16x32_bf16 v[184:187], v[120:123], v[84:87], v[184:187]
    v_accvgpr_read_b32 v12, a48
    v_accvgpr_read_b32 v13, a49
    v_mfma_f32_16x16x32_bf16 v[216:219], v[120:123], v[88:91], v[216:219]
    v_accvgpr_read_b32 v14, a50
    v_accvgpr_read_b32 v15, a51
    v_mfma_f32_16x16x32_bf16 v[248:251], v[120:123], v[92:95], v[248:251]
    buffer_store_dwordx4 v[0:3], v16, s[16:19], s38 offen offset:0
    v_mfma_f32_16x16x32_bf16 v[156:159], v[124:127], v[80:83], v[156:159]
    v_accvgpr_read_b32 v8, a16
    v_accvgpr_read_b32 v9, a17
    v_mfma_f32_16x16x32_bf16 v[188:191], v[124:127], v[84:87], v[188:191]
    v_accvgpr_read_b32 v10, a18
    v_accvgpr_read_b32 v11, a19
    v_mfma_f32_16x16x32_bf16 v[220:223], v[124:127], v[88:91], v[220:223]
    buffer_load_dwordx4 v22, s[20:23], s37 offen offset:1024 lds
    v_mfma_f32_16x16x32_bf16 v[252:255], v[124:127], v[92:95], v[252:255]
    s_waitcnt lgkmcnt(0)
    v_mul_f32 v8, s40, v8
    v_mul_f32 v9, s40, v9
    v_mfma_f32_16x16x32_bf16 v[128:131], v[48:51], v[32:35], v[128:131]
    ds_read_b64_tr_b16 v[96:97], v27 offset:43520
    ds_read_b64_tr_b16 v[98:99], v27 offset:44544
    v_mfma_f32_16x16x32_bf16 v[160:163], v[48:51], v[36:39], v[160:163]
    s_add_u32 s36, s45, 896
    v_mul_f32 v10, s40, v10
    v_mul_f32 v11, s40, v11
    v_mfma_f32_16x16x32_bf16 v[192:195], v[48:51], v[40:43], v[192:195]
    s_add_u32 m0, s42, 4096
    ds_read_b128 v[80:83], v24 offset:32768
    ds_read_b128 v[84:87], v24 offset:34816
    v_mfma_f32_16x16x32_bf16 v[224:227], v[48:51], v[44:47], v[224:227]
    buffer_load_dwordx4 v17, s[24:27], s36 offen offset:0 lds
    v_mfma_f32_16x16x32_bf16 v[132:135], v[52:55], v[32:35], v[132:135]
    ds_read_b128 v[88:91], v24 offset:36864
    ds_read_b128 v[92:95], v24 offset:38912
    v_mfma_f32_16x16x32_bf16 v[164:167], v[52:55], v[36:39], v[164:167]
    v_mul_f32 v12, s40, v12
    v_mul_f32 v13, s40, v13
    v_mfma_f32_16x16x32_bf16 v[196:199], v[52:55], v[40:43], v[196:199]
    ds_read_b64_tr_b16 v[100:101], v28 offset:43520
    ds_read_b64_tr_b16 v[102:103], v28 offset:44544
    v_mfma_f32_16x16x32_bf16 v[228:231], v[52:55], v[44:47], v[228:231]
    buffer_load_dwordx4 v18, s[24:27], s36 offen offset:1024 lds
    v_mfma_f32_16x16x32_bf16 v[136:139], v[56:59], v[32:35], v[136:139]
    ds_read_b64_tr_b16 v[104:105], v29 offset:43520
    ds_read_b64_tr_b16 v[106:107], v29 offset:44544
    v_mfma_f32_16x16x32_bf16 v[168:171], v[56:59], v[36:39], v[168:171]
    v_mul_f32 v14, s40, v14
    v_mul_f32 v15, s40, v15
    v_mfma_f32_16x16x32_bf16 v[200:203], v[56:59], v[40:43], v[200:203]
    ds_read_b64_tr_b16 v[108:109], v30 offset:43520
    ds_read_b64_tr_b16 v[110:111], v30 offset:44544
    v_mfma_f32_16x16x32_bf16 v[232:235], v[56:59], v[44:47], v[232:235]
    v_mfma_f32_16x16x32_bf16 v[140:143], v[60:63], v[32:35], v[140:143]
    ds_read_b64_tr_b16 v[112:113], v27 offset:43648
    ds_read_b64_tr_b16 v[114:115], v27 offset:44672
    v_mfma_f32_16x16x32_bf16 v[172:175], v[60:63], v[36:39], v[172:175]
    v_cvt_pk_bf16_f32 v8, v8, v9
    v_cvt_pk_bf16_f32 v9, v10, v11
    v_mfma_f32_16x16x32_bf16 v[204:207], v[60:63], v[40:43], v[204:207]
    ds_read_b64_tr_b16 v[116:117], v28 offset:43648
    ds_read_b64_tr_b16 v[118:119], v28 offset:44672
    v_mfma_f32_16x16x32_bf16 v[236:239], v[60:63], v[44:47], v[236:239]
    buffer_load_dwordx4 v19, s[24:27], s36 offen offset:2048 lds
    v_mfma_f32_16x16x32_bf16 v[144:147], v[64:67], v[32:35], v[144:147]
    ds_read_b64_tr_b16 v[120:121], v29 offset:43648
    ds_read_b64_tr_b16 v[122:123], v29 offset:44672
    v_mfma_f32_16x16x32_bf16 v[176:179], v[64:67], v[36:39], v[176:179]
    v_cvt_pk_bf16_f32 v10, v12, v13
    v_cvt_pk_bf16_f32 v11, v14, v15
    v_mfma_f32_16x16x32_bf16 v[208:211], v[64:67], v[40:43], v[208:211]
    ds_read_b64_tr_b16 v[124:125], v30 offset:43648
    ds_read_b64_tr_b16 v[126:127], v30 offset:44672
    v_mfma_f32_16x16x32_bf16 v[240:243], v[64:67], v[44:47], v[240:243]
    v_accvgpr_read_b32 v4, a180
    v_accvgpr_read_b32 v5, a181
    v_mfma_f32_16x16x32_bf16 v[148:151], v[68:71], v[32:35], v[148:151]
    v_accvgpr_read_b32 v6, a182
    v_accvgpr_read_b32 v7, a183
    v_mfma_f32_16x16x32_bf16 v[180:183], v[68:71], v[36:39], v[180:183]
    buffer_load_dwordx4 v20, s[24:27], s36 offen offset:3072 lds
    v_mfma_f32_16x16x32_bf16 v[212:215], v[68:71], v[40:43], v[212:215]
    s_add_u32 s37, s49, 3932160
    v_accvgpr_read_b32 v0, a176
    v_accvgpr_read_b32 v1, a177
    v_mfma_f32_16x16x32_bf16 v[244:247], v[68:71], v[44:47], v[244:247]
    s_add_u32 m0, s50, 26112
    v_accvgpr_read_b32 v2, a178
    v_accvgpr_read_b32 v3, a179
    v_mfma_f32_16x16x32_bf16 v[152:155], v[72:75], v[32:35], v[152:155]
    buffer_load_dwordx4 v21, s[20:23], s37 offen offset:0 lds
    v_mfma_f32_16x16x32_bf16 v[184:187], v[72:75], v[36:39], v[184:187]
    v_cvt_pk_bf16_f32 v0, v0, v1
    v_cvt_pk_bf16_f32 v1, v2, v3
    v_mfma_f32_16x16x32_bf16 v[216:219], v[72:75], v[40:43], v[216:219]
    v_cvt_pk_bf16_f32 v2, v4, v5
    v_cvt_pk_bf16_f32 v3, v6, v7
    v_mfma_f32_16x16x32_bf16 v[248:251], v[72:75], v[44:47], v[248:251]
    buffer_store_dwordx4 v[8:11], v16, s[16:19], s41 offen offset:0
    v_mfma_f32_16x16x32_bf16 v[156:159], v[76:79], v[32:35], v[156:159]
    v_accvgpr_read_b32 v12, a112
    v_accvgpr_read_b32 v13, a113
    v_mfma_f32_16x16x32_bf16 v[188:191], v[76:79], v[36:39], v[188:191]
    v_accvgpr_read_b32 v14, a114
    v_accvgpr_read_b32 v15, a115
    v_mfma_f32_16x16x32_bf16 v[220:223], v[76:79], v[40:43], v[220:223]
    buffer_load_dwordx4 v22, s[20:23], s37 offen offset:1024 lds
    v_mfma_f32_16x16x32_bf16 v[252:255], v[76:79], v[44:47], v[252:255]
    s_waitcnt vmcnt(15) lgkmcnt(0)
    s_barrier
    v_accvgpr_read_b32 v8, a80
    v_accvgpr_read_b32 v9, a81
    v_mfma_f32_16x16x32_bf16 v[128:131], v[96:99], v[80:83], v[128:131]
    ds_read_b64_tr_b16 v[48:49], v27 offset:0
    ds_read_b64_tr_b16 v[50:51], v27 offset:1024
    v_mfma_f32_16x16x32_bf16 v[160:163], v[96:99], v[84:87], v[160:163]
    s_add_u32 s36, s44, 1024
    v_accvgpr_read_b32 v10, a82
    v_accvgpr_read_b32 v11, a83
    v_mfma_f32_16x16x32_bf16 v[192:195], v[96:99], v[88:91], v[192:195]
    s_add_u32 m0, s42, 32768
    ds_read_b128 v[32:35], v25 offset:0
    ds_read_b128 v[36:39], v25 offset:2048
    v_mfma_f32_16x16x32_bf16 v[224:227], v[96:99], v[92:95], v[224:227]
    buffer_load_dwordx4 v17, s[24:27], s36 offen offset:0 lds
    v_mfma_f32_16x16x32_bf16 v[132:135], v[100:103], v[80:83], v[132:135]
    ds_read_b128 v[40:43], v25 offset:4096
    ds_read_b128 v[44:47], v25 offset:6144
    v_mfma_f32_16x16x32_bf16 v[164:167], v[100:103], v[84:87], v[164:167]
    v_mul_f32 v8, s40, v8
    v_mul_f32 v9, s40, v9
    v_mfma_f32_16x16x32_bf16 v[196:199], v[100:103], v[88:91], v[196:199]
    ds_read_b64_tr_b16 v[52:53], v28 offset:0
    ds_read_b64_tr_b16 v[54:55], v28 offset:1024
    v_mfma_f32_16x16x32_bf16 v[228:231], v[100:103], v[92:95], v[228:231]
    buffer_load_dwordx4 v18, s[24:27], s36 offen offset:1024 lds
    v_mfma_f32_16x16x32_bf16 v[136:139], v[104:107], v[80:83], v[136:139]
    ds_read_b64_tr_b16 v[56:57], v29 offset:0
    ds_read_b64_tr_b16 v[58:59], v29 offset:1024
    v_mfma_f32_16x16x32_bf16 v[168:171], v[104:107], v[84:87], v[168:171]
    v_mul_f32 v10, s40, v10
    v_mul_f32 v11, s40, v11
    v_mfma_f32_16x16x32_bf16 v[200:203], v[104:107], v[88:91], v[200:203]
    ds_read_b64_tr_b16 v[60:61], v30 offset:0
    ds_read_b64_tr_b16 v[62:63], v30 offset:1024
    v_mfma_f32_16x16x32_bf16 v[232:235], v[104:107], v[92:95], v[232:235]
    buffer_store_dwordx4 v[0:3], v16, s[16:19], s38 offen offset:1024
    v_mfma_f32_16x16x32_bf16 v[140:143], v[108:111], v[80:83], v[140:143]
    ds_read_b64_tr_b16 v[64:65], v27 offset:128
    ds_read_b64_tr_b16 v[66:67], v27 offset:1152
    v_mfma_f32_16x16x32_bf16 v[172:175], v[108:111], v[84:87], v[172:175]
    v_mul_f32 v12, s40, v12
    v_mul_f32 v13, s40, v13
    v_mfma_f32_16x16x32_bf16 v[204:207], v[108:111], v[88:91], v[204:207]
    ds_read_b64_tr_b16 v[68:69], v28 offset:128
    ds_read_b64_tr_b16 v[70:71], v28 offset:1152
    v_mfma_f32_16x16x32_bf16 v[236:239], v[108:111], v[92:95], v[236:239]
    buffer_load_dwordx4 v19, s[24:27], s36 offen offset:2048 lds
    v_mfma_f32_16x16x32_bf16 v[144:147], v[112:115], v[80:83], v[144:147]
    ds_read_b64_tr_b16 v[72:73], v29 offset:128
    ds_read_b64_tr_b16 v[74:75], v29 offset:1152
    v_mfma_f32_16x16x32_bf16 v[176:179], v[112:115], v[84:87], v[176:179]
    v_mul_f32 v14, s40, v14
    v_mul_f32 v15, s40, v15
    v_mfma_f32_16x16x32_bf16 v[208:211], v[112:115], v[88:91], v[208:211]
    ds_read_b64_tr_b16 v[76:77], v30 offset:128
    ds_read_b64_tr_b16 v[78:79], v30 offset:1152
    v_mfma_f32_16x16x32_bf16 v[240:243], v[112:115], v[92:95], v[240:243]
    v_cvt_pk_bf16_f32 v8, v8, v9
    v_cvt_pk_bf16_f32 v9, v10, v11
    v_mfma_f32_16x16x32_bf16 v[148:151], v[116:119], v[80:83], v[148:151]
    v_cvt_pk_bf16_f32 v10, v12, v13
    v_cvt_pk_bf16_f32 v11, v14, v15
    v_mfma_f32_16x16x32_bf16 v[180:183], v[116:119], v[84:87], v[180:183]
    buffer_load_dwordx4 v20, s[24:27], s36 offen offset:3072 lds
    v_mfma_f32_16x16x32_bf16 v[212:215], v[116:119], v[88:91], v[212:215]
    s_add_u32 s37, s49, 4194304
    v_accvgpr_read_b32 v4, a212
    v_accvgpr_read_b32 v5, a213
    v_mfma_f32_16x16x32_bf16 v[244:247], v[116:119], v[92:95], v[244:247]
    s_add_u32 m0, s50, 34816
    v_accvgpr_read_b32 v6, a214
    v_accvgpr_read_b32 v7, a215
    v_mfma_f32_16x16x32_bf16 v[152:155], v[120:123], v[80:83], v[152:155]
    buffer_load_dwordx4 v21, s[20:23], s37 offen offset:0 lds
    v_mfma_f32_16x16x32_bf16 v[184:187], v[120:123], v[84:87], v[184:187]
    v_accvgpr_read_b32 v0, a208
    v_accvgpr_read_b32 v1, a209
    v_mfma_f32_16x16x32_bf16 v[216:219], v[120:123], v[88:91], v[216:219]
    v_accvgpr_read_b32 v2, a210
    v_accvgpr_read_b32 v3, a211
    v_mfma_f32_16x16x32_bf16 v[248:251], v[120:123], v[92:95], v[248:251]
    buffer_store_dwordx4 v[8:11], v16, s[16:19], s41 offen offset:1024
    v_mfma_f32_16x16x32_bf16 v[156:159], v[124:127], v[80:83], v[156:159]
    s_add_u32 s41, s41, 4096
    v_cvt_pk_bf16_f32 v0, v0, v1
    v_cvt_pk_bf16_f32 v1, v2, v3
    v_mfma_f32_16x16x32_bf16 v[188:191], v[124:127], v[84:87], v[188:191]
    v_cvt_pk_bf16_f32 v2, v4, v5
    v_cvt_pk_bf16_f32 v3, v6, v7
    v_mfma_f32_16x16x32_bf16 v[220:223], v[124:127], v[88:91], v[220:223]
gated_mix__ssm_conv_h3__compressed_kv_cla__prompt_kernel_pad5:
    s_cbranch_execz gated_mix__ssm_conv_h3__compressed_kv_cla__prompt_kernel_pad13
    buffer_load_dwordx4 v22, s[20:23], s37 offen offset:1024 lds
    v_mfma_f32_16x16x32_bf16 v[252:255], v[124:127], v[92:95], v[252:255]
    s_waitcnt lgkmcnt(0)
    v_accvgpr_read_b32 v12, a52
    v_accvgpr_read_b32 v13, a53
    v_mfma_f32_16x16x32_bf16 v[128:131], v[48:51], v[32:35], v[128:131]
    ds_read_b64_tr_b16 v[96:97], v27 offset:8704
    ds_read_b64_tr_b16 v[98:99], v27 offset:9728
    v_mfma_f32_16x16x32_bf16 v[160:163], v[48:51], v[36:39], v[160:163]
    s_add_u32 s36, s45, 1024
    v_accvgpr_read_b32 v14, a54
    v_accvgpr_read_b32 v15, a55
    v_mfma_f32_16x16x32_bf16 v[192:195], v[48:51], v[40:43], v[192:195]
    s_add_u32 m0, s42, 36864
    ds_read_b128 v[80:83], v26 offset:0
    ds_read_b128 v[84:87], v26 offset:2048
    v_mfma_f32_16x16x32_bf16 v[224:227], v[48:51], v[44:47], v[224:227]
    buffer_load_dwordx4 v17, s[24:27], s36 offen offset:0 lds
    v_mfma_f32_16x16x32_bf16 v[132:135], v[52:55], v[32:35], v[132:135]
    ds_read_b128 v[88:91], v26 offset:4096
    ds_read_b128 v[92:95], v26 offset:6144
    v_mfma_f32_16x16x32_bf16 v[164:167], v[52:55], v[36:39], v[164:167]
    v_accvgpr_read_b32 v8, a20
    v_accvgpr_read_b32 v9, a21
    v_mfma_f32_16x16x32_bf16 v[196:199], v[52:55], v[40:43], v[196:199]
    ds_read_b64_tr_b16 v[100:101], v28 offset:8704
    ds_read_b64_tr_b16 v[102:103], v28 offset:9728
    v_mfma_f32_16x16x32_bf16 v[228:231], v[52:55], v[44:47], v[228:231]
    buffer_load_dwordx4 v18, s[24:27], s36 offen offset:1024 lds
    v_mfma_f32_16x16x32_bf16 v[136:139], v[56:59], v[32:35], v[136:139]
    ds_read_b64_tr_b16 v[104:105], v29 offset:8704
    ds_read_b64_tr_b16 v[106:107], v29 offset:9728
    v_mfma_f32_16x16x32_bf16 v[168:171], v[56:59], v[36:39], v[168:171]
    v_accvgpr_read_b32 v10, a22
    v_accvgpr_read_b32 v11, a23
    v_mfma_f32_16x16x32_bf16 v[200:203], v[56:59], v[40:43], v[200:203]
    ds_read_b64_tr_b16 v[108:109], v30 offset:8704
    ds_read_b64_tr_b16 v[110:111], v30 offset:9728
    v_mfma_f32_16x16x32_bf16 v[232:235], v[56:59], v[44:47], v[232:235]
    buffer_store_dwordx4 v[0:3], v16, s[16:19], s38 offen offset:2048
    v_mfma_f32_16x16x32_bf16 v[140:143], v[60:63], v[32:35], v[140:143]
    ds_read_b64_tr_b16 v[112:113], v27 offset:8832
    ds_read_b64_tr_b16 v[114:115], v27 offset:9856
    v_mfma_f32_16x16x32_bf16 v[172:175], v[60:63], v[36:39], v[172:175]
    v_mul_f32 v8, s40, v8
    v_mul_f32 v9, s40, v9
    v_mfma_f32_16x16x32_bf16 v[204:207], v[60:63], v[40:43], v[204:207]
    ds_read_b64_tr_b16 v[116:117], v28 offset:8832
    ds_read_b64_tr_b16 v[118:119], v28 offset:9856
    v_mfma_f32_16x16x32_bf16 v[236:239], v[60:63], v[44:47], v[236:239]
    buffer_load_dwordx4 v19, s[24:27], s36 offen offset:2048 lds
    v_mfma_f32_16x16x32_bf16 v[144:147], v[64:67], v[32:35], v[144:147]
    ds_read_b64_tr_b16 v[120:121], v29 offset:8832
    ds_read_b64_tr_b16 v[122:123], v29 offset:9856
    v_mfma_f32_16x16x32_bf16 v[176:179], v[64:67], v[36:39], v[176:179]
    v_mul_f32 v10, s40, v10
    v_mul_f32 v11, s40, v11
    v_mfma_f32_16x16x32_bf16 v[208:211], v[64:67], v[40:43], v[208:211]
    ds_read_b64_tr_b16 v[124:125], v30 offset:8832
    ds_read_b64_tr_b16 v[126:127], v30 offset:9856
    v_mfma_f32_16x16x32_bf16 v[240:243], v[64:67], v[44:47], v[240:243]
    v_mul_f32 v12, s40, v12
    v_mul_f32 v13, s40, v13
    v_mfma_f32_16x16x32_bf16 v[148:151], v[68:71], v[32:35], v[148:151]
    v_mul_f32 v14, s40, v14
    v_mul_f32 v15, s40, v15
    v_mfma_f32_16x16x32_bf16 v[180:183], v[68:71], v[36:39], v[180:183]
    buffer_load_dwordx4 v20, s[24:27], s36 offen offset:3072 lds
    v_mfma_f32_16x16x32_bf16 v[212:215], v[68:71], v[40:43], v[212:215]
    s_add_u32 s37, s49, 4456448
    v_cvt_pk_bf16_f32 v8, v8, v9
    v_cvt_pk_bf16_f32 v9, v10, v11
    v_mfma_f32_16x16x32_bf16 v[244:247], v[68:71], v[44:47], v[244:247]
    s_add_u32 m0, s50, 43520
    v_cvt_pk_bf16_f32 v10, v12, v13
    v_cvt_pk_bf16_f32 v11, v14, v15
    v_mfma_f32_16x16x32_bf16 v[152:155], v[72:75], v[32:35], v[152:155]
    buffer_load_dwordx4 v21, s[20:23], s37 offen offset:0 lds
    v_mfma_f32_16x16x32_bf16 v[184:187], v[72:75], v[36:39], v[184:187]
    v_accvgpr_read_b32 v4, a244
    v_accvgpr_read_b32 v5, a245
    v_mfma_f32_16x16x32_bf16 v[216:219], v[72:75], v[40:43], v[216:219]
    v_accvgpr_read_b32 v6, a246
    v_accvgpr_read_b32 v7, a247
    v_mfma_f32_16x16x32_bf16 v[248:251], v[72:75], v[44:47], v[248:251]
    buffer_store_dwordx4 v[8:11], v16, s[16:19], s41 offen offset:0
    v_mfma_f32_16x16x32_bf16 v[156:159], v[76:79], v[32:35], v[156:159]
    v_accvgpr_read_b32 v0, a240
    v_accvgpr_read_b32 v1, a241
    v_mfma_f32_16x16x32_bf16 v[188:191], v[76:79], v[36:39], v[188:191]
    v_accvgpr_read_b32 v2, a242
    v_accvgpr_read_b32 v3, a243
    v_mfma_f32_16x16x32_bf16 v[220:223], v[76:79], v[40:43], v[220:223]
    buffer_load_dwordx4 v22, s[20:23], s37 offen offset:1024 lds
    v_mfma_f32_16x16x32_bf16 v[252:255], v[76:79], v[44:47], v[252:255]
    s_waitcnt vmcnt(16) lgkmcnt(0)
    s_barrier
    v_cvt_pk_bf16_f32 v0, v0, v1
    v_cvt_pk_bf16_f32 v1, v2, v3
    v_mfma_f32_16x16x32_bf16 v[128:131], v[96:99], v[80:83], v[128:131]
    ds_read_b64_tr_b16 v[48:49], v27 offset:17408
    ds_read_b64_tr_b16 v[50:51], v27 offset:18432
    v_mfma_f32_16x16x32_bf16 v[160:163], v[96:99], v[84:87], v[160:163]
    s_add_u32 s36, s44, 1152
    v_cvt_pk_bf16_f32 v2, v4, v5
    v_cvt_pk_bf16_f32 v3, v6, v7
    v_mfma_f32_16x16x32_bf16 v[192:195], v[96:99], v[88:91], v[192:195]
    s_add_u32 m0, s42, 65536
    ds_read_b128 v[32:35], v23 offset:0
    ds_read_b128 v[36:39], v23 offset:2048
    v_mfma_f32_16x16x32_bf16 v[224:227], v[96:99], v[92:95], v[224:227]
    buffer_load_dwordx4 v17, s[24:27], s36 offen offset:0 lds
    v_mfma_f32_16x16x32_bf16 v[132:135], v[100:103], v[80:83], v[132:135]
    ds_read_b128 v[40:43], v23 offset:4096
    ds_read_b128 v[44:47], v23 offset:6144
    v_mfma_f32_16x16x32_bf16 v[164:167], v[100:103], v[84:87], v[164:167]
    v_accvgpr_read_b32 v12, a116
    v_accvgpr_read_b32 v13, a117
    v_mfma_f32_16x16x32_bf16 v[196:199], v[100:103], v[88:91], v[196:199]
    ds_read_b64_tr_b16 v[52:53], v28 offset:17408
    ds_read_b64_tr_b16 v[54:55], v28 offset:18432
    v_mfma_f32_16x16x32_bf16 v[228:231], v[100:103], v[92:95], v[228:231]
    buffer_load_dwordx4 v18, s[24:27], s36 offen offset:1024 lds
    v_mfma_f32_16x16x32_bf16 v[136:139], v[104:107], v[80:83], v[136:139]
    ds_read_b64_tr_b16 v[56:57], v29 offset:17408
    ds_read_b64_tr_b16 v[58:59], v29 offset:18432
    v_mfma_f32_16x16x32_bf16 v[168:171], v[104:107], v[84:87], v[168:171]
    v_accvgpr_read_b32 v14, a118
    v_accvgpr_read_b32 v15, a119
    v_mfma_f32_16x16x32_bf16 v[200:203], v[104:107], v[88:91], v[200:203]
    ds_read_b64_tr_b16 v[60:61], v30 offset:17408
    ds_read_b64_tr_b16 v[62:63], v30 offset:18432
    v_mfma_f32_16x16x32_bf16 v[232:235], v[104:107], v[92:95], v[232:235]
    buffer_store_dwordx4 v[0:3], v16, s[16:19], s38 offen offset:3072
    v_mfma_f32_16x16x32_bf16 v[140:143], v[108:111], v[80:83], v[140:143]
    s_add_u32 s38, s38, 16384
    ds_read_b64_tr_b16 v[64:65], v27 offset:17536
    ds_read_b64_tr_b16 v[66:67], v27 offset:18560
    v_mfma_f32_16x16x32_bf16 v[172:175], v[108:111], v[84:87], v[172:175]
    v_accvgpr_read_b32 v8, a84
    v_accvgpr_read_b32 v9, a85
    v_mfma_f32_16x16x32_bf16 v[204:207], v[108:111], v[88:91], v[204:207]
    ds_read_b64_tr_b16 v[68:69], v28 offset:17536
    ds_read_b64_tr_b16 v[70:71], v28 offset:18560
    v_mfma_f32_16x16x32_bf16 v[236:239], v[108:111], v[92:95], v[236:239]
    buffer_load_dwordx4 v19, s[24:27], s36 offen offset:2048 lds
    v_mfma_f32_16x16x32_bf16 v[144:147], v[112:115], v[80:83], v[144:147]
    ds_read_b64_tr_b16 v[72:73], v29 offset:17536
    ds_read_b64_tr_b16 v[74:75], v29 offset:18560
    v_mfma_f32_16x16x32_bf16 v[176:179], v[112:115], v[84:87], v[176:179]
    v_accvgpr_read_b32 v10, a86
    v_accvgpr_read_b32 v11, a87
    v_mfma_f32_16x16x32_bf16 v[208:211], v[112:115], v[88:91], v[208:211]
    ds_read_b64_tr_b16 v[76:77], v30 offset:17536
    ds_read_b64_tr_b16 v[78:79], v30 offset:18560
    v_mfma_f32_16x16x32_bf16 v[240:243], v[112:115], v[92:95], v[240:243]
    v_mul_f32 v8, s40, v8
    v_mul_f32 v9, s40, v9
    v_mfma_f32_16x16x32_bf16 v[148:151], v[116:119], v[80:83], v[148:151]
    v_mul_f32 v10, s40, v10
    v_mul_f32 v11, s40, v11
    v_mfma_f32_16x16x32_bf16 v[180:183], v[116:119], v[84:87], v[180:183]
    buffer_load_dwordx4 v20, s[24:27], s36 offen offset:3072 lds
    v_mfma_f32_16x16x32_bf16 v[212:215], v[116:119], v[88:91], v[212:215]
    s_add_u32 s37, s49, 4718592
    v_mul_f32 v12, s40, v12
    v_mul_f32 v13, s40, v13
    v_mfma_f32_16x16x32_bf16 v[244:247], v[116:119], v[92:95], v[244:247]
    s_add_u32 m0, s50, 0
    v_mul_f32 v14, s40, v14
    v_mul_f32 v15, s40, v15
    v_mfma_f32_16x16x32_bf16 v[152:155], v[120:123], v[80:83], v[152:155]
    buffer_load_dwordx4 v21, s[20:23], s37 offen offset:0 lds
    v_mfma_f32_16x16x32_bf16 v[184:187], v[120:123], v[84:87], v[184:187]
    v_cvt_pk_bf16_f32 v8, v8, v9
    v_cvt_pk_bf16_f32 v9, v10, v11
    v_mfma_f32_16x16x32_bf16 v[216:219], v[120:123], v[88:91], v[216:219]
    v_cvt_pk_bf16_f32 v10, v12, v13
    v_cvt_pk_bf16_f32 v11, v14, v15
    v_mfma_f32_16x16x32_bf16 v[248:251], v[120:123], v[92:95], v[248:251]
    buffer_store_dwordx4 v[8:11], v16, s[16:19], s41 offen offset:1024
    v_mfma_f32_16x16x32_bf16 v[156:159], v[124:127], v[80:83], v[156:159]
    s_add_u32 s41, s41, 12288
    v_accvgpr_read_b32 v4, a156
    v_accvgpr_read_b32 v5, a157
    v_mfma_f32_16x16x32_bf16 v[188:191], v[124:127], v[84:87], v[188:191]
    v_accvgpr_read_b32 v6, a158
    v_accvgpr_read_b32 v7, a159
    v_mfma_f32_16x16x32_bf16 v[220:223], v[124:127], v[88:91], v[220:223]
    buffer_load_dwordx4 v22, s[20:23], s37 offen offset:1024 lds
    v_mfma_f32_16x16x32_bf16 v[252:255], v[124:127], v[92:95], v[252:255]
    s_waitcnt lgkmcnt(0)
    v_accvgpr_read_b32 v0, a152
    v_accvgpr_read_b32 v1, a153
    v_mfma_f32_16x16x32_bf16 v[128:131], v[48:51], v[32:35], v[128:131]
    ds_read_b64_tr_b16 v[96:97], v27 offset:26112
    ds_read_b64_tr_b16 v[98:99], v27 offset:27136
    v_mfma_f32_16x16x32_bf16 v[160:163], v[48:51], v[36:39], v[160:163]
    s_add_u32 s36, s45, 1152
    v_accvgpr_read_b32 v2, a154
    v_accvgpr_read_b32 v3, a155
    v_mfma_f32_16x16x32_bf16 v[192:195], v[48:51], v[40:43], v[192:195]
    s_add_u32 m0, s42, 69632
    ds_read_b128 v[80:83], v24 offset:0
    ds_read_b128 v[84:87], v24 offset:2048
    v_mfma_f32_16x16x32_bf16 v[224:227], v[48:51], v[44:47], v[224:227]
    buffer_load_dwordx4 v17, s[24:27], s36 offen offset:0 lds
    v_mfma_f32_16x16x32_bf16 v[132:135], v[52:55], v[32:35], v[132:135]
    ds_read_b128 v[88:91], v24 offset:4096
    ds_read_b128 v[92:95], v24 offset:6144
    v_mfma_f32_16x16x32_bf16 v[164:167], v[52:55], v[36:39], v[164:167]
    v_cvt_pk_bf16_f32 v0, v0, v1
    v_cvt_pk_bf16_f32 v1, v2, v3
    v_mfma_f32_16x16x32_bf16 v[196:199], v[52:55], v[40:43], v[196:199]
    ds_read_b64_tr_b16 v[100:101], v28 offset:26112
    ds_read_b64_tr_b16 v[102:103], v28 offset:27136
    v_mfma_f32_16x16x32_bf16 v[228:231], v[52:55], v[44:47], v[228:231]
    buffer_load_dwordx4 v18, s[24:27], s36 offen offset:1024 lds
    v_mfma_f32_16x16x32_bf16 v[136:139], v[56:59], v[32:35], v[136:139]
    ds_read_b64_tr_b16 v[104:105], v29 offset:26112
    ds_read_b64_tr_b16 v[106:107], v29 offset:27136
    v_mfma_f32_16x16x32_bf16 v[168:171], v[56:59], v[36:39], v[168:171]
    v_cvt_pk_bf16_f32 v2, v4, v5
    v_cvt_pk_bf16_f32 v3, v6, v7
    v_mfma_f32_16x16x32_bf16 v[200:203], v[56:59], v[40:43], v[200:203]
    ds_read_b64_tr_b16 v[108:109], v30 offset:26112
    ds_read_b64_tr_b16 v[110:111], v30 offset:27136
    v_mfma_f32_16x16x32_bf16 v[232:235], v[56:59], v[44:47], v[232:235]
    buffer_store_dwordx4 v[0:3], v16, s[16:19], s38 offen offset:0
    v_mfma_f32_16x16x32_bf16 v[140:143], v[60:63], v[32:35], v[140:143]
    ds_read_b64_tr_b16 v[112:113], v27 offset:26240
    ds_read_b64_tr_b16 v[114:115], v27 offset:27264
    v_mfma_f32_16x16x32_bf16 v[172:175], v[60:63], v[36:39], v[172:175]
    v_accvgpr_read_b32 v12, a56
    v_accvgpr_read_b32 v13, a57
    v_mfma_f32_16x16x32_bf16 v[204:207], v[60:63], v[40:43], v[204:207]
    ds_read_b64_tr_b16 v[116:117], v28 offset:26240
    ds_read_b64_tr_b16 v[118:119], v28 offset:27264
    v_mfma_f32_16x16x32_bf16 v[236:239], v[60:63], v[44:47], v[236:239]
    buffer_load_dwordx4 v19, s[24:27], s36 offen offset:2048 lds
    v_mfma_f32_16x16x32_bf16 v[144:147], v[64:67], v[32:35], v[144:147]
    ds_read_b64_tr_b16 v[120:121], v29 offset:26240
    ds_read_b64_tr_b16 v[122:123], v29 offset:27264
    v_mfma_f32_16x16x32_bf16 v[176:179], v[64:67], v[36:39], v[176:179]
    v_accvgpr_read_b32 v14, a58
    v_accvgpr_read_b32 v15, a59
    v_mfma_f32_16x16x32_bf16 v[208:211], v[64:67], v[40:43], v[208:211]
    ds_read_b64_tr_b16 v[124:125], v30 offset:26240
    ds_read_b64_tr_b16 v[126:127], v30 offset:27264
    v_mfma_f32_16x16x32_bf16 v[240:243], v[64:67], v[44:47], v[240:243]
    v_accvgpr_read_b32 v8, a24
    v_accvgpr_read_b32 v9, a25
    v_mfma_f32_16x16x32_bf16 v[148:151], v[68:71], v[32:35], v[148:151]
    v_accvgpr_read_b32 v10, a26
    v_accvgpr_read_b32 v11, a27
    v_mfma_f32_16x16x32_bf16 v[180:183], v[68:71], v[36:39], v[180:183]
    buffer_load_dwordx4 v20, s[24:27], s36 offen offset:3072 lds
    v_mfma_f32_16x16x32_bf16 v[212:215], v[68:71], v[40:43], v[212:215]
    s_add_u32 s37, s49, 4980736
    v_mul_f32 v8, s40, v8
    v_mul_f32 v9, s40, v9
    v_mfma_f32_16x16x32_bf16 v[244:247], v[68:71], v[44:47], v[244:247]
    s_add_u32 m0, s50, 8704
    v_mul_f32 v10, s40, v10
    v_mul_f32 v11, s40, v11
    v_mfma_f32_16x16x32_bf16 v[152:155], v[72:75], v[32:35], v[152:155]
    buffer_load_dwordx4 v21, s[20:23], s37 offen offset:0 lds
    v_mfma_f32_16x16x32_bf16 v[184:187], v[72:75], v[36:39], v[184:187]
    v_mul_f32 v12, s40, v12
    v_mul_f32 v13, s40, v13
    v_mfma_f32_16x16x32_bf16 v[216:219], v[72:75], v[40:43], v[216:219]
    v_mul_f32 v14, s40, v14
    v_mul_f32 v15, s40, v15
    v_mfma_f32_16x16x32_bf16 v[248:251], v[72:75], v[44:47], v[248:251]
    v_mfma_f32_16x16x32_bf16 v[156:159], v[76:79], v[32:35], v[156:159]
    v_cvt_pk_bf16_f32 v8, v8, v9
    v_cvt_pk_bf16_f32 v9, v10, v11
    v_mfma_f32_16x16x32_bf16 v[188:191], v[76:79], v[36:39], v[188:191]
    v_cvt_pk_bf16_f32 v10, v12, v13
    v_cvt_pk_bf16_f32 v11, v14, v15
    v_mfma_f32_16x16x32_bf16 v[220:223], v[76:79], v[40:43], v[220:223]
    buffer_load_dwordx4 v22, s[20:23], s37 offen offset:1024 lds
    v_mfma_f32_16x16x32_bf16 v[252:255], v[76:79], v[44:47], v[252:255]
    s_waitcnt vmcnt(15) lgkmcnt(0)
    s_barrier
    v_accvgpr_read_b32 v4, a188
    v_accvgpr_read_b32 v5, a189
    v_mfma_f32_16x16x32_bf16 v[128:131], v[96:99], v[80:83], v[128:131]
    ds_read_b64_tr_b16 v[48:49], v27 offset:34816
    ds_read_b64_tr_b16 v[50:51], v27 offset:35840
    v_mfma_f32_16x16x32_bf16 v[160:163], v[96:99], v[84:87], v[160:163]
    s_add_u32 s36, s44, 1280
    v_accvgpr_read_b32 v6, a190
    v_accvgpr_read_b32 v7, a191
    v_mfma_f32_16x16x32_bf16 v[192:195], v[96:99], v[88:91], v[192:195]
    s_add_u32 m0, s42, 0
    ds_read_b128 v[32:35], v23 offset:32768
    ds_read_b128 v[36:39], v23 offset:34816
    v_mfma_f32_16x16x32_bf16 v[224:227], v[96:99], v[92:95], v[224:227]
    buffer_load_dwordx4 v17, s[24:27], s36 offen offset:0 lds
    v_mfma_f32_16x16x32_bf16 v[132:135], v[100:103], v[80:83], v[132:135]
    ds_read_b128 v[40:43], v23 offset:36864
    ds_read_b128 v[44:47], v23 offset:38912
    v_mfma_f32_16x16x32_bf16 v[164:167], v[100:103], v[84:87], v[164:167]
    v_accvgpr_read_b32 v0, a184
    v_accvgpr_read_b32 v1, a185
    v_mfma_f32_16x16x32_bf16 v[196:199], v[100:103], v[88:91], v[196:199]
    ds_read_b64_tr_b16 v[52:53], v28 offset:34816
    ds_read_b64_tr_b16 v[54:55], v28 offset:35840
    v_mfma_f32_16x16x32_bf16 v[228:231], v[100:103], v[92:95], v[228:231]
    buffer_load_dwordx4 v18, s[24:27], s36 offen offset:1024 lds
    v_mfma_f32_16x16x32_bf16 v[136:139], v[104:107], v[80:83], v[136:139]
    ds_read_b64_tr_b16 v[56:57], v29 offset:34816
    ds_read_b64_tr_b16 v[58:59], v29 offset:35840
    v_mfma_f32_16x16x32_bf16 v[168:171], v[104:107], v[84:87], v[168:171]
    v_accvgpr_read_b32 v2, a186
    v_accvgpr_read_b32 v3, a187
    v_mfma_f32_16x16x32_bf16 v[200:203], v[104:107], v[88:91], v[200:203]
    ds_read_b64_tr_b16 v[60:61], v30 offset:34816
    ds_read_b64_tr_b16 v[62:63], v30 offset:35840
    v_mfma_f32_16x16x32_bf16 v[232:235], v[104:107], v[92:95], v[232:235]
    buffer_store_dwordx4 v[8:11], v16, s[16:19], s41 offen offset:0
    v_mfma_f32_16x16x32_bf16 v[140:143], v[108:111], v[80:83], v[140:143]
    ds_read_b64_tr_b16 v[64:65], v27 offset:34944
    ds_read_b64_tr_b16 v[66:67], v27 offset:35968
    v_mfma_f32_16x16x32_bf16 v[172:175], v[108:111], v[84:87], v[172:175]
    v_cvt_pk_bf16_f32 v0, v0, v1
    v_cvt_pk_bf16_f32 v1, v2, v3
    v_mfma_f32_16x16x32_bf16 v[204:207], v[108:111], v[88:91], v[204:207]
    ds_read_b64_tr_b16 v[68:69], v28 offset:34944
    ds_read_b64_tr_b16 v[70:71], v28 offset:35968
    v_mfma_f32_16x16x32_bf16 v[236:239], v[108:111], v[92:95], v[236:239]
    buffer_load_dwordx4 v19, s[24:27], s36 offen offset:2048 lds
    v_mfma_f32_16x16x32_bf16 v[144:147], v[112:115], v[80:83], v[144:147]
    ds_read_b64_tr_b16 v[72:73], v29 offset:34944
    ds_read_b64_tr_b16 v[74:75], v29 offset:35968
    v_mfma_f32_16x16x32_bf16 v[176:179], v[112:115], v[84:87], v[176:179]
    v_cvt_pk_bf16_f32 v2, v4, v5
    v_cvt_pk_bf16_f32 v3, v6, v7
    v_mfma_f32_16x16x32_bf16 v[208:211], v[112:115], v[88:91], v[208:211]
    ds_read_b64_tr_b16 v[76:77], v30 offset:34944
    ds_read_b64_tr_b16 v[78:79], v30 offset:35968
    v_mfma_f32_16x16x32_bf16 v[240:243], v[112:115], v[92:95], v[240:243]
    v_accvgpr_read_b32 v12, a120
    v_accvgpr_read_b32 v13, a121
    v_mfma_f32_16x16x32_bf16 v[148:151], v[116:119], v[80:83], v[148:151]
    v_accvgpr_read_b32 v14, a122
    v_accvgpr_read_b32 v15, a123
    v_mfma_f32_16x16x32_bf16 v[180:183], v[116:119], v[84:87], v[180:183]
    buffer_load_dwordx4 v20, s[24:27], s36 offen offset:3072 lds
    v_mfma_f32_16x16x32_bf16 v[212:215], v[116:119], v[88:91], v[212:215]
    s_add_u32 s37, s49, 5242880
    v_accvgpr_read_b32 v8, a88
    v_accvgpr_read_b32 v9, a89
    v_mfma_f32_16x16x32_bf16 v[244:247], v[116:119], v[92:95], v[244:247]
    s_add_u32 m0, s50, 17408
    v_accvgpr_read_b32 v10, a90
    v_accvgpr_read_b32 v11, a91
    v_mfma_f32_16x16x32_bf16 v[152:155], v[120:123], v[80:83], v[152:155]
    buffer_load_dwordx4 v21, s[20:23], s37 offen offset:0 lds
    v_mfma_f32_16x16x32_bf16 v[184:187], v[120:123], v[84:87], v[184:187]
    v_mul_f32 v8, s40, v8
    v_mul_f32 v9, s40, v9
    v_mfma_f32_16x16x32_bf16 v[216:219], v[120:123], v[88:91], v[216:219]
    v_mul_f32 v10, s40, v10
    v_mul_f32 v11, s40, v11
    v_mfma_f32_16x16x32_bf16 v[248:251], v[120:123], v[92:95], v[248:251]
    buffer_store_dwordx4 v[0:3], v16, s[16:19], s38 offen offset:1024
    v_mfma_f32_16x16x32_bf16 v[156:159], v[124:127], v[80:83], v[156:159]
    v_mul_f32 v12, s40, v12
    v_mul_f32 v13, s40, v13
    v_mfma_f32_16x16x32_bf16 v[188:191], v[124:127], v[84:87], v[188:191]
    v_mul_f32 v14, s40, v14
    v_mul_f32 v15, s40, v15
    v_mfma_f32_16x16x32_bf16 v[220:223], v[124:127], v[88:91], v[220:223]
    buffer_load_dwordx4 v22, s[20:23], s37 offen offset:1024 lds
    v_mfma_f32_16x16x32_bf16 v[252:255], v[124:127], v[92:95], v[252:255]
    s_waitcnt lgkmcnt(0)
    v_cvt_pk_bf16_f32 v8, v8, v9
    v_cvt_pk_bf16_f32 v9, v10, v11
    v_mfma_f32_16x16x32_bf16 v[128:131], v[48:51], v[32:35], v[128:131]
    ds_read_b64_tr_b16 v[96:97], v27 offset:43520
    ds_read_b64_tr_b16 v[98:99], v27 offset:44544
    v_mfma_f32_16x16x32_bf16 v[160:163], v[48:51], v[36:39], v[160:163]
    s_add_u32 s36, s45, 1280
    v_cvt_pk_bf16_f32 v10, v12, v13
    v_cvt_pk_bf16_f32 v11, v14, v15
    v_mfma_f32_16x16x32_bf16 v[192:195], v[48:51], v[40:43], v[192:195]
    s_add_u32 m0, s42, 4096
    ds_read_b128 v[80:83], v24 offset:32768
    ds_read_b128 v[84:87], v24 offset:34816
    v_mfma_f32_16x16x32_bf16 v[224:227], v[48:51], v[44:47], v[224:227]
    buffer_load_dwordx4 v17, s[24:27], s36 offen offset:0 lds
    v_mfma_f32_16x16x32_bf16 v[132:135], v[52:55], v[32:35], v[132:135]
    ds_read_b128 v[88:91], v24 offset:36864
    ds_read_b128 v[92:95], v24 offset:38912
    v_mfma_f32_16x16x32_bf16 v[164:167], v[52:55], v[36:39], v[164:167]
    v_accvgpr_read_b32 v4, a220
    v_accvgpr_read_b32 v5, a221
    v_mfma_f32_16x16x32_bf16 v[196:199], v[52:55], v[40:43], v[196:199]
    ds_read_b64_tr_b16 v[100:101], v28 offset:43520
    ds_read_b64_tr_b16 v[102:103], v28 offset:44544
    v_mfma_f32_16x16x32_bf16 v[228:231], v[52:55], v[44:47], v[228:231]
    buffer_load_dwordx4 v18, s[24:27], s36 offen offset:1024 lds
    v_mfma_f32_16x16x32_bf16 v[136:139], v[56:59], v[32:35], v[136:139]
    ds_read_b64_tr_b16 v[104:105], v29 offset:43520
    ds_read_b64_tr_b16 v[106:107], v29 offset:44544
    v_mfma_f32_16x16x32_bf16 v[168:171], v[56:59], v[36:39], v[168:171]
    v_accvgpr_read_b32 v6, a222
    v_accvgpr_read_b32 v7, a223
    v_mfma_f32_16x16x32_bf16 v[200:203], v[56:59], v[40:43], v[200:203]
    ds_read_b64_tr_b16 v[108:109], v30 offset:43520
    ds_read_b64_tr_b16 v[110:111], v30 offset:44544
    v_mfma_f32_16x16x32_bf16 v[232:235], v[56:59], v[44:47], v[232:235]
    buffer_store_dwordx4 v[8:11], v16, s[16:19], s41 offen offset:1024
    v_mfma_f32_16x16x32_bf16 v[140:143], v[60:63], v[32:35], v[140:143]
    s_add_u32 s41, s41, 4096
    ds_read_b64_tr_b16 v[112:113], v27 offset:43648
    ds_read_b64_tr_b16 v[114:115], v27 offset:44672
    v_mfma_f32_16x16x32_bf16 v[172:175], v[60:63], v[36:39], v[172:175]
    v_accvgpr_read_b32 v0, a216
    v_accvgpr_read_b32 v1, a217
    v_mfma_f32_16x16x32_bf16 v[204:207], v[60:63], v[40:43], v[204:207]
    ds_read_b64_tr_b16 v[116:117], v28 offset:43648
    ds_read_b64_tr_b16 v[118:119], v28 offset:44672
    v_mfma_f32_16x16x32_bf16 v[236:239], v[60:63], v[44:47], v[236:239]
    buffer_load_dwordx4 v19, s[24:27], s36 offen offset:2048 lds
    v_mfma_f32_16x16x32_bf16 v[144:147], v[64:67], v[32:35], v[144:147]
    ds_read_b64_tr_b16 v[120:121], v29 offset:43648
    ds_read_b64_tr_b16 v[122:123], v29 offset:44672
    v_mfma_f32_16x16x32_bf16 v[176:179], v[64:67], v[36:39], v[176:179]
    v_accvgpr_read_b32 v2, a218
    v_accvgpr_read_b32 v3, a219
    v_mfma_f32_16x16x32_bf16 v[208:211], v[64:67], v[40:43], v[208:211]
    ds_read_b64_tr_b16 v[124:125], v30 offset:43648
    ds_read_b64_tr_b16 v[126:127], v30 offset:44672
    v_mfma_f32_16x16x32_bf16 v[240:243], v[64:67], v[44:47], v[240:243]
    v_cvt_pk_bf16_f32 v0, v0, v1
    v_cvt_pk_bf16_f32 v1, v2, v3
    v_mfma_f32_16x16x32_bf16 v[148:151], v[68:71], v[32:35], v[148:151]
    v_cvt_pk_bf16_f32 v2, v4, v5
    v_cvt_pk_bf16_f32 v3, v6, v7
    v_mfma_f32_16x16x32_bf16 v[180:183], v[68:71], v[36:39], v[180:183]
    buffer_load_dwordx4 v20, s[24:27], s36 offen offset:3072 lds
    v_mfma_f32_16x16x32_bf16 v[212:215], v[68:71], v[40:43], v[212:215]
    s_add_u32 s37, s49, 5505024
    v_accvgpr_read_b32 v12, a60
    v_accvgpr_read_b32 v13, a61
    v_mfma_f32_16x16x32_bf16 v[244:247], v[68:71], v[44:47], v[244:247]
    s_add_u32 m0, s50, 26112
    v_accvgpr_read_b32 v14, a62
    v_accvgpr_read_b32 v15, a63
    v_mfma_f32_16x16x32_bf16 v[152:155], v[72:75], v[32:35], v[152:155]
    buffer_load_dwordx4 v21, s[20:23], s37 offen offset:0 lds
    v_mfma_f32_16x16x32_bf16 v[184:187], v[72:75], v[36:39], v[184:187]
    v_accvgpr_read_b32 v8, a28
    v_accvgpr_read_b32 v9, a29
    v_mfma_f32_16x16x32_bf16 v[216:219], v[72:75], v[40:43], v[216:219]
    v_accvgpr_read_b32 v10, a30
    v_accvgpr_read_b32 v11, a31
    v_mfma_f32_16x16x32_bf16 v[248:251], v[72:75], v[44:47], v[248:251]
    buffer_store_dwordx4 v[0:3], v16, s[16:19], s38 offen offset:2048
    v_mfma_f32_16x16x32_bf16 v[156:159], v[76:79], v[32:35], v[156:159]
    v_mul_f32 v8, s40, v8
    v_mul_f32 v9, s40, v9
    v_mfma_f32_16x16x32_bf16 v[188:191], v[76:79], v[36:39], v[188:191]
    v_mul_f32 v10, s40, v10
    v_mul_f32 v11, s40, v11
    v_mfma_f32_16x16x32_bf16 v[220:223], v[76:79], v[40:43], v[220:223]
    buffer_load_dwordx4 v22, s[20:23], s37 offen offset:1024 lds
    v_mfma_f32_16x16x32_bf16 v[252:255], v[76:79], v[44:47], v[252:255]
    s_waitcnt vmcnt(16) lgkmcnt(0)
    s_barrier
    v_mul_f32 v12, s40, v12
    v_mul_f32 v13, s40, v13
    v_mfma_f32_16x16x32_bf16 v[128:131], v[96:99], v[80:83], v[128:131]
    ds_read_b64_tr_b16 v[48:49], v27 offset:0
    ds_read_b64_tr_b16 v[50:51], v27 offset:1024
    v_mfma_f32_16x16x32_bf16 v[160:163], v[96:99], v[84:87], v[160:163]
    s_add_u32 s36, s44, 1408
    v_mul_f32 v14, s40, v14
    v_mul_f32 v15, s40, v15
    v_mfma_f32_16x16x32_bf16 v[192:195], v[96:99], v[88:91], v[192:195]
    s_add_u32 m0, s42, 32768
    ds_read_b128 v[32:35], v25 offset:0
    ds_read_b128 v[36:39], v25 offset:2048
    v_mfma_f32_16x16x32_bf16 v[224:227], v[96:99], v[92:95], v[224:227]
    buffer_load_dwordx4 v17, s[24:27], s36 offen offset:0 lds
    v_mfma_f32_16x16x32_bf16 v[132:135], v[100:103], v[80:83], v[132:135]
    ds_read_b128 v[40:43], v25 offset:4096
    ds_read_b128 v[44:47], v25 offset:6144
    v_mfma_f32_16x16x32_bf16 v[164:167], v[100:103], v[84:87], v[164:167]
    v_cvt_pk_bf16_f32 v8, v8, v9
    v_cvt_pk_bf16_f32 v9, v10, v11
    v_mfma_f32_16x16x32_bf16 v[196:199], v[100:103], v[88:91], v[196:199]
    ds_read_b64_tr_b16 v[52:53], v28 offset:0
    ds_read_b64_tr_b16 v[54:55], v28 offset:1024
    v_mfma_f32_16x16x32_bf16 v[228:231], v[100:103], v[92:95], v[228:231]
    buffer_load_dwordx4 v18, s[24:27], s36 offen offset:1024 lds
    v_mfma_f32_16x16x32_bf16 v[136:139], v[104:107], v[80:83], v[136:139]
    ds_read_b64_tr_b16 v[56:57], v29 offset:0
    ds_read_b64_tr_b16 v[58:59], v29 offset:1024
    v_mfma_f32_16x16x32_bf16 v[168:171], v[104:107], v[84:87], v[168:171]
    v_cvt_pk_bf16_f32 v10, v12, v13
    v_cvt_pk_bf16_f32 v11, v14, v15
    v_mfma_f32_16x16x32_bf16 v[200:203], v[104:107], v[88:91], v[200:203]
    ds_read_b64_tr_b16 v[60:61], v30 offset:0
    ds_read_b64_tr_b16 v[62:63], v30 offset:1024
    v_mfma_f32_16x16x32_bf16 v[232:235], v[104:107], v[92:95], v[232:235]
    buffer_store_dwordx4 v[8:11], v16, s[16:19], s41 offen offset:0
    v_mfma_f32_16x16x32_bf16 v[140:143], v[108:111], v[80:83], v[140:143]
    ds_read_b64_tr_b16 v[64:65], v27 offset:128
    ds_read_b64_tr_b16 v[66:67], v27 offset:1152
    v_mfma_f32_16x16x32_bf16 v[172:175], v[108:111], v[84:87], v[172:175]
    v_accvgpr_read_b32 v4, a252
    v_accvgpr_read_b32 v5, a253
    v_mfma_f32_16x16x32_bf16 v[204:207], v[108:111], v[88:91], v[204:207]
    ds_read_b64_tr_b16 v[68:69], v28 offset:128
    ds_read_b64_tr_b16 v[70:71], v28 offset:1152
    v_mfma_f32_16x16x32_bf16 v[236:239], v[108:111], v[92:95], v[236:239]
    buffer_load_dwordx4 v19, s[24:27], s36 offen offset:2048 lds
    v_mfma_f32_16x16x32_bf16 v[144:147], v[112:115], v[80:83], v[144:147]
    ds_read_b64_tr_b16 v[72:73], v29 offset:128
    ds_read_b64_tr_b16 v[74:75], v29 offset:1152
    v_mfma_f32_16x16x32_bf16 v[176:179], v[112:115], v[84:87], v[176:179]
    v_accvgpr_read_b32 v6, a254
    v_accvgpr_read_b32 v7, a255
    v_mfma_f32_16x16x32_bf16 v[208:211], v[112:115], v[88:91], v[208:211]
    ds_read_b64_tr_b16 v[76:77], v30 offset:128
    ds_read_b64_tr_b16 v[78:79], v30 offset:1152
    v_mfma_f32_16x16x32_bf16 v[240:243], v[112:115], v[92:95], v[240:243]
    v_accvgpr_read_b32 v0, a248
    v_accvgpr_read_b32 v1, a249
    v_mfma_f32_16x16x32_bf16 v[148:151], v[116:119], v[80:83], v[148:151]
    v_accvgpr_read_b32 v2, a250
    v_accvgpr_read_b32 v3, a251
    v_mfma_f32_16x16x32_bf16 v[180:183], v[116:119], v[84:87], v[180:183]
gated_mix__ssm_conv_h3__compressed_kv_cla__prompt_kernel_pad6:
    s_cbranch_execz gated_mix__ssm_conv_h3__compressed_kv_cla__prompt_kernel_pad14
    buffer_load_dwordx4 v20, s[24:27], s36 offen offset:3072 lds
    v_mfma_f32_16x16x32_bf16 v[212:215], v[116:119], v[88:91], v[212:215]
    s_add_u32 s37, s49, 5767168
    v_cvt_pk_bf16_f32 v0, v0, v1
    v_cvt_pk_bf16_f32 v1, v2, v3
    v_mfma_f32_16x16x32_bf16 v[244:247], v[116:119], v[92:95], v[244:247]
    s_add_u32 m0, s50, 34816
    v_cvt_pk_bf16_f32 v2, v4, v5
    v_cvt_pk_bf16_f32 v3, v6, v7
    v_mfma_f32_16x16x32_bf16 v[152:155], v[120:123], v[80:83], v[152:155]
    buffer_load_dwordx4 v21, s[20:23], s37 offen offset:0 lds
    v_mfma_f32_16x16x32_bf16 v[184:187], v[120:123], v[84:87], v[184:187]
    v_accvgpr_read_b32 v12, a124
    v_accvgpr_read_b32 v13, a125
    v_mfma_f32_16x16x32_bf16 v[216:219], v[120:123], v[88:91], v[216:219]
    v_accvgpr_read_b32 v14, a126
    v_accvgpr_read_b32 v15, a127
    v_mfma_f32_16x16x32_bf16 v[248:251], v[120:123], v[92:95], v[248:251]
    buffer_store_dwordx4 v[0:3], v16, s[16:19], s38 offen offset:3072
    v_mfma_f32_16x16x32_bf16 v[156:159], v[124:127], v[80:83], v[156:159]
    s_add_u32 s38, s38, 16384
    v_accvgpr_read_b32 v8, a92
    v_accvgpr_read_b32 v9, a93
    v_mfma_f32_16x16x32_bf16 v[188:191], v[124:127], v[84:87], v[188:191]
    v_accvgpr_read_b32 v10, a94
    v_accvgpr_read_b32 v11, a95
    v_mfma_f32_16x16x32_bf16 v[220:223], v[124:127], v[88:91], v[220:223]
    buffer_load_dwordx4 v22, s[20:23], s37 offen offset:1024 lds
    v_mfma_f32_16x16x32_bf16 v[252:255], v[124:127], v[92:95], v[252:255]
    s_waitcnt lgkmcnt(0)
    v_mul_f32 v8, s40, v8
    v_mul_f32 v9, s40, v9
    v_mfma_f32_16x16x32_bf16 v[128:131], v[48:51], v[32:35], v[128:131]
    ds_read_b64_tr_b16 v[96:97], v27 offset:8704
    ds_read_b64_tr_b16 v[98:99], v27 offset:9728
    v_mfma_f32_16x16x32_bf16 v[160:163], v[48:51], v[36:39], v[160:163]
    s_add_u32 s36, s45, 1408
    v_mul_f32 v10, s40, v10
    v_mul_f32 v11, s40, v11
    v_mfma_f32_16x16x32_bf16 v[192:195], v[48:51], v[40:43], v[192:195]
    s_add_u32 m0, s42, 36864
    ds_read_b128 v[80:83], v26 offset:0
    ds_read_b128 v[84:87], v26 offset:2048
    v_mfma_f32_16x16x32_bf16 v[224:227], v[48:51], v[44:47], v[224:227]
    buffer_load_dwordx4 v17, s[24:27], s36 offen offset:0 lds
    v_mfma_f32_16x16x32_bf16 v[132:135], v[52:55], v[32:35], v[132:135]
    ds_read_b128 v[88:91], v26 offset:4096
    ds_read_b128 v[92:95], v26 offset:6144
    v_mfma_f32_16x16x32_bf16 v[164:167], v[52:55], v[36:39], v[164:167]
    v_mul_f32 v12, s40, v12
    v_mul_f32 v13, s40, v13
    v_mfma_f32_16x16x32_bf16 v[196:199], v[52:55], v[40:43], v[196:199]
    ds_read_b64_tr_b16 v[100:101], v28 offset:8704
    ds_read_b64_tr_b16 v[102:103], v28 offset:9728
    v_mfma_f32_16x16x32_bf16 v[228:231], v[52:55], v[44:47], v[228:231]
    buffer_load_dwordx4 v18, s[24:27], s36 offen offset:1024 lds
    v_mfma_f32_16x16x32_bf16 v[136:139], v[56:59], v[32:35], v[136:139]
    ds_read_b64_tr_b16 v[104:105], v29 offset:8704
    ds_read_b64_tr_b16 v[106:107], v29 offset:9728
    v_mfma_f32_16x16x32_bf16 v[168:171], v[56:59], v[36:39], v[168:171]
    v_mul_f32 v14, s40, v14
    v_mul_f32 v15, s40, v15
    v_mfma_f32_16x16x32_bf16 v[200:203], v[56:59], v[40:43], v[200:203]
    ds_read_b64_tr_b16 v[108:109], v30 offset:8704
    ds_read_b64_tr_b16 v[110:111], v30 offset:9728
    v_mfma_f32_16x16x32_bf16 v[232:235], v[56:59], v[44:47], v[232:235]
    v_mfma_f32_16x16x32_bf16 v[140:143], v[60:63], v[32:35], v[140:143]
    ds_read_b64_tr_b16 v[112:113], v27 offset:8832
    ds_read_b64_tr_b16 v[114:115], v27 offset:9856
    v_mfma_f32_16x16x32_bf16 v[172:175], v[60:63], v[36:39], v[172:175]
    v_cvt_pk_bf16_f32 v8, v8, v9
    v_cvt_pk_bf16_f32 v9, v10, v11
    v_mfma_f32_16x16x32_bf16 v[204:207], v[60:63], v[40:43], v[204:207]
    ds_read_b64_tr_b16 v[116:117], v28 offset:8832
    ds_read_b64_tr_b16 v[118:119], v28 offset:9856
    v_mfma_f32_16x16x32_bf16 v[236:239], v[60:63], v[44:47], v[236:239]
    buffer_load_dwordx4 v19, s[24:27], s36 offen offset:2048 lds
    v_mfma_f32_16x16x32_bf16 v[144:147], v[64:67], v[32:35], v[144:147]
    ds_read_b64_tr_b16 v[120:121], v29 offset:8832
    ds_read_b64_tr_b16 v[122:123], v29 offset:9856
    v_mfma_f32_16x16x32_bf16 v[176:179], v[64:67], v[36:39], v[176:179]
    v_cvt_pk_bf16_f32 v10, v12, v13
    v_cvt_pk_bf16_f32 v11, v14, v15
    v_mfma_f32_16x16x32_bf16 v[208:211], v[64:67], v[40:43], v[208:211]
    ds_read_b64_tr_b16 v[124:125], v30 offset:8832
    ds_read_b64_tr_b16 v[126:127], v30 offset:9856
    v_mfma_f32_16x16x32_bf16 v[240:243], v[64:67], v[44:47], v[240:243]
    v_mfma_f32_16x16x32_bf16 v[148:151], v[68:71], v[32:35], v[148:151]
    v_mfma_f32_16x16x32_bf16 v[180:183], v[68:71], v[36:39], v[180:183]
    buffer_load_dwordx4 v20, s[24:27], s36 offen offset:3072 lds
    v_mfma_f32_16x16x32_bf16 v[212:215], v[68:71], v[40:43], v[212:215]
    s_add_u32 s37, s49, 6029312
    v_mfma_f32_16x16x32_bf16 v[244:247], v[68:71], v[44:47], v[244:247]
    s_add_u32 m0, s50, 43520
    v_mfma_f32_16x16x32_bf16 v[152:155], v[72:75], v[32:35], v[152:155]
    buffer_load_dwordx4 v21, s[20:23], s37 offen offset:0 lds
    v_mfma_f32_16x16x32_bf16 v[184:187], v[72:75], v[36:39], v[184:187]
    v_mfma_f32_16x16x32_bf16 v[216:219], v[72:75], v[40:43], v[216:219]
    v_mfma_f32_16x16x32_bf16 v[248:251], v[72:75], v[44:47], v[248:251]
    buffer_store_dwordx4 v[8:11], v16, s[16:19], s41 offen offset:1024
    v_mfma_f32_16x16x32_bf16 v[156:159], v[76:79], v[32:35], v[156:159]
    s_add_u32 s41, s41, 12288
    v_mfma_f32_16x16x32_bf16 v[188:191], v[76:79], v[36:39], v[188:191]
    v_mov_b32 v1, 1
    v_mov_b32 v0, 0
    v_mfma_f32_16x16x32_bf16 v[220:223], v[76:79], v[40:43], v[220:223]
    buffer_load_dwordx4 v22, s[20:23], s37 offen offset:1024 lds
    v_mfma_f32_16x16x32_bf16 v[252:255], v[76:79], v[44:47], v[252:255]
    s_waitcnt vmcnt(15) lgkmcnt(0)
    s_barrier
    v_bfe_u32 v3, v16, 1, 8
    v_mfma_f32_16x16x32_bf16 v[128:131], v[96:99], v[80:83], v[128:131]
    s_lshl_b32 s40, s33, 7
    ds_read_b64_tr_b16 v[48:49], v27 offset:17408
    ds_read_b64_tr_b16 v[50:51], v27 offset:18432
    v_mfma_f32_16x16x32_bf16 v[160:163], v[96:99], v[84:87], v[160:163]
    s_add_u32 s36, s44, 1536
    v_mfma_f32_16x16x32_bf16 v[192:195], v[96:99], v[88:91], v[192:195]
    s_add_u32 m0, s42, 65536
    ds_read_b128 v[32:35], v23 offset:0
    ds_read_b128 v[36:39], v23 offset:2048
    v_mfma_f32_16x16x32_bf16 v[224:227], v[96:99], v[92:95], v[224:227]
    buffer_load_dwordx4 v17, s[24:27], s36 offen offset:0 lds
    v_mfma_f32_16x16x32_bf16 v[132:135], v[100:103], v[80:83], v[132:135]
    s_add_u32 s40, s40, 393216
    ds_read_b128 v[40:43], v23 offset:4096
    ds_read_b128 v[44:47], v23 offset:6144
    v_mfma_f32_16x16x32_bf16 v[164:167], v[100:103], v[84:87], v[164:167]
    v_mov_b32 v10, 0x0f0f0f0f
    v_mov_b32 v4, 0
    v_mfma_f32_16x16x32_bf16 v[196:199], v[100:103], v[88:91], v[196:199]
    ds_read_b64_tr_b16 v[52:53], v28 offset:17408
    ds_read_b64_tr_b16 v[54:55], v28 offset:18432
    v_mfma_f32_16x16x32_bf16 v[228:231], v[100:103], v[92:95], v[228:231]
    buffer_load_dwordx4 v18, s[24:27], s36 offen offset:1024 lds
    v_mfma_f32_16x16x32_bf16 v[136:139], v[104:107], v[80:83], v[136:139]
    ds_read_b64_tr_b16 v[56:57], v29 offset:17408
    ds_read_b64_tr_b16 v[58:59], v29 offset:18432
    v_mfma_f32_16x16x32_bf16 v[168:171], v[104:107], v[84:87], v[168:171]
    v_mov_b32 v5, 0
    v_mov_b32 v6, 0
    v_mfma_f32_16x16x32_bf16 v[200:203], v[104:107], v[88:91], v[200:203]
    ds_read_b64_tr_b16 v[60:61], v30 offset:17408
    ds_read_b64_tr_b16 v[62:63], v30 offset:18432
    v_mfma_f32_16x16x32_bf16 v[232:235], v[104:107], v[92:95], v[232:235]
    buffer_load_dword v9, v3, s[76:79], 0 offen sc1
    v_mfma_f32_16x16x32_bf16 v[140:143], v[108:111], v[80:83], v[140:143]
    ds_read_b64_tr_b16 v[64:65], v27 offset:17536
    ds_read_b64_tr_b16 v[66:67], v27 offset:18560
    v_mfma_f32_16x16x32_bf16 v[172:175], v[108:111], v[84:87], v[172:175]
    v_mov_b32 v7, 0
    v_mov_b32 v8, 153600
    v_mfma_f32_16x16x32_bf16 v[204:207], v[108:111], v[88:91], v[204:207]
    ds_read_b64_tr_b16 v[68:69], v28 offset:17536
    ds_read_b64_tr_b16 v[70:71], v28 offset:18560
    v_mfma_f32_16x16x32_bf16 v[236:239], v[108:111], v[92:95], v[236:239]
    buffer_load_dwordx4 v19, s[24:27], s36 offen offset:2048 lds
    v_mfma_f32_16x16x32_bf16 v[144:147], v[112:115], v[80:83], v[144:147]
    ds_read_b64_tr_b16 v[72:73], v29 offset:17536
    ds_read_b64_tr_b16 v[74:75], v29 offset:18560
    v_mfma_f32_16x16x32_bf16 v[176:179], v[112:115], v[84:87], v[176:179]
    ds_write_b128 v8, v[4:7]
    ds_read_b128 a[0:3], v8
    v_mfma_f32_16x16x32_bf16 v[208:211], v[112:115], v[88:91], v[208:211]
    ds_read_b64_tr_b16 v[76:77], v30 offset:17536
    ds_read_b64_tr_b16 v[78:79], v30 offset:18560
    v_mfma_f32_16x16x32_bf16 v[240:243], v[112:115], v[92:95], v[240:243]
    ds_read_b128 a[4:7], v8
    ds_read_b128 a[8:11], v8
    v_mfma_f32_16x16x32_bf16 v[148:151], v[116:119], v[80:83], v[148:151]
    ds_read_b128 a[12:15], v8
    ds_read_b128 a[16:19], v8
    v_mfma_f32_16x16x32_bf16 v[180:183], v[116:119], v[84:87], v[180:183]
    buffer_load_dwordx4 v20, s[24:27], s36 offen offset:3072 lds
    v_mfma_f32_16x16x32_bf16 v[212:215], v[116:119], v[88:91], v[212:215]
    s_add_u32 s37, s49, 6291456
    ds_read_b128 a[20:23], v8
    ds_read_b128 a[24:27], v8
    v_mfma_f32_16x16x32_bf16 v[244:247], v[116:119], v[92:95], v[244:247]
    s_add_u32 m0, s50, 0
    ds_read_b128 a[28:31], v8
    ds_read_b128 a[32:35], v8
    v_mfma_f32_16x16x32_bf16 v[152:155], v[120:123], v[80:83], v[152:155]
    buffer_load_dwordx4 v21, s[20:23], s37 offen offset:0 lds
    v_mfma_f32_16x16x32_bf16 v[184:187], v[120:123], v[84:87], v[184:187]
    ds_read_b128 a[36:39], v8
    ds_read_b128 a[40:43], v8
    v_mfma_f32_16x16x32_bf16 v[216:219], v[120:123], v[88:91], v[216:219]
    ds_read_b128 a[44:47], v8
    ds_read_b128 a[48:51], v8
    v_mfma_f32_16x16x32_bf16 v[248:251], v[120:123], v[92:95], v[248:251]
    v_mfma_f32_16x16x32_bf16 v[156:159], v[124:127], v[80:83], v[156:159]
    v_mfma_f32_16x16x32_bf16 v[188:191], v[124:127], v[84:87], v[188:191]
    v_mfma_f32_16x16x32_bf16 v[220:223], v[124:127], v[88:91], v[220:223]
    buffer_load_dwordx4 v22, s[20:23], s37 offen offset:1024 lds
    v_mfma_f32_16x16x32_bf16 v[252:255], v[124:127], v[92:95], v[252:255]
    s_waitcnt lgkmcnt(0)
    v_mfma_f32_16x16x32_bf16 v[128:131], v[48:51], v[32:35], v[128:131]
    s_getreg_b32 s58, hwreg(HW_REG_XCC_ID, 0, 3)
    ds_read_b64_tr_b16 v[96:97], v27 offset:26112
    ds_read_b64_tr_b16 v[98:99], v27 offset:27136
    v_mfma_f32_16x16x32_bf16 v[160:163], v[48:51], v[36:39], v[160:163]
    s_add_u32 s36, s45, 1536
    ds_read_b128 a[52:55], v8
    ds_read_b128 a[56:59], v8
    v_mfma_f32_16x16x32_bf16 v[192:195], v[48:51], v[40:43], v[192:195]
    s_add_u32 m0, s42, 69632
    ds_read_b128 v[80:83], v24 offset:0
    ds_read_b128 v[84:87], v24 offset:2048
    v_mfma_f32_16x16x32_bf16 v[224:227], v[48:51], v[44:47], v[224:227]
    buffer_load_dwordx4 v17, s[24:27], s36 offen offset:0 lds
    v_mfma_f32_16x16x32_bf16 v[132:135], v[52:55], v[32:35], v[132:135]
    s_lshl_b32 s58, s58, 2
    ds_read_b128 v[88:91], v24 offset:4096
    ds_read_b128 v[92:95], v24 offset:6144
    v_mfma_f32_16x16x32_bf16 v[164:167], v[52:55], v[36:39], v[164:167]
    s_lshl_b32 s58, 8, s58
    ds_read_b128 a[60:63], v8
    ds_read_b128 a[64:67], v8
    v_mfma_f32_16x16x32_bf16 v[196:199], v[52:55], v[40:43], v[196:199]
    ds_read_b64_tr_b16 v[100:101], v28 offset:26112
    ds_read_b64_tr_b16 v[102:103], v28 offset:27136
    v_mfma_f32_16x16x32_bf16 v[228:231], v[52:55], v[44:47], v[228:231]
    buffer_load_dwordx4 v18, s[24:27], s36 offen offset:1024 lds
    v_mfma_f32_16x16x32_bf16 v[136:139], v[56:59], v[32:35], v[136:139]
    ds_read_b64_tr_b16 v[104:105], v29 offset:26112
    ds_read_b64_tr_b16 v[106:107], v29 offset:27136
    v_mfma_f32_16x16x32_bf16 v[168:171], v[56:59], v[36:39], v[168:171]
    ds_read_b128 a[68:71], v8
    ds_read_b128 a[72:75], v8
    v_mfma_f32_16x16x32_bf16 v[200:203], v[56:59], v[40:43], v[200:203]
    ds_read_b64_tr_b16 v[108:109], v30 offset:26112
    ds_read_b64_tr_b16 v[110:111], v30 offset:27136
    v_mfma_f32_16x16x32_bf16 v[232:235], v[56:59], v[44:47], v[232:235]
    v_mfma_f32_16x16x32_bf16 v[140:143], v[60:63], v[32:35], v[140:143]
    ds_read_b64_tr_b16 v[112:113], v27 offset:26240
    ds_read_b64_tr_b16 v[114:115], v27 offset:27264
    v_mfma_f32_16x16x32_bf16 v[172:175], v[60:63], v[36:39], v[172:175]
    ds_read_b128 a[76:79], v8
    ds_read_b128 a[80:83], v8
    v_mfma_f32_16x16x32_bf16 v[204:207], v[60:63], v[40:43], v[204:207]
    ds_read_b64_tr_b16 v[116:117], v28 offset:26240
    ds_read_b64_tr_b16 v[118:119], v28 offset:27264
    v_mfma_f32_16x16x32_bf16 v[236:239], v[60:63], v[44:47], v[236:239]
    buffer_load_dwordx4 v19, s[24:27], s36 offen offset:2048 lds
    v_mfma_f32_16x16x32_bf16 v[144:147], v[64:67], v[32:35], v[144:147]
    ds_read_b64_tr_b16 v[120:121], v29 offset:26240
    ds_read_b64_tr_b16 v[122:123], v29 offset:27264
    v_mfma_f32_16x16x32_bf16 v[176:179], v[64:67], v[36:39], v[176:179]
    ds_read_b128 a[84:87], v8
    ds_read_b128 a[88:91], v8
    v_mfma_f32_16x16x32_bf16 v[208:211], v[64:67], v[40:43], v[208:211]
    ds_read_b64_tr_b16 v[124:125], v30 offset:26240
    ds_read_b64_tr_b16 v[126:127], v30 offset:27264
    v_mfma_f32_16x16x32_bf16 v[240:243], v[64:67], v[44:47], v[240:243]
    ds_read_b128 a[92:95], v8
    ds_read_b128 a[96:99], v8
    v_mfma_f32_16x16x32_bf16 v[148:151], v[68:71], v[32:35], v[148:151]
    ds_read_b128 a[100:103], v8
    ds_read_b128 a[104:107], v8
    v_mfma_f32_16x16x32_bf16 v[180:183], v[68:71], v[36:39], v[180:183]
    buffer_load_dwordx4 v20, s[24:27], s36 offen offset:3072 lds
    v_mfma_f32_16x16x32_bf16 v[212:215], v[68:71], v[40:43], v[212:215]
    s_add_u32 s37, s49, 6553600
    ds_read_b128 a[108:111], v8
    ds_read_b128 a[112:115], v8
    v_mfma_f32_16x16x32_bf16 v[244:247], v[68:71], v[44:47], v[244:247]
    s_add_u32 m0, s50, 8704
    ds_read_b128 a[116:119], v8
    ds_read_b128 a[120:123], v8
    v_mfma_f32_16x16x32_bf16 v[152:155], v[72:75], v[32:35], v[152:155]
    buffer_load_dwordx4 v21, s[20:23], s37 offen offset:0 lds
    v_mfma_f32_16x16x32_bf16 v[184:187], v[72:75], v[36:39], v[184:187]
    ds_read_b128 a[124:127], v8
    v_mfma_f32_16x16x32_bf16 v[216:219], v[72:75], v[40:43], v[216:219]
    v_mfma_f32_16x16x32_bf16 v[248:251], v[72:75], v[44:47], v[248:251]
    v_mfma_f32_16x16x32_bf16 v[156:159], v[76:79], v[32:35], v[156:159]
    v_mfma_f32_16x16x32_bf16 v[188:191], v[76:79], v[36:39], v[188:191]
    v_mfma_f32_16x16x32_bf16 v[220:223], v[76:79], v[40:43], v[220:223]
    buffer_load_dwordx4 v22, s[20:23], s37 offen offset:1024 lds
    v_mfma_f32_16x16x32_bf16 v[252:255], v[76:79], v[44:47], v[252:255]
    s_waitcnt vmcnt(10) lgkmcnt(0)
    s_barrier
    v_readlane_b32 s54, v9, s33
    v_and_b32 v11, v10, v9
    v_mfma_f32_16x16x32_bf16 v[128:131], v[96:99], v[80:83], v[128:131]
    ds_read_b64_tr_b16 v[48:49], v27 offset:34816
    ds_read_b64_tr_b16 v[50:51], v27 offset:35840
    v_mfma_f32_16x16x32_bf16 v[160:163], v[96:99], v[84:87], v[160:163]
    s_add_u32 s36, s44, 1664
    v_lshrrev_b32 v12, 4, v9
    v_and_b32 v12, v10, v12
    v_mfma_f32_16x16x32_bf16 v[192:195], v[96:99], v[88:91], v[192:195]
    s_add_u32 m0, s42, 0
    ds_read_b128 v[32:35], v23 offset:32768
    ds_read_b128 v[36:39], v23 offset:34816
    v_mfma_f32_16x16x32_bf16 v[224:227], v[96:99], v[92:95], v[224:227]
    buffer_load_dwordx4 v17, s[24:27], s36 offen offset:0 lds
    v_mfma_f32_16x16x32_bf16 v[132:135], v[100:103], v[80:83], v[132:135]
    ds_read_b128 v[40:43], v23 offset:36864
    ds_read_b128 v[44:47], v23 offset:38912
    v_mfma_f32_16x16x32_bf16 v[164:167], v[100:103], v[84:87], v[164:167]
    v_sad_u8 v11, v11, 0, 0
    v_sad_u8 v11, v12, 0, v11
    v_mfma_f32_16x16x32_bf16 v[196:199], v[100:103], v[88:91], v[196:199]
    ds_read_b64_tr_b16 v[52:53], v28 offset:34816
    ds_read_b64_tr_b16 v[54:55], v28 offset:35840
    v_mfma_f32_16x16x32_bf16 v[228:231], v[100:103], v[92:95], v[228:231]
    buffer_load_dwordx4 v18, s[24:27], s36 offen offset:1024 lds
    v_mfma_f32_16x16x32_bf16 v[136:139], v[104:107], v[80:83], v[136:139]
    ds_read_b64_tr_b16 v[56:57], v29 offset:34816
    ds_read_b64_tr_b16 v[58:59], v29 offset:35840
    v_mfma_f32_16x16x32_bf16 v[168:171], v[104:107], v[84:87], v[168:171]
    v_cmp_ne_u32 vcc, 8, v11
    v_bfe_u32 v3, v16, 2, 5
    v_mfma_f32_16x16x32_bf16 v[200:203], v[104:107], v[88:91], v[200:203]
    ds_read_b64_tr_b16 v[60:61], v30 offset:34816
    ds_read_b64_tr_b16 v[62:63], v30 offset:35840
    v_mfma_f32_16x16x32_bf16 v[232:235], v[104:107], v[92:95], v[232:235]
    v_mfma_f32_16x16x32_bf16 v[140:143], v[108:111], v[80:83], v[140:143]
    s_cbranch_vccnz gated_mix__ssm_conv_h3__compressed_kv_cla__prompt_kernel_wb
    ds_read_b64_tr_b16 v[64:65], v27 offset:34944
    ds_read_b64_tr_b16 v[66:67], v27 offset:35968
    v_mfma_f32_16x16x32_bf16 v[172:175], v[108:111], v[84:87], v[172:175]
    s_cmp_lg_u32 s54, s58
    s_cbranch_scc1 gated_mix__ssm_conv_h3__compressed_kv_cla__prompt_kernel_wb
gated_mix__ssm_conv_h3__compressed_kv_cla__prompt_kernel_wb_ret:
    v_mfma_f32_16x16x32_bf16 v[204:207], v[108:111], v[88:91], v[204:207]
    ds_read_b64_tr_b16 v[68:69], v28 offset:34944
    ds_read_b64_tr_b16 v[70:71], v28 offset:35968
    v_mfma_f32_16x16x32_bf16 v[236:239], v[108:111], v[92:95], v[236:239]
    buffer_load_dwordx4 v19, s[24:27], s36 offen offset:2048 lds
    v_mfma_f32_16x16x32_bf16 v[144:147], v[112:115], v[80:83], v[144:147]
    ds_read_b64_tr_b16 v[72:73], v29 offset:34944
    ds_read_b64_tr_b16 v[74:75], v29 offset:35968
    v_mfma_f32_16x16x32_bf16 v[176:179], v[112:115], v[84:87], v[176:179]
    v_mfma_f32_16x16x32_bf16 v[208:211], v[112:115], v[88:91], v[208:211]
    ds_read_b64_tr_b16 v[76:77], v30 offset:34944
    ds_read_b64_tr_b16 v[78:79], v30 offset:35968
    v_mfma_f32_16x16x32_bf16 v[240:243], v[112:115], v[92:95], v[240:243]
    v_mfma_f32_16x16x32_bf16 v[148:151], v[116:119], v[80:83], v[148:151]
    v_mfma_f32_16x16x32_bf16 v[180:183], v[116:119], v[84:87], v[180:183]
    buffer_load_dwordx4 v20, s[24:27], s36 offen offset:3072 lds
    v_mfma_f32_16x16x32_bf16 v[212:215], v[116:119], v[88:91], v[212:215]
    s_add_u32 s37, s49, 6815744
    v_mfma_f32_16x16x32_bf16 v[244:247], v[116:119], v[92:95], v[244:247]
    s_add_u32 m0, s50, 17408
    v_mfma_f32_16x16x32_bf16 v[152:155], v[120:123], v[80:83], v[152:155]
    buffer_load_dwordx4 v21, s[20:23], s37 offen offset:0 lds
    v_mfma_f32_16x16x32_bf16 v[184:187], v[120:123], v[84:87], v[184:187]
    v_mfma_f32_16x16x32_bf16 v[216:219], v[120:123], v[88:91], v[216:219]
    v_mfma_f32_16x16x32_bf16 v[248:251], v[120:123], v[92:95], v[248:251]
    buffer_store_dword v1, v0, s[28:31], s3 offen sc1
    v_mfma_f32_16x16x32_bf16 v[156:159], v[124:127], v[80:83], v[156:159]
    v_mfma_f32_16x16x32_bf16 v[188:191], v[124:127], v[84:87], v[188:191]
    v_mfma_f32_16x16x32_bf16 v[220:223], v[124:127], v[88:91], v[220:223]
    buffer_load_dwordx4 v22, s[20:23], s37 offen offset:1024 lds
    v_mfma_f32_16x16x32_bf16 v[252:255], v[124:127], v[92:95], v[252:255]
    s_waitcnt lgkmcnt(0)
    v_mfma_f32_16x16x32_bf16 v[128:131], v[48:51], v[32:35], v[128:131]
    ds_read_b64_tr_b16 v[96:97], v27 offset:43520
    ds_read_b64_tr_b16 v[98:99], v27 offset:44544
    v_mfma_f32_16x16x32_bf16 v[160:163], v[48:51], v[36:39], v[160:163]
    s_add_u32 s36, s45, 1664
    v_mfma_f32_16x16x32_bf16 v[192:195], v[48:51], v[40:43], v[192:195]
    s_add_u32 m0, s42, 4096
    ds_read_b128 v[80:83], v24 offset:32768
    ds_read_b128 v[84:87], v24 offset:34816
    v_mfma_f32_16x16x32_bf16 v[224:227], v[48:51], v[44:47], v[224:227]
    buffer_load_dwordx4 v17, s[24:27], s36 offen offset:0 lds
    v_mfma_f32_16x16x32_bf16 v[132:135], v[52:55], v[32:35], v[132:135]
    ds_read_b128 v[88:91], v24 offset:36864
    ds_read_b128 v[92:95], v24 offset:38912
    v_mfma_f32_16x16x32_bf16 v[164:167], v[52:55], v[36:39], v[164:167]
    v_mfma_f32_16x16x32_bf16 v[196:199], v[52:55], v[40:43], v[196:199]
    ds_read_b64_tr_b16 v[100:101], v28 offset:43520
    ds_read_b64_tr_b16 v[102:103], v28 offset:44544
    v_mfma_f32_16x16x32_bf16 v[228:231], v[52:55], v[44:47], v[228:231]
    buffer_load_dwordx4 v18, s[24:27], s36 offen offset:1024 lds
    v_mfma_f32_16x16x32_bf16 v[136:139], v[56:59], v[32:35], v[136:139]
    ds_read_b64_tr_b16 v[104:105], v29 offset:43520
    ds_read_b64_tr_b16 v[106:107], v29 offset:44544
    v_mfma_f32_16x16x32_bf16 v[168:171], v[56:59], v[36:39], v[168:171]
    v_mfma_f32_16x16x32_bf16 v[200:203], v[56:59], v[40:43], v[200:203]
    ds_read_b64_tr_b16 v[108:109], v30 offset:43520
    ds_read_b64_tr_b16 v[110:111], v30 offset:44544
    v_mfma_f32_16x16x32_bf16 v[232:235], v[56:59], v[44:47], v[232:235]
    v_mfma_f32_16x16x32_bf16 v[140:143], v[60:63], v[32:35], v[140:143]
    ds_read_b64_tr_b16 v[112:113], v27 offset:43648
    ds_read_b64_tr_b16 v[114:115], v27 offset:44672
    v_mfma_f32_16x16x32_bf16 v[172:175], v[60:63], v[36:39], v[172:175]
    v_mfma_f32_16x16x32_bf16 v[204:207], v[60:63], v[40:43], v[204:207]
    ds_read_b64_tr_b16 v[116:117], v28 offset:43648
    ds_read_b64_tr_b16 v[118:119], v28 offset:44672
    v_mfma_f32_16x16x32_bf16 v[236:239], v[60:63], v[44:47], v[236:239]
    buffer_load_dwordx4 v19, s[24:27], s36 offen offset:2048 lds
    v_mfma_f32_16x16x32_bf16 v[144:147], v[64:67], v[32:35], v[144:147]
    ds_read_b64_tr_b16 v[120:121], v29 offset:43648
    ds_read_b64_tr_b16 v[122:123], v29 offset:44672
    v_mfma_f32_16x16x32_bf16 v[176:179], v[64:67], v[36:39], v[176:179]
    v_mfma_f32_16x16x32_bf16 v[208:211], v[64:67], v[40:43], v[208:211]
    ds_read_b64_tr_b16 v[124:125], v30 offset:43648
    ds_read_b64_tr_b16 v[126:127], v30 offset:44672
    v_mfma_f32_16x16x32_bf16 v[240:243], v[64:67], v[44:47], v[240:243]
    v_mfma_f32_16x16x32_bf16 v[148:151], v[68:71], v[32:35], v[148:151]
    v_mfma_f32_16x16x32_bf16 v[180:183], v[68:71], v[36:39], v[180:183]
    buffer_load_dwordx4 v20, s[24:27], s36 offen offset:3072 lds
    v_mfma_f32_16x16x32_bf16 v[212:215], v[68:71], v[40:43], v[212:215]
    s_add_u32 s37, s49, 7077888
    v_mfma_f32_16x16x32_bf16 v[244:247], v[68:71], v[44:47], v[244:247]
    s_add_u32 m0, s50, 26112
    v_mfma_f32_16x16x32_bf16 v[152:155], v[72:75], v[32:35], v[152:155]
    buffer_load_dwordx4 v21, s[20:23], s37 offen offset:0 lds
    v_mfma_f32_16x16x32_bf16 v[184:187], v[72:75], v[36:39], v[184:187]
    v_mfma_f32_16x16x32_bf16 v[216:219], v[72:75], v[40:43], v[216:219]
    v_mfma_f32_16x16x32_bf16 v[248:251], v[72:75], v[44:47], v[248:251]
    v_mfma_f32_16x16x32_bf16 v[156:159], v[76:79], v[32:35], v[156:159]
    v_mfma_f32_16x16x32_bf16 v[188:191], v[76:79], v[36:39], v[188:191]
    v_mfma_f32_16x16x32_bf16 v[220:223], v[76:79], v[40:43], v[220:223]
    buffer_load_dwordx4 v22, s[20:23], s37 offen offset:1024 lds
    v_mfma_f32_16x16x32_bf16 v[252:255], v[76:79], v[44:47], v[252:255]
    s_waitcnt vmcnt(13) lgkmcnt(0)
    s_barrier
    v_mfma_f32_16x16x32_bf16 v[128:131], v[96:99], v[80:83], v[128:131]
    ds_read_b64_tr_b16 v[48:49], v27 offset:0
    ds_read_b64_tr_b16 v[50:51], v27 offset:1024
    v_mfma_f32_16x16x32_bf16 v[160:163], v[96:99], v[84:87], v[160:163]
    s_add_u32 s36, s44, 1792
    v_mfma_f32_16x16x32_bf16 v[192:195], v[96:99], v[88:91], v[192:195]
    s_add_u32 m0, s42, 32768
    ds_read_b128 v[32:35], v25 offset:0
    ds_read_b128 v[36:39], v25 offset:2048
    v_mfma_f32_16x16x32_bf16 v[224:227], v[96:99], v[92:95], v[224:227]
    buffer_load_dwordx4 v17, s[24:27], s36 offen offset:0 lds
    v_mfma_f32_16x16x32_bf16 v[132:135], v[100:103], v[80:83], v[132:135]
    ds_read_b128 v[40:43], v25 offset:4096
    ds_read_b128 v[44:47], v25 offset:6144
    v_mfma_f32_16x16x32_bf16 v[164:167], v[100:103], v[84:87], v[164:167]
    v_mfma_f32_16x16x32_bf16 v[196:199], v[100:103], v[88:91], v[196:199]
    ds_read_b64_tr_b16 v[52:53], v28 offset:0
    ds_read_b64_tr_b16 v[54:55], v28 offset:1024
    v_mfma_f32_16x16x32_bf16 v[228:231], v[100:103], v[92:95], v[228:231]
    buffer_load_dwordx4 v18, s[24:27], s36 offen offset:1024 lds
    v_mfma_f32_16x16x32_bf16 v[136:139], v[104:107], v[80:83], v[136:139]
    ds_read_b64_tr_b16 v[56:57], v29 offset:0
    ds_read_b64_tr_b16 v[58:59], v29 offset:1024
    v_mfma_f32_16x16x32_bf16 v[168:171], v[104:107], v[84:87], v[168:171]
    v_mfma_f32_16x16x32_bf16 v[200:203], v[104:107], v[88:91], v[200:203]
    ds_read_b64_tr_b16 v[60:61], v30 offset:0
    ds_read_b64_tr_b16 v[62:63], v30 offset:1024
    v_mfma_f32_16x16x32_bf16 v[232:235], v[104:107], v[92:95], v[232:235]
    v_mfma_f32_16x16x32_bf16 v[140:143], v[108:111], v[80:83], v[140:143]
    ds_read_b64_tr_b16 v[64:65], v27 offset:128
    ds_read_b64_tr_b16 v[66:67], v27 offset:1152
    v_mfma_f32_16x16x32_bf16 v[172:175], v[108:111], v[84:87], v[172:175]
    v_mfma_f32_16x16x32_bf16 v[204:207], v[108:111], v[88:91], v[204:207]
    ds_read_b64_tr_b16 v[68:69], v28 offset:128
    ds_read_b64_tr_b16 v[70:71], v28 offset:1152
    v_mfma_f32_16x16x32_bf16 v[236:239], v[108:111], v[92:95], v[236:239]
    buffer_load_dwordx4 v19, s[24:27], s36 offen offset:2048 lds
    v_mfma_f32_16x16x32_bf16 v[144:147], v[112:115], v[80:83], v[144:147]
    ds_read_b64_tr_b16 v[72:73], v29 offset:128
    ds_read_b64_tr_b16 v[74:75], v29 offset:1152
    v_mfma_f32_16x16x32_bf16 v[176:179], v[112:115], v[84:87], v[176:179]
    v_mfma_f32_16x16x32_bf16 v[208:211], v[112:115], v[88:91], v[208:211]
    ds_read_b64_tr_b16 v[76:77], v30 offset:128
    ds_read_b64_tr_b16 v[78:79], v30 offset:1152
    v_mfma_f32_16x16x32_bf16 v[240:243], v[112:115], v[92:95], v[240:243]
    v_mfma_f32_16x16x32_bf16 v[148:151], v[116:119], v[80:83], v[148:151]
    v_mfma_f32_16x16x32_bf16 v[180:183], v[116:119], v[84:87], v[180:183]
    buffer_load_dwordx4 v20, s[24:27], s36 offen offset:3072 lds
    v_mfma_f32_16x16x32_bf16 v[212:215], v[116:119], v[88:91], v[212:215]
    s_add_u32 s37, s49, 7340032
    v_mfma_f32_16x16x32_bf16 v[244:247], v[116:119], v[92:95], v[244:247]
    s_add_u32 m0, s50, 34816
    v_mfma_f32_16x16x32_bf16 v[152:155], v[120:123], v[80:83], v[152:155]
    buffer_load_dwordx4 v21, s[20:23], s37 offen offset:0 lds
    v_mfma_f32_16x16x32_bf16 v[184:187], v[120:123], v[84:87], v[184:187]
    v_mfma_f32_16x16x32_bf16 v[216:219], v[120:123], v[88:91], v[216:219]
    v_mfma_f32_16x16x32_bf16 v[248:251], v[120:123], v[92:95], v[248:251]
    v_mfma_f32_16x16x32_bf16 v[156:159], v[124:127], v[80:83], v[156:159]
    v_mfma_f32_16x16x32_bf16 v[188:191], v[124:127], v[84:87], v[188:191]
    v_mfma_f32_16x16x32_bf16 v[220:223], v[124:127], v[88:91], v[220:223]
    buffer_load_dwordx4 v22, s[20:23], s37 offen offset:1024 lds
    v_mfma_f32_16x16x32_bf16 v[252:255], v[124:127], v[92:95], v[252:255]
    s_waitcnt lgkmcnt(0)
    v_mfma_f32_16x16x32_bf16 v[128:131], v[48:51], v[32:35], v[128:131]
    ds_read_b64_tr_b16 v[96:97], v27 offset:8704
    ds_read_b64_tr_b16 v[98:99], v27 offset:9728
    v_mfma_f32_16x16x32_bf16 v[160:163], v[48:51], v[36:39], v[160:163]
    s_add_u32 s36, s45, 1792
    v_mfma_f32_16x16x32_bf16 v[192:195], v[48:51], v[40:43], v[192:195]
    s_add_u32 m0, s42, 36864
    ds_read_b128 v[80:83], v26 offset:0
    ds_read_b128 v[84:87], v26 offset:2048
    v_mfma_f32_16x16x32_bf16 v[224:227], v[48:51], v[44:47], v[224:227]
    buffer_load_dwordx4 v17, s[24:27], s36 offen offset:0 lds
    v_mfma_f32_16x16x32_bf16 v[132:135], v[52:55], v[32:35], v[132:135]
    ds_read_b128 v[88:91], v26 offset:4096
    ds_read_b128 v[92:95], v26 offset:6144
    v_mfma_f32_16x16x32_bf16 v[164:167], v[52:55], v[36:39], v[164:167]
    v_mfma_f32_16x16x32_bf16 v[196:199], v[52:55], v[40:43], v[196:199]
    ds_read_b64_tr_b16 v[100:101], v28 offset:8704
    ds_read_b64_tr_b16 v[102:103], v28 offset:9728
    v_mfma_f32_16x16x32_bf16 v[228:231], v[52:55], v[44:47], v[228:231]
    buffer_load_dwordx4 v18, s[24:27], s36 offen offset:1024 lds
    v_mfma_f32_16x16x32_bf16 v[136:139], v[56:59], v[32:35], v[136:139]
    ds_read_b64_tr_b16 v[104:105], v29 offset:8704
    ds_read_b64_tr_b16 v[106:107], v29 offset:9728
    v_mfma_f32_16x16x32_bf16 v[168:171], v[56:59], v[36:39], v[168:171]
    v_mfma_f32_16x16x32_bf16 v[200:203], v[56:59], v[40:43], v[200:203]
    ds_read_b64_tr_b16 v[108:109], v30 offset:8704
    ds_read_b64_tr_b16 v[110:111], v30 offset:9728
    v_mfma_f32_16x16x32_bf16 v[232:235], v[56:59], v[44:47], v[232:235]
    v_mfma_f32_16x16x32_bf16 v[140:143], v[60:63], v[32:35], v[140:143]
    ds_read_b64_tr_b16 v[112:113], v27 offset:8832
    ds_read_b64_tr_b16 v[114:115], v27 offset:9856
    v_mfma_f32_16x16x32_bf16 v[172:175], v[60:63], v[36:39], v[172:175]
    v_mfma_f32_16x16x32_bf16 v[204:207], v[60:63], v[40:43], v[204:207]
    ds_read_b64_tr_b16 v[116:117], v28 offset:8832
    ds_read_b64_tr_b16 v[118:119], v28 offset:9856
    v_mfma_f32_16x16x32_bf16 v[236:239], v[60:63], v[44:47], v[236:239]
    buffer_load_dwordx4 v19, s[24:27], s36 offen offset:2048 lds
    v_mfma_f32_16x16x32_bf16 v[144:147], v[64:67], v[32:35], v[144:147]
    ds_read_b64_tr_b16 v[120:121], v29 offset:8832
    ds_read_b64_tr_b16 v[122:123], v29 offset:9856
    v_mfma_f32_16x16x32_bf16 v[176:179], v[64:67], v[36:39], v[176:179]
    v_mfma_f32_16x16x32_bf16 v[208:211], v[64:67], v[40:43], v[208:211]
    ds_read_b64_tr_b16 v[124:125], v30 offset:8832
    ds_read_b64_tr_b16 v[126:127], v30 offset:9856
    v_mfma_f32_16x16x32_bf16 v[240:243], v[64:67], v[44:47], v[240:243]
gated_mix__ssm_conv_h3__compressed_kv_cla__prompt_kernel_pad7:
    s_cbranch_execz gated_mix__ssm_conv_h3__compressed_kv_cla__prompt_kernel_pad15
    v_mfma_f32_16x16x32_bf16 v[148:151], v[68:71], v[32:35], v[148:151]
    v_mfma_f32_16x16x32_bf16 v[180:183], v[68:71], v[36:39], v[180:183]
    buffer_load_dwordx4 v20, s[24:27], s36 offen offset:3072 lds
    v_mfma_f32_16x16x32_bf16 v[212:215], v[68:71], v[40:43], v[212:215]
    s_add_u32 s37, s49, 7602176
    v_mfma_f32_16x16x32_bf16 v[244:247], v[68:71], v[44:47], v[244:247]
    s_add_u32 m0, s50, 43520
    v_mfma_f32_16x16x32_bf16 v[152:155], v[72:75], v[32:35], v[152:155]
    buffer_load_dwordx4 v21, s[20:23], s37 offen offset:0 lds
    v_mfma_f32_16x16x32_bf16 v[184:187], v[72:75], v[36:39], v[184:187]
    v_mfma_f32_16x16x32_bf16 v[216:219], v[72:75], v[40:43], v[216:219]
    v_mfma_f32_16x16x32_bf16 v[248:251], v[72:75], v[44:47], v[248:251]
    v_mfma_f32_16x16x32_bf16 v[156:159], v[76:79], v[32:35], v[156:159]
    v_mfma_f32_16x16x32_bf16 v[188:191], v[76:79], v[36:39], v[188:191]
    v_mfma_f32_16x16x32_bf16 v[220:223], v[76:79], v[40:43], v[220:223]
    buffer_load_dwordx4 v22, s[20:23], s37 offen offset:1024 lds
    v_mfma_f32_16x16x32_bf16 v[252:255], v[76:79], v[44:47], v[252:255]
    s_waitcnt vmcnt(12) lgkmcnt(0)
    s_barrier
    v_mfma_f32_16x16x32_bf16 v[128:131], v[96:99], v[80:83], v[128:131]
    s_add_u32 s8, s94, 67108864
    s_addc_u32 s9, s95, 0
    ds_read_b64_tr_b16 v[48:49], v27 offset:17408
    ds_read_b64_tr_b16 v[50:51], v27 offset:18432
    v_mfma_f32_16x16x32_bf16 v[160:163], v[96:99], v[84:87], v[160:163]
    s_add_u32 s36, s44, 1920
    v_mfma_f32_16x16x32_bf16 v[192:195], v[96:99], v[88:91], v[192:195]
    s_add_u32 m0, s42, 65536
    ds_read_b128 v[32:35], v23 offset:0
    ds_read_b128 v[36:39], v23 offset:2048
    v_mfma_f32_16x16x32_bf16 v[224:227], v[96:99], v[92:95], v[224:227]
    buffer_load_dwordx4 v17, s[24:27], s36 offen offset:0 lds
    v_mfma_f32_16x16x32_bf16 v[132:135], v[100:103], v[80:83], v[132:135]
    s_mov_b32 s10, 16777216
    ds_read_b128 v[40:43], v23 offset:4096
    ds_read_b128 v[44:47], v23 offset:6144
    v_mfma_f32_16x16x32_bf16 v[164:167], v[100:103], v[84:87], v[164:167]
    s_lshl_b32 s41, s2, 2
    v_mfma_f32_16x16x32_bf16 v[196:199], v[100:103], v[88:91], v[196:199]
    s_add_u32 s41, s41, s32
    ds_read_b64_tr_b16 v[52:53], v28 offset:17408
    ds_read_b64_tr_b16 v[54:55], v28 offset:18432
    v_mfma_f32_16x16x32_bf16 v[228:231], v[100:103], v[92:95], v[228:231]
    buffer_load_dwordx4 v18, s[24:27], s36 offen offset:1024 lds
    v_mfma_f32_16x16x32_bf16 v[136:139], v[104:107], v[80:83], v[136:139]
    s_lshl_b32 s41, s41, 14
    ds_read_b64_tr_b16 v[56:57], v29 offset:17408
    ds_read_b64_tr_b16 v[58:59], v29 offset:18432
    v_mfma_f32_16x16x32_bf16 v[168:171], v[104:107], v[84:87], v[168:171]
    s_add_u32 s38, s41, 4096
    v_mfma_f32_16x16x32_bf16 v[200:203], v[104:107], v[88:91], v[200:203]
    ds_read_b64_tr_b16 v[60:61], v30 offset:17408
    ds_read_b64_tr_b16 v[62:63], v30 offset:18432
    v_mfma_f32_16x16x32_bf16 v[232:235], v[104:107], v[92:95], v[232:235]
    v_mfma_f32_16x16x32_bf16 v[140:143], v[108:111], v[80:83], v[140:143]
    ds_read_b64_tr_b16 v[64:65], v27 offset:17536
    ds_read_b64_tr_b16 v[66:67], v27 offset:18560
    v_mfma_f32_16x16x32_bf16 v[172:175], v[108:111], v[84:87], v[172:175]
    v_mfma_f32_16x16x32_bf16 v[204:207], v[108:111], v[88:91], v[204:207]
    ds_read_b64_tr_b16 v[68:69], v28 offset:17536
    ds_read_b64_tr_b16 v[70:71], v28 offset:18560
    v_mfma_f32_16x16x32_bf16 v[236:239], v[108:111], v[92:95], v[236:239]
    buffer_load_dwordx4 v19, s[24:27], s36 offen offset:2048 lds
    v_mfma_f32_16x16x32_bf16 v[144:147], v[112:115], v[80:83], v[144:147]
    ds_read_b64_tr_b16 v[72:73], v29 offset:17536
    ds_read_b64_tr_b16 v[74:75], v29 offset:18560
    v_mfma_f32_16x16x32_bf16 v[176:179], v[112:115], v[84:87], v[176:179]
    v_mfma_f32_16x16x32_bf16 v[208:211], v[112:115], v[88:91], v[208:211]
    ds_read_b64_tr_b16 v[76:77], v30 offset:17536
    ds_read_b64_tr_b16 v[78:79], v30 offset:18560
    v_mfma_f32_16x16x32_bf16 v[240:243], v[112:115], v[92:95], v[240:243]
    v_mfma_f32_16x16x32_bf16 v[148:151], v[116:119], v[80:83], v[148:151]
    v_mfma_f32_16x16x32_bf16 v[180:183], v[116:119], v[84:87], v[180:183]
    buffer_load_dwordx4 v20, s[24:27], s36 offen offset:3072 lds
    v_mfma_f32_16x16x32_bf16 v[212:215], v[116:119], v[88:91], v[212:215]
    s_add_u32 s37, s49, 7864320
    v_mfma_f32_16x16x32_bf16 v[244:247], v[116:119], v[92:95], v[244:247]
    s_add_u32 m0, s50, 0
    v_mfma_f32_16x16x32_bf16 v[152:155], v[120:123], v[80:83], v[152:155]
    buffer_load_dwordx4 v21, s[20:23], s37 offen offset:0 lds
    v_mfma_f32_16x16x32_bf16 v[184:187], v[120:123], v[84:87], v[184:187]
    v_mfma_f32_16x16x32_bf16 v[216:219], v[120:123], v[88:91], v[216:219]
    v_mfma_f32_16x16x32_bf16 v[248:251], v[120:123], v[92:95], v[248:251]
    v_mfma_f32_16x16x32_bf16 v[156:159], v[124:127], v[80:83], v[156:159]
    v_mfma_f32_16x16x32_bf16 v[188:191], v[124:127], v[84:87], v[188:191]
    v_mfma_f32_16x16x32_bf16 v[220:223], v[124:127], v[88:91], v[220:223]
    buffer_load_dwordx4 v22, s[20:23], s37 offen offset:1024 lds
    v_mfma_f32_16x16x32_bf16 v[252:255], v[124:127], v[92:95], v[252:255]
    s_waitcnt lgkmcnt(0)
    v_mfma_f32_16x16x32_bf16 v[128:131], v[48:51], v[32:35], v[128:131]
    ds_read_b64_tr_b16 v[96:97], v27 offset:26112
    ds_read_b64_tr_b16 v[98:99], v27 offset:27136
    v_mfma_f32_16x16x32_bf16 v[160:163], v[48:51], v[36:39], v[160:163]
    s_add_u32 s36, s45, 1920
    v_mfma_f32_16x16x32_bf16 v[192:195], v[48:51], v[40:43], v[192:195]
    s_add_u32 m0, s42, 69632
    ds_read_b128 v[80:83], v24 offset:0
    ds_read_b128 v[84:87], v24 offset:2048
    v_mfma_f32_16x16x32_bf16 v[224:227], v[48:51], v[44:47], v[224:227]
    buffer_load_dwordx4 v17, s[24:27], s36 offen offset:0 lds
    v_mfma_f32_16x16x32_bf16 v[132:135], v[52:55], v[32:35], v[132:135]
    ds_read_b128 v[88:91], v24 offset:4096
    ds_read_b128 v[92:95], v24 offset:6144
    v_mfma_f32_16x16x32_bf16 v[164:167], v[52:55], v[36:39], v[164:167]
    v_mfma_f32_16x16x32_bf16 v[196:199], v[52:55], v[40:43], v[196:199]
    ds_read_b64_tr_b16 v[100:101], v28 offset:26112
    ds_read_b64_tr_b16 v[102:103], v28 offset:27136
    v_mfma_f32_16x16x32_bf16 v[228:231], v[52:55], v[44:47], v[228:231]
    buffer_load_dwordx4 v18, s[24:27], s36 offen offset:1024 lds
    v_mfma_f32_16x16x32_bf16 v[136:139], v[56:59], v[32:35], v[136:139]
    ds_read_b64_tr_b16 v[104:105], v29 offset:26112
    ds_read_b64_tr_b16 v[106:107], v29 offset:27136
    v_mfma_f32_16x16x32_bf16 v[168:171], v[56:59], v[36:39], v[168:171]
    v_mfma_f32_16x16x32_bf16 v[200:203], v[56:59], v[40:43], v[200:203]
    ds_read_b64_tr_b16 v[108:109], v30 offset:26112
    ds_read_b64_tr_b16 v[110:111], v30 offset:27136
    v_mfma_f32_16x16x32_bf16 v[232:235], v[56:59], v[44:47], v[232:235]
    v_mfma_f32_16x16x32_bf16 v[140:143], v[60:63], v[32:35], v[140:143]
    ds_read_b64_tr_b16 v[112:113], v27 offset:26240
    ds_read_b64_tr_b16 v[114:115], v27 offset:27264
    v_mfma_f32_16x16x32_bf16 v[172:175], v[60:63], v[36:39], v[172:175]
    v_mfma_f32_16x16x32_bf16 v[204:207], v[60:63], v[40:43], v[204:207]
    ds_read_b64_tr_b16 v[116:117], v28 offset:26240
    ds_read_b64_tr_b16 v[118:119], v28 offset:27264
    v_mfma_f32_16x16x32_bf16 v[236:239], v[60:63], v[44:47], v[236:239]
    buffer_load_dwordx4 v19, s[24:27], s36 offen offset:2048 lds
    v_mfma_f32_16x16x32_bf16 v[144:147], v[64:67], v[32:35], v[144:147]
    ds_read_b64_tr_b16 v[120:121], v29 offset:26240
    ds_read_b64_tr_b16 v[122:123], v29 offset:27264
    v_mfma_f32_16x16x32_bf16 v[176:179], v[64:67], v[36:39], v[176:179]
    v_mfma_f32_16x16x32_bf16 v[208:211], v[64:67], v[40:43], v[208:211]
    ds_read_b64_tr_b16 v[124:125], v30 offset:26240
    ds_read_b64_tr_b16 v[126:127], v30 offset:27264
    v_mfma_f32_16x16x32_bf16 v[240:243], v[64:67], v[44:47], v[240:243]
    v_mfma_f32_16x16x32_bf16 v[148:151], v[68:71], v[32:35], v[148:151]
    v_mov_b32 v12, -1
    v_mov_b32 v13, -1
    v_mfma_f32_16x16x32_bf16 v[180:183], v[68:71], v[36:39], v[180:183]
    buffer_load_dwordx4 v20, s[24:27], s36 offen offset:3072 lds
    v_mfma_f32_16x16x32_bf16 v[212:215], v[68:71], v[40:43], v[212:215]
    s_add_u32 s37, s49, 8126464
    v_mov_b32 v14, -1
    v_mov_b32 v15, -1
    v_mfma_f32_16x16x32_bf16 v[244:247], v[68:71], v[44:47], v[244:247]
    s_add_u32 m0, s50, 8704
    v_mfma_f32_16x16x32_bf16 v[152:155], v[72:75], v[32:35], v[152:155]
    buffer_load_dwordx4 v21, s[20:23], s37 offen offset:0 lds
    v_mfma_f32_16x16x32_bf16 v[184:187], v[72:75], v[36:39], v[184:187]
    v_mfma_f32_16x16x32_bf16 v[216:219], v[72:75], v[40:43], v[216:219]
    v_mfma_f32_16x16x32_bf16 v[248:251], v[72:75], v[44:47], v[248:251]
    v_mfma_f32_16x16x32_bf16 v[156:159], v[76:79], v[32:35], v[156:159]
    v_mfma_f32_16x16x32_bf16 v[188:191], v[76:79], v[36:39], v[188:191]
    v_mfma_f32_16x16x32_bf16 v[220:223], v[76:79], v[40:43], v[220:223]
    buffer_load_dwordx4 v22, s[20:23], s37 offen offset:1024 lds
    v_mfma_f32_16x16x32_bf16 v[252:255], v[76:79], v[44:47], v[252:255]
    s_waitcnt vmcnt(12) lgkmcnt(0)
    s_barrier
    v_mfma_f32_16x16x32_bf16 v[128:131], v[96:99], v[80:83], v[128:131]
    s_lshl_b32 s36, s33, 20
    ds_read_b64_tr_b16 v[48:49], v27 offset:34816
    ds_read_b64_tr_b16 v[50:51], v27 offset:35840
    v_mfma_f32_16x16x32_bf16 v[160:163], v[96:99], v[84:87], v[160:163]
    s_add_u32 s12, s94, s36
    s_addc_u32 s13, s95, 0
    v_mfma_f32_16x16x32_bf16 v[192:195], v[96:99], v[88:91], v[192:195]
    s_lshl_b32 s36, s34, 16
    ds_read_b128 v[32:35], v23 offset:32768
    ds_read_b128 v[36:39], v23 offset:34816
    v_mfma_f32_16x16x32_bf16 v[224:227], v[96:99], v[92:95], v[224:227]
    buffer_store_dwordx4 v[12:15], v16, s[8:11], s41 offen offset:0 sc1
    v_mfma_f32_16x16x32_bf16 v[132:135], v[100:103], v[80:83], v[132:135]
    s_sub_u32 s14, 1048576, s36
    ds_read_b128 v[40:43], v23 offset:36864
    ds_read_b128 v[44:47], v23 offset:38912
    v_mfma_f32_16x16x32_bf16 v[164:167], v[100:103], v[84:87], v[164:167]
    s_lshl_b32 s59, s32, 12
    v_mfma_f32_16x16x32_bf16 v[196:199], v[100:103], v[88:91], v[196:199]
    s_lshl_b32 s36, s34, 1
    ds_read_b64_tr_b16 v[52:53], v28 offset:34816
    ds_read_b64_tr_b16 v[54:55], v28 offset:35840
    v_mfma_f32_16x16x32_bf16 v[228:231], v[100:103], v[92:95], v[228:231]
    v_mfma_f32_16x16x32_bf16 v[136:139], v[104:107], v[80:83], v[136:139]
    s_add_u32 s36, s36, 3
    ds_read_b64_tr_b16 v[56:57], v29 offset:34816
    ds_read_b64_tr_b16 v[58:59], v29 offset:35840
    v_mfma_f32_16x16x32_bf16 v[168:171], v[104:107], v[84:87], v[168:171]
    s_mul_i32 s37, s36, 52
    v_mfma_f32_16x16x32_bf16 v[200:203], v[104:107], v[88:91], v[200:203]
    s_lshr_b32 s37, s37, 8
    ds_read_b64_tr_b16 v[60:61], v30 offset:34816
    ds_read_b64_tr_b16 v[62:63], v30 offset:35840
    v_mfma_f32_16x16x32_bf16 v[232:235], v[104:107], v[92:95], v[232:235]
    buffer_store_dwordx4 v[12:15], v16, s[8:11], s41 offen offset:1024 sc1
    v_mfma_f32_16x16x32_bf16 v[140:143], v[108:111], v[80:83], v[140:143]
    s_mul_i32 s37, s37, 5
    ds_read_b64_tr_b16 v[64:65], v27 offset:34944
    ds_read_b64_tr_b16 v[66:67], v27 offset:35968
    v_mfma_f32_16x16x32_bf16 v[172:175], v[108:111], v[84:87], v[172:175]
    s_sub_u32 s36, s36, s37
    v_mfma_f32_16x16x32_bf16 v[204:207], v[108:111], v[88:91], v[204:207]
    s_lshl_b32 s47, s36, 15
    ds_read_b64_tr_b16 v[68:69], v28 offset:34944
    ds_read_b64_tr_b16 v[70:71], v28 offset:35968
    v_mfma_f32_16x16x32_bf16 v[236:239], v[108:111], v[92:95], v[236:239]
    v_mfma_f32_16x16x32_bf16 v[144:147], v[112:115], v[80:83], v[144:147]
    s_add_u32 s48, s47, 32768
    ds_read_b64_tr_b16 v[72:73], v29 offset:34944
    ds_read_b64_tr_b16 v[74:75], v29 offset:35968
    v_mfma_f32_16x16x32_bf16 v[176:179], v[112:115], v[84:87], v[176:179]
    s_cmp_eq_u32 s48, 163840
    s_cselect_b32 s48, 0, s48
    v_mfma_f32_16x16x32_bf16 v[208:211], v[112:115], v[88:91], v[208:211]
    s_add_u32 s51, s48, 32768
    ds_read_b64_tr_b16 v[76:77], v30 offset:34944
    ds_read_b64_tr_b16 v[78:79], v30 offset:35968
    v_mfma_f32_16x16x32_bf16 v[240:243], v[112:115], v[92:95], v[240:243]
    s_cmp_eq_u32 s51, 163840
    s_cselect_b32 s51, 0, s51
    v_mfma_f32_16x16x32_bf16 v[148:151], v[116:119], v[80:83], v[148:151]
    s_add_u32 s52, s51, 32768
    v_mfma_f32_16x16x32_bf16 v[180:183], v[116:119], v[84:87], v[180:183]
    buffer_store_dwordx4 v[12:15], v16, s[8:11], s41 offen offset:2048 sc1
    v_mfma_f32_16x16x32_bf16 v[212:215], v[116:119], v[88:91], v[212:215]
    s_cmp_eq_u32 s52, 163840
    s_cselect_b32 s52, 0, s52
    v_mfma_f32_16x16x32_bf16 v[244:247], v[116:119], v[92:95], v[244:247]
    s_add_u32 s53, s52, 32768
    v_mfma_f32_16x16x32_bf16 v[152:155], v[120:123], v[80:83], v[152:155]
    v_mfma_f32_16x16x32_bf16 v[184:187], v[120:123], v[84:87], v[184:187]
    s_cmp_eq_u32 s53, 163840
    s_cselect_b32 s53, 0, s53
    v_mfma_f32_16x16x32_bf16 v[216:219], v[120:123], v[88:91], v[216:219]
    v_mfma_f32_16x16x32_bf16 v[248:251], v[120:123], v[92:95], v[248:251]
    buffer_store_dwordx4 v[12:15], v16, s[8:11], s41 offen offset:3072 sc1
    v_mfma_f32_16x16x32_bf16 v[156:159], v[124:127], v[80:83], v[156:159]
    v_mfma_f32_16x16x32_bf16 v[188:191], v[124:127], v[84:87], v[188:191]
    v_mfma_f32_16x16x32_bf16 v[220:223], v[124:127], v[88:91], v[220:223]
    v_mfma_f32_16x16x32_bf16 v[252:255], v[124:127], v[92:95], v[252:255]
    s_waitcnt lgkmcnt(0)
    v_mfma_f32_16x16x32_bf16 v[128:131], v[48:51], v[32:35], v[128:131]
    ds_read_b64_tr_b16 v[96:97], v27 offset:43520
    ds_read_b64_tr_b16 v[98:99], v27 offset:44544
    v_mfma_f32_16x16x32_bf16 v[160:163], v[48:51], v[36:39], v[160:163]
    s_cmp_lt_u32 s34, 2
    s_cselect_b32 s58, 4, 28
    v_mfma_f32_16x16x32_bf16 v[192:195], v[48:51], v[40:43], v[192:195]
    ds_read_b128 v[80:83], v24 offset:32768
    ds_read_b128 v[84:87], v24 offset:34816
    v_mfma_f32_16x16x32_bf16 v[224:227], v[48:51], v[44:47], v[224:227]
    buffer_store_dwordx4 v[12:15], v16, s[8:11], s38 offen offset:0 sc1
    v_mfma_f32_16x16x32_bf16 v[132:135], v[52:55], v[32:35], v[132:135]
    ds_read_b128 v[88:91], v24 offset:36864
    ds_read_b128 v[92:95], v24 offset:38912
    v_mfma_f32_16x16x32_bf16 v[164:167], v[52:55], v[36:39], v[164:167]
    v_min_u32 v3, s58, v3
    v_mfma_f32_16x16x32_bf16 v[196:199], v[52:55], v[40:43], v[196:199]
    ds_read_b64_tr_b16 v[100:101], v28 offset:43520
    ds_read_b64_tr_b16 v[102:103], v28 offset:44544
    v_mfma_f32_16x16x32_bf16 v[228:231], v[52:55], v[44:47], v[228:231]
    v_mfma_f32_16x16x32_bf16 v[136:139], v[56:59], v[32:35], v[136:139]
    ds_read_b64_tr_b16 v[104:105], v29 offset:43520
    ds_read_b64_tr_b16 v[106:107], v29 offset:44544
    v_mfma_f32_16x16x32_bf16 v[168:171], v[56:59], v[36:39], v[168:171]
    v_mfma_f32_16x16x32_bf16 v[200:203], v[56:59], v[40:43], v[200:203]
    ds_read_b64_tr_b16 v[108:109], v30 offset:43520
    ds_read_b64_tr_b16 v[110:111], v30 offset:44544
    v_mfma_f32_16x16x32_bf16 v[232:235], v[56:59], v[44:47], v[232:235]
    buffer_store_dwordx4 v[12:15], v16, s[8:11], s38 offen offset:1024 sc1
    v_mfma_f32_16x16x32_bf16 v[140:143], v[60:63], v[32:35], v[140:143]
    ds_read_b64_tr_b16 v[112:113], v27 offset:43648
    ds_read_b64_tr_b16 v[114:115], v27 offset:44672
    v_mfma_f32_16x16x32_bf16 v[172:175], v[60:63], v[36:39], v[172:175]
    v_mfma_f32_16x16x32_bf16 v[204:207], v[60:63], v[40:43], v[204:207]
    ds_read_b64_tr_b16 v[116:117], v28 offset:43648
    ds_read_b64_tr_b16 v[118:119], v28 offset:44672
    v_mfma_f32_16x16x32_bf16 v[236:239], v[60:63], v[44:47], v[236:239]
    buffer_load_dword v2, v3, s[28:31], s40 offen sc1
    v_mfma_f32_16x16x32_bf16 v[144:147], v[64:67], v[32:35], v[144:147]
    ds_read_b64_tr_b16 v[120:121], v29 offset:43648
    ds_read_b64_tr_b16 v[122:123], v29 offset:44672
    v_mfma_f32_16x16x32_bf16 v[176:179], v[64:67], v[36:39], v[176:179]
    v_mfma_f32_16x16x32_bf16 v[208:211], v[64:67], v[40:43], v[208:211]
    ds_read_b64_tr_b16 v[124:125], v30 offset:43648
    ds_read_b64_tr_b16 v[126:127], v30 offset:44672
    v_mfma_f32_16x16x32_bf16 v[240:243], v[64:67], v[44:47], v[240:243]
    v_mfma_f32_16x16x32_bf16 v[148:151], v[68:71], v[32:35], v[148:151]
    v_mfma_f32_16x16x32_bf16 v[180:183], v[68:71], v[36:39], v[180:183]
    buffer_store_dwordx4 v[12:15], v16, s[8:11], s38 offen offset:2048 sc1
    v_mfma_f32_16x16x32_bf16 v[212:215], v[68:71], v[40:43], v[212:215]
    v_mfma_f32_16x16x32_bf16 v[244:247], v[68:71], v[44:47], v[244:247]
    v_mfma_f32_16x16x32_bf16 v[152:155], v[72:75], v[32:35], v[152:155]
    v_mfma_f32_16x16x32_bf16 v[184:187], v[72:75], v[36:39], v[184:187]
    v_mfma_f32_16x16x32_bf16 v[216:219], v[72:75], v[40:43], v[216:219]
    v_mfma_f32_16x16x32_bf16 v[248:251], v[72:75], v[44:47], v[248:251]
    buffer_store_dwordx4 v[12:15], v16, s[8:11], s38 offen offset:3072 sc1
    v_mfma_f32_16x16x32_bf16 v[156:159], v[76:79], v[32:35], v[156:159]
    v_mfma_f32_16x16x32_bf16 v[188:191], v[76:79], v[36:39], v[188:191]
    v_mfma_f32_16x16x32_bf16 v[220:223], v[76:79], v[40:43], v[220:223]
    v_mfma_f32_16x16x32_bf16 v[252:255], v[76:79], v[44:47], v[252:255]
    s_waitcnt vmcnt(9) lgkmcnt(0)
    s_barrier
    v_mfma_f32_16x16x32_bf16 v[128:131], v[96:99], v[80:83], v[128:131]
    s_add_u32 s38, s59, 131072
    ds_read_b64_tr_b16 v[48:49], v27 offset:0
    ds_read_b64_tr_b16 v[50:51], v27 offset:1024
    v_mfma_f32_16x16x32_bf16 v[160:163], v[96:99], v[84:87], v[160:163]
    s_mov_b32 s42, 0x40004000
    v_mfma_f32_16x16x32_bf16 v[192:195], v[96:99], v[88:91], v[192:195]
    s_mov_b32 s39, s47
    ds_read_b128 v[32:35], v25 offset:0
    ds_read_b128 v[36:39], v25 offset:2048
    v_mfma_f32_16x16x32_bf16 v[224:227], v[96:99], v[92:95], v[224:227]
    v_mfma_f32_16x16x32_bf16 v[132:135], v[100:103], v[80:83], v[132:135]
    s_mov_b32 s45, s48
    ds_read_b128 v[40:43], v25 offset:4096
    ds_read_b128 v[44:47], v25 offset:6144
    v_mfma_f32_16x16x32_bf16 v[164:167], v[100:103], v[84:87], v[164:167]
    s_mov_b32 s44, 32768
    v_mfma_f32_16x16x32_bf16 v[196:199], v[100:103], v[88:91], v[196:199]
    s_movk_i32 s49, 16384
    ds_read_b64_tr_b16 v[52:53], v28 offset:0
    ds_read_b64_tr_b16 v[54:55], v28 offset:1024
    v_mfma_f32_16x16x32_bf16 v[228:231], v[100:103], v[92:95], v[228:231]
    v_mfma_f32_16x16x32_bf16 v[136:139], v[104:107], v[80:83], v[136:139]
    s_movk_i32 s50, 16384
    ds_read_b64_tr_b16 v[56:57], v29 offset:0
    ds_read_b64_tr_b16 v[58:59], v29 offset:1024
    v_mfma_f32_16x16x32_bf16 v[168:171], v[104:107], v[84:87], v[168:171]
    s_add_u32 s16, s94, 33554432
    s_addc_u32 s17, s95, 0
    v_mfma_f32_16x16x32_bf16 v[200:203], v[104:107], v[88:91], v[200:203]
    s_mov_b32 s18, 16777216
    ds_read_b64_tr_b16 v[60:61], v30 offset:0
    ds_read_b64_tr_b16 v[62:63], v30 offset:1024
    v_mfma_f32_16x16x32_bf16 v[232:235], v[104:107], v[92:95], v[232:235]
    v_mfma_f32_16x16x32_bf16 v[140:143], v[108:111], v[80:83], v[140:143]
    s_mov_b32 s8, s86
    ds_read_b64_tr_b16 v[64:65], v27 offset:128
    ds_read_b64_tr_b16 v[66:67], v27 offset:1152
    v_mfma_f32_16x16x32_bf16 v[172:175], v[108:111], v[84:87], v[172:175]
    s_mov_b32 s9, s87
    v_mfma_f32_16x16x32_bf16 v[204:207], v[108:111], v[88:91], v[204:207]
    s_mov_b32 s10, 8388608
    ds_read_b64_tr_b16 v[68:69], v28 offset:128
    ds_read_b64_tr_b16 v[70:71], v28 offset:1152
    v_mfma_f32_16x16x32_bf16 v[236:239], v[108:111], v[92:95], v[236:239]
    v_mfma_f32_16x16x32_bf16 v[144:147], v[112:115], v[80:83], v[144:147]
    s_mov_b32 s4, s72
    ds_read_b64_tr_b16 v[72:73], v29 offset:128
    ds_read_b64_tr_b16 v[74:75], v29 offset:1152
    v_mfma_f32_16x16x32_bf16 v[176:179], v[112:115], v[84:87], v[176:179]
    s_mov_b32 s5, s73
    v_mfma_f32_16x16x32_bf16 v[208:211], v[112:115], v[88:91], v[208:211]
    s_mov_b32 s6, 4194304
    ds_read_b64_tr_b16 v[76:77], v30 offset:128
    ds_read_b64_tr_b16 v[78:79], v30 offset:1152
    v_mfma_f32_16x16x32_bf16 v[240:243], v[112:115], v[92:95], v[240:243]
    s_lshl_b32 s58, s2, 2
    v_mfma_f32_16x16x32_bf16 v[148:151], v[116:119], v[80:83], v[148:151]
    s_add_u32 s58, s58, s32
    v_mfma_f32_16x16x32_bf16 v[180:183], v[116:119], v[84:87], v[180:183]
    v_mfma_f32_16x16x32_bf16 v[212:215], v[116:119], v[88:91], v[212:215]
    s_sub_u32 s46, s58, 512
    v_mfma_f32_16x16x32_bf16 v[244:247], v[116:119], v[92:95], v[244:247]
    s_lshl_b32 s46, s46, 11
    v_mfma_f32_16x16x32_bf16 v[152:155], v[120:123], v[80:83], v[152:155]
    v_mfma_f32_16x16x32_bf16 v[184:187], v[120:123], v[84:87], v[184:187]
    s_cmp_lt_u32 s34, 4
    s_cselect_b32 s46, 0x80000000, s46
    v_mfma_f32_16x16x32_bf16 v[216:219], v[120:123], v[88:91], v[216:219]
    v_mfma_f32_16x16x32_bf16 v[248:251], v[120:123], v[92:95], v[248:251]
    v_mfma_f32_16x16x32_bf16 v[156:159], v[124:127], v[80:83], v[156:159]
    v_mfma_f32_16x16x32_bf16 v[188:191], v[124:127], v[84:87], v[188:191]
    v_mfma_f32_16x16x32_bf16 v[220:223], v[124:127], v[88:91], v[220:223]
    v_mfma_f32_16x16x32_bf16 v[252:255], v[124:127], v[92:95], v[252:255]
    s_waitcnt lgkmcnt(0)
    v_mfma_f32_16x16x32_bf16 v[128:131], v[48:51], v[32:35], v[128:131]
    ds_read_b64_tr_b16 v[96:97], v27 offset:8704
    ds_read_b64_tr_b16 v[98:99], v27 offset:9728
    v_mfma_f32_16x16x32_bf16 v[160:163], v[48:51], v[36:39], v[160:163]
    v_mfma_f32_16x16x32_bf16 v[192:195], v[48:51], v[40:43], v[192:195]
    ds_read_b128 v[80:83], v26 offset:0
    ds_read_b128 v[84:87], v26 offset:2048
    v_mfma_f32_16x16x32_bf16 v[224:227], v[48:51], v[44:47], v[224:227]
    v_mfma_f32_16x16x32_bf16 v[132:135], v[52:55], v[32:35], v[132:135]
    ds_read_b128 v[88:91], v26 offset:4096
    ds_read_b128 v[92:95], v26 offset:6144
    v_mfma_f32_16x16x32_bf16 v[164:167], v[52:55], v[36:39], v[164:167]
    v_mfma_f32_16x16x32_bf16 v[196:199], v[52:55], v[40:43], v[196:199]
    ds_read_b64_tr_b16 v[100:101], v28 offset:8704
    ds_read_b64_tr_b16 v[102:103], v28 offset:9728
    v_mfma_f32_16x16x32_bf16 v[228:231], v[52:55], v[44:47], v[228:231]
    v_mfma_f32_16x16x32_bf16 v[136:139], v[56:59], v[32:35], v[136:139]
    ds_read_b64_tr_b16 v[104:105], v29 offset:8704
    ds_read_b64_tr_b16 v[106:107], v29 offset:9728
    v_mfma_f32_16x16x32_bf16 v[168:171], v[56:59], v[36:39], v[168:171]
    v_mfma_f32_16x16x32_bf16 v[200:203], v[56:59], v[40:43], v[200:203]
    ds_read_b64_tr_b16 v[108:109], v30 offset:8704
    ds_read_b64_tr_b16 v[110:111], v30 offset:9728
    v_mfma_f32_16x16x32_bf16 v[232:235], v[56:59], v[44:47], v[232:235]
    v_mfma_f32_16x16x32_bf16 v[140:143], v[60:63], v[32:35], v[140:143]
    ds_read_b64_tr_b16 v[112:113], v27 offset:8832
    ds_read_b64_tr_b16 v[114:115], v27 offset:9856
    v_mfma_f32_16x16x32_bf16 v[172:175], v[60:63], v[36:39], v[172:175]
    v_mfma_f32_16x16x32_bf16 v[204:207], v[60:63], v[40:43], v[204:207]
    ds_read_b64_tr_b16 v[116:117], v28 offset:8832
    ds_read_b64_tr_b16 v[118:119], v28 offset:9856
    v_mfma_f32_16x16x32_bf16 v[236:239], v[60:63], v[44:47], v[236:239]
    v_mfma_f32_16x16x32_bf16 v[144:147], v[64:67], v[32:35], v[144:147]
    ds_read_b64_tr_b16 v[120:121], v29 offset:8832
    ds_read_b64_tr_b16 v[122:123], v29 offset:9856
    v_mfma_f32_16x16x32_bf16 v[176:179], v[64:67], v[36:39], v[176:179]
    v_mfma_f32_16x16x32_bf16 v[208:211], v[64:67], v[40:43], v[208:211]
    ds_read_b64_tr_b16 v[124:125], v30 offset:8832
    ds_read_b64_tr_b16 v[126:127], v30 offset:9856
    v_mfma_f32_16x16x32_bf16 v[240:243], v[64:67], v[44:47], v[240:243]
    v_mfma_f32_16x16x32_bf16 v[148:151], v[68:71], v[32:35], v[148:151]
    v_and_b32 v14, 16, v16
    v_lshrrev_b32 v13, 5, v16
    v_mfma_f32_16x16x32_bf16 v[180:183], v[68:71], v[36:39], v[180:183]
    v_mfma_f32_16x16x32_bf16 v[212:215], v[68:71], v[40:43], v[212:215]
    v_lshl_add_u32 v14, v13, 7, v14
    v_mfma_f32_16x16x32_bf16 v[244:247], v[68:71], v[44:47], v[244:247]
    v_mfma_f32_16x16x32_bf16 v[152:155], v[72:75], v[32:35], v[152:155]
    v_mfma_f32_16x16x32_bf16 v[184:187], v[72:75], v[36:39], v[184:187]
    v_mfma_f32_16x16x32_bf16 v[216:219], v[72:75], v[40:43], v[216:219]
    v_mfma_f32_16x16x32_bf16 v[248:251], v[72:75], v[44:47], v[248:251]
    v_mfma_f32_16x16x32_bf16 v[156:159], v[76:79], v[32:35], v[156:159]
    v_mfma_f32_16x16x32_bf16 v[188:191], v[76:79], v[36:39], v[188:191]
    v_mfma_f32_16x16x32_bf16 v[220:223], v[76:79], v[40:43], v[220:223]
    v_mfma_f32_16x16x32_bf16 v[252:255], v[76:79], v[44:47], v[252:255]
    s_waitcnt vmcnt(2) lgkmcnt(0)
    s_barrier
    v_cmp_ne_u32 vcc, 1, v2
    v_mfma_f32_16x16x32_bf16 v[128:131], v[96:99], v[80:83], v[128:131]
    s_nop 0
    s_cbranch_vccnz gated_mix__ssm_conv_h3__compressed_kv_cla__prompt_kernel_spin_kv
gated_mix__ssm_conv_h3__compressed_kv_cla__prompt_kernel_spin_kv_ret:
    v_mfma_f32_16x16x32_bf16 v[160:163], v[96:99], v[84:87], v[160:163]
    s_add_u32 s36, s59, 0
    v_bfe_u32 v40, v16, 4, 4
    v_lshrrev_b32 v41, 8, v16
    v_mfma_f32_16x16x32_bf16 v[192:195], v[96:99], v[88:91], v[192:195]
    s_add_u32 s37, s59, s47
    s_mov_b32 m0, s37
    v_sub_u32 v40, v40, v41
    v_cmp_gt_u32 vcc, 256, v16
    v_mfma_f32_16x16x32_bf16 v[224:227], v[96:99], v[92:95], v[224:227]
    buffer_load_dwordx4 v16, s[12:15], s36 offen offset:0 sc1 lds
    v_mfma_f32_16x16x32_bf16 v[132:135], v[100:103], v[80:83], v[132:135]
    s_add_u32 s40, s59, s53
    v_lshl_add_u32 v40, v40, 2, s32
    v_mov_b32 v41, 0xff000000
    v_mfma_f32_16x16x32_bf16 v[164:167], v[100:103], v[84:87], v[164:167]
    s_add_u32 s41, s40, 16384
    v_lshlrev_b32 v15, 3, v16
    v_cndmask_b32 v19, v41, v15, vcc
    v_mfma_f32_16x16x32_bf16 v[196:199], v[100:103], v[88:91], v[196:199]
    s_lshl_b32 s54, s58, 12
    v_cmp_gt_i32 vcc, 0, v40
    v_cmp_gt_i32 s[66:67], 1, v40
    v_mfma_f32_16x16x32_bf16 v[228:231], v[100:103], v[92:95], v[228:231]
    buffer_load_dwordx4 v16, s[12:15], s36 offen offset:1024 sc1 lds
    v_mfma_f32_16x16x32_bf16 v[136:139], v[104:107], v[80:83], v[136:139]
    v_cndmask_b32 v48, 0, v41, vcc
    v_cndmask_b32 v49, 0, v41, s[66:67]
    v_mfma_f32_16x16x32_bf16 v[168:171], v[104:107], v[84:87], v[168:171]
    v_cmp_gt_i32 vcc, 2, v40
    v_cmp_gt_i32 s[66:67], 3, v40
    v_mfma_f32_16x16x32_bf16 v[200:203], v[104:107], v[88:91], v[200:203]
    v_cndmask_b32 v50, 0, v41, vcc
    v_cndmask_b32 v51, 0, v41, s[66:67]
    v_mfma_f32_16x16x32_bf16 v[232:235], v[104:107], v[92:95], v[232:235]
    buffer_load_dwordx4 v16, s[12:15], s36 offen offset:2048 sc1 lds
    v_mfma_f32_16x16x32_bf16 v[140:143], v[108:111], v[80:83], v[140:143]
    v_cmp_gt_i32 vcc, 16, v40
    v_cmp_gt_i32 s[66:67], 17, v40
    v_mfma_f32_16x16x32_bf16 v[172:175], v[108:111], v[84:87], v[172:175]
    v_cndmask_b32 v52, 0, v41, vcc
    v_cndmask_b32 v53, 0, v41, s[66:67]
    v_mfma_f32_16x16x32_bf16 v[204:207], v[108:111], v[88:91], v[204:207]
    v_cmp_gt_i32 vcc, 18, v40
    v_cmp_gt_i32 s[66:67], 19, v40
    v_mfma_f32_16x16x32_bf16 v[236:239], v[108:111], v[92:95], v[236:239]
    buffer_load_dwordx4 v16, s[12:15], s36 offen offset:3072 sc1 lds
    v_mfma_f32_16x16x32_bf16 v[144:147], v[112:115], v[80:83], v[144:147]
    v_cndmask_b32 v54, 0, v41, vcc
    v_cndmask_b32 v55, 0, v41, s[66:67]
    v_mfma_f32_16x16x32_bf16 v[176:179], v[112:115], v[84:87], v[176:179]
    v_cmp_gt_i32 vcc, 32, v40
    v_cmp_gt_i32 s[66:67], 33, v40
    v_mfma_f32_16x16x32_bf16 v[208:211], v[112:115], v[88:91], v[208:211]
    v_cndmask_b32 v56, 0, v41, vcc
    v_cndmask_b32 v57, 0, v41, s[66:67]
    v_mfma_f32_16x16x32_bf16 v[240:243], v[112:115], v[92:95], v[240:243]
    s_add_u32 s36, s59, 16384
    v_cmp_gt_i32 vcc, 34, v40
    v_cmp_gt_i32 s[66:67], 35, v40
    v_mfma_f32_16x16x32_bf16 v[148:151], v[116:119], v[80:83], v[148:151]
    s_add_u32 s37, s59, s47
    s_add_u32 m0, s37, 16384
    v_cndmask_b32 v58, 0, v41, vcc
    v_cndmask_b32 v59, 0, v41, s[66:67]
    v_mfma_f32_16x16x32_bf16 v[180:183], v[116:119], v[84:87], v[180:183]
    buffer_load_dwordx4 v16, s[12:15], s36 offen offset:0 sc1 lds
    v_mfma_f32_16x16x32_bf16 v[212:215], v[116:119], v[88:91], v[212:215]
    v_cmp_gt_i32 vcc, 48, v40
    v_cmp_gt_i32 s[66:67], 49, v40
    v_mfma_f32_16x16x32_bf16 v[244:247], v[116:119], v[92:95], v[244:247]
    v_cndmask_b32 v60, 0, v41, vcc
    v_cndmask_b32 v61, 0, v41, s[66:67]
    v_mfma_f32_16x16x32_bf16 v[152:155], v[120:123], v[80:83], v[152:155]
    buffer_load_dwordx4 v16, s[12:15], s36 offen offset:1024 sc1 lds
    v_mfma_f32_16x16x32_bf16 v[184:187], v[120:123], v[84:87], v[184:187]
    v_cmp_gt_i32 vcc, 50, v40
    v_cmp_gt_i32 s[66:67], 51, v40
    v_mfma_f32_16x16x32_bf16 v[216:219], v[120:123], v[88:91], v[216:219]
    v_cndmask_b32 v62, 0, v41, vcc
    v_cndmask_b32 v63, 0, v41, s[66:67]
    v_mfma_f32_16x16x32_bf16 v[248:251], v[120:123], v[92:95], v[248:251]
    buffer_load_dwordx4 v16, s[12:15], s36 offen offset:2048 sc1 lds
    v_mfma_f32_16x16x32_bf16 v[156:159], v[124:127], v[80:83], v[156:159]
    v_add_u32 v2, s47, v16
    v_add_u32 v3, s47, v16
    v_mfma_f32_16x16x32_bf16 v[188:191], v[124:127], v[84:87], v[188:191]
    v_mov_b32 v24, 0x3f803f80
    v_mov_b32 v25, 0x3f803f80
    v_mfma_f32_16x16x32_bf16 v[220:223], v[124:127], v[88:91], v[220:223]
    buffer_load_dwordx4 v16, s[12:15], s36 offen offset:3072 sc1 lds
    v_mfma_f32_16x16x32_bf16 v[252:255], v[124:127], v[92:95], v[252:255]
    v_mov_b32 v26, 0x3f803f80
    v_mov_b32 v27, 0x3f803f80
    v_cvt_pk_bf16_f32 v80, v128, v129
    v_cvt_pk_bf16_f32 v81, v130, v131
    v_cvt_pk_bf16_f32 v82, v132, v133
    v_cvt_pk_bf16_f32 v83, v134, v135
    v_cvt_pk_bf16_f32 v84, v136, v137
    v_cvt_pk_bf16_f32 v85, v138, v139
    v_cvt_pk_bf16_f32 v86, v140, v141
    v_cvt_pk_bf16_f32 v87, v142, v143
    v_cvt_pk_bf16_f32 v88, v144, v145
    v_cvt_pk_bf16_f32 v89, v146, v147
    v_cvt_pk_bf16_f32 v90, v148, v149
    v_cvt_pk_bf16_f32 v91, v150, v151
    v_cvt_pk_bf16_f32 v92, v152, v153
    v_cvt_pk_bf16_f32 v93, v154, v155
    v_cvt_pk_bf16_f32 v94, v156, v157
    s_add_u32 s36, s59, 32768
    s_add_u32 s37, s59, s48
    s_mov_b32 m0, s37
    s_nop 0
    buffer_load_dwordx4 v16, s[12:15], s36 offen offset:0 sc1 lds
    v_cvt_pk_bf16_f32 v95, v158, v159
    v_cvt_pk_bf16_f32 v96, v160, v161
    v_cvt_pk_bf16_f32 v97, v162, v163
    v_cvt_pk_bf16_f32 v98, v164, v165
    v_cvt_pk_bf16_f32 v99, v166, v167
    v_cvt_pk_bf16_f32 v100, v168, v169
    v_cvt_pk_bf16_f32 v101, v170, v171
    v_cvt_pk_bf16_f32 v102, v172, v173
    v_cvt_pk_bf16_f32 v103, v174, v175
    v_cvt_pk_bf16_f32 v104, v176, v177
gated_mix__ssm_conv_h3__compressed_kv_cla__prompt_kernel_pad8:
    s_cbranch_execz gated_mix__ssm_conv_h3__compressed_kv_cla__prompt_kernel_pad16
    v_cvt_pk_bf16_f32 v105, v178, v179
    v_cvt_pk_bf16_f32 v106, v180, v181
    v_cvt_pk_bf16_f32 v107, v182, v183
    v_cvt_pk_bf16_f32 v108, v184, v185
    v_cvt_pk_bf16_f32 v109, v186, v187
    buffer_load_dwordx4 v16, s[12:15], s36 offen offset:1024 sc1 lds
    v_cvt_pk_bf16_f32 v110, v188, v189
    v_cvt_pk_bf16_f32 v111, v190, v191
    v_cvt_pk_bf16_f32 v112, v192, v193
    v_cvt_pk_bf16_f32 v113, v194, v195
    v_cvt_pk_bf16_f32 v114, v196, v197
    v_cvt_pk_bf16_f32 v115, v198, v199
    v_cvt_pk_bf16_f32 v116, v200, v201
    v_cvt_pk_bf16_f32 v117, v202, v203
    v_cvt_pk_bf16_f32 v118, v204, v205
    v_cvt_pk_bf16_f32 v119, v206, v207
    v_cvt_pk_bf16_f32 v120, v208, v209
    v_cvt_pk_bf16_f32 v121, v210, v211
    v_cvt_pk_bf16_f32 v122, v212, v213
    v_cvt_pk_bf16_f32 v123, v214, v215
    v_cvt_pk_bf16_f32 v124, v216, v217
    buffer_load_dwordx4 v16, s[12:15], s36 offen offset:2048 sc1 lds
    v_cvt_pk_bf16_f32 v125, v218, v219
    v_cvt_pk_bf16_f32 v126, v220, v221
    v_cvt_pk_bf16_f32 v127, v222, v223
    v_cvt_pk_bf16_f32 v128, v224, v225
    v_cvt_pk_bf16_f32 v129, v226, v227
    v_cvt_pk_bf16_f32 v130, v228, v229
    v_cvt_pk_bf16_f32 v131, v230, v231
    v_cvt_pk_bf16_f32 v132, v232, v233
    v_cvt_pk_bf16_f32 v133, v234, v235
    v_cvt_pk_bf16_f32 v134, v236, v237
    v_cvt_pk_bf16_f32 v135, v238, v239
    v_cvt_pk_bf16_f32 v136, v240, v241
    v_cvt_pk_bf16_f32 v137, v242, v243
    v_cvt_pk_bf16_f32 v138, v244, v245
    v_cvt_pk_bf16_f32 v139, v246, v247
    buffer_load_dwordx4 v16, s[12:15], s36 offen offset:3072 sc1 lds
    v_cvt_pk_bf16_f32 v140, v248, v249
    v_cvt_pk_bf16_f32 v141, v250, v251
    v_cvt_pk_bf16_f32 v142, v252, v253
    v_cvt_pk_bf16_f32 v143, v254, v255
    s_waitcnt vmcnt(4)
    s_barrier
    ds_read_b128 a[128:131], v2 offset:0
    ds_read_b128 a[132:135], v2 offset:1024
    ds_read_b128 a[136:139], v2 offset:2048
    ds_read_b128 a[140:143], v2 offset:3072
    ds_read_b128 a[144:147], v2 offset:4096
    ds_read_b128 a[148:151], v2 offset:5120
    ds_read_b128 a[152:155], v2 offset:6144
    ds_read_b128 a[156:159], v2 offset:7168
    v_mov_b32 v240, 0
    v_mov_b32 v241, 0
    v_mov_b32 v242, 0
    s_add_u32 s36, s59, 49152
    s_add_u32 s37, s59, s48
    s_add_u32 m0, s37, 16384
    s_nop 0
    buffer_load_dwordx4 v16, s[12:15], s36 offen offset:0 sc1 lds
    v_mov_b32 v243, 0
    v_mov_b32 v244, 0
    v_mov_b32 v245, 0
    v_mov_b32 v246, 0
    v_mov_b32 v247, 0
    v_mov_b32 v248, 0
    v_mov_b32 v249, 0
    v_mov_b32 v250, 0
    v_mov_b32 v251, 0
    v_mov_b32 v252, 0
    v_mov_b32 v253, 0
    v_mov_b32 v254, 0
    v_mov_b32 v255, 0
    s_waitcnt lgkmcnt(7)
    v_mfma_f32_16x16x32_bf16 v[144:147], a[128:131], v[80:83], 0
    buffer_load_dwordx4 v16, s[12:15], s36 offen offset:1024 sc1 lds
    v_mfma_f32_16x16x32_bf16 v[152:155], a[128:131], v[96:99], 0
    v_mfma_f32_16x16x32_bf16 v[160:163], a[128:131], v[112:115], 0
    v_mfma_f32_16x16x32_bf16 v[168:171], a[128:131], v[128:131], 0
    s_waitcnt lgkmcnt(6)
    v_mfma_f32_16x16x32_bf16 v[144:147], a[132:135], v[84:87], v[144:147]
    buffer_load_dwordx4 v16, s[12:15], s36 offen offset:2048 sc1 lds
    v_mfma_f32_16x16x32_bf16 v[152:155], a[132:135], v[100:103], v[152:155]
    v_mfma_f32_16x16x32_bf16 v[160:163], a[132:135], v[116:119], v[160:163]
    v_mfma_f32_16x16x32_bf16 v[168:171], a[132:135], v[132:135], v[168:171]
    s_waitcnt lgkmcnt(5)
    v_mfma_f32_16x16x32_bf16 v[144:147], a[136:139], v[88:91], v[144:147]
    buffer_load_dwordx4 v16, s[12:15], s36 offen offset:3072 sc1 lds
    v_mfma_f32_16x16x32_bf16 v[152:155], a[136:139], v[104:107], v[152:155]
    v_mfma_f32_16x16x32_bf16 v[160:163], a[136:139], v[120:123], v[160:163]
    v_mfma_f32_16x16x32_bf16 v[168:171], a[136:139], v[136:139], v[168:171]
    s_waitcnt lgkmcnt(4)
    v_mfma_f32_16x16x32_bf16 v[144:147], a[140:143], v[92:95], v[144:147]
    s_add_u32 s36, s59, 65536
    s_add_u32 s37, s59, s51
    s_mov_b32 m0, s37
    s_nop 0
    buffer_load_dwordx4 v16, s[12:15], s36 offen offset:0 sc1 lds
    v_mfma_f32_16x16x32_bf16 v[152:155], a[140:143], v[108:111], v[152:155]
    v_mfma_f32_16x16x32_bf16 v[160:163], a[140:143], v[124:127], v[160:163]
    v_mfma_f32_16x16x32_bf16 v[168:171], a[140:143], v[140:143], v[168:171]
    s_waitcnt lgkmcnt(3)
    v_mfma_f32_16x16x32_bf16 v[148:151], a[144:147], v[80:83], 0
    buffer_load_dwordx4 v16, s[12:15], s36 offen offset:1024 sc1 lds
    v_mfma_f32_16x16x32_bf16 v[156:159], a[144:147], v[96:99], 0
    v_mfma_f32_16x16x32_bf16 v[164:167], a[144:147], v[112:115], 0
    v_mfma_f32_16x16x32_bf16 v[172:175], a[144:147], v[128:131], 0
    s_waitcnt lgkmcnt(2)
    v_mfma_f32_16x16x32_bf16 v[148:151], a[148:151], v[84:87], v[148:151]
    buffer_load_dwordx4 v16, s[12:15], s36 offen offset:2048 sc1 lds
    v_mfma_f32_16x16x32_bf16 v[156:159], a[148:151], v[100:103], v[156:159]
    v_mfma_f32_16x16x32_bf16 v[164:167], a[148:151], v[116:119], v[164:167]
    v_mfma_f32_16x16x32_bf16 v[172:175], a[148:151], v[132:135], v[172:175]
    s_waitcnt lgkmcnt(1)
    v_mfma_f32_16x16x32_bf16 v[148:151], a[152:155], v[88:91], v[148:151]
    buffer_load_dwordx4 v16, s[12:15], s36 offen offset:3072 sc1 lds
    v_mfma_f32_16x16x32_bf16 v[156:159], a[152:155], v[104:107], v[156:159]
    v_mfma_f32_16x16x32_bf16 v[164:167], a[152:155], v[120:123], v[164:167]
    v_mfma_f32_16x16x32_bf16 v[172:175], a[152:155], v[136:139], v[172:175]
    s_waitcnt lgkmcnt(0)
    v_mfma_f32_16x16x32_bf16 v[148:151], a[156:159], v[92:95], v[148:151]
    s_add_u32 s36, s59, 81920
    s_add_u32 s37, s59, s51
    s_add_u32 m0, s37, 16384
    s_nop 0
    buffer_load_dwordx4 v16, s[12:15], s36 offen offset:0 sc1 lds
    v_mfma_f32_16x16x32_bf16 v[156:159], a[156:159], v[108:111], v[156:159]
    v_mfma_f32_16x16x32_bf16 v[164:167], a[156:159], v[124:127], v[164:167]
    v_mfma_f32_16x16x32_bf16 v[172:175], a[156:159], v[140:143], v[172:175]
    ds_read_b128 a[128:131], v2 offset:16384
    ds_read_b128 a[132:135], v2 offset:17408
    ds_read_b128 a[136:139], v2 offset:18432
    ds_read_b128 a[140:143], v2 offset:19456
    ds_read_b128 a[144:147], v2 offset:20480
    ds_read_b128 a[148:151], v2 offset:21504
    ds_read_b128 a[152:155], v2 offset:22528
    ds_read_b128 a[156:159], v2 offset:23552
    ds_read_b128 a[160:163], v2 offset:8192
    ds_read_b128 a[164:167], v2 offset:9216
    ds_read_b128 a[168:171], v2 offset:10240
    ds_read_b128 a[172:175], v2 offset:11264
    s_cmp_lg_u32 s34, 0
    s_cbranch_scc1 gated_mix__ssm_conv_h3__compressed_kv_cla__prompt_kernel_nomask0
    v_add_f32 v144, v48, v144
    v_add_f32 v145, v49, v145
    v_add_f32 v146, v50, v146
    v_add_f32 v147, v51, v147
    v_add_f32 v148, v52, v148
    v_add_f32 v149, v53, v149
    v_add_f32 v150, v54, v150
    v_add_f32 v151, v55, v151
gated_mix__ssm_conv_h3__compressed_kv_cla__prompt_kernel_nomask0:
    v_max3_f32 v32, v144, v145, v146
    v_max3_f32 v32, v147, v148, v32
    v_max3_f32 v32, v149, v150, v32
    buffer_load_dwordx4 v16, s[12:15], s36 offen offset:1024 sc1 lds
    v_max_f32 v32, v151, v32
    v_max3_f32 v34, v152, v153, v154
    v_max3_f32 v34, v155, v156, v34
    v_max3_f32 v34, v157, v158, v34
    v_max_f32 v34, v159, v34
    v_max3_f32 v36, v160, v161, v162
    v_max3_f32 v36, v163, v164, v36
    v_max3_f32 v36, v165, v166, v36
    v_max_f32 v36, v167, v36
    v_max3_f32 v38, v168, v169, v170
    v_max3_f32 v38, v171, v172, v38
    v_max3_f32 v38, v173, v174, v38
    v_max_f32 v38, v175, v38
    v_mov_b32 v33, v32
    v_mov_b32 v35, v34
    buffer_load_dwordx4 v16, s[12:15], s36 offen offset:2048 sc1 lds
    v_mov_b32 v37, v36
    v_mov_b32 v39, v38
    v_permlane16_swap_b32 v32, v33
    v_permlane16_swap_b32 v34, v35
    v_permlane16_swap_b32 v36, v37
    v_permlane16_swap_b32 v38, v39
    v_max_f32 v32, v32, v33
    v_max_f32 v34, v34, v35
    v_max_f32 v36, v36, v37
    v_max_f32 v38, v38, v39
    v_mov_b32 v33, v32
    v_mov_b32 v35, v34
    v_mov_b32 v37, v36
    v_mov_b32 v39, v38
    v_permlane32_swap_b32 v32, v33
    buffer_load_dwordx4 v16, s[12:15], s36 offen offset:3072 sc1 lds
    v_permlane32_swap_b32 v34, v35
    v_permlane32_swap_b32 v36, v37
    v_permlane32_swap_b32 v38, v39
    v_max_f32 v32, v32, v33
    v_max_f32 v34, v34, v35
    v_max_f32 v36, v36, v37
    v_max_f32 v38, v38, v39
    v_sub_f32 v64, 0xc1c00000, v32
    v_sub_f32 v65, 0xc1c00000, v32
    v_pk_mov_b32 v[66:67], v[64:65], v[64:65] op_sel:[0,1]
    v_pk_add_f32 v[144:145], v[144:145], v[64:65]
    v_pk_add_f32 v[146:147], v[146:147], v[64:65]
    v_pk_add_f32 v[148:149], v[148:149], v[64:65]
    v_pk_add_f32 v[150:151], v[150:151], v[64:65]
    v_sub_f32 v68, 0xc1c00000, v34
    s_add_u32 s36, s59, 98304
    s_add_u32 s37, s59, s52
    s_mov_b32 m0, s37
    s_nop 0
    buffer_load_dwordx4 v16, s[12:15], s36 offen offset:0 sc1 lds
    v_sub_f32 v69, 0xc1c00000, v34
    v_pk_mov_b32 v[70:71], v[68:69], v[68:69] op_sel:[0,1]
    v_pk_add_f32 v[152:153], v[152:153], v[68:69]
    v_pk_add_f32 v[154:155], v[154:155], v[68:69]
    v_pk_add_f32 v[156:157], v[156:157], v[68:69]
    v_pk_add_f32 v[158:159], v[158:159], v[68:69]
    v_sub_f32 v72, 0xc1c00000, v36
    v_sub_f32 v73, 0xc1c00000, v36
    v_pk_mov_b32 v[74:75], v[72:73], v[72:73] op_sel:[0,1]
    v_pk_add_f32 v[160:161], v[160:161], v[72:73]
    v_pk_add_f32 v[162:163], v[162:163], v[72:73]
    v_pk_add_f32 v[164:165], v[164:165], v[72:73]
    v_pk_add_f32 v[166:167], v[166:167], v[72:73]
    v_sub_f32 v76, 0xc1c00000, v38
    v_sub_f32 v77, 0xc1c00000, v38
    buffer_load_dwordx4 v16, s[12:15], s36 offen offset:1024 sc1 lds
    v_pk_mov_b32 v[78:79], v[76:77], v[76:77] op_sel:[0,1]
    v_pk_add_f32 v[168:169], v[168:169], v[76:77]
    v_pk_add_f32 v[170:171], v[170:171], v[76:77]
    v_pk_add_f32 v[172:173], v[172:173], v[76:77]
    v_pk_add_f32 v[174:175], v[174:175], v[76:77]
    v_exp_f32 v4, v168
    v_exp_f32 v5, v169
    s_nop 0
    v_cvt_pk_bf16_f32 v220, v4, v5
    v_exp_f32 v6, v170
    v_exp_f32 v7, v171
    s_nop 0
    v_cvt_pk_bf16_f32 v221, v6, v7
    buffer_load_dwordx4 v16, s[12:15], s36 offen offset:2048 sc1 lds
    v_exp_f32 v8, v172
    v_exp_f32 v9, v173
    s_nop 0
    v_cvt_pk_bf16_f32 v222, v8, v9
    v_or3_b32 v12, v220, v221, v222
    v_exp_f32 v10, v174
    v_exp_f32 v11, v175
    s_nop 0
    v_cvt_pk_bf16_f32 v223, v10, v11
    v_exp_f32 v4, v160
    v_exp_f32 v5, v161
    s_nop 0
    v_cvt_pk_bf16_f32 v216, v4, v5
    buffer_load_dwordx4 v16, s[12:15], s36 offen offset:3072 sc1 lds
    v_or3_b32 v12, v12, v223, v216
    v_exp_f32 v6, v162
    v_exp_f32 v7, v163
    s_nop 0
    v_cvt_pk_bf16_f32 v217, v6, v7
    v_exp_f32 v8, v164
    v_exp_f32 v9, v165
    s_nop 0
    v_cvt_pk_bf16_f32 v218, v8, v9
    v_or3_b32 v12, v12, v217, v218
    v_exp_f32 v10, v166
    v_exp_f32 v11, v167
    s_nop 0
    v_cvt_pk_bf16_f32 v219, v10, v11
    s_add_u32 s36, s59, 114688
    s_add_u32 s37, s59, s52
    s_add_u32 m0, s37, 16384
    s_nop 0
    buffer_load_dwordx4 v16, s[12:15], s36 offen offset:0 sc1 lds
    buffer_load_dwordx4 v16, s[12:15], s36 offen offset:1024 sc1 lds
    buffer_load_dwordx4 v16, s[12:15], s36 offen offset:2048 sc1 lds
    buffer_load_dwordx4 v16, s[12:15], s36 offen offset:3072 sc1 lds
    s_mov_b32 s47, 393216
    buffer_load_dwordx4 v[28:31], v14, s[28:31], s47 offen sc1
    buffer_load_dword a200, v15, s[4:7], s54 offen
    s_mov_b32 s48, 0
    v_add_u32 v2, s45, v16
    s_waitcnt vmcnt(18) lgkmcnt(0)
    s_barrier
    s_lshl_b32 s35, s34, 1
    s_add_u32 s35, s35, 1
    s_min_u32 s58, s35, 14
    s_cmp_eq_u32 s34, 7
    s_cselect_b32 s58, s58, s35
    s_nop 0
    s_nop 0
    s_nop 0
    s_nop 0
gated_mix__ssm_conv_h3__compressed_kv_cla__prompt_kernel_b4_loop:
    v_mfma_f32_16x16x32_bf16 v[176:179], a[128:131], v[80:83], v[64:67]
    s_cmp_eq_u32 s35, 1
    v_exp_f32 v4, v152
    v_mfma_f32_16x16x32_bf16 v[184:187], a[128:131], v[96:99], v[68:71]
    s_cbranch_scc1 gated_mix__ssm_conv_h3__compressed_kv_cla__prompt_kernel_b4_m0
gated_mix__ssm_conv_h3__compressed_kv_cla__prompt_kernel_b4_m0_ret:
    ds_read_b128 a[176:179], v3 offset:12288
    ds_read_b128 a[180:183], v3 offset:13312
    v_mfma_f32_16x16x32_bf16 v[192:195], a[128:131], v[112:115], v[72:75]
    s_waitcnt vmcnt(18)
    ds_read_b128 a[184:187], v3 offset:14336
    v_mfma_f32_16x16x32_bf16 v[200:203], a[128:131], v[128:131], v[76:79]
    s_barrier
    ds_read_b128 a[188:191], v3 offset:15360
    v_mfma_f32_16x16x32_bf16 v[176:179], a[132:135], v[84:87], v[176:179]
    s_mov_b32 m0, s40
    v_exp_f32 v5, v153
    v_mfma_f32_16x16x32_bf16 v[184:187], a[132:135], v[100:103], v[184:187]
    s_add_u32 s43, s38, s49
    v_exp_f32 v6, v154
    v_mfma_f32_16x16x32_bf16 v[192:195], a[132:135], v[116:119], v[192:195]
    ds_read_b128 a[128:131], v2 offset:0
    v_cvt_pk_bf16_f32 v212, v4, v5
    v_mfma_f32_16x16x32_bf16 v[200:203], a[132:135], v[132:135], v[200:203]
    ds_read_b128 a[132:135], v2 offset:1024
    v_or3_b32 v12, v12, v219, v212
    v_mfma_f32_16x16x32_bf16 v[176:179], a[136:139], v[88:91], v[176:179]
    v_exp_f32 v7, v155
    v_mfma_f32_16x16x32_bf16 v[184:187], a[136:139], v[104:107], v[184:187]
    v_exp_f32 v8, v156
    v_mfma_f32_16x16x32_bf16 v[192:195], a[136:139], v[120:123], v[192:195]
    v_exp_f32 v9, v157
    v_mfma_f32_16x16x32_bf16 v[200:203], a[136:139], v[136:139], v[200:203]
    ds_read_b128 a[136:139], v2 offset:2048
    v_cvt_pk_bf16_f32 v213, v6, v7
    v_mfma_f32_16x16x32_bf16 v[176:179], a[140:143], v[92:95], v[176:179]
    v_exp_f32 v10, v158
    v_mfma_f32_16x16x32_bf16 v[184:187], a[140:143], v[108:111], v[184:187]
    v_exp_f32 v11, v159
    v_mfma_f32_16x16x32_bf16 v[192:195], a[140:143], v[124:127], v[192:195]
    v_exp_f32 v4, v144
    v_mfma_f32_16x16x32_bf16 v[200:203], a[140:143], v[140:143], v[200:203]
    s_waitcnt lgkmcnt(11)
    ds_read_b128 a[140:143], v2 offset:3072
    v_cvt_pk_bf16_f32 v214, v8, v9
    v_mfma_f32_16x16x32_bf16 v[180:183], a[144:147], v[80:83], v[64:67]
    v_exp_f32 v5, v145
    v_mfma_f32_16x16x32_bf16 v[188:191], a[144:147], v[96:99], v[68:71]
    v_exp_f32 v6, v146
    v_mfma_f32_16x16x32_bf16 v[196:199], a[144:147], v[112:115], v[72:75]
    v_exp_f32 v7, v147
    v_mfma_f32_16x16x32_bf16 v[204:207], a[144:147], v[128:131], v[76:79]
    ds_read_b128 a[144:147], v2 offset:4096
    v_or3_b32 v12, v12, v213, v214
    v_mfma_f32_16x16x32_bf16 v[180:183], a[148:151], v[84:87], v[180:183]
    buffer_load_dword a200, v19, s[8:11], s46 offen
    v_mfma_f32_16x16x32_bf16 v[188:191], a[148:151], v[100:103], v[188:191]
    v_exp_f32 v8, v148
    v_mfma_f32_16x16x32_bf16 v[196:199], a[148:151], v[116:119], v[196:199]
    v_exp_f32 v9, v149
    v_mfma_f32_16x16x32_bf16 v[204:207], a[148:151], v[132:135], v[204:207]
    ds_read_b128 a[148:151], v2 offset:5120
    v_cvt_pk_bf16_f32 v215, v10, v11
    v_mfma_f32_16x16x32_bf16 v[180:183], a[152:155], v[88:91], v[180:183]
    v_exp_f32 v10, v150
    v_mfma_f32_16x16x32_bf16 v[188:191], a[152:155], v[104:107], v[188:191]
    v_exp_f32 v11, v151
    v_mfma_f32_16x16x32_bf16 v[196:199], a[152:155], v[120:123], v[196:199]
    v_cvt_pk_bf16_f32 v208, v4, v5
    v_or3_b32 v12, v12, v215, v208
    v_mfma_f32_16x16x32_bf16 v[204:207], a[152:155], v[136:139], v[204:207]
    v_cvt_pk_bf16_f32 v209, v6, v7
    v_cvt_pk_bf16_f32 v210, v8, v9
    v_mfma_f32_16x16x32_bf16 v[180:183], a[156:159], v[92:95], v[180:183]
    v_or3_b32 v12, v12, v209, v210
    v_cvt_pk_bf16_f32 v211, v10, v11
    v_mfma_f32_16x16x32_bf16 v[188:191], a[156:159], v[108:111], v[188:191]
    v_bitop3_b32 v12, v12, v211, s42 bitop3:0xa8
    v_cmp_ne_u32 vcc, 0, v12
    v_mfma_f32_16x16x32_bf16 v[196:199], a[156:159], v[124:127], v[196:199]
    s_waitcnt lgkmcnt(10)
    ds_read_b128 a[152:155], v2 offset:6144
    v_mfma_f32_16x16x32_bf16 v[204:207], a[156:159], v[140:143], v[204:207]
    s_cbranch_vccnz gated_mix__ssm_conv_h3__compressed_kv_cla__prompt_kernel_b4_r0
gated_mix__ssm_conv_h3__compressed_kv_cla__prompt_kernel_b4_r0_ret:
    ds_read_b128 a[156:159], v2 offset:7168
    v_mfma_f32_16x16x32_bf16 a[0:3], a[160:163], v[208:211], a[0:3]
    v_mfma_f32_16x16x32_bf16 a[32:35], a[160:163], v[212:215], a[32:35]
    v_mfma_f32_16x16x32_bf16 a[64:67], a[160:163], v[216:219], a[64:67]
    buffer_load_dwordx4 v16, s[12:15], s38 offen offset:0 sc1 lds
    v_mfma_f32_16x16x32_bf16 a[96:99], a[160:163], v[220:223], a[96:99]
    s_cmp_eq_u32 s35, 1
    ds_read_b128 a[160:163], v3 offset:24576
    v_mfma_f32_16x16x32_bf16 a[4:7], a[164:167], v[208:211], a[4:7]
    s_cbranch_scc1 gated_mix__ssm_conv_h3__compressed_kv_cla__prompt_kernel_b4_m1
gated_mix__ssm_conv_h3__compressed_kv_cla__prompt_kernel_b4_m1_ret:
    v_mfma_f32_16x16x32_bf16 a[36:39], a[164:167], v[212:215], a[36:39]
    v_mfma_f32_16x16x32_bf16 a[68:71], a[164:167], v[216:219], a[68:71]
    v_mfma_f32_16x16x32_bf16 a[100:103], a[164:167], v[220:223], a[100:103]
    ds_read_b128 a[164:167], v3 offset:25600
    v_mfma_f32_16x16x32_bf16 a[8:11], a[168:171], v[208:211], a[8:11]
    v_mfma_f32_16x16x32_bf16 a[40:43], a[168:171], v[212:215], a[40:43]
    v_mfma_f32_16x16x32_bf16 a[72:75], a[168:171], v[216:219], a[72:75]
    v_exp_f32 v4, v200
    v_mfma_f32_16x16x32_bf16 a[104:107], a[168:171], v[220:223], a[104:107]
    ds_read_b128 a[168:171], v3 offset:26624
    v_mfma_f32_16x16x32_bf16 a[12:15], a[172:175], v[208:211], a[12:15]
    v_exp_f32 v5, v201
    v_mfma_f32_16x16x32_bf16 a[44:47], a[172:175], v[212:215], a[44:47]
    v_exp_f32 v6, v202
    v_mfma_f32_16x16x32_bf16 a[76:79], a[172:175], v[216:219], a[76:79]
    v_exp_f32 v7, v203
    v_mfma_f32_16x16x32_bf16 a[108:111], a[172:175], v[220:223], a[108:111]
    s_waitcnt lgkmcnt(11)
    ds_read_b128 a[172:175], v3 offset:27648
    v_mfma_f32_16x16x32_bf16 a[16:19], a[176:179], v[208:211], a[16:19]
    buffer_load_dwordx4 v16, s[12:15], s38 offen offset:1024 sc1 lds
    v_mfma_f32_16x16x32_bf16 a[48:51], a[176:179], v[212:215], a[48:51]
    v_exp_f32 v8, v204
    v_mfma_f32_16x16x32_bf16 a[80:83], a[176:179], v[216:219], a[80:83]
    v_exp_f32 v9, v205
    v_mfma_f32_16x16x32_bf16 a[112:115], a[176:179], v[220:223], a[112:115]
    ds_read_b128 a[176:179], v3 offset:28672
    v_cvt_pk_bf16_f32 v236, v4, v5
    v_mfma_f32_16x16x32_bf16 a[20:23], a[180:183], v[208:211], a[20:23]
    v_exp_f32 v10, v206
    v_mfma_f32_16x16x32_bf16 a[52:55], a[180:183], v[212:215], a[52:55]
    v_exp_f32 v11, v207
    v_mfma_f32_16x16x32_bf16 a[84:87], a[180:183], v[216:219], a[84:87]
    v_exp_f32 v4, v192
    v_mfma_f32_16x16x32_bf16 a[116:119], a[180:183], v[220:223], a[116:119]
    ds_read_b128 a[180:183], v3 offset:29696
    v_cvt_pk_bf16_f32 v237, v6, v7
    v_mfma_f32_16x16x32_bf16 a[24:27], a[184:187], v[208:211], a[24:27]
    v_exp_f32 v5, v193
    v_mfma_f32_16x16x32_bf16 a[56:59], a[184:187], v[212:215], a[56:59]
    v_exp_f32 v6, v194
    v_mfma_f32_16x16x32_bf16 a[88:91], a[184:187], v[216:219], a[88:91]
    v_exp_f32 v7, v195
    v_mfma_f32_16x16x32_bf16 a[120:123], a[184:187], v[220:223], a[120:123]
    ds_read_b128 a[184:187], v3 offset:30720
    v_cvt_pk_bf16_f32 v238, v8, v9
    v_mfma_f32_16x16x32_bf16 a[28:31], a[188:191], v[208:211], a[28:31]
    v_exp_f32 v8, v196
    v_mfma_f32_16x16x32_bf16 a[60:63], a[188:191], v[212:215], a[60:63]
    v_exp_f32 v9, v197
    v_mfma_f32_16x16x32_bf16 a[92:95], a[188:191], v[216:219], a[92:95]
    buffer_load_dwordx4 v16, s[12:15], s38 offen offset:2048 sc1 lds
    v_mfma_f32_16x16x32_bf16 a[124:127], a[188:191], v[220:223], a[124:127]
    ds_read_b128 a[188:191], v3 offset:31744
    v_or3_b32 v12, v236, v237, v238
    v_mfma_f32_16x16x32_bf16 v[240:243], v[24:27], v[208:211], v[240:243]
    v_cvt_pk_bf16_f32 v239, v10, v11
    v_cvt_pk_bf16_f32 v232, v4, v5
    v_mfma_f32_16x16x32_bf16 v[244:247], v[24:27], v[212:215], v[244:247]
    v_exp_f32 v10, v198
    v_mfma_f32_16x16x32_bf16 v[248:251], v[24:27], v[216:219], v[248:251]
    v_exp_f32 v11, v199
    v_mfma_f32_16x16x32_bf16 v[252:255], v[24:27], v[220:223], v[252:255]
    s_waitcnt lgkmcnt(12)
    v_exp_f32 v4, v184
    v_mfma_f32_16x16x32_bf16 v[144:147], a[128:131], v[80:83], v[64:67]
    v_exp_f32 v5, v185
    v_mfma_f32_16x16x32_bf16 v[152:155], a[128:131], v[96:99], v[68:71]
    v_or3_b32 v12, v12, v239, v232
    v_cvt_pk_bf16_f32 v233, v6, v7
    v_mfma_f32_16x16x32_bf16 v[160:163], a[128:131], v[112:115], v[72:75]
    v_exp_f32 v6, v186
    v_mfma_f32_16x16x32_bf16 v[168:171], a[128:131], v[128:131], v[76:79]
    ds_read_b128 a[128:131], v2 offset:16384
    v_cvt_pk_bf16_f32 v234, v8, v9
    v_mfma_f32_16x16x32_bf16 v[144:147], a[132:135], v[84:87], v[144:147]
    v_exp_f32 v7, v187
    v_mfma_f32_16x16x32_bf16 v[152:155], a[132:135], v[100:103], v[152:155]
    v_exp_f32 v8, v188
    v_mfma_f32_16x16x32_bf16 v[160:163], a[132:135], v[116:119], v[160:163]
    v_exp_f32 v9, v189
    v_mfma_f32_16x16x32_bf16 v[168:171], a[132:135], v[132:135], v[168:171]
    ds_read_b128 a[132:135], v2 offset:17408
    v_or3_b32 v12, v12, v233, v234
    v_mfma_f32_16x16x32_bf16 v[144:147], a[136:139], v[88:91], v[144:147]
    v_cvt_pk_bf16_f32 v235, v10, v11
    v_cvt_pk_bf16_f32 v228, v4, v5
    v_mfma_f32_16x16x32_bf16 v[152:155], a[136:139], v[104:107], v[152:155]
    buffer_load_dwordx4 v16, s[12:15], s38 offen offset:3072 sc1 lds
    v_mfma_f32_16x16x32_bf16 v[160:163], a[136:139], v[120:123], v[160:163]
    s_mov_b32 m0, s41
    v_exp_f32 v10, v190
    v_mfma_f32_16x16x32_bf16 v[168:171], a[136:139], v[136:139], v[168:171]
    ds_read_b128 a[136:139], v2 offset:18432
    v_or3_b32 v12, v12, v235, v228
    v_mfma_f32_16x16x32_bf16 v[144:147], a[140:143], v[92:95], v[144:147]
    v_exp_f32 v11, v191
    v_mfma_f32_16x16x32_bf16 v[152:155], a[140:143], v[108:111], v[152:155]
    v_exp_f32 v4, v176
    v_mfma_f32_16x16x32_bf16 v[160:163], a[140:143], v[124:127], v[160:163]
    v_exp_f32 v5, v177
    v_mfma_f32_16x16x32_bf16 v[168:171], a[140:143], v[140:143], v[168:171]
    s_waitcnt lgkmcnt(11)
    ds_read_b128 a[140:143], v2 offset:19456
    v_cvt_pk_bf16_f32 v229, v6, v7
    v_mfma_f32_16x16x32_bf16 v[148:151], a[144:147], v[80:83], v[64:67]
    v_exp_f32 v6, v178
    v_mfma_f32_16x16x32_bf16 v[156:159], a[144:147], v[96:99], v[68:71]
    v_exp_f32 v7, v179
    v_mfma_f32_16x16x32_bf16 v[164:167], a[144:147], v[112:115], v[72:75]
    v_cvt_pk_bf16_f32 v230, v8, v9
    v_or3_b32 v12, v12, v229, v230
    v_mfma_f32_16x16x32_bf16 v[172:175], a[144:147], v[128:131], v[76:79]
    ds_read_b128 a[144:147], v2 offset:20480
    v_cvt_pk_bf16_f32 v231, v10, v11
    v_mfma_f32_16x16x32_bf16 v[148:151], a[148:151], v[84:87], v[148:151]
    v_exp_f32 v8, v180
    v_mfma_f32_16x16x32_bf16 v[156:159], a[148:151], v[100:103], v[156:159]
    v_exp_f32 v9, v181
    v_mfma_f32_16x16x32_bf16 v[164:167], a[148:151], v[116:119], v[164:167]
    buffer_load_dwordx4 v16, s[12:15], s43 offen offset:0 sc1 lds
    v_mfma_f32_16x16x32_bf16 v[172:175], a[148:151], v[132:135], v[172:175]
    ds_read_b128 a[148:151], v2 offset:21504
    v_cvt_pk_bf16_f32 v224, v4, v5
    v_mfma_f32_16x16x32_bf16 v[148:151], a[152:155], v[88:91], v[148:151]
    v_exp_f32 v10, v182
    v_mfma_f32_16x16x32_bf16 v[156:159], a[152:155], v[104:107], v[156:159]
    v_exp_f32 v11, v183
    v_mfma_f32_16x16x32_bf16 v[164:167], a[152:155], v[120:123], v[164:167]
    v_or3_b32 v12, v12, v231, v224
    v_cvt_pk_bf16_f32 v225, v6, v7
    v_mfma_f32_16x16x32_bf16 v[172:175], a[152:155], v[136:139], v[172:175]
    ds_read_b128 a[152:155], v2 offset:22528
    v_cvt_pk_bf16_f32 v226, v8, v9
    v_mfma_f32_16x16x32_bf16 v[148:151], a[156:159], v[92:95], v[148:151]
    v_or3_b32 v12, v12, v225, v226
    v_cvt_pk_bf16_f32 v227, v10, v11
    v_mfma_f32_16x16x32_bf16 v[156:159], a[156:159], v[108:111], v[156:159]
    v_bitop3_b32 v12, v12, v227, s42 bitop3:0xa8
    v_cmp_ne_u32 vcc, 0, v12
    v_mfma_f32_16x16x32_bf16 v[164:167], a[156:159], v[124:127], v[164:167]
    s_waitcnt lgkmcnt(11)
    v_mfma_f32_16x16x32_bf16 v[172:175], a[156:159], v[140:143], v[172:175]
    s_cbranch_vccnz gated_mix__ssm_conv_h3__compressed_kv_cla__prompt_kernel_b4_r1
gated_mix__ssm_conv_h3__compressed_kv_cla__prompt_kernel_b4_r1_ret:
    ds_read_b128 a[156:159], v2 offset:23552
    v_mfma_f32_16x16x32_bf16 a[0:3], a[160:163], v[224:227], a[0:3]
    v_mfma_f32_16x16x32_bf16 a[32:35], a[160:163], v[228:231], a[32:35]
    s_add_u32 s38, s38, s44
    v_mfma_f32_16x16x32_bf16 a[64:67], a[160:163], v[232:235], a[64:67]
    s_add_u32 s40, s39, s59
    v_mfma_f32_16x16x32_bf16 a[96:99], a[160:163], v[236:239], a[96:99]
    s_add_u32 s41, s40, s50
    ds_read_b128 a[160:163], v2 offset:8192
    v_mfma_f32_16x16x32_bf16 a[4:7], a[164:167], v[224:227], a[4:7]
    s_mov_b32 s39, s45
    v_mfma_f32_16x16x32_bf16 a[36:39], a[164:167], v[228:231], a[36:39]
    buffer_load_dwordx4 v16, s[12:15], s43 offen offset:1024 sc1 lds
    v_mfma_f32_16x16x32_bf16 a[68:71], a[164:167], v[232:235], a[68:71]
    s_add_u32 s59, s59, s48
    v_mfma_f32_16x16x32_bf16 a[100:103], a[164:167], v[236:239], a[100:103]
    s_add_u32 s45, s45, 32768
    ds_read_b128 a[164:167], v2 offset:9216
    v_mfma_f32_16x16x32_bf16 a[8:11], a[168:171], v[224:227], a[8:11]
    s_cmp_eq_u32 s45, 163840
    v_mfma_f32_16x16x32_bf16 a[40:43], a[168:171], v[228:231], a[40:43]
    s_cselect_b32 s45, 0, s45
    v_mfma_f32_16x16x32_bf16 a[72:75], a[168:171], v[232:235], a[72:75]
    s_add_u32 s46, s46, 1048576
    v_exp_f32 v4, v168
    v_mfma_f32_16x16x32_bf16 a[104:107], a[168:171], v[236:239], a[104:107]
    s_sub_u32 s35, s35, 1
    ds_read_b128 a[168:171], v2 offset:10240
    v_mfma_f32_16x16x32_bf16 a[12:15], a[172:175], v[224:227], a[12:15]
    s_sub_u32 s58, s58, 1
    v_exp_f32 v5, v169
    v_mfma_f32_16x16x32_bf16 a[44:47], a[172:175], v[228:231], a[44:47]
    s_cmp_lg_u32 s58, 0
    v_exp_f32 v6, v170
    v_mfma_f32_16x16x32_bf16 a[76:79], a[172:175], v[232:235], a[76:79]
    v_exp_f32 v7, v171
    v_mfma_f32_16x16x32_bf16 a[108:111], a[172:175], v[236:239], a[108:111]
    s_waitcnt lgkmcnt(11)
    ds_read_b128 a[172:175], v2 offset:11264
    v_cvt_pk_bf16_f32 v220, v4, v5
    v_mfma_f32_16x16x32_bf16 a[16:19], a[176:179], v[224:227], a[16:19]
    v_exp_f32 v8, v172
    v_mfma_f32_16x16x32_bf16 a[48:51], a[176:179], v[228:231], a[48:51]
    v_exp_f32 v9, v173
    v_mfma_f32_16x16x32_bf16 a[80:83], a[176:179], v[232:235], a[80:83]
    v_exp_f32 v10, v174
    v_mfma_f32_16x16x32_bf16 a[112:115], a[176:179], v[236:239], a[112:115]
    buffer_load_dwordx4 v16, s[12:15], s43 offen offset:2048 sc1 lds
    v_mfma_f32_16x16x32_bf16 a[20:23], a[180:183], v[224:227], a[20:23]
    v_exp_f32 v11, v175
    v_mfma_f32_16x16x32_bf16 a[52:55], a[180:183], v[228:231], a[52:55]
    v_exp_f32 v4, v160
    v_mfma_f32_16x16x32_bf16 a[84:87], a[180:183], v[232:235], a[84:87]
    v_exp_f32 v5, v161
    v_mfma_f32_16x16x32_bf16 a[116:119], a[180:183], v[236:239], a[116:119]
    v_cvt_pk_bf16_f32 v221, v6, v7
    v_cvt_pk_bf16_f32 v222, v8, v9
    v_mfma_f32_16x16x32_bf16 a[24:27], a[184:187], v[224:227], a[24:27]
    v_exp_f32 v6, v162
    v_mfma_f32_16x16x32_bf16 a[56:59], a[184:187], v[228:231], a[56:59]
    v_exp_f32 v7, v163
    v_mfma_f32_16x16x32_bf16 a[88:91], a[184:187], v[232:235], a[88:91]
    v_exp_f32 v8, v164
    v_mfma_f32_16x16x32_bf16 a[120:123], a[184:187], v[236:239], a[120:123]
    v_exp_f32 v9, v165
    v_mfma_f32_16x16x32_bf16 a[28:31], a[188:191], v[224:227], a[28:31]
    v_or3_b32 v12, v220, v221, v222
    v_cvt_pk_bf16_f32 v223, v10, v11
    v_mfma_f32_16x16x32_bf16 a[60:63], a[188:191], v[228:231], a[60:63]
    v_exp_f32 v10, v166
    v_mfma_f32_16x16x32_bf16 a[92:95], a[188:191], v[232:235], a[92:95]
    v_exp_f32 v11, v167
    v_mfma_f32_16x16x32_bf16 a[124:127], a[188:191], v[236:239], a[124:127]
    v_cvt_pk_bf16_f32 v216, v4, v5
    v_or3_b32 v12, v12, v223, v216
    v_mfma_f32_16x16x32_bf16 v[240:243], v[24:27], v[224:227], v[240:243]
    v_cvt_pk_bf16_f32 v217, v6, v7
    v_cvt_pk_bf16_f32 v218, v8, v9
    v_mfma_f32_16x16x32_bf16 v[244:247], v[24:27], v[228:231], v[244:247]
    v_or3_b32 v12, v12, v217, v218
    v_cvt_pk_bf16_f32 v219, v10, v11
    v_mfma_f32_16x16x32_bf16 v[248:251], v[24:27], v[232:235], v[248:251]
gated_mix__ssm_conv_h3__compressed_kv_cla__prompt_kernel_pad9:
    s_cbranch_execz gated_mix__ssm_conv_h3__compressed_kv_cla__prompt_kernel_pad17
    buffer_load_dwordx4 v16, s[12:15], s43 offen offset:3072 sc1 lds
    v_mfma_f32_16x16x32_bf16 v[252:255], v[24:27], v[236:239], v[252:255]
    s_waitcnt lgkmcnt(8)
    v_mov_b32 v3, v2
    v_add_u32 v2, s45, v16
    s_cbranch_scc1 gated_mix__ssm_conv_h3__compressed_kv_cla__prompt_kernel_b4_loop
    s_cmp_lg_u32 s35, 0
    s_cbranch_scc1 gated_mix__ssm_conv_h3__compressed_kv_cla__prompt_kernel_b4_sw
    s_add_u32 s24, s94, 67108864
    s_addc_u32 s25, s95, 0
    s_mov_b32 s26, 16777216
    s_lshl_b32 s46, s2, 2
    s_add_u32 s46, s46, s32
    s_lshl_b32 s46, s46, 14
    s_add_u32 s46, s46, 8192
    s_nop 4
    v_accvgpr_read_b32 v36, a0
    v_accvgpr_read_b32 v37, a1
    v_accvgpr_read_b32 v38, a2
    v_accvgpr_read_b32 v39, a3
    v_accvgpr_read_b32 v40, a4
    v_accvgpr_read_b32 v41, a5
    v_accvgpr_read_b32 v42, a6
    v_accvgpr_read_b32 v43, a7
    v_rcp_f32 v32, v240
    s_nop 0
    v_pk_mul_f32 v[36:37], v[36:37], v[32:33] op_sel_hi:[1,0]
    v_pk_mul_f32 v[38:39], v[38:39], v[32:33] op_sel_hi:[1,0]
    v_pk_mul_f32 v[40:41], v[40:41], v[32:33] op_sel_hi:[1,0]
    v_pk_mul_f32 v[42:43], v[42:43], v[32:33] op_sel_hi:[1,0]
    v_cvt_pk_bf16_f32 v44, v36, v37
    v_cvt_pk_bf16_f32 v45, v38, v39
    v_cvt_pk_bf16_f32 v46, v40, v41
    v_cvt_pk_bf16_f32 v47, v42, v43
    buffer_store_dwordx4 v[44:47], v16, s[16:19], s60 offen offset:0 sc1
    v_accvgpr_read_b32 v36, a8
    v_accvgpr_read_b32 v37, a9
    v_accvgpr_read_b32 v38, a10
    v_accvgpr_read_b32 v39, a11
    v_accvgpr_read_b32 v40, a12
    v_accvgpr_read_b32 v41, a13
    v_accvgpr_read_b32 v42, a14
    v_accvgpr_read_b32 v43, a15
    v_pk_mul_f32 v[36:37], v[36:37], v[32:33] op_sel_hi:[1,0]
    v_pk_mul_f32 v[38:39], v[38:39], v[32:33] op_sel_hi:[1,0]
    v_pk_mul_f32 v[40:41], v[40:41], v[32:33] op_sel_hi:[1,0]
    v_pk_mul_f32 v[42:43], v[42:43], v[32:33] op_sel_hi:[1,0]
    v_cvt_pk_bf16_f32 v20, v36, v37
    v_cvt_pk_bf16_f32 v21, v38, v39
    v_cvt_pk_bf16_f32 v22, v40, v41
    v_cvt_pk_bf16_f32 v23, v42, v43
    buffer_store_dwordx4 v[20:23], v16, s[16:19], s60 offen offset:1024 sc1
    v_accvgpr_read_b32 v36, a16
    v_accvgpr_read_b32 v37, a17
    v_accvgpr_read_b32 v38, a18
    v_accvgpr_read_b32 v39, a19
    v_accvgpr_read_b32 v40, a20
    v_accvgpr_read_b32 v41, a21
    v_accvgpr_read_b32 v42, a22
    v_accvgpr_read_b32 v43, a23
    v_pk_mul_f32 v[36:37], v[36:37], v[32:33] op_sel_hi:[1,0]
    v_pk_mul_f32 v[38:39], v[38:39], v[32:33] op_sel_hi:[1,0]
    v_pk_mul_f32 v[40:41], v[40:41], v[32:33] op_sel_hi:[1,0]
    v_pk_mul_f32 v[42:43], v[42:43], v[32:33] op_sel_hi:[1,0]
    v_cvt_pk_bf16_f32 v44, v36, v37
    v_cvt_pk_bf16_f32 v45, v38, v39
    v_cvt_pk_bf16_f32 v46, v40, v41
    v_cvt_pk_bf16_f32 v47, v42, v43
    buffer_store_dwordx4 v[44:47], v16, s[16:19], s60 offen offset:2048 sc1
    v_accvgpr_read_b32 v36, a24
    v_accvgpr_read_b32 v37, a25
    v_accvgpr_read_b32 v38, a26
    v_accvgpr_read_b32 v39, a27
    v_accvgpr_read_b32 v40, a28
    v_accvgpr_read_b32 v41, a29
    v_accvgpr_read_b32 v42, a30
    v_accvgpr_read_b32 v43, a31
    v_pk_mul_f32 v[36:37], v[36:37], v[32:33] op_sel_hi:[1,0]
    v_pk_mul_f32 v[38:39], v[38:39], v[32:33] op_sel_hi:[1,0]
    v_pk_mul_f32 v[40:41], v[40:41], v[32:33] op_sel_hi:[1,0]
    v_pk_mul_f32 v[42:43], v[42:43], v[32:33] op_sel_hi:[1,0]
    v_cvt_pk_bf16_f32 v20, v36, v37
    v_cvt_pk_bf16_f32 v21, v38, v39
    v_cvt_pk_bf16_f32 v22, v40, v41
    v_cvt_pk_bf16_f32 v23, v42, v43
    buffer_store_dwordx4 v[20:23], v16, s[16:19], s60 offen offset:3072 sc1
    s_waitcnt vmcnt(12)
    v_and_b32 v17, v28, v29
    v_and_b32 v18, v30, v31
    v_and_b32 v17, v17, v18
    v_cmp_ne_u32 vcc, 1, v17
    s_nop 0
    s_cbranch_vccnz gated_mix__ssm_conv_h3__compressed_kv_cla__prompt_kernel_spin_all
gated_mix__ssm_conv_h3__compressed_kv_cla__prompt_kernel_spin_all_ret:
    v_mfma_f32_16x16x32_bf16 v[184:187], a[128:131], v[96:99], v[68:71]
    ds_read_b128 a[176:179], v3 offset:12288
    ds_read_b128 a[180:183], v3 offset:13312
    v_mfma_f32_16x16x32_bf16 v[192:195], a[128:131], v[112:115], v[72:75]
    v_mov_b32 v20, -1
    v_mov_b32 v21, -1
    v_mfma_f32_16x16x32_bf16 v[200:203], a[128:131], v[128:131], v[76:79]
    s_waitcnt vmcnt(16)
    ds_read_b128 a[184:187], v3 offset:14336
    v_mov_b32 v22, -1
    v_mfma_f32_16x16x32_bf16 v[184:187], a[132:135], v[100:103], v[184:187]
    s_barrier
    ds_read_b128 a[188:191], v3 offset:15360
    v_mov_b32 v23, -1
    v_mfma_f32_16x16x32_bf16 v[192:195], a[132:135], v[116:119], v[192:195]
    s_mov_b32 m0, s40
    v_add_f32 v152, v48, v152
    v_add_f32 v153, v49, v153
    v_mfma_f32_16x16x32_bf16 v[200:203], a[132:135], v[132:135], v[200:203]
    s_add_u32 s43, s38, s49
    v_add_f32 v154, v50, v154
    v_add_f32 v155, v51, v155
    v_mfma_f32_16x16x32_bf16 v[184:187], a[136:139], v[104:107], v[184:187]
    v_add_f32 v156, v52, v156
    v_add_f32 v157, v53, v157
    v_mfma_f32_16x16x32_bf16 v[192:195], a[136:139], v[120:123], v[192:195]
    v_add_f32 v158, v54, v158
    v_add_f32 v159, v55, v159
    v_mfma_f32_16x16x32_bf16 v[200:203], a[136:139], v[136:139], v[200:203]
    v_exp_f32 v4, v152
    v_mfma_f32_16x16x32_bf16 v[184:187], a[140:143], v[108:111], v[184:187]
    v_exp_f32 v5, v153
    v_mfma_f32_16x16x32_bf16 v[192:195], a[140:143], v[124:127], v[192:195]
    v_exp_f32 v6, v154
    v_mfma_f32_16x16x32_bf16 v[200:203], a[140:143], v[140:143], v[200:203]
    s_waitcnt lgkmcnt(8)
    v_exp_f32 v7, v155
    v_mfma_f32_16x16x32_bf16 v[188:191], a[144:147], v[96:99], v[68:71]
    v_exp_f32 v8, v156
    v_mfma_f32_16x16x32_bf16 v[196:199], a[144:147], v[112:115], v[72:75]
    buffer_store_dwordx4 v[20:23], v16, s[24:27], s46 offen offset:0 sc1
    v_mfma_f32_16x16x32_bf16 v[204:207], a[144:147], v[128:131], v[76:79]
    v_exp_f32 v9, v157
    v_mfma_f32_16x16x32_bf16 v[188:191], a[148:151], v[100:103], v[188:191]
    v_exp_f32 v10, v158
    v_mfma_f32_16x16x32_bf16 v[196:199], a[148:151], v[116:119], v[196:199]
    v_exp_f32 v11, v159
    v_mfma_f32_16x16x32_bf16 v[204:207], a[148:151], v[132:135], v[204:207]
    v_cvt_pk_bf16_f32 v212, v4, v5
    v_or3_b32 v12, v12, v219, v212
    v_mfma_f32_16x16x32_bf16 v[188:191], a[152:155], v[104:107], v[188:191]
    v_cvt_pk_bf16_f32 v213, v6, v7
    v_cvt_pk_bf16_f32 v214, v8, v9
    v_mfma_f32_16x16x32_bf16 v[196:199], a[152:155], v[120:123], v[196:199]
    v_or3_b32 v12, v12, v213, v214
    v_cvt_pk_bf16_f32 v215, v10, v11
    v_mfma_f32_16x16x32_bf16 v[204:207], a[152:155], v[136:139], v[204:207]
    v_bitop3_b32 v12, v12, v215, s42 bitop3:0xa8
    v_cmp_ne_u32 vcc, 0, v12
    v_mfma_f32_16x16x32_bf16 v[188:191], a[156:159], v[108:111], v[188:191]
    buffer_store_dwordx4 v[20:23], v16, s[24:27], s46 offen offset:1024 sc1
    v_mfma_f32_16x16x32_bf16 v[196:199], a[156:159], v[124:127], v[196:199]
    s_waitcnt lgkmcnt(4)
    ds_read_b128 a[128:131], v2 offset:0
    ds_read_b128 a[132:135], v2 offset:1024
    v_mfma_f32_16x16x32_bf16 v[204:207], a[156:159], v[140:143], v[204:207]
    s_cbranch_vccnz gated_mix__ssm_conv_h3__compressed_kv_cla__prompt_kernel_b3_r0
gated_mix__ssm_conv_h3__compressed_kv_cla__prompt_kernel_b3_r0_ret:
    ds_read_b128 a[136:139], v2 offset:2048
    ds_read_b128 a[140:143], v2 offset:3072
    v_mfma_f32_16x16x32_bf16 a[32:35], a[160:163], v[212:215], a[32:35]
    ds_read_b128 a[144:147], v2 offset:4096
    ds_read_b128 a[148:151], v2 offset:5120
    v_mfma_f32_16x16x32_bf16 a[64:67], a[160:163], v[216:219], a[64:67]
    ds_read_b128 a[152:155], v2 offset:6144
    ds_read_b128 a[156:159], v2 offset:7168
    v_mfma_f32_16x16x32_bf16 a[96:99], a[160:163], v[220:223], a[96:99]
    v_exp_f32 v4, v200
    v_mfma_f32_16x16x32_bf16 a[36:39], a[164:167], v[212:215], a[36:39]
    v_exp_f32 v5, v201
    v_mfma_f32_16x16x32_bf16 a[68:71], a[164:167], v[216:219], a[68:71]
    v_exp_f32 v6, v202
    v_mfma_f32_16x16x32_bf16 a[100:103], a[164:167], v[220:223], a[100:103]
    buffer_store_dwordx4 v[20:23], v16, s[24:27], s46 offen offset:2048 sc1
    v_mfma_f32_16x16x32_bf16 a[40:43], a[168:171], v[212:215], a[40:43]
    v_exp_f32 v7, v203
    v_mfma_f32_16x16x32_bf16 a[72:75], a[168:171], v[216:219], a[72:75]
    ds_read_b128 a[160:163], v3 offset:24576
    v_cvt_pk_bf16_f32 v236, v4, v5
    v_mfma_f32_16x16x32_bf16 a[104:107], a[168:171], v[220:223], a[104:107]
    v_exp_f32 v8, v204
    v_mfma_f32_16x16x32_bf16 a[44:47], a[172:175], v[212:215], a[44:47]
    v_exp_f32 v9, v205
    v_mfma_f32_16x16x32_bf16 a[76:79], a[172:175], v[216:219], a[76:79]
    ds_read_b128 a[164:167], v3 offset:25600
    v_cvt_pk_bf16_f32 v237, v6, v7
    v_mfma_f32_16x16x32_bf16 a[108:111], a[172:175], v[220:223], a[108:111]
    s_waitcnt lgkmcnt(10)
    ds_read_b128 a[168:171], v3 offset:26624
    v_cvt_pk_bf16_f32 v238, v8, v9
    v_mfma_f32_16x16x32_bf16 a[48:51], a[176:179], v[212:215], a[48:51]
    v_exp_f32 v10, v206
    v_mfma_f32_16x16x32_bf16 a[80:83], a[176:179], v[216:219], a[80:83]
    buffer_store_dwordx4 v[20:23], v16, s[24:27], s46 offen offset:3072 sc1
    v_mfma_f32_16x16x32_bf16 a[112:115], a[176:179], v[220:223], a[112:115]
    v_exp_f32 v11, v207
    v_mfma_f32_16x16x32_bf16 a[52:55], a[180:183], v[212:215], a[52:55]
    ds_read_b128 a[172:175], v3 offset:27648
    v_or3_b32 v12, v236, v237, v238
    v_mfma_f32_16x16x32_bf16 a[84:87], a[180:183], v[216:219], a[84:87]
    v_exp_f32 v4, v192
    v_mfma_f32_16x16x32_bf16 a[116:119], a[180:183], v[220:223], a[116:119]
    v_exp_f32 v5, v193
    v_mfma_f32_16x16x32_bf16 a[56:59], a[184:187], v[212:215], a[56:59]
    ds_read_b128 a[176:179], v3 offset:28672
    v_cvt_pk_bf16_f32 v239, v10, v11
    v_mfma_f32_16x16x32_bf16 a[88:91], a[184:187], v[216:219], a[88:91]
    ds_read_b128 a[180:183], v3 offset:29696
    v_cvt_pk_bf16_f32 v232, v4, v5
    v_mfma_f32_16x16x32_bf16 a[120:123], a[184:187], v[220:223], a[120:123]
    v_exp_f32 v6, v194
    v_mfma_f32_16x16x32_bf16 a[60:63], a[188:191], v[212:215], a[60:63]
    buffer_load_dwordx4 v16, s[12:15], s38 offen offset:0 sc1 lds
    v_mfma_f32_16x16x32_bf16 a[92:95], a[188:191], v[216:219], a[92:95]
    v_exp_f32 v7, v195
    v_mfma_f32_16x16x32_bf16 a[124:127], a[188:191], v[220:223], a[124:127]
    ds_read_b128 a[184:187], v3 offset:30720
    v_or3_b32 v12, v12, v239, v232
    v_mfma_f32_16x16x32_bf16 v[244:247], v[24:27], v[212:215], v[244:247]
    v_exp_f32 v8, v196
    v_mfma_f32_16x16x32_bf16 v[248:251], v[24:27], v[216:219], v[248:251]
    v_exp_f32 v9, v197
    v_mfma_f32_16x16x32_bf16 v[252:255], v[24:27], v[220:223], v[252:255]
    s_waitcnt lgkmcnt(11)
    v_exp_f32 v10, v198
    v_mfma_f32_16x16x32_bf16 v[152:155], a[128:131], v[96:99], v[68:71]
    v_exp_f32 v11, v199
    v_mfma_f32_16x16x32_bf16 v[160:163], a[128:131], v[112:115], v[72:75]
    v_cvt_pk_bf16_f32 v233, v6, v7
    v_cvt_pk_bf16_f32 v234, v8, v9
    v_mfma_f32_16x16x32_bf16 v[168:171], a[128:131], v[128:131], v[76:79]
    buffer_load_dwordx4 v16, s[12:15], s38 offen offset:1024 sc1 lds
    v_mfma_f32_16x16x32_bf16 v[152:155], a[132:135], v[100:103], v[152:155]
    v_or3_b32 v12, v12, v233, v234
    v_cvt_pk_bf16_f32 v235, v10, v11
    v_mfma_f32_16x16x32_bf16 v[160:163], a[132:135], v[116:119], v[160:163]
    v_add_f32 v184, v56, v184
    v_add_f32 v185, v57, v185
    v_mfma_f32_16x16x32_bf16 v[168:171], a[132:135], v[132:135], v[168:171]
    v_add_f32 v186, v58, v186
    v_add_f32 v187, v59, v187
    v_mfma_f32_16x16x32_bf16 v[152:155], a[136:139], v[104:107], v[152:155]
    v_add_f32 v188, v60, v188
    v_add_f32 v189, v61, v189
    v_mfma_f32_16x16x32_bf16 v[160:163], a[136:139], v[120:123], v[160:163]
    v_add_f32 v190, v62, v190
    v_add_f32 v191, v63, v191
    v_mfma_f32_16x16x32_bf16 v[168:171], a[136:139], v[136:139], v[168:171]
    v_exp_f32 v4, v184
    v_mfma_f32_16x16x32_bf16 v[152:155], a[140:143], v[108:111], v[152:155]
    buffer_load_dwordx4 v16, s[12:15], s38 offen offset:2048 sc1 lds
    v_mfma_f32_16x16x32_bf16 v[160:163], a[140:143], v[124:127], v[160:163]
    v_exp_f32 v5, v185
    v_mfma_f32_16x16x32_bf16 v[168:171], a[140:143], v[140:143], v[168:171]
    s_waitcnt lgkmcnt(7)
    v_exp_f32 v6, v186
    v_mfma_f32_16x16x32_bf16 v[156:159], a[144:147], v[96:99], v[68:71]
    v_exp_f32 v7, v187
    v_mfma_f32_16x16x32_bf16 v[164:167], a[144:147], v[112:115], v[72:75]
    v_exp_f32 v8, v188
    v_mfma_f32_16x16x32_bf16 v[172:175], a[144:147], v[128:131], v[76:79]
    v_exp_f32 v9, v189
    v_mfma_f32_16x16x32_bf16 v[156:159], a[148:151], v[100:103], v[156:159]
    v_exp_f32 v10, v190
    v_mfma_f32_16x16x32_bf16 v[164:167], a[148:151], v[116:119], v[164:167]
    v_exp_f32 v11, v191
    v_mfma_f32_16x16x32_bf16 v[172:175], a[148:151], v[132:135], v[172:175]
    buffer_load_dwordx4 v16, s[12:15], s38 offen offset:3072 sc1 lds
    v_mfma_f32_16x16x32_bf16 v[156:159], a[152:155], v[104:107], v[156:159]
    s_mov_b32 m0, s41
    v_cvt_pk_bf16_f32 v228, v4, v5
    v_or3_b32 v12, v12, v235, v228
    v_mfma_f32_16x16x32_bf16 v[164:167], a[152:155], v[120:123], v[164:167]
    v_cvt_pk_bf16_f32 v229, v6, v7
    v_cvt_pk_bf16_f32 v230, v8, v9
    v_mfma_f32_16x16x32_bf16 v[172:175], a[152:155], v[136:139], v[172:175]
    v_or3_b32 v12, v12, v229, v230
    v_cvt_pk_bf16_f32 v231, v10, v11
    v_mfma_f32_16x16x32_bf16 v[156:159], a[156:159], v[108:111], v[156:159]
    v_bitop3_b32 v12, v12, v231, s42 bitop3:0xa8
    v_cmp_ne_u32 vcc, 0, v12
    v_mfma_f32_16x16x32_bf16 v[164:167], a[156:159], v[124:127], v[164:167]
    s_waitcnt lgkmcnt(3)
    ds_read_b128 a[188:191], v3 offset:31744
    v_mfma_f32_16x16x32_bf16 v[172:175], a[156:159], v[140:143], v[172:175]
    s_cbranch_vccnz gated_mix__ssm_conv_h3__compressed_kv_cla__prompt_kernel_b3_r1
gated_mix__ssm_conv_h3__compressed_kv_cla__prompt_kernel_b3_r1_ret:
    ds_read_b128 a[128:131], v2 offset:16384
    v_mfma_f32_16x16x32_bf16 a[32:35], a[160:163], v[228:231], a[32:35]
    ds_read_b128 a[132:135], v2 offset:17408
    v_mfma_f32_16x16x32_bf16 a[64:67], a[160:163], v[232:235], a[64:67]
    buffer_load_dwordx4 v16, s[12:15], s43 offen offset:0 sc1 lds
    v_mfma_f32_16x16x32_bf16 a[96:99], a[160:163], v[236:239], a[96:99]
    s_add_u32 s38, s38, s44
    ds_read_b128 a[136:139], v2 offset:18432
    v_mfma_f32_16x16x32_bf16 a[36:39], a[164:167], v[228:231], a[36:39]
    s_add_u32 s40, s39, s59
    ds_read_b128 a[140:143], v2 offset:19456
    v_mfma_f32_16x16x32_bf16 a[68:71], a[164:167], v[232:235], a[68:71]
    s_add_u32 s41, s40, s50
    ds_read_b128 a[144:147], v2 offset:20480
    v_mfma_f32_16x16x32_bf16 a[100:103], a[164:167], v[236:239], a[100:103]
    s_mov_b32 s39, s45
    ds_read_b128 a[148:151], v2 offset:21504
    v_mfma_f32_16x16x32_bf16 a[40:43], a[168:171], v[228:231], a[40:43]
    s_add_u32 s59, s59, s48
    ds_read_b128 a[152:155], v2 offset:22528
    v_mfma_f32_16x16x32_bf16 a[72:75], a[168:171], v[232:235], a[72:75]
    s_add_u32 s45, s45, 32768
    ds_read_b128 a[156:159], v2 offset:23552
    v_mfma_f32_16x16x32_bf16 a[104:107], a[168:171], v[236:239], a[104:107]
    s_cmp_eq_u32 s45, 163840
    ds_read_b128 a[160:163], v2 offset:8192
    v_mfma_f32_16x16x32_bf16 a[44:47], a[172:175], v[228:231], a[44:47]
    buffer_load_dwordx4 v16, s[12:15], s43 offen offset:1024 sc1 lds
    v_mfma_f32_16x16x32_bf16 a[76:79], a[172:175], v[232:235], a[76:79]
    s_cselect_b32 s45, 0, s45
    ds_read_b128 a[164:167], v2 offset:9216
    v_mfma_f32_16x16x32_bf16 a[108:111], a[172:175], v[236:239], a[108:111]
    s_waitcnt lgkmcnt(10)
    ds_read_b128 a[168:171], v2 offset:10240
    v_mfma_f32_16x16x32_bf16 a[48:51], a[176:179], v[228:231], a[48:51]
    ds_read_b128 a[172:175], v2 offset:11264
    v_mfma_f32_16x16x32_bf16 a[80:83], a[176:179], v[232:235], a[80:83]
    v_exp_f32 v4, v168
    v_mfma_f32_16x16x32_bf16 a[112:115], a[176:179], v[236:239], a[112:115]
    v_exp_f32 v5, v169
    v_mfma_f32_16x16x32_bf16 a[52:55], a[180:183], v[228:231], a[52:55]
    v_exp_f32 v6, v170
    v_mfma_f32_16x16x32_bf16 a[84:87], a[180:183], v[232:235], a[84:87]
    v_exp_f32 v7, v171
    v_mfma_f32_16x16x32_bf16 a[116:119], a[180:183], v[236:239], a[116:119]
    buffer_load_dwordx4 v16, s[12:15], s43 offen offset:2048 sc1 lds
    v_mfma_f32_16x16x32_bf16 a[56:59], a[184:187], v[228:231], a[56:59]
    v_exp_f32 v8, v172
    v_mfma_f32_16x16x32_bf16 a[88:91], a[184:187], v[232:235], a[88:91]
    v_exp_f32 v9, v173
    v_mfma_f32_16x16x32_bf16 a[120:123], a[184:187], v[236:239], a[120:123]
    v_exp_f32 v10, v174
    v_mfma_f32_16x16x32_bf16 a[60:63], a[188:191], v[228:231], a[60:63]
    v_exp_f32 v11, v175
    v_mfma_f32_16x16x32_bf16 a[92:95], a[188:191], v[232:235], a[92:95]
    v_cvt_pk_bf16_f32 v220, v4, v5
    v_mfma_f32_16x16x32_bf16 a[124:127], a[188:191], v[236:239], a[124:127]
    v_cvt_pk_bf16_f32 v221, v6, v7
    v_cvt_pk_bf16_f32 v222, v8, v9
    v_mfma_f32_16x16x32_bf16 v[244:247], v[24:27], v[228:231], v[244:247]
    v_or3_b32 v12, v220, v221, v222
    v_cvt_pk_bf16_f32 v223, v10, v11
    v_mfma_f32_16x16x32_bf16 v[248:251], v[24:27], v[232:235], v[248:251]
    buffer_load_dwordx4 v16, s[12:15], s43 offen offset:3072 sc1 lds
    v_mfma_f32_16x16x32_bf16 v[252:255], v[24:27], v[236:239], v[252:255]
    s_waitcnt lgkmcnt(8)
    v_mov_b32 v3, v2
    v_add_u32 v2, s45, v16
    s_nop 4
    v_accvgpr_read_b32 v36, a32
    v_accvgpr_read_b32 v37, a33
    v_accvgpr_read_b32 v38, a34
    v_accvgpr_read_b32 v39, a35
    v_accvgpr_read_b32 v40, a36
    v_accvgpr_read_b32 v41, a37
    v_accvgpr_read_b32 v42, a38
    v_accvgpr_read_b32 v43, a39
    v_rcp_f32 v32, v244
    s_nop 0
    v_pk_mul_f32 v[36:37], v[36:37], v[32:33] op_sel_hi:[1,0]
    v_pk_mul_f32 v[38:39], v[38:39], v[32:33] op_sel_hi:[1,0]
    v_pk_mul_f32 v[40:41], v[40:41], v[32:33] op_sel_hi:[1,0]
    v_pk_mul_f32 v[42:43], v[42:43], v[32:33] op_sel_hi:[1,0]
    v_cvt_pk_bf16_f32 v44, v36, v37
    v_cvt_pk_bf16_f32 v45, v38, v39
    v_cvt_pk_bf16_f32 v46, v40, v41
    v_cvt_pk_bf16_f32 v47, v42, v43
    buffer_store_dwordx4 v[44:47], v16, s[16:19], s61 offen offset:0 sc1
    v_accvgpr_read_b32 v36, a40
    v_accvgpr_read_b32 v37, a41
    v_accvgpr_read_b32 v38, a42
    v_accvgpr_read_b32 v39, a43
    v_accvgpr_read_b32 v40, a44
    v_accvgpr_read_b32 v41, a45
    v_accvgpr_read_b32 v42, a46
    v_accvgpr_read_b32 v43, a47
    v_pk_mul_f32 v[36:37], v[36:37], v[32:33] op_sel_hi:[1,0]
    v_pk_mul_f32 v[38:39], v[38:39], v[32:33] op_sel_hi:[1,0]
    v_pk_mul_f32 v[40:41], v[40:41], v[32:33] op_sel_hi:[1,0]
    v_pk_mul_f32 v[42:43], v[42:43], v[32:33] op_sel_hi:[1,0]
    v_cvt_pk_bf16_f32 v20, v36, v37
    v_cvt_pk_bf16_f32 v21, v38, v39
    v_cvt_pk_bf16_f32 v22, v40, v41
    v_cvt_pk_bf16_f32 v23, v42, v43
    buffer_store_dwordx4 v[20:23], v16, s[16:19], s61 offen offset:1024 sc1
    v_accvgpr_read_b32 v36, a48
    v_accvgpr_read_b32 v37, a49
    v_accvgpr_read_b32 v38, a50
    v_accvgpr_read_b32 v39, a51
    v_accvgpr_read_b32 v40, a52
    v_accvgpr_read_b32 v41, a53
    v_accvgpr_read_b32 v42, a54
    v_accvgpr_read_b32 v43, a55
    v_pk_mul_f32 v[36:37], v[36:37], v[32:33] op_sel_hi:[1,0]
    v_pk_mul_f32 v[38:39], v[38:39], v[32:33] op_sel_hi:[1,0]
    v_pk_mul_f32 v[40:41], v[40:41], v[32:33] op_sel_hi:[1,0]
    v_pk_mul_f32 v[42:43], v[42:43], v[32:33] op_sel_hi:[1,0]
    v_cvt_pk_bf16_f32 v44, v36, v37
    v_cvt_pk_bf16_f32 v45, v38, v39
    v_cvt_pk_bf16_f32 v46, v40, v41
    v_cvt_pk_bf16_f32 v47, v42, v43
    buffer_store_dwordx4 v[44:47], v16, s[16:19], s61 offen offset:2048 sc1
    v_accvgpr_read_b32 v36, a56
    v_accvgpr_read_b32 v37, a57
    v_accvgpr_read_b32 v38, a58
    v_accvgpr_read_b32 v39, a59
    v_accvgpr_read_b32 v40, a60
    v_accvgpr_read_b32 v41, a61
    v_accvgpr_read_b32 v42, a62
    v_accvgpr_read_b32 v43, a63
    v_pk_mul_f32 v[36:37], v[36:37], v[32:33] op_sel_hi:[1,0]
    v_pk_mul_f32 v[38:39], v[38:39], v[32:33] op_sel_hi:[1,0]
    v_pk_mul_f32 v[40:41], v[40:41], v[32:33] op_sel_hi:[1,0]
    v_pk_mul_f32 v[42:43], v[42:43], v[32:33] op_sel_hi:[1,0]
    v_cvt_pk_bf16_f32 v20, v36, v37
    v_cvt_pk_bf16_f32 v21, v38, v39
    v_cvt_pk_bf16_f32 v22, v40, v41
    v_cvt_pk_bf16_f32 v23, v42, v43
    buffer_store_dwordx4 v[20:23], v16, s[16:19], s61 offen offset:3072 sc1
    s_lshl_b32 s35, s34, 2
    s_sub_u32 s35, 29, s35
    s_sub_u32 s58, s35, 3
    s_cmp_eq_u32 s34, 7
    s_cselect_b32 s58, s35, s58
    s_nop 0
    s_nop 0
    s_nop 0
    s_nop 0
    s_nop 0
    s_nop 0
    s_nop 0
    s_nop 0
    s_nop 0
    s_nop 0
    s_nop 0
    s_nop 0
    s_nop 0
    s_nop 0
    s_nop 0
gated_mix__ssm_conv_h3__compressed_kv_cla__prompt_kernel_b2_loop:
    v_mfma_f32_16x16x32_bf16 v[192:195], a[128:131], v[112:115], v[72:75]
    s_cmp_eq_u32 s35, 1
    ds_read_b128 a[176:179], v3 offset:12288
    ds_read_b128 a[180:183], v3 offset:13312
    v_mfma_f32_16x16x32_bf16 v[200:203], a[128:131], v[128:131], v[76:79]
    s_cbranch_scc1 gated_mix__ssm_conv_h3__compressed_kv_cla__prompt_kernel_b2_m0
gated_mix__ssm_conv_h3__compressed_kv_cla__prompt_kernel_b2_m0_ret:
    ds_read_b128 a[184:187], v3 offset:14336
    v_exp_f32 v4, v160
    v_mfma_f32_16x16x32_bf16 v[192:195], a[132:135], v[116:119], v[192:195]
    s_waitcnt vmcnt(16)
    ds_read_b128 a[188:191], v3 offset:15360
    v_exp_f32 v5, v161
    v_mfma_f32_16x16x32_bf16 v[200:203], a[132:135], v[132:135], v[200:203]
    s_barrier
    ds_read_b128 a[128:131], v2 offset:0
    v_exp_f32 v6, v162
    v_mfma_f32_16x16x32_bf16 v[192:195], a[136:139], v[120:123], v[192:195]
    s_mov_b32 m0, s40
    v_exp_f32 v7, v163
    v_mfma_f32_16x16x32_bf16 v[200:203], a[136:139], v[136:139], v[200:203]
    s_add_u32 s43, s38, s49
    v_exp_f32 v8, v164
    v_mfma_f32_16x16x32_bf16 v[192:195], a[140:143], v[124:127], v[192:195]
    v_exp_f32 v9, v165
    v_mfma_f32_16x16x32_bf16 v[200:203], a[140:143], v[140:143], v[200:203]
    s_waitcnt lgkmcnt(9)
    ds_read_b128 a[132:135], v2 offset:1024
    v_exp_f32 v10, v166
    v_mfma_f32_16x16x32_bf16 v[196:199], a[144:147], v[112:115], v[72:75]
    v_exp_f32 v11, v167
    v_mfma_f32_16x16x32_bf16 v[204:207], a[144:147], v[128:131], v[76:79]
    v_cvt_pk_bf16_f32 v216, v4, v5
    v_or3_b32 v12, v12, v223, v216
    v_mfma_f32_16x16x32_bf16 v[196:199], a[148:151], v[116:119], v[196:199]
    v_cvt_pk_bf16_f32 v217, v6, v7
    v_cvt_pk_bf16_f32 v218, v8, v9
    v_mfma_f32_16x16x32_bf16 v[204:207], a[148:151], v[132:135], v[204:207]
    v_or3_b32 v12, v12, v217, v218
    v_cvt_pk_bf16_f32 v219, v10, v11
    v_mfma_f32_16x16x32_bf16 v[196:199], a[152:155], v[120:123], v[196:199]
    v_bitop3_b32 v12, v12, v219, s42 bitop3:0xa8
    v_cmp_ne_u32 vcc, 0, v12
    v_mfma_f32_16x16x32_bf16 v[204:207], a[152:155], v[136:139], v[204:207]
    buffer_load_dwordx4 v16, s[12:15], s38 offen offset:0 sc1 lds
    v_mfma_f32_16x16x32_bf16 v[196:199], a[156:159], v[124:127], v[196:199]
    s_waitcnt lgkmcnt(6)
    ds_read_b128 a[136:139], v2 offset:2048
    ds_read_b128 a[140:143], v2 offset:3072
    v_mfma_f32_16x16x32_bf16 v[204:207], a[156:159], v[140:143], v[204:207]
    s_cbranch_vccnz gated_mix__ssm_conv_h3__compressed_kv_cla__prompt_kernel_b2_r0
gated_mix__ssm_conv_h3__compressed_kv_cla__prompt_kernel_b2_r0_ret:
    ds_read_b128 a[144:147], v2 offset:4096
    ds_read_b128 a[148:151], v2 offset:5120
    v_mfma_f32_16x16x32_bf16 a[64:67], a[160:163], v[216:219], a[64:67]
    v_exp_f32 v4, v200
    v_mfma_f32_16x16x32_bf16 a[96:99], a[160:163], v[220:223], a[96:99]
    ds_read_b128 a[152:155], v2 offset:6144
    ds_read_b128 a[156:159], v2 offset:7168
    v_mfma_f32_16x16x32_bf16 a[68:71], a[164:167], v[216:219], a[68:71]
    v_exp_f32 v5, v201
    v_mfma_f32_16x16x32_bf16 a[100:103], a[164:167], v[220:223], a[100:103]
    s_cmp_eq_u32 s35, 1
    ds_read_b128 a[160:163], v3 offset:24576
    ds_read_b128 a[164:167], v3 offset:25600
    v_mfma_f32_16x16x32_bf16 a[72:75], a[168:171], v[216:219], a[72:75]
    s_cbranch_scc1 gated_mix__ssm_conv_h3__compressed_kv_cla__prompt_kernel_b2_m1
gated_mix__ssm_conv_h3__compressed_kv_cla__prompt_kernel_b2_m1_ret:
    v_exp_f32 v6, v202
    v_mfma_f32_16x16x32_bf16 a[104:107], a[168:171], v[220:223], a[104:107]
    buffer_load_dwordx4 v16, s[12:15], s38 offen offset:1024 sc1 lds
    v_mfma_f32_16x16x32_bf16 a[76:79], a[172:175], v[216:219], a[76:79]
    v_exp_f32 v7, v203
    v_mfma_f32_16x16x32_bf16 a[108:111], a[172:175], v[220:223], a[108:111]
    s_waitcnt lgkmcnt(10)
    ds_read_b128 a[168:171], v3 offset:26624
    v_cvt_pk_bf16_f32 v236, v4, v5
    v_mfma_f32_16x16x32_bf16 a[80:83], a[176:179], v[216:219], a[80:83]
    v_exp_f32 v8, v204
    v_mfma_f32_16x16x32_bf16 a[112:115], a[176:179], v[220:223], a[112:115]
    ds_read_b128 a[172:175], v3 offset:27648
    ds_read_b128 a[176:179], v3 offset:28672
    v_mfma_f32_16x16x32_bf16 a[84:87], a[180:183], v[216:219], a[84:87]
    v_exp_f32 v9, v205
    v_mfma_f32_16x16x32_bf16 a[116:119], a[180:183], v[220:223], a[116:119]
    ds_read_b128 a[180:183], v3 offset:29696
    v_cvt_pk_bf16_f32 v237, v6, v7
    v_mfma_f32_16x16x32_bf16 a[88:91], a[184:187], v[216:219], a[88:91]
    buffer_load_dwordx4 v16, s[12:15], s38 offen offset:2048 sc1 lds
    v_mfma_f32_16x16x32_bf16 a[120:123], a[184:187], v[220:223], a[120:123]
    v_exp_f32 v10, v206
    v_mfma_f32_16x16x32_bf16 a[92:95], a[188:191], v[216:219], a[92:95]
    ds_read_b128 a[184:187], v3 offset:30720
    v_cvt_pk_bf16_f32 v238, v8, v9
    v_mfma_f32_16x16x32_bf16 a[124:127], a[188:191], v[220:223], a[124:127]
    ds_read_b128 a[188:191], v3 offset:31744
    v_or3_b32 v12, v236, v237, v238
    v_mfma_f32_16x16x32_bf16 v[248:251], v[24:27], v[216:219], v[248:251]
    v_exp_f32 v11, v207
    v_mfma_f32_16x16x32_bf16 v[252:255], v[24:27], v[220:223], v[252:255]
    s_waitcnt lgkmcnt(12)
    v_exp_f32 v4, v192
    v_mfma_f32_16x16x32_bf16 v[160:163], a[128:131], v[112:115], v[72:75]
    v_exp_f32 v5, v193
    v_mfma_f32_16x16x32_bf16 v[168:171], a[128:131], v[128:131], v[76:79]
    ds_read_b128 a[128:131], v2 offset:16384
    v_cvt_pk_bf16_f32 v239, v10, v11
    v_mfma_f32_16x16x32_bf16 v[160:163], a[132:135], v[116:119], v[160:163]
    buffer_load_dwordx4 v16, s[12:15], s38 offen offset:3072 sc1 lds
    v_mfma_f32_16x16x32_bf16 v[168:171], a[132:135], v[132:135], v[168:171]
    s_mov_b32 m0, s41
    v_exp_f32 v6, v194
    v_mfma_f32_16x16x32_bf16 v[160:163], a[136:139], v[120:123], v[160:163]
    v_exp_f32 v7, v195
    v_mfma_f32_16x16x32_bf16 v[168:171], a[136:139], v[136:139], v[168:171]
    v_exp_f32 v8, v196
    v_mfma_f32_16x16x32_bf16 v[160:163], a[140:143], v[124:127], v[160:163]
    v_exp_f32 v9, v197
    v_mfma_f32_16x16x32_bf16 v[168:171], a[140:143], v[140:143], v[168:171]
    s_waitcnt lgkmcnt(9)
    v_exp_f32 v10, v198
    v_mfma_f32_16x16x32_bf16 v[164:167], a[144:147], v[112:115], v[72:75]
    v_exp_f32 v11, v199
    v_mfma_f32_16x16x32_bf16 v[172:175], a[144:147], v[128:131], v[76:79]
    buffer_load_dwordx4 v16, s[12:15], s43 offen offset:0 sc1 lds
    v_mfma_f32_16x16x32_bf16 v[164:167], a[148:151], v[116:119], v[164:167]
    v_cvt_pk_bf16_f32 v232, v4, v5
    v_or3_b32 v12, v12, v239, v232
    v_mfma_f32_16x16x32_bf16 v[172:175], a[148:151], v[132:135], v[172:175]
    v_cvt_pk_bf16_f32 v233, v6, v7
    v_cvt_pk_bf16_f32 v234, v8, v9
    v_mfma_f32_16x16x32_bf16 v[164:167], a[152:155], v[120:123], v[164:167]
    v_or3_b32 v12, v12, v233, v234
    v_cvt_pk_bf16_f32 v235, v10, v11
    v_mfma_f32_16x16x32_bf16 v[172:175], a[152:155], v[136:139], v[172:175]
    s_cmp_eq_u32 s35, 1
    v_bitop3_b32 v12, v12, v235, s42 bitop3:0xa8
    v_cmp_ne_u32 vcc, 0, v12
    v_mfma_f32_16x16x32_bf16 v[164:167], a[156:159], v[124:127], v[164:167]
    s_waitcnt lgkmcnt(5)
    ds_read_b128 a[132:135], v2 offset:17408
    ds_read_b128 a[136:139], v2 offset:18432
    v_mfma_f32_16x16x32_bf16 v[172:175], a[156:159], v[140:143], v[172:175]
    s_cbranch_vccnz gated_mix__ssm_conv_h3__compressed_kv_cla__prompt_kernel_b2_r1
gated_mix__ssm_conv_h3__compressed_kv_cla__prompt_kernel_b2_r1_ret:
    ds_read_b128 a[140:143], v2 offset:19456
    ds_read_b128 a[144:147], v2 offset:20480
    v_mfma_f32_16x16x32_bf16 a[64:67], a[160:163], v[232:235], a[64:67]
    s_cbranch_scc1 gated_mix__ssm_conv_h3__compressed_kv_cla__prompt_kernel_b2_m2
gated_mix__ssm_conv_h3__compressed_kv_cla__prompt_kernel_b2_m2_ret:
    ds_read_b128 a[148:151], v2 offset:21504
    ds_read_b128 a[152:155], v2 offset:22528
    v_mfma_f32_16x16x32_bf16 a[96:99], a[160:163], v[236:239], a[96:99]
    buffer_load_dwordx4 v16, s[12:15], s43 offen offset:1024 sc1 lds
    v_mfma_f32_16x16x32_bf16 a[68:71], a[164:167], v[232:235], a[68:71]
    s_add_u32 s38, s38, s44
    v_exp_f32 v4, v168
    v_mfma_f32_16x16x32_bf16 a[100:103], a[164:167], v[236:239], a[100:103]
gated_mix__ssm_conv_h3__compressed_kv_cla__prompt_kernel_pad10:
    s_cbranch_execz gated_mix__ssm_conv_h3__compressed_kv_cla__prompt_kernel_pad18
    s_add_u32 s40, s39, s59
    ds_read_b128 a[156:159], v2 offset:23552
    ds_read_b128 a[160:163], v2 offset:8192
    v_mfma_f32_16x16x32_bf16 a[72:75], a[168:171], v[232:235], a[72:75]
    s_add_u32 s41, s40, s50
    v_exp_f32 v5, v169
    v_mfma_f32_16x16x32_bf16 a[104:107], a[168:171], v[236:239], a[104:107]
    s_mov_b32 s39, s45
    ds_read_b128 a[164:167], v2 offset:9216
    v_cvt_pk_bf16_f32 v220, v4, v5
    v_mfma_f32_16x16x32_bf16 a[76:79], a[172:175], v[232:235], a[76:79]
    s_add_u32 s59, s59, s48
    v_exp_f32 v6, v170
    v_mfma_f32_16x16x32_bf16 a[108:111], a[172:175], v[236:239], a[108:111]
    s_waitcnt lgkmcnt(10)
    v_exp_f32 v7, v171
    v_mfma_f32_16x16x32_bf16 a[80:83], a[176:179], v[232:235], a[80:83]
    buffer_load_dwordx4 v16, s[12:15], s43 offen offset:2048 sc1 lds
    v_mfma_f32_16x16x32_bf16 a[112:115], a[176:179], v[236:239], a[112:115]
    s_add_u32 s45, s45, 32768
    ds_read_b128 a[168:171], v2 offset:10240
    v_cvt_pk_bf16_f32 v221, v6, v7
    v_mfma_f32_16x16x32_bf16 a[84:87], a[180:183], v[232:235], a[84:87]
    s_cmp_eq_u32 s45, 163840
    v_exp_f32 v8, v172
    v_mfma_f32_16x16x32_bf16 a[116:119], a[180:183], v[236:239], a[116:119]
    s_cselect_b32 s45, 0, s45
    v_exp_f32 v9, v173
    v_mfma_f32_16x16x32_bf16 a[88:91], a[184:187], v[232:235], a[88:91]
    s_sub_u32 s35, s35, 1
    v_exp_f32 v10, v174
    v_mfma_f32_16x16x32_bf16 a[120:123], a[184:187], v[236:239], a[120:123]
    s_sub_u32 s58, s58, 1
    ds_read_b128 a[172:175], v2 offset:11264
    v_cvt_pk_bf16_f32 v222, v8, v9
    v_mfma_f32_16x16x32_bf16 a[92:95], a[188:191], v[232:235], a[92:95]
    s_cmp_lg_u32 s58, 0
    v_exp_f32 v11, v175
    v_mfma_f32_16x16x32_bf16 a[124:127], a[188:191], v[236:239], a[124:127]
    v_or3_b32 v12, v220, v221, v222
    v_cvt_pk_bf16_f32 v223, v10, v11
    v_mfma_f32_16x16x32_bf16 v[248:251], v[24:27], v[232:235], v[248:251]
    buffer_load_dwordx4 v16, s[12:15], s43 offen offset:3072 sc1 lds
    v_mfma_f32_16x16x32_bf16 v[252:255], v[24:27], v[236:239], v[252:255]
    s_waitcnt lgkmcnt(8)
    v_mov_b32 v3, v2
    v_add_u32 v2, s45, v16
    s_cbranch_scc1 gated_mix__ssm_conv_h3__compressed_kv_cla__prompt_kernel_b2_loop
    s_cmp_lg_u32 s35, 0
    s_cbranch_scc1 gated_mix__ssm_conv_h3__compressed_kv_cla__prompt_kernel_b2_sw
    s_waitcnt vmcnt(8)
    v_mov_b32 v0, 0
    v_mov_b32 v1, 1
    buffer_store_dword v1, v0, s[28:31], s55 offen sc1
    s_nop 4
    v_accvgpr_read_b32 v36, a64
    v_accvgpr_read_b32 v37, a65
    v_accvgpr_read_b32 v38, a66
    v_accvgpr_read_b32 v39, a67
    v_accvgpr_read_b32 v40, a68
    v_accvgpr_read_b32 v41, a69
    v_accvgpr_read_b32 v42, a70
    v_accvgpr_read_b32 v43, a71
    v_rcp_f32 v32, v248
    s_nop 0
    v_pk_mul_f32 v[36:37], v[36:37], v[32:33] op_sel_hi:[1,0]
    v_pk_mul_f32 v[38:39], v[38:39], v[32:33] op_sel_hi:[1,0]
    v_pk_mul_f32 v[40:41], v[40:41], v[32:33] op_sel_hi:[1,0]
    v_pk_mul_f32 v[42:43], v[42:43], v[32:33] op_sel_hi:[1,0]
    v_cvt_pk_bf16_f32 v44, v36, v37
    v_cvt_pk_bf16_f32 v45, v38, v39
    v_cvt_pk_bf16_f32 v46, v40, v41
    v_cvt_pk_bf16_f32 v47, v42, v43
    buffer_store_dwordx4 v[44:47], v16, s[16:19], s62 offen offset:0 sc1
    v_accvgpr_read_b32 v36, a72
    v_accvgpr_read_b32 v37, a73
    v_accvgpr_read_b32 v38, a74
    v_accvgpr_read_b32 v39, a75
    v_accvgpr_read_b32 v40, a76
    v_accvgpr_read_b32 v41, a77
    v_accvgpr_read_b32 v42, a78
    v_accvgpr_read_b32 v43, a79
    v_pk_mul_f32 v[36:37], v[36:37], v[32:33] op_sel_hi:[1,0]
    v_pk_mul_f32 v[38:39], v[38:39], v[32:33] op_sel_hi:[1,0]
    v_pk_mul_f32 v[40:41], v[40:41], v[32:33] op_sel_hi:[1,0]
    v_pk_mul_f32 v[42:43], v[42:43], v[32:33] op_sel_hi:[1,0]
    v_cvt_pk_bf16_f32 v20, v36, v37
    v_cvt_pk_bf16_f32 v21, v38, v39
    v_cvt_pk_bf16_f32 v22, v40, v41
    v_cvt_pk_bf16_f32 v23, v42, v43
    buffer_store_dwordx4 v[20:23], v16, s[16:19], s62 offen offset:1024 sc1
    v_accvgpr_read_b32 v36, a80
    v_accvgpr_read_b32 v37, a81
    v_accvgpr_read_b32 v38, a82
    v_accvgpr_read_b32 v39, a83
    v_accvgpr_read_b32 v40, a84
    v_accvgpr_read_b32 v41, a85
    v_accvgpr_read_b32 v42, a86
    v_accvgpr_read_b32 v43, a87
    v_pk_mul_f32 v[36:37], v[36:37], v[32:33] op_sel_hi:[1,0]
    v_pk_mul_f32 v[38:39], v[38:39], v[32:33] op_sel_hi:[1,0]
    v_pk_mul_f32 v[40:41], v[40:41], v[32:33] op_sel_hi:[1,0]
    v_pk_mul_f32 v[42:43], v[42:43], v[32:33] op_sel_hi:[1,0]
    v_cvt_pk_bf16_f32 v44, v36, v37
    v_cvt_pk_bf16_f32 v45, v38, v39
    v_cvt_pk_bf16_f32 v46, v40, v41
    v_cvt_pk_bf16_f32 v47, v42, v43
    buffer_store_dwordx4 v[44:47], v16, s[16:19], s62 offen offset:2048 sc1
    v_accvgpr_read_b32 v36, a88
    v_accvgpr_read_b32 v37, a89
    v_accvgpr_read_b32 v38, a90
    v_accvgpr_read_b32 v39, a91
    v_accvgpr_read_b32 v40, a92
    v_accvgpr_read_b32 v41, a93
    v_accvgpr_read_b32 v42, a94
    v_accvgpr_read_b32 v43, a95
    v_pk_mul_f32 v[36:37], v[36:37], v[32:33] op_sel_hi:[1,0]
    v_pk_mul_f32 v[38:39], v[38:39], v[32:33] op_sel_hi:[1,0]
    v_pk_mul_f32 v[40:41], v[40:41], v[32:33] op_sel_hi:[1,0]
    v_pk_mul_f32 v[42:43], v[42:43], v[32:33] op_sel_hi:[1,0]
    v_cvt_pk_bf16_f32 v20, v36, v37
    v_cvt_pk_bf16_f32 v21, v38, v39
    v_cvt_pk_bf16_f32 v22, v40, v41
    v_cvt_pk_bf16_f32 v23, v42, v43
    buffer_store_dwordx4 v[20:23], v16, s[16:19], s62 offen offset:3072 sc1
    s_mov_b32 m0, s40
    s_add_u32 s43, s38, s49
    s_barrier
    v_bitop3_b32 v12, v12, v223, s42 bitop3:0xa8
    v_cmp_ne_u32 vcc, 0, v12
    v_mfma_f32_16x16x32_bf16 v[200:203], a[128:131], v[128:131], v[76:79]
    v_mfma_f32_16x16x32_bf16 v[200:203], a[132:135], v[132:135], v[200:203]
    buffer_load_dwordx4 v16, s[12:15], s38 offen offset:0 sc1 lds
    v_mfma_f32_16x16x32_bf16 v[200:203], a[136:139], v[136:139], v[200:203]
    v_mfma_f32_16x16x32_bf16 v[200:203], a[140:143], v[140:143], v[200:203]
    s_waitcnt lgkmcnt(4)
    buffer_load_dwordx4 v16, s[12:15], s38 offen offset:1024 sc1 lds
    v_mfma_f32_16x16x32_bf16 v[204:207], a[144:147], v[128:131], v[76:79]
    ds_read_b128 a[176:179], v3 offset:12288
    v_mfma_f32_16x16x32_bf16 v[204:207], a[148:151], v[132:135], v[204:207]
    ds_read_b128 a[180:183], v3 offset:13312
    buffer_load_dwordx4 v16, s[12:15], s38 offen offset:2048 sc1 lds
    v_mfma_f32_16x16x32_bf16 v[204:207], a[152:155], v[136:139], v[204:207]
    ds_read_b128 a[184:187], v3 offset:14336
    v_mfma_f32_16x16x32_bf16 v[204:207], a[156:159], v[140:143], v[204:207]
    s_waitcnt lgkmcnt(3)
    ds_read_b128 a[188:191], v3 offset:15360
    buffer_load_dwordx4 v16, s[12:15], s38 offen offset:3072 sc1 lds
    s_mov_b32 m0, s41
    s_cbranch_vccnz gated_mix__ssm_conv_h3__compressed_kv_cla__prompt_kernel_b1_r0
gated_mix__ssm_conv_h3__compressed_kv_cla__prompt_kernel_b1_r0_ret:
    ds_read_b128 a[128:131], v3 offset:24576
    ds_read_b128 a[132:135], v3 offset:25600
    ds_read_b128 a[136:139], v3 offset:26624
    ds_read_b128 a[140:143], v3 offset:27648
    ds_read_b128 a[144:147], v3 offset:28672
    ds_read_b128 a[148:151], v3 offset:29696
    ds_read_b128 a[152:155], v3 offset:30720
    ds_read_b128 a[156:159], v3 offset:31744
    v_mfma_f32_16x16x32_bf16 a[96:99], a[160:163], v[220:223], a[96:99]
    buffer_load_dwordx4 v16, s[12:15], s43 offen offset:0 sc1 lds
    v_mfma_f32_16x16x32_bf16 a[100:103], a[164:167], v[220:223], a[100:103]
    buffer_load_dwordx4 v16, s[12:15], s43 offen offset:1024 sc1 lds
    v_mfma_f32_16x16x32_bf16 a[104:107], a[168:171], v[220:223], a[104:107]
    buffer_load_dwordx4 v16, s[12:15], s43 offen offset:2048 sc1 lds
    v_mfma_f32_16x16x32_bf16 a[108:111], a[172:175], v[220:223], a[108:111]
    s_waitcnt lgkmcnt(8)
    buffer_load_dwordx4 v16, s[12:15], s43 offen offset:3072 sc1 lds
    v_mfma_f32_16x16x32_bf16 a[112:115], a[176:179], v[220:223], a[112:115]
    v_add_f32 v200, v56, v200
    v_add_f32 v201, v57, v201
    v_add_f32 v202, v58, v202
    v_add_f32 v203, v59, v203
    v_add_f32 v204, v60, v204
    v_add_f32 v205, v61, v205
    v_add_f32 v206, v62, v206
    v_add_f32 v207, v63, v207
    v_mfma_f32_16x16x32_bf16 a[116:119], a[180:183], v[220:223], a[116:119]
    v_exp_f32 v4, v200
    v_exp_f32 v5, v201
    s_nop 0
    v_cvt_pk_bf16_f32 v236, v4, v5
    v_mfma_f32_16x16x32_bf16 a[120:123], a[184:187], v[220:223], a[120:123]
    v_exp_f32 v6, v202
    v_exp_f32 v7, v203
    s_nop 0
    v_cvt_pk_bf16_f32 v237, v6, v7
    v_mfma_f32_16x16x32_bf16 a[124:127], a[188:191], v[220:223], a[124:127]
    v_exp_f32 v8, v204
    v_exp_f32 v9, v205
    s_nop 0
    v_cvt_pk_bf16_f32 v238, v8, v9
    v_mfma_f32_16x16x32_bf16 v[252:255], v[24:27], v[220:223], v[252:255]
    s_waitcnt lgkmcnt(4)
    v_or3_b32 v12, v236, v237, v238
    v_exp_f32 v10, v206
    v_exp_f32 v11, v207
    s_nop 0
    v_cvt_pk_bf16_f32 v239, v10, v11
    v_bitop3_b32 v12, v12, v239, s42 bitop3:0xa8
    v_cmp_ne_u32 vcc, 0, v12
    s_cbranch_vccnz gated_mix__ssm_conv_h3__compressed_kv_cla__prompt_kernel_b1_r1
gated_mix__ssm_conv_h3__compressed_kv_cla__prompt_kernel_b1_r1_ret:
    v_mfma_f32_16x16x32_bf16 a[96:99], a[128:131], v[236:239], a[96:99]
    v_mfma_f32_16x16x32_bf16 a[100:103], a[132:135], v[236:239], a[100:103]
    v_mfma_f32_16x16x32_bf16 a[104:107], a[136:139], v[236:239], a[104:107]
    v_mfma_f32_16x16x32_bf16 a[108:111], a[140:143], v[236:239], a[108:111]
    s_waitcnt lgkmcnt(0)
    v_mfma_f32_16x16x32_bf16 a[112:115], a[144:147], v[236:239], a[112:115]
    v_mfma_f32_16x16x32_bf16 a[116:119], a[148:151], v[236:239], a[116:119]
    v_mfma_f32_16x16x32_bf16 a[120:123], a[152:155], v[236:239], a[120:123]
    v_mfma_f32_16x16x32_bf16 a[124:127], a[156:159], v[236:239], a[124:127]
    v_mfma_f32_16x16x32_bf16 v[252:255], v[24:27], v[236:239], v[252:255]
    s_mov_b32 s20, s74
    s_mov_b32 s21, s75
    s_mov_b32 s22, 2048
    s_lshl_b32 s36, s2, 2
    s_add_u32 s36, s36, s32
    s_mul_i32 s43, s32, 27040
    s_lshl_b32 s44, s36, 12
    s_lshl_b32 s47, s36, 1
    s_mul_i32 s59, s32, 2304
    v_mov_b32 v8, 0
    v_mov_b32 v9, 1
    buffer_load_dwordx2 v[10:11], v8, s[4:7], s44 offen
    buffer_load_ushort v12, v8, s[20:23], s47 offen
    s_nop 4
    v_accvgpr_read_b32 v36, a96
    v_accvgpr_read_b32 v37, a97
    v_accvgpr_read_b32 v38, a98
    v_accvgpr_read_b32 v39, a99
    v_accvgpr_read_b32 v40, a100
    v_accvgpr_read_b32 v41, a101
    v_accvgpr_read_b32 v42, a102
    v_accvgpr_read_b32 v43, a103
    v_rcp_f32 v32, v252
    s_nop 0
    v_pk_mul_f32 v[36:37], v[36:37], v[32:33] op_sel_hi:[1,0]
    v_pk_mul_f32 v[38:39], v[38:39], v[32:33] op_sel_hi:[1,0]
    v_pk_mul_f32 v[40:41], v[40:41], v[32:33] op_sel_hi:[1,0]
    v_pk_mul_f32 v[42:43], v[42:43], v[32:33] op_sel_hi:[1,0]
    v_cvt_pk_bf16_f32 v44, v36, v37
    v_cvt_pk_bf16_f32 v45, v38, v39
    v_cvt_pk_bf16_f32 v46, v40, v41
    v_cvt_pk_bf16_f32 v47, v42, v43
    buffer_store_dwordx4 v[44:47], v16, s[16:19], s63 offen offset:0 sc1
    v_accvgpr_read_b32 v36, a104
    v_accvgpr_read_b32 v37, a105
    v_accvgpr_read_b32 v38, a106
    v_accvgpr_read_b32 v39, a107
    v_accvgpr_read_b32 v40, a108
    v_accvgpr_read_b32 v41, a109
    v_accvgpr_read_b32 v42, a110
    v_accvgpr_read_b32 v43, a111
    v_pk_mul_f32 v[36:37], v[36:37], v[32:33] op_sel_hi:[1,0]
    v_pk_mul_f32 v[38:39], v[38:39], v[32:33] op_sel_hi:[1,0]
    v_pk_mul_f32 v[40:41], v[40:41], v[32:33] op_sel_hi:[1,0]
    v_pk_mul_f32 v[42:43], v[42:43], v[32:33] op_sel_hi:[1,0]
    v_cvt_pk_bf16_f32 v20, v36, v37
    v_cvt_pk_bf16_f32 v21, v38, v39
    v_cvt_pk_bf16_f32 v22, v40, v41
    v_cvt_pk_bf16_f32 v23, v42, v43
    buffer_store_dwordx4 v[20:23], v16, s[16:19], s63 offen offset:1024 sc1
    v_accvgpr_read_b32 v36, a112
    v_accvgpr_read_b32 v37, a113
    v_accvgpr_read_b32 v38, a114
    v_accvgpr_read_b32 v39, a115
    v_accvgpr_read_b32 v40, a116
    v_accvgpr_read_b32 v41, a117
    v_accvgpr_read_b32 v42, a118
    v_accvgpr_read_b32 v43, a119
    v_pk_mul_f32 v[36:37], v[36:37], v[32:33] op_sel_hi:[1,0]
    v_pk_mul_f32 v[38:39], v[38:39], v[32:33] op_sel_hi:[1,0]
    v_pk_mul_f32 v[40:41], v[40:41], v[32:33] op_sel_hi:[1,0]
    v_pk_mul_f32 v[42:43], v[42:43], v[32:33] op_sel_hi:[1,0]
    v_cvt_pk_bf16_f32 v44, v36, v37
    v_cvt_pk_bf16_f32 v45, v38, v39
    v_cvt_pk_bf16_f32 v46, v40, v41
    v_cvt_pk_bf16_f32 v47, v42, v43
    buffer_store_dwordx4 v[44:47], v16, s[16:19], s63 offen offset:2048 sc1
    v_accvgpr_read_b32 v36, a120
    v_accvgpr_read_b32 v37, a121
    v_accvgpr_read_b32 v38, a122
    v_accvgpr_read_b32 v39, a123
    v_accvgpr_read_b32 v40, a124
    v_accvgpr_read_b32 v41, a125
    v_accvgpr_read_b32 v42, a126
    v_accvgpr_read_b32 v43, a127
    v_pk_mul_f32 v[36:37], v[36:37], v[32:33] op_sel_hi:[1,0]
    v_pk_mul_f32 v[38:39], v[38:39], v[32:33] op_sel_hi:[1,0]
    v_pk_mul_f32 v[40:41], v[40:41], v[32:33] op_sel_hi:[1,0]
    v_pk_mul_f32 v[42:43], v[42:43], v[32:33] op_sel_hi:[1,0]
    v_cvt_pk_bf16_f32 v20, v36, v37
    v_cvt_pk_bf16_f32 v21, v38, v39
    v_cvt_pk_bf16_f32 v22, v40, v41
    v_cvt_pk_bf16_f32 v23, v42, v43
    buffer_store_dwordx4 v[20:23], v16, s[16:19], s63 offen offset:3072 sc1
    v_lshrrev_b32 v232, 4, v16
    v_and_b32 v6, 15, v232
    v_lshrrev_b32 v7, 4, v232
    v_and_b32 v233, 1, v6
    v_cmp_eq_u32 vcc, 1, v233
    v_mov_b32 v234, 4240
    v_lshlrev_b32 v235, 4, v7
    v_cndmask_b32 v234, v234, 8, vcc
    v_lshl_add_u32 v234, v6, 3, v234
    v_add3_u32 v3, v234, v235, s43
    v_and_b32 v236, 3, v6
    v_mul_u32_u24 v236, 4640, v236
    v_lshrrev_b32 v234, 2, v6
    v_lshlrev_b32 v234, 7, v234
    v_sub_u32 v236, v236, v234
    v_add3_u32 v4, v236, v235, s43
    v_add_u32 v4, 8864, v4
    v_mov_b32 v20, 0
    v_mov_b32 v21, 0
    v_mov_b32 v22, 0
    v_mov_b32 v23, 0
    v_and_b32 v234, 7, v232
    v_lshlrev_b32 v234, 4, v234
    v_bfe_u32 v235, v232, 3, 1
    v_mul_u32_u24 v235, 4240, v235
    v_add3_u32 v234, v234, v235, s43
    ds_write_b128 v234, v[20:23]
    v_min_u32 v235, 368, v16
    v_add_u32 v235, s43, v235
    ds_write_b128 v235, v[20:23] offset:12576
    ds_write_b128 v235, v[20:23] offset:17216
    ds_write_b128 v235, v[20:23] offset:21856
    ds_write_b128 v235, v[20:23] offset:26496
    v_lshlrev_b32 v236, 2, v6
    v_sub_u32 v236, 60, v236
    v_lshrrev_b32 v236, 3, v236
    v_sub_u32 v236, v236, v7
    v_lshl_add_u32 v236, v233, 4, v236
    s_waitcnt vmcnt(4)
    v_mov_b32 v234, s43
    ds_write_b64 v234, v[10:11] offset:4360
    v_cmp_eq_u32 vcc, 16, v236
    v_mov_b32 v25, 0
    s_nop 0
    v_cndmask_b32 v24, 0, v12, vcc
    v_cmp_eq_u32 vcc, 0, v236
    v_mov_b32 v27, 0
    s_nop 0
    v_cndmask_b32 v26, 0, v12, vcc
    v_cmp_eq_u32 vcc, 20, v236
    v_mov_b32 v29, 0
    s_nop 0
    v_cndmask_b32 v28, 0, v12, vcc
    v_cmp_eq_u32 vcc, 4, v236
    v_mov_b32 v31, 0
    s_nop 0
    v_cndmask_b32 v30, 0, v12, vcc
    s_waitcnt vmcnt(6) lgkmcnt(0)
    s_barrier
    ds_read_b128 v[96:99], v4 offset:3584
    ds_read_b128 v[64:67], v3 offset:0
    ds_read_b128 v[100:103], v4 offset:3072
    ds_read_b128 v[68:71], v3 offset:512
    ds_read_b128 v[104:107], v4 offset:2560
    ds_read_b128 v[72:75], v3 offset:1024
    ds_read_b128 v[108:111], v4 offset:2048
    ds_read_b128 v[76:79], v3 offset:1536
    ds_read_b128 v[112:115], v4 offset:1536
    ds_read_b128 v[80:83], v3 offset:2048
    ds_read_b128 v[116:119], v4 offset:1024
    ds_read_b128 v[84:87], v3 offset:2560
    ds_read_b128 v[120:123], v4 offset:512
    ds_read_b128 v[88:91], v3 offset:3072
    ds_read_b128 v[124:127], v4 offset:0
    ds_read_b128 v[92:95], v3 offset:3584
    s_waitcnt lgkmcnt(0)
    v_mfma_f32_16x16x32_bf16 v[32:35], v[24:27], v[96:99], 0
    s_and_b32 s45, s2, 3
    s_bfe_u32 s38, s2, 0x20003
    v_mfma_f32_16x16x32_bf16 v[36:39], v[24:27], v[100:103], 0
    s_and_b32 s36, s2, 4
    s_add_u32 s38, s38, s36
    v_mfma_f32_16x16x32_bf16 v[40:43], v[24:27], v[104:107], 0
    ds_read_b128 v[160:163], v4 offset:3648
    s_lshr_b32 s39, s2, 5
    s_xor_b32 s37, s45, 3
    v_mfma_f32_16x16x32_bf16 v[44:47], v[24:27], v[108:111], 0
    s_lshl_b32 s37, s37, 2
    v_lshlrev_b32 v233, 1, v7
    v_xor_b32 v233, v233, v6
    v_mfma_f32_16x16x32_bf16 v[48:51], v[24:27], v[112:115], 0
    ds_read_b128 v[128:131], v3 offset:64
    v_xor_b32 v233, s37, v233
    v_mfma_f32_16x16x32_bf16 v[52:55], v[24:27], v[116:119], 0
    v_lshlrev_b32 v233, 4, v233
    v_lshl_add_u32 v0, v7, 11, v233
    v_mfma_f32_16x16x32_bf16 v[56:59], v[24:27], v[120:123], 0
    ds_read_b128 v[164:167], v4 offset:3136
    v_add_u32 v1, 7040, v0
    s_lshl_b32 s40, s45, 21
    s_lshl_b32 s37, s32, 14
    v_mfma_f32_16x16x32_bf16 v[60:63], v[24:27], v[124:127], 0
    s_add_u32 s40, s40, s37
    s_lshl_b32 s37, s39, 8
    v_mfma_f32_16x16x32_bf16 v[32:35], v[64:67], v[96:99], v[32:35]
    ds_read_b128 v[132:135], v3 offset:576
    s_add_u32 s40, s40, s37
    v_mfma_f32_16x16x32_bf16 v[36:39], v[64:67], v[100:103], v[36:39]
    s_lshl_b32 s52, s38, 2
    s_add_u32 s52, s52, s32
    v_mfma_f32_16x16x32_bf16 v[40:43], v[64:67], v[104:107], v[40:43]
    ds_read_b128 v[168:171], v4 offset:2624
    s_lshl_b32 s52, s52, 7
    s_lshl_b32 s37, s45, 5
    v_mfma_f32_16x16x32_bf16 v[44:47], v[64:67], v[108:111], v[44:47]
    s_add_u32 s52, s52, s37
    v_and_b32 v13, 7, v6
    v_lshlrev_b32 v13, 2, v13
    v_mfma_f32_16x16x32_bf16 v[48:51], v[64:67], v[112:115], v[48:51]
    s_add_u32 m0, s59, 108544
    ds_read_b128 v[136:139], v3 offset:1088
    v_add_u32 v2, 524288, v16
    s_lshl_b32 s41, s38, 3
    s_add_u32 s41, s41, s32
    v_mfma_f32_16x16x32_bf16 v[52:55], v[64:67], v[116:119], v[52:55]
    buffer_load_dwordx4 v0, s[8:11], s40 offen offset:0 lds
    v_mfma_f32_16x16x32_bf16 v[56:59], v[64:67], v[120:123], v[56:59]
    ds_read_b128 v[172:175], v4 offset:2112
    s_lshl_b32 s41, s41, 17
    s_lshl_b32 s37, s45, 15
    v_mfma_f32_16x16x32_bf16 v[60:63], v[64:67], v[124:127], v[60:63]
    s_add_u32 s41, s41, s37
    s_add_u32 s42, s41, 8388608
    v_mfma_f32_16x16x32_bf16 v[36:39], v[68:71], v[96:99], v[36:39]
    ds_read_b128 v[140:143], v3 offset:1600
    v_mfma_f32_16x16x32_bf16 v[40:43], v[68:71], v[100:103], v[40:43]
    buffer_load_dwordx4 v1, s[8:11], s40 offen offset:1152 lds
    v_mfma_f32_16x16x32_bf16 v[44:47], v[68:71], v[104:107], v[44:47]
    ds_read_b128 v[176:179], v4 offset:1600
    v_mfma_f32_16x16x32_bf16 v[48:51], v[68:71], v[108:111], v[48:51]
    v_mfma_f32_16x16x32_bf16 v[52:55], v[68:71], v[112:115], v[52:55]
    s_add_u32 s40, s40, 65536
    ds_read_b128 v[144:147], v3 offset:2112
    v_mfma_f32_16x16x32_bf16 v[56:59], v[68:71], v[116:119], v[56:59]
    buffer_load_dword v14, v13, s[28:31], s52 offen sc1
    v_mfma_f32_16x16x32_bf16 v[60:63], v[68:71], v[120:123], v[60:63]
    ds_read_b128 v[180:183], v4 offset:1088
    v_mfma_f32_16x16x32_bf16 v[40:43], v[72:75], v[96:99], v[40:43]
    v_mfma_f32_16x16x32_bf16 v[44:47], v[72:75], v[100:103], v[44:47]
    s_add_u32 m0, s59, 117760
    ds_read_b128 v[148:151], v3 offset:2624
    v_mfma_f32_16x16x32_bf16 v[48:51], v[72:75], v[104:107], v[48:51]
    buffer_load_dwordx4 v0, s[8:11], s40 offen offset:0 lds
    v_mfma_f32_16x16x32_bf16 v[52:55], v[72:75], v[108:111], v[52:55]
    ds_read_b128 v[184:187], v4 offset:576
    v_mfma_f32_16x16x32_bf16 v[56:59], v[72:75], v[112:115], v[56:59]
    v_mfma_f32_16x16x32_bf16 v[60:63], v[72:75], v[116:119], v[60:63]
    ds_read_b128 v[152:155], v3 offset:3136
    v_mfma_f32_16x16x32_bf16 v[44:47], v[76:79], v[96:99], v[44:47]
    buffer_load_dwordx4 v1, s[8:11], s40 offen offset:1152 lds
    v_mfma_f32_16x16x32_bf16 v[48:51], v[76:79], v[100:103], v[48:51]
    ds_read_b128 v[188:191], v4 offset:64
    v_mfma_f32_16x16x32_bf16 v[52:55], v[76:79], v[104:107], v[52:55]
    v_mfma_f32_16x16x32_bf16 v[56:59], v[76:79], v[108:111], v[56:59]
    s_add_u32 s40, s40, 65536
    s_add_u32 m0, s59, 126976
    ds_read_b128 v[156:159], v3 offset:3648
    v_mfma_f32_16x16x32_bf16 v[60:63], v[76:79], v[112:115], v[60:63]
    buffer_load_dwordx4 v0, s[8:11], s40 offen offset:0 lds
    v_mfma_f32_16x16x32_bf16 v[48:51], v[80:83], v[96:99], v[48:51]
    v_mfma_f32_16x16x32_bf16 v[52:55], v[80:83], v[100:103], v[52:55]
    v_mfma_f32_16x16x32_bf16 v[56:59], v[80:83], v[104:107], v[56:59]
    v_mfma_f32_16x16x32_bf16 v[60:63], v[80:83], v[108:111], v[60:63]
    buffer_load_dwordx4 v1, s[8:11], s40 offen offset:1152 lds
    v_mfma_f32_16x16x32_bf16 v[52:55], v[84:87], v[96:99], v[52:55]
    v_mfma_f32_16x16x32_bf16 v[56:59], v[84:87], v[100:103], v[56:59]
    v_mfma_f32_16x16x32_bf16 v[60:63], v[84:87], v[104:107], v[60:63]
    s_add_u32 s40, s40, 65536
    s_add_u32 m0, s59, 136192
    v_mfma_f32_16x16x32_bf16 v[56:59], v[88:91], v[96:99], v[56:59]
    buffer_load_dwordx4 v0, s[8:11], s40 offen offset:0 lds
    v_mfma_f32_16x16x32_bf16 v[60:63], v[88:91], v[100:103], v[60:63]
    v_mfma_f32_16x16x32_bf16 v[60:63], v[92:95], v[96:99], v[60:63]
    s_waitcnt lgkmcnt(0)
    v_mfma_f32_16x16x32_bf16 v[32:35], v[28:31], v[160:163], v[32:35]
    v_mul_u32_u24 v233, 1152, v7
    v_lshrrev_b32 v234, 2, v6
    v_mfma_f32_16x16x32_bf16 v[36:39], v[28:31], v[164:167], v[36:39]
    buffer_load_dwordx4 v1, s[8:11], s40 offen offset:1152 lds
    v_mfma_f32_16x16x32_bf16 v[40:43], v[28:31], v[168:171], v[40:43]
    ds_read_b128 v[96:99], v4 offset:3712
    v_lshl_add_u32 v233, v234, 8, v233
    v_mfma_f32_16x16x32_bf16 v[44:47], v[28:31], v[172:175], v[44:47]
    v_and_b32 v235, 3, v6
    v_lshl_add_u32 v233, v235, 3, v233
    v_mfma_f32_16x16x32_bf16 v[48:51], v[28:31], v[176:179], v[48:51]
    s_add_u32 s40, s40, 65536
    s_waitcnt vmcnt(9)
    ds_read_b128 v[64:67], v3 offset:128
    v_add_u32 v233, 80896, v233
    v_mfma_f32_16x16x32_bf16 v[52:55], v[28:31], v[180:183], v[52:55]
    buffer_store_dword v9, v8, s[28:31], s56 offen sc1
    v_mfma_f32_16x16x32_bf16 v[56:59], v[28:31], v[184:187], v[56:59]
    ds_read_b128 v[100:103], v4 offset:3200
    v_xor_b32 v236, 0, v234
    v_mfma_f32_16x16x32_bf16 v[60:63], v[28:31], v[188:191], v[60:63]
    v_lshl_add_u32 v17, v236, 5, v233
    v_xor_b32 v236, 1, v234
    v_mfma_f32_16x16x32_bf16 v[32:35], v[128:131], v[160:163], v[32:35]
    s_add_u32 m0, s59, 145408
    ds_read_b128 v[68:71], v3 offset:640
    v_lshl_add_u32 v18, v236, 5, v233
    v_mfma_f32_16x16x32_bf16 v[36:39], v[128:131], v[164:167], v[36:39]
    buffer_load_dwordx4 v0, s[8:11], s40 offen offset:0 lds
    v_mfma_f32_16x16x32_bf16 v[40:43], v[128:131], v[168:171], v[40:43]
    ds_read_b128 v[104:107], v4 offset:2688
    v_xor_b32 v236, 2, v234
    v_mfma_f32_16x16x32_bf16 v[44:47], v[128:131], v[172:175], v[44:47]
    v_lshl_add_u32 v19, v236, 5, v233
    v_xor_b32 v236, 3, v234
    v_mfma_f32_16x16x32_bf16 v[48:51], v[128:131], v[176:179], v[48:51]
    ds_read_b128 v[72:75], v3 offset:1152
    v_lshl_add_u32 v20, v236, 5, v233
    v_mfma_f32_16x16x32_bf16 v[52:55], v[128:131], v[180:183], v[52:55]
    buffer_load_dwordx4 v1, s[8:11], s40 offen offset:1152 lds
    v_mfma_f32_16x16x32_bf16 v[56:59], v[128:131], v[184:187], v[56:59]
    ds_read_b128 v[108:111], v4 offset:2176
    v_lshlrev_b32 v236, 3, v7
    v_mfma_f32_16x16x32_bf16 v[60:63], v[128:131], v[188:191], v[60:63]
    v_lshl_add_u32 v5, v6, 5, v236
    v_lshl_add_u32 v21, v6, 13, v236
    v_mfma_f32_16x16x32_bf16 v[36:39], v[132:135], v[160:163], v[36:39]
    s_add_u32 s40, s40, 65536
    s_add_u32 m0, s59, 154624
    ds_read_b128 v[76:79], v3 offset:1664
    v_and_b32 v236, 1, v7
    v_mfma_f32_16x16x32_bf16 v[40:43], v[132:135], v[164:167], v[40:43]
    buffer_load_dwordx4 v0, s[8:11], s40 offen offset:0 lds
    v_mfma_f32_16x16x32_bf16 v[44:47], v[132:135], v[168:171], v[44:47]
    ds_read_b128 v[112:115], v4 offset:1664
    v_mad_u32_u24 v21, v236, 24, v21
    v_mfma_f32_16x16x32_bf16 v[48:51], v[132:135], v[172:175], v[48:51]
    v_mul_u32_u24 v236, 504, v236
    v_add_u32 v5, v5, v236
    v_mfma_f32_16x16x32_bf16 v[52:55], v[132:135], v[176:179], v[52:55]
    ds_read_b128 v[80:83], v3 offset:2176
    v_lshlrev_b32 v10, 11, v7
    v_mfma_f32_16x16x32_bf16 v[56:59], v[132:135], v[180:183], v[56:59]
    buffer_load_dwordx4 v1, s[8:11], s40 offen offset:1152 lds
    v_mfma_f32_16x16x32_bf16 v[60:63], v[132:135], v[184:187], v[60:63]
    ds_read_b128 v[116:119], v4 offset:1152
    v_lshl_add_u32 v10, v6, 4, v10
    v_mfma_f32_16x16x32_bf16 v[40:43], v[136:139], v[160:163], v[40:43]
    v_lshrrev_b32 v236, 2, v232
    v_lshlrev_b32 v236, 9, v236
    v_mfma_f32_16x16x32_bf16 v[44:47], v[136:139], v[164:167], v[44:47]
    s_add_u32 s40, s40, 65536
    ds_read_b128 v[84:87], v3 offset:2688
    v_lshl_add_u32 v236, v235, 3, v236
    s_lshl_b32 s37, s32, 5
    v_mfma_f32_16x16x32_bf16 v[48:51], v[136:139], v[168:171], v[48:51]
    v_add_u32 v22, s37, v236
    v_lshlrev_b32 v23, 4, v6
    s_lshl_b32 s48, s38, 7
    s_add_u32 s48, s48, s32
    v_mfma_f32_16x16x32_bf16 v[52:55], v[136:139], v[172:175], v[52:55]
    ds_read_b128 v[120:123], v4 offset:640
    s_lshl_b32 s50, s48, 2
    s_lshl_b32 s48, s48, 11
    v_mfma_f32_16x16x32_bf16 v[56:59], v[136:139], v[176:179], v[56:59]
    s_lshl_b32 s37, s39, 2
    s_add_u32 s37, s37, s45
    v_mfma_f32_16x16x32_bf16 v[60:63], v[136:139], v[180:183], v[60:63]
    ds_read_b128 v[88:91], v3 offset:3200
    s_lshl_b32 s51, s37, 2
    s_lshl_b32 s37, s37, 6
    v_mfma_f32_16x16x32_bf16 v[44:47], v[140:143], v[160:163], v[44:47]
    s_add_u32 s48, s48, s37
    s_add_u32 s51, s51, s32
    v_mfma_f32_16x16x32_bf16 v[48:51], v[140:143], v[164:167], v[48:51]
    ds_read_b128 v[124:127], v4 offset:128
    s_lshl_b32 s53, s51, 5
    s_add_u32 s53, s53, 262144
    v_mfma_f32_16x16x32_bf16 v[52:55], v[140:143], v[168:171], v[52:55]
    s_lshl_b32 s51, s51, 15
    s_lshl_b32 s37, s38, 8
    v_mfma_f32_16x16x32_bf16 v[56:59], v[140:143], v[172:175], v[56:59]
    ds_read_b128 v[92:95], v3 offset:3712
    s_add_u32 s51, s51, s37
    s_add_u32 s12, s94, 55574528
    s_addc_u32 s13, s95, 0
    v_mfma_f32_16x16x32_bf16 v[60:63], v[140:143], v[176:179], v[60:63]
    s_mov_b32 s14, 4194304
    s_mov_b32 s20, s90
    v_mfma_f32_16x16x32_bf16 v[48:51], v[144:147], v[160:163], v[48:51]
    s_mov_b32 s21, s91
    s_mov_b32 s22, 4194304
    v_mfma_f32_16x16x32_bf16 v[52:55], v[144:147], v[164:167], v[52:55]
    s_add_u32 s4, s94, 59768832
    s_addc_u32 s5, s95, 0
    s_mov_b32 s6, 8192
    v_mfma_f32_16x16x32_bf16 v[56:59], v[144:147], v[168:171], v[56:59]
    s_mov_b32 s24, s64
    s_mov_b32 s25, s65
    v_mfma_f32_16x16x32_bf16 v[60:63], v[144:147], v[172:175], v[60:63]
gated_mix__ssm_conv_h3__compressed_kv_cla__prompt_kernel_pad11:
    s_cbranch_execz gated_mix__ssm_conv_h3__compressed_kv_cla__prompt_kernel_pad19
    s_mov_b32 s26, 4194304
    s_lshl_b32 s46, s44, 2
    v_mfma_f32_16x16x32_bf16 v[52:55], v[148:151], v[160:163], v[52:55]
    v_mfma_f32_16x16x32_bf16 v[56:59], v[148:151], v[164:167], v[56:59]
    v_mfma_f32_16x16x32_bf16 v[60:63], v[148:151], v[168:171], v[60:63]
    s_add_u32 s36, s48, 0
    v_mfma_f32_16x16x32_bf16 v[56:59], v[152:155], v[160:163], v[56:59]
    buffer_load_dwordx4 v[24:27], v21, s[24:27], s36 offen
    v_mfma_f32_16x16x32_bf16 v[60:63], v[152:155], v[164:167], v[60:63]
    v_mfma_f32_16x16x32_bf16 v[60:63], v[156:159], v[160:163], v[60:63]
    s_waitcnt lgkmcnt(0)
    s_waitcnt vmcnt(12)
    v_cmp_ne_u32 vcc, 1, v14
    s_nop 0
    s_cbranch_vccnz gated_mix__ssm_conv_h3__compressed_kv_cla__prompt_kernel_spin_s
gated_mix__ssm_conv_h3__compressed_kv_cla__prompt_kernel_spin_s_ret:
    v_mfma_f32_16x16x32_bf16 v[32:35], v[64:67], v[96:99], v[32:35]
    s_add_u32 s36, s48, 131072
    v_mfma_f32_16x16x32_bf16 v[36:39], v[64:67], v[100:103], v[36:39]
    buffer_load_dwordx4 v[28:31], v21, s[24:27], s36 offen
    v_mfma_f32_16x16x32_bf16 v[40:43], v[64:67], v[104:107], v[40:43]
    ds_read_b128 v[160:163], v4 offset:3776
    v_mfma_f32_16x16x32_bf16 v[44:47], v[64:67], v[108:111], v[44:47]
    v_mfma_f32_16x16x32_bf16 v[48:51], v[64:67], v[112:115], v[48:51]
    s_add_u32 s36, s50, 0
    ds_read_b128 v[128:131], v3 offset:192
    v_mfma_f32_16x16x32_bf16 v[52:55], v[64:67], v[116:119], v[52:55]
    buffer_load_dword v6, v23, s[4:7], s36 offen sc1
    v_mfma_f32_16x16x32_bf16 v[56:59], v[64:67], v[120:123], v[56:59]
    ds_read_b128 v[164:167], v4 offset:3264
    v_mfma_f32_16x16x32_bf16 v[60:63], v[64:67], v[124:127], v[60:63]
    v_mfma_f32_16x16x32_bf16 v[36:39], v[68:71], v[96:99], v[36:39]
    s_add_u32 s36, s50, 256
    ds_read_b128 v[132:135], v3 offset:704
    v_mfma_f32_16x16x32_bf16 v[40:43], v[68:71], v[100:103], v[40:43]
    buffer_load_dword v7, v23, s[4:7], s36 offen sc1
    v_mfma_f32_16x16x32_bf16 v[44:47], v[68:71], v[104:107], v[44:47]
    ds_read_b128 v[168:171], v4 offset:2752
    v_mfma_f32_16x16x32_bf16 v[48:51], v[68:71], v[108:111], v[48:51]
    v_mfma_f32_16x16x32_bf16 v[52:55], v[68:71], v[112:115], v[52:55]
    s_add_u32 s36, s50, 4096
    ds_read_b128 v[136:139], v3 offset:1216
    v_mfma_f32_16x16x32_bf16 v[56:59], v[68:71], v[116:119], v[56:59]
    buffer_load_dword v11, v23, s[4:7], s36 offen sc1
    v_mfma_f32_16x16x32_bf16 v[60:63], v[68:71], v[120:123], v[60:63]
    ds_read_b128 v[172:175], v4 offset:2240
    v_mfma_f32_16x16x32_bf16 v[40:43], v[72:75], v[96:99], v[40:43]
    v_mfma_f32_16x16x32_bf16 v[44:47], v[72:75], v[100:103], v[44:47]
    s_add_u32 s36, s50, 4352
    ds_read_b128 v[140:143], v3 offset:1728
    v_mfma_f32_16x16x32_bf16 v[48:51], v[72:75], v[104:107], v[48:51]
    buffer_load_dword v12, v23, s[4:7], s36 offen sc1
    v_mfma_f32_16x16x32_bf16 v[52:55], v[72:75], v[108:111], v[52:55]
    ds_read_b128 v[176:179], v4 offset:1728
    v_mfma_f32_16x16x32_bf16 v[56:59], v[72:75], v[112:115], v[56:59]
    v_mfma_f32_16x16x32_bf16 v[60:63], v[72:75], v[116:119], v[60:63]
    ds_read_b128 v[144:147], v3 offset:2240
    v_mfma_f32_16x16x32_bf16 v[44:47], v[76:79], v[96:99], v[44:47]
    buffer_load_dwordx4 a[0:3], v16, s[16:19], s41 offen offset:0 sc1
    v_mfma_f32_16x16x32_bf16 v[48:51], v[76:79], v[100:103], v[48:51]
    ds_read_b128 v[180:183], v4 offset:1216
    v_mfma_f32_16x16x32_bf16 v[52:55], v[76:79], v[104:107], v[52:55]
    v_mfma_f32_16x16x32_bf16 v[56:59], v[76:79], v[108:111], v[56:59]
    ds_read_b128 v[148:151], v3 offset:2752
    v_mfma_f32_16x16x32_bf16 v[60:63], v[76:79], v[112:115], v[60:63]
    buffer_load_dwordx4 a[4:7], v2, s[16:19], s41 offen offset:0 sc1
    v_mfma_f32_16x16x32_bf16 v[48:51], v[80:83], v[96:99], v[48:51]
    ds_read_b128 v[184:187], v4 offset:704
    v_mfma_f32_16x16x32_bf16 v[52:55], v[80:83], v[100:103], v[52:55]
    v_mfma_f32_16x16x32_bf16 v[56:59], v[80:83], v[104:107], v[56:59]
    ds_read_b128 v[152:155], v3 offset:3264
    v_mfma_f32_16x16x32_bf16 v[60:63], v[80:83], v[108:111], v[60:63]
    buffer_load_dwordx4 a[8:11], v16, s[16:19], s41 offen offset:1024 sc1
    v_mfma_f32_16x16x32_bf16 v[52:55], v[84:87], v[96:99], v[52:55]
    ds_read_b128 v[188:191], v4 offset:192
    v_mfma_f32_16x16x32_bf16 v[56:59], v[84:87], v[100:103], v[56:59]
    v_mfma_f32_16x16x32_bf16 v[60:63], v[84:87], v[104:107], v[60:63]
    ds_read_b128 v[156:159], v3 offset:3776
    v_mfma_f32_16x16x32_bf16 v[56:59], v[88:91], v[96:99], v[56:59]
    buffer_load_dwordx4 a[12:15], v2, s[16:19], s41 offen offset:1024 sc1
    v_mfma_f32_16x16x32_bf16 v[60:63], v[88:91], v[100:103], v[60:63]
    v_mfma_f32_16x16x32_bf16 v[60:63], v[92:95], v[96:99], v[60:63]
    s_waitcnt lgkmcnt(0)
    v_mfma_f32_16x16x32_bf16 v[32:35], v[128:131], v[160:163], v[32:35]
    v_mfma_f32_16x16x32_bf16 v[36:39], v[128:131], v[164:167], v[36:39]
    buffer_load_dwordx4 a[16:19], v16, s[16:19], s41 offen offset:2048 sc1
    v_mfma_f32_16x16x32_bf16 v[40:43], v[128:131], v[168:171], v[40:43]
    ds_read_b128 v[96:99], v4 offset:3840
    v_mfma_f32_16x16x32_bf16 v[44:47], v[128:131], v[172:175], v[44:47]
    v_mfma_f32_16x16x32_bf16 v[48:51], v[128:131], v[176:179], v[48:51]
    ds_read_b128 v[64:67], v3 offset:256
    v_mfma_f32_16x16x32_bf16 v[52:55], v[128:131], v[180:183], v[52:55]
    buffer_load_dwordx4 a[20:23], v2, s[16:19], s41 offen offset:2048 sc1
    v_mfma_f32_16x16x32_bf16 v[56:59], v[128:131], v[184:187], v[56:59]
    ds_read_b128 v[100:103], v4 offset:3328
    v_mfma_f32_16x16x32_bf16 v[60:63], v[128:131], v[188:191], v[60:63]
    v_mfma_f32_16x16x32_bf16 v[36:39], v[132:135], v[160:163], v[36:39]
    ds_read_b128 v[68:71], v3 offset:768
    v_mfma_f32_16x16x32_bf16 v[40:43], v[132:135], v[164:167], v[40:43]
    buffer_load_dwordx4 a[24:27], v16, s[16:19], s41 offen offset:3072 sc1
    v_mfma_f32_16x16x32_bf16 v[44:47], v[132:135], v[168:171], v[44:47]
    ds_read_b128 v[104:107], v4 offset:2816
    v_mfma_f32_16x16x32_bf16 v[48:51], v[132:135], v[172:175], v[48:51]
    v_mfma_f32_16x16x32_bf16 v[52:55], v[132:135], v[176:179], v[52:55]
    ds_read_b128 v[72:75], v3 offset:1280
    v_mfma_f32_16x16x32_bf16 v[56:59], v[132:135], v[180:183], v[56:59]
    buffer_load_dwordx4 a[28:31], v2, s[16:19], s41 offen offset:3072 sc1
    v_mfma_f32_16x16x32_bf16 v[60:63], v[132:135], v[184:187], v[60:63]
    ds_read_b128 v[108:111], v4 offset:2304
    v_mfma_f32_16x16x32_bf16 v[40:43], v[136:139], v[160:163], v[40:43]
    v_mfma_f32_16x16x32_bf16 v[44:47], v[136:139], v[164:167], v[44:47]
    s_add_u32 s41, s41, 4096
    ds_read_b128 v[76:79], v3 offset:1792
    v_mfma_f32_16x16x32_bf16 v[48:51], v[136:139], v[168:171], v[48:51]
    buffer_load_dwordx4 a[32:35], v16, s[16:19], s41 offen offset:0 sc1
    v_mfma_f32_16x16x32_bf16 v[52:55], v[136:139], v[172:175], v[52:55]
    ds_read_b128 v[112:115], v4 offset:1792
    v_mfma_f32_16x16x32_bf16 v[56:59], v[136:139], v[176:179], v[56:59]
    v_mfma_f32_16x16x32_bf16 v[60:63], v[136:139], v[180:183], v[60:63]
    ds_read_b128 v[80:83], v3 offset:2304
    v_mfma_f32_16x16x32_bf16 v[44:47], v[140:143], v[160:163], v[44:47]
    buffer_load_dwordx4 a[36:39], v2, s[16:19], s41 offen offset:0 sc1
    v_mfma_f32_16x16x32_bf16 v[48:51], v[140:143], v[164:167], v[48:51]
    ds_read_b128 v[116:119], v4 offset:1280
    v_mfma_f32_16x16x32_bf16 v[52:55], v[140:143], v[168:171], v[52:55]
    v_mfma_f32_16x16x32_bf16 v[56:59], v[140:143], v[172:175], v[56:59]
    ds_read_b128 v[84:87], v3 offset:2816
    v_mfma_f32_16x16x32_bf16 v[60:63], v[140:143], v[176:179], v[60:63]
    buffer_load_dwordx4 a[40:43], v16, s[16:19], s41 offen offset:1024 sc1
    v_mfma_f32_16x16x32_bf16 v[48:51], v[144:147], v[160:163], v[48:51]
    ds_read_b128 v[120:123], v4 offset:768
    v_mfma_f32_16x16x32_bf16 v[52:55], v[144:147], v[164:167], v[52:55]
    v_mfma_f32_16x16x32_bf16 v[56:59], v[144:147], v[168:171], v[56:59]
    ds_read_b128 v[88:91], v3 offset:3328
    v_mfma_f32_16x16x32_bf16 v[60:63], v[144:147], v[172:175], v[60:63]
    buffer_load_dwordx4 a[44:47], v2, s[16:19], s41 offen offset:1024 sc1
    v_mfma_f32_16x16x32_bf16 v[52:55], v[148:151], v[160:163], v[52:55]
    ds_read_b128 v[124:127], v4 offset:256
    v_mfma_f32_16x16x32_bf16 v[56:59], v[148:151], v[164:167], v[56:59]
    v_mfma_f32_16x16x32_bf16 v[60:63], v[148:151], v[168:171], v[60:63]
    ds_read_b128 v[92:95], v3 offset:3840
    v_mfma_f32_16x16x32_bf16 v[56:59], v[152:155], v[160:163], v[56:59]
    buffer_load_dwordx4 a[48:51], v16, s[16:19], s41 offen offset:2048 sc1
    v_mfma_f32_16x16x32_bf16 v[60:63], v[152:155], v[164:167], v[60:63]
    v_mfma_f32_16x16x32_bf16 v[60:63], v[156:159], v[160:163], v[60:63]
    s_waitcnt lgkmcnt(0)
    v_mfma_f32_16x16x32_bf16 v[32:35], v[64:67], v[96:99], v[32:35]
    v_mfma_f32_16x16x32_bf16 v[36:39], v[64:67], v[100:103], v[36:39]
    buffer_load_dwordx4 a[52:55], v2, s[16:19], s41 offen offset:2048 sc1
    v_mfma_f32_16x16x32_bf16 v[40:43], v[64:67], v[104:107], v[40:43]
    ds_read_b128 v[160:163], v4 offset:3904
    v_mfma_f32_16x16x32_bf16 v[44:47], v[64:67], v[108:111], v[44:47]
    v_mfma_f32_16x16x32_bf16 v[48:51], v[64:67], v[112:115], v[48:51]
    s_add_u32 s52, s52, 4096
    ds_read_b128 v[128:131], v3 offset:320
    v_mfma_f32_16x16x32_bf16 v[52:55], v[64:67], v[116:119], v[52:55]
    buffer_load_dword v14, v13, s[28:31], s52 offen sc1
    v_mfma_f32_16x16x32_bf16 v[56:59], v[64:67], v[120:123], v[56:59]
    ds_read_b128 v[164:167], v4 offset:3392
    v_mfma_f32_16x16x32_bf16 v[60:63], v[64:67], v[124:127], v[60:63]
    v_mfma_f32_16x16x32_bf16 v[36:39], v[68:71], v[96:99], v[36:39]
    ds_read_b128 v[132:135], v3 offset:832
    v_mfma_f32_16x16x32_bf16 v[40:43], v[68:71], v[100:103], v[40:43]
    buffer_load_dwordx4 a[56:59], v16, s[16:19], s41 offen offset:3072 sc1
    v_mfma_f32_16x16x32_bf16 v[44:47], v[68:71], v[104:107], v[44:47]
    ds_read_b128 v[168:171], v4 offset:2880
    v_mfma_f32_16x16x32_bf16 v[48:51], v[68:71], v[108:111], v[48:51]
    v_mfma_f32_16x16x32_bf16 v[52:55], v[68:71], v[112:115], v[52:55]
    ds_read_b128 v[136:139], v3 offset:1344
    v_mfma_f32_16x16x32_bf16 v[56:59], v[68:71], v[116:119], v[56:59]
    buffer_load_dwordx4 a[60:63], v2, s[16:19], s41 offen offset:3072 sc1
    v_mfma_f32_16x16x32_bf16 v[60:63], v[68:71], v[120:123], v[60:63]
    ds_read_b128 v[172:175], v4 offset:2368
    v_mfma_f32_16x16x32_bf16 v[40:43], v[72:75], v[96:99], v[40:43]
    v_mfma_f32_16x16x32_bf16 v[44:47], v[72:75], v[100:103], v[44:47]
    s_add_u32 s41, s41, 4096
    ds_read_b128 v[140:143], v3 offset:1856
    v_mfma_f32_16x16x32_bf16 v[48:51], v[72:75], v[104:107], v[48:51]
    buffer_load_dwordx4 a[64:67], v16, s[16:19], s41 offen offset:0 sc1
    v_mfma_f32_16x16x32_bf16 v[52:55], v[72:75], v[108:111], v[52:55]
    ds_read_b128 v[176:179], v4 offset:1856
    v_mfma_f32_16x16x32_bf16 v[56:59], v[72:75], v[112:115], v[56:59]
    v_mfma_f32_16x16x32_bf16 v[60:63], v[72:75], v[116:119], v[60:63]
    ds_read_b128 v[144:147], v3 offset:2368
    v_mfma_f32_16x16x32_bf16 v[44:47], v[76:79], v[96:99], v[44:47]
    buffer_load_dwordx4 a[68:71], v2, s[16:19], s41 offen offset:0 sc1
    v_mfma_f32_16x16x32_bf16 v[48:51], v[76:79], v[100:103], v[48:51]
    ds_read_b128 v[180:183], v4 offset:1344
    v_mfma_f32_16x16x32_bf16 v[52:55], v[76:79], v[104:107], v[52:55]
    v_mfma_f32_16x16x32_bf16 v[56:59], v[76:79], v[108:111], v[56:59]
    ds_read_b128 v[148:151], v3 offset:2880
    v_mfma_f32_16x16x32_bf16 v[60:63], v[76:79], v[112:115], v[60:63]
    buffer_load_dwordx4 a[72:75], v16, s[16:19], s41 offen offset:1024 sc1
    v_mfma_f32_16x16x32_bf16 v[48:51], v[80:83], v[96:99], v[48:51]
    ds_read_b128 v[184:187], v4 offset:832
    v_mfma_f32_16x16x32_bf16 v[52:55], v[80:83], v[100:103], v[52:55]
    v_mfma_f32_16x16x32_bf16 v[56:59], v[80:83], v[104:107], v[56:59]
    ds_read_b128 v[152:155], v3 offset:3392
    v_mfma_f32_16x16x32_bf16 v[60:63], v[80:83], v[108:111], v[60:63]
    buffer_load_dwordx4 a[76:79], v2, s[16:19], s41 offen offset:1024 sc1
    v_mfma_f32_16x16x32_bf16 v[52:55], v[84:87], v[96:99], v[52:55]
    ds_read_b128 v[188:191], v4 offset:320
    v_mfma_f32_16x16x32_bf16 v[56:59], v[84:87], v[100:103], v[56:59]
    v_mfma_f32_16x16x32_bf16 v[60:63], v[84:87], v[104:107], v[60:63]
    ds_read_b128 v[156:159], v3 offset:3904
    v_mfma_f32_16x16x32_bf16 v[56:59], v[88:91], v[96:99], v[56:59]
    buffer_load_dwordx4 a[80:83], v16, s[16:19], s41 offen offset:2048 sc1
    v_mfma_f32_16x16x32_bf16 v[60:63], v[88:91], v[100:103], v[60:63]
    v_mfma_f32_16x16x32_bf16 v[60:63], v[92:95], v[96:99], v[60:63]
    s_waitcnt lgkmcnt(0)
    s_waitcnt vmcnt(7)
    v_cmp_ne_u32 vcc, 1, v14
    s_nop 0
    s_cbranch_vccnz gated_mix__ssm_conv_h3__compressed_kv_cla__prompt_kernel_spin_l
gated_mix__ssm_conv_h3__compressed_kv_cla__prompt_kernel_spin_l_ret:
    v_mfma_f32_16x16x32_bf16 v[32:35], v[128:131], v[160:163], v[32:35]
    v_mfma_f32_16x16x32_bf16 v[36:39], v[128:131], v[164:167], v[36:39]
    buffer_load_dwordx4 a[84:87], v2, s[16:19], s41 offen offset:2048 sc1
    v_mfma_f32_16x16x32_bf16 v[40:43], v[128:131], v[168:171], v[40:43]
    ds_read_b128 v[96:99], v4 offset:3968
    v_mfma_f32_16x16x32_bf16 v[44:47], v[128:131], v[172:175], v[44:47]
    v_mfma_f32_16x16x32_bf16 v[48:51], v[128:131], v[176:179], v[48:51]
    ds_read_b128 v[64:67], v3 offset:384
    v_mfma_f32_16x16x32_bf16 v[52:55], v[128:131], v[180:183], v[52:55]
    buffer_load_dwordx4 a[128:131], v16, s[16:19], s42 offen offset:0 sc1
    v_mfma_f32_16x16x32_bf16 v[56:59], v[128:131], v[184:187], v[56:59]
    ds_read_b128 v[100:103], v4 offset:3456
    v_mfma_f32_16x16x32_bf16 v[60:63], v[128:131], v[188:191], v[60:63]
    v_mfma_f32_16x16x32_bf16 v[36:39], v[132:135], v[160:163], v[36:39]
    ds_read_b128 v[68:71], v3 offset:896
    v_mfma_f32_16x16x32_bf16 v[40:43], v[132:135], v[164:167], v[40:43]
    buffer_load_dwordx4 a[132:135], v2, s[16:19], s42 offen offset:0 sc1
    v_mfma_f32_16x16x32_bf16 v[44:47], v[132:135], v[168:171], v[44:47]
    ds_read_b128 v[104:107], v4 offset:2944
    v_mfma_f32_16x16x32_bf16 v[48:51], v[132:135], v[172:175], v[48:51]
    v_mfma_f32_16x16x32_bf16 v[52:55], v[132:135], v[176:179], v[52:55]
    ds_read_b128 v[72:75], v3 offset:1408
    v_mfma_f32_16x16x32_bf16 v[56:59], v[132:135], v[180:183], v[56:59]
    buffer_load_dwordx4 a[136:139], v16, s[16:19], s42 offen offset:1024 sc1
    v_mfma_f32_16x16x32_bf16 v[60:63], v[132:135], v[184:187], v[60:63]
    ds_read_b128 v[108:111], v4 offset:2432
    v_mfma_f32_16x16x32_bf16 v[40:43], v[136:139], v[160:163], v[40:43]
    v_mfma_f32_16x16x32_bf16 v[44:47], v[136:139], v[164:167], v[44:47]
    ds_read_b128 v[76:79], v3 offset:1920
    v_mfma_f32_16x16x32_bf16 v[48:51], v[136:139], v[168:171], v[48:51]
    buffer_load_dwordx4 a[140:143], v2, s[16:19], s42 offen offset:1024 sc1
    v_mfma_f32_16x16x32_bf16 v[52:55], v[136:139], v[172:175], v[52:55]
    ds_read_b128 v[112:115], v4 offset:1920
    v_mfma_f32_16x16x32_bf16 v[56:59], v[136:139], v[176:179], v[56:59]
    v_mfma_f32_16x16x32_bf16 v[60:63], v[136:139], v[180:183], v[60:63]
    ds_read_b128 v[80:83], v3 offset:2432
    v_mfma_f32_16x16x32_bf16 v[44:47], v[140:143], v[160:163], v[44:47]
    buffer_load_dwordx4 a[144:147], v16, s[16:19], s42 offen offset:2048 sc1
    v_mfma_f32_16x16x32_bf16 v[48:51], v[140:143], v[164:167], v[48:51]
    ds_read_b128 v[116:119], v4 offset:1408
    v_mfma_f32_16x16x32_bf16 v[52:55], v[140:143], v[168:171], v[52:55]
    v_mfma_f32_16x16x32_bf16 v[56:59], v[140:143], v[172:175], v[56:59]
    ds_read_b128 v[84:87], v3 offset:2944
    v_mfma_f32_16x16x32_bf16 v[60:63], v[140:143], v[176:179], v[60:63]
    buffer_load_dwordx4 a[148:151], v2, s[16:19], s42 offen offset:2048 sc1
    v_mfma_f32_16x16x32_bf16 v[48:51], v[144:147], v[160:163], v[48:51]
    ds_read_b128 v[120:123], v4 offset:896
    v_mfma_f32_16x16x32_bf16 v[52:55], v[144:147], v[164:167], v[52:55]
    v_mfma_f32_16x16x32_bf16 v[56:59], v[144:147], v[168:171], v[56:59]
    ds_read_b128 v[88:91], v3 offset:3456
    v_mfma_f32_16x16x32_bf16 v[60:63], v[144:147], v[172:175], v[60:63]
    buffer_load_dwordx4 a[152:155], v16, s[16:19], s42 offen offset:3072 sc1
    v_mfma_f32_16x16x32_bf16 v[52:55], v[148:151], v[160:163], v[52:55]
    ds_read_b128 v[124:127], v4 offset:384
    v_mfma_f32_16x16x32_bf16 v[56:59], v[148:151], v[164:167], v[56:59]
    v_mfma_f32_16x16x32_bf16 v[60:63], v[148:151], v[168:171], v[60:63]
    ds_read_b128 v[92:95], v3 offset:3968
    v_mfma_f32_16x16x32_bf16 v[56:59], v[152:155], v[160:163], v[56:59]
    buffer_load_dwordx4 a[156:159], v2, s[16:19], s42 offen offset:3072 sc1
    v_mfma_f32_16x16x32_bf16 v[60:63], v[152:155], v[164:167], v[60:63]
    v_mfma_f32_16x16x32_bf16 v[60:63], v[156:159], v[160:163], v[60:63]
    s_waitcnt lgkmcnt(0)
    v_mfma_f32_16x16x32_bf16 v[32:35], v[64:67], v[96:99], v[32:35]
    s_add_u32 s42, s42, 4096
    v_mfma_f32_16x16x32_bf16 v[36:39], v[64:67], v[100:103], v[36:39]
    buffer_load_dwordx4 a[160:163], v16, s[16:19], s42 offen offset:0 sc1
    v_mfma_f32_16x16x32_bf16 v[40:43], v[64:67], v[104:107], v[40:43]
    ds_read_b128 v[160:163], v4 offset:4032
    v_mfma_f32_16x16x32_bf16 v[44:47], v[64:67], v[108:111], v[44:47]
    v_mfma_f32_16x16x32_bf16 v[48:51], v[64:67], v[112:115], v[48:51]
    ds_read_b128 v[128:131], v3 offset:448
    v_mfma_f32_16x16x32_bf16 v[52:55], v[64:67], v[116:119], v[52:55]
    buffer_load_dwordx4 a[164:167], v2, s[16:19], s42 offen offset:0 sc1
    v_mfma_f32_16x16x32_bf16 v[56:59], v[64:67], v[120:123], v[56:59]
    ds_read_b128 v[164:167], v4 offset:3520
    v_mfma_f32_16x16x32_bf16 v[60:63], v[64:67], v[124:127], v[60:63]
    v_mfma_f32_16x16x32_bf16 v[36:39], v[68:71], v[96:99], v[36:39]
    ds_read_b128 v[132:135], v3 offset:960
    v_mfma_f32_16x16x32_bf16 v[40:43], v[68:71], v[100:103], v[40:43]
    buffer_load_dwordx4 a[168:171], v16, s[16:19], s42 offen offset:1024 sc1
    v_mfma_f32_16x16x32_bf16 v[44:47], v[68:71], v[104:107], v[44:47]
    ds_read_b128 v[168:171], v4 offset:3008
    v_mfma_f32_16x16x32_bf16 v[48:51], v[68:71], v[108:111], v[48:51]
    v_mfma_f32_16x16x32_bf16 v[52:55], v[68:71], v[112:115], v[52:55]
    ds_read_b128 v[136:139], v3 offset:1472
    v_mfma_f32_16x16x32_bf16 v[56:59], v[68:71], v[116:119], v[56:59]
    buffer_load_dwordx4 a[172:175], v2, s[16:19], s42 offen offset:1024 sc1
    v_mfma_f32_16x16x32_bf16 v[60:63], v[68:71], v[120:123], v[60:63]
    ds_read_b128 v[172:175], v4 offset:2496
    v_mfma_f32_16x16x32_bf16 v[40:43], v[72:75], v[96:99], v[40:43]
    v_mfma_f32_16x16x32_bf16 v[44:47], v[72:75], v[100:103], v[44:47]
    ds_read_b128 v[140:143], v3 offset:1984
    v_mfma_f32_16x16x32_bf16 v[48:51], v[72:75], v[104:107], v[48:51]
    buffer_load_dwordx4 a[176:179], v16, s[16:19], s42 offen offset:2048 sc1
    v_mfma_f32_16x16x32_bf16 v[52:55], v[72:75], v[108:111], v[52:55]
    ds_read_b128 v[176:179], v4 offset:1984
    v_mfma_f32_16x16x32_bf16 v[56:59], v[72:75], v[112:115], v[56:59]
    v_mfma_f32_16x16x32_bf16 v[60:63], v[72:75], v[116:119], v[60:63]
    ds_read_b128 v[144:147], v3 offset:2496
    v_mfma_f32_16x16x32_bf16 v[44:47], v[76:79], v[96:99], v[44:47]
    buffer_load_dwordx4 a[180:183], v2, s[16:19], s42 offen offset:2048 sc1
    v_mfma_f32_16x16x32_bf16 v[48:51], v[76:79], v[100:103], v[48:51]
    ds_read_b128 v[180:183], v4 offset:1472
    v_mfma_f32_16x16x32_bf16 v[52:55], v[76:79], v[104:107], v[52:55]
    v_mfma_f32_16x16x32_bf16 v[56:59], v[76:79], v[108:111], v[56:59]
    ds_read_b128 v[148:151], v3 offset:3008
    v_mfma_f32_16x16x32_bf16 v[60:63], v[76:79], v[112:115], v[60:63]
    buffer_load_dwordx4 a[184:187], v16, s[16:19], s42 offen offset:3072 sc1
    v_mfma_f32_16x16x32_bf16 v[48:51], v[80:83], v[96:99], v[48:51]
    ds_read_b128 v[184:187], v4 offset:960
    v_mfma_f32_16x16x32_bf16 v[52:55], v[80:83], v[100:103], v[52:55]
    v_mfma_f32_16x16x32_bf16 v[56:59], v[80:83], v[104:107], v[56:59]
    ds_read_b128 v[152:155], v3 offset:3520
    v_mfma_f32_16x16x32_bf16 v[60:63], v[80:83], v[108:111], v[60:63]
    buffer_load_dwordx4 a[188:191], v2, s[16:19], s42 offen offset:3072 sc1
    v_mfma_f32_16x16x32_bf16 v[52:55], v[84:87], v[96:99], v[52:55]
    ds_read_b128 v[188:191], v4 offset:448
    v_mfma_f32_16x16x32_bf16 v[56:59], v[84:87], v[100:103], v[56:59]
    v_mfma_f32_16x16x32_bf16 v[60:63], v[84:87], v[104:107], v[60:63]
    s_add_u32 s42, s42, 4096
    ds_read_b128 v[156:159], v3 offset:4032
    v_mfma_f32_16x16x32_bf16 v[56:59], v[88:91], v[96:99], v[56:59]
    buffer_load_dwordx4 a[192:195], v16, s[16:19], s42 offen offset:0 sc1
    v_mfma_f32_16x16x32_bf16 v[60:63], v[88:91], v[100:103], v[60:63]
    v_mfma_f32_16x16x32_bf16 v[60:63], v[92:95], v[96:99], v[60:63]
    s_waitcnt lgkmcnt(0)
    s_waitcnt vmcnt(46)
    s_barrier
    v_mfma_f32_16x16x32_bf16 v[32:35], v[128:131], v[160:163], v[32:35]
    ds_read_b64_tr_b16 v[192:193], v17 offset:27648
    ds_read_b64_tr_b16 v[194:195], v17 offset:32256
    v_mfma_f32_16x16x32_bf16 v[36:39], v[128:131], v[164:167], v[36:39]
    buffer_load_dwordx4 a[196:199], v2, s[16:19], s42 offen offset:0 sc1
    v_mfma_f32_16x16x32_bf16 v[40:43], v[128:131], v[168:171], v[40:43]
    ds_read_b64_tr_b16 v[196:197], v18 offset:27648
    ds_read_b64_tr_b16 v[198:199], v18 offset:32256
    v_mfma_f32_16x16x32_bf16 v[44:47], v[128:131], v[172:175], v[44:47]
    ds_read_b64_tr_b16 v[200:201], v19 offset:27648
    ds_read_b64_tr_b16 v[202:203], v19 offset:32256
    v_mfma_f32_16x16x32_bf16 v[48:51], v[128:131], v[176:179], v[48:51]
    s_add_u32 m0, s59, 16384
    ds_read_b64_tr_b16 v[204:205], v20 offset:27648
    ds_read_b64_tr_b16 v[206:207], v20 offset:32256
    v_mfma_f32_16x16x32_bf16 v[52:55], v[128:131], v[180:183], v[52:55]
    buffer_load_dwordx4 v0, s[8:11], s40 offen offset:0 lds
    v_mfma_f32_16x16x32_bf16 v[56:59], v[128:131], v[184:187], v[56:59]
    ds_read_b64_tr_b16 v[208:209], v17 offset:27776
    ds_read_b64_tr_b16 v[210:211], v17 offset:32384
    v_mfma_f32_16x16x32_bf16 v[60:63], v[128:131], v[188:191], v[60:63]
    ds_read_b64_tr_b16 v[212:213], v18 offset:27776
    ds_read_b64_tr_b16 v[214:215], v18 offset:32384
    v_mfma_f32_16x16x32_bf16 v[36:39], v[132:135], v[160:163], v[36:39]
    ds_read_b64_tr_b16 v[216:217], v19 offset:27776
    ds_read_b64_tr_b16 v[218:219], v19 offset:32384
    v_mfma_f32_16x16x32_bf16 v[40:43], v[132:135], v[164:167], v[40:43]
    buffer_load_dwordx4 v1, s[8:11], s40 offen offset:1152 lds
    v_mfma_f32_16x16x32_bf16 v[44:47], v[132:135], v[168:171], v[44:47]
    ds_read_b64_tr_b16 v[220:221], v20 offset:27776
    ds_read_b64_tr_b16 v[222:223], v20 offset:32384
    v_mfma_f32_16x16x32_bf16 v[48:51], v[132:135], v[172:175], v[48:51]
    v_mfma_f32_16x16x32_bf16 v[52:55], v[132:135], v[176:179], v[52:55]
    s_add_u32 s40, s40, 65536
    s_add_u32 m0, s59, 25600
    v_mfma_f32_16x16x32_bf16 v[56:59], v[132:135], v[180:183], v[56:59]
    buffer_load_dwordx4 v0, s[8:11], s40 offen offset:0 lds
    v_mfma_f32_16x16x32_bf16 v[60:63], v[132:135], v[184:187], v[60:63]
    v_mfma_f32_16x16x32_bf16 v[40:43], v[136:139], v[160:163], v[40:43]
    v_mfma_f32_16x16x32_bf16 v[44:47], v[136:139], v[164:167], v[44:47]
    v_mfma_f32_16x16x32_bf16 v[48:51], v[136:139], v[168:171], v[48:51]
    buffer_load_dwordx4 v1, s[8:11], s40 offen offset:1152 lds
    v_mfma_f32_16x16x32_bf16 v[52:55], v[136:139], v[172:175], v[52:55]
    v_mfma_f32_16x16x32_bf16 v[56:59], v[136:139], v[176:179], v[56:59]
    v_mfma_f32_16x16x32_bf16 v[60:63], v[136:139], v[180:183], v[60:63]
    s_add_u32 s40, s40, 65536
    s_add_u32 m0, s59, 34816
    v_mfma_f32_16x16x32_bf16 v[44:47], v[140:143], v[160:163], v[44:47]
    buffer_load_dwordx4 v0, s[8:11], s40 offen offset:0 lds
    v_mfma_f32_16x16x32_bf16 v[48:51], v[140:143], v[164:167], v[48:51]
    v_mfma_f32_16x16x32_bf16 v[52:55], v[140:143], v[168:171], v[52:55]
    v_mfma_f32_16x16x32_bf16 v[56:59], v[140:143], v[172:175], v[56:59]
    v_mfma_f32_16x16x32_bf16 v[60:63], v[140:143], v[176:179], v[60:63]
    buffer_load_dwordx4 v1, s[8:11], s40 offen offset:1152 lds
    v_mfma_f32_16x16x32_bf16 v[48:51], v[144:147], v[160:163], v[48:51]
    v_mfma_f32_16x16x32_bf16 v[52:55], v[144:147], v[164:167], v[52:55]
    v_mfma_f32_16x16x32_bf16 v[56:59], v[144:147], v[168:171], v[56:59]
    s_add_u32 s40, s40, 65536
    s_add_u32 m0, s59, 44032
    v_mfma_f32_16x16x32_bf16 v[60:63], v[144:147], v[172:175], v[60:63]
    buffer_load_dwordx4 v0, s[8:11], s40 offen offset:0 lds
    v_mfma_f32_16x16x32_bf16 v[52:55], v[148:151], v[160:163], v[52:55]
    v_mfma_f32_16x16x32_bf16 v[56:59], v[148:151], v[164:167], v[56:59]
    v_mfma_f32_16x16x32_bf16 v[60:63], v[148:151], v[168:171], v[60:63]
    v_mfma_f32_16x16x32_bf16 v[56:59], v[152:155], v[160:163], v[56:59]
    buffer_load_dwordx4 v1, s[8:11], s40 offen offset:1152 lds
    v_mfma_f32_16x16x32_bf16 v[60:63], v[152:155], v[164:167], v[60:63]
    v_mfma_f32_16x16x32_bf16 v[60:63], v[156:159], v[160:163], v[60:63]
    s_nop 4
    v_cvt_pk_bf16_f32 v32, v32, v33
    v_cvt_pk_bf16_f32 v33, v34, v35
    v_cvt_pk_bf16_f32 v34, v36, v37
    v_cvt_pk_bf16_f32 v35, v38, v39
    v_cvt_pk_bf16_f32 v40, v40, v41
    v_cvt_pk_bf16_f32 v41, v42, v43
    v_cvt_pk_bf16_f32 v42, v44, v45
    v_cvt_pk_bf16_f32 v43, v46, v47
    v_cvt_pk_bf16_f32 v48, v48, v49
    v_cvt_pk_bf16_f32 v49, v50, v51
    v_cvt_pk_bf16_f32 v50, v52, v53
    v_cvt_pk_bf16_f32 v51, v54, v55
    v_cvt_pk_bf16_f32 v56, v56, v57
    v_cvt_pk_bf16_f32 v57, v58, v59
    v_cvt_pk_bf16_f32 v58, v60, v61
    v_cvt_pk_bf16_f32 v59, v62, v63
    v_permlane16_swap_b32 v32, v34
    v_permlane16_swap_b32 v33, v35
    v_permlane16_swap_b32 v40, v42
    v_permlane16_swap_b32 v41, v43
    v_permlane16_swap_b32 v48, v50
    v_permlane16_swap_b32 v49, v51
    v_permlane16_swap_b32 v56, v58
    v_permlane16_swap_b32 v57, v59
    s_waitcnt vmcnt(24) lgkmcnt(0)
    v_mfma_f32_16x16x32_bf16 v[64:67], v[192:195], a[0:3], 0
    v_mfma_f32_16x16x32_bf16 v[68:71], v[192:195], a[4:7], 0
    v_mfma_f32_16x16x32_bf16 v[72:75], v[192:195], a[128:131], 0
    ds_read_b64_tr_b16 v[224:225], v17 offset:36864
    ds_read_b64_tr_b16 v[226:227], v17 offset:41472
    v_mfma_f32_16x16x32_bf16 v[76:79], v[192:195], a[132:135], 0
    s_add_u32 s40, s40, 65536
    ds_read_b64_tr_b16 v[228:229], v18 offset:36864
    ds_read_b64_tr_b16 v[230:231], v18 offset:41472
    v_mfma_f32_16x16x32_bf16 v[80:83], v[196:199], a[0:3], 0
    buffer_store_dwordx4 v[32:35], v5, s[12:15], s44 offen offset:0 sc1
    v_mfma_f32_16x16x32_bf16 v[84:87], v[196:199], a[4:7], 0
    ds_read_b64_tr_b16 v[232:233], v19 offset:36864
    ds_read_b64_tr_b16 v[234:235], v19 offset:41472
    v_mfma_f32_16x16x32_bf16 v[88:91], v[196:199], a[128:131], 0
    ds_read_b64_tr_b16 v[236:237], v20 offset:36864
    ds_read_b64_tr_b16 v[238:239], v20 offset:41472
    v_mfma_f32_16x16x32_bf16 v[92:95], v[196:199], a[132:135], 0
    v_mfma_f32_16x16x32_bf16 v[96:99], v[200:203], a[0:3], 0
    ds_read_b64_tr_b16 v[240:241], v17 offset:36992
    ds_read_b64_tr_b16 v[242:243], v17 offset:41600
    v_mfma_f32_16x16x32_bf16 v[100:103], v[200:203], a[4:7], 0
    buffer_store_dwordx4 v[40:43], v5, s[12:15], s44 offen offset:1024 sc1
    v_mfma_f32_16x16x32_bf16 v[104:107], v[200:203], a[128:131], 0
    ds_read_b64_tr_b16 v[244:245], v18 offset:36992
    ds_read_b64_tr_b16 v[246:247], v18 offset:41600
    v_mfma_f32_16x16x32_bf16 v[108:111], v[200:203], a[132:135], 0
    ds_read_b64_tr_b16 v[248:249], v19 offset:36992
    ds_read_b64_tr_b16 v[250:251], v19 offset:41600
    v_mfma_f32_16x16x32_bf16 v[112:115], v[204:207], a[0:3], 0
    v_mfma_f32_16x16x32_bf16 v[116:119], v[204:207], a[4:7], 0
    ds_read_b64_tr_b16 v[252:253], v20 offset:36992
    ds_read_b64_tr_b16 v[254:255], v20 offset:41600
    v_mfma_f32_16x16x32_bf16 v[120:123], v[204:207], a[128:131], 0
    buffer_store_dwordx4 v[48:51], v5, s[12:15], s44 offen offset:2048 sc1
    v_mfma_f32_16x16x32_bf16 v[124:127], v[204:207], a[132:135], 0
    v_mfma_f32_16x16x32_bf16 v[128:131], v[208:211], a[0:3], 0
    v_mfma_f32_16x16x32_bf16 v[132:135], v[208:211], a[4:7], 0
    v_mfma_f32_16x16x32_bf16 v[136:139], v[208:211], a[128:131], 0
    buffer_store_dwordx4 v[56:59], v5, s[12:15], s44 offen offset:3072 sc1
    v_mfma_f32_16x16x32_bf16 v[140:143], v[208:211], a[132:135], 0
    v_mfma_f32_16x16x32_bf16 v[144:147], v[212:215], a[0:3], 0
    v_mfma_f32_16x16x32_bf16 v[148:151], v[212:215], a[4:7], 0
    v_mfma_f32_16x16x32_bf16 v[152:155], v[212:215], a[128:131], 0
    buffer_load_dwordx4 a[200:203], v16, s[16:19], s42 offen offset:1024 sc1
    v_mfma_f32_16x16x32_bf16 v[156:159], v[212:215], a[132:135], 0
    v_mfma_f32_16x16x32_bf16 v[160:163], v[216:219], a[0:3], 0
    v_mfma_f32_16x16x32_bf16 v[164:167], v[216:219], a[4:7], 0
    v_mfma_f32_16x16x32_bf16 v[168:171], v[216:219], a[128:131], 0
    buffer_load_dwordx4 a[204:207], v2, s[16:19], s42 offen offset:1024 sc1
    v_mfma_f32_16x16x32_bf16 v[172:175], v[216:219], a[132:135], 0
    v_mfma_f32_16x16x32_bf16 v[176:179], v[220:223], a[0:3], 0
    v_mfma_f32_16x16x32_bf16 v[180:183], v[220:223], a[4:7], 0
    s_add_u32 m0, s59, 53248
    v_mfma_f32_16x16x32_bf16 v[184:187], v[220:223], a[128:131], 0
    buffer_load_dwordx4 v0, s[8:11], s40 offen offset:0 lds
    v_mfma_f32_16x16x32_bf16 v[188:191], v[220:223], a[132:135], 0
    buffer_load_dwordx4 v1, s[8:11], s40 offen offset:1152 lds
    s_waitcnt vmcnt(28) lgkmcnt(0)
    s_barrier
    v_mfma_f32_16x16x32_bf16 v[64:67], v[224:227], a[8:11], v[64:67]
    v_mfma_f32_16x16x32_bf16 v[68:71], v[224:227], a[12:15], v[68:71]
    v_mfma_f32_16x16x32_bf16 v[72:75], v[224:227], a[136:139], v[72:75]
    ds_read_b64_tr_b16 v[192:193], v17 offset:46080
    ds_read_b64_tr_b16 v[194:195], v17 offset:50688
    v_mfma_f32_16x16x32_bf16 v[76:79], v[224:227], a[140:143], v[76:79]
    s_add_u32 s40, s40, 65536
    ds_read_b64_tr_b16 v[196:197], v18 offset:46080
    ds_read_b64_tr_b16 v[198:199], v18 offset:50688
    v_mfma_f32_16x16x32_bf16 v[80:83], v[228:231], a[8:11], v[80:83]
    buffer_load_dwordx4 a[208:211], v16, s[16:19], s42 offen offset:2048 sc1
    v_mfma_f32_16x16x32_bf16 v[84:87], v[228:231], a[12:15], v[84:87]
    ds_read_b64_tr_b16 v[200:201], v19 offset:46080
    ds_read_b64_tr_b16 v[202:203], v19 offset:50688
    v_mfma_f32_16x16x32_bf16 v[88:91], v[228:231], a[136:139], v[88:91]
    ds_read_b64_tr_b16 v[204:205], v20 offset:46080
    ds_read_b64_tr_b16 v[206:207], v20 offset:50688
    v_mfma_f32_16x16x32_bf16 v[92:95], v[228:231], a[140:143], v[92:95]
    v_mfma_f32_16x16x32_bf16 v[96:99], v[232:235], a[8:11], v[96:99]
    ds_read_b64_tr_b16 v[208:209], v17 offset:46208
    ds_read_b64_tr_b16 v[210:211], v17 offset:50816
    v_mfma_f32_16x16x32_bf16 v[100:103], v[232:235], a[12:15], v[100:103]
    buffer_load_dwordx4 a[212:215], v2, s[16:19], s42 offen offset:2048 sc1
    v_mfma_f32_16x16x32_bf16 v[104:107], v[232:235], a[136:139], v[104:107]
    ds_read_b64_tr_b16 v[212:213], v18 offset:46208
    ds_read_b64_tr_b16 v[214:215], v18 offset:50816
    v_mfma_f32_16x16x32_bf16 v[108:111], v[232:235], a[140:143], v[108:111]
    ds_read_b64_tr_b16 v[216:217], v19 offset:46208
    ds_read_b64_tr_b16 v[218:219], v19 offset:50816
    v_mfma_f32_16x16x32_bf16 v[112:115], v[236:239], a[8:11], v[112:115]
    v_mfma_f32_16x16x32_bf16 v[116:119], v[236:239], a[12:15], v[116:119]
gated_mix__ssm_conv_h3__compressed_kv_cla__prompt_kernel_pad12:
    s_cbranch_execz gated_mix__ssm_conv_h3__compressed_kv_cla__prompt_kernel_pad20
    s_add_u32 m0, s59, 62464
    ds_read_b64_tr_b16 v[220:221], v20 offset:46208
    ds_read_b64_tr_b16 v[222:223], v20 offset:50816
    v_mfma_f32_16x16x32_bf16 v[120:123], v[236:239], a[136:139], v[120:123]
    buffer_load_dwordx4 v0, s[8:11], s40 offen offset:0 lds
    v_mfma_f32_16x16x32_bf16 v[124:127], v[236:239], a[140:143], v[124:127]
    v_mfma_f32_16x16x32_bf16 v[128:131], v[240:243], a[8:11], v[128:131]
    v_mfma_f32_16x16x32_bf16 v[132:135], v[240:243], a[12:15], v[132:135]
    v_mfma_f32_16x16x32_bf16 v[136:139], v[240:243], a[136:139], v[136:139]
    buffer_load_dwordx4 v1, s[8:11], s40 offen offset:1152 lds
    v_mfma_f32_16x16x32_bf16 v[140:143], v[240:243], a[140:143], v[140:143]
    v_mfma_f32_16x16x32_bf16 v[144:147], v[244:247], a[8:11], v[144:147]
    v_mfma_f32_16x16x32_bf16 v[148:151], v[244:247], a[12:15], v[148:151]
    s_add_u32 s40, s40, 65536
    v_mfma_f32_16x16x32_bf16 v[152:155], v[244:247], a[136:139], v[152:155]
    buffer_load_dwordx4 a[216:219], v16, s[16:19], s42 offen offset:3072 sc1
    v_mfma_f32_16x16x32_bf16 v[156:159], v[244:247], a[140:143], v[156:159]
    v_mfma_f32_16x16x32_bf16 v[160:163], v[248:251], a[8:11], v[160:163]
    v_mfma_f32_16x16x32_bf16 v[164:167], v[248:251], a[12:15], v[164:167]
    v_mfma_f32_16x16x32_bf16 v[168:171], v[248:251], a[136:139], v[168:171]
    buffer_load_dwordx4 a[220:223], v2, s[16:19], s42 offen offset:3072 sc1
    v_mfma_f32_16x16x32_bf16 v[172:175], v[248:251], a[140:143], v[172:175]
    v_mfma_f32_16x16x32_bf16 v[176:179], v[252:255], a[8:11], v[176:179]
    v_mfma_f32_16x16x32_bf16 v[180:183], v[252:255], a[12:15], v[180:183]
    s_add_u32 s42, s42, 4096
    v_mfma_f32_16x16x32_bf16 v[184:187], v[252:255], a[136:139], v[184:187]
    buffer_load_dwordx4 a[88:91], v16, s[16:19], s41 offen offset:3072 sc1
    v_mfma_f32_16x16x32_bf16 v[188:191], v[252:255], a[140:143], v[188:191]
    s_waitcnt lgkmcnt(0)
    v_mfma_f32_16x16x32_bf16 v[64:67], v[192:195], a[16:19], v[64:67]
    v_mfma_f32_16x16x32_bf16 v[68:71], v[192:195], a[20:23], v[68:71]
    v_mfma_f32_16x16x32_bf16 v[72:75], v[192:195], a[144:147], v[72:75]
    ds_read_b64_tr_b16 v[224:225], v17 offset:55296
    ds_read_b64_tr_b16 v[226:227], v17 offset:59904
    v_mfma_f32_16x16x32_bf16 v[76:79], v[192:195], a[148:151], v[76:79]
    ds_read_b64_tr_b16 v[228:229], v18 offset:55296
    ds_read_b64_tr_b16 v[230:231], v18 offset:59904
    v_mfma_f32_16x16x32_bf16 v[80:83], v[196:199], a[16:19], v[80:83]
    buffer_load_dwordx4 a[92:95], v2, s[16:19], s41 offen offset:3072 sc1
    v_mfma_f32_16x16x32_bf16 v[84:87], v[196:199], a[20:23], v[84:87]
    ds_read_b64_tr_b16 v[232:233], v19 offset:55296
    ds_read_b64_tr_b16 v[234:235], v19 offset:59904
    v_mfma_f32_16x16x32_bf16 v[88:91], v[196:199], a[144:147], v[88:91]
    ds_read_b64_tr_b16 v[236:237], v20 offset:55296
    ds_read_b64_tr_b16 v[238:239], v20 offset:59904
    v_mfma_f32_16x16x32_bf16 v[92:95], v[196:199], a[148:151], v[92:95]
    v_mfma_f32_16x16x32_bf16 v[96:99], v[200:203], a[16:19], v[96:99]
    s_add_u32 s41, s41, 4096
    s_add_u32 s36, s48, 2097152
    ds_read_b64_tr_b16 v[240:241], v17 offset:55424
    ds_read_b64_tr_b16 v[242:243], v17 offset:60032
    v_mfma_f32_16x16x32_bf16 v[100:103], v[200:203], a[20:23], v[100:103]
    buffer_load_dwordx4 v[32:35], v21, s[24:27], s36 offen
    v_mfma_f32_16x16x32_bf16 v[104:107], v[200:203], a[144:147], v[104:107]
    ds_read_b64_tr_b16 v[244:245], v18 offset:55424
    ds_read_b64_tr_b16 v[246:247], v18 offset:60032
    v_mfma_f32_16x16x32_bf16 v[108:111], v[200:203], a[148:151], v[108:111]
    ds_read_b64_tr_b16 v[248:249], v19 offset:55424
    ds_read_b64_tr_b16 v[250:251], v19 offset:60032
    v_mfma_f32_16x16x32_bf16 v[112:115], v[204:207], a[16:19], v[112:115]
    v_mfma_f32_16x16x32_bf16 v[116:119], v[204:207], a[20:23], v[116:119]
    s_add_u32 s36, s48, 2228224
    ds_read_b64_tr_b16 v[252:253], v20 offset:55424
    ds_read_b64_tr_b16 v[254:255], v20 offset:60032
    v_mfma_f32_16x16x32_bf16 v[120:123], v[204:207], a[144:147], v[120:123]
    buffer_load_dwordx4 v[36:39], v21, s[24:27], s36 offen
    v_mfma_f32_16x16x32_bf16 v[124:127], v[204:207], a[148:151], v[124:127]
    v_mfma_f32_16x16x32_bf16 v[128:131], v[208:211], a[16:19], v[128:131]
    v_mfma_f32_16x16x32_bf16 v[132:135], v[208:211], a[20:23], v[132:135]
    s_add_u32 m0, s59, 71680
    v_mfma_f32_16x16x32_bf16 v[136:139], v[208:211], a[144:147], v[136:139]
    buffer_load_dwordx4 v0, s[8:11], s40 offen offset:0 lds
    v_mfma_f32_16x16x32_bf16 v[140:143], v[208:211], a[148:151], v[140:143]
    v_mfma_f32_16x16x32_bf16 v[144:147], v[212:215], a[16:19], v[144:147]
    v_mfma_f32_16x16x32_bf16 v[148:151], v[212:215], a[20:23], v[148:151]
    v_mfma_f32_16x16x32_bf16 v[152:155], v[212:215], a[144:147], v[152:155]
    buffer_load_dwordx4 v1, s[8:11], s40 offen offset:1152 lds
    v_mfma_f32_16x16x32_bf16 v[156:159], v[212:215], a[148:151], v[156:159]
    v_mfma_f32_16x16x32_bf16 v[160:163], v[216:219], a[16:19], v[160:163]
    v_mfma_f32_16x16x32_bf16 v[164:167], v[216:219], a[20:23], v[164:167]
    s_add_u32 s40, s40, 65536
    v_mfma_f32_16x16x32_bf16 v[168:171], v[216:219], a[144:147], v[168:171]
    buffer_load_dwordx4 a[224:227], v16, s[16:19], s42 offen offset:0 sc1
    v_mfma_f32_16x16x32_bf16 v[172:175], v[216:219], a[148:151], v[172:175]
    v_mfma_f32_16x16x32_bf16 v[176:179], v[220:223], a[16:19], v[176:179]
    v_mfma_f32_16x16x32_bf16 v[180:183], v[220:223], a[20:23], v[180:183]
    v_mfma_f32_16x16x32_bf16 v[184:187], v[220:223], a[144:147], v[184:187]
    buffer_load_dwordx4 a[228:231], v2, s[16:19], s42 offen offset:0 sc1
    v_mfma_f32_16x16x32_bf16 v[188:191], v[220:223], a[148:151], v[188:191]
    s_waitcnt vmcnt(38) lgkmcnt(0)
    s_barrier
    v_mfma_f32_16x16x32_bf16 v[64:67], v[224:227], a[24:27], v[64:67]
    v_add_u32 v17, 64512, v17
    v_add_u32 v18, 64512, v18
    v_mfma_f32_16x16x32_bf16 v[68:71], v[224:227], a[28:31], v[68:71]
    v_add_u32 v19, 64512, v19
    v_add_u32 v20, 64512, v20
    v_mfma_f32_16x16x32_bf16 v[72:75], v[224:227], a[152:155], v[72:75]
    ds_read_b64_tr_b16 v[192:193], v17 offset:0
    ds_read_b64_tr_b16 v[194:195], v17 offset:4608
    v_mfma_f32_16x16x32_bf16 v[76:79], v[224:227], a[156:159], v[76:79]
    ds_read_b64_tr_b16 v[196:197], v18 offset:0
    ds_read_b64_tr_b16 v[198:199], v18 offset:4608
    v_mfma_f32_16x16x32_bf16 v[80:83], v[228:231], a[24:27], v[80:83]
    buffer_load_dwordx4 a[96:99], v16, s[16:19], s41 offen offset:0 sc1
    v_mfma_f32_16x16x32_bf16 v[84:87], v[228:231], a[28:31], v[84:87]
    ds_read_b64_tr_b16 v[200:201], v19 offset:0
    ds_read_b64_tr_b16 v[202:203], v19 offset:4608
    v_mfma_f32_16x16x32_bf16 v[88:91], v[228:231], a[152:155], v[88:91]
    ds_read_b64_tr_b16 v[204:205], v20 offset:0
    ds_read_b64_tr_b16 v[206:207], v20 offset:4608
    v_mfma_f32_16x16x32_bf16 v[92:95], v[228:231], a[156:159], v[92:95]
    v_mfma_f32_16x16x32_bf16 v[96:99], v[232:235], a[24:27], v[96:99]
    ds_read_b64_tr_b16 v[208:209], v17 offset:128
    ds_read_b64_tr_b16 v[210:211], v17 offset:4736
    v_mfma_f32_16x16x32_bf16 v[100:103], v[232:235], a[28:31], v[100:103]
    buffer_load_dwordx4 a[100:103], v2, s[16:19], s41 offen offset:0 sc1
    v_mfma_f32_16x16x32_bf16 v[104:107], v[232:235], a[152:155], v[104:107]
    ds_read_b64_tr_b16 v[212:213], v18 offset:128
    ds_read_b64_tr_b16 v[214:215], v18 offset:4736
    v_mfma_f32_16x16x32_bf16 v[108:111], v[232:235], a[156:159], v[108:111]
    ds_read_b64_tr_b16 v[216:217], v19 offset:128
    ds_read_b64_tr_b16 v[218:219], v19 offset:4736
    v_mfma_f32_16x16x32_bf16 v[112:115], v[236:239], a[24:27], v[112:115]
    v_mfma_f32_16x16x32_bf16 v[116:119], v[236:239], a[28:31], v[116:119]
    s_add_u32 m0, s59, 80896
    ds_read_b64_tr_b16 v[220:221], v20 offset:128
    ds_read_b64_tr_b16 v[222:223], v20 offset:4736
    v_mfma_f32_16x16x32_bf16 v[120:123], v[236:239], a[152:155], v[120:123]
    buffer_load_dwordx4 v0, s[8:11], s40 offen offset:0 lds
    v_mfma_f32_16x16x32_bf16 v[124:127], v[236:239], a[156:159], v[124:127]
    v_mfma_f32_16x16x32_bf16 v[128:131], v[240:243], a[24:27], v[128:131]
    v_mfma_f32_16x16x32_bf16 v[132:135], v[240:243], a[28:31], v[132:135]
    v_mfma_f32_16x16x32_bf16 v[136:139], v[240:243], a[152:155], v[136:139]
    buffer_load_dwordx4 v1, s[8:11], s40 offen offset:1152 lds
    v_mfma_f32_16x16x32_bf16 v[140:143], v[240:243], a[156:159], v[140:143]
    v_mfma_f32_16x16x32_bf16 v[144:147], v[244:247], a[24:27], v[144:147]
    v_mfma_f32_16x16x32_bf16 v[148:151], v[244:247], a[28:31], v[148:151]
    s_add_u32 s40, s40, 65536
    v_mfma_f32_16x16x32_bf16 v[152:155], v[244:247], a[152:155], v[152:155]
    buffer_load_dwordx4 a[232:235], v16, s[16:19], s42 offen offset:1024 sc1
    v_mfma_f32_16x16x32_bf16 v[156:159], v[244:247], a[156:159], v[156:159]
    v_mfma_f32_16x16x32_bf16 v[160:163], v[248:251], a[24:27], v[160:163]
    v_mfma_f32_16x16x32_bf16 v[164:167], v[248:251], a[28:31], v[164:167]
    v_mfma_f32_16x16x32_bf16 v[168:171], v[248:251], a[152:155], v[168:171]
    buffer_load_dwordx4 a[236:239], v2, s[16:19], s42 offen offset:1024 sc1
    v_mfma_f32_16x16x32_bf16 v[172:175], v[248:251], a[156:159], v[172:175]
    v_mfma_f32_16x16x32_bf16 v[176:179], v[252:255], a[24:27], v[176:179]
    v_mfma_f32_16x16x32_bf16 v[180:183], v[252:255], a[28:31], v[180:183]
    v_mfma_f32_16x16x32_bf16 v[184:187], v[252:255], a[152:155], v[184:187]
    buffer_load_dwordx4 a[104:107], v16, s[16:19], s41 offen offset:1024 sc1
    v_mfma_f32_16x16x32_bf16 v[188:191], v[252:255], a[156:159], v[188:191]
    s_waitcnt lgkmcnt(0)
    v_mfma_f32_16x16x32_bf16 v[64:67], v[192:195], a[32:35], v[64:67]
    v_mfma_f32_16x16x32_bf16 v[68:71], v[192:195], a[36:39], v[68:71]
    v_mfma_f32_16x16x32_bf16 v[72:75], v[192:195], a[160:163], v[72:75]
    ds_read_b64_tr_b16 v[224:225], v17 offset:9216
    ds_read_b64_tr_b16 v[226:227], v17 offset:13824
    v_mfma_f32_16x16x32_bf16 v[76:79], v[192:195], a[164:167], v[76:79]
    ds_read_b64_tr_b16 v[228:229], v18 offset:9216
    ds_read_b64_tr_b16 v[230:231], v18 offset:13824
    v_mfma_f32_16x16x32_bf16 v[80:83], v[196:199], a[32:35], v[80:83]
    buffer_load_dwordx4 a[108:111], v2, s[16:19], s41 offen offset:1024 sc1
    v_mfma_f32_16x16x32_bf16 v[84:87], v[196:199], a[36:39], v[84:87]
    ds_read_b64_tr_b16 v[232:233], v19 offset:9216
    ds_read_b64_tr_b16 v[234:235], v19 offset:13824
    v_mfma_f32_16x16x32_bf16 v[88:91], v[196:199], a[160:163], v[88:91]
    ds_read_b64_tr_b16 v[236:237], v20 offset:9216
    ds_read_b64_tr_b16 v[238:239], v20 offset:13824
    v_mfma_f32_16x16x32_bf16 v[92:95], v[196:199], a[164:167], v[92:95]
    v_mfma_f32_16x16x32_bf16 v[96:99], v[200:203], a[32:35], v[96:99]
    s_waitcnt vmcnt(26)
    ds_read_b64_tr_b16 v[240:241], v17 offset:9344
    ds_read_b64_tr_b16 v[242:243], v17 offset:13952
    v_mfma_f32_16x16x32_bf16 v[100:103], v[200:203], a[36:39], v[100:103]
    buffer_store_dword v9, v8, s[28:31], s57 offen sc1
    v_mfma_f32_16x16x32_bf16 v[104:107], v[200:203], a[160:163], v[104:107]
    ds_read_b64_tr_b16 v[244:245], v18 offset:9344
    ds_read_b64_tr_b16 v[246:247], v18 offset:13952
    v_mfma_f32_16x16x32_bf16 v[108:111], v[200:203], a[164:167], v[108:111]
    ds_read_b64_tr_b16 v[248:249], v19 offset:9344
    ds_read_b64_tr_b16 v[250:251], v19 offset:13952
    v_mfma_f32_16x16x32_bf16 v[112:115], v[204:207], a[32:35], v[112:115]
    v_mfma_f32_16x16x32_bf16 v[116:119], v[204:207], a[36:39], v[116:119]
    s_add_u32 m0, s59, 90112
    ds_read_b64_tr_b16 v[252:253], v20 offset:9344
    ds_read_b64_tr_b16 v[254:255], v20 offset:13952
    v_mfma_f32_16x16x32_bf16 v[120:123], v[204:207], a[160:163], v[120:123]
    buffer_load_dwordx4 v0, s[8:11], s40 offen offset:0 lds
    v_mfma_f32_16x16x32_bf16 v[124:127], v[204:207], a[164:167], v[124:127]
    v_mfma_f32_16x16x32_bf16 v[128:131], v[208:211], a[32:35], v[128:131]
    v_mfma_f32_16x16x32_bf16 v[132:135], v[208:211], a[36:39], v[132:135]
    v_mfma_f32_16x16x32_bf16 v[136:139], v[208:211], a[160:163], v[136:139]
    buffer_load_dwordx4 v1, s[8:11], s40 offen offset:1152 lds
    v_mfma_f32_16x16x32_bf16 v[140:143], v[208:211], a[164:167], v[140:143]
    v_mfma_f32_16x16x32_bf16 v[144:147], v[212:215], a[32:35], v[144:147]
    v_mfma_f32_16x16x32_bf16 v[148:151], v[212:215], a[36:39], v[148:151]
    s_add_u32 s40, s40, 65536
    v_mfma_f32_16x16x32_bf16 v[152:155], v[212:215], a[160:163], v[152:155]
    buffer_load_dwordx4 a[240:243], v16, s[16:19], s42 offen offset:2048 sc1
    v_mfma_f32_16x16x32_bf16 v[156:159], v[212:215], a[164:167], v[156:159]
    v_mfma_f32_16x16x32_bf16 v[160:163], v[216:219], a[32:35], v[160:163]
    v_mfma_f32_16x16x32_bf16 v[164:167], v[216:219], a[36:39], v[164:167]
    v_mfma_f32_16x16x32_bf16 v[168:171], v[216:219], a[160:163], v[168:171]
    buffer_load_dwordx4 a[244:247], v2, s[16:19], s42 offen offset:2048 sc1
    v_mfma_f32_16x16x32_bf16 v[172:175], v[216:219], a[164:167], v[172:175]
    v_mfma_f32_16x16x32_bf16 v[176:179], v[220:223], a[32:35], v[176:179]
    v_mfma_f32_16x16x32_bf16 v[180:183], v[220:223], a[36:39], v[180:183]
    v_mfma_f32_16x16x32_bf16 v[184:187], v[220:223], a[160:163], v[184:187]
    buffer_load_dwordx4 a[112:115], v16, s[16:19], s41 offen offset:2048 sc1
    v_mfma_f32_16x16x32_bf16 v[188:191], v[220:223], a[164:167], v[188:191]
    buffer_load_dwordx4 a[116:119], v2, s[16:19], s41 offen offset:2048 sc1
    s_waitcnt vmcnt(41) lgkmcnt(0)
    s_barrier
    v_mfma_f32_16x16x32_bf16 v[64:67], v[224:227], a[40:43], v[64:67]
    v_add_u32 v17, 4294838272, v17
    v_add_u32 v18, 4294838272, v18
    v_mfma_f32_16x16x32_bf16 v[68:71], v[224:227], a[44:47], v[68:71]
    v_add_u32 v19, 4294838272, v19
    v_add_u32 v20, 4294838272, v20
    v_mfma_f32_16x16x32_bf16 v[72:75], v[224:227], a[168:171], v[72:75]
    ds_read_b64_tr_b16 v[192:193], v17 offset:0
    ds_read_b64_tr_b16 v[194:195], v17 offset:4608
    v_mfma_f32_16x16x32_bf16 v[76:79], v[224:227], a[172:175], v[76:79]
    s_add_u32 m0, s59, 99328
    ds_read_b64_tr_b16 v[196:197], v18 offset:0
    ds_read_b64_tr_b16 v[198:199], v18 offset:4608
    v_mfma_f32_16x16x32_bf16 v[80:83], v[228:231], a[40:43], v[80:83]
    buffer_load_dwordx4 v0, s[8:11], s40 offen offset:0 lds
    v_mfma_f32_16x16x32_bf16 v[84:87], v[228:231], a[44:47], v[84:87]
    ds_read_b64_tr_b16 v[200:201], v19 offset:0
    ds_read_b64_tr_b16 v[202:203], v19 offset:4608
    v_mfma_f32_16x16x32_bf16 v[88:91], v[228:231], a[168:171], v[88:91]
    ds_read_b64_tr_b16 v[204:205], v20 offset:0
    ds_read_b64_tr_b16 v[206:207], v20 offset:4608
    v_mfma_f32_16x16x32_bf16 v[92:95], v[228:231], a[172:175], v[92:95]
    v_mfma_f32_16x16x32_bf16 v[96:99], v[232:235], a[40:43], v[96:99]
    ds_read_b64_tr_b16 v[208:209], v17 offset:128
    ds_read_b64_tr_b16 v[210:211], v17 offset:4736
    v_mfma_f32_16x16x32_bf16 v[100:103], v[232:235], a[44:47], v[100:103]
    buffer_load_dwordx4 v1, s[8:11], s40 offen offset:1152 lds
    v_mfma_f32_16x16x32_bf16 v[104:107], v[232:235], a[168:171], v[104:107]
    ds_read_b64_tr_b16 v[212:213], v18 offset:128
    ds_read_b64_tr_b16 v[214:215], v18 offset:4736
    v_mfma_f32_16x16x32_bf16 v[108:111], v[232:235], a[172:175], v[108:111]
    ds_read_b64_tr_b16 v[216:217], v19 offset:128
    ds_read_b64_tr_b16 v[218:219], v19 offset:4736
    v_mfma_f32_16x16x32_bf16 v[112:115], v[236:239], a[40:43], v[112:115]
    v_mfma_f32_16x16x32_bf16 v[116:119], v[236:239], a[44:47], v[116:119]
    s_add_u32 s40, s40, 65536
    ds_read_b64_tr_b16 v[220:221], v20 offset:128
    ds_read_b64_tr_b16 v[222:223], v20 offset:4736
    v_mfma_f32_16x16x32_bf16 v[120:123], v[236:239], a[168:171], v[120:123]
    buffer_load_dwordx4 a[248:251], v16, s[16:19], s42 offen offset:3072 sc1
    v_mfma_f32_16x16x32_bf16 v[124:127], v[236:239], a[172:175], v[124:127]
    v_mfma_f32_16x16x32_bf16 v[128:131], v[240:243], a[40:43], v[128:131]
    v_mfma_f32_16x16x32_bf16 v[132:135], v[240:243], a[44:47], v[132:135]
    v_mfma_f32_16x16x32_bf16 v[136:139], v[240:243], a[168:171], v[136:139]
    buffer_load_dwordx4 a[252:255], v2, s[16:19], s42 offen offset:3072 sc1
    v_mfma_f32_16x16x32_bf16 v[140:143], v[240:243], a[172:175], v[140:143]
    v_mfma_f32_16x16x32_bf16 v[144:147], v[244:247], a[40:43], v[144:147]
    v_mfma_f32_16x16x32_bf16 v[148:151], v[244:247], a[44:47], v[148:151]
    s_add_u32 s42, s42, 4096
    v_mfma_f32_16x16x32_bf16 v[152:155], v[244:247], a[168:171], v[152:155]
    buffer_load_dwordx4 a[120:123], v16, s[16:19], s41 offen offset:3072 sc1
    v_mfma_f32_16x16x32_bf16 v[156:159], v[244:247], a[172:175], v[156:159]
    v_mfma_f32_16x16x32_bf16 v[160:163], v[248:251], a[40:43], v[160:163]
    v_mfma_f32_16x16x32_bf16 v[164:167], v[248:251], a[44:47], v[164:167]
    v_mfma_f32_16x16x32_bf16 v[168:171], v[248:251], a[168:171], v[168:171]
    buffer_load_dwordx4 a[124:127], v2, s[16:19], s41 offen offset:3072 sc1
    v_mfma_f32_16x16x32_bf16 v[172:175], v[248:251], a[172:175], v[172:175]
    v_mfma_f32_16x16x32_bf16 v[176:179], v[252:255], a[40:43], v[176:179]
    v_mfma_f32_16x16x32_bf16 v[180:183], v[252:255], a[44:47], v[180:183]
    s_add_u32 s41, s41, 4096
    s_add_u32 m0, s59, 108544
    v_mfma_f32_16x16x32_bf16 v[184:187], v[252:255], a[168:171], v[184:187]
    buffer_load_dwordx4 v0, s[8:11], s40 offen offset:0 lds
    v_mfma_f32_16x16x32_bf16 v[188:191], v[252:255], a[172:175], v[188:191]
    s_waitcnt lgkmcnt(0)
    v_mfma_f32_16x16x32_bf16 v[64:67], v[192:195], a[48:51], v[64:67]
    v_mfma_f32_16x16x32_bf16 v[68:71], v[192:195], a[52:55], v[68:71]
    v_mfma_f32_16x16x32_bf16 v[72:75], v[192:195], a[176:179], v[72:75]
    ds_read_b64_tr_b16 v[224:225], v17 offset:9216
    ds_read_b64_tr_b16 v[226:227], v17 offset:13824
    v_mfma_f32_16x16x32_bf16 v[76:79], v[192:195], a[180:183], v[76:79]
    ds_read_b64_tr_b16 v[228:229], v18 offset:9216
    ds_read_b64_tr_b16 v[230:231], v18 offset:13824
    v_mfma_f32_16x16x32_bf16 v[80:83], v[196:199], a[48:51], v[80:83]
    buffer_load_dwordx4 v1, s[8:11], s40 offen offset:1152 lds
    v_mfma_f32_16x16x32_bf16 v[84:87], v[196:199], a[52:55], v[84:87]
    ds_read_b64_tr_b16 v[232:233], v19 offset:9216
    ds_read_b64_tr_b16 v[234:235], v19 offset:13824
    v_mfma_f32_16x16x32_bf16 v[88:91], v[196:199], a[176:179], v[88:91]
    ds_read_b64_tr_b16 v[236:237], v20 offset:9216
    ds_read_b64_tr_b16 v[238:239], v20 offset:13824
    v_mfma_f32_16x16x32_bf16 v[92:95], v[196:199], a[180:183], v[92:95]
    v_mfma_f32_16x16x32_bf16 v[96:99], v[200:203], a[48:51], v[96:99]
    s_add_u32 s40, s40, 65536
    ds_read_b64_tr_b16 v[240:241], v17 offset:9344
    ds_read_b64_tr_b16 v[242:243], v17 offset:13952
    v_mfma_f32_16x16x32_bf16 v[100:103], v[200:203], a[52:55], v[100:103]
    buffer_load_dwordx4 a[128:131], v16, s[16:19], s42 offen offset:0 sc1
    v_mfma_f32_16x16x32_bf16 v[104:107], v[200:203], a[176:179], v[104:107]
    ds_read_b64_tr_b16 v[244:245], v18 offset:9344
    ds_read_b64_tr_b16 v[246:247], v18 offset:13952
    v_mfma_f32_16x16x32_bf16 v[108:111], v[200:203], a[180:183], v[108:111]
    ds_read_b64_tr_b16 v[248:249], v19 offset:9344
    ds_read_b64_tr_b16 v[250:251], v19 offset:13952
    v_mfma_f32_16x16x32_bf16 v[112:115], v[204:207], a[48:51], v[112:115]
    v_mfma_f32_16x16x32_bf16 v[116:119], v[204:207], a[52:55], v[116:119]
    ds_read_b64_tr_b16 v[252:253], v20 offset:9344
    ds_read_b64_tr_b16 v[254:255], v20 offset:13952
    v_mfma_f32_16x16x32_bf16 v[120:123], v[204:207], a[176:179], v[120:123]
    buffer_load_dwordx4 a[132:135], v2, s[16:19], s42 offen offset:0 sc1
    v_mfma_f32_16x16x32_bf16 v[124:127], v[204:207], a[180:183], v[124:127]
    v_mfma_f32_16x16x32_bf16 v[128:131], v[208:211], a[48:51], v[128:131]
    v_mfma_f32_16x16x32_bf16 v[132:135], v[208:211], a[52:55], v[132:135]
    v_mfma_f32_16x16x32_bf16 v[136:139], v[208:211], a[176:179], v[136:139]
    buffer_load_dwordx4 a[0:3], v16, s[16:19], s41 offen offset:0 sc1
    v_mfma_f32_16x16x32_bf16 v[140:143], v[208:211], a[180:183], v[140:143]
    v_mfma_f32_16x16x32_bf16 v[144:147], v[212:215], a[48:51], v[144:147]
    v_mfma_f32_16x16x32_bf16 v[148:151], v[212:215], a[52:55], v[148:151]
    v_mfma_f32_16x16x32_bf16 v[152:155], v[212:215], a[176:179], v[152:155]
    buffer_load_dwordx4 a[4:7], v2, s[16:19], s41 offen offset:0 sc1
    v_mfma_f32_16x16x32_bf16 v[156:159], v[212:215], a[180:183], v[156:159]
    v_mfma_f32_16x16x32_bf16 v[160:163], v[216:219], a[48:51], v[160:163]
    v_mfma_f32_16x16x32_bf16 v[164:167], v[216:219], a[52:55], v[164:167]
    s_add_u32 m0, s59, 117760
    v_mfma_f32_16x16x32_bf16 v[168:171], v[216:219], a[176:179], v[168:171]
    buffer_load_dwordx4 v0, s[8:11], s40 offen offset:0 lds
    v_mfma_f32_16x16x32_bf16 v[172:175], v[216:219], a[180:183], v[172:175]
    v_mfma_f32_16x16x32_bf16 v[176:179], v[220:223], a[48:51], v[176:179]
    v_mfma_f32_16x16x32_bf16 v[180:183], v[220:223], a[52:55], v[180:183]
    v_mfma_f32_16x16x32_bf16 v[184:187], v[220:223], a[176:179], v[184:187]
    buffer_load_dwordx4 v1, s[8:11], s40 offen offset:1152 lds
    v_mfma_f32_16x16x32_bf16 v[188:191], v[220:223], a[180:183], v[188:191]
    s_waitcnt vmcnt(51) lgkmcnt(0)
    s_barrier
    v_mfma_f32_16x16x32_bf16 v[64:67], v[224:227], a[56:59], v[64:67]
    v_mfma_f32_16x16x32_bf16 v[68:71], v[224:227], a[60:63], v[68:71]
    v_mfma_f32_16x16x32_bf16 v[72:75], v[224:227], a[184:187], v[72:75]
    ds_read_b64_tr_b16 v[192:193], v17 offset:18432
    ds_read_b64_tr_b16 v[194:195], v17 offset:23040
    v_mfma_f32_16x16x32_bf16 v[76:79], v[224:227], a[188:191], v[76:79]
    s_add_u32 s40, s40, 65536
    ds_read_b64_tr_b16 v[196:197], v18 offset:18432
    ds_read_b64_tr_b16 v[198:199], v18 offset:23040
    v_mfma_f32_16x16x32_bf16 v[80:83], v[228:231], a[56:59], v[80:83]
    buffer_load_dwordx4 a[136:139], v16, s[16:19], s42 offen offset:1024 sc1
    v_mfma_f32_16x16x32_bf16 v[84:87], v[228:231], a[60:63], v[84:87]
    ds_read_b64_tr_b16 v[200:201], v19 offset:18432
    ds_read_b64_tr_b16 v[202:203], v19 offset:23040
    v_mfma_f32_16x16x32_bf16 v[88:91], v[228:231], a[184:187], v[88:91]
    ds_read_b64_tr_b16 v[204:205], v20 offset:18432
    ds_read_b64_tr_b16 v[206:207], v20 offset:23040
    v_mfma_f32_16x16x32_bf16 v[92:95], v[228:231], a[188:191], v[92:95]
    v_mfma_f32_16x16x32_bf16 v[96:99], v[232:235], a[56:59], v[96:99]
    ds_read_b64_tr_b16 v[208:209], v17 offset:18560
    ds_read_b64_tr_b16 v[210:211], v17 offset:23168
    v_mfma_f32_16x16x32_bf16 v[100:103], v[232:235], a[60:63], v[100:103]
    buffer_load_dwordx4 a[140:143], v2, s[16:19], s42 offen offset:1024 sc1
    v_mfma_f32_16x16x32_bf16 v[104:107], v[232:235], a[184:187], v[104:107]
    ds_read_b64_tr_b16 v[212:213], v18 offset:18560
    ds_read_b64_tr_b16 v[214:215], v18 offset:23168
    v_mfma_f32_16x16x32_bf16 v[108:111], v[232:235], a[188:191], v[108:111]
    ds_read_b64_tr_b16 v[216:217], v19 offset:18560
    ds_read_b64_tr_b16 v[218:219], v19 offset:23168
    v_mfma_f32_16x16x32_bf16 v[112:115], v[236:239], a[56:59], v[112:115]
    v_mfma_f32_16x16x32_bf16 v[116:119], v[236:239], a[60:63], v[116:119]
    ds_read_b64_tr_b16 v[220:221], v20 offset:18560
    ds_read_b64_tr_b16 v[222:223], v20 offset:23168
    v_mfma_f32_16x16x32_bf16 v[120:123], v[236:239], a[184:187], v[120:123]
    buffer_load_dwordx4 a[8:11], v16, s[16:19], s41 offen offset:1024 sc1
    v_mfma_f32_16x16x32_bf16 v[124:127], v[236:239], a[188:191], v[124:127]
    v_mfma_f32_16x16x32_bf16 v[128:131], v[240:243], a[56:59], v[128:131]
    v_mfma_f32_16x16x32_bf16 v[132:135], v[240:243], a[60:63], v[132:135]
    v_mfma_f32_16x16x32_bf16 v[136:139], v[240:243], a[184:187], v[136:139]
    buffer_load_dwordx4 a[12:15], v2, s[16:19], s41 offen offset:1024 sc1
    v_mfma_f32_16x16x32_bf16 v[140:143], v[240:243], a[188:191], v[140:143]
    v_mfma_f32_16x16x32_bf16 v[144:147], v[244:247], a[56:59], v[144:147]
    v_mfma_f32_16x16x32_bf16 v[148:151], v[244:247], a[60:63], v[148:151]
    s_add_u32 m0, s59, 126976
    v_mfma_f32_16x16x32_bf16 v[152:155], v[244:247], a[184:187], v[152:155]
    buffer_load_dwordx4 v0, s[8:11], s40 offen offset:0 lds
    v_mfma_f32_16x16x32_bf16 v[156:159], v[244:247], a[188:191], v[156:159]
    v_mfma_f32_16x16x32_bf16 v[160:163], v[248:251], a[56:59], v[160:163]
    v_mfma_f32_16x16x32_bf16 v[164:167], v[248:251], a[60:63], v[164:167]
    v_mfma_f32_16x16x32_bf16 v[168:171], v[248:251], a[184:187], v[168:171]
    buffer_load_dwordx4 v1, s[8:11], s40 offen offset:1152 lds
    v_mfma_f32_16x16x32_bf16 v[172:175], v[248:251], a[188:191], v[172:175]
    v_mfma_f32_16x16x32_bf16 v[176:179], v[252:255], a[56:59], v[176:179]
    v_mfma_f32_16x16x32_bf16 v[180:183], v[252:255], a[60:63], v[180:183]
    s_add_u32 s40, s40, 65536
    v_mfma_f32_16x16x32_bf16 v[184:187], v[252:255], a[184:187], v[184:187]
    buffer_load_dwordx4 a[144:147], v16, s[16:19], s42 offen offset:2048 sc1
    v_mfma_f32_16x16x32_bf16 v[188:191], v[252:255], a[188:191], v[188:191]
    s_waitcnt lgkmcnt(0)
    v_mfma_f32_16x16x32_bf16 v[64:67], v[192:195], a[64:67], v[64:67]
    v_mfma_f32_16x16x32_bf16 v[68:71], v[192:195], a[68:71], v[68:71]
    v_mfma_f32_16x16x32_bf16 v[72:75], v[192:195], a[192:195], v[72:75]
    ds_read_b64_tr_b16 v[224:225], v17 offset:27648
    ds_read_b64_tr_b16 v[226:227], v17 offset:32256
    v_mfma_f32_16x16x32_bf16 v[76:79], v[192:195], a[196:199], v[76:79]
    ds_read_b64_tr_b16 v[228:229], v18 offset:27648
    ds_read_b64_tr_b16 v[230:231], v18 offset:32256
    v_mfma_f32_16x16x32_bf16 v[80:83], v[196:199], a[64:67], v[80:83]
    buffer_load_dwordx4 a[148:151], v2, s[16:19], s42 offen offset:2048 sc1
    v_mfma_f32_16x16x32_bf16 v[84:87], v[196:199], a[68:71], v[84:87]
    ds_read_b64_tr_b16 v[232:233], v19 offset:27648
    ds_read_b64_tr_b16 v[234:235], v19 offset:32256
    v_mfma_f32_16x16x32_bf16 v[88:91], v[196:199], a[192:195], v[88:91]
    ds_read_b64_tr_b16 v[236:237], v20 offset:27648
    ds_read_b64_tr_b16 v[238:239], v20 offset:32256
    v_mfma_f32_16x16x32_bf16 v[92:95], v[196:199], a[196:199], v[92:95]
    v_mfma_f32_16x16x32_bf16 v[96:99], v[200:203], a[64:67], v[96:99]
    ds_read_b64_tr_b16 v[240:241], v17 offset:27776
    ds_read_b64_tr_b16 v[242:243], v17 offset:32384
    v_mfma_f32_16x16x32_bf16 v[100:103], v[200:203], a[68:71], v[100:103]
    buffer_load_dwordx4 a[16:19], v16, s[16:19], s41 offen offset:2048 sc1
    v_mfma_f32_16x16x32_bf16 v[104:107], v[200:203], a[192:195], v[104:107]
    ds_read_b64_tr_b16 v[244:245], v18 offset:27776
    ds_read_b64_tr_b16 v[246:247], v18 offset:32384
    v_mfma_f32_16x16x32_bf16 v[108:111], v[200:203], a[196:199], v[108:111]
    ds_read_b64_tr_b16 v[248:249], v19 offset:27776
    ds_read_b64_tr_b16 v[250:251], v19 offset:32384
    v_mfma_f32_16x16x32_bf16 v[112:115], v[204:207], a[64:67], v[112:115]
    v_mfma_f32_16x16x32_bf16 v[116:119], v[204:207], a[68:71], v[116:119]
    ds_read_b64_tr_b16 v[252:253], v20 offset:27776
    ds_read_b64_tr_b16 v[254:255], v20 offset:32384
    v_mfma_f32_16x16x32_bf16 v[120:123], v[204:207], a[192:195], v[120:123]
    buffer_load_dwordx4 a[20:23], v2, s[16:19], s41 offen offset:2048 sc1
    v_mfma_f32_16x16x32_bf16 v[124:127], v[204:207], a[196:199], v[124:127]
    v_mfma_f32_16x16x32_bf16 v[128:131], v[208:211], a[64:67], v[128:131]
    v_mfma_f32_16x16x32_bf16 v[132:135], v[208:211], a[68:71], v[132:135]
    s_add_u32 m0, s59, 136192
    v_mfma_f32_16x16x32_bf16 v[136:139], v[208:211], a[192:195], v[136:139]
    buffer_load_dwordx4 v0, s[8:11], s40 offen offset:0 lds
    v_mfma_f32_16x16x32_bf16 v[140:143], v[208:211], a[196:199], v[140:143]
    v_mfma_f32_16x16x32_bf16 v[144:147], v[212:215], a[64:67], v[144:147]
    v_mfma_f32_16x16x32_bf16 v[148:151], v[212:215], a[68:71], v[148:151]
    v_mfma_f32_16x16x32_bf16 v[152:155], v[212:215], a[192:195], v[152:155]
    buffer_load_dwordx4 v1, s[8:11], s40 offen offset:1152 lds
    v_mfma_f32_16x16x32_bf16 v[156:159], v[212:215], a[196:199], v[156:159]
    v_mfma_f32_16x16x32_bf16 v[160:163], v[216:219], a[64:67], v[160:163]
    v_mfma_f32_16x16x32_bf16 v[164:167], v[216:219], a[68:71], v[164:167]
    s_add_u32 s40, s40, 65536
    v_mfma_f32_16x16x32_bf16 v[168:171], v[216:219], a[192:195], v[168:171]
    buffer_load_dwordx4 a[152:155], v16, s[16:19], s42 offen offset:3072 sc1
    v_mfma_f32_16x16x32_bf16 v[172:175], v[216:219], a[196:199], v[172:175]
    v_mfma_f32_16x16x32_bf16 v[176:179], v[220:223], a[64:67], v[176:179]
    v_mfma_f32_16x16x32_bf16 v[180:183], v[220:223], a[68:71], v[180:183]
    v_mfma_f32_16x16x32_bf16 v[184:187], v[220:223], a[192:195], v[184:187]
    buffer_load_dwordx4 a[156:159], v2, s[16:19], s42 offen offset:3072 sc1
    v_mfma_f32_16x16x32_bf16 v[188:191], v[220:223], a[196:199], v[188:191]
    s_waitcnt vmcnt(53) lgkmcnt(0)
    s_barrier
    v_mfma_f32_16x16x32_bf16 v[64:67], v[224:227], a[72:75], v[64:67]
    v_mfma_f32_16x16x32_bf16 v[68:71], v[224:227], a[76:79], v[68:71]
    v_mfma_f32_16x16x32_bf16 v[72:75], v[224:227], a[200:203], v[72:75]
    ds_read_b64_tr_b16 v[192:193], v17 offset:36864
    ds_read_b64_tr_b16 v[194:195], v17 offset:41472
    v_mfma_f32_16x16x32_bf16 v[76:79], v[224:227], a[204:207], v[76:79]
    s_add_u32 s42, s42, 4096
    ds_read_b64_tr_b16 v[196:197], v18 offset:36864
    ds_read_b64_tr_b16 v[198:199], v18 offset:41472
    v_mfma_f32_16x16x32_bf16 v[80:83], v[228:231], a[72:75], v[80:83]
    buffer_load_dwordx4 a[24:27], v16, s[16:19], s41 offen offset:3072 sc1
    v_mfma_f32_16x16x32_bf16 v[84:87], v[228:231], a[76:79], v[84:87]
    ds_read_b64_tr_b16 v[200:201], v19 offset:36864
    ds_read_b64_tr_b16 v[202:203], v19 offset:41472
    v_mfma_f32_16x16x32_bf16 v[88:91], v[228:231], a[200:203], v[88:91]
    ds_read_b64_tr_b16 v[204:205], v20 offset:36864
    ds_read_b64_tr_b16 v[206:207], v20 offset:41472
    v_mfma_f32_16x16x32_bf16 v[92:95], v[228:231], a[204:207], v[92:95]
    v_mfma_f32_16x16x32_bf16 v[96:99], v[232:235], a[72:75], v[96:99]
    ds_read_b64_tr_b16 v[208:209], v17 offset:36992
    ds_read_b64_tr_b16 v[210:211], v17 offset:41600
    v_mfma_f32_16x16x32_bf16 v[100:103], v[232:235], a[76:79], v[100:103]
    buffer_load_dwordx4 a[28:31], v2, s[16:19], s41 offen offset:3072 sc1
    v_mfma_f32_16x16x32_bf16 v[104:107], v[232:235], a[200:203], v[104:107]
    ds_read_b64_tr_b16 v[212:213], v18 offset:36992
    ds_read_b64_tr_b16 v[214:215], v18 offset:41600
    v_mfma_f32_16x16x32_bf16 v[108:111], v[232:235], a[204:207], v[108:111]
    ds_read_b64_tr_b16 v[216:217], v19 offset:36992
    ds_read_b64_tr_b16 v[218:219], v19 offset:41600
    v_mfma_f32_16x16x32_bf16 v[112:115], v[236:239], a[72:75], v[112:115]
    v_mfma_f32_16x16x32_bf16 v[116:119], v[236:239], a[76:79], v[116:119]
    s_add_u32 s41, s41, 4096
    s_add_u32 m0, s59, 145408
    ds_read_b64_tr_b16 v[220:221], v20 offset:36992
    ds_read_b64_tr_b16 v[222:223], v20 offset:41600
    v_mfma_f32_16x16x32_bf16 v[120:123], v[236:239], a[200:203], v[120:123]
    buffer_load_dwordx4 v0, s[8:11], s40 offen offset:0 lds
    v_mfma_f32_16x16x32_bf16 v[124:127], v[236:239], a[204:207], v[124:127]
    v_mfma_f32_16x16x32_bf16 v[128:131], v[240:243], a[72:75], v[128:131]
    v_mfma_f32_16x16x32_bf16 v[132:135], v[240:243], a[76:79], v[132:135]
    v_mfma_f32_16x16x32_bf16 v[136:139], v[240:243], a[200:203], v[136:139]
    buffer_load_dwordx4 v1, s[8:11], s40 offen offset:1152 lds
    v_mfma_f32_16x16x32_bf16 v[140:143], v[240:243], a[204:207], v[140:143]
    v_mfma_f32_16x16x32_bf16 v[144:147], v[244:247], a[72:75], v[144:147]
    v_mfma_f32_16x16x32_bf16 v[148:151], v[244:247], a[76:79], v[148:151]
    s_add_u32 s40, s40, 65536
    v_mfma_f32_16x16x32_bf16 v[152:155], v[244:247], a[200:203], v[152:155]
    buffer_load_dwordx4 a[160:163], v16, s[16:19], s42 offen offset:0 sc1
    v_mfma_f32_16x16x32_bf16 v[156:159], v[244:247], a[204:207], v[156:159]
    v_mfma_f32_16x16x32_bf16 v[160:163], v[248:251], a[72:75], v[160:163]
    v_mfma_f32_16x16x32_bf16 v[164:167], v[248:251], a[76:79], v[164:167]
    v_mfma_f32_16x16x32_bf16 v[168:171], v[248:251], a[200:203], v[168:171]
    buffer_load_dwordx4 a[164:167], v2, s[16:19], s42 offen offset:0 sc1
    v_mfma_f32_16x16x32_bf16 v[172:175], v[248:251], a[204:207], v[172:175]
    v_mfma_f32_16x16x32_bf16 v[176:179], v[252:255], a[72:75], v[176:179]
    v_mfma_f32_16x16x32_bf16 v[180:183], v[252:255], a[76:79], v[180:183]
    v_mfma_f32_16x16x32_bf16 v[184:187], v[252:255], a[200:203], v[184:187]
    buffer_load_dwordx4 a[32:35], v16, s[16:19], s41 offen offset:0 sc1
    v_mfma_f32_16x16x32_bf16 v[188:191], v[252:255], a[204:207], v[188:191]
    s_waitcnt lgkmcnt(0)
    v_mfma_f32_16x16x32_bf16 v[64:67], v[192:195], a[80:83], v[64:67]
    v_mfma_f32_16x16x32_bf16 v[68:71], v[192:195], a[84:87], v[68:71]
    v_mfma_f32_16x16x32_bf16 v[72:75], v[192:195], a[208:211], v[72:75]
gated_mix__ssm_conv_h3__compressed_kv_cla__prompt_kernel_pad13:
    s_cbranch_execz gated_mix__ssm_conv_h3__compressed_kv_cla__prompt_kernel_pad21
    ds_read_b64_tr_b16 v[224:225], v17 offset:46080
    ds_read_b64_tr_b16 v[226:227], v17 offset:50688
    v_mfma_f32_16x16x32_bf16 v[76:79], v[192:195], a[212:215], v[76:79]
    ds_read_b64_tr_b16 v[228:229], v18 offset:46080
    ds_read_b64_tr_b16 v[230:231], v18 offset:50688
    v_mfma_f32_16x16x32_bf16 v[80:83], v[196:199], a[80:83], v[80:83]
    buffer_load_dwordx4 a[36:39], v2, s[16:19], s41 offen offset:0 sc1
    v_mfma_f32_16x16x32_bf16 v[84:87], v[196:199], a[84:87], v[84:87]
    ds_read_b64_tr_b16 v[232:233], v19 offset:46080
    ds_read_b64_tr_b16 v[234:235], v19 offset:50688
    v_mfma_f32_16x16x32_bf16 v[88:91], v[196:199], a[208:211], v[88:91]
    ds_read_b64_tr_b16 v[236:237], v20 offset:46080
    ds_read_b64_tr_b16 v[238:239], v20 offset:50688
    v_mfma_f32_16x16x32_bf16 v[92:95], v[196:199], a[212:215], v[92:95]
    v_mfma_f32_16x16x32_bf16 v[96:99], v[200:203], a[80:83], v[96:99]
    s_add_u32 m0, s59, 154624
    ds_read_b64_tr_b16 v[240:241], v17 offset:46208
    ds_read_b64_tr_b16 v[242:243], v17 offset:50816
    v_mfma_f32_16x16x32_bf16 v[100:103], v[200:203], a[84:87], v[100:103]
    buffer_load_dwordx4 v0, s[8:11], s40 offen offset:0 lds
    v_mfma_f32_16x16x32_bf16 v[104:107], v[200:203], a[208:211], v[104:107]
    ds_read_b64_tr_b16 v[244:245], v18 offset:46208
    ds_read_b64_tr_b16 v[246:247], v18 offset:50816
    v_mfma_f32_16x16x32_bf16 v[108:111], v[200:203], a[212:215], v[108:111]
    ds_read_b64_tr_b16 v[248:249], v19 offset:46208
    ds_read_b64_tr_b16 v[250:251], v19 offset:50816
    v_mfma_f32_16x16x32_bf16 v[112:115], v[204:207], a[80:83], v[112:115]
    v_add_u32 v13, s53, v13
    v_lshrrev_b32 v15, 8, v16
    v_mfma_f32_16x16x32_bf16 v[116:119], v[204:207], a[84:87], v[116:119]
    ds_read_b64_tr_b16 v[252:253], v20 offset:46208
    ds_read_b64_tr_b16 v[254:255], v20 offset:50816
    v_mfma_f32_16x16x32_bf16 v[120:123], v[204:207], a[208:211], v[120:123]
    buffer_load_dwordx4 v1, s[8:11], s40 offen offset:1152 lds
    v_mfma_f32_16x16x32_bf16 v[124:127], v[204:207], a[212:215], v[124:127]
    v_lshlrev_b32 v15, 4, v15
    v_cmp_gt_u32 vcc, 256, v16
    v_mfma_f32_16x16x32_bf16 v[128:131], v[208:211], a[80:83], v[128:131]
    v_xor_b32 v15, s57, v15
    v_mfma_f32_16x16x32_bf16 v[132:135], v[208:211], a[84:87], v[132:135]
    s_add_u32 s40, s40, 65536
    v_cndmask_b32 v13, v15, v13, vcc
    v_mfma_f32_16x16x32_bf16 v[136:139], v[208:211], a[208:211], v[136:139]
    buffer_load_dwordx4 a[168:171], v16, s[16:19], s42 offen offset:1024 sc1
    v_mfma_f32_16x16x32_bf16 v[140:143], v[208:211], a[212:215], v[140:143]
    v_mfma_f32_16x16x32_bf16 v[144:147], v[212:215], a[80:83], v[144:147]
    v_mfma_f32_16x16x32_bf16 v[148:151], v[212:215], a[84:87], v[148:151]
    v_mfma_f32_16x16x32_bf16 v[152:155], v[212:215], a[208:211], v[152:155]
    buffer_load_dwordx4 a[172:175], v2, s[16:19], s42 offen offset:1024 sc1
    v_mfma_f32_16x16x32_bf16 v[156:159], v[212:215], a[212:215], v[156:159]
    v_mfma_f32_16x16x32_bf16 v[160:163], v[216:219], a[80:83], v[160:163]
    v_mfma_f32_16x16x32_bf16 v[164:167], v[216:219], a[84:87], v[164:167]
    v_mfma_f32_16x16x32_bf16 v[168:171], v[216:219], a[208:211], v[168:171]
    buffer_load_dwordx4 a[40:43], v16, s[16:19], s41 offen offset:1024 sc1
    v_mfma_f32_16x16x32_bf16 v[172:175], v[216:219], a[212:215], v[172:175]
    v_mfma_f32_16x16x32_bf16 v[176:179], v[220:223], a[80:83], v[176:179]
    v_mfma_f32_16x16x32_bf16 v[180:183], v[220:223], a[84:87], v[180:183]
    v_mfma_f32_16x16x32_bf16 v[184:187], v[220:223], a[208:211], v[184:187]
    buffer_load_dwordx4 a[44:47], v2, s[16:19], s41 offen offset:1024 sc1
    v_mfma_f32_16x16x32_bf16 v[188:191], v[220:223], a[212:215], v[188:191]
    s_waitcnt vmcnt(53) lgkmcnt(0)
    s_barrier
    v_mfma_f32_16x16x32_bf16 v[64:67], v[224:227], a[88:91], v[64:67]
    v_mfma_f32_16x16x32_bf16 v[68:71], v[224:227], a[92:95], v[68:71]
    v_mfma_f32_16x16x32_bf16 v[72:75], v[224:227], a[216:219], v[72:75]
    ds_read_b64_tr_b16 v[192:193], v17 offset:55296
    ds_read_b64_tr_b16 v[194:195], v17 offset:59904
    v_mfma_f32_16x16x32_bf16 v[76:79], v[224:227], a[220:223], v[76:79]
    ds_read_b64_tr_b16 v[196:197], v18 offset:55296
    ds_read_b64_tr_b16 v[198:199], v18 offset:59904
    v_mfma_f32_16x16x32_bf16 v[80:83], v[228:231], a[88:91], v[80:83]
    buffer_load_dword v14, v13, s[28:31], 0 offen sc1
    v_mfma_f32_16x16x32_bf16 v[84:87], v[228:231], a[92:95], v[84:87]
    ds_read_b64_tr_b16 v[200:201], v19 offset:55296
    ds_read_b64_tr_b16 v[202:203], v19 offset:59904
    v_mfma_f32_16x16x32_bf16 v[88:91], v[228:231], a[216:219], v[88:91]
    ds_read_b64_tr_b16 v[204:205], v20 offset:55296
    ds_read_b64_tr_b16 v[206:207], v20 offset:59904
    v_mfma_f32_16x16x32_bf16 v[92:95], v[228:231], a[220:223], v[92:95]
    v_mfma_f32_16x16x32_bf16 v[96:99], v[232:235], a[88:91], v[96:99]
    s_add_u32 m0, s59, 16384
    ds_read_b64_tr_b16 v[208:209], v17 offset:55424
    ds_read_b64_tr_b16 v[210:211], v17 offset:60032
    v_mfma_f32_16x16x32_bf16 v[100:103], v[232:235], a[92:95], v[100:103]
    buffer_load_dwordx4 v0, s[8:11], s40 offen offset:0 lds
    v_mfma_f32_16x16x32_bf16 v[104:107], v[232:235], a[216:219], v[104:107]
    ds_read_b64_tr_b16 v[212:213], v18 offset:55424
    ds_read_b64_tr_b16 v[214:215], v18 offset:60032
    v_mfma_f32_16x16x32_bf16 v[108:111], v[232:235], a[220:223], v[108:111]
    ds_read_b64_tr_b16 v[216:217], v19 offset:55424
    ds_read_b64_tr_b16 v[218:219], v19 offset:60032
    v_mfma_f32_16x16x32_bf16 v[112:115], v[236:239], a[88:91], v[112:115]
    v_mfma_f32_16x16x32_bf16 v[116:119], v[236:239], a[92:95], v[116:119]
    ds_read_b64_tr_b16 v[220:221], v20 offset:55424
    ds_read_b64_tr_b16 v[222:223], v20 offset:60032
    v_mfma_f32_16x16x32_bf16 v[120:123], v[236:239], a[216:219], v[120:123]
    buffer_load_dwordx4 v1, s[8:11], s40 offen offset:1152 lds
    v_mfma_f32_16x16x32_bf16 v[124:127], v[236:239], a[220:223], v[124:127]
    v_mfma_f32_16x16x32_bf16 v[128:131], v[240:243], a[88:91], v[128:131]
    v_mfma_f32_16x16x32_bf16 v[132:135], v[240:243], a[92:95], v[132:135]
    s_add_u32 s40, s40, 65536
    v_mfma_f32_16x16x32_bf16 v[136:139], v[240:243], a[216:219], v[136:139]
    buffer_load_dwordx4 a[176:179], v16, s[16:19], s42 offen offset:2048 sc1
    v_mfma_f32_16x16x32_bf16 v[140:143], v[240:243], a[220:223], v[140:143]
    v_mfma_f32_16x16x32_bf16 v[144:147], v[244:247], a[88:91], v[144:147]
    v_mfma_f32_16x16x32_bf16 v[148:151], v[244:247], a[92:95], v[148:151]
    v_mfma_f32_16x16x32_bf16 v[152:155], v[244:247], a[216:219], v[152:155]
    buffer_load_dwordx4 a[180:183], v2, s[16:19], s42 offen offset:2048 sc1
    v_mfma_f32_16x16x32_bf16 v[156:159], v[244:247], a[220:223], v[156:159]
    v_mfma_f32_16x16x32_bf16 v[160:163], v[248:251], a[88:91], v[160:163]
    v_mfma_f32_16x16x32_bf16 v[164:167], v[248:251], a[92:95], v[164:167]
    v_mfma_f32_16x16x32_bf16 v[168:171], v[248:251], a[216:219], v[168:171]
    buffer_load_dwordx4 a[48:51], v16, s[16:19], s41 offen offset:2048 sc1
    v_mfma_f32_16x16x32_bf16 v[172:175], v[248:251], a[220:223], v[172:175]
    v_mfma_f32_16x16x32_bf16 v[176:179], v[252:255], a[88:91], v[176:179]
    v_mfma_f32_16x16x32_bf16 v[180:183], v[252:255], a[92:95], v[180:183]
    v_mfma_f32_16x16x32_bf16 v[184:187], v[252:255], a[216:219], v[184:187]
    buffer_load_dwordx4 a[52:55], v2, s[16:19], s41 offen offset:2048 sc1
    v_mfma_f32_16x16x32_bf16 v[188:191], v[252:255], a[220:223], v[188:191]
    s_waitcnt lgkmcnt(0)
    v_mfma_f32_16x16x32_bf16 v[64:67], v[192:195], a[96:99], v[64:67]
    v_add_u32 v17, 64512, v17
    v_add_u32 v18, 64512, v18
    v_mfma_f32_16x16x32_bf16 v[68:71], v[192:195], a[100:103], v[68:71]
    v_add_u32 v19, 64512, v19
    v_add_u32 v20, 64512, v20
    v_mfma_f32_16x16x32_bf16 v[72:75], v[192:195], a[224:227], v[72:75]
    ds_read_b64_tr_b16 v[224:225], v17 offset:0
    ds_read_b64_tr_b16 v[226:227], v17 offset:4608
    v_mfma_f32_16x16x32_bf16 v[76:79], v[192:195], a[228:231], v[76:79]
    s_add_u32 m0, s59, 25600
    ds_read_b64_tr_b16 v[228:229], v18 offset:0
    ds_read_b64_tr_b16 v[230:231], v18 offset:4608
    v_mfma_f32_16x16x32_bf16 v[80:83], v[196:199], a[96:99], v[80:83]
    buffer_load_dwordx4 v0, s[8:11], s40 offen offset:0 lds
    v_mfma_f32_16x16x32_bf16 v[84:87], v[196:199], a[100:103], v[84:87]
    ds_read_b64_tr_b16 v[232:233], v19 offset:0
    ds_read_b64_tr_b16 v[234:235], v19 offset:4608
    v_mfma_f32_16x16x32_bf16 v[88:91], v[196:199], a[224:227], v[88:91]
    ds_read_b64_tr_b16 v[236:237], v20 offset:0
    ds_read_b64_tr_b16 v[238:239], v20 offset:4608
    v_mfma_f32_16x16x32_bf16 v[92:95], v[196:199], a[228:231], v[92:95]
    v_mfma_f32_16x16x32_bf16 v[96:99], v[200:203], a[96:99], v[96:99]
    ds_read_b64_tr_b16 v[240:241], v17 offset:128
    ds_read_b64_tr_b16 v[242:243], v17 offset:4736
    v_mfma_f32_16x16x32_bf16 v[100:103], v[200:203], a[100:103], v[100:103]
    buffer_load_dwordx4 v1, s[8:11], s40 offen offset:1152 lds
    v_mfma_f32_16x16x32_bf16 v[104:107], v[200:203], a[224:227], v[104:107]
    ds_read_b64_tr_b16 v[244:245], v18 offset:128
    ds_read_b64_tr_b16 v[246:247], v18 offset:4736
    v_mfma_f32_16x16x32_bf16 v[108:111], v[200:203], a[228:231], v[108:111]
    ds_read_b64_tr_b16 v[248:249], v19 offset:128
    ds_read_b64_tr_b16 v[250:251], v19 offset:4736
    v_mfma_f32_16x16x32_bf16 v[112:115], v[204:207], a[96:99], v[112:115]
    v_mfma_f32_16x16x32_bf16 v[116:119], v[204:207], a[100:103], v[116:119]
    s_add_u32 s40, s40, 65536
    ds_read_b64_tr_b16 v[252:253], v20 offset:128
    ds_read_b64_tr_b16 v[254:255], v20 offset:4736
    v_mfma_f32_16x16x32_bf16 v[120:123], v[204:207], a[224:227], v[120:123]
    buffer_load_dwordx4 a[184:187], v16, s[16:19], s42 offen offset:3072 sc1
    v_mfma_f32_16x16x32_bf16 v[124:127], v[204:207], a[228:231], v[124:127]
    v_mfma_f32_16x16x32_bf16 v[128:131], v[208:211], a[96:99], v[128:131]
    v_mfma_f32_16x16x32_bf16 v[132:135], v[208:211], a[100:103], v[132:135]
    v_mfma_f32_16x16x32_bf16 v[136:139], v[208:211], a[224:227], v[136:139]
    buffer_load_dwordx4 a[188:191], v2, s[16:19], s42 offen offset:3072 sc1
    v_mfma_f32_16x16x32_bf16 v[140:143], v[208:211], a[228:231], v[140:143]
    v_mfma_f32_16x16x32_bf16 v[144:147], v[212:215], a[96:99], v[144:147]
    v_mfma_f32_16x16x32_bf16 v[148:151], v[212:215], a[100:103], v[148:151]
    s_add_u32 s42, s42, 4096
    v_mfma_f32_16x16x32_bf16 v[152:155], v[212:215], a[224:227], v[152:155]
    buffer_load_dwordx4 a[56:59], v16, s[16:19], s41 offen offset:3072 sc1
    v_mfma_f32_16x16x32_bf16 v[156:159], v[212:215], a[228:231], v[156:159]
    v_mfma_f32_16x16x32_bf16 v[160:163], v[216:219], a[96:99], v[160:163]
    v_mfma_f32_16x16x32_bf16 v[164:167], v[216:219], a[100:103], v[164:167]
    v_mfma_f32_16x16x32_bf16 v[168:171], v[216:219], a[224:227], v[168:171]
    buffer_load_dwordx4 a[60:63], v2, s[16:19], s41 offen offset:3072 sc1
    v_mfma_f32_16x16x32_bf16 v[172:175], v[216:219], a[228:231], v[172:175]
    v_mfma_f32_16x16x32_bf16 v[176:179], v[220:223], a[96:99], v[176:179]
    v_mfma_f32_16x16x32_bf16 v[180:183], v[220:223], a[100:103], v[180:183]
    s_add_u32 s41, s41, 4096
    s_add_u32 m0, s59, 34816
    v_mfma_f32_16x16x32_bf16 v[184:187], v[220:223], a[224:227], v[184:187]
    buffer_load_dwordx4 v0, s[8:11], s40 offen offset:0 lds
    v_mfma_f32_16x16x32_bf16 v[188:191], v[220:223], a[228:231], v[188:191]
    buffer_load_dwordx4 v1, s[8:11], s40 offen offset:1152 lds
    s_waitcnt vmcnt(55) lgkmcnt(0)
    s_barrier
    v_mfma_f32_16x16x32_bf16 v[64:67], v[224:227], a[104:107], v[64:67]
    v_mfma_f32_16x16x32_bf16 v[68:71], v[224:227], a[108:111], v[68:71]
    v_mfma_f32_16x16x32_bf16 v[72:75], v[224:227], a[232:235], v[72:75]
    ds_read_b64_tr_b16 v[192:193], v17 offset:9216
    ds_read_b64_tr_b16 v[194:195], v17 offset:13824
    v_mfma_f32_16x16x32_bf16 v[76:79], v[224:227], a[236:239], v[76:79]
    s_add_u32 s40, s40, 65536
    ds_read_b64_tr_b16 v[196:197], v18 offset:9216
    ds_read_b64_tr_b16 v[198:199], v18 offset:13824
    v_mfma_f32_16x16x32_bf16 v[80:83], v[228:231], a[104:107], v[80:83]
    buffer_load_dwordx4 a[192:195], v16, s[16:19], s42 offen offset:0 sc1
    v_mfma_f32_16x16x32_bf16 v[84:87], v[228:231], a[108:111], v[84:87]
    ds_read_b64_tr_b16 v[200:201], v19 offset:9216
    ds_read_b64_tr_b16 v[202:203], v19 offset:13824
    v_mfma_f32_16x16x32_bf16 v[88:91], v[228:231], a[232:235], v[88:91]
    ds_read_b64_tr_b16 v[204:205], v20 offset:9216
    ds_read_b64_tr_b16 v[206:207], v20 offset:13824
    v_mfma_f32_16x16x32_bf16 v[92:95], v[228:231], a[236:239], v[92:95]
    v_mfma_f32_16x16x32_bf16 v[96:99], v[232:235], a[104:107], v[96:99]
    ds_read_b64_tr_b16 v[208:209], v17 offset:9344
    ds_read_b64_tr_b16 v[210:211], v17 offset:13952
    v_mfma_f32_16x16x32_bf16 v[100:103], v[232:235], a[108:111], v[100:103]
    buffer_load_dwordx4 a[196:199], v2, s[16:19], s42 offen offset:0 sc1
    v_mfma_f32_16x16x32_bf16 v[104:107], v[232:235], a[232:235], v[104:107]
    ds_read_b64_tr_b16 v[212:213], v18 offset:9344
    ds_read_b64_tr_b16 v[214:215], v18 offset:13952
    v_mfma_f32_16x16x32_bf16 v[108:111], v[232:235], a[236:239], v[108:111]
    ds_read_b64_tr_b16 v[216:217], v19 offset:9344
    ds_read_b64_tr_b16 v[218:219], v19 offset:13952
    v_mfma_f32_16x16x32_bf16 v[112:115], v[236:239], a[104:107], v[112:115]
    s_waitcnt vmcnt(16)
    v_cmp_ne_u32 vcc, 1, v14
    s_nop 0
    v_mfma_f32_16x16x32_bf16 v[116:119], v[236:239], a[108:111], v[116:119]
    ds_read_b64_tr_b16 v[220:221], v20 offset:9344
    ds_read_b64_tr_b16 v[222:223], v20 offset:13952
    v_mfma_f32_16x16x32_bf16 v[120:123], v[236:239], a[232:235], v[120:123]
    buffer_load_dwordx4 a[64:67], v16, s[16:19], s41 offen offset:0 sc1
    v_mfma_f32_16x16x32_bf16 v[124:127], v[236:239], a[236:239], v[124:127]
    s_cbranch_vccnz gated_mix__ssm_conv_h3__compressed_kv_cla__prompt_kernel_spin_y
gated_mix__ssm_conv_h3__compressed_kv_cla__prompt_kernel_spin_y_ret:
    v_mfma_f32_16x16x32_bf16 v[128:131], v[240:243], a[104:107], v[128:131]
    s_lshl_b32 s53, s32, 12
    v_mfma_f32_16x16x32_bf16 v[132:135], v[240:243], a[108:111], v[132:135]
    v_mfma_f32_16x16x32_bf16 v[136:139], v[240:243], a[232:235], v[136:139]
    buffer_load_dwordx4 a[68:71], v2, s[16:19], s41 offen offset:0 sc1
    v_mfma_f32_16x16x32_bf16 v[140:143], v[240:243], a[236:239], v[140:143]
    v_mfma_f32_16x16x32_bf16 v[144:147], v[244:247], a[104:107], v[144:147]
    v_mfma_f32_16x16x32_bf16 v[148:151], v[244:247], a[108:111], v[148:151]
    s_add_u32 m0, s59, 44032
    v_mfma_f32_16x16x32_bf16 v[152:155], v[244:247], a[232:235], v[152:155]
    buffer_load_dwordx4 v0, s[8:11], s40 offen offset:0 lds
    v_mfma_f32_16x16x32_bf16 v[156:159], v[244:247], a[236:239], v[156:159]
    v_mfma_f32_16x16x32_bf16 v[160:163], v[248:251], a[104:107], v[160:163]
    v_mfma_f32_16x16x32_bf16 v[164:167], v[248:251], a[108:111], v[164:167]
    v_mfma_f32_16x16x32_bf16 v[168:171], v[248:251], a[232:235], v[168:171]
    buffer_load_dwordx4 v1, s[8:11], s40 offen offset:1152 lds
    v_mfma_f32_16x16x32_bf16 v[172:175], v[248:251], a[236:239], v[172:175]
    v_mfma_f32_16x16x32_bf16 v[176:179], v[252:255], a[104:107], v[176:179]
    v_mfma_f32_16x16x32_bf16 v[180:183], v[252:255], a[108:111], v[180:183]
    s_add_u32 s40, s40, 65536
    v_mfma_f32_16x16x32_bf16 v[184:187], v[252:255], a[232:235], v[184:187]
    buffer_load_dwordx4 a[200:203], v16, s[16:19], s42 offen offset:1024 sc1
    v_mfma_f32_16x16x32_bf16 v[188:191], v[252:255], a[236:239], v[188:191]
    s_waitcnt lgkmcnt(0)
    v_mfma_f32_16x16x32_bf16 v[64:67], v[192:195], a[112:115], v[64:67]
    v_mfma_f32_16x16x32_bf16 v[68:71], v[192:195], a[116:119], v[68:71]
    v_mfma_f32_16x16x32_bf16 v[72:75], v[192:195], a[240:243], v[72:75]
    ds_read_b64_tr_b16 v[224:225], v17 offset:18432
    ds_read_b64_tr_b16 v[226:227], v17 offset:23040
    v_mfma_f32_16x16x32_bf16 v[76:79], v[192:195], a[244:247], v[76:79]
    ds_read_b64_tr_b16 v[228:229], v18 offset:18432
    ds_read_b64_tr_b16 v[230:231], v18 offset:23040
    v_mfma_f32_16x16x32_bf16 v[80:83], v[196:199], a[112:115], v[80:83]
    buffer_load_dwordx4 a[204:207], v2, s[16:19], s42 offen offset:1024 sc1
    v_mfma_f32_16x16x32_bf16 v[84:87], v[196:199], a[116:119], v[84:87]
    ds_read_b64_tr_b16 v[232:233], v19 offset:18432
    ds_read_b64_tr_b16 v[234:235], v19 offset:23040
    v_mfma_f32_16x16x32_bf16 v[88:91], v[196:199], a[240:243], v[88:91]
    ds_read_b64_tr_b16 v[236:237], v20 offset:18432
    ds_read_b64_tr_b16 v[238:239], v20 offset:23040
    v_mfma_f32_16x16x32_bf16 v[92:95], v[196:199], a[244:247], v[92:95]
    v_mfma_f32_16x16x32_bf16 v[96:99], v[200:203], a[112:115], v[96:99]
    s_add_u32 m0, s53, 0
    s_add_u32 s36, s51, 0
    ds_read_b64_tr_b16 v[240:241], v17 offset:18560
    ds_read_b64_tr_b16 v[242:243], v17 offset:23168
    v_mfma_f32_16x16x32_bf16 v[100:103], v[200:203], a[116:119], v[100:103]
    buffer_load_dwordx4 v10, s[12:15], s36 offen sc1 lds
    v_mfma_f32_16x16x32_bf16 v[104:107], v[200:203], a[240:243], v[104:107]
    ds_read_b64_tr_b16 v[244:245], v18 offset:18560
    ds_read_b64_tr_b16 v[246:247], v18 offset:23168
    v_mfma_f32_16x16x32_bf16 v[108:111], v[200:203], a[244:247], v[108:111]
    ds_read_b64_tr_b16 v[248:249], v19 offset:18560
    ds_read_b64_tr_b16 v[250:251], v19 offset:23168
    v_mfma_f32_16x16x32_bf16 v[112:115], v[204:207], a[112:115], v[112:115]
    s_mov_b32 s37, 0xffff0000
    s_waitcnt vmcnt(62)
    v_permlane16_swap_b32 v24, v26
    v_mfma_f32_16x16x32_bf16 v[116:119], v[204:207], a[116:119], v[116:119]
    s_add_u32 m0, s53, 1024
    s_add_u32 s36, s51, 8192
    ds_read_b64_tr_b16 v[252:253], v20 offset:18560
    ds_read_b64_tr_b16 v[254:255], v20 offset:23168
    v_mfma_f32_16x16x32_bf16 v[120:123], v[204:207], a[240:243], v[120:123]
    buffer_load_dwordx4 v10, s[12:15], s36 offen sc1 lds
    v_mfma_f32_16x16x32_bf16 v[124:127], v[204:207], a[244:247], v[124:127]
    v_permlane16_swap_b32 v25, v27
    v_mfma_f32_16x16x32_bf16 v[128:131], v[208:211], a[112:115], v[128:131]
    v_permlane16_swap_b32 v28, v30
    v_mfma_f32_16x16x32_bf16 v[132:135], v[208:211], a[116:119], v[132:135]
    s_add_u32 m0, s53, 2048
    s_add_u32 s36, s51, 16384
    v_permlane16_swap_b32 v29, v31
    v_mfma_f32_16x16x32_bf16 v[136:139], v[208:211], a[240:243], v[136:139]
    buffer_load_dwordx4 v10, s[12:15], s36 offen sc1 lds
    v_mfma_f32_16x16x32_bf16 v[140:143], v[208:211], a[244:247], v[140:143]
    v_permlane16_swap_b32 v32, v34
    v_mfma_f32_16x16x32_bf16 v[144:147], v[212:215], a[112:115], v[144:147]
    v_permlane16_swap_b32 v33, v35
    v_mfma_f32_16x16x32_bf16 v[148:151], v[212:215], a[116:119], v[148:151]
    s_add_u32 m0, s53, 3072
    s_add_u32 s36, s51, 24576
    v_permlane16_swap_b32 v36, v38
    v_mfma_f32_16x16x32_bf16 v[152:155], v[212:215], a[240:243], v[152:155]
    buffer_load_dwordx4 v10, s[12:15], s36 offen sc1 lds
    v_mfma_f32_16x16x32_bf16 v[156:159], v[212:215], a[244:247], v[156:159]
    v_permlane16_swap_b32 v37, v39
    v_mfma_f32_16x16x32_bf16 v[160:163], v[216:219], a[112:115], v[160:163]
    v_mfma_f32_16x16x32_bf16 v[164:167], v[216:219], a[116:119], v[164:167]
    v_mfma_f32_16x16x32_bf16 v[168:171], v[216:219], a[240:243], v[168:171]
    buffer_load_dwordx4 a[72:75], v16, s[16:19], s41 offen offset:1024 sc1
    v_mfma_f32_16x16x32_bf16 v[172:175], v[216:219], a[244:247], v[172:175]
    v_mfma_f32_16x16x32_bf16 v[176:179], v[220:223], a[112:115], v[176:179]
    v_mfma_f32_16x16x32_bf16 v[180:183], v[220:223], a[116:119], v[180:183]
    v_mfma_f32_16x16x32_bf16 v[184:187], v[220:223], a[240:243], v[184:187]
    buffer_load_dwordx4 a[76:79], v2, s[16:19], s41 offen offset:1024 sc1
    v_mfma_f32_16x16x32_bf16 v[188:191], v[220:223], a[244:247], v[188:191]
    s_waitcnt vmcnt(57) lgkmcnt(0)
    s_barrier
    v_mfma_f32_16x16x32_bf16 v[64:67], v[224:227], a[120:123], v[64:67]
    v_mfma_f32_16x16x32_bf16 v[68:71], v[224:227], a[124:127], v[68:71]
    v_mfma_f32_16x16x32_bf16 v[72:75], v[224:227], a[248:251], v[72:75]
    ds_read_b64_tr_b16 v[192:193], v17 offset:27648
    ds_read_b64_tr_b16 v[194:195], v17 offset:32256
    v_mfma_f32_16x16x32_bf16 v[76:79], v[224:227], a[252:255], v[76:79]
    s_add_u32 m0, s59, 53248
    ds_read_b64_tr_b16 v[196:197], v18 offset:27648
    ds_read_b64_tr_b16 v[198:199], v18 offset:32256
    v_mfma_f32_16x16x32_bf16 v[80:83], v[228:231], a[120:123], v[80:83]
    buffer_load_dwordx4 v0, s[8:11], s40 offen offset:0 lds
    v_mfma_f32_16x16x32_bf16 v[84:87], v[228:231], a[124:127], v[84:87]
    ds_read_b64_tr_b16 v[200:201], v19 offset:27648
    ds_read_b64_tr_b16 v[202:203], v19 offset:32256
    v_mfma_f32_16x16x32_bf16 v[88:91], v[228:231], a[248:251], v[88:91]
    ds_read_b64_tr_b16 v[204:205], v20 offset:27648
    ds_read_b64_tr_b16 v[206:207], v20 offset:32256
    v_mfma_f32_16x16x32_bf16 v[92:95], v[228:231], a[252:255], v[92:95]
    v_mfma_f32_16x16x32_bf16 v[96:99], v[232:235], a[120:123], v[96:99]
    ds_read_b64_tr_b16 v[208:209], v17 offset:27776
    ds_read_b64_tr_b16 v[210:211], v17 offset:32384
    v_mfma_f32_16x16x32_bf16 v[100:103], v[232:235], a[124:127], v[100:103]
    buffer_load_dwordx4 v1, s[8:11], s40 offen offset:1152 lds
    v_mfma_f32_16x16x32_bf16 v[104:107], v[232:235], a[248:251], v[104:107]
    ds_read_b64_tr_b16 v[212:213], v18 offset:27776
    ds_read_b64_tr_b16 v[214:215], v18 offset:32384
    v_mfma_f32_16x16x32_bf16 v[108:111], v[232:235], a[252:255], v[108:111]
    ds_read_b64_tr_b16 v[216:217], v19 offset:27776
    ds_read_b64_tr_b16 v[218:219], v19 offset:32384
    v_mfma_f32_16x16x32_bf16 v[112:115], v[236:239], a[120:123], v[112:115]
    v_mfma_f32_16x16x32_bf16 v[116:119], v[236:239], a[124:127], v[116:119]
    s_add_u32 s40, s40, 65536
    ds_read_b64_tr_b16 v[220:221], v20 offset:27776
    ds_read_b64_tr_b16 v[222:223], v20 offset:32384
    v_mfma_f32_16x16x32_bf16 v[120:123], v[236:239], a[248:251], v[120:123]
    buffer_load_dwordx4 a[208:211], v16, s[16:19], s42 offen offset:2048 sc1
    v_mfma_f32_16x16x32_bf16 v[124:127], v[236:239], a[252:255], v[124:127]
    v_mfma_f32_16x16x32_bf16 v[128:131], v[240:243], a[120:123], v[128:131]
    v_mfma_f32_16x16x32_bf16 v[132:135], v[240:243], a[124:127], v[132:135]
    v_mfma_f32_16x16x32_bf16 v[136:139], v[240:243], a[248:251], v[136:139]
    buffer_load_dwordx4 a[212:215], v2, s[16:19], s42 offen offset:2048 sc1
    v_mfma_f32_16x16x32_bf16 v[140:143], v[240:243], a[252:255], v[140:143]
    v_mfma_f32_16x16x32_bf16 v[144:147], v[244:247], a[120:123], v[144:147]
    v_mfma_f32_16x16x32_bf16 v[148:151], v[244:247], a[124:127], v[148:151]
    v_mfma_f32_16x16x32_bf16 v[152:155], v[244:247], a[248:251], v[152:155]
    buffer_load_dwordx4 a[80:83], v16, s[16:19], s41 offen offset:2048 sc1
    v_mfma_f32_16x16x32_bf16 v[156:159], v[244:247], a[252:255], v[156:159]
    v_mfma_f32_16x16x32_bf16 v[160:163], v[248:251], a[120:123], v[160:163]
    v_mfma_f32_16x16x32_bf16 v[164:167], v[248:251], a[124:127], v[164:167]
    v_mfma_f32_16x16x32_bf16 v[168:171], v[248:251], a[248:251], v[168:171]
    buffer_load_dwordx4 a[84:87], v2, s[16:19], s41 offen offset:2048 sc1
    v_mfma_f32_16x16x32_bf16 v[172:175], v[248:251], a[252:255], v[172:175]
    v_mfma_f32_16x16x32_bf16 v[176:179], v[252:255], a[120:123], v[176:179]
    v_mfma_f32_16x16x32_bf16 v[180:183], v[252:255], a[124:127], v[180:183]
    s_add_u32 m0, s59, 62464
    v_mfma_f32_16x16x32_bf16 v[184:187], v[252:255], a[248:251], v[184:187]
    buffer_load_dwordx4 v0, s[8:11], s40 offen offset:0 lds
    v_mfma_f32_16x16x32_bf16 v[188:191], v[252:255], a[252:255], v[188:191]
    s_waitcnt lgkmcnt(0)
    v_mfma_f32_16x16x32_bf16 v[64:67], v[192:195], a[0:3], v[64:67]
    ds_read_b64_tr_b16 v[224:225], v17 offset:36864
    ds_read_b64_tr_b16 v[226:227], v17 offset:41472
    v_mfma_f32_16x16x32_bf16 v[68:71], v[192:195], a[4:7], v[68:71]
    buffer_load_dwordx4 v1, s[8:11], s40 offen offset:1152 lds
    v_mfma_f32_16x16x32_bf16 v[72:75], v[192:195], a[128:131], v[72:75]
    ds_read_b64_tr_b16 v[228:229], v18 offset:36864
    ds_read_b64_tr_b16 v[230:231], v18 offset:41472
    v_mfma_f32_16x16x32_bf16 v[76:79], v[192:195], a[132:135], v[76:79]
    v_mfma_f32_16x16x32_bf16 v[80:83], v[196:199], a[0:3], v[80:83]
    v_mfma_f32_16x16x32_bf16 v[84:87], v[196:199], a[4:7], v[84:87]
    s_add_u32 s40, s40, 65536
    buffer_load_dwordx4 a[216:219], v16, s[16:19], s42 offen offset:3072 sc1
    v_mfma_f32_16x16x32_bf16 v[88:91], v[196:199], a[128:131], v[88:91]
    v_mfma_f32_16x16x32_bf16 v[92:95], v[196:199], a[132:135], v[92:95]
    buffer_load_dwordx4 a[220:223], v2, s[16:19], s42 offen offset:3072 sc1
    s_waitcnt vmcnt(12) lgkmcnt(0)
    s_barrier
    v_mfma_f32_16x16x32_bf16 v[64:67], v[224:227], a[8:11], v[64:67]
    ds_read_b64_tr_b16 v[192:193], v17 offset:46080
    ds_read_b64_tr_b16 v[194:195], v17 offset:50688
    v_mfma_f32_16x16x32_bf16 v[68:71], v[224:227], a[12:15], v[68:71]
    s_add_u32 s42, s42, 4096
    buffer_load_dwordx4 a[88:91], v16, s[16:19], s41 offen offset:3072 sc1
    v_mfma_f32_16x16x32_bf16 v[72:75], v[224:227], a[136:139], v[72:75]
    ds_read_b64_tr_b16 v[196:197], v18 offset:46080
    ds_read_b64_tr_b16 v[198:199], v18 offset:50688
    v_mfma_f32_16x16x32_bf16 v[76:79], v[224:227], a[140:143], v[76:79]
    ds_read_b64_tr_b16 v[48:49], v22 offset:0
    ds_read_b64_tr_b16 v[50:51], v22 offset:128
    v_mfma_f32_16x16x32_bf16 v[80:83], v[228:231], a[8:11], v[80:83]
    ds_read_b64_tr_b16 v[52:53], v22 offset:256
    ds_read_b64_tr_b16 v[54:55], v22 offset:384
    v_mfma_f32_16x16x32_bf16 v[84:87], v[228:231], a[12:15], v[84:87]
    buffer_load_dwordx4 a[92:95], v2, s[16:19], s41 offen offset:3072 sc1
    v_mfma_f32_16x16x32_bf16 v[88:91], v[228:231], a[136:139], v[88:91]
    ds_read_b64_tr_b16 v[56:57], v22 offset:8192
    ds_read_b64_tr_b16 v[58:59], v22 offset:8320
    v_mfma_f32_16x16x32_bf16 v[92:95], v[228:231], a[140:143], v[92:95]
    s_waitcnt lgkmcnt(0)
    ds_read_b64_tr_b16 v[60:61], v22 offset:8448
    ds_read_b64_tr_b16 v[62:63], v22 offset:8576
    v_mfma_f32_16x16x32_bf16 v[64:67], v[192:195], a[16:19], v[64:67]
    ds_read_b64_tr_b16 v[224:225], v17 offset:55296
    ds_read_b64_tr_b16 v[226:227], v17 offset:59904
    v_mfma_f32_16x16x32_bf16 v[68:71], v[192:195], a[20:23], v[68:71]
    s_add_u32 s41, s41, 4096
    s_add_u32 m0, s59, 71680
    s_nop 0
    buffer_load_dwordx4 v0, s[8:11], s40 offen offset:0 lds
    v_mfma_f32_16x16x32_bf16 v[72:75], v[192:195], a[144:147], v[72:75]
    ds_read_b64_tr_b16 v[228:229], v18 offset:55296
    ds_read_b64_tr_b16 v[230:231], v18 offset:59904
    v_mfma_f32_16x16x32_bf16 v[76:79], v[192:195], a[148:151], v[76:79]
    v_mfma_f32_16x16x32_bf16 v[80:83], v[196:199], a[16:19], v[80:83]
    v_mfma_f32_16x16x32_bf16 v[84:87], v[196:199], a[20:23], v[84:87]
    buffer_load_dwordx4 v1, s[8:11], s40 offen offset:1152 lds
    v_mfma_f32_16x16x32_bf16 v[88:91], v[196:199], a[144:147], v[88:91]
    v_mfma_f32_16x16x32_bf16 v[92:95], v[196:199], a[148:151], v[92:95]
    s_waitcnt lgkmcnt(0)
    v_lshlrev_b32 v3, 16, v24
    v_lshlrev_b32 v4, 16, v48
    s_waitcnt vmcnt(47) lgkmcnt(0)
    s_barrier
    v_mfma_f32_16x16x32_bf16 v[64:67], v[224:227], a[24:27], v[64:67]
    v_add_u32 v17, 64512, v17
    v_add_u32 v18, 64512, v18
    v_mfma_f32_16x16x32_bf16 v[68:71], v[224:227], a[28:31], v[68:71]
    v_add_u32 v19, 64512, v19
    v_add_u32 v20, 64512, v20
    v_mfma_f32_16x16x32_bf16 v[72:75], v[224:227], a[152:155], v[72:75]
    ds_read_b64_tr_b16 v[192:193], v17 offset:0
    ds_read_b64_tr_b16 v[194:195], v17 offset:4608
    v_mfma_f32_16x16x32_bf16 v[76:79], v[224:227], a[156:159], v[76:79]
    ds_read_b64_tr_b16 v[196:197], v18 offset:0
    ds_read_b64_tr_b16 v[198:199], v18 offset:4608
    v_mfma_f32_16x16x32_bf16 v[80:83], v[228:231], a[24:27], v[80:83]
    s_add_u32 s40, s40, 65536
    buffer_load_dwordx4 a[224:227], v16, s[16:19], s42 offen offset:0 sc1
    v_mfma_f32_16x16x32_bf16 v[84:87], v[228:231], a[28:31], v[84:87]
    buffer_load_dwordx4 a[228:231], v2, s[16:19], s42 offen offset:0 sc1
    v_mfma_f32_16x16x32_bf16 v[88:91], v[228:231], a[152:155], v[88:91]
    v_mul_f32 v3, v3, v4
    v_mul_f32 v40, v6, v3
    v_mfma_f32_16x16x32_bf16 v[92:95], v[228:231], a[156:159], v[92:95]
    s_waitcnt lgkmcnt(0)
    v_and_b32 v3, s37, v24
    v_and_b32 v4, s37, v48
    v_mfma_f32_16x16x32_bf16 v[64:67], v[192:195], a[32:35], v[64:67]
    ds_read_b64_tr_b16 v[224:225], v17 offset:9216
    ds_read_b64_tr_b16 v[226:227], v17 offset:13824
    v_mfma_f32_16x16x32_bf16 v[68:71], v[192:195], a[36:39], v[68:71]
    buffer_load_dwordx4 a[96:99], v16, s[16:19], s41 offen offset:0 sc1
    v_mfma_f32_16x16x32_bf16 v[72:75], v[192:195], a[160:163], v[72:75]
    ds_read_b64_tr_b16 v[228:229], v18 offset:9216
    ds_read_b64_tr_b16 v[230:231], v18 offset:13824
    v_mfma_f32_16x16x32_bf16 v[76:79], v[192:195], a[164:167], v[76:79]
    v_mul_f32 v3, v3, v4
    v_mul_f32 v41, v6, v3
    v_mfma_f32_16x16x32_bf16 v[80:83], v[196:199], a[32:35], v[80:83]
    v_lshlrev_b32 v3, 16, v25
    v_lshlrev_b32 v4, 16, v49
    v_mfma_f32_16x16x32_bf16 v[84:87], v[196:199], a[36:39], v[84:87]
    buffer_load_dwordx4 a[100:103], v2, s[16:19], s41 offen offset:0 sc1
    v_mfma_f32_16x16x32_bf16 v[88:91], v[196:199], a[160:163], v[88:91]
    v_mul_f32 v3, v3, v4
    v_mul_f32 v42, v6, v3
    v_mfma_f32_16x16x32_bf16 v[92:95], v[196:199], a[164:167], v[92:95]
    v_and_b32 v3, s37, v25
    v_and_b32 v4, s37, v49
    s_waitcnt vmcnt(38) lgkmcnt(0)
    s_barrier
    v_mfma_f32_16x16x32_bf16 v[64:67], v[224:227], a[40:43], v[64:67]
    v_add_u32 v17, 4294838272, v17
    v_add_u32 v18, 4294838272, v18
    v_mfma_f32_16x16x32_bf16 v[68:71], v[224:227], a[44:47], v[68:71]
    v_add_u32 v19, 4294838272, v19
    v_add_u32 v20, 4294838272, v20
    v_mfma_f32_16x16x32_bf16 v[72:75], v[224:227], a[168:171], v[72:75]
    ds_read_b64_tr_b16 v[192:193], v17 offset:0
    ds_read_b64_tr_b16 v[194:195], v17 offset:4608
    v_mfma_f32_16x16x32_bf16 v[76:79], v[224:227], a[172:175], v[76:79]
    ds_read_b64_tr_b16 v[196:197], v18 offset:0
    ds_read_b64_tr_b16 v[198:199], v18 offset:4608
    v_mfma_f32_16x16x32_bf16 v[80:83], v[228:231], a[40:43], v[80:83]
    s_add_u32 m0, s59, 80896
    s_nop 0
    buffer_load_dwordx4 v0, s[8:11], s40 offen offset:0 lds
    v_mfma_f32_16x16x32_bf16 v[84:87], v[228:231], a[44:47], v[84:87]
    buffer_load_dwordx4 v1, s[8:11], s40 offen offset:1152 lds
    v_mfma_f32_16x16x32_bf16 v[88:91], v[228:231], a[168:171], v[88:91]
    v_mul_f32 v3, v3, v4
    v_mul_f32 v43, v6, v3
    v_mfma_f32_16x16x32_bf16 v[92:95], v[228:231], a[172:175], v[92:95]
    s_waitcnt lgkmcnt(0)
    v_lshlrev_b32 v3, 16, v28
    v_lshlrev_b32 v4, 16, v50
    v_mfma_f32_16x16x32_bf16 v[64:67], v[192:195], a[48:51], v[64:67]
    ds_read_b64_tr_b16 v[224:225], v17 offset:9216
    ds_read_b64_tr_b16 v[226:227], v17 offset:13824
    v_mfma_f32_16x16x32_bf16 v[68:71], v[192:195], a[52:55], v[68:71]
    s_add_u32 s40, s40, 65536
    buffer_load_dwordx4 a[232:235], v16, s[16:19], s42 offen offset:1024 sc1
    v_mfma_f32_16x16x32_bf16 v[72:75], v[192:195], a[176:179], v[72:75]
    ds_read_b64_tr_b16 v[228:229], v18 offset:9216
    ds_read_b64_tr_b16 v[230:231], v18 offset:13824
    v_mfma_f32_16x16x32_bf16 v[76:79], v[192:195], a[180:183], v[76:79]
    v_mul_f32 v3, v3, v4
    v_mul_f32 v44, v7, v3
    v_mfma_f32_16x16x32_bf16 v[80:83], v[196:199], a[48:51], v[80:83]
    v_and_b32 v3, s37, v28
    v_and_b32 v4, s37, v50
    v_mfma_f32_16x16x32_bf16 v[84:87], v[196:199], a[52:55], v[84:87]
    buffer_load_dwordx4 a[236:239], v2, s[16:19], s42 offen offset:1024 sc1
    v_mfma_f32_16x16x32_bf16 v[88:91], v[196:199], a[176:179], v[88:91]
    v_mul_f32 v3, v3, v4
    v_mul_f32 v45, v7, v3
    v_mfma_f32_16x16x32_bf16 v[92:95], v[196:199], a[180:183], v[92:95]
    v_lshlrev_b32 v3, 16, v29
    v_lshlrev_b32 v4, 16, v51
    s_waitcnt vmcnt(30) lgkmcnt(0)
    s_barrier
    v_mfma_f32_16x16x32_bf16 v[64:67], v[224:227], a[56:59], v[64:67]
gated_mix__ssm_conv_h3__compressed_kv_cla__prompt_kernel_pad14:
    s_cbranch_execz gated_mix__ssm_conv_h3__compressed_kv_cla__prompt_kernel_pad22
    ds_read_b64_tr_b16 v[192:193], v17 offset:18432
    ds_read_b64_tr_b16 v[194:195], v17 offset:23040
    v_mfma_f32_16x16x32_bf16 v[68:71], v[224:227], a[60:63], v[68:71]
    buffer_load_dwordx4 a[104:107], v16, s[16:19], s41 offen offset:1024 sc1
    v_mfma_f32_16x16x32_bf16 v[72:75], v[224:227], a[184:187], v[72:75]
    ds_read_b64_tr_b16 v[196:197], v18 offset:18432
    ds_read_b64_tr_b16 v[198:199], v18 offset:23040
    v_mfma_f32_16x16x32_bf16 v[76:79], v[224:227], a[188:191], v[76:79]
    v_mul_f32 v3, v3, v4
    v_mul_f32 v46, v7, v3
    v_mfma_f32_16x16x32_bf16 v[80:83], v[228:231], a[56:59], v[80:83]
    v_and_b32 v3, s37, v29
    v_and_b32 v4, s37, v51
    v_mfma_f32_16x16x32_bf16 v[84:87], v[228:231], a[60:63], v[84:87]
    buffer_load_dwordx4 a[108:111], v2, s[16:19], s41 offen offset:1024 sc1
    v_mfma_f32_16x16x32_bf16 v[88:91], v[228:231], a[184:187], v[88:91]
    v_mul_f32 v3, v3, v4
    v_mul_f32 v47, v7, v3
    v_mfma_f32_16x16x32_bf16 v[92:95], v[228:231], a[188:191], v[92:95]
    s_waitcnt lgkmcnt(0)
    v_lshlrev_b32 v3, 16, v32
    v_lshlrev_b32 v4, 16, v52
    v_mfma_f32_16x16x32_bf16 v[64:67], v[192:195], a[64:67], v[64:67]
    ds_read_b64_tr_b16 v[224:225], v17 offset:27648
    ds_read_b64_tr_b16 v[226:227], v17 offset:32256
    v_mfma_f32_16x16x32_bf16 v[68:71], v[192:195], a[68:71], v[68:71]
    s_add_u32 m0, s59, 90112
    s_nop 0
    buffer_load_dwordx4 v0, s[8:11], s40 offen offset:0 lds
    v_mfma_f32_16x16x32_bf16 v[72:75], v[192:195], a[192:195], v[72:75]
    ds_read_b64_tr_b16 v[228:229], v18 offset:27648
    ds_read_b64_tr_b16 v[230:231], v18 offset:32256
    v_mfma_f32_16x16x32_bf16 v[76:79], v[192:195], a[196:199], v[76:79]
    v_mul_f32 v3, v3, v4
    v_mul_f32 v48, v11, v3
    v_mfma_f32_16x16x32_bf16 v[80:83], v[196:199], a[64:67], v[80:83]
    v_and_b32 v3, s37, v32
    v_and_b32 v4, s37, v52
    v_mfma_f32_16x16x32_bf16 v[84:87], v[196:199], a[68:71], v[84:87]
    buffer_load_dwordx4 v1, s[8:11], s40 offen offset:1152 lds
    v_mfma_f32_16x16x32_bf16 v[88:91], v[196:199], a[192:195], v[88:91]
    v_mul_f32 v3, v3, v4
    v_mul_f32 v49, v11, v3
    v_mfma_f32_16x16x32_bf16 v[92:95], v[196:199], a[196:199], v[92:95]
    v_lshlrev_b32 v3, 16, v33
    v_lshlrev_b32 v4, 16, v53
    s_waitcnt vmcnt(18) lgkmcnt(0)
    s_barrier
    v_mfma_f32_16x16x32_bf16 v[64:67], v[224:227], a[72:75], v[64:67]
    ds_read_b64_tr_b16 v[192:193], v17 offset:36864
    ds_read_b64_tr_b16 v[194:195], v17 offset:41472
    v_mfma_f32_16x16x32_bf16 v[68:71], v[224:227], a[76:79], v[68:71]
    s_add_u32 s40, s40, 65536
    buffer_load_dwordx4 a[240:243], v16, s[16:19], s42 offen offset:2048 sc1
    v_mfma_f32_16x16x32_bf16 v[72:75], v[224:227], a[200:203], v[72:75]
    ds_read_b64_tr_b16 v[196:197], v18 offset:36864
    ds_read_b64_tr_b16 v[198:199], v18 offset:41472
    v_mfma_f32_16x16x32_bf16 v[76:79], v[224:227], a[204:207], v[76:79]
    v_mul_f32 v3, v3, v4
    v_mul_f32 v50, v11, v3
    v_mfma_f32_16x16x32_bf16 v[80:83], v[228:231], a[72:75], v[80:83]
    v_and_b32 v3, s37, v33
    v_and_b32 v4, s37, v53
    v_mfma_f32_16x16x32_bf16 v[84:87], v[228:231], a[76:79], v[84:87]
    buffer_load_dwordx4 a[244:247], v2, s[16:19], s42 offen offset:2048 sc1
    v_mfma_f32_16x16x32_bf16 v[88:91], v[228:231], a[200:203], v[88:91]
    v_mul_f32 v3, v3, v4
    v_mul_f32 v51, v11, v3
    v_mfma_f32_16x16x32_bf16 v[92:95], v[228:231], a[204:207], v[92:95]
    s_waitcnt lgkmcnt(0)
    v_lshlrev_b32 v3, 16, v36
    v_lshlrev_b32 v4, 16, v54
    v_mfma_f32_16x16x32_bf16 v[64:67], v[192:195], a[80:83], v[64:67]
    ds_read_b64_tr_b16 v[224:225], v17 offset:46080
    ds_read_b64_tr_b16 v[226:227], v17 offset:50688
    v_mfma_f32_16x16x32_bf16 v[68:71], v[192:195], a[84:87], v[68:71]
    buffer_load_dwordx4 a[112:115], v16, s[16:19], s41 offen offset:2048 sc1
    v_mfma_f32_16x16x32_bf16 v[72:75], v[192:195], a[208:211], v[72:75]
    ds_read_b64_tr_b16 v[228:229], v18 offset:46080
    ds_read_b64_tr_b16 v[230:231], v18 offset:50688
    v_mfma_f32_16x16x32_bf16 v[76:79], v[192:195], a[212:215], v[76:79]
    v_mul_f32 v3, v3, v4
    v_mul_f32 v52, v12, v3
    v_mfma_f32_16x16x32_bf16 v[80:83], v[196:199], a[80:83], v[80:83]
    v_and_b32 v3, s37, v36
    v_and_b32 v4, s37, v54
    v_mfma_f32_16x16x32_bf16 v[84:87], v[196:199], a[84:87], v[84:87]
    buffer_load_dwordx4 a[116:119], v2, s[16:19], s41 offen offset:2048 sc1
    v_mfma_f32_16x16x32_bf16 v[88:91], v[196:199], a[208:211], v[88:91]
    v_mul_f32 v3, v3, v4
    v_mul_f32 v53, v12, v3
    v_mfma_f32_16x16x32_bf16 v[92:95], v[196:199], a[212:215], v[92:95]
    v_lshlrev_b32 v3, 16, v37
    v_lshlrev_b32 v4, 16, v55
    s_waitcnt vmcnt(10) lgkmcnt(0)
    s_barrier
    v_mfma_f32_16x16x32_bf16 v[64:67], v[224:227], a[88:91], v[64:67]
    ds_read_b64_tr_b16 v[192:193], v17 offset:55296
    ds_read_b64_tr_b16 v[194:195], v17 offset:59904
    v_mfma_f32_16x16x32_bf16 v[68:71], v[224:227], a[92:95], v[68:71]
    s_add_u32 m0, s59, 99328
    s_nop 0
    buffer_load_dwordx4 v0, s[8:11], s40 offen offset:0 lds
    v_mfma_f32_16x16x32_bf16 v[72:75], v[224:227], a[216:219], v[72:75]
    ds_read_b64_tr_b16 v[196:197], v18 offset:55296
    ds_read_b64_tr_b16 v[198:199], v18 offset:59904
    v_mfma_f32_16x16x32_bf16 v[76:79], v[224:227], a[220:223], v[76:79]
    v_mul_f32 v3, v3, v4
    v_mul_f32 v54, v12, v3
    v_mfma_f32_16x16x32_bf16 v[80:83], v[228:231], a[88:91], v[80:83]
    v_and_b32 v3, s37, v37
    v_and_b32 v4, s37, v55
    v_mfma_f32_16x16x32_bf16 v[84:87], v[228:231], a[92:95], v[84:87]
    buffer_load_dwordx4 v1, s[8:11], s40 offen offset:1152 lds
    v_mfma_f32_16x16x32_bf16 v[88:91], v[228:231], a[216:219], v[88:91]
    v_mul_f32 v3, v3, v4
    v_mul_f32 v55, v12, v3
    v_mfma_f32_16x16x32_bf16 v[92:95], v[228:231], a[220:223], v[92:95]
    s_waitcnt lgkmcnt(0)
    v_lshlrev_b32 v3, 16, v26
    v_lshlrev_b32 v4, 16, v56
    v_mfma_f32_16x16x32_bf16 v[64:67], v[192:195], a[96:99], v[64:67]
    v_add_u32 v17, 64512, v17
    v_add_u32 v18, 64512, v18
    v_mfma_f32_16x16x32_bf16 v[68:71], v[192:195], a[100:103], v[68:71]
    v_add_u32 v19, 64512, v19
    v_add_u32 v20, 64512, v20
    v_mfma_f32_16x16x32_bf16 v[72:75], v[192:195], a[224:227], v[72:75]
    ds_read_b64_tr_b16 v[224:225], v17 offset:0
    ds_read_b64_tr_b16 v[226:227], v17 offset:4608
    v_mfma_f32_16x16x32_bf16 v[76:79], v[192:195], a[228:231], v[76:79]
    ds_read_b64_tr_b16 v[228:229], v18 offset:0
    ds_read_b64_tr_b16 v[230:231], v18 offset:4608
    v_mfma_f32_16x16x32_bf16 v[80:83], v[196:199], a[96:99], v[80:83]
    s_add_u32 s40, s40, 65536
    buffer_load_dwordx4 a[248:251], v16, s[16:19], s42 offen offset:3072 sc1
    v_mfma_f32_16x16x32_bf16 v[84:87], v[196:199], a[100:103], v[84:87]
    buffer_load_dwordx4 a[252:255], v2, s[16:19], s42 offen offset:3072 sc1
    v_mfma_f32_16x16x32_bf16 v[88:91], v[196:199], a[224:227], v[88:91]
    v_mul_f32 v3, v3, v4
    v_mul_f32 v24, v6, v3
    v_mfma_f32_16x16x32_bf16 v[92:95], v[196:199], a[228:231], v[92:95]
    v_and_b32 v3, s37, v26
    v_and_b32 v4, s37, v56
    s_waitcnt vmcnt(2) lgkmcnt(0)
    s_barrier
    v_mfma_f32_16x16x32_bf16 v[64:67], v[224:227], a[104:107], v[64:67]
    ds_read_b64_tr_b16 v[192:193], v17 offset:9216
    ds_read_b64_tr_b16 v[194:195], v17 offset:13824
    v_mfma_f32_16x16x32_bf16 v[68:71], v[224:227], a[108:111], v[68:71]
    s_add_u32 s42, s42, 4096
    buffer_load_dwordx4 a[120:123], v16, s[16:19], s41 offen offset:3072 sc1
    v_mfma_f32_16x16x32_bf16 v[72:75], v[224:227], a[232:235], v[72:75]
    ds_read_b64_tr_b16 v[196:197], v18 offset:9216
    ds_read_b64_tr_b16 v[198:199], v18 offset:13824
    v_mfma_f32_16x16x32_bf16 v[76:79], v[224:227], a[236:239], v[76:79]
    v_mul_f32 v3, v3, v4
    v_mul_f32 v25, v6, v3
    v_mfma_f32_16x16x32_bf16 v[80:83], v[228:231], a[104:107], v[80:83]
    v_lshlrev_b32 v3, 16, v27
    v_lshlrev_b32 v4, 16, v57
    v_mfma_f32_16x16x32_bf16 v[84:87], v[228:231], a[108:111], v[84:87]
    buffer_load_dwordx4 a[124:127], v2, s[16:19], s41 offen offset:3072 sc1
    v_mfma_f32_16x16x32_bf16 v[88:91], v[228:231], a[232:235], v[88:91]
    v_mul_f32 v3, v3, v4
    v_mul_f32 v28, v6, v3
    v_mfma_f32_16x16x32_bf16 v[92:95], v[228:231], a[236:239], v[92:95]
    s_waitcnt lgkmcnt(0)
    v_and_b32 v3, s37, v27
    v_and_b32 v4, s37, v57
    v_mfma_f32_16x16x32_bf16 v[64:67], v[192:195], a[112:115], v[64:67]
    ds_read_b64_tr_b16 v[224:225], v17 offset:18432
    ds_read_b64_tr_b16 v[226:227], v17 offset:23040
    v_mfma_f32_16x16x32_bf16 v[68:71], v[192:195], a[116:119], v[68:71]
    s_add_u32 s41, s41, 4096
    s_add_u32 s16, s94, 67108864
    s_addc_u32 s17, s95, 0
    s_mov_b32 s18, 16777216
    v_mul_f32 v3, v3, v4
    v_mul_f32 v29, v6, v3
    v_mfma_f32_16x16x32_bf16 v[72:75], v[192:195], a[240:243], v[72:75]
    ds_read_b64_tr_b16 v[228:229], v18 offset:18432
    ds_read_b64_tr_b16 v[230:231], v18 offset:23040
    v_mfma_f32_16x16x32_bf16 v[76:79], v[192:195], a[244:247], v[76:79]
    v_lshlrev_b32 v3, 16, v30
    v_lshlrev_b32 v4, 16, v58
    v_mfma_f32_16x16x32_bf16 v[80:83], v[196:199], a[112:115], v[80:83]
    v_mul_f32 v3, v3, v4
    v_mul_f32 v32, v7, v3
    v_mfma_f32_16x16x32_bf16 v[84:87], v[196:199], a[116:119], v[84:87]
    v_and_b32 v3, s37, v30
    v_and_b32 v4, s37, v58
    v_mfma_f32_16x16x32_bf16 v[88:91], v[196:199], a[240:243], v[88:91]
    v_mul_f32 v3, v3, v4
    v_mul_f32 v33, v7, v3
    v_mfma_f32_16x16x32_bf16 v[92:95], v[196:199], a[244:247], v[92:95]
    v_lshlrev_b32 v3, 16, v31
    v_lshlrev_b32 v4, 16, v59
    s_waitcnt vmcnt(0) lgkmcnt(0)
    s_barrier
    v_mfma_f32_16x16x32_bf16 v[64:67], v[224:227], a[120:123], v[64:67]
    v_mfma_f32_16x16x32_bf16 v[68:71], v[224:227], a[124:127], v[68:71]
    v_mul_f32 v3, v3, v4
    v_mul_f32 v36, v7, v3
    v_mfma_f32_16x16x32_bf16 v[72:75], v[224:227], a[248:251], v[72:75]
    v_mfma_f32_16x16x32_bf16 v[76:79], v[224:227], a[252:255], v[76:79]
    v_and_b32 v3, s37, v31
    v_and_b32 v4, s37, v59
    v_mfma_f32_16x16x32_bf16 v[80:83], v[228:231], a[120:123], v[80:83]
    v_mul_f32 v3, v3, v4
    v_mul_f32 v37, v7, v3
    v_mfma_f32_16x16x32_bf16 v[84:87], v[228:231], a[124:127], v[84:87]
    v_lshlrev_b32 v3, 16, v34
    v_lshlrev_b32 v4, 16, v60
    v_mfma_f32_16x16x32_bf16 v[88:91], v[228:231], a[248:251], v[88:91]
    v_mul_f32 v3, v3, v4
    v_mul_f32 v56, v11, v3
    v_mfma_f32_16x16x32_bf16 v[92:95], v[228:231], a[252:255], v[92:95]
    s_waitcnt lgkmcnt(0)
    v_and_b32 v3, s37, v34
    v_and_b32 v4, s37, v60
    v_mfma_f32_16x16x32_bf16 v[96:99], v[200:203], a[0:3], v[96:99]
    ds_read_b64_tr_b16 v[232:233], v19 offset:36864
    ds_read_b64_tr_b16 v[234:235], v19 offset:41472
    v_mfma_f32_16x16x32_bf16 v[100:103], v[200:203], a[4:7], v[100:103]
    v_mfma_f32_16x16x32_bf16 v[104:107], v[200:203], a[128:131], v[104:107]
    ds_read_b64_tr_b16 v[236:237], v20 offset:36864
    ds_read_b64_tr_b16 v[238:239], v20 offset:41472
    v_mfma_f32_16x16x32_bf16 v[108:111], v[200:203], a[132:135], v[108:111]
    v_mfma_f32_16x16x32_bf16 v[112:115], v[204:207], a[0:3], v[112:115]
    v_mfma_f32_16x16x32_bf16 v[116:119], v[204:207], a[4:7], v[116:119]
    v_cvt_pk_bf16_f32 v64, v64, v65
    v_cvt_pk_bf16_f32 v65, v66, v67
    v_mfma_f32_16x16x32_bf16 v[120:123], v[204:207], a[128:131], v[120:123]
    v_cvt_pk_bf16_f32 v66, v68, v69
    v_cvt_pk_bf16_f32 v67, v70, v71
    v_mfma_f32_16x16x32_bf16 v[124:127], v[204:207], a[132:135], v[124:127]
    s_waitcnt lgkmcnt(0)
    v_mfma_f32_16x16x32_bf16 v[96:99], v[232:235], a[8:11], v[96:99]
    ds_read_b64_tr_b16 v[200:201], v19 offset:46080
    ds_read_b64_tr_b16 v[202:203], v19 offset:50688
    v_mfma_f32_16x16x32_bf16 v[100:103], v[232:235], a[12:15], v[100:103]
    buffer_store_dwordx4 v[64:67], v16, s[16:19], s46 offen offset:0 sc1
    v_mfma_f32_16x16x32_bf16 v[104:107], v[232:235], a[136:139], v[104:107]
    ds_read_b64_tr_b16 v[204:205], v20 offset:46080
    ds_read_b64_tr_b16 v[206:207], v20 offset:50688
    v_mfma_f32_16x16x32_bf16 v[108:111], v[232:235], a[140:143], v[108:111]
    v_cvt_pk_bf16_f32 v68, v72, v73
    v_cvt_pk_bf16_f32 v69, v74, v75
    v_mfma_f32_16x16x32_bf16 v[112:115], v[236:239], a[8:11], v[112:115]
    v_cvt_pk_bf16_f32 v70, v76, v77
    v_cvt_pk_bf16_f32 v71, v78, v79
    v_mfma_f32_16x16x32_bf16 v[116:119], v[236:239], a[12:15], v[116:119]
    buffer_store_dwordx4 v[68:71], v16, s[16:19], s46 offen offset:1024 sc1
    v_mfma_f32_16x16x32_bf16 v[120:123], v[236:239], a[136:139], v[120:123]
    v_cvt_pk_bf16_f32 v72, v80, v81
    v_cvt_pk_bf16_f32 v73, v82, v83
    v_mfma_f32_16x16x32_bf16 v[124:127], v[236:239], a[140:143], v[124:127]
    s_waitcnt lgkmcnt(0)
    v_cvt_pk_bf16_f32 v74, v84, v85
    v_cvt_pk_bf16_f32 v75, v86, v87
    v_mfma_f32_16x16x32_bf16 v[96:99], v[200:203], a[16:19], v[96:99]
    ds_read_b64_tr_b16 v[232:233], v19 offset:55296
    ds_read_b64_tr_b16 v[234:235], v19 offset:59904
    v_mfma_f32_16x16x32_bf16 v[100:103], v[200:203], a[20:23], v[100:103]
    buffer_store_dwordx4 v[72:75], v16, s[16:19], s46 offen offset:2048 sc1
    v_mfma_f32_16x16x32_bf16 v[104:107], v[200:203], a[144:147], v[104:107]
    ds_read_b64_tr_b16 v[236:237], v20 offset:55296
    ds_read_b64_tr_b16 v[238:239], v20 offset:59904
    v_mfma_f32_16x16x32_bf16 v[108:111], v[200:203], a[148:151], v[108:111]
    v_cvt_pk_bf16_f32 v76, v88, v89
    v_cvt_pk_bf16_f32 v77, v90, v91
    v_mfma_f32_16x16x32_bf16 v[112:115], v[204:207], a[16:19], v[112:115]
    v_cvt_pk_bf16_f32 v78, v92, v93
    v_cvt_pk_bf16_f32 v79, v94, v95
    v_mfma_f32_16x16x32_bf16 v[116:119], v[204:207], a[20:23], v[116:119]
    buffer_store_dwordx4 v[76:79], v16, s[16:19], s46 offen offset:3072 sc1
    v_mfma_f32_16x16x32_bf16 v[120:123], v[204:207], a[144:147], v[120:123]
    s_add_u32 s46, s46, 4096
    v_mul_f32 v3, v3, v4
    v_mul_f32 v57, v11, v3
    v_mfma_f32_16x16x32_bf16 v[124:127], v[204:207], a[148:151], v[124:127]
    s_waitcnt lgkmcnt(0)
    v_lshlrev_b32 v3, 16, v35
    v_lshlrev_b32 v4, 16, v61
    v_mfma_f32_16x16x32_bf16 v[96:99], v[232:235], a[24:27], v[96:99]
    v_add_u32 v17, 64512, v17
    v_add_u32 v18, 64512, v18
    v_mfma_f32_16x16x32_bf16 v[100:103], v[232:235], a[28:31], v[100:103]
    v_add_u32 v19, 64512, v19
    v_add_u32 v20, 64512, v20
    v_mfma_f32_16x16x32_bf16 v[104:107], v[232:235], a[152:155], v[104:107]
    ds_read_b64_tr_b16 v[200:201], v19 offset:0
    ds_read_b64_tr_b16 v[202:203], v19 offset:4608
    v_mfma_f32_16x16x32_bf16 v[108:111], v[232:235], a[156:159], v[108:111]
    ds_read_b64_tr_b16 v[204:205], v20 offset:0
    ds_read_b64_tr_b16 v[206:207], v20 offset:4608
    v_mfma_f32_16x16x32_bf16 v[112:115], v[236:239], a[24:27], v[112:115]
    v_mul_f32 v3, v3, v4
    v_mul_f32 v58, v11, v3
    v_mfma_f32_16x16x32_bf16 v[116:119], v[236:239], a[28:31], v[116:119]
    v_and_b32 v3, s37, v35
    v_and_b32 v4, s37, v61
    v_mfma_f32_16x16x32_bf16 v[120:123], v[236:239], a[152:155], v[120:123]
    v_mul_f32 v3, v3, v4
    v_mul_f32 v59, v11, v3
    v_mfma_f32_16x16x32_bf16 v[124:127], v[236:239], a[156:159], v[124:127]
    s_waitcnt lgkmcnt(0)
    v_lshlrev_b32 v3, 16, v38
    v_lshlrev_b32 v4, 16, v62
    v_mfma_f32_16x16x32_bf16 v[96:99], v[200:203], a[32:35], v[96:99]
    ds_read_b64_tr_b16 v[232:233], v19 offset:9216
    ds_read_b64_tr_b16 v[234:235], v19 offset:13824
    v_mfma_f32_16x16x32_bf16 v[100:103], v[200:203], a[36:39], v[100:103]
    v_mul_f32 v3, v3, v4
    v_mul_f32 v26, v12, v3
    v_mfma_f32_16x16x32_bf16 v[104:107], v[200:203], a[160:163], v[104:107]
    ds_read_b64_tr_b16 v[236:237], v20 offset:9216
    ds_read_b64_tr_b16 v[238:239], v20 offset:13824
    v_mfma_f32_16x16x32_bf16 v[108:111], v[200:203], a[164:167], v[108:111]
    v_and_b32 v3, s37, v38
    v_and_b32 v4, s37, v62
    v_mfma_f32_16x16x32_bf16 v[112:115], v[204:207], a[32:35], v[112:115]
    v_mul_f32 v3, v3, v4
    v_mul_f32 v27, v12, v3
    v_mfma_f32_16x16x32_bf16 v[116:119], v[204:207], a[36:39], v[116:119]
    v_lshlrev_b32 v3, 16, v39
    v_lshlrev_b32 v4, 16, v63
    v_mfma_f32_16x16x32_bf16 v[120:123], v[204:207], a[160:163], v[120:123]
    v_mul_f32 v3, v3, v4
    v_mul_f32 v30, v12, v3
    v_mfma_f32_16x16x32_bf16 v[124:127], v[204:207], a[164:167], v[124:127]
    s_waitcnt lgkmcnt(0)
    v_and_b32 v3, s37, v39
    v_and_b32 v4, s37, v63
    v_mfma_f32_16x16x32_bf16 v[96:99], v[232:235], a[40:43], v[96:99]
    v_add_u32 v17, 4294838272, v17
    v_add_u32 v18, 4294838272, v18
    v_mfma_f32_16x16x32_bf16 v[100:103], v[232:235], a[44:47], v[100:103]
    v_add_u32 v19, 4294838272, v19
    v_add_u32 v20, 4294838272, v20
    v_mfma_f32_16x16x32_bf16 v[104:107], v[232:235], a[168:171], v[104:107]
    ds_read_b64_tr_b16 v[200:201], v19 offset:0
    ds_read_b64_tr_b16 v[202:203], v19 offset:4608
    v_mfma_f32_16x16x32_bf16 v[108:111], v[232:235], a[172:175], v[108:111]
    ds_read_b64_tr_b16 v[204:205], v20 offset:0
    ds_read_b64_tr_b16 v[206:207], v20 offset:4608
    v_mfma_f32_16x16x32_bf16 v[112:115], v[236:239], a[40:43], v[112:115]
    v_mul_f32 v3, v3, v4
    v_mul_f32 v31, v12, v3
    v_mfma_f32_16x16x32_bf16 v[116:119], v[236:239], a[44:47], v[116:119]
    v_sub_f32 v6, 1.0, v6
    v_sub_f32 v7, 1.0, v7
    v_mfma_f32_16x16x32_bf16 v[120:123], v[236:239], a[168:171], v[120:123]
    v_sub_f32 v11, 1.0, v11
    v_sub_f32 v12, 1.0, v12
    v_mfma_f32_16x16x32_bf16 v[124:127], v[236:239], a[172:175], v[124:127]
    s_waitcnt lgkmcnt(0)
    v_mfma_f32_16x16x32_bf16 v[96:99], v[200:203], a[48:51], v[96:99]
    ds_read_b64_tr_b16 v[232:233], v19 offset:9216
    ds_read_b64_tr_b16 v[234:235], v19 offset:13824
    v_mfma_f32_16x16x32_bf16 v[100:103], v[200:203], a[52:55], v[100:103]
    v_mfma_f32_16x16x32_bf16 v[104:107], v[200:203], a[176:179], v[104:107]
    ds_read_b64_tr_b16 v[236:237], v20 offset:9216
    ds_read_b64_tr_b16 v[238:239], v20 offset:13824
    v_mfma_f32_16x16x32_bf16 v[108:111], v[200:203], a[180:183], v[108:111]
    v_mfma_f32_16x16x32_bf16 v[112:115], v[204:207], a[48:51], v[112:115]
    v_mfma_f32_16x16x32_bf16 v[116:119], v[204:207], a[52:55], v[116:119]
    v_mfma_f32_16x16x32_bf16 v[120:123], v[204:207], a[176:179], v[120:123]
    v_mfma_f32_16x16x32_bf16 v[124:127], v[204:207], a[180:183], v[124:127]
    s_waitcnt lgkmcnt(0)
    v_mfma_f32_16x16x32_bf16 v[96:99], v[232:235], a[56:59], v[96:99]
    ds_read_b64_tr_b16 v[200:201], v19 offset:18432
    ds_read_b64_tr_b16 v[202:203], v19 offset:23040
    v_mfma_f32_16x16x32_bf16 v[100:103], v[232:235], a[60:63], v[100:103]
    v_mfma_f32_16x16x32_bf16 v[104:107], v[232:235], a[184:187], v[104:107]
    ds_read_b64_tr_b16 v[204:205], v20 offset:18432
    ds_read_b64_tr_b16 v[206:207], v20 offset:23040
    v_mfma_f32_16x16x32_bf16 v[108:111], v[232:235], a[188:191], v[108:111]
    v_mfma_f32_16x16x32_bf16 v[112:115], v[236:239], a[56:59], v[112:115]
    v_mfma_f32_16x16x32_bf16 v[116:119], v[236:239], a[60:63], v[116:119]
    v_mfma_f32_16x16x32_bf16 v[120:123], v[236:239], a[184:187], v[120:123]
    v_mfma_f32_16x16x32_bf16 v[124:127], v[236:239], a[188:191], v[124:127]
    s_waitcnt lgkmcnt(0)
    v_mfma_f32_16x16x32_bf16 v[96:99], v[200:203], a[64:67], v[96:99]
    ds_read_b64_tr_b16 v[232:233], v19 offset:27648
    ds_read_b64_tr_b16 v[234:235], v19 offset:32256
    v_mfma_f32_16x16x32_bf16 v[100:103], v[200:203], a[68:71], v[100:103]
    v_mfma_f32_16x16x32_bf16 v[104:107], v[200:203], a[192:195], v[104:107]
    ds_read_b64_tr_b16 v[236:237], v20 offset:27648
    ds_read_b64_tr_b16 v[238:239], v20 offset:32256
    v_mfma_f32_16x16x32_bf16 v[108:111], v[200:203], a[196:199], v[108:111]
    v_mfma_f32_16x16x32_bf16 v[112:115], v[204:207], a[64:67], v[112:115]
    v_mfma_f32_16x16x32_bf16 v[116:119], v[204:207], a[68:71], v[116:119]
    v_mfma_f32_16x16x32_bf16 v[120:123], v[204:207], a[192:195], v[120:123]
    v_mfma_f32_16x16x32_bf16 v[124:127], v[204:207], a[196:199], v[124:127]
    s_waitcnt lgkmcnt(0)
    v_mfma_f32_16x16x32_bf16 v[96:99], v[232:235], a[72:75], v[96:99]
    ds_read_b64_tr_b16 v[200:201], v19 offset:36864
    ds_read_b64_tr_b16 v[202:203], v19 offset:41472
    v_mfma_f32_16x16x32_bf16 v[100:103], v[232:235], a[76:79], v[100:103]
    v_mfma_f32_16x16x32_bf16 v[104:107], v[232:235], a[200:203], v[104:107]
    ds_read_b64_tr_b16 v[204:205], v20 offset:36864
    ds_read_b64_tr_b16 v[206:207], v20 offset:41472
    v_mfma_f32_16x16x32_bf16 v[108:111], v[232:235], a[204:207], v[108:111]
    v_mfma_f32_16x16x32_bf16 v[112:115], v[236:239], a[72:75], v[112:115]
    v_mfma_f32_16x16x32_bf16 v[116:119], v[236:239], a[76:79], v[116:119]
    v_mfma_f32_16x16x32_bf16 v[120:123], v[236:239], a[200:203], v[120:123]
    v_mfma_f32_16x16x32_bf16 v[124:127], v[236:239], a[204:207], v[124:127]
    s_waitcnt lgkmcnt(0)
    v_mfma_f32_16x16x32_bf16 v[96:99], v[200:203], a[80:83], v[96:99]
    ds_read_b64_tr_b16 v[232:233], v19 offset:46080
    ds_read_b64_tr_b16 v[234:235], v19 offset:50688
    v_mfma_f32_16x16x32_bf16 v[100:103], v[200:203], a[84:87], v[100:103]
    v_mfma_f32_16x16x32_bf16 v[104:107], v[200:203], a[208:211], v[104:107]
    ds_read_b64_tr_b16 v[236:237], v20 offset:46080
    ds_read_b64_tr_b16 v[238:239], v20 offset:50688
    v_mfma_f32_16x16x32_bf16 v[108:111], v[200:203], a[212:215], v[108:111]
    v_mfma_f32_16x16x32_bf16 v[112:115], v[204:207], a[80:83], v[112:115]
    v_mfma_f32_16x16x32_bf16 v[116:119], v[204:207], a[84:87], v[116:119]
    v_mfma_f32_16x16x32_bf16 v[120:123], v[204:207], a[208:211], v[120:123]
    v_mfma_f32_16x16x32_bf16 v[124:127], v[204:207], a[212:215], v[124:127]
    s_waitcnt lgkmcnt(0)
    v_mfma_f32_16x16x32_bf16 v[96:99], v[232:235], a[88:91], v[96:99]
    ds_read_b64_tr_b16 v[200:201], v19 offset:55296
    ds_read_b64_tr_b16 v[202:203], v19 offset:59904
    v_mfma_f32_16x16x32_bf16 v[100:103], v[232:235], a[92:95], v[100:103]
    v_mfma_f32_16x16x32_bf16 v[104:107], v[232:235], a[216:219], v[104:107]
    ds_read_b64_tr_b16 v[204:205], v20 offset:55296
    ds_read_b64_tr_b16 v[206:207], v20 offset:59904
    v_mfma_f32_16x16x32_bf16 v[108:111], v[232:235], a[220:223], v[108:111]
    v_mfma_f32_16x16x32_bf16 v[112:115], v[236:239], a[88:91], v[112:115]
    v_mfma_f32_16x16x32_bf16 v[116:119], v[236:239], a[92:95], v[116:119]
    v_mfma_f32_16x16x32_bf16 v[120:123], v[236:239], a[216:219], v[120:123]
    v_mfma_f32_16x16x32_bf16 v[124:127], v[236:239], a[220:223], v[124:127]
    s_waitcnt lgkmcnt(0)
    v_mfma_f32_16x16x32_bf16 v[96:99], v[200:203], a[96:99], v[96:99]
    v_add_u32 v17, 64512, v17
    v_add_u32 v18, 64512, v18
    v_mfma_f32_16x16x32_bf16 v[100:103], v[200:203], a[100:103], v[100:103]
    v_add_u32 v19, 64512, v19
    v_add_u32 v20, 64512, v20
    v_mfma_f32_16x16x32_bf16 v[104:107], v[200:203], a[224:227], v[104:107]
    ds_read_b64_tr_b16 v[232:233], v19 offset:0
    ds_read_b64_tr_b16 v[234:235], v19 offset:4608
    v_mfma_f32_16x16x32_bf16 v[108:111], v[200:203], a[228:231], v[108:111]
    ds_read_b64_tr_b16 v[236:237], v20 offset:0
    ds_read_b64_tr_b16 v[238:239], v20 offset:4608
    v_mfma_f32_16x16x32_bf16 v[112:115], v[204:207], a[96:99], v[112:115]
    v_mfma_f32_16x16x32_bf16 v[116:119], v[204:207], a[100:103], v[116:119]
    v_mfma_f32_16x16x32_bf16 v[120:123], v[204:207], a[224:227], v[120:123]
    v_mfma_f32_16x16x32_bf16 v[124:127], v[204:207], a[228:231], v[124:127]
    s_waitcnt lgkmcnt(0)
    v_mfma_f32_16x16x32_bf16 v[96:99], v[232:235], a[104:107], v[96:99]
    ds_read_b64_tr_b16 v[200:201], v19 offset:9216
    ds_read_b64_tr_b16 v[202:203], v19 offset:13824
    v_mfma_f32_16x16x32_bf16 v[100:103], v[232:235], a[108:111], v[100:103]
    v_mfma_f32_16x16x32_bf16 v[104:107], v[232:235], a[232:235], v[104:107]
    ds_read_b64_tr_b16 v[204:205], v20 offset:9216
    ds_read_b64_tr_b16 v[206:207], v20 offset:13824
    v_mfma_f32_16x16x32_bf16 v[108:111], v[232:235], a[236:239], v[108:111]
    v_mfma_f32_16x16x32_bf16 v[112:115], v[236:239], a[104:107], v[112:115]
    v_mfma_f32_16x16x32_bf16 v[116:119], v[236:239], a[108:111], v[116:119]
    v_mfma_f32_16x16x32_bf16 v[120:123], v[236:239], a[232:235], v[120:123]
    v_mfma_f32_16x16x32_bf16 v[124:127], v[236:239], a[236:239], v[124:127]
    s_waitcnt lgkmcnt(0)
    v_mfma_f32_16x16x32_bf16 v[96:99], v[200:203], a[112:115], v[96:99]
    ds_read_b64_tr_b16 v[232:233], v19 offset:18432
    ds_read_b64_tr_b16 v[234:235], v19 offset:23040
    v_mfma_f32_16x16x32_bf16 v[100:103], v[200:203], a[116:119], v[100:103]
    v_mfma_f32_16x16x32_bf16 v[104:107], v[200:203], a[240:243], v[104:107]
    ds_read_b64_tr_b16 v[236:237], v20 offset:18432
    ds_read_b64_tr_b16 v[238:239], v20 offset:23040
    v_mfma_f32_16x16x32_bf16 v[108:111], v[200:203], a[244:247], v[108:111]
    v_mfma_f32_16x16x32_bf16 v[112:115], v[204:207], a[112:115], v[112:115]
    v_mfma_f32_16x16x32_bf16 v[116:119], v[204:207], a[116:119], v[116:119]
    v_mfma_f32_16x16x32_bf16 v[120:123], v[204:207], a[240:243], v[120:123]
    v_mfma_f32_16x16x32_bf16 v[124:127], v[204:207], a[244:247], v[124:127]
    s_waitcnt lgkmcnt(0)
    v_mfma_f32_16x16x32_bf16 v[96:99], v[232:235], a[120:123], v[96:99]
    v_mfma_f32_16x16x32_bf16 v[100:103], v[232:235], a[124:127], v[100:103]
    s_lshl_b32 s52, s44, 2
    s_xor_b32 s52, s52, 196608
    v_mfma_f32_16x16x32_bf16 v[104:107], v[232:235], a[248:251], v[104:107]
    v_mfma_f32_16x16x32_bf16 v[108:111], v[232:235], a[252:255], v[108:111]
    s_add_u32 s52, s52, 0
    buffer_load_dwordx4 v[80:83], v16, s[16:19], s52 offen offset:0 sc1
    v_mfma_f32_16x16x32_bf16 v[112:115], v[236:239], a[120:123], v[112:115]
    buffer_load_dwordx4 v[84:87], v16, s[16:19], s52 offen offset:1024 sc1
    v_mfma_f32_16x16x32_bf16 v[116:119], v[236:239], a[124:127], v[116:119]
    buffer_load_dwordx4 v[88:91], v16, s[16:19], s52 offen offset:2048 sc1
    v_mfma_f32_16x16x32_bf16 v[120:123], v[236:239], a[248:251], v[120:123]
    buffer_load_dwordx4 v[92:95], v16, s[16:19], s52 offen offset:3072 sc1
    v_mfma_f32_16x16x32_bf16 v[124:127], v[236:239], a[252:255], v[124:127]
    s_waitcnt lgkmcnt(0)
    v_mfma_f32_16x16x32_bf16 v[128:131], v[208:211], a[0:3], v[128:131]
    ds_read_b64_tr_b16 v[240:241], v17 offset:36992
    ds_read_b64_tr_b16 v[242:243], v17 offset:41600
    v_mfma_f32_16x16x32_bf16 v[132:135], v[208:211], a[4:7], v[132:135]
    v_mfma_f32_16x16x32_bf16 v[136:139], v[208:211], a[128:131], v[136:139]
    ds_read_b64_tr_b16 v[244:245], v18 offset:36992
    ds_read_b64_tr_b16 v[246:247], v18 offset:41600
    v_mfma_f32_16x16x32_bf16 v[140:143], v[208:211], a[132:135], v[140:143]
    v_mfma_f32_16x16x32_bf16 v[144:147], v[212:215], a[0:3], v[144:147]
    v_mfma_f32_16x16x32_bf16 v[148:151], v[212:215], a[4:7], v[148:151]
    v_cvt_pk_bf16_f32 v96, v96, v97
    v_cvt_pk_bf16_f32 v97, v98, v99
    v_mfma_f32_16x16x32_bf16 v[152:155], v[212:215], a[128:131], v[152:155]
    v_cvt_pk_bf16_f32 v98, v100, v101
    v_cvt_pk_bf16_f32 v99, v102, v103
    v_mfma_f32_16x16x32_bf16 v[156:159], v[212:215], a[132:135], v[156:159]
    s_waitcnt lgkmcnt(0)
    v_mfma_f32_16x16x32_bf16 v[128:131], v[240:243], a[8:11], v[128:131]
    ds_read_b64_tr_b16 v[208:209], v17 offset:46208
    ds_read_b64_tr_b16 v[210:211], v17 offset:50816
    v_mfma_f32_16x16x32_bf16 v[132:135], v[240:243], a[12:15], v[132:135]
    buffer_store_dwordx4 v[96:99], v16, s[16:19], s46 offen offset:0 sc1
    v_mfma_f32_16x16x32_bf16 v[136:139], v[240:243], a[136:139], v[136:139]
    ds_read_b64_tr_b16 v[212:213], v18 offset:46208
    ds_read_b64_tr_b16 v[214:215], v18 offset:50816
    v_mfma_f32_16x16x32_bf16 v[140:143], v[240:243], a[140:143], v[140:143]
    v_cvt_pk_bf16_f32 v100, v104, v105
    v_cvt_pk_bf16_f32 v101, v106, v107
    v_mfma_f32_16x16x32_bf16 v[144:147], v[244:247], a[8:11], v[144:147]
    v_cvt_pk_bf16_f32 v102, v108, v109
    v_cvt_pk_bf16_f32 v103, v110, v111
    v_mfma_f32_16x16x32_bf16 v[148:151], v[244:247], a[12:15], v[148:151]
    buffer_store_dwordx4 v[100:103], v16, s[16:19], s46 offen offset:1024 sc1
    v_mfma_f32_16x16x32_bf16 v[152:155], v[244:247], a[136:139], v[152:155]
    v_cvt_pk_bf16_f32 v104, v112, v113
    v_cvt_pk_bf16_f32 v105, v114, v115
    v_mfma_f32_16x16x32_bf16 v[156:159], v[244:247], a[140:143], v[156:159]
    s_waitcnt lgkmcnt(0)
    v_cvt_pk_bf16_f32 v106, v116, v117
    v_cvt_pk_bf16_f32 v107, v118, v119
    v_mfma_f32_16x16x32_bf16 v[128:131], v[208:211], a[16:19], v[128:131]
    ds_read_b64_tr_b16 v[240:241], v17 offset:55424
    ds_read_b64_tr_b16 v[242:243], v17 offset:60032
    v_mfma_f32_16x16x32_bf16 v[132:135], v[208:211], a[20:23], v[132:135]
    buffer_store_dwordx4 v[104:107], v16, s[16:19], s46 offen offset:2048 sc1
    v_mfma_f32_16x16x32_bf16 v[136:139], v[208:211], a[144:147], v[136:139]
    ds_read_b64_tr_b16 v[244:245], v18 offset:55424
    ds_read_b64_tr_b16 v[246:247], v18 offset:60032
    v_mfma_f32_16x16x32_bf16 v[140:143], v[208:211], a[148:151], v[140:143]
    v_cvt_pk_bf16_f32 v108, v120, v121
    v_cvt_pk_bf16_f32 v109, v122, v123
    v_mfma_f32_16x16x32_bf16 v[144:147], v[212:215], a[16:19], v[144:147]
    v_cvt_pk_bf16_f32 v110, v124, v125
    v_cvt_pk_bf16_f32 v111, v126, v127
    v_mfma_f32_16x16x32_bf16 v[148:151], v[212:215], a[20:23], v[148:151]
    buffer_store_dwordx4 v[108:111], v16, s[16:19], s46 offen offset:3072 sc1
    v_mfma_f32_16x16x32_bf16 v[152:155], v[212:215], a[144:147], v[152:155]
    s_add_u32 s46, s46, 4096
    v_mfma_f32_16x16x32_bf16 v[156:159], v[212:215], a[148:151], v[156:159]
    s_waitcnt lgkmcnt(0)
    v_mfma_f32_16x16x32_bf16 v[128:131], v[240:243], a[24:27], v[128:131]
    v_add_u32 v17, 64512, v17
    v_add_u32 v18, 64512, v18
    v_mfma_f32_16x16x32_bf16 v[132:135], v[240:243], a[28:31], v[132:135]
    v_add_u32 v19, 64512, v19
    v_add_u32 v20, 64512, v20
    v_mfma_f32_16x16x32_bf16 v[136:139], v[240:243], a[152:155], v[136:139]
    ds_read_b64_tr_b16 v[208:209], v17 offset:128
    ds_read_b64_tr_b16 v[210:211], v17 offset:4736
    v_mfma_f32_16x16x32_bf16 v[140:143], v[240:243], a[156:159], v[140:143]
    ds_read_b64_tr_b16 v[212:213], v18 offset:128
    ds_read_b64_tr_b16 v[214:215], v18 offset:4736
    v_mfma_f32_16x16x32_bf16 v[144:147], v[244:247], a[24:27], v[144:147]
    v_mfma_f32_16x16x32_bf16 v[148:151], v[244:247], a[28:31], v[148:151]
    v_mfma_f32_16x16x32_bf16 v[152:155], v[244:247], a[152:155], v[152:155]
    v_mfma_f32_16x16x32_bf16 v[156:159], v[244:247], a[156:159], v[156:159]
    s_waitcnt lgkmcnt(0)
    v_mfma_f32_16x16x32_bf16 v[128:131], v[208:211], a[32:35], v[128:131]
    ds_read_b64_tr_b16 v[240:241], v17 offset:9344
    ds_read_b64_tr_b16 v[242:243], v17 offset:13952
    v_mfma_f32_16x16x32_bf16 v[132:135], v[208:211], a[36:39], v[132:135]
    v_mfma_f32_16x16x32_bf16 v[136:139], v[208:211], a[160:163], v[136:139]
    ds_read_b64_tr_b16 v[244:245], v18 offset:9344
    ds_read_b64_tr_b16 v[246:247], v18 offset:13952
    v_mfma_f32_16x16x32_bf16 v[140:143], v[208:211], a[164:167], v[140:143]
    v_mfma_f32_16x16x32_bf16 v[144:147], v[212:215], a[32:35], v[144:147]
    v_mfma_f32_16x16x32_bf16 v[148:151], v[212:215], a[36:39], v[148:151]
gated_mix__ssm_conv_h3__compressed_kv_cla__prompt_kernel_pad15:
    s_cbranch_execz gated_mix__ssm_conv_h3__compressed_kv_cla__prompt_kernel_pad23
    v_mfma_f32_16x16x32_bf16 v[152:155], v[212:215], a[160:163], v[152:155]
    v_mfma_f32_16x16x32_bf16 v[156:159], v[212:215], a[164:167], v[156:159]
    s_waitcnt lgkmcnt(0)
    v_mfma_f32_16x16x32_bf16 v[128:131], v[240:243], a[40:43], v[128:131]
    v_add_u32 v17, 4294838272, v17
    v_add_u32 v18, 4294838272, v18
    v_mfma_f32_16x16x32_bf16 v[132:135], v[240:243], a[44:47], v[132:135]
    v_add_u32 v19, 4294838272, v19
    v_add_u32 v20, 4294838272, v20
    v_mfma_f32_16x16x32_bf16 v[136:139], v[240:243], a[168:171], v[136:139]
    ds_read_b64_tr_b16 v[208:209], v17 offset:128
    ds_read_b64_tr_b16 v[210:211], v17 offset:4736
    v_mfma_f32_16x16x32_bf16 v[140:143], v[240:243], a[172:175], v[140:143]
    ds_read_b64_tr_b16 v[212:213], v18 offset:128
    ds_read_b64_tr_b16 v[214:215], v18 offset:4736
    v_mfma_f32_16x16x32_bf16 v[144:147], v[244:247], a[40:43], v[144:147]
    s_waitcnt vmcnt(4)
    v_max3_u32 v15, v80, v81, v82
    v_max3_u32 v15, v15, v83, v84
    v_mfma_f32_16x16x32_bf16 v[148:151], v[244:247], a[44:47], v[148:151]
    v_max3_u32 v15, v15, v85, v86
    v_max3_u32 v15, v15, v87, v88
    v_mfma_f32_16x16x32_bf16 v[152:155], v[244:247], a[168:171], v[152:155]
    v_max3_u32 v15, v15, v89, v90
    v_max3_u32 v15, v15, v91, v92
    v_mfma_f32_16x16x32_bf16 v[156:159], v[244:247], a[172:175], v[156:159]
    s_waitcnt lgkmcnt(0)
    v_max3_u32 v15, v15, v93, v94
    v_max_u32 v15, v15, v95
    v_mfma_f32_16x16x32_bf16 v[128:131], v[208:211], a[48:51], v[128:131]
    ds_read_b64_tr_b16 v[240:241], v17 offset:9344
    ds_read_b64_tr_b16 v[242:243], v17 offset:13952
    v_mfma_f32_16x16x32_bf16 v[132:135], v[208:211], a[52:55], v[132:135]
    v_cmp_eq_u32 vcc, -1, v15
    v_mfma_f32_16x16x32_bf16 v[136:139], v[208:211], a[176:179], v[136:139]
    ds_read_b64_tr_b16 v[244:245], v18 offset:9344
    ds_read_b64_tr_b16 v[246:247], v18 offset:13952
    v_mfma_f32_16x16x32_bf16 v[140:143], v[208:211], a[180:183], v[140:143]
    v_mfma_f32_16x16x32_bf16 v[144:147], v[212:215], a[48:51], v[144:147]
    s_cbranch_vccnz gated_mix__ssm_conv_h3__compressed_kv_cla__prompt_kernel_spin_x3
gated_mix__ssm_conv_h3__compressed_kv_cla__prompt_kernel_spin_x3_ret:
    v_lshlrev_b32 v3, 16, v80
    v_fmac_f32 v40, v6, v3
    v_mfma_f32_16x16x32_bf16 v[148:151], v[212:215], a[52:55], v[148:151]
    v_and_b32 v4, s37, v80
    v_fmac_f32 v41, v6, v4
    v_mfma_f32_16x16x32_bf16 v[152:155], v[212:215], a[176:179], v[152:155]
    v_lshlrev_b32 v3, 16, v81
    v_fmac_f32 v42, v6, v3
    v_mfma_f32_16x16x32_bf16 v[156:159], v[212:215], a[180:183], v[156:159]
    s_waitcnt lgkmcnt(0)
    v_and_b32 v4, s37, v81
    v_fmac_f32 v43, v6, v4
    v_mfma_f32_16x16x32_bf16 v[128:131], v[240:243], a[56:59], v[128:131]
    ds_read_b64_tr_b16 v[208:209], v17 offset:18560
    ds_read_b64_tr_b16 v[210:211], v17 offset:23168
    v_mfma_f32_16x16x32_bf16 v[132:135], v[240:243], a[60:63], v[132:135]
    v_lshlrev_b32 v3, 16, v82
    v_fmac_f32 v44, v7, v3
    v_mfma_f32_16x16x32_bf16 v[136:139], v[240:243], a[184:187], v[136:139]
    ds_read_b64_tr_b16 v[212:213], v18 offset:18560
    ds_read_b64_tr_b16 v[214:215], v18 offset:23168
    v_mfma_f32_16x16x32_bf16 v[140:143], v[240:243], a[188:191], v[140:143]
    v_and_b32 v4, s37, v82
    v_fmac_f32 v45, v7, v4
    v_mfma_f32_16x16x32_bf16 v[144:147], v[244:247], a[56:59], v[144:147]
    v_lshlrev_b32 v3, 16, v83
    v_fmac_f32 v46, v7, v3
    v_mfma_f32_16x16x32_bf16 v[148:151], v[244:247], a[60:63], v[148:151]
    v_and_b32 v4, s37, v83
    v_fmac_f32 v47, v7, v4
    v_mfma_f32_16x16x32_bf16 v[152:155], v[244:247], a[184:187], v[152:155]
    v_lshlrev_b32 v3, 16, v84
    v_fmac_f32 v48, v11, v3
    v_mfma_f32_16x16x32_bf16 v[156:159], v[244:247], a[188:191], v[156:159]
    s_waitcnt lgkmcnt(0)
    v_and_b32 v4, s37, v84
    v_fmac_f32 v49, v11, v4
    v_mfma_f32_16x16x32_bf16 v[128:131], v[208:211], a[64:67], v[128:131]
    ds_read_b64_tr_b16 v[240:241], v17 offset:27776
    ds_read_b64_tr_b16 v[242:243], v17 offset:32384
    v_mfma_f32_16x16x32_bf16 v[132:135], v[208:211], a[68:71], v[132:135]
    v_lshlrev_b32 v3, 16, v85
    v_fmac_f32 v50, v11, v3
    v_mfma_f32_16x16x32_bf16 v[136:139], v[208:211], a[192:195], v[136:139]
    ds_read_b64_tr_b16 v[244:245], v18 offset:27776
    ds_read_b64_tr_b16 v[246:247], v18 offset:32384
    v_mfma_f32_16x16x32_bf16 v[140:143], v[208:211], a[196:199], v[140:143]
    v_and_b32 v4, s37, v85
    v_fmac_f32 v51, v11, v4
    v_mfma_f32_16x16x32_bf16 v[144:147], v[212:215], a[64:67], v[144:147]
    v_lshlrev_b32 v3, 16, v86
    v_fmac_f32 v52, v12, v3
    v_mfma_f32_16x16x32_bf16 v[148:151], v[212:215], a[68:71], v[148:151]
    v_and_b32 v4, s37, v86
    v_fmac_f32 v53, v12, v4
    v_mfma_f32_16x16x32_bf16 v[152:155], v[212:215], a[192:195], v[152:155]
    v_lshlrev_b32 v3, 16, v87
    v_fmac_f32 v54, v12, v3
    v_mfma_f32_16x16x32_bf16 v[156:159], v[212:215], a[196:199], v[156:159]
    s_waitcnt lgkmcnt(0)
    v_and_b32 v4, s37, v87
    v_fmac_f32 v55, v12, v4
    v_mfma_f32_16x16x32_bf16 v[128:131], v[240:243], a[72:75], v[128:131]
    ds_read_b64_tr_b16 v[208:209], v17 offset:36992
    ds_read_b64_tr_b16 v[210:211], v17 offset:41600
    v_mfma_f32_16x16x32_bf16 v[132:135], v[240:243], a[76:79], v[132:135]
    v_lshlrev_b32 v3, 16, v88
    v_fmac_f32 v24, v6, v3
    v_mfma_f32_16x16x32_bf16 v[136:139], v[240:243], a[200:203], v[136:139]
    ds_read_b64_tr_b16 v[212:213], v18 offset:36992
    ds_read_b64_tr_b16 v[214:215], v18 offset:41600
    v_mfma_f32_16x16x32_bf16 v[140:143], v[240:243], a[204:207], v[140:143]
    v_and_b32 v4, s37, v88
    v_fmac_f32 v25, v6, v4
    v_mfma_f32_16x16x32_bf16 v[144:147], v[244:247], a[72:75], v[144:147]
    v_lshlrev_b32 v3, 16, v89
    v_fmac_f32 v28, v6, v3
    v_mfma_f32_16x16x32_bf16 v[148:151], v[244:247], a[76:79], v[148:151]
    v_and_b32 v4, s37, v89
    v_fmac_f32 v29, v6, v4
    v_mfma_f32_16x16x32_bf16 v[152:155], v[244:247], a[200:203], v[152:155]
    v_lshlrev_b32 v3, 16, v90
    v_fmac_f32 v32, v7, v3
    v_mfma_f32_16x16x32_bf16 v[156:159], v[244:247], a[204:207], v[156:159]
    s_waitcnt lgkmcnt(0)
    v_and_b32 v4, s37, v90
    v_fmac_f32 v33, v7, v4
    v_mfma_f32_16x16x32_bf16 v[128:131], v[208:211], a[80:83], v[128:131]
    ds_read_b64_tr_b16 v[240:241], v17 offset:46208
    ds_read_b64_tr_b16 v[242:243], v17 offset:50816
    v_mfma_f32_16x16x32_bf16 v[132:135], v[208:211], a[84:87], v[132:135]
    v_lshlrev_b32 v3, 16, v91
    v_fmac_f32 v36, v7, v3
    v_mfma_f32_16x16x32_bf16 v[136:139], v[208:211], a[208:211], v[136:139]
    ds_read_b64_tr_b16 v[244:245], v18 offset:46208
    ds_read_b64_tr_b16 v[246:247], v18 offset:50816
    v_mfma_f32_16x16x32_bf16 v[140:143], v[208:211], a[212:215], v[140:143]
    v_and_b32 v4, s37, v91
    v_fmac_f32 v37, v7, v4
    v_mfma_f32_16x16x32_bf16 v[144:147], v[212:215], a[80:83], v[144:147]
    v_lshlrev_b32 v3, 16, v92
    v_fmac_f32 v56, v11, v3
    v_mfma_f32_16x16x32_bf16 v[148:151], v[212:215], a[84:87], v[148:151]
    v_and_b32 v4, s37, v92
    v_fmac_f32 v57, v11, v4
    v_mfma_f32_16x16x32_bf16 v[152:155], v[212:215], a[208:211], v[152:155]
    v_lshlrev_b32 v3, 16, v93
    v_fmac_f32 v58, v11, v3
    v_mfma_f32_16x16x32_bf16 v[156:159], v[212:215], a[212:215], v[156:159]
    s_waitcnt lgkmcnt(0)
    v_and_b32 v4, s37, v93
    v_fmac_f32 v59, v11, v4
    v_mfma_f32_16x16x32_bf16 v[128:131], v[240:243], a[88:91], v[128:131]
    ds_read_b64_tr_b16 v[208:209], v17 offset:55424
    ds_read_b64_tr_b16 v[210:211], v17 offset:60032
    v_mfma_f32_16x16x32_bf16 v[132:135], v[240:243], a[92:95], v[132:135]
    v_lshlrev_b32 v3, 16, v94
    v_fmac_f32 v26, v12, v3
    v_mfma_f32_16x16x32_bf16 v[136:139], v[240:243], a[216:219], v[136:139]
    ds_read_b64_tr_b16 v[212:213], v18 offset:55424
    ds_read_b64_tr_b16 v[214:215], v18 offset:60032
    v_mfma_f32_16x16x32_bf16 v[140:143], v[240:243], a[220:223], v[140:143]
    v_and_b32 v4, s37, v94
    v_fmac_f32 v27, v12, v4
    v_mfma_f32_16x16x32_bf16 v[144:147], v[244:247], a[88:91], v[144:147]
    v_lshlrev_b32 v3, 16, v95
    v_fmac_f32 v30, v12, v3
    v_mfma_f32_16x16x32_bf16 v[148:151], v[244:247], a[92:95], v[148:151]
    v_and_b32 v4, s37, v95
    v_fmac_f32 v31, v12, v4
    v_mfma_f32_16x16x32_bf16 v[152:155], v[244:247], a[216:219], v[152:155]
    v_mfma_f32_16x16x32_bf16 v[156:159], v[244:247], a[220:223], v[156:159]
    s_waitcnt lgkmcnt(0)
    v_mfma_f32_16x16x32_bf16 v[128:131], v[208:211], a[96:99], v[128:131]
    v_add_u32 v17, 64512, v17
    v_add_u32 v18, 64512, v18
    v_mfma_f32_16x16x32_bf16 v[132:135], v[208:211], a[100:103], v[132:135]
    v_add_u32 v19, 64512, v19
    v_add_u32 v20, 64512, v20
    v_mfma_f32_16x16x32_bf16 v[136:139], v[208:211], a[224:227], v[136:139]
    ds_read_b64_tr_b16 v[240:241], v17 offset:128
    ds_read_b64_tr_b16 v[242:243], v17 offset:4736
    v_mfma_f32_16x16x32_bf16 v[140:143], v[208:211], a[228:231], v[140:143]
    ds_read_b64_tr_b16 v[244:245], v18 offset:128
    ds_read_b64_tr_b16 v[246:247], v18 offset:4736
    v_mfma_f32_16x16x32_bf16 v[144:147], v[212:215], a[96:99], v[144:147]
    v_mfma_f32_16x16x32_bf16 v[148:151], v[212:215], a[100:103], v[148:151]
    v_mfma_f32_16x16x32_bf16 v[152:155], v[212:215], a[224:227], v[152:155]
    v_mfma_f32_16x16x32_bf16 v[156:159], v[212:215], a[228:231], v[156:159]
    s_waitcnt lgkmcnt(0)
    v_mfma_f32_16x16x32_bf16 v[128:131], v[240:243], a[104:107], v[128:131]
    ds_read_b64_tr_b16 v[208:209], v17 offset:9344
    ds_read_b64_tr_b16 v[210:211], v17 offset:13952
    v_mfma_f32_16x16x32_bf16 v[132:135], v[240:243], a[108:111], v[132:135]
    v_mfma_f32_16x16x32_bf16 v[136:139], v[240:243], a[232:235], v[136:139]
    ds_read_b64_tr_b16 v[212:213], v18 offset:9344
    ds_read_b64_tr_b16 v[214:215], v18 offset:13952
    v_mfma_f32_16x16x32_bf16 v[140:143], v[240:243], a[236:239], v[140:143]
    v_mfma_f32_16x16x32_bf16 v[144:147], v[244:247], a[104:107], v[144:147]
    v_mfma_f32_16x16x32_bf16 v[148:151], v[244:247], a[108:111], v[148:151]
    v_mfma_f32_16x16x32_bf16 v[152:155], v[244:247], a[232:235], v[152:155]
    v_mfma_f32_16x16x32_bf16 v[156:159], v[244:247], a[236:239], v[156:159]
    s_waitcnt lgkmcnt(0)
    v_mfma_f32_16x16x32_bf16 v[128:131], v[208:211], a[112:115], v[128:131]
    ds_read_b64_tr_b16 v[240:241], v17 offset:18560
    ds_read_b64_tr_b16 v[242:243], v17 offset:23168
    v_mfma_f32_16x16x32_bf16 v[132:135], v[208:211], a[116:119], v[132:135]
    v_mfma_f32_16x16x32_bf16 v[136:139], v[208:211], a[240:243], v[136:139]
    ds_read_b64_tr_b16 v[244:245], v18 offset:18560
    ds_read_b64_tr_b16 v[246:247], v18 offset:23168
    v_mfma_f32_16x16x32_bf16 v[140:143], v[208:211], a[244:247], v[140:143]
    v_mfma_f32_16x16x32_bf16 v[144:147], v[212:215], a[112:115], v[144:147]
    v_mfma_f32_16x16x32_bf16 v[148:151], v[212:215], a[116:119], v[148:151]
    v_mfma_f32_16x16x32_bf16 v[152:155], v[212:215], a[240:243], v[152:155]
    v_mfma_f32_16x16x32_bf16 v[156:159], v[212:215], a[244:247], v[156:159]
    s_waitcnt lgkmcnt(0)
    v_mfma_f32_16x16x32_bf16 v[128:131], v[240:243], a[120:123], v[128:131]
    v_mfma_f32_16x16x32_bf16 v[132:135], v[240:243], a[124:127], v[132:135]
    s_lshl_b32 s42, s44, 2
    s_xor_b32 s42, s42, 131072
    v_mfma_f32_16x16x32_bf16 v[136:139], v[240:243], a[248:251], v[136:139]
    v_mfma_f32_16x16x32_bf16 v[140:143], v[240:243], a[252:255], v[140:143]
    s_add_u32 s42, s42, 4096
    buffer_load_dwordx4 v[64:67], v16, s[16:19], s42 offen offset:0 sc1
    v_mfma_f32_16x16x32_bf16 v[144:147], v[244:247], a[120:123], v[144:147]
    buffer_load_dwordx4 v[68:71], v16, s[16:19], s42 offen offset:1024 sc1
    v_mfma_f32_16x16x32_bf16 v[148:151], v[244:247], a[124:127], v[148:151]
    buffer_load_dwordx4 v[72:75], v16, s[16:19], s42 offen offset:2048 sc1
    v_mfma_f32_16x16x32_bf16 v[152:155], v[244:247], a[248:251], v[152:155]
    buffer_load_dwordx4 v[76:79], v16, s[16:19], s42 offen offset:3072 sc1
    v_mfma_f32_16x16x32_bf16 v[156:159], v[244:247], a[252:255], v[156:159]
    s_waitcnt lgkmcnt(0)
    v_mfma_f32_16x16x32_bf16 v[160:163], v[216:219], a[0:3], v[160:163]
    ds_read_b64_tr_b16 v[248:249], v19 offset:36992
    ds_read_b64_tr_b16 v[250:251], v19 offset:41600
    v_mfma_f32_16x16x32_bf16 v[164:167], v[216:219], a[4:7], v[164:167]
    v_mfma_f32_16x16x32_bf16 v[168:171], v[216:219], a[128:131], v[168:171]
    ds_read_b64_tr_b16 v[252:253], v20 offset:36992
    ds_read_b64_tr_b16 v[254:255], v20 offset:41600
    v_mfma_f32_16x16x32_bf16 v[172:175], v[216:219], a[132:135], v[172:175]
    v_mfma_f32_16x16x32_bf16 v[176:179], v[220:223], a[0:3], v[176:179]
    v_mfma_f32_16x16x32_bf16 v[180:183], v[220:223], a[4:7], v[180:183]
    v_cvt_pk_bf16_f32 v128, v128, v129
    v_cvt_pk_bf16_f32 v129, v130, v131
    v_mfma_f32_16x16x32_bf16 v[184:187], v[220:223], a[128:131], v[184:187]
    v_cvt_pk_bf16_f32 v130, v132, v133
    v_cvt_pk_bf16_f32 v131, v134, v135
    v_mfma_f32_16x16x32_bf16 v[188:191], v[220:223], a[132:135], v[188:191]
    s_waitcnt lgkmcnt(0)
    v_mfma_f32_16x16x32_bf16 v[160:163], v[248:251], a[8:11], v[160:163]
    ds_read_b64_tr_b16 v[216:217], v19 offset:46208
    ds_read_b64_tr_b16 v[218:219], v19 offset:50816
    v_mfma_f32_16x16x32_bf16 v[164:167], v[248:251], a[12:15], v[164:167]
    buffer_store_dwordx4 v[128:131], v16, s[16:19], s46 offen offset:0 sc1
    v_mfma_f32_16x16x32_bf16 v[168:171], v[248:251], a[136:139], v[168:171]
    ds_read_b64_tr_b16 v[220:221], v20 offset:46208
    ds_read_b64_tr_b16 v[222:223], v20 offset:50816
    v_mfma_f32_16x16x32_bf16 v[172:175], v[248:251], a[140:143], v[172:175]
    v_cvt_pk_bf16_f32 v132, v136, v137
    v_cvt_pk_bf16_f32 v133, v138, v139
    v_mfma_f32_16x16x32_bf16 v[176:179], v[252:255], a[8:11], v[176:179]
    v_cvt_pk_bf16_f32 v134, v140, v141
    v_cvt_pk_bf16_f32 v135, v142, v143
    v_mfma_f32_16x16x32_bf16 v[180:183], v[252:255], a[12:15], v[180:183]
    buffer_store_dwordx4 v[132:135], v16, s[16:19], s46 offen offset:1024 sc1
    v_mfma_f32_16x16x32_bf16 v[184:187], v[252:255], a[136:139], v[184:187]
    v_cvt_pk_bf16_f32 v136, v144, v145
    v_cvt_pk_bf16_f32 v137, v146, v147
    v_mfma_f32_16x16x32_bf16 v[188:191], v[252:255], a[140:143], v[188:191]
    s_waitcnt lgkmcnt(0)
    v_cvt_pk_bf16_f32 v138, v148, v149
    v_cvt_pk_bf16_f32 v139, v150, v151
    v_mfma_f32_16x16x32_bf16 v[160:163], v[216:219], a[16:19], v[160:163]
    ds_read_b64_tr_b16 v[248:249], v19 offset:55424
    ds_read_b64_tr_b16 v[250:251], v19 offset:60032
    v_mfma_f32_16x16x32_bf16 v[164:167], v[216:219], a[20:23], v[164:167]
    buffer_store_dwordx4 v[136:139], v16, s[16:19], s46 offen offset:2048 sc1
    v_mfma_f32_16x16x32_bf16 v[168:171], v[216:219], a[144:147], v[168:171]
    ds_read_b64_tr_b16 v[252:253], v20 offset:55424
    ds_read_b64_tr_b16 v[254:255], v20 offset:60032
    v_mfma_f32_16x16x32_bf16 v[172:175], v[216:219], a[148:151], v[172:175]
    v_cvt_pk_bf16_f32 v140, v152, v153
    v_cvt_pk_bf16_f32 v141, v154, v155
    v_mfma_f32_16x16x32_bf16 v[176:179], v[220:223], a[16:19], v[176:179]
    v_cvt_pk_bf16_f32 v142, v156, v157
    v_cvt_pk_bf16_f32 v143, v158, v159
    v_mfma_f32_16x16x32_bf16 v[180:183], v[220:223], a[20:23], v[180:183]
    buffer_store_dwordx4 v[140:143], v16, s[16:19], s46 offen offset:3072 sc1
    v_mfma_f32_16x16x32_bf16 v[184:187], v[220:223], a[144:147], v[184:187]
    s_add_u32 s46, s46, 4096
    v_mfma_f32_16x16x32_bf16 v[188:191], v[220:223], a[148:151], v[188:191]
    s_waitcnt lgkmcnt(0)
    v_mfma_f32_16x16x32_bf16 v[160:163], v[248:251], a[24:27], v[160:163]
    v_add_u32 v17, 64512, v17
    v_add_u32 v18, 64512, v18
    v_mfma_f32_16x16x32_bf16 v[164:167], v[248:251], a[28:31], v[164:167]
    v_add_u32 v19, 64512, v19
    v_add_u32 v20, 64512, v20
    v_mfma_f32_16x16x32_bf16 v[168:171], v[248:251], a[152:155], v[168:171]
    ds_read_b64_tr_b16 v[216:217], v19 offset:128
    ds_read_b64_tr_b16 v[218:219], v19 offset:4736
    v_mfma_f32_16x16x32_bf16 v[172:175], v[248:251], a[156:159], v[172:175]
    ds_read_b64_tr_b16 v[220:221], v20 offset:128
    ds_read_b64_tr_b16 v[222:223], v20 offset:4736
    v_mfma_f32_16x16x32_bf16 v[176:179], v[252:255], a[24:27], v[176:179]
    v_mfma_f32_16x16x32_bf16 v[180:183], v[252:255], a[28:31], v[180:183]
    v_mfma_f32_16x16x32_bf16 v[184:187], v[252:255], a[152:155], v[184:187]
    v_mfma_f32_16x16x32_bf16 v[188:191], v[252:255], a[156:159], v[188:191]
    s_waitcnt lgkmcnt(0)
    v_mfma_f32_16x16x32_bf16 v[160:163], v[216:219], a[32:35], v[160:163]
    ds_read_b64_tr_b16 v[248:249], v19 offset:9344
    ds_read_b64_tr_b16 v[250:251], v19 offset:13952
    v_mfma_f32_16x16x32_bf16 v[164:167], v[216:219], a[36:39], v[164:167]
    v_mfma_f32_16x16x32_bf16 v[168:171], v[216:219], a[160:163], v[168:171]
    ds_read_b64_tr_b16 v[252:253], v20 offset:9344
    ds_read_b64_tr_b16 v[254:255], v20 offset:13952
    v_mfma_f32_16x16x32_bf16 v[172:175], v[216:219], a[164:167], v[172:175]
    v_mfma_f32_16x16x32_bf16 v[176:179], v[220:223], a[32:35], v[176:179]
    v_mfma_f32_16x16x32_bf16 v[180:183], v[220:223], a[36:39], v[180:183]
    v_mfma_f32_16x16x32_bf16 v[184:187], v[220:223], a[160:163], v[184:187]
    v_mfma_f32_16x16x32_bf16 v[188:191], v[220:223], a[164:167], v[188:191]
    s_waitcnt lgkmcnt(0)
    v_mfma_f32_16x16x32_bf16 v[160:163], v[248:251], a[40:43], v[160:163]
    v_add_u32 v17, 4294838272, v17
    v_add_u32 v18, 4294838272, v18
    v_mfma_f32_16x16x32_bf16 v[164:167], v[248:251], a[44:47], v[164:167]
    v_add_u32 v19, 4294838272, v19
    v_add_u32 v20, 4294838272, v20
    v_mfma_f32_16x16x32_bf16 v[168:171], v[248:251], a[168:171], v[168:171]
    ds_read_b64_tr_b16 v[216:217], v19 offset:128
    ds_read_b64_tr_b16 v[218:219], v19 offset:4736
    v_mfma_f32_16x16x32_bf16 v[172:175], v[248:251], a[172:175], v[172:175]
    ds_read_b64_tr_b16 v[220:221], v20 offset:128
    ds_read_b64_tr_b16 v[222:223], v20 offset:4736
    v_mfma_f32_16x16x32_bf16 v[176:179], v[252:255], a[40:43], v[176:179]
    s_waitcnt vmcnt(4)
    v_max3_u32 v15, v64, v65, v66
    v_max3_u32 v15, v15, v67, v68
    v_mfma_f32_16x16x32_bf16 v[180:183], v[252:255], a[44:47], v[180:183]
    v_max3_u32 v15, v15, v69, v70
    v_max3_u32 v15, v15, v71, v72
    v_mfma_f32_16x16x32_bf16 v[184:187], v[252:255], a[168:171], v[184:187]
    v_max3_u32 v15, v15, v73, v74
    v_max3_u32 v15, v15, v75, v76
    v_mfma_f32_16x16x32_bf16 v[188:191], v[252:255], a[172:175], v[188:191]
    s_waitcnt lgkmcnt(0)
    v_max3_u32 v15, v15, v77, v78
    v_max_u32 v15, v15, v79
    v_mfma_f32_16x16x32_bf16 v[160:163], v[216:219], a[48:51], v[160:163]
    ds_read_b64_tr_b16 v[248:249], v19 offset:9344
    ds_read_b64_tr_b16 v[250:251], v19 offset:13952
    v_mfma_f32_16x16x32_bf16 v[164:167], v[216:219], a[52:55], v[164:167]
    v_cmp_eq_u32 vcc, -1, v15
    v_mfma_f32_16x16x32_bf16 v[168:171], v[216:219], a[176:179], v[168:171]
    ds_read_b64_tr_b16 v[252:253], v20 offset:9344
    ds_read_b64_tr_b16 v[254:255], v20 offset:13952
    v_mfma_f32_16x16x32_bf16 v[172:175], v[216:219], a[180:183], v[172:175]
    v_mfma_f32_16x16x32_bf16 v[176:179], v[220:223], a[48:51], v[176:179]
    s_cbranch_vccnz gated_mix__ssm_conv_h3__compressed_kv_cla__prompt_kernel_spin_x2
gated_mix__ssm_conv_h3__compressed_kv_cla__prompt_kernel_spin_x2_ret:
    v_lshlrev_b32 v3, 16, v64
    v_fmac_f32 v40, v6, v3
    v_mfma_f32_16x16x32_bf16 v[180:183], v[220:223], a[52:55], v[180:183]
    v_and_b32 v4, s37, v64
    v_fmac_f32 v41, v6, v4
    v_mfma_f32_16x16x32_bf16 v[184:187], v[220:223], a[176:179], v[184:187]
    v_lshlrev_b32 v3, 16, v65
    v_fmac_f32 v42, v6, v3
    v_mfma_f32_16x16x32_bf16 v[188:191], v[220:223], a[180:183], v[188:191]
    s_waitcnt lgkmcnt(0)
    v_and_b32 v4, s37, v65
    v_fmac_f32 v43, v6, v4
    v_mfma_f32_16x16x32_bf16 v[160:163], v[248:251], a[56:59], v[160:163]
    ds_read_b64_tr_b16 v[216:217], v19 offset:18560
    ds_read_b64_tr_b16 v[218:219], v19 offset:23168
    v_mfma_f32_16x16x32_bf16 v[164:167], v[248:251], a[60:63], v[164:167]
    v_lshlrev_b32 v3, 16, v66
    v_fmac_f32 v44, v7, v3
    v_mfma_f32_16x16x32_bf16 v[168:171], v[248:251], a[184:187], v[168:171]
    ds_read_b64_tr_b16 v[220:221], v20 offset:18560
    ds_read_b64_tr_b16 v[222:223], v20 offset:23168
    v_mfma_f32_16x16x32_bf16 v[172:175], v[248:251], a[188:191], v[172:175]
    v_and_b32 v4, s37, v66
    v_fmac_f32 v45, v7, v4
    v_mfma_f32_16x16x32_bf16 v[176:179], v[252:255], a[56:59], v[176:179]
    v_lshlrev_b32 v3, 16, v67
    v_fmac_f32 v46, v7, v3
    v_mfma_f32_16x16x32_bf16 v[180:183], v[252:255], a[60:63], v[180:183]
    v_and_b32 v4, s37, v67
    v_fmac_f32 v47, v7, v4
    v_mfma_f32_16x16x32_bf16 v[184:187], v[252:255], a[184:187], v[184:187]
    v_lshlrev_b32 v3, 16, v68
    v_fmac_f32 v48, v11, v3
    v_mfma_f32_16x16x32_bf16 v[188:191], v[252:255], a[188:191], v[188:191]
    s_waitcnt lgkmcnt(0)
    v_and_b32 v4, s37, v68
    v_fmac_f32 v49, v11, v4
    v_mfma_f32_16x16x32_bf16 v[160:163], v[216:219], a[64:67], v[160:163]
    ds_read_b64_tr_b16 v[248:249], v19 offset:27776
    ds_read_b64_tr_b16 v[250:251], v19 offset:32384
    v_mfma_f32_16x16x32_bf16 v[164:167], v[216:219], a[68:71], v[164:167]
    v_lshlrev_b32 v3, 16, v69
    v_fmac_f32 v50, v11, v3
    v_mfma_f32_16x16x32_bf16 v[168:171], v[216:219], a[192:195], v[168:171]
    ds_read_b64_tr_b16 v[252:253], v20 offset:27776
    ds_read_b64_tr_b16 v[254:255], v20 offset:32384
    v_mfma_f32_16x16x32_bf16 v[172:175], v[216:219], a[196:199], v[172:175]
    v_and_b32 v4, s37, v69
    v_fmac_f32 v51, v11, v4
    v_mfma_f32_16x16x32_bf16 v[176:179], v[220:223], a[64:67], v[176:179]
    v_lshlrev_b32 v3, 16, v70
    v_fmac_f32 v52, v12, v3
    v_mfma_f32_16x16x32_bf16 v[180:183], v[220:223], a[68:71], v[180:183]
    v_and_b32 v4, s37, v70
    v_fmac_f32 v53, v12, v4
    v_mfma_f32_16x16x32_bf16 v[184:187], v[220:223], a[192:195], v[184:187]
    v_lshlrev_b32 v3, 16, v71
    v_fmac_f32 v54, v12, v3
    v_mfma_f32_16x16x32_bf16 v[188:191], v[220:223], a[196:199], v[188:191]
    s_waitcnt lgkmcnt(0)
    v_and_b32 v4, s37, v71
    v_fmac_f32 v55, v12, v4
    v_mfma_f32_16x16x32_bf16 v[160:163], v[248:251], a[72:75], v[160:163]
    ds_read_b64_tr_b16 v[216:217], v19 offset:36992
    ds_read_b64_tr_b16 v[218:219], v19 offset:41600
    v_mfma_f32_16x16x32_bf16 v[164:167], v[248:251], a[76:79], v[164:167]
    v_lshlrev_b32 v3, 16, v72
    v_fmac_f32 v24, v6, v3
    v_mfma_f32_16x16x32_bf16 v[168:171], v[248:251], a[200:203], v[168:171]
    ds_read_b64_tr_b16 v[220:221], v20 offset:36992
    ds_read_b64_tr_b16 v[222:223], v20 offset:41600
    v_mfma_f32_16x16x32_bf16 v[172:175], v[248:251], a[204:207], v[172:175]
    v_and_b32 v4, s37, v72
    v_fmac_f32 v25, v6, v4
    v_mfma_f32_16x16x32_bf16 v[176:179], v[252:255], a[72:75], v[176:179]
    v_lshlrev_b32 v3, 16, v73
    v_fmac_f32 v28, v6, v3
    v_mfma_f32_16x16x32_bf16 v[180:183], v[252:255], a[76:79], v[180:183]
    v_and_b32 v4, s37, v73
    v_fmac_f32 v29, v6, v4
    v_mfma_f32_16x16x32_bf16 v[184:187], v[252:255], a[200:203], v[184:187]
    v_lshlrev_b32 v3, 16, v74
    v_fmac_f32 v32, v7, v3
    v_mfma_f32_16x16x32_bf16 v[188:191], v[252:255], a[204:207], v[188:191]
    s_waitcnt lgkmcnt(0)
    v_and_b32 v4, s37, v74
    v_fmac_f32 v33, v7, v4
    v_mfma_f32_16x16x32_bf16 v[160:163], v[216:219], a[80:83], v[160:163]
    ds_read_b64_tr_b16 v[248:249], v19 offset:46208
    ds_read_b64_tr_b16 v[250:251], v19 offset:50816
    v_mfma_f32_16x16x32_bf16 v[164:167], v[216:219], a[84:87], v[164:167]
    s_lshl_b32 s41, s44, 2
    s_xor_b32 s41, s41, 65536
    v_mfma_f32_16x16x32_bf16 v[168:171], v[216:219], a[208:211], v[168:171]
    ds_read_b64_tr_b16 v[252:253], v20 offset:46208
    ds_read_b64_tr_b16 v[254:255], v20 offset:50816
    v_mfma_f32_16x16x32_bf16 v[172:175], v[216:219], a[212:215], v[172:175]
    s_add_u32 s41, s41, 8192
    buffer_load_dwordx4 v[96:99], v16, s[16:19], s41 offen offset:0 sc1
    v_mfma_f32_16x16x32_bf16 v[176:179], v[220:223], a[80:83], v[176:179]
    buffer_load_dwordx4 v[100:103], v16, s[16:19], s41 offen offset:1024 sc1
    v_mfma_f32_16x16x32_bf16 v[180:183], v[220:223], a[84:87], v[180:183]
    buffer_load_dwordx4 v[104:107], v16, s[16:19], s41 offen offset:2048 sc1
    v_mfma_f32_16x16x32_bf16 v[184:187], v[220:223], a[208:211], v[184:187]
    buffer_load_dwordx4 v[108:111], v16, s[16:19], s41 offen offset:3072 sc1
    v_mfma_f32_16x16x32_bf16 v[188:191], v[220:223], a[212:215], v[188:191]
    s_waitcnt lgkmcnt(0)
    v_lshlrev_b32 v3, 16, v75
    v_fmac_f32 v36, v7, v3
    v_mfma_f32_16x16x32_bf16 v[160:163], v[248:251], a[88:91], v[160:163]
    ds_read_b64_tr_b16 v[216:217], v19 offset:55424
    ds_read_b64_tr_b16 v[218:219], v19 offset:60032
    v_mfma_f32_16x16x32_bf16 v[164:167], v[248:251], a[92:95], v[164:167]
    v_and_b32 v4, s37, v75
    v_fmac_f32 v37, v7, v4
    v_mfma_f32_16x16x32_bf16 v[168:171], v[248:251], a[216:219], v[168:171]
    ds_read_b64_tr_b16 v[220:221], v20 offset:55424
    ds_read_b64_tr_b16 v[222:223], v20 offset:60032
    v_mfma_f32_16x16x32_bf16 v[172:175], v[248:251], a[220:223], v[172:175]
    v_lshlrev_b32 v3, 16, v76
    v_fmac_f32 v56, v11, v3
    v_mfma_f32_16x16x32_bf16 v[176:179], v[252:255], a[88:91], v[176:179]
    v_and_b32 v4, s37, v76
    v_fmac_f32 v57, v11, v4
    v_mfma_f32_16x16x32_bf16 v[180:183], v[252:255], a[92:95], v[180:183]
    v_lshlrev_b32 v3, 16, v77
    v_fmac_f32 v58, v11, v3
    v_mfma_f32_16x16x32_bf16 v[184:187], v[252:255], a[216:219], v[184:187]
    v_and_b32 v4, s37, v77
    v_fmac_f32 v59, v11, v4
    v_mfma_f32_16x16x32_bf16 v[188:191], v[252:255], a[220:223], v[188:191]
    s_waitcnt lgkmcnt(0)
    v_lshlrev_b32 v3, 16, v78
    v_fmac_f32 v26, v12, v3
    v_mfma_f32_16x16x32_bf16 v[160:163], v[216:219], a[96:99], v[160:163]
    v_add_u32 v17, 64512, v17
    v_add_u32 v18, 64512, v18
    v_mfma_f32_16x16x32_bf16 v[164:167], v[216:219], a[100:103], v[164:167]
    v_add_u32 v19, 64512, v19
    v_add_u32 v20, 64512, v20
    v_mfma_f32_16x16x32_bf16 v[168:171], v[216:219], a[224:227], v[168:171]
    ds_read_b64_tr_b16 v[248:249], v19 offset:128
    ds_read_b64_tr_b16 v[250:251], v19 offset:4736
    v_mfma_f32_16x16x32_bf16 v[172:175], v[216:219], a[228:231], v[172:175]
    ds_read_b64_tr_b16 v[252:253], v20 offset:128
    ds_read_b64_tr_b16 v[254:255], v20 offset:4736
    v_mfma_f32_16x16x32_bf16 v[176:179], v[220:223], a[96:99], v[176:179]
    v_and_b32 v4, s37, v78
    v_fmac_f32 v27, v12, v4
    v_mfma_f32_16x16x32_bf16 v[180:183], v[220:223], a[100:103], v[180:183]
    v_lshlrev_b32 v3, 16, v79
    v_fmac_f32 v30, v12, v3
    v_mfma_f32_16x16x32_bf16 v[184:187], v[220:223], a[224:227], v[184:187]
    v_and_b32 v4, s37, v79
    v_fmac_f32 v31, v12, v4
    v_mfma_f32_16x16x32_bf16 v[188:191], v[220:223], a[228:231], v[188:191]
    s_waitcnt lgkmcnt(0)
    v_mfma_f32_16x16x32_bf16 v[160:163], v[248:251], a[104:107], v[160:163]
    ds_read_b64_tr_b16 v[216:217], v19 offset:9344
    ds_read_b64_tr_b16 v[218:219], v19 offset:13952
    v_mfma_f32_16x16x32_bf16 v[164:167], v[248:251], a[108:111], v[164:167]
    v_mfma_f32_16x16x32_bf16 v[168:171], v[248:251], a[232:235], v[168:171]
    ds_read_b64_tr_b16 v[220:221], v20 offset:9344
    ds_read_b64_tr_b16 v[222:223], v20 offset:13952
    v_mfma_f32_16x16x32_bf16 v[172:175], v[248:251], a[236:239], v[172:175]
    v_mfma_f32_16x16x32_bf16 v[176:179], v[252:255], a[104:107], v[176:179]
    v_mfma_f32_16x16x32_bf16 v[180:183], v[252:255], a[108:111], v[180:183]
    v_mfma_f32_16x16x32_bf16 v[184:187], v[252:255], a[232:235], v[184:187]
    v_mfma_f32_16x16x32_bf16 v[188:191], v[252:255], a[236:239], v[188:191]
    s_waitcnt lgkmcnt(0)
    v_mfma_f32_16x16x32_bf16 v[160:163], v[216:219], a[112:115], v[160:163]
    ds_read_b64_tr_b16 v[248:249], v19 offset:18560
    ds_read_b64_tr_b16 v[250:251], v19 offset:23168
    v_mfma_f32_16x16x32_bf16 v[164:167], v[216:219], a[116:119], v[164:167]
    v_mfma_f32_16x16x32_bf16 v[168:171], v[216:219], a[240:243], v[168:171]
    ds_read_b64_tr_b16 v[252:253], v20 offset:18560
    ds_read_b64_tr_b16 v[254:255], v20 offset:23168
    v_mfma_f32_16x16x32_bf16 v[172:175], v[216:219], a[244:247], v[172:175]
    v_mfma_f32_16x16x32_bf16 v[176:179], v[220:223], a[112:115], v[176:179]
    v_mfma_f32_16x16x32_bf16 v[180:183], v[220:223], a[116:119], v[180:183]
    v_mfma_f32_16x16x32_bf16 v[184:187], v[220:223], a[240:243], v[184:187]
    v_mfma_f32_16x16x32_bf16 v[188:191], v[220:223], a[244:247], v[188:191]
    s_waitcnt lgkmcnt(0)
    v_mfma_f32_16x16x32_bf16 v[160:163], v[248:251], a[120:123], v[160:163]
    v_mfma_f32_16x16x32_bf16 v[164:167], v[248:251], a[124:127], v[164:167]
    v_mfma_f32_16x16x32_bf16 v[168:171], v[248:251], a[248:251], v[168:171]
    v_mfma_f32_16x16x32_bf16 v[172:175], v[248:251], a[252:255], v[172:175]
    v_mfma_f32_16x16x32_bf16 v[176:179], v[252:255], a[120:123], v[176:179]
    v_mfma_f32_16x16x32_bf16 v[180:183], v[252:255], a[124:127], v[180:183]
    v_mfma_f32_16x16x32_bf16 v[184:187], v[252:255], a[248:251], v[184:187]
    v_mfma_f32_16x16x32_bf16 v[188:191], v[252:255], a[252:255], v[188:191]
    s_waitcnt lgkmcnt(0)
    s_waitcnt vmcnt(0)
    v_max3_u32 v15, v96, v97, v98
    v_max3_u32 v15, v15, v99, v100
    v_max3_u32 v15, v15, v101, v102
    v_max3_u32 v15, v15, v103, v104
    v_max3_u32 v15, v15, v105, v106
    v_max3_u32 v15, v15, v107, v108
    v_max3_u32 v15, v15, v109, v110
    v_max_u32 v15, v15, v111
    v_cmp_eq_u32 vcc, -1, v15
    s_nop 0
    s_nop 0
    s_cbranch_vccnz gated_mix__ssm_conv_h3__compressed_kv_cla__prompt_kernel_spin_x1
gated_mix__ssm_conv_h3__compressed_kv_cla__prompt_kernel_spin_x1_ret:
    v_lshlrev_b32 v132, 16, v96
    v_and_b32 v133, s37, v96
    v_lshlrev_b32 v134, 16, v97
    v_and_b32 v135, s37, v97
    v_pk_add_f32 v[160:161], v[160:161], v[132:133]
    v_pk_add_f32 v[162:163], v[162:163], v[134:135]
    v_fma_f32 v160, v160, v6, v40
    v_fma_f32 v161, v161, v6, v41
    v_fma_f32 v162, v162, v6, v42
    v_fma_f32 v163, v163, v6, v43
    v_cvt_pk_bf16_f32 v112, v160, v161
    v_cvt_pk_bf16_f32 v113, v162, v163
    v_lshlrev_b32 v132, 16, v104
    v_and_b32 v133, s37, v104
    v_lshlrev_b32 v134, 16, v105
    v_and_b32 v135, s37, v105
    v_pk_add_f32 v[176:177], v[176:177], v[132:133]
    v_pk_add_f32 v[178:179], v[178:179], v[134:135]
    v_fma_f32 v176, v176, v6, v24
    v_fma_f32 v177, v177, v6, v25
    v_fma_f32 v178, v178, v6, v28
    v_fma_f32 v179, v179, v6, v29
    v_cvt_pk_bf16_f32 v114, v176, v177
    v_cvt_pk_bf16_f32 v115, v178, v179
    s_add_u32 s36, s48, 0
    v_permlane16_swap_b32 v112, v114
    v_permlane16_swap_b32 v113, v115
    buffer_store_dwordx4 v[112:115], v21, s[20:23], s36 offen
    v_lshlrev_b32 v132, 16, v98
    v_and_b32 v133, s37, v98
    v_lshlrev_b32 v134, 16, v99
    v_and_b32 v135, s37, v99
    v_pk_add_f32 v[164:165], v[164:165], v[132:133]
    v_pk_add_f32 v[166:167], v[166:167], v[134:135]
    v_fma_f32 v164, v164, v7, v44
    v_fma_f32 v165, v165, v7, v45
    v_fma_f32 v166, v166, v7, v46
    v_fma_f32 v167, v167, v7, v47
    v_cvt_pk_bf16_f32 v116, v164, v165
    v_cvt_pk_bf16_f32 v117, v166, v167
    v_lshlrev_b32 v132, 16, v106
    v_and_b32 v133, s37, v106
    v_lshlrev_b32 v134, 16, v107
    v_and_b32 v135, s37, v107
    v_pk_add_f32 v[180:181], v[180:181], v[132:133]
    v_pk_add_f32 v[182:183], v[182:183], v[134:135]
    v_fma_f32 v180, v180, v7, v32
    v_fma_f32 v181, v181, v7, v33
    v_fma_f32 v182, v182, v7, v36
    v_fma_f32 v183, v183, v7, v37
gated_mix__ssm_conv_h3__compressed_kv_cla__prompt_kernel_pad16:
    s_cbranch_execz gated_mix__ssm_conv_h3__compressed_kv_cla__prompt_kernel_back
    v_cvt_pk_bf16_f32 v118, v180, v181
    v_cvt_pk_bf16_f32 v119, v182, v183
    s_add_u32 s36, s48, 131072
    v_permlane16_swap_b32 v116, v118
    v_permlane16_swap_b32 v117, v119
    buffer_store_dwordx4 v[116:119], v21, s[20:23], s36 offen
    v_lshlrev_b32 v132, 16, v100
    v_and_b32 v133, s37, v100
    v_lshlrev_b32 v134, 16, v101
    v_and_b32 v135, s37, v101
    v_pk_add_f32 v[168:169], v[168:169], v[132:133]
    v_pk_add_f32 v[170:171], v[170:171], v[134:135]
    v_fma_f32 v168, v168, v11, v48
    v_fma_f32 v169, v169, v11, v49
    v_fma_f32 v170, v170, v11, v50
    v_fma_f32 v171, v171, v11, v51
    v_cvt_pk_bf16_f32 v112, v168, v169
    v_cvt_pk_bf16_f32 v113, v170, v171
    v_lshlrev_b32 v132, 16, v108
    v_and_b32 v133, s37, v108
    v_lshlrev_b32 v134, 16, v109
    v_and_b32 v135, s37, v109
    v_pk_add_f32 v[184:185], v[184:185], v[132:133]
    v_pk_add_f32 v[186:187], v[186:187], v[134:135]
    v_fma_f32 v184, v184, v11, v56
    v_fma_f32 v185, v185, v11, v57
    v_fma_f32 v186, v186, v11, v58
    v_fma_f32 v187, v187, v11, v59
    v_cvt_pk_bf16_f32 v114, v184, v185
    v_cvt_pk_bf16_f32 v115, v186, v187
    s_add_u32 s36, s48, 2097152
    v_permlane16_swap_b32 v112, v114
    v_permlane16_swap_b32 v113, v115
    buffer_store_dwordx4 v[112:115], v21, s[20:23], s36 offen
    v_lshlrev_b32 v132, 16, v102
    v_and_b32 v133, s37, v102
    v_lshlrev_b32 v134, 16, v103
    v_and_b32 v135, s37, v103
    v_pk_add_f32 v[172:173], v[172:173], v[132:133]
    v_pk_add_f32 v[174:175], v[174:175], v[134:135]
    v_fma_f32 v172, v172, v12, v52
    v_fma_f32 v173, v173, v12, v53
    v_fma_f32 v174, v174, v12, v54
    v_fma_f32 v175, v175, v12, v55
    v_cvt_pk_bf16_f32 v116, v172, v173
    v_cvt_pk_bf16_f32 v117, v174, v175
    v_lshlrev_b32 v132, 16, v110
    v_and_b32 v133, s37, v110
    v_lshlrev_b32 v134, 16, v111
    v_and_b32 v135, s37, v111
    v_pk_add_f32 v[188:189], v[188:189], v[132:133]
    v_pk_add_f32 v[190:191], v[190:191], v[134:135]
    v_fma_f32 v188, v188, v12, v26
    v_fma_f32 v189, v189, v12, v27
    v_fma_f32 v190, v190, v12, v30
    v_fma_f32 v191, v191, v12, v31
    v_cvt_pk_bf16_f32 v118, v188, v189
    v_cvt_pk_bf16_f32 v119, v190, v191
    s_add_u32 s36, s48, 2228224
    v_permlane16_swap_b32 v116, v118
    v_permlane16_swap_b32 v117, v119
    buffer_store_dwordx4 v[116:119], v21, s[20:23], s36 offen
gated_mix__ssm_conv_h3__compressed_kv_cla__prompt_kernel_end:
    s_endpgm
gated_mix__ssm_conv_h3__compressed_kv_cla__prompt_kernel_wb:
    v_bfe_u32 v3, v16, 1, 8
    s_branch gated_mix__ssm_conv_h3__compressed_kv_cla__prompt_kernel_wbs
gated_mix__ssm_conv_h3__compressed_kv_cla__prompt_kernel_wbs_ret:
    v_bfe_u32 v3, v16, 2, 5
    buffer_wbl2 sc1
    s_waitcnt vmcnt(0)
    s_branch gated_mix__ssm_conv_h3__compressed_kv_cla__prompt_kernel_wb_ret
gated_mix__ssm_conv_h3__compressed_kv_cla__prompt_kernel_wbs:
    s_mov_b32 s54, 0
gated_mix__ssm_conv_h3__compressed_kv_cla__prompt_kernel_wbs_again:
    s_sleep 2
    buffer_load_dword v9, v3, s[76:79], 0 offen sc1
    s_waitcnt vmcnt(0)
    v_and_b32 v11, v10, v9
    v_lshrrev_b32 v12, 4, v9
    v_and_b32 v12, v10, v12
    v_sad_u8 v11, v11, 0, 0
    v_sad_u8 v11, v12, 0, v11
    v_cmp_ne_u32 vcc, 8, v11
    s_add_u32 s54, s54, 1
    s_cmp_gt_u32 s54, 0x40000
    s_cbranch_scc1 gated_mix__ssm_conv_h3__compressed_kv_cla__prompt_kernel_wbs_ret
    s_cbranch_vccnz gated_mix__ssm_conv_h3__compressed_kv_cla__prompt_kernel_wbs_again
    s_branch gated_mix__ssm_conv_h3__compressed_kv_cla__prompt_kernel_wbs_ret
gated_mix__ssm_conv_h3__compressed_kv_cla__prompt_kernel_spin_kv:
    s_mov_b32 s54, 0
gated_mix__ssm_conv_h3__compressed_kv_cla__prompt_kernel_spin_kv_again:
    s_sleep 2
    buffer_load_dword v2, v3, s[28:31], s40 offen sc1
    s_waitcnt vmcnt(0)
    v_cmp_ne_u32 vcc, 1, v2
    s_add_u32 s54, s54, 1
    s_cmp_gt_u32 s54, 0x40000
    s_cbranch_scc1 gated_mix__ssm_conv_h3__compressed_kv_cla__prompt_kernel_spin_kv_ret
    s_cbranch_vccnz gated_mix__ssm_conv_h3__compressed_kv_cla__prompt_kernel_spin_kv_again
    s_branch gated_mix__ssm_conv_h3__compressed_kv_cla__prompt_kernel_spin_kv_ret
gated_mix__ssm_conv_h3__compressed_kv_cla__prompt_kernel_b4_sw:
    s_waitcnt vmcnt(8)
    v_and_b32 v17, v28, v29
    v_and_b32 v18, v30, v31
    v_and_b32 v17, v17, v18
    v_cmp_ne_u32 vcc, 1, v17
    s_mov_b32 s58, s35
    s_cbranch_vccnz gated_mix__ssm_conv_h3__compressed_kv_cla__prompt_kernel_b4_sw_spin
gated_mix__ssm_conv_h3__compressed_kv_cla__prompt_kernel_b4_sw_spin_ret:
    s_lshl_b32 s36, s2, 2
    s_cmp_eq_u32 s32, 0
    s_cbranch_scc1 gated_mix__ssm_conv_h3__compressed_kv_cla__prompt_kernel_b4_sw_h
    s_add_u32 s12, s94, 50331648
    s_addc_u32 s13, s95, 0
    s_mov_b32 s14, 4718592
    s_mov_b32 s15, 0x00020000
    s_mul_i32 s38, s36, 4608
    s_movk_i32 s44, 4608
    s_mov_b32 s49, -2
    s_movk_i32 s50, 4640
    s_lshl_b32 s37, s32, 2
    s_sub_u32 s37, 10, s37
    s_add_u32 s38, s38, s37
    s_mul_i32 s59, s32, 9280
    s_add_u32 s59, s59, 4294966496
    s_cmp_eq_u32 s32, 3
    s_cbranch_scc0 gated_mix__ssm_conv_h3__compressed_kv_cla__prompt_kernel_b4_sw_go
    s_mov_b32 s14, 0
    s_mov_b32 s38, 2
    s_mov_b32 s59, 163840
    s_mov_b32 s50, 0
    s_branch gated_mix__ssm_conv_h3__compressed_kv_cla__prompt_kernel_b4_sw_go
gated_mix__ssm_conv_h3__compressed_kv_cla__prompt_kernel_b4_sw_h:
    s_mov_b32 s12, s72
    s_mov_b32 s13, s73
    s_mov_b32 s14, 4194304
    s_mov_b32 s15, 0x00020000
    s_lshl_b32 s38, s36, 12
    s_movk_i32 s44, 4096
    s_mov_b32 s49, 8
    s_movk_i32 s50, 4240
    s_movk_i32 s59, 128
gated_mix__ssm_conv_h3__compressed_kv_cla__prompt_kernel_b4_sw_go:
    s_mov_b32 s40, s59
    s_add_u32 s41, s59, s50
    s_movk_i32 s48, -5728
    s_add_u32 s59, s59, s48
    s_branch gated_mix__ssm_conv_h3__compressed_kv_cla__prompt_kernel_b4_loop
gated_mix__ssm_conv_h3__compressed_kv_cla__prompt_kernel_b4_sw_spin:
    s_mov_b32 s54, 0
gated_mix__ssm_conv_h3__compressed_kv_cla__prompt_kernel_b4_sw_spin_again:
    s_sleep 2
    buffer_load_dwordx4 v[28:31], v14, s[28:31], s47 offen sc1
    s_waitcnt vmcnt(0)
    v_and_b32 v17, v28, v29
    v_and_b32 v18, v30, v31
    v_and_b32 v17, v17, v18
    v_cmp_ne_u32 vcc, 1, v17
    s_add_u32 s54, s54, 1
    s_cmp_gt_u32 s54, 0x40000
    s_cbranch_scc1 gated_mix__ssm_conv_h3__compressed_kv_cla__prompt_kernel_b4_sw_spin_ret
    s_cbranch_vccnz gated_mix__ssm_conv_h3__compressed_kv_cla__prompt_kernel_b4_sw_spin_again
    s_branch gated_mix__ssm_conv_h3__compressed_kv_cla__prompt_kernel_b4_sw_spin_ret
gated_mix__ssm_conv_h3__compressed_kv_cla__prompt_kernel_spin_all:
    s_mov_b32 s54, 0
gated_mix__ssm_conv_h3__compressed_kv_cla__prompt_kernel_spin_all_again:
    s_sleep 2
    buffer_load_dwordx4 v[28:31], v14, s[28:31], s47 offen sc1
    s_waitcnt vmcnt(0)
    v_and_b32 v17, v28, v29
    v_and_b32 v18, v30, v31
    v_and_b32 v17, v17, v18
    v_cmp_ne_u32 vcc, 1, v17
    s_add_u32 s54, s54, 1
    s_cmp_gt_u32 s54, 0x40000
    s_cbranch_scc1 gated_mix__ssm_conv_h3__compressed_kv_cla__prompt_kernel_spin_all_ret
    s_cbranch_vccnz gated_mix__ssm_conv_h3__compressed_kv_cla__prompt_kernel_spin_all_again
    s_branch gated_mix__ssm_conv_h3__compressed_kv_cla__prompt_kernel_spin_all_ret
gated_mix__ssm_conv_h3__compressed_kv_cla__prompt_kernel_b2_sw:
gated_mix__ssm_conv_h3__compressed_kv_cla__prompt_kernel_pad17:
    s_cbranch_execz gated_mix__ssm_conv_h3__compressed_kv_cla__prompt_kernel_back
    s_waitcnt vmcnt(8)
    v_and_b32 v17, v28, v29
    v_and_b32 v18, v30, v31
    v_and_b32 v17, v17, v18
    v_cmp_ne_u32 vcc, 1, v17
    s_mov_b32 s58, s35
    s_cbranch_vccnz gated_mix__ssm_conv_h3__compressed_kv_cla__prompt_kernel_b2_sw_spin
gated_mix__ssm_conv_h3__compressed_kv_cla__prompt_kernel_b2_sw_spin_ret:
    v_mov_b32 v0, 0
    v_mov_b32 v1, 1
    buffer_store_dword v1, v0, s[28:31], s55 offen sc1
    s_lshl_b32 s36, s2, 2
    s_cmp_eq_u32 s32, 0
    s_cbranch_scc1 gated_mix__ssm_conv_h3__compressed_kv_cla__prompt_kernel_b2_sw_h
    s_add_u32 s12, s94, 50331648
    s_addc_u32 s13, s95, 0
    s_mov_b32 s14, 4718592
    s_mov_b32 s15, 0x00020000
    s_mul_i32 s38, s36, 4608
    s_movk_i32 s44, 4608
    s_mov_b32 s49, -2
    s_movk_i32 s50, 4640
    s_lshl_b32 s37, s32, 2
    s_sub_u32 s37, 10, s37
    s_add_u32 s38, s38, s37
    s_mul_i32 s59, s32, 9280
    s_add_u32 s59, s59, 4294966496
    s_cmp_eq_u32 s32, 3
    s_cbranch_scc0 gated_mix__ssm_conv_h3__compressed_kv_cla__prompt_kernel_b2_sw_go
    s_mov_b32 s14, 0
    s_mov_b32 s38, 2
    s_mov_b32 s59, 163840
    s_mov_b32 s50, 0
    s_branch gated_mix__ssm_conv_h3__compressed_kv_cla__prompt_kernel_b2_sw_go
gated_mix__ssm_conv_h3__compressed_kv_cla__prompt_kernel_b2_sw_h:
gated_mix__ssm_conv_h3__compressed_kv_cla__prompt_kernel_pad18:
    s_cbranch_execz gated_mix__ssm_conv_h3__compressed_kv_cla__prompt_kernel_back
    s_mov_b32 s12, s72
    s_mov_b32 s13, s73
    s_mov_b32 s14, 4194304
    s_mov_b32 s15, 0x00020000
    s_lshl_b32 s38, s36, 12
    s_movk_i32 s44, 4096
    s_mov_b32 s49, 8
    s_movk_i32 s50, 4240
    s_movk_i32 s59, 128
gated_mix__ssm_conv_h3__compressed_kv_cla__prompt_kernel_b2_sw_go:
    s_mov_b32 s40, s59
    s_add_u32 s41, s59, s50
    s_movk_i32 s48, -5728
    s_add_u32 s59, s59, s48
    s_branch gated_mix__ssm_conv_h3__compressed_kv_cla__prompt_kernel_b2_loop
gated_mix__ssm_conv_h3__compressed_kv_cla__prompt_kernel_b2_sw_spin:
    s_mov_b32 s54, 0
gated_mix__ssm_conv_h3__compressed_kv_cla__prompt_kernel_b2_sw_spin_again:
    s_sleep 2
    buffer_load_dwordx4 v[28:31], v14, s[28:31], s47 offen sc1
    s_waitcnt vmcnt(0)
    v_and_b32 v17, v28, v29
    v_and_b32 v18, v30, v31
    v_and_b32 v17, v17, v18
    v_cmp_ne_u32 vcc, 1, v17
    s_add_u32 s54, s54, 1
    s_cmp_gt_u32 s54, 0x40000
    s_cbranch_scc1 gated_mix__ssm_conv_h3__compressed_kv_cla__prompt_kernel_b2_sw_spin_ret
    s_cbranch_vccnz gated_mix__ssm_conv_h3__compressed_kv_cla__prompt_kernel_b2_sw_spin_again
    s_branch gated_mix__ssm_conv_h3__compressed_kv_cla__prompt_kernel_b2_sw_spin_ret
gated_mix__ssm_conv_h3__compressed_kv_cla__prompt_kernel_b4_m0:
gated_mix__ssm_conv_h3__compressed_kv_cla__prompt_kernel_pad19:
    s_cbranch_execz gated_mix__ssm_conv_h3__compressed_kv_cla__prompt_kernel_back
    v_add_f32 v144, v48, v144
    v_add_f32 v145, v49, v145
    v_add_f32 v146, v50, v146
    v_add_f32 v147, v51, v147
    v_add_f32 v148, v52, v148
    v_add_f32 v149, v53, v149
    v_add_f32 v150, v54, v150
    v_add_f32 v151, v55, v151
    s_branch gated_mix__ssm_conv_h3__compressed_kv_cla__prompt_kernel_b4_m0_ret
gated_mix__ssm_conv_h3__compressed_kv_cla__prompt_kernel_b4_m1:
gated_mix__ssm_conv_h3__compressed_kv_cla__prompt_kernel_pad20:
    s_cbranch_execz gated_mix__ssm_conv_h3__compressed_kv_cla__prompt_kernel_back
    v_add_f32 v176, v56, v176
    v_add_f32 v177, v57, v177
    v_add_f32 v178, v58, v178
    v_add_f32 v179, v59, v179
    v_add_f32 v180, v60, v180
    v_add_f32 v181, v61, v181
    v_add_f32 v182, v62, v182
    v_add_f32 v183, v63, v183
    s_branch gated_mix__ssm_conv_h3__compressed_kv_cla__prompt_kernel_b4_m1_ret
gated_mix__ssm_conv_h3__compressed_kv_cla__prompt_kernel_b2_m0:
gated_mix__ssm_conv_h3__compressed_kv_cla__prompt_kernel_pad21:
    s_cbranch_execz gated_mix__ssm_conv_h3__compressed_kv_cla__prompt_kernel_back
    v_add_f32 v160, v48, v160
    v_add_f32 v161, v49, v161
    v_add_f32 v162, v50, v162
    v_add_f32 v163, v51, v163
    v_add_f32 v164, v52, v164
    v_add_f32 v165, v53, v165
    v_add_f32 v166, v54, v166
    v_add_f32 v167, v55, v167
    s_branch gated_mix__ssm_conv_h3__compressed_kv_cla__prompt_kernel_b2_m0_ret
gated_mix__ssm_conv_h3__compressed_kv_cla__prompt_kernel_b2_m1:
gated_mix__ssm_conv_h3__compressed_kv_cla__prompt_kernel_pad22:
    s_cbranch_execz gated_mix__ssm_conv_h3__compressed_kv_cla__prompt_kernel_back
    v_add_f32 v192, v56, v192
    v_add_f32 v193, v57, v193
    v_add_f32 v194, v58, v194
    v_add_f32 v195, v59, v195
    v_add_f32 v196, v60, v196
    v_add_f32 v197, v61, v197
    v_add_f32 v198, v62, v198
    v_add_f32 v199, v63, v199
    s_branch gated_mix__ssm_conv_h3__compressed_kv_cla__prompt_kernel_b2_m1_ret
gated_mix__ssm_conv_h3__compressed_kv_cla__prompt_kernel_b2_m2:
gated_mix__ssm_conv_h3__compressed_kv_cla__prompt_kernel_pad23:
    s_cbranch_execz gated_mix__ssm_conv_h3__compressed_kv_cla__prompt_kernel_back
    s_nop 5
    v_add_f32 v168, v48, v168
    v_add_f32 v169, v49, v169
    v_add_f32 v170, v50, v170
    v_add_f32 v171, v51, v171
    v_add_f32 v172, v52, v172
    v_add_f32 v173, v53, v173
    v_add_f32 v174, v54, v174
    v_add_f32 v175, v55, v175
    s_branch gated_mix__ssm_conv_h3__compressed_kv_cla__prompt_kernel_b2_m2_ret
gated_mix__ssm_conv_h3__compressed_kv_cla__prompt_kernel_spin_s:
    s_mov_b32 s54, 0
gated_mix__ssm_conv_h3__compressed_kv_cla__prompt_kernel_spin_s_again:
    s_sleep 2
    buffer_load_dword v14, v13, s[28:31], s52 offen sc1
    s_waitcnt vmcnt(0)
    v_cmp_ne_u32 vcc, 1, v14
    s_add_u32 s54, s54, 1
    s_cmp_gt_u32 s54, 0x40000
    s_cbranch_scc1 gated_mix__ssm_conv_h3__compressed_kv_cla__prompt_kernel_spin_s_ret
    s_cbranch_vccnz gated_mix__ssm_conv_h3__compressed_kv_cla__prompt_kernel_spin_s_again
    s_branch gated_mix__ssm_conv_h3__compressed_kv_cla__prompt_kernel_spin_s_ret
gated_mix__ssm_conv_h3__compressed_kv_cla__prompt_kernel_spin_l:
    s_mov_b32 s54, 0
gated_mix__ssm_conv_h3__compressed_kv_cla__prompt_kernel_spin_l_again:
    s_sleep 2
    buffer_load_dword v14, v13, s[28:31], s52 offen sc1
    s_waitcnt vmcnt(0)
    v_cmp_ne_u32 vcc, 1, v14
    s_add_u32 s54, s54, 1
    s_cmp_gt_u32 s54, 0x40000
    s_cbranch_scc1 gated_mix__ssm_conv_h3__compressed_kv_cla__prompt_kernel_spin_l_ret
    s_cbranch_vccnz gated_mix__ssm_conv_h3__compressed_kv_cla__prompt_kernel_spin_l_again
    s_branch gated_mix__ssm_conv_h3__compressed_kv_cla__prompt_kernel_spin_l_ret
gated_mix__ssm_conv_h3__compressed_kv_cla__prompt_kernel_spin_y:
    s_mov_b32 s54, 0
gated_mix__ssm_conv_h3__compressed_kv_cla__prompt_kernel_spin_y_again:
    s_sleep 2
    buffer_load_dword v14, v13, s[28:31], 0 offen sc1
    s_waitcnt vmcnt(0)
    v_cmp_ne_u32 vcc, 1, v14
    s_add_u32 s54, s54, 1
    s_cmp_gt_u32 s54, 0x40000
    s_cbranch_scc1 gated_mix__ssm_conv_h3__compressed_kv_cla__prompt_kernel_spin_y_ret
    s_cbranch_vccnz gated_mix__ssm_conv_h3__compressed_kv_cla__prompt_kernel_spin_y_again
    s_branch gated_mix__ssm_conv_h3__compressed_kv_cla__prompt_kernel_spin_y_ret
gated_mix__ssm_conv_h3__compressed_kv_cla__prompt_kernel_spin_x3:
    s_mov_b32 s54, 0
gated_mix__ssm_conv_h3__compressed_kv_cla__prompt_kernel_spin_x3_again:
    s_sleep 2
    buffer_load_dwordx4 v[80:83], v16, s[16:19], s52 offen offset:0 sc1
    buffer_load_dwordx4 v[84:87], v16, s[16:19], s52 offen offset:1024 sc1
    buffer_load_dwordx4 v[88:91], v16, s[16:19], s52 offen offset:2048 sc1
    buffer_load_dwordx4 v[92:95], v16, s[16:19], s52 offen offset:3072 sc1
    s_waitcnt vmcnt(0)
    v_max3_u32 v15, v80, v81, v82
    v_max3_u32 v15, v15, v83, v84
    v_max3_u32 v15, v15, v85, v86
    v_max3_u32 v15, v15, v87, v88
    v_max3_u32 v15, v15, v89, v90
    v_max3_u32 v15, v15, v91, v92
    v_max3_u32 v15, v15, v93, v94
    v_max_u32 v15, v15, v95
    v_cmp_eq_u32 vcc, -1, v15
    s_add_u32 s54, s54, 1
    s_cmp_gt_u32 s54, 0x40000
    s_cbranch_scc1 gated_mix__ssm_conv_h3__compressed_kv_cla__prompt_kernel_spin_x3_ret
    s_cbranch_vccnz gated_mix__ssm_conv_h3__compressed_kv_cla__prompt_kernel_spin_x3_again
    s_branch gated_mix__ssm_conv_h3__compressed_kv_cla__prompt_kernel_spin_x3_ret
gated_mix__ssm_conv_h3__compressed_kv_cla__prompt_kernel_spin_x2:
    s_mov_b32 s54, 0
gated_mix__ssm_conv_h3__compressed_kv_cla__prompt_kernel_spin_x2_again:
    s_sleep 2
    buffer_load_dwordx4 v[64:67], v16, s[16:19], s42 offen offset:0 sc1
    buffer_load_dwordx4 v[68:71], v16, s[16:19], s42 offen offset:1024 sc1
    buffer_load_dwordx4 v[72:75], v16, s[16:19], s42 offen offset:2048 sc1
    buffer_load_dwordx4 v[76:79], v16, s[16:19], s42 offen offset:3072 sc1
    s_waitcnt vmcnt(0)
    v_max3_u32 v15, v64, v65, v66
    v_max3_u32 v15, v15, v67, v68
    v_max3_u32 v15, v15, v69, v70
    v_max3_u32 v15, v15, v71, v72
    v_max3_u32 v15, v15, v73, v74
    v_max3_u32 v15, v15, v75, v76
    v_max3_u32 v15, v15, v77, v78
    v_max_u32 v15, v15, v79
    v_cmp_eq_u32 vcc, -1, v15
    s_add_u32 s54, s54, 1
    s_cmp_gt_u32 s54, 0x40000
    s_cbranch_scc1 gated_mix__ssm_conv_h3__compressed_kv_cla__prompt_kernel_spin_x2_ret
    s_cbranch_vccnz gated_mix__ssm_conv_h3__compressed_kv_cla__prompt_kernel_spin_x2_again
    s_branch gated_mix__ssm_conv_h3__compressed_kv_cla__prompt_kernel_spin_x2_ret
gated_mix__ssm_conv_h3__compressed_kv_cla__prompt_kernel_spin_x1:
    s_mov_b32 s54, 0
gated_mix__ssm_conv_h3__compressed_kv_cla__prompt_kernel_spin_x1_again:
    s_sleep 2
    buffer_load_dwordx4 v[96:99], v16, s[16:19], s41 offen offset:0 sc1
    buffer_load_dwordx4 v[100:103], v16, s[16:19], s41 offen offset:1024 sc1
    buffer_load_dwordx4 v[104:107], v16, s[16:19], s41 offen offset:2048 sc1
    buffer_load_dwordx4 v[108:111], v16, s[16:19], s41 offen offset:3072 sc1
    s_waitcnt vmcnt(0)
    v_max3_u32 v15, v96, v97, v98
    v_max3_u32 v15, v15, v99, v100
    v_max3_u32 v15, v15, v101, v102
    v_max3_u32 v15, v15, v103, v104
    v_max3_u32 v15, v15, v105, v106
    v_max3_u32 v15, v15, v107, v108
    v_max3_u32 v15, v15, v109, v110
    v_max_u32 v15, v15, v111
    v_cmp_eq_u32 vcc, -1, v15
    s_add_u32 s54, s54, 1
    s_cmp_gt_u32 s54, 0x40000
    s_cbranch_scc1 gated_mix__ssm_conv_h3__compressed_kv_cla__prompt_kernel_spin_x1_ret
    s_cbranch_vccnz gated_mix__ssm_conv_h3__compressed_kv_cla__prompt_kernel_spin_x1_again
    s_branch gated_mix__ssm_conv_h3__compressed_kv_cla__prompt_kernel_spin_x1_ret
gated_mix__ssm_conv_h3__compressed_kv_cla__prompt_kernel_hotend:
gated_mix__ssm_conv_h3__compressed_kv_cla__prompt_kernel_b4_r0:
    s_nop 7
    v_max3_f32 v32, v144, v145, v146
    v_max3_f32 v32, v147, v148, v32
    v_max3_f32 v32, v149, v150, v32
    v_max_f32 v32, v151, v32
    v_mov_b32 v33, v32
    s_nop 1
    v_permlane16_swap_b32 v32, v33
    s_nop 1
    v_max_f32 v32, v32, v33
    v_mov_b32 v33, v32
    s_nop 1
    v_permlane32_swap_b32 v32, v33
    s_nop 1
    v_max_f32 v32, v32, v33
    v_add_f32 v32, 0x41c00000, v32
    v_max_f32 v32, 0, v32
    v_exp_f32 v34, -v32
    v_sub_f32 v64, v64, v32
    v_sub_f32 v65, v65, v32
    v_sub_f32 v66, v66, v32
    v_sub_f32 v67, v67, v32
    v_sub_f32 v144, v144, v32
    v_sub_f32 v145, v145, v32
    v_sub_f32 v146, v146, v32
    v_sub_f32 v147, v147, v32
    v_sub_f32 v148, v148, v32
    v_sub_f32 v149, v149, v32
    v_sub_f32 v150, v150, v32
    v_sub_f32 v151, v151, v32
    v_sub_f32 v176, v176, v32
    v_sub_f32 v177, v177, v32
    v_sub_f32 v178, v178, v32
    v_sub_f32 v179, v179, v32
    v_sub_f32 v180, v180, v32
    v_sub_f32 v181, v181, v32
    v_sub_f32 v182, v182, v32
    v_sub_f32 v183, v183, v32
    v_mul_f32 v240, v240, v34
    v_mul_f32 v241, v241, v34
    v_mul_f32 v242, v242, v34
    v_mul_f32 v243, v243, v34
    v_accvgpr_read_b32 v33, a0
    v_mul_f32 v33, v33, v34
    v_accvgpr_write_b32 a0, v33
    v_accvgpr_read_b32 v33, a1
    v_mul_f32 v33, v33, v34
    v_accvgpr_write_b32 a1, v33
    v_accvgpr_read_b32 v33, a2
    v_mul_f32 v33, v33, v34
    v_accvgpr_write_b32 a2, v33
    v_accvgpr_read_b32 v33, a3
    v_mul_f32 v33, v33, v34
    v_accvgpr_write_b32 a3, v33
    v_accvgpr_read_b32 v33, a4
    v_mul_f32 v33, v33, v34
    v_accvgpr_write_b32 a4, v33
    v_accvgpr_read_b32 v33, a5
    v_mul_f32 v33, v33, v34
    v_accvgpr_write_b32 a5, v33
    v_accvgpr_read_b32 v33, a6
    v_mul_f32 v33, v33, v34
    v_accvgpr_write_b32 a6, v33
    v_accvgpr_read_b32 v33, a7
    v_mul_f32 v33, v33, v34
    v_accvgpr_write_b32 a7, v33
    v_accvgpr_read_b32 v33, a8
    v_mul_f32 v33, v33, v34
    v_accvgpr_write_b32 a8, v33
    v_accvgpr_read_b32 v33, a9
    v_mul_f32 v33, v33, v34
    v_accvgpr_write_b32 a9, v33
    v_accvgpr_read_b32 v33, a10
    v_mul_f32 v33, v33, v34
    v_accvgpr_write_b32 a10, v33
    v_accvgpr_read_b32 v33, a11
    v_mul_f32 v33, v33, v34
    v_accvgpr_write_b32 a11, v33
    v_accvgpr_read_b32 v33, a12
    v_mul_f32 v33, v33, v34
    v_accvgpr_write_b32 a12, v33
    v_accvgpr_read_b32 v33, a13
    v_mul_f32 v33, v33, v34
    v_accvgpr_write_b32 a13, v33
    v_accvgpr_read_b32 v33, a14
    v_mul_f32 v33, v33, v34
    v_accvgpr_write_b32 a14, v33
    v_accvgpr_read_b32 v33, a15
    v_mul_f32 v33, v33, v34
    v_accvgpr_write_b32 a15, v33
    v_accvgpr_read_b32 v33, a16
    v_mul_f32 v33, v33, v34
    v_accvgpr_write_b32 a16, v33
    v_accvgpr_read_b32 v33, a17
    v_mul_f32 v33, v33, v34
    v_accvgpr_write_b32 a17, v33
    v_accvgpr_read_b32 v33, a18
    v_mul_f32 v33, v33, v34
    v_accvgpr_write_b32 a18, v33
    v_accvgpr_read_b32 v33, a19
    v_mul_f32 v33, v33, v34
    v_accvgpr_write_b32 a19, v33
    v_accvgpr_read_b32 v33, a20
    v_mul_f32 v33, v33, v34
    v_accvgpr_write_b32 a20, v33
    v_accvgpr_read_b32 v33, a21
    v_mul_f32 v33, v33, v34
    v_accvgpr_write_b32 a21, v33
    v_accvgpr_read_b32 v33, a22
    v_mul_f32 v33, v33, v34
    v_accvgpr_write_b32 a22, v33
    v_accvgpr_read_b32 v33, a23
    v_mul_f32 v33, v33, v34
    v_accvgpr_write_b32 a23, v33
    v_accvgpr_read_b32 v33, a24
    v_mul_f32 v33, v33, v34
    v_accvgpr_write_b32 a24, v33
    v_accvgpr_read_b32 v33, a25
    v_mul_f32 v33, v33, v34
    v_accvgpr_write_b32 a25, v33
    v_accvgpr_read_b32 v33, a26
    v_mul_f32 v33, v33, v34
    v_accvgpr_write_b32 a26, v33
    v_accvgpr_read_b32 v33, a27
    v_mul_f32 v33, v33, v34
    v_accvgpr_write_b32 a27, v33
    v_accvgpr_read_b32 v33, a28
    v_mul_f32 v33, v33, v34
    v_accvgpr_write_b32 a28, v33
    v_accvgpr_read_b32 v33, a29
    v_mul_f32 v33, v33, v34
    v_accvgpr_write_b32 a29, v33
    v_accvgpr_read_b32 v33, a30
    v_mul_f32 v33, v33, v34
    v_accvgpr_write_b32 a30, v33
    v_accvgpr_read_b32 v33, a31
    v_mul_f32 v33, v33, v34
    v_accvgpr_write_b32 a31, v33
    v_exp_f32 v36, v144
    v_exp_f32 v37, v145
    s_nop 0
    v_cvt_pk_bf16_f32 v208, v36, v37
    v_exp_f32 v36, v146
    v_exp_f32 v37, v147
    s_nop 0
    v_cvt_pk_bf16_f32 v209, v36, v37
    v_exp_f32 v36, v148
    v_exp_f32 v37, v149
    s_nop 0
    v_cvt_pk_bf16_f32 v210, v36, v37
    v_exp_f32 v36, v150
    v_exp_f32 v37, v151
    s_nop 0
    v_cvt_pk_bf16_f32 v211, v36, v37
    v_max3_f32 v32, v152, v153, v154
    v_max3_f32 v32, v155, v156, v32
    v_max3_f32 v32, v157, v158, v32
    v_max_f32 v32, v159, v32
    v_mov_b32 v33, v32
    s_nop 1
    v_permlane16_swap_b32 v32, v33
    s_nop 1
    v_max_f32 v32, v32, v33
    v_mov_b32 v33, v32
    s_nop 1
    v_permlane32_swap_b32 v32, v33
    s_nop 1
    v_max_f32 v32, v32, v33
    v_add_f32 v32, 0x41c00000, v32
    v_max_f32 v32, 0, v32
    v_exp_f32 v34, -v32
    v_sub_f32 v68, v68, v32
    v_sub_f32 v69, v69, v32
    v_sub_f32 v70, v70, v32
    v_sub_f32 v71, v71, v32
    v_sub_f32 v152, v152, v32
    v_sub_f32 v153, v153, v32
    v_sub_f32 v154, v154, v32
    v_sub_f32 v155, v155, v32
    v_sub_f32 v156, v156, v32
    v_sub_f32 v157, v157, v32
    v_sub_f32 v158, v158, v32
    v_sub_f32 v159, v159, v32
    v_sub_f32 v184, v184, v32
    v_sub_f32 v185, v185, v32
    v_sub_f32 v186, v186, v32
    v_sub_f32 v187, v187, v32
    v_sub_f32 v188, v188, v32
    v_sub_f32 v189, v189, v32
    v_sub_f32 v190, v190, v32
    v_sub_f32 v191, v191, v32
    v_mul_f32 v244, v244, v34
    v_mul_f32 v245, v245, v34
    v_mul_f32 v246, v246, v34
    v_mul_f32 v247, v247, v34
    v_accvgpr_read_b32 v33, a32
    v_mul_f32 v33, v33, v34
    v_accvgpr_write_b32 a32, v33
    v_accvgpr_read_b32 v33, a33
    v_mul_f32 v33, v33, v34
    v_accvgpr_write_b32 a33, v33
    v_accvgpr_read_b32 v33, a34
    v_mul_f32 v33, v33, v34
    v_accvgpr_write_b32 a34, v33
    v_accvgpr_read_b32 v33, a35
    v_mul_f32 v33, v33, v34
    v_accvgpr_write_b32 a35, v33
    v_accvgpr_read_b32 v33, a36
    v_mul_f32 v33, v33, v34
    v_accvgpr_write_b32 a36, v33
    v_accvgpr_read_b32 v33, a37
    v_mul_f32 v33, v33, v34
    v_accvgpr_write_b32 a37, v33
    v_accvgpr_read_b32 v33, a38
    v_mul_f32 v33, v33, v34
    v_accvgpr_write_b32 a38, v33
    v_accvgpr_read_b32 v33, a39
    v_mul_f32 v33, v33, v34
    v_accvgpr_write_b32 a39, v33
    v_accvgpr_read_b32 v33, a40
    v_mul_f32 v33, v33, v34
    v_accvgpr_write_b32 a40, v33
    v_accvgpr_read_b32 v33, a41
    v_mul_f32 v33, v33, v34
    v_accvgpr_write_b32 a41, v33
    v_accvgpr_read_b32 v33, a42
    v_mul_f32 v33, v33, v34
    v_accvgpr_write_b32 a42, v33
    v_accvgpr_read_b32 v33, a43
    v_mul_f32 v33, v33, v34
    v_accvgpr_write_b32 a43, v33
    v_accvgpr_read_b32 v33, a44
    v_mul_f32 v33, v33, v34
    v_accvgpr_write_b32 a44, v33
    v_accvgpr_read_b32 v33, a45
    v_mul_f32 v33, v33, v34
    v_accvgpr_write_b32 a45, v33
    v_accvgpr_read_b32 v33, a46
    v_mul_f32 v33, v33, v34
    v_accvgpr_write_b32 a46, v33
    v_accvgpr_read_b32 v33, a47
    v_mul_f32 v33, v33, v34
    v_accvgpr_write_b32 a47, v33
    v_accvgpr_read_b32 v33, a48
    v_mul_f32 v33, v33, v34
    v_accvgpr_write_b32 a48, v33
    v_accvgpr_read_b32 v33, a49
    v_mul_f32 v33, v33, v34
    v_accvgpr_write_b32 a49, v33
    v_accvgpr_read_b32 v33, a50
    v_mul_f32 v33, v33, v34
    v_accvgpr_write_b32 a50, v33
    v_accvgpr_read_b32 v33, a51
    v_mul_f32 v33, v33, v34
    v_accvgpr_write_b32 a51, v33
    v_accvgpr_read_b32 v33, a52
    v_mul_f32 v33, v33, v34
    v_accvgpr_write_b32 a52, v33
    v_accvgpr_read_b32 v33, a53
    v_mul_f32 v33, v33, v34
    v_accvgpr_write_b32 a53, v33
    v_accvgpr_read_b32 v33, a54
    v_mul_f32 v33, v33, v34
    v_accvgpr_write_b32 a54, v33
    v_accvgpr_read_b32 v33, a55
    v_mul_f32 v33, v33, v34
    v_accvgpr_write_b32 a55, v33
    v_accvgpr_read_b32 v33, a56
    v_mul_f32 v33, v33, v34
    v_accvgpr_write_b32 a56, v33
    v_accvgpr_read_b32 v33, a57
    v_mul_f32 v33, v33, v34
    v_accvgpr_write_b32 a57, v33
    v_accvgpr_read_b32 v33, a58
    v_mul_f32 v33, v33, v34
    v_accvgpr_write_b32 a58, v33
    v_accvgpr_read_b32 v33, a59
    v_mul_f32 v33, v33, v34
    v_accvgpr_write_b32 a59, v33
    v_accvgpr_read_b32 v33, a60
    v_mul_f32 v33, v33, v34
    v_accvgpr_write_b32 a60, v33
    v_accvgpr_read_b32 v33, a61
    v_mul_f32 v33, v33, v34
    v_accvgpr_write_b32 a61, v33
    v_accvgpr_read_b32 v33, a62
    v_mul_f32 v33, v33, v34
    v_accvgpr_write_b32 a62, v33
    v_accvgpr_read_b32 v33, a63
    v_mul_f32 v33, v33, v34
    v_accvgpr_write_b32 a63, v33
    v_exp_f32 v36, v152
    v_exp_f32 v37, v153
    s_nop 0
    v_cvt_pk_bf16_f32 v212, v36, v37
    v_exp_f32 v36, v154
    v_exp_f32 v37, v155
    s_nop 0
    v_cvt_pk_bf16_f32 v213, v36, v37
    v_exp_f32 v36, v156
    v_exp_f32 v37, v157
    s_nop 0
    v_cvt_pk_bf16_f32 v214, v36, v37
    v_exp_f32 v36, v158
    v_exp_f32 v37, v159
    s_nop 0
    v_cvt_pk_bf16_f32 v215, v36, v37
    v_max3_f32 v32, v160, v161, v162
    v_max3_f32 v32, v163, v164, v32
    v_max3_f32 v32, v165, v166, v32
    v_max_f32 v32, v167, v32
    v_mov_b32 v33, v32
    s_nop 1
    v_permlane16_swap_b32 v32, v33
    s_nop 1
    v_max_f32 v32, v32, v33
    v_mov_b32 v33, v32
    s_nop 1
    v_permlane32_swap_b32 v32, v33
    s_nop 1
    v_max_f32 v32, v32, v33
    v_add_f32 v32, 0x41c00000, v32
    v_max_f32 v32, 0, v32
    v_exp_f32 v34, -v32
    v_sub_f32 v72, v72, v32
    v_sub_f32 v73, v73, v32
    v_sub_f32 v74, v74, v32
    v_sub_f32 v75, v75, v32
    v_sub_f32 v160, v160, v32
    v_sub_f32 v161, v161, v32
    v_sub_f32 v162, v162, v32
    v_sub_f32 v163, v163, v32
    v_sub_f32 v164, v164, v32
    v_sub_f32 v165, v165, v32
    v_sub_f32 v166, v166, v32
    v_sub_f32 v167, v167, v32
    v_sub_f32 v192, v192, v32
    v_sub_f32 v193, v193, v32
    v_sub_f32 v194, v194, v32
    v_sub_f32 v195, v195, v32
    v_sub_f32 v196, v196, v32
    v_sub_f32 v197, v197, v32
    v_sub_f32 v198, v198, v32
    v_sub_f32 v199, v199, v32
    v_mul_f32 v248, v248, v34
    v_mul_f32 v249, v249, v34
    v_mul_f32 v250, v250, v34
    v_mul_f32 v251, v251, v34
    v_accvgpr_read_b32 v33, a64
    v_mul_f32 v33, v33, v34
    v_accvgpr_write_b32 a64, v33
    v_accvgpr_read_b32 v33, a65
    v_mul_f32 v33, v33, v34
    v_accvgpr_write_b32 a65, v33
    v_accvgpr_read_b32 v33, a66
    v_mul_f32 v33, v33, v34
    v_accvgpr_write_b32 a66, v33
    v_accvgpr_read_b32 v33, a67
    v_mul_f32 v33, v33, v34
    v_accvgpr_write_b32 a67, v33
    v_accvgpr_read_b32 v33, a68
    v_mul_f32 v33, v33, v34
    v_accvgpr_write_b32 a68, v33
    v_accvgpr_read_b32 v33, a69
    v_mul_f32 v33, v33, v34
    v_accvgpr_write_b32 a69, v33
    v_accvgpr_read_b32 v33, a70
    v_mul_f32 v33, v33, v34
    v_accvgpr_write_b32 a70, v33
    v_accvgpr_read_b32 v33, a71
    v_mul_f32 v33, v33, v34
    v_accvgpr_write_b32 a71, v33
    v_accvgpr_read_b32 v33, a72
    v_mul_f32 v33, v33, v34
    v_accvgpr_write_b32 a72, v33
    v_accvgpr_read_b32 v33, a73
    v_mul_f32 v33, v33, v34
    v_accvgpr_write_b32 a73, v33
    v_accvgpr_read_b32 v33, a74
    v_mul_f32 v33, v33, v34
    v_accvgpr_write_b32 a74, v33
    v_accvgpr_read_b32 v33, a75
    v_mul_f32 v33, v33, v34
    v_accvgpr_write_b32 a75, v33
    v_accvgpr_read_b32 v33, a76
    v_mul_f32 v33, v33, v34
    v_accvgpr_write_b32 a76, v33
    v_accvgpr_read_b32 v33, a77
    v_mul_f32 v33, v33, v34
    v_accvgpr_write_b32 a77, v33
    v_accvgpr_read_b32 v33, a78
    v_mul_f32 v33, v33, v34
    v_accvgpr_write_b32 a78, v33
    v_accvgpr_read_b32 v33, a79
    v_mul_f32 v33, v33, v34
    v_accvgpr_write_b32 a79, v33
    v_accvgpr_read_b32 v33, a80
    v_mul_f32 v33, v33, v34
    v_accvgpr_write_b32 a80, v33
    v_accvgpr_read_b32 v33, a81
    v_mul_f32 v33, v33, v34
    v_accvgpr_write_b32 a81, v33
    v_accvgpr_read_b32 v33, a82
    v_mul_f32 v33, v33, v34
    v_accvgpr_write_b32 a82, v33
    v_accvgpr_read_b32 v33, a83
    v_mul_f32 v33, v33, v34
    v_accvgpr_write_b32 a83, v33
    v_accvgpr_read_b32 v33, a84
    v_mul_f32 v33, v33, v34
    v_accvgpr_write_b32 a84, v33
    v_accvgpr_read_b32 v33, a85
    v_mul_f32 v33, v33, v34
    v_accvgpr_write_b32 a85, v33
    v_accvgpr_read_b32 v33, a86
    v_mul_f32 v33, v33, v34
    v_accvgpr_write_b32 a86, v33
    v_accvgpr_read_b32 v33, a87
    v_mul_f32 v33, v33, v34
    v_accvgpr_write_b32 a87, v33
    v_accvgpr_read_b32 v33, a88
    v_mul_f32 v33, v33, v34
    v_accvgpr_write_b32 a88, v33
    v_accvgpr_read_b32 v33, a89
    v_mul_f32 v33, v33, v34
    v_accvgpr_write_b32 a89, v33
    v_accvgpr_read_b32 v33, a90
    v_mul_f32 v33, v33, v34
    v_accvgpr_write_b32 a90, v33
    v_accvgpr_read_b32 v33, a91
    v_mul_f32 v33, v33, v34
    v_accvgpr_write_b32 a91, v33
    v_accvgpr_read_b32 v33, a92
    v_mul_f32 v33, v33, v34
    v_accvgpr_write_b32 a92, v33
    v_accvgpr_read_b32 v33, a93
    v_mul_f32 v33, v33, v34
    v_accvgpr_write_b32 a93, v33
    v_accvgpr_read_b32 v33, a94
    v_mul_f32 v33, v33, v34
    v_accvgpr_write_b32 a94, v33
    v_accvgpr_read_b32 v33, a95
    v_mul_f32 v33, v33, v34
    v_accvgpr_write_b32 a95, v33
    v_exp_f32 v36, v160
    v_exp_f32 v37, v161
    s_nop 0
    v_cvt_pk_bf16_f32 v216, v36, v37
    v_exp_f32 v36, v162
    v_exp_f32 v37, v163
    s_nop 0
    v_cvt_pk_bf16_f32 v217, v36, v37
    v_exp_f32 v36, v164
    v_exp_f32 v37, v165
    s_nop 0
    v_cvt_pk_bf16_f32 v218, v36, v37
    v_exp_f32 v36, v166
    v_exp_f32 v37, v167
    s_nop 0
    v_cvt_pk_bf16_f32 v219, v36, v37
    v_max3_f32 v32, v168, v169, v170
    v_max3_f32 v32, v171, v172, v32
    v_max3_f32 v32, v173, v174, v32
    v_max_f32 v32, v175, v32
    v_mov_b32 v33, v32
    s_nop 1
    v_permlane16_swap_b32 v32, v33
    s_nop 1
    v_max_f32 v32, v32, v33
    v_mov_b32 v33, v32
    s_nop 1
    v_permlane32_swap_b32 v32, v33
    s_nop 1
    v_max_f32 v32, v32, v33
    v_add_f32 v32, 0x41c00000, v32
    v_max_f32 v32, 0, v32
    v_exp_f32 v34, -v32
    v_sub_f32 v76, v76, v32
    v_sub_f32 v77, v77, v32
    v_sub_f32 v78, v78, v32
    v_sub_f32 v79, v79, v32
    v_sub_f32 v168, v168, v32
    v_sub_f32 v169, v169, v32
    v_sub_f32 v170, v170, v32
    v_sub_f32 v171, v171, v32
    v_sub_f32 v172, v172, v32
    v_sub_f32 v173, v173, v32
    v_sub_f32 v174, v174, v32
    v_sub_f32 v175, v175, v32
    v_sub_f32 v200, v200, v32
    v_sub_f32 v201, v201, v32
    v_sub_f32 v202, v202, v32
    v_sub_f32 v203, v203, v32
    v_sub_f32 v204, v204, v32
    v_sub_f32 v205, v205, v32
    v_sub_f32 v206, v206, v32
    v_sub_f32 v207, v207, v32
    v_mul_f32 v252, v252, v34
    v_mul_f32 v253, v253, v34
    v_mul_f32 v254, v254, v34
    v_mul_f32 v255, v255, v34
    v_accvgpr_read_b32 v33, a96
    v_mul_f32 v33, v33, v34
    v_accvgpr_write_b32 a96, v33
    v_accvgpr_read_b32 v33, a97
    v_mul_f32 v33, v33, v34
    v_accvgpr_write_b32 a97, v33
    v_accvgpr_read_b32 v33, a98
    v_mul_f32 v33, v33, v34
    v_accvgpr_write_b32 a98, v33
    v_accvgpr_read_b32 v33, a99
    v_mul_f32 v33, v33, v34
    v_accvgpr_write_b32 a99, v33
    v_accvgpr_read_b32 v33, a100
    v_mul_f32 v33, v33, v34
    v_accvgpr_write_b32 a100, v33
    v_accvgpr_read_b32 v33, a101
    v_mul_f32 v33, v33, v34
    v_accvgpr_write_b32 a101, v33
    v_accvgpr_read_b32 v33, a102
    v_mul_f32 v33, v33, v34
    v_accvgpr_write_b32 a102, v33
    v_accvgpr_read_b32 v33, a103
    v_mul_f32 v33, v33, v34
    v_accvgpr_write_b32 a103, v33
    v_accvgpr_read_b32 v33, a104
    v_mul_f32 v33, v33, v34
    v_accvgpr_write_b32 a104, v33
    v_accvgpr_read_b32 v33, a105
    v_mul_f32 v33, v33, v34
    v_accvgpr_write_b32 a105, v33
    v_accvgpr_read_b32 v33, a106
    v_mul_f32 v33, v33, v34
    v_accvgpr_write_b32 a106, v33
    v_accvgpr_read_b32 v33, a107
    v_mul_f32 v33, v33, v34
    v_accvgpr_write_b32 a107, v33
    v_accvgpr_read_b32 v33, a108
    v_mul_f32 v33, v33, v34
    v_accvgpr_write_b32 a108, v33
    v_accvgpr_read_b32 v33, a109
    v_mul_f32 v33, v33, v34
    v_accvgpr_write_b32 a109, v33
    v_accvgpr_read_b32 v33, a110
    v_mul_f32 v33, v33, v34
    v_accvgpr_write_b32 a110, v33
    v_accvgpr_read_b32 v33, a111
    v_mul_f32 v33, v33, v34
    v_accvgpr_write_b32 a111, v33
    v_accvgpr_read_b32 v33, a112
    v_mul_f32 v33, v33, v34
    v_accvgpr_write_b32 a112, v33
    v_accvgpr_read_b32 v33, a113
    v_mul_f32 v33, v33, v34
    v_accvgpr_write_b32 a113, v33
    v_accvgpr_read_b32 v33, a114
    v_mul_f32 v33, v33, v34
    v_accvgpr_write_b32 a114, v33
    v_accvgpr_read_b32 v33, a115
    v_mul_f32 v33, v33, v34
    v_accvgpr_write_b32 a115, v33
    v_accvgpr_read_b32 v33, a116
    v_mul_f32 v33, v33, v34
    v_accvgpr_write_b32 a116, v33
    v_accvgpr_read_b32 v33, a117
    v_mul_f32 v33, v33, v34
    v_accvgpr_write_b32 a117, v33
    v_accvgpr_read_b32 v33, a118
    v_mul_f32 v33, v33, v34
    v_accvgpr_write_b32 a118, v33
    v_accvgpr_read_b32 v33, a119
    v_mul_f32 v33, v33, v34
    v_accvgpr_write_b32 a119, v33
    v_accvgpr_read_b32 v33, a120
    v_mul_f32 v33, v33, v34
    v_accvgpr_write_b32 a120, v33
    v_accvgpr_read_b32 v33, a121
    v_mul_f32 v33, v33, v34
    v_accvgpr_write_b32 a121, v33
    v_accvgpr_read_b32 v33, a122
    v_mul_f32 v33, v33, v34
    v_accvgpr_write_b32 a122, v33
    v_accvgpr_read_b32 v33, a123
    v_mul_f32 v33, v33, v34
    v_accvgpr_write_b32 a123, v33
    v_accvgpr_read_b32 v33, a124
    v_mul_f32 v33, v33, v34
    v_accvgpr_write_b32 a124, v33
    v_accvgpr_read_b32 v33, a125
    v_mul_f32 v33, v33, v34
    v_accvgpr_write_b32 a125, v33
    v_accvgpr_read_b32 v33, a126
    v_mul_f32 v33, v33, v34
    v_accvgpr_write_b32 a126, v33
    v_accvgpr_read_b32 v33, a127
    v_mul_f32 v33, v33, v34
    v_accvgpr_write_b32 a127, v33
    v_exp_f32 v36, v168
    v_exp_f32 v37, v169
    s_nop 0
    v_cvt_pk_bf16_f32 v220, v36, v37
    v_exp_f32 v36, v170
    v_exp_f32 v37, v171
    s_nop 0
    v_cvt_pk_bf16_f32 v221, v36, v37
    v_exp_f32 v36, v172
    v_exp_f32 v37, v173
    s_nop 0
    v_cvt_pk_bf16_f32 v222, v36, v37
    v_exp_f32 v36, v174
    v_exp_f32 v37, v175
    s_nop 0
    v_cvt_pk_bf16_f32 v223, v36, v37
    s_nop 1
    s_branch gated_mix__ssm_conv_h3__compressed_kv_cla__prompt_kernel_b4_r0_ret
gated_mix__ssm_conv_h3__compressed_kv_cla__prompt_kernel_b4_r1:
    s_nop 7
    v_max3_f32 v32, v176, v177, v178
    v_max3_f32 v32, v179, v180, v32
    v_max3_f32 v32, v181, v182, v32
    v_max_f32 v32, v183, v32
    v_mov_b32 v33, v32
    s_nop 1
    v_permlane16_swap_b32 v32, v33
    s_nop 1
    v_max_f32 v32, v32, v33
    v_mov_b32 v33, v32
    s_nop 1
    v_permlane32_swap_b32 v32, v33
    s_nop 1
    v_max_f32 v32, v32, v33
    v_add_f32 v32, 0x41c00000, v32
    v_max_f32 v32, 0, v32
    v_exp_f32 v34, -v32
    v_sub_f32 v64, v64, v32
    v_sub_f32 v65, v65, v32
    v_sub_f32 v66, v66, v32
    v_sub_f32 v67, v67, v32
    v_sub_f32 v176, v176, v32
    v_sub_f32 v177, v177, v32
    v_sub_f32 v178, v178, v32
    v_sub_f32 v179, v179, v32
    v_sub_f32 v180, v180, v32
    v_sub_f32 v181, v181, v32
    v_sub_f32 v182, v182, v32
    v_sub_f32 v183, v183, v32
    v_sub_f32 v144, v144, v32
    v_sub_f32 v145, v145, v32
    v_sub_f32 v146, v146, v32
    v_sub_f32 v147, v147, v32
    v_sub_f32 v148, v148, v32
    v_sub_f32 v149, v149, v32
    v_sub_f32 v150, v150, v32
    v_sub_f32 v151, v151, v32
    v_mul_f32 v240, v240, v34
    v_mul_f32 v241, v241, v34
    v_mul_f32 v242, v242, v34
    v_mul_f32 v243, v243, v34
    v_accvgpr_read_b32 v33, a0
    v_mul_f32 v33, v33, v34
    v_accvgpr_write_b32 a0, v33
    v_accvgpr_read_b32 v33, a1
    v_mul_f32 v33, v33, v34
    v_accvgpr_write_b32 a1, v33
    v_accvgpr_read_b32 v33, a2
    v_mul_f32 v33, v33, v34
    v_accvgpr_write_b32 a2, v33
    v_accvgpr_read_b32 v33, a3
    v_mul_f32 v33, v33, v34
    v_accvgpr_write_b32 a3, v33
    v_accvgpr_read_b32 v33, a4
    v_mul_f32 v33, v33, v34
    v_accvgpr_write_b32 a4, v33
    v_accvgpr_read_b32 v33, a5
    v_mul_f32 v33, v33, v34
    v_accvgpr_write_b32 a5, v33
    v_accvgpr_read_b32 v33, a6
    v_mul_f32 v33, v33, v34
    v_accvgpr_write_b32 a6, v33
    v_accvgpr_read_b32 v33, a7
    v_mul_f32 v33, v33, v34
    v_accvgpr_write_b32 a7, v33
    v_accvgpr_read_b32 v33, a8
    v_mul_f32 v33, v33, v34
    v_accvgpr_write_b32 a8, v33
    v_accvgpr_read_b32 v33, a9
    v_mul_f32 v33, v33, v34
    v_accvgpr_write_b32 a9, v33
    v_accvgpr_read_b32 v33, a10
    v_mul_f32 v33, v33, v34
    v_accvgpr_write_b32 a10, v33
    v_accvgpr_read_b32 v33, a11
    v_mul_f32 v33, v33, v34
    v_accvgpr_write_b32 a11, v33
    v_accvgpr_read_b32 v33, a12
    v_mul_f32 v33, v33, v34
    v_accvgpr_write_b32 a12, v33
    v_accvgpr_read_b32 v33, a13
    v_mul_f32 v33, v33, v34
    v_accvgpr_write_b32 a13, v33
    v_accvgpr_read_b32 v33, a14
    v_mul_f32 v33, v33, v34
    v_accvgpr_write_b32 a14, v33
    v_accvgpr_read_b32 v33, a15
    v_mul_f32 v33, v33, v34
    v_accvgpr_write_b32 a15, v33
    v_accvgpr_read_b32 v33, a16
    v_mul_f32 v33, v33, v34
    v_accvgpr_write_b32 a16, v33
    v_accvgpr_read_b32 v33, a17
    v_mul_f32 v33, v33, v34
    v_accvgpr_write_b32 a17, v33
    v_accvgpr_read_b32 v33, a18
    v_mul_f32 v33, v33, v34
    v_accvgpr_write_b32 a18, v33
    v_accvgpr_read_b32 v33, a19
    v_mul_f32 v33, v33, v34
    v_accvgpr_write_b32 a19, v33
    v_accvgpr_read_b32 v33, a20
    v_mul_f32 v33, v33, v34
    v_accvgpr_write_b32 a20, v33
    v_accvgpr_read_b32 v33, a21
    v_mul_f32 v33, v33, v34
    v_accvgpr_write_b32 a21, v33
    v_accvgpr_read_b32 v33, a22
    v_mul_f32 v33, v33, v34
    v_accvgpr_write_b32 a22, v33
    v_accvgpr_read_b32 v33, a23
    v_mul_f32 v33, v33, v34
    v_accvgpr_write_b32 a23, v33
    v_accvgpr_read_b32 v33, a24
    v_mul_f32 v33, v33, v34
    v_accvgpr_write_b32 a24, v33
    v_accvgpr_read_b32 v33, a25
    v_mul_f32 v33, v33, v34
    v_accvgpr_write_b32 a25, v33
    v_accvgpr_read_b32 v33, a26
    v_mul_f32 v33, v33, v34
    v_accvgpr_write_b32 a26, v33
    v_accvgpr_read_b32 v33, a27
    v_mul_f32 v33, v33, v34
    v_accvgpr_write_b32 a27, v33
    v_accvgpr_read_b32 v33, a28
    v_mul_f32 v33, v33, v34
    v_accvgpr_write_b32 a28, v33
    v_accvgpr_read_b32 v33, a29
    v_mul_f32 v33, v33, v34
    v_accvgpr_write_b32 a29, v33
    v_accvgpr_read_b32 v33, a30
    v_mul_f32 v33, v33, v34
    v_accvgpr_write_b32 a30, v33
    v_accvgpr_read_b32 v33, a31
    v_mul_f32 v33, v33, v34
    v_accvgpr_write_b32 a31, v33
    v_exp_f32 v36, v176
    v_exp_f32 v37, v177
    s_nop 0
    v_cvt_pk_bf16_f32 v224, v36, v37
    v_exp_f32 v36, v178
    v_exp_f32 v37, v179
    s_nop 0
    v_cvt_pk_bf16_f32 v225, v36, v37
    v_exp_f32 v36, v180
    v_exp_f32 v37, v181
    s_nop 0
    v_cvt_pk_bf16_f32 v226, v36, v37
    v_exp_f32 v36, v182
    v_exp_f32 v37, v183
    s_nop 0
    v_cvt_pk_bf16_f32 v227, v36, v37
    v_max3_f32 v32, v184, v185, v186
    v_max3_f32 v32, v187, v188, v32
    v_max3_f32 v32, v189, v190, v32
    v_max_f32 v32, v191, v32
    v_mov_b32 v33, v32
    s_nop 1
    v_permlane16_swap_b32 v32, v33
    s_nop 1
    v_max_f32 v32, v32, v33
    v_mov_b32 v33, v32
    s_nop 1
    v_permlane32_swap_b32 v32, v33
    s_nop 1
    v_max_f32 v32, v32, v33
    v_add_f32 v32, 0x41c00000, v32
    v_max_f32 v32, 0, v32
    v_exp_f32 v34, -v32
    v_sub_f32 v68, v68, v32
    v_sub_f32 v69, v69, v32
    v_sub_f32 v70, v70, v32
    v_sub_f32 v71, v71, v32
    v_sub_f32 v184, v184, v32
    v_sub_f32 v185, v185, v32
    v_sub_f32 v186, v186, v32
    v_sub_f32 v187, v187, v32
    v_sub_f32 v188, v188, v32
    v_sub_f32 v189, v189, v32
    v_sub_f32 v190, v190, v32
    v_sub_f32 v191, v191, v32
    v_sub_f32 v152, v152, v32
    v_sub_f32 v153, v153, v32
    v_sub_f32 v154, v154, v32
    v_sub_f32 v155, v155, v32
    v_sub_f32 v156, v156, v32
    v_sub_f32 v157, v157, v32
    v_sub_f32 v158, v158, v32
    v_sub_f32 v159, v159, v32
    v_mul_f32 v244, v244, v34
    v_mul_f32 v245, v245, v34
    v_mul_f32 v246, v246, v34
    v_mul_f32 v247, v247, v34
    v_accvgpr_read_b32 v33, a32
    v_mul_f32 v33, v33, v34
    v_accvgpr_write_b32 a32, v33
    v_accvgpr_read_b32 v33, a33
    v_mul_f32 v33, v33, v34
    v_accvgpr_write_b32 a33, v33
    v_accvgpr_read_b32 v33, a34
    v_mul_f32 v33, v33, v34
    v_accvgpr_write_b32 a34, v33
    v_accvgpr_read_b32 v33, a35
    v_mul_f32 v33, v33, v34
    v_accvgpr_write_b32 a35, v33
    v_accvgpr_read_b32 v33, a36
    v_mul_f32 v33, v33, v34
    v_accvgpr_write_b32 a36, v33
    v_accvgpr_read_b32 v33, a37
    v_mul_f32 v33, v33, v34
    v_accvgpr_write_b32 a37, v33
    v_accvgpr_read_b32 v33, a38
    v_mul_f32 v33, v33, v34
    v_accvgpr_write_b32 a38, v33
    v_accvgpr_read_b32 v33, a39
    v_mul_f32 v33, v33, v34
    v_accvgpr_write_b32 a39, v33
    v_accvgpr_read_b32 v33, a40
    v_mul_f32 v33, v33, v34
    v_accvgpr_write_b32 a40, v33
    v_accvgpr_read_b32 v33, a41
    v_mul_f32 v33, v33, v34
    v_accvgpr_write_b32 a41, v33
    v_accvgpr_read_b32 v33, a42
    v_mul_f32 v33, v33, v34
    v_accvgpr_write_b32 a42, v33
    v_accvgpr_read_b32 v33, a43
    v_mul_f32 v33, v33, v34
    v_accvgpr_write_b32 a43, v33
    v_accvgpr_read_b32 v33, a44
    v_mul_f32 v33, v33, v34
    v_accvgpr_write_b32 a44, v33
    v_accvgpr_read_b32 v33, a45
    v_mul_f32 v33, v33, v34
    v_accvgpr_write_b32 a45, v33
    v_accvgpr_read_b32 v33, a46
    v_mul_f32 v33, v33, v34
    v_accvgpr_write_b32 a46, v33
    v_accvgpr_read_b32 v33, a47
    v_mul_f32 v33, v33, v34
    v_accvgpr_write_b32 a47, v33
    v_accvgpr_read_b32 v33, a48
    v_mul_f32 v33, v33, v34
    v_accvgpr_write_b32 a48, v33
    v_accvgpr_read_b32 v33, a49
    v_mul_f32 v33, v33, v34
    v_accvgpr_write_b32 a49, v33
    v_accvgpr_read_b32 v33, a50
    v_mul_f32 v33, v33, v34
    v_accvgpr_write_b32 a50, v33
    v_accvgpr_read_b32 v33, a51
    v_mul_f32 v33, v33, v34
    v_accvgpr_write_b32 a51, v33
    v_accvgpr_read_b32 v33, a52
    v_mul_f32 v33, v33, v34
    v_accvgpr_write_b32 a52, v33
    v_accvgpr_read_b32 v33, a53
    v_mul_f32 v33, v33, v34
    v_accvgpr_write_b32 a53, v33
    v_accvgpr_read_b32 v33, a54
    v_mul_f32 v33, v33, v34
    v_accvgpr_write_b32 a54, v33
    v_accvgpr_read_b32 v33, a55
    v_mul_f32 v33, v33, v34
    v_accvgpr_write_b32 a55, v33
    v_accvgpr_read_b32 v33, a56
    v_mul_f32 v33, v33, v34
    v_accvgpr_write_b32 a56, v33
    v_accvgpr_read_b32 v33, a57
    v_mul_f32 v33, v33, v34
    v_accvgpr_write_b32 a57, v33
    v_accvgpr_read_b32 v33, a58
    v_mul_f32 v33, v33, v34
    v_accvgpr_write_b32 a58, v33
    v_accvgpr_read_b32 v33, a59
    v_mul_f32 v33, v33, v34
    v_accvgpr_write_b32 a59, v33
    v_accvgpr_read_b32 v33, a60
    v_mul_f32 v33, v33, v34
    v_accvgpr_write_b32 a60, v33
    v_accvgpr_read_b32 v33, a61
    v_mul_f32 v33, v33, v34
    v_accvgpr_write_b32 a61, v33
    v_accvgpr_read_b32 v33, a62
    v_mul_f32 v33, v33, v34
    v_accvgpr_write_b32 a62, v33
    v_accvgpr_read_b32 v33, a63
    v_mul_f32 v33, v33, v34
    v_accvgpr_write_b32 a63, v33
    v_exp_f32 v36, v184
    v_exp_f32 v37, v185
    s_nop 0
    v_cvt_pk_bf16_f32 v228, v36, v37
    v_exp_f32 v36, v186
    v_exp_f32 v37, v187
    s_nop 0
    v_cvt_pk_bf16_f32 v229, v36, v37
    v_exp_f32 v36, v188
    v_exp_f32 v37, v189
    s_nop 0
    v_cvt_pk_bf16_f32 v230, v36, v37
    v_exp_f32 v36, v190
    v_exp_f32 v37, v191
    s_nop 0
    v_cvt_pk_bf16_f32 v231, v36, v37
    v_max3_f32 v32, v192, v193, v194
    v_max3_f32 v32, v195, v196, v32
    v_max3_f32 v32, v197, v198, v32
    v_max_f32 v32, v199, v32
    v_mov_b32 v33, v32
    s_nop 1
    v_permlane16_swap_b32 v32, v33
    s_nop 1
    v_max_f32 v32, v32, v33
    v_mov_b32 v33, v32
    s_nop 1
    v_permlane32_swap_b32 v32, v33
    s_nop 1
    v_max_f32 v32, v32, v33
    v_add_f32 v32, 0x41c00000, v32
    v_max_f32 v32, 0, v32
    v_exp_f32 v34, -v32
    v_sub_f32 v72, v72, v32
    v_sub_f32 v73, v73, v32
    v_sub_f32 v74, v74, v32
    v_sub_f32 v75, v75, v32
    v_sub_f32 v192, v192, v32
    v_sub_f32 v193, v193, v32
    v_sub_f32 v194, v194, v32
    v_sub_f32 v195, v195, v32
    v_sub_f32 v196, v196, v32
    v_sub_f32 v197, v197, v32
    v_sub_f32 v198, v198, v32
    v_sub_f32 v199, v199, v32
    v_sub_f32 v160, v160, v32
    v_sub_f32 v161, v161, v32
    v_sub_f32 v162, v162, v32
    v_sub_f32 v163, v163, v32
    v_sub_f32 v164, v164, v32
    v_sub_f32 v165, v165, v32
    v_sub_f32 v166, v166, v32
    v_sub_f32 v167, v167, v32
    v_mul_f32 v248, v248, v34
    v_mul_f32 v249, v249, v34
    v_mul_f32 v250, v250, v34
    v_mul_f32 v251, v251, v34
    v_accvgpr_read_b32 v33, a64
    v_mul_f32 v33, v33, v34
    v_accvgpr_write_b32 a64, v33
    v_accvgpr_read_b32 v33, a65
    v_mul_f32 v33, v33, v34
    v_accvgpr_write_b32 a65, v33
    v_accvgpr_read_b32 v33, a66
    v_mul_f32 v33, v33, v34
    v_accvgpr_write_b32 a66, v33
    v_accvgpr_read_b32 v33, a67
    v_mul_f32 v33, v33, v34
    v_accvgpr_write_b32 a67, v33
    v_accvgpr_read_b32 v33, a68
    v_mul_f32 v33, v33, v34
    v_accvgpr_write_b32 a68, v33
    v_accvgpr_read_b32 v33, a69
    v_mul_f32 v33, v33, v34
    v_accvgpr_write_b32 a69, v33
    v_accvgpr_read_b32 v33, a70
    v_mul_f32 v33, v33, v34
    v_accvgpr_write_b32 a70, v33
    v_accvgpr_read_b32 v33, a71
    v_mul_f32 v33, v33, v34
    v_accvgpr_write_b32 a71, v33
    v_accvgpr_read_b32 v33, a72
    v_mul_f32 v33, v33, v34
    v_accvgpr_write_b32 a72, v33
    v_accvgpr_read_b32 v33, a73
    v_mul_f32 v33, v33, v34
    v_accvgpr_write_b32 a73, v33
    v_accvgpr_read_b32 v33, a74
    v_mul_f32 v33, v33, v34
    v_accvgpr_write_b32 a74, v33
    v_accvgpr_read_b32 v33, a75
    v_mul_f32 v33, v33, v34
    v_accvgpr_write_b32 a75, v33
    v_accvgpr_read_b32 v33, a76
    v_mul_f32 v33, v33, v34
    v_accvgpr_write_b32 a76, v33
    v_accvgpr_read_b32 v33, a77
    v_mul_f32 v33, v33, v34
    v_accvgpr_write_b32 a77, v33
    v_accvgpr_read_b32 v33, a78
    v_mul_f32 v33, v33, v34
    v_accvgpr_write_b32 a78, v33
    v_accvgpr_read_b32 v33, a79
    v_mul_f32 v33, v33, v34
    v_accvgpr_write_b32 a79, v33
    v_accvgpr_read_b32 v33, a80
    v_mul_f32 v33, v33, v34
    v_accvgpr_write_b32 a80, v33
    v_accvgpr_read_b32 v33, a81
    v_mul_f32 v33, v33, v34
    v_accvgpr_write_b32 a81, v33
    v_accvgpr_read_b32 v33, a82
    v_mul_f32 v33, v33, v34
    v_accvgpr_write_b32 a82, v33
    v_accvgpr_read_b32 v33, a83
    v_mul_f32 v33, v33, v34
    v_accvgpr_write_b32 a83, v33
    v_accvgpr_read_b32 v33, a84
    v_mul_f32 v33, v33, v34
    v_accvgpr_write_b32 a84, v33
    v_accvgpr_read_b32 v33, a85
    v_mul_f32 v33, v33, v34
    v_accvgpr_write_b32 a85, v33
    v_accvgpr_read_b32 v33, a86
    v_mul_f32 v33, v33, v34
    v_accvgpr_write_b32 a86, v33
    v_accvgpr_read_b32 v33, a87
    v_mul_f32 v33, v33, v34
    v_accvgpr_write_b32 a87, v33
    v_accvgpr_read_b32 v33, a88
    v_mul_f32 v33, v33, v34
    v_accvgpr_write_b32 a88, v33
    v_accvgpr_read_b32 v33, a89
    v_mul_f32 v33, v33, v34
    v_accvgpr_write_b32 a89, v33
    v_accvgpr_read_b32 v33, a90
    v_mul_f32 v33, v33, v34
    v_accvgpr_write_b32 a90, v33
    v_accvgpr_read_b32 v33, a91
    v_mul_f32 v33, v33, v34
    v_accvgpr_write_b32 a91, v33
    v_accvgpr_read_b32 v33, a92
    v_mul_f32 v33, v33, v34
    v_accvgpr_write_b32 a92, v33
    v_accvgpr_read_b32 v33, a93
    v_mul_f32 v33, v33, v34
    v_accvgpr_write_b32 a93, v33
    v_accvgpr_read_b32 v33, a94
    v_mul_f32 v33, v33, v34
    v_accvgpr_write_b32 a94, v33
    v_accvgpr_read_b32 v33, a95
    v_mul_f32 v33, v33, v34
    v_accvgpr_write_b32 a95, v33
    v_exp_f32 v36, v192
    v_exp_f32 v37, v193
    s_nop 0
    v_cvt_pk_bf16_f32 v232, v36, v37
    v_exp_f32 v36, v194
    v_exp_f32 v37, v195
    s_nop 0
    v_cvt_pk_bf16_f32 v233, v36, v37
    v_exp_f32 v36, v196
    v_exp_f32 v37, v197
    s_nop 0
    v_cvt_pk_bf16_f32 v234, v36, v37
    v_exp_f32 v36, v198
    v_exp_f32 v37, v199
    s_nop 0
    v_cvt_pk_bf16_f32 v235, v36, v37
    v_max3_f32 v32, v200, v201, v202
    v_max3_f32 v32, v203, v204, v32
    v_max3_f32 v32, v205, v206, v32
    v_max_f32 v32, v207, v32
    v_mov_b32 v33, v32
    s_nop 1
    v_permlane16_swap_b32 v32, v33
    s_nop 1
    v_max_f32 v32, v32, v33
    v_mov_b32 v33, v32
    s_nop 1
    v_permlane32_swap_b32 v32, v33
    s_nop 1
    v_max_f32 v32, v32, v33
    v_add_f32 v32, 0x41c00000, v32
    v_max_f32 v32, 0, v32
    v_exp_f32 v34, -v32
    v_sub_f32 v76, v76, v32
    v_sub_f32 v77, v77, v32
    v_sub_f32 v78, v78, v32
    v_sub_f32 v79, v79, v32
    v_sub_f32 v200, v200, v32
    v_sub_f32 v201, v201, v32
    v_sub_f32 v202, v202, v32
    v_sub_f32 v203, v203, v32
    v_sub_f32 v204, v204, v32
    v_sub_f32 v205, v205, v32
    v_sub_f32 v206, v206, v32
    v_sub_f32 v207, v207, v32
    v_sub_f32 v168, v168, v32
    v_sub_f32 v169, v169, v32
    v_sub_f32 v170, v170, v32
    v_sub_f32 v171, v171, v32
    v_sub_f32 v172, v172, v32
    v_sub_f32 v173, v173, v32
    v_sub_f32 v174, v174, v32
    v_sub_f32 v175, v175, v32
    v_mul_f32 v252, v252, v34
    v_mul_f32 v253, v253, v34
    v_mul_f32 v254, v254, v34
    v_mul_f32 v255, v255, v34
    v_accvgpr_read_b32 v33, a96
    v_mul_f32 v33, v33, v34
    v_accvgpr_write_b32 a96, v33
    v_accvgpr_read_b32 v33, a97
    v_mul_f32 v33, v33, v34
    v_accvgpr_write_b32 a97, v33
    v_accvgpr_read_b32 v33, a98
    v_mul_f32 v33, v33, v34
    v_accvgpr_write_b32 a98, v33
    v_accvgpr_read_b32 v33, a99
    v_mul_f32 v33, v33, v34
    v_accvgpr_write_b32 a99, v33
    v_accvgpr_read_b32 v33, a100
    v_mul_f32 v33, v33, v34
    v_accvgpr_write_b32 a100, v33
    v_accvgpr_read_b32 v33, a101
    v_mul_f32 v33, v33, v34
    v_accvgpr_write_b32 a101, v33
    v_accvgpr_read_b32 v33, a102
    v_mul_f32 v33, v33, v34
    v_accvgpr_write_b32 a102, v33
    v_accvgpr_read_b32 v33, a103
    v_mul_f32 v33, v33, v34
    v_accvgpr_write_b32 a103, v33
    v_accvgpr_read_b32 v33, a104
    v_mul_f32 v33, v33, v34
    v_accvgpr_write_b32 a104, v33
    v_accvgpr_read_b32 v33, a105
    v_mul_f32 v33, v33, v34
    v_accvgpr_write_b32 a105, v33
    v_accvgpr_read_b32 v33, a106
    v_mul_f32 v33, v33, v34
    v_accvgpr_write_b32 a106, v33
    v_accvgpr_read_b32 v33, a107
    v_mul_f32 v33, v33, v34
    v_accvgpr_write_b32 a107, v33
    v_accvgpr_read_b32 v33, a108
    v_mul_f32 v33, v33, v34
    v_accvgpr_write_b32 a108, v33
    v_accvgpr_read_b32 v33, a109
    v_mul_f32 v33, v33, v34
    v_accvgpr_write_b32 a109, v33
    v_accvgpr_read_b32 v33, a110
    v_mul_f32 v33, v33, v34
    v_accvgpr_write_b32 a110, v33
    v_accvgpr_read_b32 v33, a111
    v_mul_f32 v33, v33, v34
    v_accvgpr_write_b32 a111, v33
    v_accvgpr_read_b32 v33, a112
    v_mul_f32 v33, v33, v34
    v_accvgpr_write_b32 a112, v33
    v_accvgpr_read_b32 v33, a113
    v_mul_f32 v33, v33, v34
    v_accvgpr_write_b32 a113, v33
    v_accvgpr_read_b32 v33, a114
    v_mul_f32 v33, v33, v34
    v_accvgpr_write_b32 a114, v33
    v_accvgpr_read_b32 v33, a115
    v_mul_f32 v33, v33, v34
    v_accvgpr_write_b32 a115, v33
    v_accvgpr_read_b32 v33, a116
    v_mul_f32 v33, v33, v34
    v_accvgpr_write_b32 a116, v33
    v_accvgpr_read_b32 v33, a117
    v_mul_f32 v33, v33, v34
    v_accvgpr_write_b32 a117, v33
    v_accvgpr_read_b32 v33, a118
    v_mul_f32 v33, v33, v34
    v_accvgpr_write_b32 a118, v33
    v_accvgpr_read_b32 v33, a119
    v_mul_f32 v33, v33, v34
    v_accvgpr_write_b32 a119, v33
    v_accvgpr_read_b32 v33, a120
    v_mul_f32 v33, v33, v34
    v_accvgpr_write_b32 a120, v33
    v_accvgpr_read_b32 v33, a121
    v_mul_f32 v33, v33, v34
    v_accvgpr_write_b32 a121, v33
    v_accvgpr_read_b32 v33, a122
    v_mul_f32 v33, v33, v34
    v_accvgpr_write_b32 a122, v33
    v_accvgpr_read_b32 v33, a123
    v_mul_f32 v33, v33, v34
    v_accvgpr_write_b32 a123, v33
    v_accvgpr_read_b32 v33, a124
    v_mul_f32 v33, v33, v34
    v_accvgpr_write_b32 a124, v33
    v_accvgpr_read_b32 v33, a125
    v_mul_f32 v33, v33, v34
    v_accvgpr_write_b32 a125, v33
    v_accvgpr_read_b32 v33, a126
    v_mul_f32 v33, v33, v34
    v_accvgpr_write_b32 a126, v33
    v_accvgpr_read_b32 v33, a127
    v_mul_f32 v33, v33, v34
    v_accvgpr_write_b32 a127, v33
    v_exp_f32 v36, v200
    v_exp_f32 v37, v201
    s_nop 0
    v_cvt_pk_bf16_f32 v236, v36, v37
    v_exp_f32 v36, v202
    v_exp_f32 v37, v203
    s_nop 0
    v_cvt_pk_bf16_f32 v237, v36, v37
    v_exp_f32 v36, v204
    v_exp_f32 v37, v205
    s_nop 0
    v_cvt_pk_bf16_f32 v238, v36, v37
    v_exp_f32 v36, v206
    v_exp_f32 v37, v207
    s_nop 0
    v_cvt_pk_bf16_f32 v239, v36, v37
    s_nop 1
    s_branch gated_mix__ssm_conv_h3__compressed_kv_cla__prompt_kernel_b4_r1_ret
gated_mix__ssm_conv_h3__compressed_kv_cla__prompt_kernel_b3_r0:
    s_nop 7
    v_max3_f32 v32, v152, v153, v154
    v_max3_f32 v32, v155, v156, v32
    v_max3_f32 v32, v157, v158, v32
    v_max_f32 v32, v159, v32
    v_mov_b32 v33, v32
    s_nop 1
    v_permlane16_swap_b32 v32, v33
    s_nop 1
    v_max_f32 v32, v32, v33
    v_mov_b32 v33, v32
    s_nop 1
    v_permlane32_swap_b32 v32, v33
    s_nop 1
    v_max_f32 v32, v32, v33
    v_add_f32 v32, 0x41c00000, v32
    v_max_f32 v32, 0, v32
    v_exp_f32 v34, -v32
    v_sub_f32 v68, v68, v32
    v_sub_f32 v69, v69, v32
    v_sub_f32 v70, v70, v32
    v_sub_f32 v71, v71, v32
    v_sub_f32 v152, v152, v32
    v_sub_f32 v153, v153, v32
    v_sub_f32 v154, v154, v32
    v_sub_f32 v155, v155, v32
    v_sub_f32 v156, v156, v32
    v_sub_f32 v157, v157, v32
    v_sub_f32 v158, v158, v32
    v_sub_f32 v159, v159, v32
    v_sub_f32 v184, v184, v32
    v_sub_f32 v185, v185, v32
    v_sub_f32 v186, v186, v32
    v_sub_f32 v187, v187, v32
    v_sub_f32 v188, v188, v32
    v_sub_f32 v189, v189, v32
    v_sub_f32 v190, v190, v32
    v_sub_f32 v191, v191, v32
    v_mul_f32 v244, v244, v34
    v_mul_f32 v245, v245, v34
    v_mul_f32 v246, v246, v34
    v_mul_f32 v247, v247, v34
    v_accvgpr_read_b32 v33, a32
    v_mul_f32 v33, v33, v34
    v_accvgpr_write_b32 a32, v33
    v_accvgpr_read_b32 v33, a33
    v_mul_f32 v33, v33, v34
    v_accvgpr_write_b32 a33, v33
    v_accvgpr_read_b32 v33, a34
    v_mul_f32 v33, v33, v34
    v_accvgpr_write_b32 a34, v33
    v_accvgpr_read_b32 v33, a35
    v_mul_f32 v33, v33, v34
    v_accvgpr_write_b32 a35, v33
    v_accvgpr_read_b32 v33, a36
    v_mul_f32 v33, v33, v34
    v_accvgpr_write_b32 a36, v33
    v_accvgpr_read_b32 v33, a37
    v_mul_f32 v33, v33, v34
    v_accvgpr_write_b32 a37, v33
    v_accvgpr_read_b32 v33, a38
    v_mul_f32 v33, v33, v34
    v_accvgpr_write_b32 a38, v33
    v_accvgpr_read_b32 v33, a39
    v_mul_f32 v33, v33, v34
    v_accvgpr_write_b32 a39, v33
    v_accvgpr_read_b32 v33, a40
    v_mul_f32 v33, v33, v34
    v_accvgpr_write_b32 a40, v33
    v_accvgpr_read_b32 v33, a41
    v_mul_f32 v33, v33, v34
    v_accvgpr_write_b32 a41, v33
    v_accvgpr_read_b32 v33, a42
    v_mul_f32 v33, v33, v34
    v_accvgpr_write_b32 a42, v33
    v_accvgpr_read_b32 v33, a43
    v_mul_f32 v33, v33, v34
    v_accvgpr_write_b32 a43, v33
    v_accvgpr_read_b32 v33, a44
    v_mul_f32 v33, v33, v34
    v_accvgpr_write_b32 a44, v33
    v_accvgpr_read_b32 v33, a45
    v_mul_f32 v33, v33, v34
    v_accvgpr_write_b32 a45, v33
    v_accvgpr_read_b32 v33, a46
    v_mul_f32 v33, v33, v34
    v_accvgpr_write_b32 a46, v33
    v_accvgpr_read_b32 v33, a47
    v_mul_f32 v33, v33, v34
    v_accvgpr_write_b32 a47, v33
    v_accvgpr_read_b32 v33, a48
    v_mul_f32 v33, v33, v34
    v_accvgpr_write_b32 a48, v33
    v_accvgpr_read_b32 v33, a49
    v_mul_f32 v33, v33, v34
    v_accvgpr_write_b32 a49, v33
    v_accvgpr_read_b32 v33, a50
    v_mul_f32 v33, v33, v34
    v_accvgpr_write_b32 a50, v33
    v_accvgpr_read_b32 v33, a51
    v_mul_f32 v33, v33, v34
    v_accvgpr_write_b32 a51, v33
    v_accvgpr_read_b32 v33, a52
    v_mul_f32 v33, v33, v34
    v_accvgpr_write_b32 a52, v33
    v_accvgpr_read_b32 v33, a53
    v_mul_f32 v33, v33, v34
    v_accvgpr_write_b32 a53, v33
    v_accvgpr_read_b32 v33, a54
    v_mul_f32 v33, v33, v34
    v_accvgpr_write_b32 a54, v33
    v_accvgpr_read_b32 v33, a55
    v_mul_f32 v33, v33, v34
    v_accvgpr_write_b32 a55, v33
    v_accvgpr_read_b32 v33, a56
    v_mul_f32 v33, v33, v34
    v_accvgpr_write_b32 a56, v33
    v_accvgpr_read_b32 v33, a57
    v_mul_f32 v33, v33, v34
    v_accvgpr_write_b32 a57, v33
    v_accvgpr_read_b32 v33, a58
    v_mul_f32 v33, v33, v34
    v_accvgpr_write_b32 a58, v33
    v_accvgpr_read_b32 v33, a59
    v_mul_f32 v33, v33, v34
    v_accvgpr_write_b32 a59, v33
    v_accvgpr_read_b32 v33, a60
    v_mul_f32 v33, v33, v34
    v_accvgpr_write_b32 a60, v33
    v_accvgpr_read_b32 v33, a61
    v_mul_f32 v33, v33, v34
    v_accvgpr_write_b32 a61, v33
    v_accvgpr_read_b32 v33, a62
    v_mul_f32 v33, v33, v34
    v_accvgpr_write_b32 a62, v33
    v_accvgpr_read_b32 v33, a63
    v_mul_f32 v33, v33, v34
    v_accvgpr_write_b32 a63, v33
    v_exp_f32 v36, v152
    v_exp_f32 v37, v153
    s_nop 0
    v_cvt_pk_bf16_f32 v212, v36, v37
    v_exp_f32 v36, v154
    v_exp_f32 v37, v155
    s_nop 0
    v_cvt_pk_bf16_f32 v213, v36, v37
    v_exp_f32 v36, v156
    v_exp_f32 v37, v157
    s_nop 0
    v_cvt_pk_bf16_f32 v214, v36, v37
    v_exp_f32 v36, v158
    v_exp_f32 v37, v159
    s_nop 0
    v_cvt_pk_bf16_f32 v215, v36, v37
    v_max3_f32 v32, v160, v161, v162
    v_max3_f32 v32, v163, v164, v32
    v_max3_f32 v32, v165, v166, v32
    v_max_f32 v32, v167, v32
    v_mov_b32 v33, v32
    s_nop 1
    v_permlane16_swap_b32 v32, v33
    s_nop 1
    v_max_f32 v32, v32, v33
    v_mov_b32 v33, v32
    s_nop 1
    v_permlane32_swap_b32 v32, v33
    s_nop 1
    v_max_f32 v32, v32, v33
    v_add_f32 v32, 0x41c00000, v32
    v_max_f32 v32, 0, v32
    v_exp_f32 v34, -v32
    v_sub_f32 v72, v72, v32
    v_sub_f32 v73, v73, v32
    v_sub_f32 v74, v74, v32
    v_sub_f32 v75, v75, v32
    v_sub_f32 v160, v160, v32
    v_sub_f32 v161, v161, v32
    v_sub_f32 v162, v162, v32
    v_sub_f32 v163, v163, v32
    v_sub_f32 v164, v164, v32
    v_sub_f32 v165, v165, v32
    v_sub_f32 v166, v166, v32
    v_sub_f32 v167, v167, v32
    v_sub_f32 v192, v192, v32
    v_sub_f32 v193, v193, v32
    v_sub_f32 v194, v194, v32
    v_sub_f32 v195, v195, v32
    v_sub_f32 v196, v196, v32
    v_sub_f32 v197, v197, v32
    v_sub_f32 v198, v198, v32
    v_sub_f32 v199, v199, v32
    v_mul_f32 v248, v248, v34
    v_mul_f32 v249, v249, v34
    v_mul_f32 v250, v250, v34
    v_mul_f32 v251, v251, v34
    v_accvgpr_read_b32 v33, a64
    v_mul_f32 v33, v33, v34
    v_accvgpr_write_b32 a64, v33
    v_accvgpr_read_b32 v33, a65
    v_mul_f32 v33, v33, v34
    v_accvgpr_write_b32 a65, v33
    v_accvgpr_read_b32 v33, a66
    v_mul_f32 v33, v33, v34
    v_accvgpr_write_b32 a66, v33
    v_accvgpr_read_b32 v33, a67
    v_mul_f32 v33, v33, v34
    v_accvgpr_write_b32 a67, v33
    v_accvgpr_read_b32 v33, a68
    v_mul_f32 v33, v33, v34
    v_accvgpr_write_b32 a68, v33
    v_accvgpr_read_b32 v33, a69
    v_mul_f32 v33, v33, v34
    v_accvgpr_write_b32 a69, v33
    v_accvgpr_read_b32 v33, a70
    v_mul_f32 v33, v33, v34
    v_accvgpr_write_b32 a70, v33
    v_accvgpr_read_b32 v33, a71
    v_mul_f32 v33, v33, v34
    v_accvgpr_write_b32 a71, v33
    v_accvgpr_read_b32 v33, a72
    v_mul_f32 v33, v33, v34
    v_accvgpr_write_b32 a72, v33
    v_accvgpr_read_b32 v33, a73
    v_mul_f32 v33, v33, v34
    v_accvgpr_write_b32 a73, v33
    v_accvgpr_read_b32 v33, a74
    v_mul_f32 v33, v33, v34
    v_accvgpr_write_b32 a74, v33
    v_accvgpr_read_b32 v33, a75
    v_mul_f32 v33, v33, v34
    v_accvgpr_write_b32 a75, v33
    v_accvgpr_read_b32 v33, a76
    v_mul_f32 v33, v33, v34
    v_accvgpr_write_b32 a76, v33
    v_accvgpr_read_b32 v33, a77
    v_mul_f32 v33, v33, v34
    v_accvgpr_write_b32 a77, v33
    v_accvgpr_read_b32 v33, a78
    v_mul_f32 v33, v33, v34
    v_accvgpr_write_b32 a78, v33
    v_accvgpr_read_b32 v33, a79
    v_mul_f32 v33, v33, v34
    v_accvgpr_write_b32 a79, v33
    v_accvgpr_read_b32 v33, a80
    v_mul_f32 v33, v33, v34
    v_accvgpr_write_b32 a80, v33
    v_accvgpr_read_b32 v33, a81
    v_mul_f32 v33, v33, v34
    v_accvgpr_write_b32 a81, v33
    v_accvgpr_read_b32 v33, a82
    v_mul_f32 v33, v33, v34
    v_accvgpr_write_b32 a82, v33
    v_accvgpr_read_b32 v33, a83
    v_mul_f32 v33, v33, v34
    v_accvgpr_write_b32 a83, v33
    v_accvgpr_read_b32 v33, a84
    v_mul_f32 v33, v33, v34
    v_accvgpr_write_b32 a84, v33
    v_accvgpr_read_b32 v33, a85
    v_mul_f32 v33, v33, v34
    v_accvgpr_write_b32 a85, v33
    v_accvgpr_read_b32 v33, a86
    v_mul_f32 v33, v33, v34
    v_accvgpr_write_b32 a86, v33
    v_accvgpr_read_b32 v33, a87
    v_mul_f32 v33, v33, v34
    v_accvgpr_write_b32 a87, v33
    v_accvgpr_read_b32 v33, a88
    v_mul_f32 v33, v33, v34
    v_accvgpr_write_b32 a88, v33
    v_accvgpr_read_b32 v33, a89
    v_mul_f32 v33, v33, v34
    v_accvgpr_write_b32 a89, v33
    v_accvgpr_read_b32 v33, a90
    v_mul_f32 v33, v33, v34
    v_accvgpr_write_b32 a90, v33
    v_accvgpr_read_b32 v33, a91
    v_mul_f32 v33, v33, v34
    v_accvgpr_write_b32 a91, v33
    v_accvgpr_read_b32 v33, a92
    v_mul_f32 v33, v33, v34
    v_accvgpr_write_b32 a92, v33
    v_accvgpr_read_b32 v33, a93
    v_mul_f32 v33, v33, v34
    v_accvgpr_write_b32 a93, v33
    v_accvgpr_read_b32 v33, a94
    v_mul_f32 v33, v33, v34
    v_accvgpr_write_b32 a94, v33
    v_accvgpr_read_b32 v33, a95
    v_mul_f32 v33, v33, v34
    v_accvgpr_write_b32 a95, v33
    v_exp_f32 v36, v160
    v_exp_f32 v37, v161
    s_nop 0
    v_cvt_pk_bf16_f32 v216, v36, v37
    v_exp_f32 v36, v162
    v_exp_f32 v37, v163
    s_nop 0
    v_cvt_pk_bf16_f32 v217, v36, v37
    v_exp_f32 v36, v164
    v_exp_f32 v37, v165
    s_nop 0
    v_cvt_pk_bf16_f32 v218, v36, v37
    v_exp_f32 v36, v166
    v_exp_f32 v37, v167
    s_nop 0
    v_cvt_pk_bf16_f32 v219, v36, v37
    v_max3_f32 v32, v168, v169, v170
    v_max3_f32 v32, v171, v172, v32
    v_max3_f32 v32, v173, v174, v32
    v_max_f32 v32, v175, v32
    v_mov_b32 v33, v32
    s_nop 1
    v_permlane16_swap_b32 v32, v33
    s_nop 1
    v_max_f32 v32, v32, v33
    v_mov_b32 v33, v32
    s_nop 1
    v_permlane32_swap_b32 v32, v33
    s_nop 1
    v_max_f32 v32, v32, v33
    v_add_f32 v32, 0x41c00000, v32
    v_max_f32 v32, 0, v32
    v_exp_f32 v34, -v32
    v_sub_f32 v76, v76, v32
    v_sub_f32 v77, v77, v32
    v_sub_f32 v78, v78, v32
    v_sub_f32 v79, v79, v32
    v_sub_f32 v168, v168, v32
    v_sub_f32 v169, v169, v32
    v_sub_f32 v170, v170, v32
    v_sub_f32 v171, v171, v32
    v_sub_f32 v172, v172, v32
    v_sub_f32 v173, v173, v32
    v_sub_f32 v174, v174, v32
    v_sub_f32 v175, v175, v32
    v_sub_f32 v200, v200, v32
    v_sub_f32 v201, v201, v32
    v_sub_f32 v202, v202, v32
    v_sub_f32 v203, v203, v32
    v_sub_f32 v204, v204, v32
    v_sub_f32 v205, v205, v32
    v_sub_f32 v206, v206, v32
    v_sub_f32 v207, v207, v32
    v_mul_f32 v252, v252, v34
    v_mul_f32 v253, v253, v34
    v_mul_f32 v254, v254, v34
    v_mul_f32 v255, v255, v34
    v_accvgpr_read_b32 v33, a96
    v_mul_f32 v33, v33, v34
    v_accvgpr_write_b32 a96, v33
    v_accvgpr_read_b32 v33, a97
    v_mul_f32 v33, v33, v34
    v_accvgpr_write_b32 a97, v33
    v_accvgpr_read_b32 v33, a98
    v_mul_f32 v33, v33, v34
    v_accvgpr_write_b32 a98, v33
    v_accvgpr_read_b32 v33, a99
    v_mul_f32 v33, v33, v34
    v_accvgpr_write_b32 a99, v33
    v_accvgpr_read_b32 v33, a100
    v_mul_f32 v33, v33, v34
    v_accvgpr_write_b32 a100, v33
    v_accvgpr_read_b32 v33, a101
    v_mul_f32 v33, v33, v34
    v_accvgpr_write_b32 a101, v33
    v_accvgpr_read_b32 v33, a102
    v_mul_f32 v33, v33, v34
    v_accvgpr_write_b32 a102, v33
    v_accvgpr_read_b32 v33, a103
    v_mul_f32 v33, v33, v34
    v_accvgpr_write_b32 a103, v33
    v_accvgpr_read_b32 v33, a104
    v_mul_f32 v33, v33, v34
    v_accvgpr_write_b32 a104, v33
    v_accvgpr_read_b32 v33, a105
    v_mul_f32 v33, v33, v34
    v_accvgpr_write_b32 a105, v33
    v_accvgpr_read_b32 v33, a106
    v_mul_f32 v33, v33, v34
    v_accvgpr_write_b32 a106, v33
    v_accvgpr_read_b32 v33, a107
    v_mul_f32 v33, v33, v34
    v_accvgpr_write_b32 a107, v33
    v_accvgpr_read_b32 v33, a108
    v_mul_f32 v33, v33, v34
    v_accvgpr_write_b32 a108, v33
    v_accvgpr_read_b32 v33, a109
    v_mul_f32 v33, v33, v34
    v_accvgpr_write_b32 a109, v33
    v_accvgpr_read_b32 v33, a110
    v_mul_f32 v33, v33, v34
    v_accvgpr_write_b32 a110, v33
    v_accvgpr_read_b32 v33, a111
    v_mul_f32 v33, v33, v34
    v_accvgpr_write_b32 a111, v33
    v_accvgpr_read_b32 v33, a112
    v_mul_f32 v33, v33, v34
    v_accvgpr_write_b32 a112, v33
    v_accvgpr_read_b32 v33, a113
    v_mul_f32 v33, v33, v34
    v_accvgpr_write_b32 a113, v33
    v_accvgpr_read_b32 v33, a114
    v_mul_f32 v33, v33, v34
    v_accvgpr_write_b32 a114, v33
    v_accvgpr_read_b32 v33, a115
    v_mul_f32 v33, v33, v34
    v_accvgpr_write_b32 a115, v33
    v_accvgpr_read_b32 v33, a116
    v_mul_f32 v33, v33, v34
    v_accvgpr_write_b32 a116, v33
    v_accvgpr_read_b32 v33, a117
    v_mul_f32 v33, v33, v34
    v_accvgpr_write_b32 a117, v33
    v_accvgpr_read_b32 v33, a118
    v_mul_f32 v33, v33, v34
    v_accvgpr_write_b32 a118, v33
    v_accvgpr_read_b32 v33, a119
    v_mul_f32 v33, v33, v34
    v_accvgpr_write_b32 a119, v33
    v_accvgpr_read_b32 v33, a120
    v_mul_f32 v33, v33, v34
    v_accvgpr_write_b32 a120, v33
    v_accvgpr_read_b32 v33, a121
    v_mul_f32 v33, v33, v34
    v_accvgpr_write_b32 a121, v33
    v_accvgpr_read_b32 v33, a122
    v_mul_f32 v33, v33, v34
    v_accvgpr_write_b32 a122, v33
    v_accvgpr_read_b32 v33, a123
    v_mul_f32 v33, v33, v34
    v_accvgpr_write_b32 a123, v33
    v_accvgpr_read_b32 v33, a124
    v_mul_f32 v33, v33, v34
    v_accvgpr_write_b32 a124, v33
    v_accvgpr_read_b32 v33, a125
    v_mul_f32 v33, v33, v34
    v_accvgpr_write_b32 a125, v33
    v_accvgpr_read_b32 v33, a126
    v_mul_f32 v33, v33, v34
    v_accvgpr_write_b32 a126, v33
    v_accvgpr_read_b32 v33, a127
    v_mul_f32 v33, v33, v34
    v_accvgpr_write_b32 a127, v33
    v_exp_f32 v36, v168
    v_exp_f32 v37, v169
    s_nop 0
    v_cvt_pk_bf16_f32 v220, v36, v37
    v_exp_f32 v36, v170
    v_exp_f32 v37, v171
    s_nop 0
    v_cvt_pk_bf16_f32 v221, v36, v37
    v_exp_f32 v36, v172
    v_exp_f32 v37, v173
    s_nop 0
    v_cvt_pk_bf16_f32 v222, v36, v37
    v_exp_f32 v36, v174
    v_exp_f32 v37, v175
    s_nop 0
    v_cvt_pk_bf16_f32 v223, v36, v37
    s_nop 1
    s_branch gated_mix__ssm_conv_h3__compressed_kv_cla__prompt_kernel_b3_r0_ret
gated_mix__ssm_conv_h3__compressed_kv_cla__prompt_kernel_b3_r1:
    s_nop 7
    v_max3_f32 v32, v184, v185, v186
    v_max3_f32 v32, v187, v188, v32
    v_max3_f32 v32, v189, v190, v32
    v_max_f32 v32, v191, v32
    v_mov_b32 v33, v32
    s_nop 1
    v_permlane16_swap_b32 v32, v33
    s_nop 1
    v_max_f32 v32, v32, v33
    v_mov_b32 v33, v32
    s_nop 1
    v_permlane32_swap_b32 v32, v33
    s_nop 1
    v_max_f32 v32, v32, v33
    v_add_f32 v32, 0x41c00000, v32
    v_max_f32 v32, 0, v32
    v_exp_f32 v34, -v32
    v_sub_f32 v68, v68, v32
    v_sub_f32 v69, v69, v32
    v_sub_f32 v70, v70, v32
    v_sub_f32 v71, v71, v32
    v_sub_f32 v184, v184, v32
    v_sub_f32 v185, v185, v32
    v_sub_f32 v186, v186, v32
    v_sub_f32 v187, v187, v32
    v_sub_f32 v188, v188, v32
    v_sub_f32 v189, v189, v32
    v_sub_f32 v190, v190, v32
    v_sub_f32 v191, v191, v32
    v_sub_f32 v152, v152, v32
    v_sub_f32 v153, v153, v32
    v_sub_f32 v154, v154, v32
    v_sub_f32 v155, v155, v32
    v_sub_f32 v156, v156, v32
    v_sub_f32 v157, v157, v32
    v_sub_f32 v158, v158, v32
    v_sub_f32 v159, v159, v32
    v_mul_f32 v244, v244, v34
    v_mul_f32 v245, v245, v34
    v_mul_f32 v246, v246, v34
    v_mul_f32 v247, v247, v34
    v_accvgpr_read_b32 v33, a32
    v_mul_f32 v33, v33, v34
    v_accvgpr_write_b32 a32, v33
    v_accvgpr_read_b32 v33, a33
    v_mul_f32 v33, v33, v34
    v_accvgpr_write_b32 a33, v33
    v_accvgpr_read_b32 v33, a34
    v_mul_f32 v33, v33, v34
    v_accvgpr_write_b32 a34, v33
    v_accvgpr_read_b32 v33, a35
    v_mul_f32 v33, v33, v34
    v_accvgpr_write_b32 a35, v33
    v_accvgpr_read_b32 v33, a36
    v_mul_f32 v33, v33, v34
    v_accvgpr_write_b32 a36, v33
    v_accvgpr_read_b32 v33, a37
    v_mul_f32 v33, v33, v34
    v_accvgpr_write_b32 a37, v33
    v_accvgpr_read_b32 v33, a38
    v_mul_f32 v33, v33, v34
    v_accvgpr_write_b32 a38, v33
    v_accvgpr_read_b32 v33, a39
    v_mul_f32 v33, v33, v34
    v_accvgpr_write_b32 a39, v33
    v_accvgpr_read_b32 v33, a40
    v_mul_f32 v33, v33, v34
    v_accvgpr_write_b32 a40, v33
    v_accvgpr_read_b32 v33, a41
    v_mul_f32 v33, v33, v34
    v_accvgpr_write_b32 a41, v33
    v_accvgpr_read_b32 v33, a42
    v_mul_f32 v33, v33, v34
    v_accvgpr_write_b32 a42, v33
    v_accvgpr_read_b32 v33, a43
    v_mul_f32 v33, v33, v34
    v_accvgpr_write_b32 a43, v33
    v_accvgpr_read_b32 v33, a44
    v_mul_f32 v33, v33, v34
    v_accvgpr_write_b32 a44, v33
    v_accvgpr_read_b32 v33, a45
    v_mul_f32 v33, v33, v34
    v_accvgpr_write_b32 a45, v33
    v_accvgpr_read_b32 v33, a46
    v_mul_f32 v33, v33, v34
    v_accvgpr_write_b32 a46, v33
    v_accvgpr_read_b32 v33, a47
    v_mul_f32 v33, v33, v34
    v_accvgpr_write_b32 a47, v33
    v_accvgpr_read_b32 v33, a48
    v_mul_f32 v33, v33, v34
    v_accvgpr_write_b32 a48, v33
    v_accvgpr_read_b32 v33, a49
    v_mul_f32 v33, v33, v34
    v_accvgpr_write_b32 a49, v33
    v_accvgpr_read_b32 v33, a50
    v_mul_f32 v33, v33, v34
    v_accvgpr_write_b32 a50, v33
    v_accvgpr_read_b32 v33, a51
    v_mul_f32 v33, v33, v34
    v_accvgpr_write_b32 a51, v33
    v_accvgpr_read_b32 v33, a52
    v_mul_f32 v33, v33, v34
    v_accvgpr_write_b32 a52, v33
    v_accvgpr_read_b32 v33, a53
    v_mul_f32 v33, v33, v34
    v_accvgpr_write_b32 a53, v33
    v_accvgpr_read_b32 v33, a54
    v_mul_f32 v33, v33, v34
    v_accvgpr_write_b32 a54, v33
    v_accvgpr_read_b32 v33, a55
    v_mul_f32 v33, v33, v34
    v_accvgpr_write_b32 a55, v33
    v_accvgpr_read_b32 v33, a56
    v_mul_f32 v33, v33, v34
    v_accvgpr_write_b32 a56, v33
    v_accvgpr_read_b32 v33, a57
    v_mul_f32 v33, v33, v34
    v_accvgpr_write_b32 a57, v33
    v_accvgpr_read_b32 v33, a58
    v_mul_f32 v33, v33, v34
    v_accvgpr_write_b32 a58, v33
    v_accvgpr_read_b32 v33, a59
    v_mul_f32 v33, v33, v34
    v_accvgpr_write_b32 a59, v33
    v_accvgpr_read_b32 v33, a60
    v_mul_f32 v33, v33, v34
    v_accvgpr_write_b32 a60, v33
    v_accvgpr_read_b32 v33, a61
    v_mul_f32 v33, v33, v34
    v_accvgpr_write_b32 a61, v33
    v_accvgpr_read_b32 v33, a62
    v_mul_f32 v33, v33, v34
    v_accvgpr_write_b32 a62, v33
    v_accvgpr_read_b32 v33, a63
    v_mul_f32 v33, v33, v34
    v_accvgpr_write_b32 a63, v33
    v_exp_f32 v36, v184
    v_exp_f32 v37, v185
    s_nop 0
    v_cvt_pk_bf16_f32 v228, v36, v37
    v_exp_f32 v36, v186
    v_exp_f32 v37, v187
    s_nop 0
    v_cvt_pk_bf16_f32 v229, v36, v37
    v_exp_f32 v36, v188
    v_exp_f32 v37, v189
    s_nop 0
    v_cvt_pk_bf16_f32 v230, v36, v37
    v_exp_f32 v36, v190
    v_exp_f32 v37, v191
    s_nop 0
    v_cvt_pk_bf16_f32 v231, v36, v37
    v_max3_f32 v32, v192, v193, v194
    v_max3_f32 v32, v195, v196, v32
    v_max3_f32 v32, v197, v198, v32
    v_max_f32 v32, v199, v32
    v_mov_b32 v33, v32
    s_nop 1
    v_permlane16_swap_b32 v32, v33
    s_nop 1
    v_max_f32 v32, v32, v33
    v_mov_b32 v33, v32
    s_nop 1
    v_permlane32_swap_b32 v32, v33
    s_nop 1
    v_max_f32 v32, v32, v33
    v_add_f32 v32, 0x41c00000, v32
    v_max_f32 v32, 0, v32
    v_exp_f32 v34, -v32
    v_sub_f32 v72, v72, v32
    v_sub_f32 v73, v73, v32
    v_sub_f32 v74, v74, v32
    v_sub_f32 v75, v75, v32
    v_sub_f32 v192, v192, v32
    v_sub_f32 v193, v193, v32
    v_sub_f32 v194, v194, v32
    v_sub_f32 v195, v195, v32
    v_sub_f32 v196, v196, v32
    v_sub_f32 v197, v197, v32
    v_sub_f32 v198, v198, v32
    v_sub_f32 v199, v199, v32
    v_sub_f32 v160, v160, v32
    v_sub_f32 v161, v161, v32
    v_sub_f32 v162, v162, v32
    v_sub_f32 v163, v163, v32
    v_sub_f32 v164, v164, v32
    v_sub_f32 v165, v165, v32
    v_sub_f32 v166, v166, v32
    v_sub_f32 v167, v167, v32
    v_mul_f32 v248, v248, v34
    v_mul_f32 v249, v249, v34
    v_mul_f32 v250, v250, v34
    v_mul_f32 v251, v251, v34
    v_accvgpr_read_b32 v33, a64
    v_mul_f32 v33, v33, v34
    v_accvgpr_write_b32 a64, v33
    v_accvgpr_read_b32 v33, a65
    v_mul_f32 v33, v33, v34
    v_accvgpr_write_b32 a65, v33
    v_accvgpr_read_b32 v33, a66
    v_mul_f32 v33, v33, v34
    v_accvgpr_write_b32 a66, v33
    v_accvgpr_read_b32 v33, a67
    v_mul_f32 v33, v33, v34
    v_accvgpr_write_b32 a67, v33
    v_accvgpr_read_b32 v33, a68
    v_mul_f32 v33, v33, v34
    v_accvgpr_write_b32 a68, v33
    v_accvgpr_read_b32 v33, a69
    v_mul_f32 v33, v33, v34
    v_accvgpr_write_b32 a69, v33
    v_accvgpr_read_b32 v33, a70
    v_mul_f32 v33, v33, v34
    v_accvgpr_write_b32 a70, v33
    v_accvgpr_read_b32 v33, a71
    v_mul_f32 v33, v33, v34
    v_accvgpr_write_b32 a71, v33
    v_accvgpr_read_b32 v33, a72
    v_mul_f32 v33, v33, v34
    v_accvgpr_write_b32 a72, v33
    v_accvgpr_read_b32 v33, a73
    v_mul_f32 v33, v33, v34
    v_accvgpr_write_b32 a73, v33
    v_accvgpr_read_b32 v33, a74
    v_mul_f32 v33, v33, v34
    v_accvgpr_write_b32 a74, v33
    v_accvgpr_read_b32 v33, a75
    v_mul_f32 v33, v33, v34
    v_accvgpr_write_b32 a75, v33
    v_accvgpr_read_b32 v33, a76
    v_mul_f32 v33, v33, v34
    v_accvgpr_write_b32 a76, v33
    v_accvgpr_read_b32 v33, a77
    v_mul_f32 v33, v33, v34
    v_accvgpr_write_b32 a77, v33
    v_accvgpr_read_b32 v33, a78
    v_mul_f32 v33, v33, v34
    v_accvgpr_write_b32 a78, v33
    v_accvgpr_read_b32 v33, a79
    v_mul_f32 v33, v33, v34
    v_accvgpr_write_b32 a79, v33
    v_accvgpr_read_b32 v33, a80
    v_mul_f32 v33, v33, v34
    v_accvgpr_write_b32 a80, v33
    v_accvgpr_read_b32 v33, a81
    v_mul_f32 v33, v33, v34
    v_accvgpr_write_b32 a81, v33
    v_accvgpr_read_b32 v33, a82
    v_mul_f32 v33, v33, v34
    v_accvgpr_write_b32 a82, v33
    v_accvgpr_read_b32 v33, a83
    v_mul_f32 v33, v33, v34
    v_accvgpr_write_b32 a83, v33
    v_accvgpr_read_b32 v33, a84
    v_mul_f32 v33, v33, v34
    v_accvgpr_write_b32 a84, v33
    v_accvgpr_read_b32 v33, a85
    v_mul_f32 v33, v33, v34
    v_accvgpr_write_b32 a85, v33
    v_accvgpr_read_b32 v33, a86
    v_mul_f32 v33, v33, v34
    v_accvgpr_write_b32 a86, v33
    v_accvgpr_read_b32 v33, a87
    v_mul_f32 v33, v33, v34
    v_accvgpr_write_b32 a87, v33
    v_accvgpr_read_b32 v33, a88
    v_mul_f32 v33, v33, v34
    v_accvgpr_write_b32 a88, v33
    v_accvgpr_read_b32 v33, a89
    v_mul_f32 v33, v33, v34
    v_accvgpr_write_b32 a89, v33
    v_accvgpr_read_b32 v33, a90
    v_mul_f32 v33, v33, v34
    v_accvgpr_write_b32 a90, v33
    v_accvgpr_read_b32 v33, a91
    v_mul_f32 v33, v33, v34
    v_accvgpr_write_b32 a91, v33
    v_accvgpr_read_b32 v33, a92
    v_mul_f32 v33, v33, v34
    v_accvgpr_write_b32 a92, v33
    v_accvgpr_read_b32 v33, a93
    v_mul_f32 v33, v33, v34
    v_accvgpr_write_b32 a93, v33
    v_accvgpr_read_b32 v33, a94
    v_mul_f32 v33, v33, v34
    v_accvgpr_write_b32 a94, v33
    v_accvgpr_read_b32 v33, a95
    v_mul_f32 v33, v33, v34
    v_accvgpr_write_b32 a95, v33
    v_exp_f32 v36, v192
    v_exp_f32 v37, v193
    s_nop 0
    v_cvt_pk_bf16_f32 v232, v36, v37
    v_exp_f32 v36, v194
    v_exp_f32 v37, v195
    s_nop 0
    v_cvt_pk_bf16_f32 v233, v36, v37
    v_exp_f32 v36, v196
    v_exp_f32 v37, v197
    s_nop 0
    v_cvt_pk_bf16_f32 v234, v36, v37
    v_exp_f32 v36, v198
    v_exp_f32 v37, v199
    s_nop 0
    v_cvt_pk_bf16_f32 v235, v36, v37
    v_max3_f32 v32, v200, v201, v202
    v_max3_f32 v32, v203, v204, v32
    v_max3_f32 v32, v205, v206, v32
    v_max_f32 v32, v207, v32
    v_mov_b32 v33, v32
    s_nop 1
    v_permlane16_swap_b32 v32, v33
    s_nop 1
    v_max_f32 v32, v32, v33
    v_mov_b32 v33, v32
    s_nop 1
    v_permlane32_swap_b32 v32, v33
    s_nop 1
    v_max_f32 v32, v32, v33
    v_add_f32 v32, 0x41c00000, v32
    v_max_f32 v32, 0, v32
    v_exp_f32 v34, -v32
    v_sub_f32 v76, v76, v32
    v_sub_f32 v77, v77, v32
    v_sub_f32 v78, v78, v32
    v_sub_f32 v79, v79, v32
    v_sub_f32 v200, v200, v32
    v_sub_f32 v201, v201, v32
    v_sub_f32 v202, v202, v32
    v_sub_f32 v203, v203, v32
    v_sub_f32 v204, v204, v32
    v_sub_f32 v205, v205, v32
    v_sub_f32 v206, v206, v32
    v_sub_f32 v207, v207, v32
    v_sub_f32 v168, v168, v32
    v_sub_f32 v169, v169, v32
    v_sub_f32 v170, v170, v32
    v_sub_f32 v171, v171, v32
    v_sub_f32 v172, v172, v32
    v_sub_f32 v173, v173, v32
    v_sub_f32 v174, v174, v32
    v_sub_f32 v175, v175, v32
    v_mul_f32 v252, v252, v34
    v_mul_f32 v253, v253, v34
    v_mul_f32 v254, v254, v34
    v_mul_f32 v255, v255, v34
    v_accvgpr_read_b32 v33, a96
    v_mul_f32 v33, v33, v34
    v_accvgpr_write_b32 a96, v33
    v_accvgpr_read_b32 v33, a97
    v_mul_f32 v33, v33, v34
    v_accvgpr_write_b32 a97, v33
    v_accvgpr_read_b32 v33, a98
    v_mul_f32 v33, v33, v34
    v_accvgpr_write_b32 a98, v33
    v_accvgpr_read_b32 v33, a99
    v_mul_f32 v33, v33, v34
    v_accvgpr_write_b32 a99, v33
    v_accvgpr_read_b32 v33, a100
    v_mul_f32 v33, v33, v34
    v_accvgpr_write_b32 a100, v33
    v_accvgpr_read_b32 v33, a101
    v_mul_f32 v33, v33, v34
    v_accvgpr_write_b32 a101, v33
    v_accvgpr_read_b32 v33, a102
    v_mul_f32 v33, v33, v34
    v_accvgpr_write_b32 a102, v33
    v_accvgpr_read_b32 v33, a103
    v_mul_f32 v33, v33, v34
    v_accvgpr_write_b32 a103, v33
    v_accvgpr_read_b32 v33, a104
    v_mul_f32 v33, v33, v34
    v_accvgpr_write_b32 a104, v33
    v_accvgpr_read_b32 v33, a105
    v_mul_f32 v33, v33, v34
    v_accvgpr_write_b32 a105, v33
    v_accvgpr_read_b32 v33, a106
    v_mul_f32 v33, v33, v34
    v_accvgpr_write_b32 a106, v33
    v_accvgpr_read_b32 v33, a107
    v_mul_f32 v33, v33, v34
    v_accvgpr_write_b32 a107, v33
    v_accvgpr_read_b32 v33, a108
    v_mul_f32 v33, v33, v34
    v_accvgpr_write_b32 a108, v33
    v_accvgpr_read_b32 v33, a109
    v_mul_f32 v33, v33, v34
    v_accvgpr_write_b32 a109, v33
    v_accvgpr_read_b32 v33, a110
    v_mul_f32 v33, v33, v34
    v_accvgpr_write_b32 a110, v33
    v_accvgpr_read_b32 v33, a111
    v_mul_f32 v33, v33, v34
    v_accvgpr_write_b32 a111, v33
    v_accvgpr_read_b32 v33, a112
    v_mul_f32 v33, v33, v34
    v_accvgpr_write_b32 a112, v33
    v_accvgpr_read_b32 v33, a113
    v_mul_f32 v33, v33, v34
    v_accvgpr_write_b32 a113, v33
    v_accvgpr_read_b32 v33, a114
    v_mul_f32 v33, v33, v34
    v_accvgpr_write_b32 a114, v33
    v_accvgpr_read_b32 v33, a115
    v_mul_f32 v33, v33, v34
    v_accvgpr_write_b32 a115, v33
    v_accvgpr_read_b32 v33, a116
    v_mul_f32 v33, v33, v34
    v_accvgpr_write_b32 a116, v33
    v_accvgpr_read_b32 v33, a117
    v_mul_f32 v33, v33, v34
    v_accvgpr_write_b32 a117, v33
    v_accvgpr_read_b32 v33, a118
    v_mul_f32 v33, v33, v34
    v_accvgpr_write_b32 a118, v33
    v_accvgpr_read_b32 v33, a119
    v_mul_f32 v33, v33, v34
    v_accvgpr_write_b32 a119, v33
    v_accvgpr_read_b32 v33, a120
    v_mul_f32 v33, v33, v34
    v_accvgpr_write_b32 a120, v33
    v_accvgpr_read_b32 v33, a121
    v_mul_f32 v33, v33, v34
    v_accvgpr_write_b32 a121, v33
    v_accvgpr_read_b32 v33, a122
    v_mul_f32 v33, v33, v34
    v_accvgpr_write_b32 a122, v33
    v_accvgpr_read_b32 v33, a123
    v_mul_f32 v33, v33, v34
    v_accvgpr_write_b32 a123, v33
    v_accvgpr_read_b32 v33, a124
    v_mul_f32 v33, v33, v34
    v_accvgpr_write_b32 a124, v33
    v_accvgpr_read_b32 v33, a125
    v_mul_f32 v33, v33, v34
    v_accvgpr_write_b32 a125, v33
    v_accvgpr_read_b32 v33, a126
    v_mul_f32 v33, v33, v34
    v_accvgpr_write_b32 a126, v33
    v_accvgpr_read_b32 v33, a127
    v_mul_f32 v33, v33, v34
    v_accvgpr_write_b32 a127, v33
    v_exp_f32 v36, v200
    v_exp_f32 v37, v201
    s_nop 0
    v_cvt_pk_bf16_f32 v236, v36, v37
    v_exp_f32 v36, v202
    v_exp_f32 v37, v203
    s_nop 0
    v_cvt_pk_bf16_f32 v237, v36, v37
    v_exp_f32 v36, v204
    v_exp_f32 v37, v205
    s_nop 0
    v_cvt_pk_bf16_f32 v238, v36, v37
    v_exp_f32 v36, v206
    v_exp_f32 v37, v207
    s_nop 0
    v_cvt_pk_bf16_f32 v239, v36, v37
    s_nop 1
    s_branch gated_mix__ssm_conv_h3__compressed_kv_cla__prompt_kernel_b3_r1_ret
gated_mix__ssm_conv_h3__compressed_kv_cla__prompt_kernel_b2_r0:
    s_nop 7
    v_max3_f32 v32, v160, v161, v162
    v_max3_f32 v32, v163, v164, v32
    v_max3_f32 v32, v165, v166, v32
    v_max_f32 v32, v167, v32
    v_mov_b32 v33, v32
    s_nop 1
    v_permlane16_swap_b32 v32, v33
    s_nop 1
    v_max_f32 v32, v32, v33
    v_mov_b32 v33, v32
    s_nop 1
    v_permlane32_swap_b32 v32, v33
    s_nop 1
    v_max_f32 v32, v32, v33
    v_add_f32 v32, 0x41c00000, v32
    v_max_f32 v32, 0, v32
    v_exp_f32 v34, -v32
    v_sub_f32 v72, v72, v32
    v_sub_f32 v73, v73, v32
    v_sub_f32 v74, v74, v32
    v_sub_f32 v75, v75, v32
    v_sub_f32 v160, v160, v32
    v_sub_f32 v161, v161, v32
    v_sub_f32 v162, v162, v32
    v_sub_f32 v163, v163, v32
    v_sub_f32 v164, v164, v32
    v_sub_f32 v165, v165, v32
    v_sub_f32 v166, v166, v32
    v_sub_f32 v167, v167, v32
    v_sub_f32 v192, v192, v32
    v_sub_f32 v193, v193, v32
    v_sub_f32 v194, v194, v32
    v_sub_f32 v195, v195, v32
    v_sub_f32 v196, v196, v32
    v_sub_f32 v197, v197, v32
    v_sub_f32 v198, v198, v32
    v_sub_f32 v199, v199, v32
    v_mul_f32 v248, v248, v34
    v_mul_f32 v249, v249, v34
    v_mul_f32 v250, v250, v34
    v_mul_f32 v251, v251, v34
    v_accvgpr_read_b32 v33, a64
    v_mul_f32 v33, v33, v34
    v_accvgpr_write_b32 a64, v33
    v_accvgpr_read_b32 v33, a65
    v_mul_f32 v33, v33, v34
    v_accvgpr_write_b32 a65, v33
    v_accvgpr_read_b32 v33, a66
    v_mul_f32 v33, v33, v34
    v_accvgpr_write_b32 a66, v33
    v_accvgpr_read_b32 v33, a67
    v_mul_f32 v33, v33, v34
    v_accvgpr_write_b32 a67, v33
    v_accvgpr_read_b32 v33, a68
    v_mul_f32 v33, v33, v34
    v_accvgpr_write_b32 a68, v33
    v_accvgpr_read_b32 v33, a69
    v_mul_f32 v33, v33, v34
    v_accvgpr_write_b32 a69, v33
    v_accvgpr_read_b32 v33, a70
    v_mul_f32 v33, v33, v34
    v_accvgpr_write_b32 a70, v33
    v_accvgpr_read_b32 v33, a71
    v_mul_f32 v33, v33, v34
    v_accvgpr_write_b32 a71, v33
    v_accvgpr_read_b32 v33, a72
    v_mul_f32 v33, v33, v34
    v_accvgpr_write_b32 a72, v33
    v_accvgpr_read_b32 v33, a73
    v_mul_f32 v33, v33, v34
    v_accvgpr_write_b32 a73, v33
    v_accvgpr_read_b32 v33, a74
    v_mul_f32 v33, v33, v34
    v_accvgpr_write_b32 a74, v33
    v_accvgpr_read_b32 v33, a75
    v_mul_f32 v33, v33, v34
    v_accvgpr_write_b32 a75, v33
    v_accvgpr_read_b32 v33, a76
    v_mul_f32 v33, v33, v34
    v_accvgpr_write_b32 a76, v33
    v_accvgpr_read_b32 v33, a77
    v_mul_f32 v33, v33, v34
    v_accvgpr_write_b32 a77, v33
    v_accvgpr_read_b32 v33, a78
    v_mul_f32 v33, v33, v34
    v_accvgpr_write_b32 a78, v33
    v_accvgpr_read_b32 v33, a79
    v_mul_f32 v33, v33, v34
    v_accvgpr_write_b32 a79, v33
    v_accvgpr_read_b32 v33, a80
    v_mul_f32 v33, v33, v34
    v_accvgpr_write_b32 a80, v33
    v_accvgpr_read_b32 v33, a81
    v_mul_f32 v33, v33, v34
    v_accvgpr_write_b32 a81, v33
    v_accvgpr_read_b32 v33, a82
    v_mul_f32 v33, v33, v34
    v_accvgpr_write_b32 a82, v33
    v_accvgpr_read_b32 v33, a83
    v_mul_f32 v33, v33, v34
    v_accvgpr_write_b32 a83, v33
    v_accvgpr_read_b32 v33, a84
    v_mul_f32 v33, v33, v34
    v_accvgpr_write_b32 a84, v33
    v_accvgpr_read_b32 v33, a85
    v_mul_f32 v33, v33, v34
    v_accvgpr_write_b32 a85, v33
    v_accvgpr_read_b32 v33, a86
    v_mul_f32 v33, v33, v34
    v_accvgpr_write_b32 a86, v33
    v_accvgpr_read_b32 v33, a87
    v_mul_f32 v33, v33, v34
    v_accvgpr_write_b32 a87, v33
    v_accvgpr_read_b32 v33, a88
    v_mul_f32 v33, v33, v34
    v_accvgpr_write_b32 a88, v33
    v_accvgpr_read_b32 v33, a89
    v_mul_f32 v33, v33, v34
    v_accvgpr_write_b32 a89, v33
    v_accvgpr_read_b32 v33, a90
    v_mul_f32 v33, v33, v34
    v_accvgpr_write_b32 a90, v33
    v_accvgpr_read_b32 v33, a91
    v_mul_f32 v33, v33, v34
    v_accvgpr_write_b32 a91, v33
    v_accvgpr_read_b32 v33, a92
    v_mul_f32 v33, v33, v34
    v_accvgpr_write_b32 a92, v33
    v_accvgpr_read_b32 v33, a93
    v_mul_f32 v33, v33, v34
    v_accvgpr_write_b32 a93, v33
    v_accvgpr_read_b32 v33, a94
    v_mul_f32 v33, v33, v34
    v_accvgpr_write_b32 a94, v33
    v_accvgpr_read_b32 v33, a95
    v_mul_f32 v33, v33, v34
    v_accvgpr_write_b32 a95, v33
    v_exp_f32 v36, v160
    v_exp_f32 v37, v161
    s_nop 0
    v_cvt_pk_bf16_f32 v216, v36, v37
    v_exp_f32 v36, v162
    v_exp_f32 v37, v163
    s_nop 0
    v_cvt_pk_bf16_f32 v217, v36, v37
    v_exp_f32 v36, v164
    v_exp_f32 v37, v165
    s_nop 0
    v_cvt_pk_bf16_f32 v218, v36, v37
    v_exp_f32 v36, v166
    v_exp_f32 v37, v167
    s_nop 0
    v_cvt_pk_bf16_f32 v219, v36, v37
    v_max3_f32 v32, v168, v169, v170
    v_max3_f32 v32, v171, v172, v32
    v_max3_f32 v32, v173, v174, v32
    v_max_f32 v32, v175, v32
    v_mov_b32 v33, v32
    s_nop 1
    v_permlane16_swap_b32 v32, v33
    s_nop 1
    v_max_f32 v32, v32, v33
    v_mov_b32 v33, v32
    s_nop 1
    v_permlane32_swap_b32 v32, v33
    s_nop 1
    v_max_f32 v32, v32, v33
    v_add_f32 v32, 0x41c00000, v32
    v_max_f32 v32, 0, v32
    v_exp_f32 v34, -v32
    v_sub_f32 v76, v76, v32
    v_sub_f32 v77, v77, v32
    v_sub_f32 v78, v78, v32
    v_sub_f32 v79, v79, v32
    v_sub_f32 v168, v168, v32
    v_sub_f32 v169, v169, v32
    v_sub_f32 v170, v170, v32
    v_sub_f32 v171, v171, v32
    v_sub_f32 v172, v172, v32
    v_sub_f32 v173, v173, v32
    v_sub_f32 v174, v174, v32
    v_sub_f32 v175, v175, v32
    v_sub_f32 v200, v200, v32
    v_sub_f32 v201, v201, v32
    v_sub_f32 v202, v202, v32
    v_sub_f32 v203, v203, v32
    v_sub_f32 v204, v204, v32
    v_sub_f32 v205, v205, v32
    v_sub_f32 v206, v206, v32
    v_sub_f32 v207, v207, v32
    v_mul_f32 v252, v252, v34
    v_mul_f32 v253, v253, v34
    v_mul_f32 v254, v254, v34
    v_mul_f32 v255, v255, v34
    v_accvgpr_read_b32 v33, a96
    v_mul_f32 v33, v33, v34
    v_accvgpr_write_b32 a96, v33
    v_accvgpr_read_b32 v33, a97
    v_mul_f32 v33, v33, v34
    v_accvgpr_write_b32 a97, v33
    v_accvgpr_read_b32 v33, a98
    v_mul_f32 v33, v33, v34
    v_accvgpr_write_b32 a98, v33
    v_accvgpr_read_b32 v33, a99
    v_mul_f32 v33, v33, v34
    v_accvgpr_write_b32 a99, v33
    v_accvgpr_read_b32 v33, a100
    v_mul_f32 v33, v33, v34
    v_accvgpr_write_b32 a100, v33
    v_accvgpr_read_b32 v33, a101
    v_mul_f32 v33, v33, v34
    v_accvgpr_write_b32 a101, v33
    v_accvgpr_read_b32 v33, a102
    v_mul_f32 v33, v33, v34
    v_accvgpr_write_b32 a102, v33
    v_accvgpr_read_b32 v33, a103
    v_mul_f32 v33, v33, v34
    v_accvgpr_write_b32 a103, v33
    v_accvgpr_read_b32 v33, a104
    v_mul_f32 v33, v33, v34
    v_accvgpr_write_b32 a104, v33
    v_accvgpr_read_b32 v33, a105
    v_mul_f32 v33, v33, v34
    v_accvgpr_write_b32 a105, v33
    v_accvgpr_read_b32 v33, a106
    v_mul_f32 v33, v33, v34
    v_accvgpr_write_b32 a106, v33
    v_accvgpr_read_b32 v33, a107
    v_mul_f32 v33, v33, v34
    v_accvgpr_write_b32 a107, v33
    v_accvgpr_read_b32 v33, a108
    v_mul_f32 v33, v33, v34
    v_accvgpr_write_b32 a108, v33
    v_accvgpr_read_b32 v33, a109
    v_mul_f32 v33, v33, v34
    v_accvgpr_write_b32 a109, v33
    v_accvgpr_read_b32 v33, a110
    v_mul_f32 v33, v33, v34
    v_accvgpr_write_b32 a110, v33
    v_accvgpr_read_b32 v33, a111
    v_mul_f32 v33, v33, v34
    v_accvgpr_write_b32 a111, v33
    v_accvgpr_read_b32 v33, a112
    v_mul_f32 v33, v33, v34
    v_accvgpr_write_b32 a112, v33
    v_accvgpr_read_b32 v33, a113
    v_mul_f32 v33, v33, v34
    v_accvgpr_write_b32 a113, v33
    v_accvgpr_read_b32 v33, a114
    v_mul_f32 v33, v33, v34
    v_accvgpr_write_b32 a114, v33
    v_accvgpr_read_b32 v33, a115
    v_mul_f32 v33, v33, v34
    v_accvgpr_write_b32 a115, v33
    v_accvgpr_read_b32 v33, a116
    v_mul_f32 v33, v33, v34
    v_accvgpr_write_b32 a116, v33
    v_accvgpr_read_b32 v33, a117
    v_mul_f32 v33, v33, v34
    v_accvgpr_write_b32 a117, v33
    v_accvgpr_read_b32 v33, a118
    v_mul_f32 v33, v33, v34
    v_accvgpr_write_b32 a118, v33
    v_accvgpr_read_b32 v33, a119
    v_mul_f32 v33, v33, v34
    v_accvgpr_write_b32 a119, v33
    v_accvgpr_read_b32 v33, a120
    v_mul_f32 v33, v33, v34
    v_accvgpr_write_b32 a120, v33
    v_accvgpr_read_b32 v33, a121
    v_mul_f32 v33, v33, v34
    v_accvgpr_write_b32 a121, v33
    v_accvgpr_read_b32 v33, a122
    v_mul_f32 v33, v33, v34
    v_accvgpr_write_b32 a122, v33
    v_accvgpr_read_b32 v33, a123
    v_mul_f32 v33, v33, v34
    v_accvgpr_write_b32 a123, v33
    v_accvgpr_read_b32 v33, a124
    v_mul_f32 v33, v33, v34
    v_accvgpr_write_b32 a124, v33
    v_accvgpr_read_b32 v33, a125
    v_mul_f32 v33, v33, v34
    v_accvgpr_write_b32 a125, v33
    v_accvgpr_read_b32 v33, a126
    v_mul_f32 v33, v33, v34
    v_accvgpr_write_b32 a126, v33
    v_accvgpr_read_b32 v33, a127
    v_mul_f32 v33, v33, v34
    v_accvgpr_write_b32 a127, v33
    v_exp_f32 v36, v168
    v_exp_f32 v37, v169
    s_nop 0
    v_cvt_pk_bf16_f32 v220, v36, v37
    v_exp_f32 v36, v170
    v_exp_f32 v37, v171
    s_nop 0
    v_cvt_pk_bf16_f32 v221, v36, v37
    v_exp_f32 v36, v172
    v_exp_f32 v37, v173
    s_nop 0
    v_cvt_pk_bf16_f32 v222, v36, v37
    v_exp_f32 v36, v174
    v_exp_f32 v37, v175
    s_nop 0
    v_cvt_pk_bf16_f32 v223, v36, v37
    s_nop 1
    s_branch gated_mix__ssm_conv_h3__compressed_kv_cla__prompt_kernel_b2_r0_ret
gated_mix__ssm_conv_h3__compressed_kv_cla__prompt_kernel_b2_r1:
    s_nop 7
    v_max3_f32 v32, v192, v193, v194
    v_max3_f32 v32, v195, v196, v32
    v_max3_f32 v32, v197, v198, v32
    v_max_f32 v32, v199, v32
    v_mov_b32 v33, v32
    s_nop 1
    v_permlane16_swap_b32 v32, v33
    s_nop 1
    v_max_f32 v32, v32, v33
    v_mov_b32 v33, v32
    s_nop 1
    v_permlane32_swap_b32 v32, v33
    s_nop 1
    v_max_f32 v32, v32, v33
    v_add_f32 v32, 0x41c00000, v32
    v_max_f32 v32, 0, v32
    v_exp_f32 v34, -v32
    v_sub_f32 v72, v72, v32
    v_sub_f32 v73, v73, v32
    v_sub_f32 v74, v74, v32
    v_sub_f32 v75, v75, v32
    v_sub_f32 v192, v192, v32
    v_sub_f32 v193, v193, v32
    v_sub_f32 v194, v194, v32
    v_sub_f32 v195, v195, v32
    v_sub_f32 v196, v196, v32
    v_sub_f32 v197, v197, v32
    v_sub_f32 v198, v198, v32
    v_sub_f32 v199, v199, v32
    v_sub_f32 v160, v160, v32
    v_sub_f32 v161, v161, v32
    v_sub_f32 v162, v162, v32
    v_sub_f32 v163, v163, v32
    v_sub_f32 v164, v164, v32
    v_sub_f32 v165, v165, v32
    v_sub_f32 v166, v166, v32
    v_sub_f32 v167, v167, v32
    v_mul_f32 v248, v248, v34
    v_mul_f32 v249, v249, v34
    v_mul_f32 v250, v250, v34
    v_mul_f32 v251, v251, v34
    v_accvgpr_read_b32 v33, a64
    v_mul_f32 v33, v33, v34
    v_accvgpr_write_b32 a64, v33
    v_accvgpr_read_b32 v33, a65
    v_mul_f32 v33, v33, v34
    v_accvgpr_write_b32 a65, v33
    v_accvgpr_read_b32 v33, a66
    v_mul_f32 v33, v33, v34
    v_accvgpr_write_b32 a66, v33
    v_accvgpr_read_b32 v33, a67
    v_mul_f32 v33, v33, v34
    v_accvgpr_write_b32 a67, v33
    v_accvgpr_read_b32 v33, a68
    v_mul_f32 v33, v33, v34
    v_accvgpr_write_b32 a68, v33
    v_accvgpr_read_b32 v33, a69
    v_mul_f32 v33, v33, v34
    v_accvgpr_write_b32 a69, v33
    v_accvgpr_read_b32 v33, a70
    v_mul_f32 v33, v33, v34
    v_accvgpr_write_b32 a70, v33
    v_accvgpr_read_b32 v33, a71
    v_mul_f32 v33, v33, v34
    v_accvgpr_write_b32 a71, v33
    v_accvgpr_read_b32 v33, a72
    v_mul_f32 v33, v33, v34
    v_accvgpr_write_b32 a72, v33
    v_accvgpr_read_b32 v33, a73
    v_mul_f32 v33, v33, v34
    v_accvgpr_write_b32 a73, v33
    v_accvgpr_read_b32 v33, a74
    v_mul_f32 v33, v33, v34
    v_accvgpr_write_b32 a74, v33
    v_accvgpr_read_b32 v33, a75
    v_mul_f32 v33, v33, v34
    v_accvgpr_write_b32 a75, v33
    v_accvgpr_read_b32 v33, a76
    v_mul_f32 v33, v33, v34
    v_accvgpr_write_b32 a76, v33
    v_accvgpr_read_b32 v33, a77
    v_mul_f32 v33, v33, v34
    v_accvgpr_write_b32 a77, v33
    v_accvgpr_read_b32 v33, a78
    v_mul_f32 v33, v33, v34
    v_accvgpr_write_b32 a78, v33
    v_accvgpr_read_b32 v33, a79
    v_mul_f32 v33, v33, v34
    v_accvgpr_write_b32 a79, v33
    v_accvgpr_read_b32 v33, a80
    v_mul_f32 v33, v33, v34
    v_accvgpr_write_b32 a80, v33
    v_accvgpr_read_b32 v33, a81
    v_mul_f32 v33, v33, v34
    v_accvgpr_write_b32 a81, v33
    v_accvgpr_read_b32 v33, a82
    v_mul_f32 v33, v33, v34
    v_accvgpr_write_b32 a82, v33
    v_accvgpr_read_b32 v33, a83
    v_mul_f32 v33, v33, v34
    v_accvgpr_write_b32 a83, v33
    v_accvgpr_read_b32 v33, a84
    v_mul_f32 v33, v33, v34
    v_accvgpr_write_b32 a84, v33
    v_accvgpr_read_b32 v33, a85
    v_mul_f32 v33, v33, v34
    v_accvgpr_write_b32 a85, v33
    v_accvgpr_read_b32 v33, a86
    v_mul_f32 v33, v33, v34
    v_accvgpr_write_b32 a86, v33
    v_accvgpr_read_b32 v33, a87
    v_mul_f32 v33, v33, v34
    v_accvgpr_write_b32 a87, v33
    v_accvgpr_read_b32 v33, a88
    v_mul_f32 v33, v33, v34
    v_accvgpr_write_b32 a88, v33
    v_accvgpr_read_b32 v33, a89
    v_mul_f32 v33, v33, v34
    v_accvgpr_write_b32 a89, v33
    v_accvgpr_read_b32 v33, a90
    v_mul_f32 v33, v33, v34
    v_accvgpr_write_b32 a90, v33
    v_accvgpr_read_b32 v33, a91
    v_mul_f32 v33, v33, v34
    v_accvgpr_write_b32 a91, v33
    v_accvgpr_read_b32 v33, a92
    v_mul_f32 v33, v33, v34
    v_accvgpr_write_b32 a92, v33
    v_accvgpr_read_b32 v33, a93
    v_mul_f32 v33, v33, v34
    v_accvgpr_write_b32 a93, v33
    v_accvgpr_read_b32 v33, a94
    v_mul_f32 v33, v33, v34
    v_accvgpr_write_b32 a94, v33
    v_accvgpr_read_b32 v33, a95
    v_mul_f32 v33, v33, v34
    v_accvgpr_write_b32 a95, v33
    v_exp_f32 v36, v192
    v_exp_f32 v37, v193
    s_nop 0
    v_cvt_pk_bf16_f32 v232, v36, v37
    v_exp_f32 v36, v194
    v_exp_f32 v37, v195
    s_nop 0
    v_cvt_pk_bf16_f32 v233, v36, v37
    v_exp_f32 v36, v196
    v_exp_f32 v37, v197
    s_nop 0
    v_cvt_pk_bf16_f32 v234, v36, v37
    v_exp_f32 v36, v198
    v_exp_f32 v37, v199
    s_nop 0
    v_cvt_pk_bf16_f32 v235, v36, v37
    v_max3_f32 v32, v200, v201, v202
    v_max3_f32 v32, v203, v204, v32
    v_max3_f32 v32, v205, v206, v32
    v_max_f32 v32, v207, v32
    v_mov_b32 v33, v32
    s_nop 1
    v_permlane16_swap_b32 v32, v33
    s_nop 1
    v_max_f32 v32, v32, v33
    v_mov_b32 v33, v32
    s_nop 1
    v_permlane32_swap_b32 v32, v33
    s_nop 1
    v_max_f32 v32, v32, v33
    v_add_f32 v32, 0x41c00000, v32
    v_max_f32 v32, 0, v32
    v_exp_f32 v34, -v32
    v_sub_f32 v76, v76, v32
    v_sub_f32 v77, v77, v32
    v_sub_f32 v78, v78, v32
    v_sub_f32 v79, v79, v32
    v_sub_f32 v200, v200, v32
    v_sub_f32 v201, v201, v32
    v_sub_f32 v202, v202, v32
    v_sub_f32 v203, v203, v32
    v_sub_f32 v204, v204, v32
    v_sub_f32 v205, v205, v32
    v_sub_f32 v206, v206, v32
    v_sub_f32 v207, v207, v32
    v_sub_f32 v168, v168, v32
    v_sub_f32 v169, v169, v32
    v_sub_f32 v170, v170, v32
    v_sub_f32 v171, v171, v32
    v_sub_f32 v172, v172, v32
    v_sub_f32 v173, v173, v32
    v_sub_f32 v174, v174, v32
    v_sub_f32 v175, v175, v32
    v_mul_f32 v252, v252, v34
    v_mul_f32 v253, v253, v34
    v_mul_f32 v254, v254, v34
    v_mul_f32 v255, v255, v34
    v_accvgpr_read_b32 v33, a96
    v_mul_f32 v33, v33, v34
    v_accvgpr_write_b32 a96, v33
    v_accvgpr_read_b32 v33, a97
    v_mul_f32 v33, v33, v34
    v_accvgpr_write_b32 a97, v33
    v_accvgpr_read_b32 v33, a98
    v_mul_f32 v33, v33, v34
    v_accvgpr_write_b32 a98, v33
    v_accvgpr_read_b32 v33, a99
    v_mul_f32 v33, v33, v34
    v_accvgpr_write_b32 a99, v33
    v_accvgpr_read_b32 v33, a100
    v_mul_f32 v33, v33, v34
    v_accvgpr_write_b32 a100, v33
    v_accvgpr_read_b32 v33, a101
    v_mul_f32 v33, v33, v34
    v_accvgpr_write_b32 a101, v33
    v_accvgpr_read_b32 v33, a102
    v_mul_f32 v33, v33, v34
    v_accvgpr_write_b32 a102, v33
    v_accvgpr_read_b32 v33, a103
    v_mul_f32 v33, v33, v34
    v_accvgpr_write_b32 a103, v33
    v_accvgpr_read_b32 v33, a104
    v_mul_f32 v33, v33, v34
    v_accvgpr_write_b32 a104, v33
    v_accvgpr_read_b32 v33, a105
    v_mul_f32 v33, v33, v34
    v_accvgpr_write_b32 a105, v33
    v_accvgpr_read_b32 v33, a106
    v_mul_f32 v33, v33, v34
    v_accvgpr_write_b32 a106, v33
    v_accvgpr_read_b32 v33, a107
    v_mul_f32 v33, v33, v34
    v_accvgpr_write_b32 a107, v33
    v_accvgpr_read_b32 v33, a108
    v_mul_f32 v33, v33, v34
    v_accvgpr_write_b32 a108, v33
    v_accvgpr_read_b32 v33, a109
    v_mul_f32 v33, v33, v34
    v_accvgpr_write_b32 a109, v33
    v_accvgpr_read_b32 v33, a110
    v_mul_f32 v33, v33, v34
    v_accvgpr_write_b32 a110, v33
    v_accvgpr_read_b32 v33, a111
    v_mul_f32 v33, v33, v34
    v_accvgpr_write_b32 a111, v33
    v_accvgpr_read_b32 v33, a112
    v_mul_f32 v33, v33, v34
    v_accvgpr_write_b32 a112, v33
    v_accvgpr_read_b32 v33, a113
    v_mul_f32 v33, v33, v34
    v_accvgpr_write_b32 a113, v33
    v_accvgpr_read_b32 v33, a114
    v_mul_f32 v33, v33, v34
    v_accvgpr_write_b32 a114, v33
    v_accvgpr_read_b32 v33, a115
    v_mul_f32 v33, v33, v34
    v_accvgpr_write_b32 a115, v33
    v_accvgpr_read_b32 v33, a116
    v_mul_f32 v33, v33, v34
    v_accvgpr_write_b32 a116, v33
    v_accvgpr_read_b32 v33, a117
    v_mul_f32 v33, v33, v34
    v_accvgpr_write_b32 a117, v33
    v_accvgpr_read_b32 v33, a118
    v_mul_f32 v33, v33, v34
    v_accvgpr_write_b32 a118, v33
    v_accvgpr_read_b32 v33, a119
    v_mul_f32 v33, v33, v34
    v_accvgpr_write_b32 a119, v33
    v_accvgpr_read_b32 v33, a120
    v_mul_f32 v33, v33, v34
    v_accvgpr_write_b32 a120, v33
    v_accvgpr_read_b32 v33, a121
    v_mul_f32 v33, v33, v34
    v_accvgpr_write_b32 a121, v33
    v_accvgpr_read_b32 v33, a122
    v_mul_f32 v33, v33, v34
    v_accvgpr_write_b32 a122, v33
    v_accvgpr_read_b32 v33, a123
    v_mul_f32 v33, v33, v34
    v_accvgpr_write_b32 a123, v33
    v_accvgpr_read_b32 v33, a124
    v_mul_f32 v33, v33, v34
    v_accvgpr_write_b32 a124, v33
    v_accvgpr_read_b32 v33, a125
    v_mul_f32 v33, v33, v34
    v_accvgpr_write_b32 a125, v33
    v_accvgpr_read_b32 v33, a126
    v_mul_f32 v33, v33, v34
    v_accvgpr_write_b32 a126, v33
    v_accvgpr_read_b32 v33, a127
    v_mul_f32 v33, v33, v34
    v_accvgpr_write_b32 a127, v33
    v_exp_f32 v36, v200
    v_exp_f32 v37, v201
    s_nop 0
    v_cvt_pk_bf16_f32 v236, v36, v37
    v_exp_f32 v36, v202
    v_exp_f32 v37, v203
    s_nop 0
    v_cvt_pk_bf16_f32 v237, v36, v37
    v_exp_f32 v36, v204
    v_exp_f32 v37, v205
    s_nop 0
    v_cvt_pk_bf16_f32 v238, v36, v37
    v_exp_f32 v36, v206
    v_exp_f32 v37, v207
    s_nop 0
    v_cvt_pk_bf16_f32 v239, v36, v37
    s_nop 1
    s_branch gated_mix__ssm_conv_h3__compressed_kv_cla__prompt_kernel_b2_r1_ret
gated_mix__ssm_conv_h3__compressed_kv_cla__prompt_kernel_b1_r0:
    s_nop 7
    v_max3_f32 v32, v168, v169, v170
    v_max3_f32 v32, v171, v172, v32
    v_max3_f32 v32, v173, v174, v32
    v_max_f32 v32, v175, v32
    v_mov_b32 v33, v32
    s_nop 1
    v_permlane16_swap_b32 v32, v33
    s_nop 1
    v_max_f32 v32, v32, v33
    v_mov_b32 v33, v32
    s_nop 1
    v_permlane32_swap_b32 v32, v33
    s_nop 1
    v_max_f32 v32, v32, v33
    v_add_f32 v32, 0x41c00000, v32
    v_max_f32 v32, 0, v32
    v_exp_f32 v34, -v32
    v_sub_f32 v76, v76, v32
    v_sub_f32 v77, v77, v32
    v_sub_f32 v78, v78, v32
    v_sub_f32 v79, v79, v32
    v_sub_f32 v168, v168, v32
    v_sub_f32 v169, v169, v32
    v_sub_f32 v170, v170, v32
    v_sub_f32 v171, v171, v32
    v_sub_f32 v172, v172, v32
    v_sub_f32 v173, v173, v32
    v_sub_f32 v174, v174, v32
    v_sub_f32 v175, v175, v32
    v_sub_f32 v200, v200, v32
    v_sub_f32 v201, v201, v32
    v_sub_f32 v202, v202, v32
    v_sub_f32 v203, v203, v32
    v_sub_f32 v204, v204, v32
    v_sub_f32 v205, v205, v32
    v_sub_f32 v206, v206, v32
    v_sub_f32 v207, v207, v32
    v_mul_f32 v252, v252, v34
    v_mul_f32 v253, v253, v34
    v_mul_f32 v254, v254, v34
    v_mul_f32 v255, v255, v34
    v_accvgpr_read_b32 v33, a96
    v_mul_f32 v33, v33, v34
    v_accvgpr_write_b32 a96, v33
    v_accvgpr_read_b32 v33, a97
    v_mul_f32 v33, v33, v34
    v_accvgpr_write_b32 a97, v33
    v_accvgpr_read_b32 v33, a98
    v_mul_f32 v33, v33, v34
    v_accvgpr_write_b32 a98, v33
    v_accvgpr_read_b32 v33, a99
    v_mul_f32 v33, v33, v34
    v_accvgpr_write_b32 a99, v33
    v_accvgpr_read_b32 v33, a100
    v_mul_f32 v33, v33, v34
    v_accvgpr_write_b32 a100, v33
    v_accvgpr_read_b32 v33, a101
    v_mul_f32 v33, v33, v34
    v_accvgpr_write_b32 a101, v33
    v_accvgpr_read_b32 v33, a102
    v_mul_f32 v33, v33, v34
    v_accvgpr_write_b32 a102, v33
    v_accvgpr_read_b32 v33, a103
    v_mul_f32 v33, v33, v34
    v_accvgpr_write_b32 a103, v33
    v_accvgpr_read_b32 v33, a104
    v_mul_f32 v33, v33, v34
    v_accvgpr_write_b32 a104, v33
    v_accvgpr_read_b32 v33, a105
    v_mul_f32 v33, v33, v34
    v_accvgpr_write_b32 a105, v33
    v_accvgpr_read_b32 v33, a106
    v_mul_f32 v33, v33, v34
    v_accvgpr_write_b32 a106, v33
    v_accvgpr_read_b32 v33, a107
    v_mul_f32 v33, v33, v34
    v_accvgpr_write_b32 a107, v33
    v_accvgpr_read_b32 v33, a108
    v_mul_f32 v33, v33, v34
    v_accvgpr_write_b32 a108, v33
    v_accvgpr_read_b32 v33, a109
    v_mul_f32 v33, v33, v34
    v_accvgpr_write_b32 a109, v33
    v_accvgpr_read_b32 v33, a110
    v_mul_f32 v33, v33, v34
    v_accvgpr_write_b32 a110, v33
    v_accvgpr_read_b32 v33, a111
    v_mul_f32 v33, v33, v34
    v_accvgpr_write_b32 a111, v33
    v_accvgpr_read_b32 v33, a112
    v_mul_f32 v33, v33, v34
    v_accvgpr_write_b32 a112, v33
    v_accvgpr_read_b32 v33, a113
    v_mul_f32 v33, v33, v34
    v_accvgpr_write_b32 a113, v33
    v_accvgpr_read_b32 v33, a114
    v_mul_f32 v33, v33, v34
    v_accvgpr_write_b32 a114, v33
    v_accvgpr_read_b32 v33, a115
    v_mul_f32 v33, v33, v34
    v_accvgpr_write_b32 a115, v33
    v_accvgpr_read_b32 v33, a116
    v_mul_f32 v33, v33, v34
    v_accvgpr_write_b32 a116, v33
    v_accvgpr_read_b32 v33, a117
    v_mul_f32 v33, v33, v34
    v_accvgpr_write_b32 a117, v33
    v_accvgpr_read_b32 v33, a118
    v_mul_f32 v33, v33, v34
    v_accvgpr_write_b32 a118, v33
    v_accvgpr_read_b32 v33, a119
    v_mul_f32 v33, v33, v34
    v_accvgpr_write_b32 a119, v33
    v_accvgpr_read_b32 v33, a120
    v_mul_f32 v33, v33, v34
    v_accvgpr_write_b32 a120, v33
    v_accvgpr_read_b32 v33, a121
    v_mul_f32 v33, v33, v34
    v_accvgpr_write_b32 a121, v33
    v_accvgpr_read_b32 v33, a122
    v_mul_f32 v33, v33, v34
    v_accvgpr_write_b32 a122, v33
    v_accvgpr_read_b32 v33, a123
    v_mul_f32 v33, v33, v34
    v_accvgpr_write_b32 a123, v33
    v_accvgpr_read_b32 v33, a124
    v_mul_f32 v33, v33, v34
    v_accvgpr_write_b32 a124, v33
    v_accvgpr_read_b32 v33, a125
    v_mul_f32 v33, v33, v34
    v_accvgpr_write_b32 a125, v33
    v_accvgpr_read_b32 v33, a126
    v_mul_f32 v33, v33, v34
    v_accvgpr_write_b32 a126, v33
    v_accvgpr_read_b32 v33, a127
    v_mul_f32 v33, v33, v34
    v_accvgpr_write_b32 a127, v33
    v_exp_f32 v36, v168
    v_exp_f32 v37, v169
    s_nop 0
    v_cvt_pk_bf16_f32 v220, v36, v37
    v_exp_f32 v36, v170
    v_exp_f32 v37, v171
    s_nop 0
    v_cvt_pk_bf16_f32 v221, v36, v37
    v_exp_f32 v36, v172
    v_exp_f32 v37, v173
    s_nop 0
    v_cvt_pk_bf16_f32 v222, v36, v37
    v_exp_f32 v36, v174
    v_exp_f32 v37, v175
    s_nop 0
    v_cvt_pk_bf16_f32 v223, v36, v37
    s_nop 1
    s_branch gated_mix__ssm_conv_h3__compressed_kv_cla__prompt_kernel_b1_r0_ret
gated_mix__ssm_conv_h3__compressed_kv_cla__prompt_kernel_b1_r1:
    s_nop 7
    v_max3_f32 v32, v200, v201, v202
    v_max3_f32 v32, v203, v204, v32
    v_max3_f32 v32, v205, v206, v32
    v_max_f32 v32, v207, v32
    v_mov_b32 v33, v32
    s_nop 1
    v_permlane16_swap_b32 v32, v33
    s_nop 1
    v_max_f32 v32, v32, v33
    v_mov_b32 v33, v32
    s_nop 1
    v_permlane32_swap_b32 v32, v33
    s_nop 1
    v_max_f32 v32, v32, v33
    v_add_f32 v32, 0x41c00000, v32
    v_max_f32 v32, 0, v32
    v_exp_f32 v34, -v32
    v_sub_f32 v76, v76, v32
    v_sub_f32 v77, v77, v32
    v_sub_f32 v78, v78, v32
    v_sub_f32 v79, v79, v32
    v_sub_f32 v200, v200, v32
    v_sub_f32 v201, v201, v32
    v_sub_f32 v202, v202, v32
    v_sub_f32 v203, v203, v32
    v_sub_f32 v204, v204, v32
    v_sub_f32 v205, v205, v32
    v_sub_f32 v206, v206, v32
    v_sub_f32 v207, v207, v32
    v_mul_f32 v252, v252, v34
    v_mul_f32 v253, v253, v34
    v_mul_f32 v254, v254, v34
    v_mul_f32 v255, v255, v34
    v_accvgpr_read_b32 v33, a96
    v_mul_f32 v33, v33, v34
    v_accvgpr_write_b32 a96, v33
    v_accvgpr_read_b32 v33, a97
    v_mul_f32 v33, v33, v34
    v_accvgpr_write_b32 a97, v33
    v_accvgpr_read_b32 v33, a98
    v_mul_f32 v33, v33, v34
    v_accvgpr_write_b32 a98, v33
    v_accvgpr_read_b32 v33, a99
    v_mul_f32 v33, v33, v34
    v_accvgpr_write_b32 a99, v33
    v_accvgpr_read_b32 v33, a100
    v_mul_f32 v33, v33, v34
    v_accvgpr_write_b32 a100, v33
    v_accvgpr_read_b32 v33, a101
    v_mul_f32 v33, v33, v34
    v_accvgpr_write_b32 a101, v33
    v_accvgpr_read_b32 v33, a102
    v_mul_f32 v33, v33, v34
    v_accvgpr_write_b32 a102, v33
    v_accvgpr_read_b32 v33, a103
    v_mul_f32 v33, v33, v34
    v_accvgpr_write_b32 a103, v33
    v_accvgpr_read_b32 v33, a104
    v_mul_f32 v33, v33, v34
    v_accvgpr_write_b32 a104, v33
    v_accvgpr_read_b32 v33, a105
    v_mul_f32 v33, v33, v34
    v_accvgpr_write_b32 a105, v33
    v_accvgpr_read_b32 v33, a106
    v_mul_f32 v33, v33, v34
    v_accvgpr_write_b32 a106, v33
    v_accvgpr_read_b32 v33, a107
    v_mul_f32 v33, v33, v34
    v_accvgpr_write_b32 a107, v33
    v_accvgpr_read_b32 v33, a108
    v_mul_f32 v33, v33, v34
    v_accvgpr_write_b32 a108, v33
    v_accvgpr_read_b32 v33, a109
    v_mul_f32 v33, v33, v34
    v_accvgpr_write_b32 a109, v33
    v_accvgpr_read_b32 v33, a110
    v_mul_f32 v33, v33, v34
    v_accvgpr_write_b32 a110, v33
    v_accvgpr_read_b32 v33, a111
    v_mul_f32 v33, v33, v34
    v_accvgpr_write_b32 a111, v33
    v_accvgpr_read_b32 v33, a112
    v_mul_f32 v33, v33, v34
    v_accvgpr_write_b32 a112, v33
    v_accvgpr_read_b32 v33, a113
    v_mul_f32 v33, v33, v34
    v_accvgpr_write_b32 a113, v33
    v_accvgpr_read_b32 v33, a114
    v_mul_f32 v33, v33, v34
    v_accvgpr_write_b32 a114, v33
    v_accvgpr_read_b32 v33, a115
    v_mul_f32 v33, v33, v34
    v_accvgpr_write_b32 a115, v33
    v_accvgpr_read_b32 v33, a116
    v_mul_f32 v33, v33, v34
    v_accvgpr_write_b32 a116, v33
    v_accvgpr_read_b32 v33, a117
    v_mul_f32 v33, v33, v34
    v_accvgpr_write_b32 a117, v33
    v_accvgpr_read_b32 v33, a118
    v_mul_f32 v33, v33, v34
    v_accvgpr_write_b32 a118, v33
    v_accvgpr_read_b32 v33, a119
    v_mul_f32 v33, v33, v34
    v_accvgpr_write_b32 a119, v33
    v_accvgpr_read_b32 v33, a120
    v_mul_f32 v33, v33, v34
    v_accvgpr_write_b32 a120, v33
    v_accvgpr_read_b32 v33, a121
    v_mul_f32 v33, v33, v34
    v_accvgpr_write_b32 a121, v33
    v_accvgpr_read_b32 v33, a122
    v_mul_f32 v33, v33, v34
    v_accvgpr_write_b32 a122, v33
    v_accvgpr_read_b32 v33, a123
    v_mul_f32 v33, v33, v34
    v_accvgpr_write_b32 a123, v33
    v_accvgpr_read_b32 v33, a124
    v_mul_f32 v33, v33, v34
    v_accvgpr_write_b32 a124, v33
    v_accvgpr_read_b32 v33, a125
    v_mul_f32 v33, v33, v34
    v_accvgpr_write_b32 a125, v33
    v_accvgpr_read_b32 v33, a126
    v_mul_f32 v33, v33, v34
    v_accvgpr_write_b32 a126, v33
    v_accvgpr_read_b32 v33, a127
    v_mul_f32 v33, v33, v34
    v_accvgpr_write_b32 a127, v33
    v_exp_f32 v36, v200
    v_exp_f32 v37, v201
    s_nop 0
    v_cvt_pk_bf16_f32 v236, v36, v37
    v_exp_f32 v36, v202
    v_exp_f32 v37, v203
    s_nop 0
    v_cvt_pk_bf16_f32 v237, v36, v37
    v_exp_f32 v36, v204
    v_exp_f32 v37, v205
    s_nop 0
    v_cvt_pk_bf16_f32 v238, v36, v37
    v_exp_f32 v36, v206
    v_exp_f32 v37, v207
    s_nop 0
    v_cvt_pk_bf16_f32 v239, v36, v37
    s_nop 1
    s_branch gated_mix__ssm_conv_h3__compressed_kv_cla__prompt_kernel_b1_r1_ret

.section .rodata,"a"
.p2align 6
.amdhsa_kernel gated_mix__ssm_conv_h3__compressed_kv_cla__prompt_kernel
  .amdhsa_next_free_vgpr 512
  .amdhsa_next_free_sgpr 102
  .amdhsa_accum_offset 256
  .amdhsa_group_segment_fixed_size 0
  .amdhsa_kernarg_size 128
  .amdhsa_user_sgpr_count 2
  .amdhsa_user_sgpr_kernarg_segment_ptr 1
  .amdhsa_system_sgpr_workgroup_id_x 1
  .amdhsa_float_denorm_mode_32 3
.end_amdhsa_kernel
```

```asm
; @launch grid=(256,1,1) block=(256,1,1) lds=163840
.amdgcn_target "amdgcn-amd-amdhsa--gfx950"
.text
.globl gated_mix__ssm_conv_h3__compressed_kv_cla__prompt_kernel
.p2align 8
.type gated_mix__ssm_conv_h3__compressed_kv_cla__prompt_kernel,@function
gated_mix__ssm_conv_h3__compressed_kv_cla__prompt_kernel:
 s_cmp_ge_u32 s2, 256
 s_cbranch_scc1 L_end
 s_load_dwordx16 s[64:79], s[0:1], 0
 s_load_dwordx16 s[80:95], s[0:1], 64
 s_getpc_b64 s[4:5]
L_pc:
 s_lshr_b32 s6, s2, 3
 s_mul_i32 s6, s6, 24
 v_min_u32 v242, 23, v0
 v_add_u32 v242, s6, v242
 v_lshlrev_b32 v242, 7, v242
 v_min_u32 v242, L_hotend-L_pc, v242
 global_load_dword v255, v242, s[4:5]
 v_lshrrev_b32 v242, 6, v0
 v_and_b32 v240, 63, v0
 v_readfirstlane_b32 s32, v242
 v_lshlrev_b32 v16, 4, v240
 s_and_b32 s36, s2, 7
 s_lshl_b32 s36, s36, 2
 s_bfe_u32 s33, s2, 0x20003
 s_add_u32 s33, s33, s36
 s_lshr_b32 s34, s2, 5
 v_lshrrev_b32 v242, 3, v240
 v_and_b32 v247, 7, v240
 v_lshrrev_b32 v245, 4, v240
 v_xor_b32 v243, v245, v247
 v_lshlrev_b32 v243, 4, v243
 v_xor_b32 v244, 64, v243
 v_lshl_add_u32 v2, v242, 10, v243
 v_lshl_add_u32 v3, v242, 10, v244
 v_add_u32 v3, 7168, v3
 v_add_u32 v4, 14336, v2
 v_add_u32 v5, 14336, v3
 v_and_b32 v246, 15, v240
 v_lshlrev_b32 v247, 1, v245
 v_xor_b32 v247, v247, v246
 v_lshlrev_b32 v247, 4, v247
 v_lshl_add_u32 v21, v245, 13, v247
 s_and_b32 s36, s32, 1
 s_lshl_b32 s36, s36, 7
 v_xor_b32 v6, s36, v21
 v_add_u32 v7, 31744, v6
 s_lshl_b32 s38, s34, 18
 s_lshl_b32 s36, s32, 16
 s_add_u32 s38, s38, s36
 s_lshl_b32 s39, s33, 8
 s_add_u32 s39, s39, s36
 s_lshl_b32 s42, s32, 13
 s_lshl_b32 s43, s32, 12
 s_add_u32 s43, s43, 98304
 s_waitcnt lgkmcnt(0)
 s_mov_b32 s4, s78
 s_mov_b32 s5, s79
 s_mov_b32 s6, 2097152
 s_mov_b32 s7, 0x00020000
 s_mov_b32 s8, s82
 s_mov_b32 s9, s83
 s_mov_b32 s10, 4194304
 s_mov_b32 s11, 0x00020000
 s_mov_b32 s12, s84
 s_mov_b32 s13, s85
 s_mov_b32 s14, 4194304
 s_mov_b32 s15, 0x00020000
 s_add_u32 s35, s2, s34
 s_and_b32 s35, s35, 7
 s_lshl_b32 s58, s35, 19
 s_lshl_b32 s35, s35, 7
 s_add_u32 s59, s38, 32768
 s_add_u32 s36, s35, 0
 s_and_b32 s36, s36, 1023
 s_add_u32 s36, s36, s38
 s_add_u32 m0, s42, 0
 s_nop 0
 buffer_load_dwordx4 v2, s[4:7], s36 offen offset:0 lds
 buffer_load_dwordx4 v3, s[4:7], s36 offen offset:1024 lds
 buffer_load_dwordx4 v4, s[4:7], s36 offen offset:2048 lds
 buffer_load_dwordx4 v5, s[4:7], s36 offen offset:3072 lds
 s_add_u32 s36, s35, 0
 s_and_b32 s36, s36, 1023
 s_add_u32 s36, s36, s59
 s_add_u32 m0, s42, 4096
 s_nop 0
 buffer_load_dwordx4 v2, s[4:7], s36 offen offset:0 lds
 buffer_load_dwordx4 v3, s[4:7], s36 offen offset:1024 lds
 buffer_load_dwordx4 v4, s[4:7], s36 offen offset:2048 lds
 buffer_load_dwordx4 v5, s[4:7], s36 offen offset:3072 lds
 s_add_u32 s37, s58, 0
 s_and_b32 s37, s37, 4194303
 s_add_u32 s37, s37, s39
 s_add_u32 m0, s43, 0
 s_nop 0
 buffer_load_dwordx4 v6, s[8:11], s37 offen offset:0 lds
 buffer_load_dwordx4 v7, s[8:11], s37 offen offset:1024 lds
 s_add_u32 m0, s43, 2048
 s_nop 0
 buffer_load_dwordx4 v6, s[12:15], s37 offen offset:0 lds
 buffer_load_dwordx4 v7, s[12:15], s37 offen offset:1024 lds
 s_add_u32 s37, s58, 262144
 s_and_b32 s37, s37, 4194303
 s_add_u32 s37, s37, s39
 s_add_u32 m0, s43, 16384
 s_nop 0
 buffer_load_dwordx4 v6, s[8:11], s37 offen offset:0 lds
 buffer_load_dwordx4 v7, s[8:11], s37 offen offset:1024 lds
 s_add_u32 m0, s43, 18432
 s_nop 0
 buffer_load_dwordx4 v6, s[12:15], s37 offen offset:0 lds
 buffer_load_dwordx4 v7, s[12:15], s37 offen offset:1024 lds
 s_add_u32 s36, s35, 128
 s_and_b32 s36, s36, 1023
 s_add_u32 s36, s36, s38
 s_add_u32 m0, s42, 32768
 s_nop 0
 buffer_load_dwordx4 v2, s[4:7], s36 offen offset:0 lds
 buffer_load_dwordx4 v3, s[4:7], s36 offen offset:1024 lds
 buffer_load_dwordx4 v4, s[4:7], s36 offen offset:2048 lds
 buffer_load_dwordx4 v5, s[4:7], s36 offen offset:3072 lds
 v_lshrrev_b32 v247, 1, v246
 v_xor_b32 v247, v245, v247
 v_lshlrev_b32 v247, 4, v247
 v_lshl_add_u32 v247, v246, 7, v247
 s_lshr_b32 s36, s32, 1
 s_lshl_b32 s36, s36, 14
 v_add_u32 v8, s36, v247
 v_xor_b32 v9, 64, v8
 v_add_u32 v14, 65536, v8
 v_add_u32 v15, 65536, v9
 v_add_u32 v23, s42, v247
 v_xor_b32 v24, 64, v23
 v_add_u32 v25, 65536, v23
 v_add_u32 v26, 65536, v24
 v_lshrrev_b32 v247, 2, v246
 v_and_b32 v248, 3, v246
 v_lshlrev_b32 v248, 3, v248
 v_lshl_add_u32 v248, v247, 8, v248
 v_add_u32 v248, 98304, v248
 v_lshl_add_u32 v249, v245, 12, v248
 v_mul_u32_u24 v250, 2176, v245
 v_add_u32 v250, v250, v248
 v_xor_b32 v248, s32, v245
 v_and_b32 v248, 1, v248
 v_lshl_add_u32 v249, v248, 7, v249
 v_xor_b32 v248, 0, v247
 v_lshl_add_u32 v10, v248, 5, v249
 v_lshl_add_u32 v27, v248, 5, v250
 v_xor_b32 v248, 1, v247
 v_lshl_add_u32 v11, v248, 5, v249
 v_lshl_add_u32 v28, v248, 5, v250
 v_xor_b32 v248, 2, v247
 v_lshl_add_u32 v12, v248, 5, v249
 v_lshl_add_u32 v29, v248, 5, v250
 v_xor_b32 v248, 3, v247
 v_lshl_add_u32 v13, v248, 5, v249
 v_lshl_add_u32 v30, v248, 5, v250
 v_lshl_add_u32 v17, v242, 13, v243
 v_lshl_add_u32 v18, v242, 13, v244
 v_add_u32 v18, 64512, v18
 v_add_u32 v19, 129024, v17
 v_add_u32 v20, 129024, v18
 v_add_u32 v22, 31744, v21
 s_lshl_b32 s54, s2, 2
 s_add_u32 s54, s54, s32
 v_lshlrev_b32 v254, 7, v240
 s_lshl_b32 s46, s54, 13
 s_sub_u32 s46, s46, 4194304
 s_cselect_b32 s46, 0x80000000, s46
 s_mov_b32 s20, s80
 s_mov_b32 s21, s81
 s_mov_b32 s22, 8388608
 s_mov_b32 s23, 0x00020000
 s_mov_b32 s24, s64
 s_mov_b32 s25, s65
 s_mov_b32 s26, 4194304
 s_mov_b32 s27, 0x00020000
 s_add_u32 s28, s94, 60817408
 s_addc_u32 s29, s95, 0
 s_mov_b32 s30, 524288
 s_mov_b32 s31, 0x00020000
 s_mov_b32 s49, s39
 s_mul_i32 s50, s32, 2176
 s_add_u32 s50, s50, 98304
 s_lshl_b32 s44, s34, 7
 s_add_u32 s44, s44, s32
 s_lshl_b32 s44, s44, 11
 s_lshl_b32 s37, s34, 1
 s_sub_u32 s45, 15, s37
 s_lshl_b32 s45, s45, 18
 s_add_u32 s45, s45, s44
 s_lshl_b32 s57, s54, 2
 s_add_u32 s57, s57, 262144
 s_lshl_b32 s36, s32, 5
 s_add_u32 s36, s36, s33
 s_lshl_b32 s36, s36, 2
 s_lshl_b32 s37, s34, 9
 s_add_u32 s55, s36, s37
 s_sub_u32 s56, 7680, s37
 s_add_u32 s56, s56, s36
 s_lshl_b32 s36, s34, 3
 s_add_u32 s36, s36, 0
 s_add_u32 s36, s36, s32
 s_lshl_b32 s36, s36, 5
 s_add_u32 s36, s36, s33
 s_lshl_b32 s60, s36, 12
 s_lshl_b32 s36, s34, 3
 s_add_u32 s36, s36, 4
 s_add_u32 s36, s36, s32
 s_lshl_b32 s36, s36, 5
 s_add_u32 s36, s36, s33
 s_lshl_b32 s61, s36, 12
 s_lshl_b32 s36, s34, 3
 s_sub_u32 s36, 120, s36
 s_add_u32 s36, s36, s32
 s_lshl_b32 s36, s36, 5
 s_add_u32 s36, s36, s33
 s_lshl_b32 s62, s36, 12
 s_lshl_b32 s36, s34, 3
 s_sub_u32 s36, 124, s36
 s_add_u32 s36, s36, s32
 s_lshl_b32 s36, s36, 5
 s_add_u32 s36, s36, s33
 s_lshl_b32 s63, s36, 12
 s_lshr_b32 s36, s2, 4
 s_lshl_b32 s36, s36, 4
 s_lshl_b32 s37, s32, 2
 s_add_u32 s36, s36, s37
 s_and_b32 s37, s2, 15
 s_lshl_b32 s37, s37, 6
 v_add_u32 v247, s36, v245
 v_lshl_add_u32 v248, v246, 2, s37
 v_lshlrev_b32 v0, 14, v247
 v_lshl_add_u32 v0, v248, 1, v0
 v_subrev_u32 v1, 6144, v0
 v_lshlrev_b32 v232, 3, v248
 v_lshlrev_b32 v233, 4, v240
 v_mul_u32_u24 v234, 4608, v248
 v_lshlrev_b32 v247, 4, v247
 v_sub_u32 v247, 4080, v247
 v_add_u32 v234, v234, v247
 v_add_u32 v235, s37, v240
 v_mul_u32_u24 v235, 4608, v235
 s_movk_i32 s47, 4096
 s_movk_i32 s48, 8192
 s_movk_i32 s51, 12288
 s_mov_b32 s52, 0xffff0000
 s_lshr_b32 s37, s2, 4
 s_or_b32 s37, s37, s32
 s_cmp_eq_u32 s37, 0
 s_cselect_b32 s53, s47, 0x80000000
 s_lshl_b32 s36, s33, 13
 s_add_u32 s40, s44, s36
 s_add_u32 s41, s45, s36
 s_branch L_body
.p2align 12
L_body:
 s_waitcnt vmcnt(8)
 s_barrier
 ds_read_b64_tr_b16 v[64:65], v10 offset:0
 ds_read_b64_tr_b16 v[66:67], v10 offset:1024
 ds_read_b64_tr_b16 v[68:69], v11 offset:0
 ds_read_b64_tr_b16 v[70:71], v11 offset:1024
 ds_read_b128 v[32:35], v8 offset:0
 ds_read_b64_tr_b16 v[72:73], v12 offset:0
 ds_read_b64_tr_b16 v[74:75], v12 offset:1024
 ds_read_b128 v[36:39], v8 offset:2048
 ds_read_b64_tr_b16 v[76:77], v13 offset:0
 ds_read_b64_tr_b16 v[78:79], v13 offset:1024
 ds_read_b128 v[40:43], v8 offset:4096
 ds_read_b64_tr_b16 v[80:81], v10 offset:2048
 ds_read_b64_tr_b16 v[82:83], v10 offset:3072
 ds_read_b128 v[44:47], v8 offset:6144
 ds_read_b64_tr_b16 v[84:85], v11 offset:2048
 ds_read_b64_tr_b16 v[86:87], v11 offset:3072
 ds_read_b128 v[48:51], v8 offset:8192
 ds_read_b64_tr_b16 v[88:89], v12 offset:2048
 ds_read_b64_tr_b16 v[90:91], v12 offset:3072
 ds_read_b128 v[52:55], v8 offset:10240
 ds_read_b64_tr_b16 v[92:93], v13 offset:2048
 ds_read_b64_tr_b16 v[94:95], v13 offset:3072
 ds_read_b128 v[56:59], v8 offset:12288
 ds_read_b128 v[60:63], v8 offset:14336
 s_waitcnt lgkmcnt(0)
 v_mfma_f32_16x16x32_bf16 a[0:3], v[64:67], v[32:35], 0
 ds_read_b128 v[96:99], v9 offset:0
 v_mfma_f32_16x16x32_bf16 a[4:7], v[64:67], v[36:39], 0
 s_add_u32 s36, s35, 128
 s_and_b32 s36, s36, 1023
 s_add_u32 s36, s36, s59
 v_mfma_f32_16x16x32_bf16 a[8:11], v[64:67], v[40:43], 0
 s_add_u32 m0, s42, 36864
 ds_read_b128 v[100:103], v9 offset:2048
 v_mfma_f32_16x16x32_bf16 a[12:15], v[64:67], v[44:47], 0
 buffer_load_dwordx4 v2, s[4:7], s36 offen offset:0 lds
 v_mfma_f32_16x16x32_bf16 a[16:19], v[64:67], v[48:51], 0
 ds_read_b128 v[104:107], v9 offset:4096
 v_mfma_f32_16x16x32_bf16 a[20:23], v[64:67], v[52:55], 0
 v_mfma_f32_16x16x32_bf16 a[24:27], v[64:67], v[56:59], 0
 ds_read_b128 v[108:111], v9 offset:6144
 v_mfma_f32_16x16x32_bf16 a[28:31], v[64:67], v[60:63], 0
 buffer_load_dwordx4 v3, s[4:7], s36 offen offset:1024 lds
 v_mfma_f32_16x16x32_bf16 a[32:35], v[68:71], v[32:35], 0
 ds_read_b128 v[112:115], v9 offset:8192
 v_mfma_f32_16x16x32_bf16 a[36:39], v[68:71], v[36:39], 0
 v_mfma_f32_16x16x32_bf16 a[40:43], v[68:71], v[40:43], 0
 ds_read_b128 v[116:119], v9 offset:10240
 v_mfma_f32_16x16x32_bf16 a[44:47], v[68:71], v[44:47], 0
 buffer_load_dwordx4 v4, s[4:7], s36 offen offset:2048 lds
 v_mfma_f32_16x16x32_bf16 a[48:51], v[68:71], v[48:51], 0
 ds_read_b128 v[120:123], v9 offset:12288
 v_mfma_f32_16x16x32_bf16 a[52:55], v[68:71], v[52:55], 0
 v_mfma_f32_16x16x32_bf16 a[56:59], v[68:71], v[56:59], 0
 ds_read_b128 v[124:127], v9 offset:14336
 v_mfma_f32_16x16x32_bf16 a[60:63], v[68:71], v[60:63], 0
 buffer_load_dwordx4 v5, s[4:7], s36 offen offset:3072 lds
 v_mfma_f32_16x16x32_bf16 a[64:67], v[72:75], v[32:35], 0
 v_mfma_f32_16x16x32_bf16 a[68:71], v[72:75], v[36:39], 0
 s_add_u32 s37, s58, 524288
 s_and_b32 s37, s37, 4194303
 s_add_u32 s37, s37, s39
 v_mfma_f32_16x16x32_bf16 a[72:75], v[72:75], v[40:43], 0
 s_add_u32 m0, s43, 32768
 v_mfma_f32_16x16x32_bf16 a[76:79], v[72:75], v[44:47], 0
 buffer_load_dwordx4 v6, s[8:11], s37 offen offset:0 lds
 v_mfma_f32_16x16x32_bf16 a[80:83], v[72:75], v[48:51], 0
 v_mfma_f32_16x16x32_bf16 a[84:87], v[72:75], v[52:55], 0
 v_mfma_f32_16x16x32_bf16 a[88:91], v[72:75], v[56:59], 0
 v_mfma_f32_16x16x32_bf16 a[92:95], v[72:75], v[60:63], 0
 buffer_load_dwordx4 v7, s[8:11], s37 offen offset:1024 lds
 v_mfma_f32_16x16x32_bf16 a[96:99], v[76:79], v[32:35], 0
 v_mfma_f32_16x16x32_bf16 a[100:103], v[76:79], v[36:39], 0
 v_mfma_f32_16x16x32_bf16 a[104:107], v[76:79], v[40:43], 0
 s_add_u32 m0, s43, 34816
 v_mfma_f32_16x16x32_bf16 a[108:111], v[76:79], v[44:47], 0
 buffer_load_dwordx4 v6, s[12:15], s37 offen offset:0 lds
 v_mfma_f32_16x16x32_bf16 a[112:115], v[76:79], v[48:51], 0
 v_mfma_f32_16x16x32_bf16 a[116:119], v[76:79], v[52:55], 0
 v_mfma_f32_16x16x32_bf16 a[120:123], v[76:79], v[56:59], 0
 v_mfma_f32_16x16x32_bf16 a[124:127], v[76:79], v[60:63], 0
 buffer_load_dwordx4 v7, s[12:15], s37 offen offset:1024 lds
 v_mfma_f32_16x16x32_bf16 a[128:131], v[32:35], v[80:83], 0
 v_mfma_f32_16x16x32_bf16 a[132:135], v[36:39], v[80:83], 0
 s_add_u32 s37, s58, 786432
 s_and_b32 s37, s37, 4194303
 s_add_u32 s37, s37, s39
 v_mfma_f32_16x16x32_bf16 a[136:139], v[40:43], v[80:83], 0
 s_add_u32 m0, s43, 49152
 v_mfma_f32_16x16x32_bf16 a[140:143], v[44:47], v[80:83], 0
 buffer_load_dwordx4 v6, s[8:11], s37 offen offset:0 lds
 v_mfma_f32_16x16x32_bf16 a[144:147], v[48:51], v[80:83], 0
 s_waitcnt vmcnt(13)
 s_barrier
 v_mfma_f32_16x16x32_bf16 a[148:151], v[52:55], v[80:83], 0
 v_mfma_f32_16x16x32_bf16 a[152:155], v[56:59], v[80:83], 0
 ds_read_b64_tr_b16 v[128:129], v10 offset:16384
 ds_read_b64_tr_b16 v[130:131], v10 offset:17408
 v_mfma_f32_16x16x32_bf16 a[156:159], v[60:63], v[80:83], 0
 buffer_load_dwordx4 v7, s[8:11], s37 offen offset:1024 lds
 v_mfma_f32_16x16x32_bf16 a[160:163], v[32:35], v[84:87], 0
 ds_read_b64_tr_b16 v[132:133], v11 offset:16384
 ds_read_b64_tr_b16 v[134:135], v11 offset:17408
 v_mfma_f32_16x16x32_bf16 a[164:167], v[36:39], v[84:87], 0
 v_mfma_f32_16x16x32_bf16 a[168:171], v[40:43], v[84:87], 0
 s_add_u32 m0, s43, 51200
 ds_read_b64_tr_b16 v[136:137], v12 offset:16384
 ds_read_b64_tr_b16 v[138:139], v12 offset:17408
 v_mfma_f32_16x16x32_bf16 a[172:175], v[44:47], v[84:87], 0
 buffer_load_dwordx4 v6, s[12:15], s37 offen offset:0 lds
 v_mfma_f32_16x16x32_bf16 a[176:179], v[48:51], v[84:87], 0
 ds_read_b64_tr_b16 v[140:141], v13 offset:16384
 ds_read_b64_tr_b16 v[142:143], v13 offset:17408
 v_mfma_f32_16x16x32_bf16 a[180:183], v[52:55], v[84:87], 0
 v_mfma_f32_16x16x32_bf16 a[184:187], v[56:59], v[84:87], 0
 ds_read_b64_tr_b16 v[144:145], v10 offset:18432
 ds_read_b64_tr_b16 v[146:147], v10 offset:19456
 v_mfma_f32_16x16x32_bf16 a[188:191], v[60:63], v[84:87], 0
 buffer_load_dwordx4 v7, s[12:15], s37 offen offset:1024 lds
 v_mfma_f32_16x16x32_bf16 a[192:195], v[32:35], v[88:91], 0
 ds_read_b64_tr_b16 v[148:149], v11 offset:18432
 ds_read_b64_tr_b16 v[150:151], v11 offset:19456
 v_mfma_f32_16x16x32_bf16 a[196:199], v[36:39], v[88:91], 0
 v_mfma_f32_16x16x32_bf16 a[200:203], v[40:43], v[88:91], 0
 ds_read_b64_tr_b16 v[152:153], v12 offset:18432
 ds_read_b64_tr_b16 v[154:155], v12 offset:19456
 v_mfma_f32_16x16x32_bf16 a[204:207], v[44:47], v[88:91], 0
 v_mfma_f32_16x16x32_bf16 a[208:211], v[48:51], v[88:91], 0
 ds_read_b64_tr_b16 v[156:157], v13 offset:18432
 ds_read_b64_tr_b16 v[158:159], v13 offset:19456
 v_mfma_f32_16x16x32_bf16 a[212:215], v[52:55], v[88:91], 0
 v_mfma_f32_16x16x32_bf16 a[216:219], v[56:59], v[88:91], 0
 v_mfma_f32_16x16x32_bf16 a[220:223], v[60:63], v[88:91], 0
 v_mfma_f32_16x16x32_bf16 a[224:227], v[32:35], v[92:95], 0
 v_mfma_f32_16x16x32_bf16 a[228:231], v[36:39], v[92:95], 0
 v_mfma_f32_16x16x32_bf16 a[232:235], v[40:43], v[92:95], 0
 v_mfma_f32_16x16x32_bf16 a[236:239], v[44:47], v[92:95], 0
 v_mfma_f32_16x16x32_bf16 a[240:243], v[48:51], v[92:95], 0
 v_mfma_f32_16x16x32_bf16 a[244:247], v[52:55], v[92:95], 0
 v_mfma_f32_16x16x32_bf16 a[248:251], v[56:59], v[92:95], 0
 s_bfe_u32 s54, s2, 0x10005
 s_lshl_b32 s54, s54, 2
 s_add_u32 s54, s54, s32
 s_mov_b64 exec, 0
 s_cmp_eq_u32 s54, 0
 s_cbranch_scc1 L_pad0
 s_cmp_eq_u32 s54, 1
 s_cbranch_scc1 L_pad1
 s_cmp_eq_u32 s54, 2
 s_cbranch_scc1 L_pad2
 s_cmp_eq_u32 s54, 3
 s_cbranch_scc1 L_pad3
 s_cmp_eq_u32 s54, 4
 s_cbranch_scc1 L_pad4
 s_cmp_eq_u32 s54, 5
 s_cbranch_scc1 L_pad5
 s_cmp_eq_u32 s54, 6
 s_cbranch_scc1 L_pad6
 s_cbranch_execz L_pad7
L_back:
 s_mov_b64 exec, -1
 v_mfma_f32_16x16x32_bf16 a[252:255], v[60:63], v[92:95], 0
 s_waitcnt vmcnt(4) lgkmcnt(0)
 s_barrier
 v_mfma_f32_16x16x32_bf16 a[0:3], v[128:131], v[96:99], a[0:3]
 ds_read_b64_tr_b16 v[64:65], v10 offset:32768
 v_mfma_f32_16x16x32_bf16 a[4:7], v[128:131], v[100:103], a[4:7]
 s_add_u32 s36, s35, 256
 s_and_b32 s36, s36, 1023
 s_add_u32 s36, s36, s38
 v_mfma_f32_16x16x32_bf16 a[8:11], v[128:131], v[104:107], a[8:11]
 s_add_u32 m0, s42, 65536
 ds_read_b64_tr_b16 v[66:67], v10 offset:33792
 v_mfma_f32_16x16x32_bf16 a[12:15], v[128:131], v[108:111], a[12:15]
 buffer_load_dwordx4 v2, s[4:7], s36 offen offset:0 lds
 v_mfma_f32_16x16x32_bf16 a[16:19], v[128:131], v[112:115], a[16:19]
 ds_read_b64_tr_b16 v[68:69], v11 offset:32768
 v_mfma_f32_16x16x32_bf16 a[20:23], v[128:131], v[116:119], a[20:23]
 v_mfma_f32_16x16x32_bf16 a[24:27], v[128:131], v[120:123], a[24:27]
 ds_read_b64_tr_b16 v[70:71], v11 offset:33792
 v_mfma_f32_16x16x32_bf16 a[28:31], v[128:131], v[124:127], a[28:31]
 buffer_load_dwordx4 v3, s[4:7], s36 offen offset:1024 lds
 v_mfma_f32_16x16x32_bf16 a[32:35], v[132:135], v[96:99], a[32:35]
 ds_read_b128 v[32:35], v8 offset:32768
 v_mfma_f32_16x16x32_bf16 a[36:39], v[132:135], v[100:103], a[36:39]
 v_mfma_f32_16x16x32_bf16 a[40:43], v[132:135], v[104:107], a[40:43]
 ds_read_b64_tr_b16 v[72:73], v12 offset:32768
 v_mfma_f32_16x16x32_bf16 a[44:47], v[132:135], v[108:111], a[44:47]
 buffer_load_dwordx4 v4, s[4:7], s36 offen offset:2048 lds
 v_mfma_f32_16x16x32_bf16 a[48:51], v[132:135], v[112:115], a[48:51]
 ds_read_b64_tr_b16 v[74:75], v12 offset:33792
 v_mfma_f32_16x16x32_bf16 a[52:55], v[132:135], v[116:119], a[52:55]
 v_mfma_f32_16x16x32_bf16 a[56:59], v[132:135], v[120:123], a[56:59]
 ds_read_b128 v[36:39], v8 offset:34816
 v_mfma_f32_16x16x32_bf16 a[60:63], v[132:135], v[124:127], a[60:63]
 buffer_load_dwordx4 v5, s[4:7], s36 offen offset:3072 lds
 v_mfma_f32_16x16x32_bf16 a[64:67], v[136:139], v[96:99], a[64:67]
 ds_read_b64_tr_b16 v[76:77], v13 offset:32768
 v_mfma_f32_16x16x32_bf16 a[68:71], v[136:139], v[100:103], a[68:71]
 s_add_u32 s36, s35, 256
 s_and_b32 s36, s36, 1023
 s_add_u32 s36, s36, s59
 v_mfma_f32_16x16x32_bf16 a[72:75], v[136:139], v[104:107], a[72:75]
 s_add_u32 m0, s42, 69632
 ds_read_b64_tr_b16 v[78:79], v13 offset:33792
 v_mfma_f32_16x16x32_bf16 a[76:79], v[136:139], v[108:111], a[76:79]
 buffer_load_dwordx4 v2, s[4:7], s36 offen offset:0 lds
 v_mfma_f32_16x16x32_bf16 a[80:83], v[136:139], v[112:115], a[80:83]
 ds_read_b128 v[40:43], v8 offset:36864
 v_mfma_f32_16x16x32_bf16 a[84:87], v[136:139], v[116:119], a[84:87]
 v_mfma_f32_16x16x32_bf16 a[88:91], v[136:139], v[120:123], a[88:91]
 ds_read_b64_tr_b16 v[80:81], v10 offset:34816
 v_mfma_f32_16x16x32_bf16 a[92:95], v[136:139], v[124:127], a[92:95]
 buffer_load_dwordx4 v3, s[4:7], s36 offen offset:1024 lds
 v_mfma_f32_16x16x32_bf16 a[96:99], v[140:143], v[96:99], a[96:99]
 ds_read_b64_tr_b16 v[82:83], v10 offset:35840
 v_mfma_f32_16x16x32_bf16 a[100:103], v[140:143], v[100:103], a[100:103]
 v_mfma_f32_16x16x32_bf16 a[104:107], v[140:143], v[104:107], a[104:107]
 ds_read_b128 v[44:47], v8 offset:38912
 v_mfma_f32_16x16x32_bf16 a[108:111], v[140:143], v[108:111], a[108:111]
 buffer_load_dwordx4 v4, s[4:7], s36 offen offset:2048 lds
 v_mfma_f32_16x16x32_bf16 a[112:115], v[140:143], v[112:115], a[112:115]
 ds_read_b64_tr_b16 v[84:85], v11 offset:34816
 v_mfma_f32_16x16x32_bf16 a[116:119], v[140:143], v[116:119], a[116:119]
 v_mfma_f32_16x16x32_bf16 a[120:123], v[140:143], v[120:123], a[120:123]
 ds_read_b64_tr_b16 v[86:87], v11 offset:35840
 v_mfma_f32_16x16x32_bf16 a[124:127], v[140:143], v[124:127], a[124:127]
 buffer_load_dwordx4 v5, s[4:7], s36 offen offset:3072 lds
 v_mfma_f32_16x16x32_bf16 a[128:131], v[96:99], v[144:147], a[128:131]
 ds_read_b128 v[48:51], v8 offset:40960
 v_mfma_f32_16x16x32_bf16 a[132:135], v[100:103], v[144:147], a[132:135]
 s_add_u32 s37, s58, 1048576
 s_and_b32 s37, s37, 4194303
 s_add_u32 s37, s37, s39
 v_mfma_f32_16x16x32_bf16 a[136:139], v[104:107], v[144:147], a[136:139]
 s_add_u32 m0, s43, 0
 ds_read_b64_tr_b16 v[88:89], v12 offset:34816
 v_mfma_f32_16x16x32_bf16 a[140:143], v[108:111], v[144:147], a[140:143]
 buffer_load_dwordx4 v6, s[8:11], s37 offen offset:0 lds
 v_mfma_f32_16x16x32_bf16 a[144:147], v[112:115], v[144:147], a[144:147]
 ds_read_b64_tr_b16 v[90:91], v12 offset:35840
 v_mfma_f32_16x16x32_bf16 a[148:151], v[116:119], v[144:147], a[148:151]
 v_mfma_f32_16x16x32_bf16 a[152:155], v[120:123], v[144:147], a[152:155]
 ds_read_b128 v[52:55], v8 offset:43008
 v_mfma_f32_16x16x32_bf16 a[156:159], v[124:127], v[144:147], a[156:159]
 buffer_load_dwordx4 v7, s[8:11], s37 offen offset:1024 lds
 v_mfma_f32_16x16x32_bf16 a[160:163], v[96:99], v[148:151], a[160:163]
 s_lshl_b32 s3, s33, 5
 ds_read_b64_tr_b16 v[92:93], v13 offset:34816
 v_mfma_f32_16x16x32_bf16 a[164:167], v[100:103], v[148:151], a[164:167]
 s_add_u32 s3, s3, s34
 v_mfma_f32_16x16x32_bf16 a[168:171], v[104:107], v[148:151], a[168:171]
 s_add_u32 m0, s43, 2048
 ds_read_b64_tr_b16 v[94:95], v13 offset:35840
 v_mfma_f32_16x16x32_bf16 a[172:175], v[108:111], v[148:151], a[172:175]
 buffer_load_dwordx4 v6, s[12:15], s37 offen offset:0 lds
 v_mfma_f32_16x16x32_bf16 a[176:179], v[112:115], v[148:151], a[176:179]
 s_lshl_b32 s3, s3, 2
 ds_read_b128 v[56:59], v8 offset:45056
 v_mfma_f32_16x16x32_bf16 a[180:183], v[116:119], v[148:151], a[180:183]
 s_add_u32 s3, s3, 393216
 v_mfma_f32_16x16x32_bf16 a[184:187], v[120:123], v[148:151], a[184:187]
 s_cmp_eq_u32 s32, 0
 s_cselect_b32 s3, s3, 0x80000000
 ds_read_b128 v[60:63], v8 offset:47104
 v_mfma_f32_16x16x32_bf16 a[188:191], v[124:127], v[148:151], a[188:191]
 buffer_load_dwordx4 v7, s[12:15], s37 offen offset:1024 lds
 v_mfma_f32_16x16x32_bf16 a[192:195], v[96:99], v[152:155], a[192:195]
 v_mov_b32 v241, 0
 v_mfma_f32_16x16x32_bf16 a[196:199], v[100:103], v[152:155], a[196:199]
 s_mov_b32 s16, s66
 v_mfma_f32_16x16x32_bf16 a[200:203], v[104:107], v[152:155], a[200:203]
 s_mov_b32 s17, s67
 v_mfma_f32_16x16x32_bf16 a[204:207], v[108:111], v[152:155], a[204:207]
 v_mfma_f32_16x16x32_bf16 a[208:211], v[112:115], v[152:155], a[208:211]
 s_mov_b32 s18, 4194304
 v_mfma_f32_16x16x32_bf16 a[212:215], v[116:119], v[152:155], a[212:215]
 s_mov_b32 s19, 0x00020000
 v_mfma_f32_16x16x32_bf16 a[216:219], v[120:123], v[152:155], a[216:219]
 s_mov_b32 s76, s68
 v_mfma_f32_16x16x32_bf16 a[220:223], v[124:127], v[152:155], a[220:223]
 v_mfma_f32_16x16x32_bf16 a[224:227], v[96:99], v[156:159], a[224:227]
 s_mov_b32 s77, s69
 v_mfma_f32_16x16x32_bf16 a[228:231], v[100:103], v[156:159], a[228:231]
 s_mov_b32 s78, 4194304
 v_mfma_f32_16x16x32_bf16 a[232:235], v[104:107], v[156:159], a[232:235]
 s_mov_b32 s79, 0x00020000
 v_mfma_f32_16x16x32_bf16 a[236:239], v[108:111], v[156:159], a[236:239]
 v_mfma_f32_16x16x32_bf16 a[240:243], v[112:115], v[156:159], a[240:243]
 v_mfma_f32_16x16x32_bf16 a[244:247], v[116:119], v[156:159], a[244:247]
 v_mfma_f32_16x16x32_bf16 a[248:251], v[120:123], v[156:159], a[248:251]
 v_mfma_f32_16x16x32_bf16 a[252:255], v[124:127], v[156:159], a[252:255]
 s_waitcnt vmcnt(12) lgkmcnt(0)
 s_barrier
 v_mfma_f32_16x16x32_bf16 a[0:3], v[64:67], v[32:35], a[0:3]
 ds_read_b64_tr_b16 v[128:129], v10 offset:49152
 v_mfma_f32_16x16x32_bf16 a[4:7], v[64:67], v[36:39], a[4:7]
 s_add_u32 s36, s35, 384
 s_and_b32 s36, s36, 1023
 s_add_u32 s36, s36, s38
 v_mfma_f32_16x16x32_bf16 a[8:11], v[64:67], v[40:43], a[8:11]
 s_add_u32 m0, s42, 0
 ds_read_b64_tr_b16 v[130:131], v10 offset:50176
 v_mfma_f32_16x16x32_bf16 a[12:15], v[64:67], v[44:47], a[12:15]
 buffer_load_dwordx4 v2, s[4:7], s36 offen offset:0 lds
 v_mfma_f32_16x16x32_bf16 a[16:19], v[64:67], v[48:51], a[16:19]
 ds_read_b64_tr_b16 v[132:133], v11 offset:49152
 v_mfma_f32_16x16x32_bf16 a[20:23], v[64:67], v[52:55], a[20:23]
 v_mfma_f32_16x16x32_bf16 a[24:27], v[64:67], v[56:59], a[24:27]
 ds_read_b64_tr_b16 v[134:135], v11 offset:50176
 v_mfma_f32_16x16x32_bf16 a[28:31], v[64:67], v[60:63], a[28:31]
 buffer_load_dwordx4 v3, s[4:7], s36 offen offset:1024 lds
 v_mfma_f32_16x16x32_bf16 a[32:35], v[68:71], v[32:35], a[32:35]
 ds_read_b128 v[96:99], v9 offset:32768
 v_mfma_f32_16x16x32_bf16 a[36:39], v[68:71], v[36:39], a[36:39]
 v_mfma_f32_16x16x32_bf16 a[40:43], v[68:71], v[40:43], a[40:43]
 ds_read_b64_tr_b16 v[136:137], v12 offset:49152
 v_mfma_f32_16x16x32_bf16 a[44:47], v[68:71], v[44:47], a[44:47]
 buffer_load_dwordx4 v4, s[4:7], s36 offen offset:2048 lds
 v_mfma_f32_16x16x32_bf16 a[48:51], v[68:71], v[48:51], a[48:51]
 ds_read_b64_tr_b16 v[138:139], v12 offset:50176
 v_mfma_f32_16x16x32_bf16 a[52:55], v[68:71], v[52:55], a[52:55]
 v_mfma_f32_16x16x32_bf16 a[56:59], v[68:71], v[56:59], a[56:59]
 ds_read_b128 v[100:103], v9 offset:34816
 v_mfma_f32_16x16x32_bf16 a[60:63], v[68:71], v[60:63], a[60:63]
 buffer_load_dwordx4 v5, s[4:7], s36 offen offset:3072 lds
 v_mfma_f32_16x16x32_bf16 a[64:67], v[72:75], v[32:35], a[64:67]
 ds_read_b64_tr_b16 v[140:141], v13 offset:49152
 v_mfma_f32_16x16x32_bf16 a[68:71], v[72:75], v[36:39], a[68:71]
 s_add_u32 s37, s58, 1310720
 s_and_b32 s37, s37, 4194303
 s_add_u32 s37, s37, s39
 v_mfma_f32_16x16x32_bf16 a[72:75], v[72:75], v[40:43], a[72:75]
 s_add_u32 m0, s43, 16384
 ds_read_b64_tr_b16 v[142:143], v13 offset:50176
 v_mfma_f32_16x16x32_bf16 a[76:79], v[72:75], v[44:47], a[76:79]
 buffer_load_dwordx4 v6, s[8:11], s37 offen offset:0 lds
 v_mfma_f32_16x16x32_bf16 a[80:83], v[72:75], v[48:51], a[80:83]
 ds_read_b128 v[104:107], v9 offset:36864
 v_mfma_f32_16x16x32_bf16 a[84:87], v[72:75], v[52:55], a[84:87]
 v_mfma_f32_16x16x32_bf16 a[88:91], v[72:75], v[56:59], a[88:91]
 ds_read_b64_tr_b16 v[144:145], v10 offset:51200
 v_mfma_f32_16x16x32_bf16 a[92:95], v[72:75], v[60:63], a[92:95]
 buffer_load_dwordx4 v7, s[8:11], s37 offen offset:1024 lds
 v_mfma_f32_16x16x32_bf16 a[96:99], v[76:79], v[32:35], a[96:99]
 ds_read_b64_tr_b16 v[146:147], v10 offset:52224
 v_mfma_f32_16x16x32_bf16 a[100:103], v[76:79], v[36:39], a[100:103]
 v_mfma_f32_16x16x32_bf16 a[104:107], v[76:79], v[40:43], a[104:107]
 s_add_u32 m0, s43, 18432
 ds_read_b128 v[108:111], v9 offset:38912
 v_mfma_f32_16x16x32_bf16 a[108:111], v[76:79], v[44:47], a[108:111]
 buffer_load_dwordx4 v6, s[12:15], s37 offen offset:0 lds
 v_mfma_f32_16x16x32_bf16 a[112:115], v[76:79], v[48:51], a[112:115]
 ds_read_b64_tr_b16 v[148:149], v11 offset:51200
 v_mfma_f32_16x16x32_bf16 a[116:119], v[76:79], v[52:55], a[116:119]
 v_mfma_f32_16x16x32_bf16 a[120:123], v[76:79], v[56:59], a[120:123]
 ds_read_b64_tr_b16 v[150:151], v11 offset:52224
 v_mfma_f32_16x16x32_bf16 a[124:127], v[76:79], v[60:63], a[124:127]
 buffer_load_dwordx4 v7, s[12:15], s37 offen offset:1024 lds
 v_mfma_f32_16x16x32_bf16 a[128:131], v[32:35], v[80:83], a[128:131]
 ds_read_b128 v[112:115], v9 offset:40960
 v_mfma_f32_16x16x32_bf16 a[132:135], v[36:39], v[80:83], a[132:135]
 s_add_u32 s36, s35, 384
 s_and_b32 s36, s36, 1023
 s_add_u32 s36, s36, s59
 v_mfma_f32_16x16x32_bf16 a[136:139], v[40:43], v[80:83], a[136:139]
 s_add_u32 m0, s42, 4096
 ds_read_b64_tr_b16 v[152:153], v12 offset:51200
 v_mfma_f32_16x16x32_bf16 a[140:143], v[44:47], v[80:83], a[140:143]
 buffer_load_dwordx4 v2, s[4:7], s36 offen offset:0 lds
 v_mfma_f32_16x16x32_bf16 a[144:147], v[48:51], v[80:83], a[144:147]
 ds_read_b64_tr_b16 v[154:155], v12 offset:52224
 v_mfma_f32_16x16x32_bf16 a[148:151], v[52:55], v[80:83], a[148:151]
 v_mfma_f32_16x16x32_bf16 a[152:155], v[56:59], v[80:83], a[152:155]
 ds_read_b128 v[116:119], v9 offset:43008
 v_mfma_f32_16x16x32_bf16 a[156:159], v[60:63], v[80:83], a[156:159]
 buffer_load_dwordx4 v3, s[4:7], s36 offen offset:1024 lds
 v_mfma_f32_16x16x32_bf16 a[160:163], v[32:35], v[84:87], a[160:163]
 ds_read_b64_tr_b16 v[156:157], v13 offset:51200
 v_mfma_f32_16x16x32_bf16 a[164:167], v[36:39], v[84:87], a[164:167]
 v_mfma_f32_16x16x32_bf16 a[168:171], v[40:43], v[84:87], a[168:171]
 ds_read_b64_tr_b16 v[158:159], v13 offset:52224
 v_mfma_f32_16x16x32_bf16 a[172:175], v[44:47], v[84:87], a[172:175]
 buffer_load_dwordx4 v4, s[4:7], s36 offen offset:2048 lds
 v_mfma_f32_16x16x32_bf16 a[176:179], v[48:51], v[84:87], a[176:179]
 ds_read_b128 v[120:123], v9 offset:45056
 v_mfma_f32_16x16x32_bf16 a[180:183], v[52:55], v[84:87], a[180:183]
 v_mfma_f32_16x16x32_bf16 a[184:187], v[56:59], v[84:87], a[184:187]
 ds_read_b128 v[124:127], v9 offset:47104
 v_mfma_f32_16x16x32_bf16 a[188:191], v[60:63], v[84:87], a[188:191]
 buffer_load_dwordx4 v5, s[4:7], s36 offen offset:3072 lds
 v_mfma_f32_16x16x32_bf16 a[192:195], v[32:35], v[88:91], a[192:195]
 v_mfma_f32_16x16x32_bf16 a[196:199], v[36:39], v[88:91], a[196:199]
 v_mfma_f32_16x16x32_bf16 a[200:203], v[40:43], v[88:91], a[200:203]
 v_mfma_f32_16x16x32_bf16 a[204:207], v[44:47], v[88:91], a[204:207]
 v_mfma_f32_16x16x32_bf16 a[208:211], v[48:51], v[88:91], a[208:211]
 v_mfma_f32_16x16x32_bf16 a[212:215], v[52:55], v[88:91], a[212:215]
 v_mfma_f32_16x16x32_bf16 a[216:219], v[56:59], v[88:91], a[216:219]
 v_mfma_f32_16x16x32_bf16 a[220:223], v[60:63], v[88:91], a[220:223]
 v_mfma_f32_16x16x32_bf16 a[224:227], v[32:35], v[92:95], a[224:227]
 v_mfma_f32_16x16x32_bf16 a[228:231], v[36:39], v[92:95], a[228:231]
 v_mfma_f32_16x16x32_bf16 a[232:235], v[40:43], v[92:95], a[232:235]
 v_mfma_f32_16x16x32_bf16 a[236:239], v[44:47], v[92:95], a[236:239]
 v_mfma_f32_16x16x32_bf16 a[240:243], v[48:51], v[92:95], a[240:243]
 v_mfma_f32_16x16x32_bf16 a[244:247], v[52:55], v[92:95], a[244:247]
 v_mfma_f32_16x16x32_bf16 a[248:251], v[56:59], v[92:95], a[248:251]
 v_mfma_f32_16x16x32_bf16 a[252:255], v[60:63], v[92:95], a[252:255]
 s_waitcnt vmcnt(12) lgkmcnt(0)
 s_barrier
 v_mfma_f32_16x16x32_bf16 a[0:3], v[128:131], v[96:99], a[0:3]
 ds_read_b64_tr_b16 v[64:65], v10 offset:0
 v_mfma_f32_16x16x32_bf16 a[4:7], v[128:131], v[100:103], a[4:7]
 s_add_u32 s37, s58, 1572864
 s_and_b32 s37, s37, 4194303
 s_add_u32 s37, s37, s39
 v_mfma_f32_16x16x32_bf16 a[8:11], v[128:131], v[104:107], a[8:11]
 s_add_u32 m0, s43, 32768
 ds_read_b64_tr_b16 v[66:67], v10 offset:1024
 v_mfma_f32_16x16x32_bf16 a[12:15], v[128:131], v[108:111], a[12:15]
 buffer_load_dwordx4 v6, s[8:11], s37 offen offset:0 lds
 v_mfma_f32_16x16x32_bf16 a[16:19], v[128:131], v[112:115], a[16:19]
 ds_read_b64_tr_b16 v[68:69], v11 offset:0
 v_mfma_f32_16x16x32_bf16 a[20:23], v[128:131], v[116:119], a[20:23]
 v_mfma_f32_16x16x32_bf16 a[24:27], v[128:131], v[120:123], a[24:27]
 ds_read_b64_tr_b16 v[70:71], v11 offset:1024
 v_mfma_f32_16x16x32_bf16 a[28:31], v[128:131], v[124:127], a[28:31]
 buffer_load_dwordx4 v7, s[8:11], s37 offen offset:1024 lds
 v_mfma_f32_16x16x32_bf16 a[32:35], v[132:135], v[96:99], a[32:35]
 ds_read_b128 v[32:35], v14 offset:0
 v_mfma_f32_16x16x32_bf16 a[36:39], v[132:135], v[100:103], a[36:39]
 v_mfma_f32_16x16x32_bf16 a[40:43], v[132:135], v[104:107], a[40:43]
 s_add_u32 m0, s43, 34816
 ds_read_b64_tr_b16 v[72:73], v12 offset:0
 v_mfma_f32_16x16x32_bf16 a[44:47], v[132:135], v[108:111], a[44:47]
 buffer_load_dwordx4 v6, s[12:15], s37 offen offset:0 lds
 v_mfma_f32_16x16x32_bf16 a[48:51], v[132:135], v[112:115], a[48:51]
 ds_read_b64_tr_b16 v[74:75], v12 offset:1024
 v_mfma_f32_16x16x32_bf16 a[52:55], v[132:135], v[116:119], a[52:55]
 v_mfma_f32_16x16x32_bf16 a[56:59], v[132:135], v[120:123], a[56:59]
 ds_read_b128 v[36:39], v14 offset:2048
 v_mfma_f32_16x16x32_bf16 a[60:63], v[132:135], v[124:127], a[60:63]
 buffer_load_dwordx4 v7, s[12:15], s37 offen offset:1024 lds
 v_mfma_f32_16x16x32_bf16 a[64:67], v[136:139], v[96:99], a[64:67]
 ds_read_b64_tr_b16 v[76:77], v13 offset:0
 v_mfma_f32_16x16x32_bf16 a[68:71], v[136:139], v[100:103], a[68:71]
 s_add_u32 s36, s35, 512
 s_and_b32 s36, s36, 1023
 s_add_u32 s36, s36, s38
 v_mfma_f32_16x16x32_bf16 a[72:75], v[136:139], v[104:107], a[72:75]
 s_add_u32 m0, s42, 32768
 ds_read_b64_tr_b16 v[78:79], v13 offset:1024
 v_mfma_f32_16x16x32_bf16 a[76:79], v[136:139], v[108:111], a[76:79]
 buffer_load_dwordx4 v2, s[4:7], s36 offen offset:0 lds
 v_mfma_f32_16x16x32_bf16 a[80:83], v[136:139], v[112:115], a[80:83]
 ds_read_b128 v[40:43], v14 offset:4096
 v_mfma_f32_16x16x32_bf16 a[84:87], v[136:139], v[116:119], a[84:87]
 v_mfma_f32_16x16x32_bf16 a[88:91], v[136:139], v[120:123], a[88:91]
 ds_read_b64_tr_b16 v[80:81], v10 offset:2048
 v_mfma_f32_16x16x32_bf16 a[92:95], v[136:139], v[124:127], a[92:95]
 buffer_load_dwordx4 v3, s[4:7], s36 offen offset:1024 lds
 v_mfma_f32_16x16x32_bf16 a[96:99], v[140:143], v[96:99], a[96:99]
 ds_read_b64_tr_b16 v[82:83], v10 offset:3072
 v_mfma_f32_16x16x32_bf16 a[100:103], v[140:143], v[100:103], a[100:103]
 v_mfma_f32_16x16x32_bf16 a[104:107], v[140:143], v[104:107], a[104:107]
 ds_read_b128 v[44:47], v14 offset:6144
 v_mfma_f32_16x16x32_bf16 a[108:111], v[140:143], v[108:111], a[108:111]
 buffer_load_dwordx4 v4, s[4:7], s36 offen offset:2048 lds
 v_mfma_f32_16x16x32_bf16 a[112:115], v[140:143], v[112:115], a[112:115]
 ds_read_b64_tr_b16 v[84:85], v11 offset:2048
 v_mfma_f32_16x16x32_bf16 a[116:119], v[140:143], v[116:119], a[116:119]
 v_mfma_f32_16x16x32_bf16 a[120:123], v[140:143], v[120:123], a[120:123]
 ds_read_b64_tr_b16 v[86:87], v11 offset:3072
 v_mfma_f32_16x16x32_bf16 a[124:127], v[140:143], v[124:127], a[124:127]
 buffer_load_dwordx4 v5, s[4:7], s36 offen offset:3072 lds
 v_mfma_f32_16x16x32_bf16 a[128:131], v[96:99], v[144:147], a[128:131]
 ds_read_b128 v[48:51], v14 offset:8192
 v_mfma_f32_16x16x32_bf16 a[132:135], v[100:103], v[144:147], a[132:135]
 s_add_u32 s37, s58, 1835008
 s_and_b32 s37, s37, 4194303
 s_add_u32 s37, s37, s39
 v_mfma_f32_16x16x32_bf16 a[136:139], v[104:107], v[144:147], a[136:139]
 s_add_u32 m0, s43, 49152
 ds_read_b64_tr_b16 v[88:89], v12 offset:2048
 v_mfma_f32_16x16x32_bf16 a[140:143], v[108:111], v[144:147], a[140:143]
 buffer_load_dwordx4 v6, s[8:11], s37 offen offset:0 lds
 v_mfma_f32_16x16x32_bf16 a[144:147], v[112:115], v[144:147], a[144:147]
 ds_read_b64_tr_b16 v[90:91], v12 offset:3072
 v_mfma_f32_16x16x32_bf16 a[148:151], v[116:119], v[144:147], a[148:151]
 v_mfma_f32_16x16x32_bf16 a[152:155], v[120:123], v[144:147], a[152:155]
 ds_read_b128 v[52:55], v14 offset:10240
 v_mfma_f32_16x16x32_bf16 a[156:159], v[124:127], v[144:147], a[156:159]
 buffer_load_dwordx4 v7, s[8:11], s37 offen offset:1024 lds
 v_mfma_f32_16x16x32_bf16 a[160:163], v[96:99], v[148:151], a[160:163]
 ds_read_b64_tr_b16 v[92:93], v13 offset:2048
 v_mfma_f32_16x16x32_bf16 a[164:167], v[100:103], v[148:151], a[164:167]
 v_mfma_f32_16x16x32_bf16 a[168:171], v[104:107], v[148:151], a[168:171]
 s_add_u32 m0, s43, 51200
 ds_read_b64_tr_b16 v[94:95], v13 offset:3072
 v_mfma_f32_16x16x32_bf16 a[172:175], v[108:111], v[148:151], a[172:175]
 buffer_load_dwordx4 v6, s[12:15], s37 offen offset:0 lds
 v_mfma_f32_16x16x32_bf16 a[176:179], v[112:115], v[148:151], a[176:179]
 ds_read_b128 v[56:59], v14 offset:12288
 v_mfma_f32_16x16x32_bf16 a[180:183], v[116:119], v[148:151], a[180:183]
 v_mfma_f32_16x16x32_bf16 a[184:187], v[120:123], v[148:151], a[184:187]
 ds_read_b128 v[60:63], v14 offset:14336
 v_mfma_f32_16x16x32_bf16 a[188:191], v[124:127], v[148:151], a[188:191]
 buffer_load_dwordx4 v7, s[12:15], s37 offen offset:1024 lds
 v_mfma_f32_16x16x32_bf16 a[192:195], v[96:99], v[152:155], a[192:195]
 v_mfma_f32_16x16x32_bf16 a[196:199], v[100:103], v[152:155], a[196:199]
 v_mfma_f32_16x16x32_bf16 a[200:203], v[104:107], v[152:155], a[200:203]
 v_mfma_f32_16x16x32_bf16 a[204:207], v[108:111], v[152:155], a[204:207]
 v_mfma_f32_16x16x32_bf16 a[208:211], v[112:115], v[152:155], a[208:211]
 v_mfma_f32_16x16x32_bf16 a[212:215], v[116:119], v[152:155], a[212:215]
 v_mfma_f32_16x16x32_bf16 a[216:219], v[120:123], v[152:155], a[216:219]
 v_mfma_f32_16x16x32_bf16 a[220:223], v[124:127], v[152:155], a[220:223]
 v_mfma_f32_16x16x32_bf16 a[224:227], v[96:99], v[156:159], a[224:227]
 v_mfma_f32_16x16x32_bf16 a[228:231], v[100:103], v[156:159], a[228:231]
 v_mfma_f32_16x16x32_bf16 a[232:235], v[104:107], v[156:159], a[232:235]
 v_mfma_f32_16x16x32_bf16 a[236:239], v[108:111], v[156:159], a[236:239]
 v_mfma_f32_16x16x32_bf16 a[240:243], v[112:115], v[156:159], a[240:243]
 v_mfma_f32_16x16x32_bf16 a[244:247], v[116:119], v[156:159], a[244:247]
 v_mfma_f32_16x16x32_bf16 a[248:251], v[120:123], v[156:159], a[248:251]
 v_mfma_f32_16x16x32_bf16 a[252:255], v[124:127], v[156:159], a[252:255]
 s_waitcnt vmcnt(16) lgkmcnt(0)
 s_barrier
 v_mfma_f32_16x16x32_bf16 a[0:3], v[64:67], v[32:35], a[0:3]
 ds_read_b64_tr_b16 v[128:129], v10 offset:16384
 v_mfma_f32_16x16x32_bf16 a[4:7], v[64:67], v[36:39], a[4:7]
 s_add_u32 s36, s35, 512
 s_and_b32 s36, s36, 1023
 s_add_u32 s36, s36, s59
 v_mfma_f32_16x16x32_bf16 a[8:11], v[64:67], v[40:43], a[8:11]
 s_add_u32 m0, s42, 36864
 ds_read_b64_tr_b16 v[130:131], v10 offset:17408
 v_mfma_f32_16x16x32_bf16 a[12:15], v[64:67], v[44:47], a[12:15]
 buffer_load_dwordx4 v2, s[4:7], s36 offen offset:0 lds
 v_mfma_f32_16x16x32_bf16 a[16:19], v[64:67], v[48:51], a[16:19]
 ds_read_b64_tr_b16 v[132:133], v11 offset:16384
 v_mfma_f32_16x16x32_bf16 a[20:23], v[64:67], v[52:55], a[20:23]
L_pad0:
 s_cbranch_execz L_pad8
 v_mfma_f32_16x16x32_bf16 a[24:27], v[64:67], v[56:59], a[24:27]
 ds_read_b64_tr_b16 v[134:135], v11 offset:17408
 v_mfma_f32_16x16x32_bf16 a[28:31], v[64:67], v[60:63], a[28:31]
 buffer_load_dwordx4 v3, s[4:7], s36 offen offset:1024 lds
 v_mfma_f32_16x16x32_bf16 a[32:35], v[68:71], v[32:35], a[32:35]
 ds_read_b128 v[96:99], v15 offset:0
 v_mfma_f32_16x16x32_bf16 a[36:39], v[68:71], v[36:39], a[36:39]
 v_mfma_f32_16x16x32_bf16 a[40:43], v[68:71], v[40:43], a[40:43]
 ds_read_b64_tr_b16 v[136:137], v12 offset:16384
 v_mfma_f32_16x16x32_bf16 a[44:47], v[68:71], v[44:47], a[44:47]
 buffer_load_dwordx4 v4, s[4:7], s36 offen offset:2048 lds
 v_mfma_f32_16x16x32_bf16 a[48:51], v[68:71], v[48:51], a[48:51]
 ds_read_b64_tr_b16 v[138:139], v12 offset:17408
 v_mfma_f32_16x16x32_bf16 a[52:55], v[68:71], v[52:55], a[52:55]
 v_mfma_f32_16x16x32_bf16 a[56:59], v[68:71], v[56:59], a[56:59]
 ds_read_b128 v[100:103], v15 offset:2048
 v_mfma_f32_16x16x32_bf16 a[60:63], v[68:71], v[60:63], a[60:63]
 buffer_load_dwordx4 v5, s[4:7], s36 offen offset:3072 lds
 v_mfma_f32_16x16x32_bf16 a[64:67], v[72:75], v[32:35], a[64:67]
 ds_read_b64_tr_b16 v[140:141], v13 offset:16384
 v_mfma_f32_16x16x32_bf16 a[68:71], v[72:75], v[36:39], a[68:71]
 s_add_u32 s37, s58, 2097152
 s_and_b32 s37, s37, 4194303
 s_add_u32 s37, s37, s39
 v_mfma_f32_16x16x32_bf16 a[72:75], v[72:75], v[40:43], a[72:75]
 s_add_u32 m0, s43, 0
 ds_read_b64_tr_b16 v[142:143], v13 offset:17408
 v_mfma_f32_16x16x32_bf16 a[76:79], v[72:75], v[44:47], a[76:79]
 buffer_load_dwordx4 v6, s[8:11], s37 offen offset:0 lds
 v_mfma_f32_16x16x32_bf16 a[80:83], v[72:75], v[48:51], a[80:83]
 ds_read_b128 v[104:107], v15 offset:4096
 v_mfma_f32_16x16x32_bf16 a[84:87], v[72:75], v[52:55], a[84:87]
 v_mfma_f32_16x16x32_bf16 a[88:91], v[72:75], v[56:59], a[88:91]
 ds_read_b64_tr_b16 v[144:145], v10 offset:18432
 v_mfma_f32_16x16x32_bf16 a[92:95], v[72:75], v[60:63], a[92:95]
 buffer_load_dwordx4 v7, s[8:11], s37 offen offset:1024 lds
 v_mfma_f32_16x16x32_bf16 a[96:99], v[76:79], v[32:35], a[96:99]
 ds_read_b64_tr_b16 v[146:147], v10 offset:19456
 v_mfma_f32_16x16x32_bf16 a[100:103], v[76:79], v[36:39], a[100:103]
 v_mfma_f32_16x16x32_bf16 a[104:107], v[76:79], v[40:43], a[104:107]
 s_add_u32 m0, s43, 2048
 ds_read_b128 v[108:111], v15 offset:6144
 v_mfma_f32_16x16x32_bf16 a[108:111], v[76:79], v[44:47], a[108:111]
 buffer_load_dwordx4 v6, s[12:15], s37 offen offset:0 lds
 v_mfma_f32_16x16x32_bf16 a[112:115], v[76:79], v[48:51], a[112:115]
 ds_read_b64_tr_b16 v[148:149], v11 offset:18432
 v_mfma_f32_16x16x32_bf16 a[116:119], v[76:79], v[52:55], a[116:119]
 v_mfma_f32_16x16x32_bf16 a[120:123], v[76:79], v[56:59], a[120:123]
 ds_read_b64_tr_b16 v[150:151], v11 offset:19456
 v_mfma_f32_16x16x32_bf16 a[124:127], v[76:79], v[60:63], a[124:127]
 buffer_load_dwordx4 v7, s[12:15], s37 offen offset:1024 lds
 v_mfma_f32_16x16x32_bf16 a[128:131], v[32:35], v[80:83], a[128:131]
 ds_read_b128 v[112:115], v15 offset:8192
 v_mfma_f32_16x16x32_bf16 a[132:135], v[36:39], v[80:83], a[132:135]
 v_mfma_f32_16x16x32_bf16 a[136:139], v[40:43], v[80:83], a[136:139]
 ds_read_b64_tr_b16 v[152:153], v12 offset:18432
 v_mfma_f32_16x16x32_bf16 a[140:143], v[44:47], v[80:83], a[140:143]
 v_mfma_f32_16x16x32_bf16 a[144:147], v[48:51], v[80:83], a[144:147]
 ds_read_b64_tr_b16 v[154:155], v12 offset:19456
 v_mfma_f32_16x16x32_bf16 a[148:151], v[52:55], v[80:83], a[148:151]
 v_mfma_f32_16x16x32_bf16 a[152:155], v[56:59], v[80:83], a[152:155]
 ds_read_b128 v[116:119], v15 offset:10240
 v_mfma_f32_16x16x32_bf16 a[156:159], v[60:63], v[80:83], a[156:159]
 v_mfma_f32_16x16x32_bf16 a[160:163], v[32:35], v[84:87], a[160:163]
 ds_read_b64_tr_b16 v[156:157], v13 offset:18432
 v_mfma_f32_16x16x32_bf16 a[164:167], v[36:39], v[84:87], a[164:167]
 buffer_load_dwordx2 v[160:161], v1, s[16:19], 0 offen offset:0
 v_mfma_f32_16x16x32_bf16 a[168:171], v[40:43], v[84:87], a[168:171]
 ds_read_b64_tr_b16 v[158:159], v13 offset:19456
 v_mfma_f32_16x16x32_bf16 a[172:175], v[44:47], v[84:87], a[172:175]
 buffer_load_dwordx2 v[162:163], v1, s[16:19], 0 offen offset:2048
 v_mfma_f32_16x16x32_bf16 a[176:179], v[48:51], v[84:87], a[176:179]
 ds_read_b128 v[120:123], v15 offset:12288
 v_mfma_f32_16x16x32_bf16 a[180:183], v[52:55], v[84:87], a[180:183]
 buffer_load_dwordx2 v[164:165], v1, s[16:19], s47 offen offset:0
 v_mfma_f32_16x16x32_bf16 a[184:187], v[56:59], v[84:87], a[184:187]
 ds_read_b128 v[124:127], v15 offset:14336
 v_mfma_f32_16x16x32_bf16 a[188:191], v[60:63], v[84:87], a[188:191]
 buffer_load_dwordx2 v[166:167], v0, s[16:19], 0 offen offset:0
 v_mfma_f32_16x16x32_bf16 a[192:195], v[32:35], v[88:91], a[192:195]
 v_mfma_f32_16x16x32_bf16 a[196:199], v[36:39], v[88:91], a[196:199]
 buffer_load_dwordx2 v[168:169], v0, s[16:19], 0 offen offset:2048
 v_mfma_f32_16x16x32_bf16 a[200:203], v[40:43], v[88:91], a[200:203]
 v_mfma_f32_16x16x32_bf16 a[204:207], v[44:47], v[88:91], a[204:207]
 buffer_load_dwordx2 v[170:171], v0, s[16:19], s47 offen offset:0
 v_mfma_f32_16x16x32_bf16 a[208:211], v[48:51], v[88:91], a[208:211]
 v_mfma_f32_16x16x32_bf16 a[212:215], v[52:55], v[88:91], a[212:215]
 buffer_load_dwordx2 v[172:173], v0, s[16:19], s47 offen offset:2048
 v_mfma_f32_16x16x32_bf16 a[216:219], v[56:59], v[88:91], a[216:219]
 v_mfma_f32_16x16x32_bf16 a[220:223], v[60:63], v[88:91], a[220:223]
 buffer_load_dwordx2 v[174:175], v0, s[16:19], s48 offen offset:0
 v_mfma_f32_16x16x32_bf16 a[224:227], v[32:35], v[92:95], a[224:227]
 v_mfma_f32_16x16x32_bf16 a[228:231], v[36:39], v[92:95], a[228:231]
 buffer_load_dwordx2 v[176:177], v0, s[16:19], s48 offen offset:2048
 v_mfma_f32_16x16x32_bf16 a[232:235], v[40:43], v[92:95], a[232:235]
 v_mfma_f32_16x16x32_bf16 a[236:239], v[44:47], v[92:95], a[236:239]
 buffer_load_dwordx2 v[178:179], v0, s[16:19], s51 offen offset:0
 v_mfma_f32_16x16x32_bf16 a[240:243], v[48:51], v[92:95], a[240:243]
 v_mfma_f32_16x16x32_bf16 a[244:247], v[52:55], v[92:95], a[244:247]
 buffer_load_dwordx2 v[180:181], v0, s[16:19], s51 offen offset:2048
 v_mfma_f32_16x16x32_bf16 a[248:251], v[56:59], v[92:95], a[248:251]
 v_mfma_f32_16x16x32_bf16 a[252:255], v[60:63], v[92:95], a[252:255]
 s_waitcnt vmcnt(27) lgkmcnt(0)
 s_barrier
 v_mfma_f32_16x16x32_bf16 a[0:3], v[128:131], v[96:99], a[0:3]
 ds_read_b64_tr_b16 v[64:65], v10 offset:32768
 v_mfma_f32_16x16x32_bf16 a[4:7], v[128:131], v[100:103], a[4:7]
 s_add_u32 s36, s35, 640
 s_and_b32 s36, s36, 1023
 s_add_u32 s36, s36, s38
 v_mfma_f32_16x16x32_bf16 a[8:11], v[128:131], v[104:107], a[8:11]
 s_add_u32 m0, s42, 65536
 ds_read_b64_tr_b16 v[66:67], v10 offset:33792
 v_mfma_f32_16x16x32_bf16 a[12:15], v[128:131], v[108:111], a[12:15]
 buffer_load_dwordx4 v2, s[4:7], s36 offen offset:0 lds
 v_mfma_f32_16x16x32_bf16 a[16:19], v[128:131], v[112:115], a[16:19]
 ds_read_b64_tr_b16 v[68:69], v11 offset:32768
 v_mfma_f32_16x16x32_bf16 a[20:23], v[128:131], v[116:119], a[20:23]
 v_mfma_f32_16x16x32_bf16 a[24:27], v[128:131], v[120:123], a[24:27]
 ds_read_b64_tr_b16 v[70:71], v11 offset:33792
 v_mfma_f32_16x16x32_bf16 a[28:31], v[128:131], v[124:127], a[28:31]
 buffer_load_dwordx4 v3, s[4:7], s36 offen offset:1024 lds
 v_mfma_f32_16x16x32_bf16 a[32:35], v[132:135], v[96:99], a[32:35]
 ds_read_b128 v[32:35], v8 offset:0
 v_mfma_f32_16x16x32_bf16 a[36:39], v[132:135], v[100:103], a[36:39]
 v_mfma_f32_16x16x32_bf16 a[40:43], v[132:135], v[104:107], a[40:43]
 ds_read_b64_tr_b16 v[72:73], v12 offset:32768
 v_mfma_f32_16x16x32_bf16 a[44:47], v[132:135], v[108:111], a[44:47]
 buffer_load_dwordx4 v4, s[4:7], s36 offen offset:2048 lds
 v_mfma_f32_16x16x32_bf16 a[48:51], v[132:135], v[112:115], a[48:51]
 ds_read_b64_tr_b16 v[74:75], v12 offset:33792
 v_mfma_f32_16x16x32_bf16 a[52:55], v[132:135], v[116:119], a[52:55]
 v_mfma_f32_16x16x32_bf16 a[56:59], v[132:135], v[120:123], a[56:59]
 ds_read_b128 v[36:39], v8 offset:2048
 v_mfma_f32_16x16x32_bf16 a[60:63], v[132:135], v[124:127], a[60:63]
 buffer_load_dwordx4 v5, s[4:7], s36 offen offset:3072 lds
 v_mfma_f32_16x16x32_bf16 a[64:67], v[136:139], v[96:99], a[64:67]
 ds_read_b64_tr_b16 v[76:77], v13 offset:32768
 v_mfma_f32_16x16x32_bf16 a[68:71], v[136:139], v[100:103], a[68:71]
 s_add_u32 s37, s58, 2359296
 s_and_b32 s37, s37, 4194303
 s_add_u32 s37, s37, s39
 v_mfma_f32_16x16x32_bf16 a[72:75], v[136:139], v[104:107], a[72:75]
 s_add_u32 m0, s43, 16384
 ds_read_b64_tr_b16 v[78:79], v13 offset:33792
 v_mfma_f32_16x16x32_bf16 a[76:79], v[136:139], v[108:111], a[76:79]
 buffer_load_dwordx4 v6, s[8:11], s37 offen offset:0 lds
 v_mfma_f32_16x16x32_bf16 a[80:83], v[136:139], v[112:115], a[80:83]
 ds_read_b128 v[40:43], v8 offset:4096
 v_mfma_f32_16x16x32_bf16 a[84:87], v[136:139], v[116:119], a[84:87]
 v_mfma_f32_16x16x32_bf16 a[88:91], v[136:139], v[120:123], a[88:91]
 ds_read_b64_tr_b16 v[80:81], v10 offset:34816
 v_mfma_f32_16x16x32_bf16 a[92:95], v[136:139], v[124:127], a[92:95]
 buffer_load_dwordx4 v7, s[8:11], s37 offen offset:1024 lds
 v_mfma_f32_16x16x32_bf16 a[96:99], v[140:143], v[96:99], a[96:99]
 ds_read_b64_tr_b16 v[82:83], v10 offset:35840
 v_mfma_f32_16x16x32_bf16 a[100:103], v[140:143], v[100:103], a[100:103]
 v_mfma_f32_16x16x32_bf16 a[104:107], v[140:143], v[104:107], a[104:107]
 s_add_u32 m0, s43, 18432
 ds_read_b128 v[44:47], v8 offset:6144
 v_mfma_f32_16x16x32_bf16 a[108:111], v[140:143], v[108:111], a[108:111]
 buffer_load_dwordx4 v6, s[12:15], s37 offen offset:0 lds
 v_mfma_f32_16x16x32_bf16 a[112:115], v[140:143], v[112:115], a[112:115]
 ds_read_b64_tr_b16 v[84:85], v11 offset:34816
 v_mfma_f32_16x16x32_bf16 a[116:119], v[140:143], v[116:119], a[116:119]
 v_mfma_f32_16x16x32_bf16 a[120:123], v[140:143], v[120:123], a[120:123]
 ds_read_b64_tr_b16 v[86:87], v11 offset:35840
 v_mfma_f32_16x16x32_bf16 a[124:127], v[140:143], v[124:127], a[124:127]
 buffer_load_dwordx4 v7, s[12:15], s37 offen offset:1024 lds
 v_mfma_f32_16x16x32_bf16 a[128:131], v[96:99], v[144:147], a[128:131]
 ds_read_b128 v[48:51], v8 offset:8192
 v_mfma_f32_16x16x32_bf16 a[132:135], v[100:103], v[144:147], a[132:135]
 buffer_load_dwordx2 v[182:183], v0, s[76:79], 0 offen offset:0
 v_mfma_f32_16x16x32_bf16 a[136:139], v[104:107], v[144:147], a[136:139]
 ds_read_b64_tr_b16 v[88:89], v12 offset:34816
 v_mfma_f32_16x16x32_bf16 a[140:143], v[108:111], v[144:147], a[140:143]
 v_mfma_f32_16x16x32_bf16 a[144:147], v[112:115], v[144:147], a[144:147]
 ds_read_b64_tr_b16 v[90:91], v12 offset:35840
 v_mfma_f32_16x16x32_bf16 a[148:151], v[116:119], v[144:147], a[148:151]
 buffer_load_dwordx2 v[184:185], v0, s[76:79], 0 offen offset:2048
 v_mfma_f32_16x16x32_bf16 a[152:155], v[120:123], v[144:147], a[152:155]
 ds_read_b128 v[52:55], v8 offset:10240
 v_mfma_f32_16x16x32_bf16 a[156:159], v[124:127], v[144:147], a[156:159]
 v_mfma_f32_16x16x32_bf16 a[160:163], v[96:99], v[148:151], a[160:163]
 ds_read_b64_tr_b16 v[92:93], v13 offset:34816
 v_mfma_f32_16x16x32_bf16 a[164:167], v[100:103], v[148:151], a[164:167]
 buffer_load_dwordx2 v[186:187], v0, s[76:79], s47 offen offset:0
 v_mfma_f32_16x16x32_bf16 a[168:171], v[104:107], v[148:151], a[168:171]
 ds_read_b64_tr_b16 v[94:95], v13 offset:35840
 v_mfma_f32_16x16x32_bf16 a[172:175], v[108:111], v[148:151], a[172:175]
 v_mfma_f32_16x16x32_bf16 a[176:179], v[112:115], v[148:151], a[176:179]
 ds_read_b128 v[56:59], v8 offset:12288
 v_mfma_f32_16x16x32_bf16 a[180:183], v[116:119], v[148:151], a[180:183]
 buffer_load_dwordx2 v[188:189], v0, s[76:79], s47 offen offset:2048
 v_mfma_f32_16x16x32_bf16 a[184:187], v[120:123], v[148:151], a[184:187]
 ds_read_b128 v[60:63], v8 offset:14336
 v_mfma_f32_16x16x32_bf16 a[188:191], v[124:127], v[148:151], a[188:191]
 v_mfma_f32_16x16x32_bf16 a[192:195], v[96:99], v[152:155], a[192:195]
 v_mfma_f32_16x16x32_bf16 a[196:199], v[100:103], v[152:155], a[196:199]
 buffer_load_dwordx2 v[190:191], v0, s[76:79], s48 offen offset:0
 v_mfma_f32_16x16x32_bf16 a[200:203], v[104:107], v[152:155], a[200:203]
 v_mfma_f32_16x16x32_bf16 a[204:207], v[108:111], v[152:155], a[204:207]
 v_mfma_f32_16x16x32_bf16 a[208:211], v[112:115], v[152:155], a[208:211]
 v_mfma_f32_16x16x32_bf16 a[212:215], v[116:119], v[152:155], a[212:215]
 buffer_load_dwordx2 v[192:193], v0, s[76:79], s48 offen offset:2048
 v_mfma_f32_16x16x32_bf16 a[216:219], v[120:123], v[152:155], a[216:219]
 v_mfma_f32_16x16x32_bf16 a[220:223], v[124:127], v[152:155], a[220:223]
 v_mfma_f32_16x16x32_bf16 a[224:227], v[96:99], v[156:159], a[224:227]
 v_mfma_f32_16x16x32_bf16 a[228:231], v[100:103], v[156:159], a[228:231]
 buffer_load_dwordx2 v[194:195], v0, s[76:79], s51 offen offset:0
 v_mfma_f32_16x16x32_bf16 a[232:235], v[104:107], v[156:159], a[232:235]
 v_mfma_f32_16x16x32_bf16 a[236:239], v[108:111], v[156:159], a[236:239]
 v_mfma_f32_16x16x32_bf16 a[240:243], v[112:115], v[156:159], a[240:243]
 v_mfma_f32_16x16x32_bf16 a[244:247], v[116:119], v[156:159], a[244:247]
 buffer_load_dwordx2 v[196:197], v0, s[76:79], s51 offen offset:2048
 v_mfma_f32_16x16x32_bf16 a[248:251], v[120:123], v[156:159], a[248:251]
 v_mfma_f32_16x16x32_bf16 a[252:255], v[124:127], v[156:159], a[252:255]
 s_waitcnt vmcnt(35) lgkmcnt(0)
 s_barrier
 v_mfma_f32_16x16x32_bf16 a[0:3], v[64:67], v[32:35], a[0:3]
 s_mov_b32 s16, s88
 ds_read_b64_tr_b16 v[128:129], v10 offset:49152
 v_mfma_f32_16x16x32_bf16 a[4:7], v[64:67], v[36:39], a[4:7]
 s_add_u32 s36, s35, 640
 s_and_b32 s36, s36, 1023
 s_add_u32 s36, s36, s59
 v_mfma_f32_16x16x32_bf16 a[8:11], v[64:67], v[40:43], a[8:11]
 s_add_u32 m0, s42, 69632
 ds_read_b64_tr_b16 v[130:131], v10 offset:50176
 v_mfma_f32_16x16x32_bf16 a[12:15], v[64:67], v[44:47], a[12:15]
 buffer_load_dwordx4 v2, s[4:7], s36 offen offset:0 lds
 v_mfma_f32_16x16x32_bf16 a[16:19], v[64:67], v[48:51], a[16:19]
 s_mov_b32 s17, s89
 ds_read_b64_tr_b16 v[132:133], v11 offset:49152
 v_mfma_f32_16x16x32_bf16 a[20:23], v[64:67], v[52:55], a[20:23]
 s_mov_b32 s18, 2048
 v_mfma_f32_16x16x32_bf16 a[24:27], v[64:67], v[56:59], a[24:27]
 s_mov_b32 s76, s70
 ds_read_b64_tr_b16 v[134:135], v11 offset:50176
 v_mfma_f32_16x16x32_bf16 a[28:31], v[64:67], v[60:63], a[28:31]
 buffer_load_dwordx4 v3, s[4:7], s36 offen offset:1024 lds
 v_mfma_f32_16x16x32_bf16 a[32:35], v[68:71], v[32:35], a[32:35]
 s_mov_b32 s77, s71
 ds_read_b128 v[96:99], v9 offset:0
 v_mfma_f32_16x16x32_bf16 a[36:39], v[68:71], v[36:39], a[36:39]
 s_mov_b32 s78, 8192
 v_mfma_f32_16x16x32_bf16 a[40:43], v[68:71], v[40:43], a[40:43]
 ds_read_b64_tr_b16 v[136:137], v12 offset:49152
 v_mfma_f32_16x16x32_bf16 a[44:47], v[68:71], v[44:47], a[44:47]
 buffer_load_dwordx4 v4, s[4:7], s36 offen offset:2048 lds
 v_mfma_f32_16x16x32_bf16 a[48:51], v[68:71], v[48:51], a[48:51]
 ds_read_b64_tr_b16 v[138:139], v12 offset:50176
 v_mfma_f32_16x16x32_bf16 a[52:55], v[68:71], v[52:55], a[52:55]
 v_mfma_f32_16x16x32_bf16 a[56:59], v[68:71], v[56:59], a[56:59]
 ds_read_b128 v[100:103], v9 offset:2048
 v_mfma_f32_16x16x32_bf16 a[60:63], v[68:71], v[60:63], a[60:63]
 buffer_load_dwordx4 v5, s[4:7], s36 offen offset:3072 lds
 v_mfma_f32_16x16x32_bf16 a[64:67], v[72:75], v[32:35], a[64:67]
 ds_read_b64_tr_b16 v[140:141], v13 offset:49152
 v_mfma_f32_16x16x32_bf16 a[68:71], v[72:75], v[36:39], a[68:71]
 s_add_u32 s37, s58, 2621440
 s_and_b32 s37, s37, 4194303
 s_add_u32 s37, s37, s39
 v_mfma_f32_16x16x32_bf16 a[72:75], v[72:75], v[40:43], a[72:75]
 s_add_u32 m0, s43, 32768
 ds_read_b64_tr_b16 v[142:143], v13 offset:50176
 v_mfma_f32_16x16x32_bf16 a[76:79], v[72:75], v[44:47], a[76:79]
 buffer_load_dwordx4 v6, s[8:11], s37 offen offset:0 lds
 v_mfma_f32_16x16x32_bf16 a[80:83], v[72:75], v[48:51], a[80:83]
 ds_read_b128 v[104:107], v9 offset:4096
 v_mfma_f32_16x16x32_bf16 a[84:87], v[72:75], v[52:55], a[84:87]
 v_mfma_f32_16x16x32_bf16 a[88:91], v[72:75], v[56:59], a[88:91]
 ds_read_b64_tr_b16 v[144:145], v10 offset:51200
 v_mfma_f32_16x16x32_bf16 a[92:95], v[72:75], v[60:63], a[92:95]
 buffer_load_dwordx4 v7, s[8:11], s37 offen offset:1024 lds
 v_mfma_f32_16x16x32_bf16 a[96:99], v[76:79], v[32:35], a[96:99]
 ds_read_b64_tr_b16 v[146:147], v10 offset:52224
 v_mfma_f32_16x16x32_bf16 a[100:103], v[76:79], v[36:39], a[100:103]
 v_mfma_f32_16x16x32_bf16 a[104:107], v[76:79], v[40:43], a[104:107]
 s_add_u32 m0, s43, 34816
 ds_read_b128 v[108:111], v9 offset:6144
 v_mfma_f32_16x16x32_bf16 a[108:111], v[76:79], v[44:47], a[108:111]
 buffer_load_dwordx4 v6, s[12:15], s37 offen offset:0 lds
 v_mfma_f32_16x16x32_bf16 a[112:115], v[76:79], v[48:51], a[112:115]
 ds_read_b64_tr_b16 v[148:149], v11 offset:51200
 v_mfma_f32_16x16x32_bf16 a[116:119], v[76:79], v[52:55], a[116:119]
 v_mfma_f32_16x16x32_bf16 a[120:123], v[76:79], v[56:59], a[120:123]
 ds_read_b64_tr_b16 v[150:151], v11 offset:52224
 v_mfma_f32_16x16x32_bf16 a[124:127], v[76:79], v[60:63], a[124:127]
 buffer_load_dwordx4 v7, s[12:15], s37 offen offset:1024 lds
 v_mfma_f32_16x16x32_bf16 a[128:131], v[32:35], v[80:83], a[128:131]
 ds_read_b128 v[112:115], v9 offset:8192
 v_mfma_f32_16x16x32_bf16 a[132:135], v[36:39], v[80:83], a[132:135]
 v_mfma_f32_16x16x32_bf16 a[136:139], v[40:43], v[80:83], a[136:139]
 ds_read_b64_tr_b16 v[152:153], v12 offset:51200
 v_mfma_f32_16x16x32_bf16 a[140:143], v[44:47], v[80:83], a[140:143]
 v_mfma_f32_16x16x32_bf16 a[144:147], v[48:51], v[80:83], a[144:147]
 ds_read_b64_tr_b16 v[154:155], v12 offset:52224
 v_mfma_f32_16x16x32_bf16 a[148:151], v[52:55], v[80:83], a[148:151]
 v_mfma_f32_16x16x32_bf16 a[152:155], v[56:59], v[80:83], a[152:155]
 ds_read_b128 v[116:119], v9 offset:10240
 v_mfma_f32_16x16x32_bf16 a[156:159], v[60:63], v[80:83], a[156:159]
 v_mfma_f32_16x16x32_bf16 a[160:163], v[32:35], v[84:87], a[160:163]
 ds_read_b64_tr_b16 v[156:157], v13 offset:51200
 v_mfma_f32_16x16x32_bf16 a[164:167], v[36:39], v[84:87], a[164:167]
 v_mfma_f32_16x16x32_bf16 a[168:171], v[40:43], v[84:87], a[168:171]
 ds_read_b64_tr_b16 v[158:159], v13 offset:52224
 v_mfma_f32_16x16x32_bf16 a[172:175], v[44:47], v[84:87], a[172:175]
 v_mfma_f32_16x16x32_bf16 a[176:179], v[48:51], v[84:87], a[176:179]
 ds_read_b128 v[120:123], v9 offset:12288
 v_mfma_f32_16x16x32_bf16 a[180:183], v[52:55], v[84:87], a[180:183]
 v_mfma_f32_16x16x32_bf16 a[184:187], v[56:59], v[84:87], a[184:187]
 ds_read_b128 v[124:127], v9 offset:14336
 v_mfma_f32_16x16x32_bf16 a[188:191], v[60:63], v[84:87], a[188:191]
 v_mfma_f32_16x16x32_bf16 a[192:195], v[32:35], v[88:91], a[192:195]
 v_mfma_f32_16x16x32_bf16 a[196:199], v[36:39], v[88:91], a[196:199]
 v_mfma_f32_16x16x32_bf16 a[200:203], v[40:43], v[88:91], a[200:203]
 v_mfma_f32_16x16x32_bf16 a[204:207], v[44:47], v[88:91], a[204:207]
 v_mfma_f32_16x16x32_bf16 a[208:211], v[48:51], v[88:91], a[208:211]
 v_mfma_f32_16x16x32_bf16 a[212:215], v[52:55], v[88:91], a[212:215]
 v_mfma_f32_16x16x32_bf16 a[216:219], v[56:59], v[88:91], a[216:219]
 v_mfma_f32_16x16x32_bf16 a[220:223], v[60:63], v[88:91], a[220:223]
 v_mfma_f32_16x16x32_bf16 a[224:227], v[32:35], v[92:95], a[224:227]
 v_mfma_f32_16x16x32_bf16 a[228:231], v[36:39], v[92:95], a[228:231]
 v_mfma_f32_16x16x32_bf16 a[232:235], v[40:43], v[92:95], a[232:235]
 v_mfma_f32_16x16x32_bf16 a[236:239], v[44:47], v[92:95], a[236:239]
 v_mfma_f32_16x16x32_bf16 a[240:243], v[48:51], v[92:95], a[240:243]
 v_mfma_f32_16x16x32_bf16 a[244:247], v[52:55], v[92:95], a[244:247]
 v_mfma_f32_16x16x32_bf16 a[248:251], v[56:59], v[92:95], a[248:251]
 v_mfma_f32_16x16x32_bf16 a[252:255], v[60:63], v[92:95], a[252:255]
 s_waitcnt vmcnt(35) lgkmcnt(0)
 s_barrier
 v_mfma_f32_16x16x32_bf16 a[0:3], v[128:131], v[96:99], a[0:3]
 ds_read_b64_tr_b16 v[64:65], v10 offset:0
 v_mfma_f32_16x16x32_bf16 a[4:7], v[128:131], v[100:103], a[4:7]
 s_add_u32 s36, s35, 768
 s_and_b32 s36, s36, 1023
 s_add_u32 s36, s36, s38
 v_mfma_f32_16x16x32_bf16 a[8:11], v[128:131], v[104:107], a[8:11]
 s_add_u32 m0, s42, 0
 ds_read_b64_tr_b16 v[66:67], v10 offset:1024
 v_mfma_f32_16x16x32_bf16 a[12:15], v[128:131], v[108:111], a[12:15]
 buffer_load_dwordx4 v2, s[4:7], s36 offen offset:0 lds
 v_mfma_f32_16x16x32_bf16 a[16:19], v[128:131], v[112:115], a[16:19]
 ds_read_b64_tr_b16 v[68:69], v11 offset:0
 v_mfma_f32_16x16x32_bf16 a[20:23], v[128:131], v[116:119], a[20:23]
 v_mfma_f32_16x16x32_bf16 a[24:27], v[128:131], v[120:123], a[24:27]
 ds_read_b64_tr_b16 v[70:71], v11 offset:1024
 v_mfma_f32_16x16x32_bf16 a[28:31], v[128:131], v[124:127], a[28:31]
 buffer_load_dwordx4 v3, s[4:7], s36 offen offset:1024 lds
 v_mfma_f32_16x16x32_bf16 a[32:35], v[132:135], v[96:99], a[32:35]
 ds_read_b128 v[32:35], v8 offset:32768
 v_mfma_f32_16x16x32_bf16 a[36:39], v[132:135], v[100:103], a[36:39]
 v_mfma_f32_16x16x32_bf16 a[40:43], v[132:135], v[104:107], a[40:43]
 ds_read_b64_tr_b16 v[72:73], v12 offset:0
 v_mfma_f32_16x16x32_bf16 a[44:47], v[132:135], v[108:111], a[44:47]
 buffer_load_dwordx4 v4, s[4:7], s36 offen offset:2048 lds
 v_mfma_f32_16x16x32_bf16 a[48:51], v[132:135], v[112:115], a[48:51]
 ds_read_b64_tr_b16 v[74:75], v12 offset:1024
 v_mfma_f32_16x16x32_bf16 a[52:55], v[132:135], v[116:119], a[52:55]
 v_mfma_f32_16x16x32_bf16 a[56:59], v[132:135], v[120:123], a[56:59]
 ds_read_b128 v[36:39], v8 offset:34816
 v_mfma_f32_16x16x32_bf16 a[60:63], v[132:135], v[124:127], a[60:63]
 buffer_load_dwordx4 v5, s[4:7], s36 offen offset:3072 lds
 v_mfma_f32_16x16x32_bf16 a[64:67], v[136:139], v[96:99], a[64:67]
 ds_read_b64_tr_b16 v[76:77], v13 offset:0
 v_mfma_f32_16x16x32_bf16 a[68:71], v[136:139], v[100:103], a[68:71]
 s_add_u32 s37, s58, 2883584
 s_and_b32 s37, s37, 4194303
 s_add_u32 s37, s37, s39
 v_mfma_f32_16x16x32_bf16 a[72:75], v[136:139], v[104:107], a[72:75]
 s_add_u32 m0, s43, 49152
 ds_read_b64_tr_b16 v[78:79], v13 offset:1024
 v_mfma_f32_16x16x32_bf16 a[76:79], v[136:139], v[108:111], a[76:79]
 buffer_load_dwordx4 v6, s[8:11], s37 offen offset:0 lds
 v_mfma_f32_16x16x32_bf16 a[80:83], v[136:139], v[112:115], a[80:83]
 ds_read_b128 v[40:43], v8 offset:36864
 v_mfma_f32_16x16x32_bf16 a[84:87], v[136:139], v[116:119], a[84:87]
 v_mfma_f32_16x16x32_bf16 a[88:91], v[136:139], v[120:123], a[88:91]
 ds_read_b64_tr_b16 v[80:81], v10 offset:2048
 v_mfma_f32_16x16x32_bf16 a[92:95], v[136:139], v[124:127], a[92:95]
 buffer_load_dwordx4 v7, s[8:11], s37 offen offset:1024 lds
 v_mfma_f32_16x16x32_bf16 a[96:99], v[140:143], v[96:99], a[96:99]
 ds_read_b64_tr_b16 v[82:83], v10 offset:3072
 v_mfma_f32_16x16x32_bf16 a[100:103], v[140:143], v[100:103], a[100:103]
 v_mfma_f32_16x16x32_bf16 a[104:107], v[140:143], v[104:107], a[104:107]
 s_add_u32 m0, s43, 51200
 ds_read_b128 v[44:47], v8 offset:38912
 v_mfma_f32_16x16x32_bf16 a[108:111], v[140:143], v[108:111], a[108:111]
 buffer_load_dwordx4 v6, s[12:15], s37 offen offset:0 lds
 v_mfma_f32_16x16x32_bf16 a[112:115], v[140:143], v[112:115], a[112:115]
 ds_read_b64_tr_b16 v[84:85], v11 offset:2048
 v_mfma_f32_16x16x32_bf16 a[116:119], v[140:143], v[116:119], a[116:119]
 v_mfma_f32_16x16x32_bf16 a[120:123], v[140:143], v[120:123], a[120:123]
 ds_read_b64_tr_b16 v[86:87], v11 offset:3072
 v_mfma_f32_16x16x32_bf16 a[124:127], v[140:143], v[124:127], a[124:127]
 buffer_load_dwordx4 v7, s[12:15], s37 offen offset:1024 lds
 v_mfma_f32_16x16x32_bf16 a[128:131], v[96:99], v[144:147], a[128:131]
 ds_read_b128 v[48:51], v8 offset:40960
 v_mfma_f32_16x16x32_bf16 a[132:135], v[100:103], v[144:147], a[132:135]
 v_mfma_f32_16x16x32_bf16 a[136:139], v[104:107], v[144:147], a[136:139]
 ds_read_b64_tr_b16 v[88:89], v12 offset:2048
 v_mfma_f32_16x16x32_bf16 a[140:143], v[108:111], v[144:147], a[140:143]
 v_mfma_f32_16x16x32_bf16 a[144:147], v[112:115], v[144:147], a[144:147]
 ds_read_b64_tr_b16 v[90:91], v12 offset:3072
 v_mfma_f32_16x16x32_bf16 a[148:151], v[116:119], v[144:147], a[148:151]
 v_mfma_f32_16x16x32_bf16 a[152:155], v[120:123], v[144:147], a[152:155]
 ds_read_b128 v[52:55], v8 offset:43008
 v_mfma_f32_16x16x32_bf16 a[156:159], v[124:127], v[144:147], a[156:159]
 buffer_load_dwordx4 v[206:209], v233, s[24:27], s40 offen offset:0
 v_mfma_f32_16x16x32_bf16 a[160:163], v[96:99], v[148:151], a[160:163]
 ds_read_b64_tr_b16 v[92:93], v13 offset:2048
 v_mfma_f32_16x16x32_bf16 a[164:167], v[100:103], v[148:151], a[164:167]
 buffer_load_dwordx4 v[210:213], v233, s[24:27], s40 offen offset:1024
 v_mfma_f32_16x16x32_bf16 a[168:171], v[104:107], v[148:151], a[168:171]
 ds_read_b64_tr_b16 v[94:95], v13 offset:3072
 v_mfma_f32_16x16x32_bf16 a[172:175], v[108:111], v[148:151], a[172:175]
 buffer_load_dwordx4 v[214:217], v233, s[24:27], s41 offen offset:0
 v_mfma_f32_16x16x32_bf16 a[176:179], v[112:115], v[148:151], a[176:179]
 ds_read_b128 v[56:59], v8 offset:45056
 v_mfma_f32_16x16x32_bf16 a[180:183], v[116:119], v[148:151], a[180:183]
 buffer_load_dwordx4 v[218:221], v233, s[24:27], s41 offen offset:1024
 v_mfma_f32_16x16x32_bf16 a[184:187], v[120:123], v[148:151], a[184:187]
 ds_read_b128 v[60:63], v8 offset:47104
 v_mfma_f32_16x16x32_bf16 a[188:191], v[124:127], v[148:151], a[188:191]
 buffer_load_dwordx4 v[222:225], v233, s[16:19], 0 offen offset:0
 v_mfma_f32_16x16x32_bf16 a[192:195], v[96:99], v[152:155], a[192:195]
 v_mfma_f32_16x16x32_bf16 a[196:199], v[100:103], v[152:155], a[196:199]
 buffer_load_dwordx4 v[226:229], v233, s[16:19], 0 offen offset:1024
 v_mfma_f32_16x16x32_bf16 a[200:203], v[104:107], v[152:155], a[200:203]
 v_mfma_f32_16x16x32_bf16 a[204:207], v[108:111], v[152:155], a[204:207]
 buffer_load_dwordx4 v[198:201], v232, s[76:79], 0 offen offset:0
 v_mfma_f32_16x16x32_bf16 a[208:211], v[112:115], v[152:155], a[208:211]
 v_mfma_f32_16x16x32_bf16 a[212:215], v[116:119], v[152:155], a[212:215]
 buffer_load_dwordx4 v[202:205], v232, s[76:79], 0 offen offset:16
 v_mfma_f32_16x16x32_bf16 a[216:219], v[120:123], v[152:155], a[216:219]
 v_mfma_f32_16x16x32_bf16 a[220:223], v[124:127], v[152:155], a[220:223]
 buffer_store_dword v241, v241, s[28:31], s55 offen sc1
 v_mfma_f32_16x16x32_bf16 a[224:227], v[96:99], v[156:159], a[224:227]
 v_mfma_f32_16x16x32_bf16 a[228:231], v[100:103], v[156:159], a[228:231]
 buffer_store_dword v241, v241, s[28:31], s56 offen sc1
 v_mfma_f32_16x16x32_bf16 a[232:235], v[104:107], v[156:159], a[232:235]
 v_mfma_f32_16x16x32_bf16 a[236:239], v[108:111], v[156:159], a[236:239]
 buffer_store_dword v241, v241, s[28:31], s57 offen sc1
 v_mfma_f32_16x16x32_bf16 a[240:243], v[112:115], v[156:159], a[240:243]
 v_mfma_f32_16x16x32_bf16 a[244:247], v[116:119], v[156:159], a[244:247]
 buffer_store_dword v241, v241, s[28:31], s3 offen sc1
 v_mfma_f32_16x16x32_bf16 a[248:251], v[120:123], v[156:159], a[248:251]
 v_mfma_f32_16x16x32_bf16 a[252:255], v[124:127], v[156:159], a[252:255]
 s_waitcnt vmcnt(36) lgkmcnt(0)
 s_barrier
 v_mfma_f32_16x16x32_bf16 a[0:3], v[64:67], v[32:35], a[0:3]
 ds_read_b64_tr_b16 v[128:129], v10 offset:16384
 v_mfma_f32_16x16x32_bf16 a[4:7], v[64:67], v[36:39], a[4:7]
 s_add_u32 s36, s35, 768
 s_and_b32 s36, s36, 1023
 s_add_u32 s36, s36, s59
 v_mfma_f32_16x16x32_bf16 a[8:11], v[64:67], v[40:43], a[8:11]
 s_add_u32 m0, s42, 4096
 ds_read_b64_tr_b16 v[130:131], v10 offset:17408
 v_mfma_f32_16x16x32_bf16 a[12:15], v[64:67], v[44:47], a[12:15]
 buffer_load_dwordx4 v2, s[4:7], s36 offen offset:0 lds
 v_mfma_f32_16x16x32_bf16 a[16:19], v[64:67], v[48:51], a[16:19]
 ds_read_b64_tr_b16 v[132:133], v11 offset:16384
 v_mfma_f32_16x16x32_bf16 a[20:23], v[64:67], v[52:55], a[20:23]
 v_mfma_f32_16x16x32_bf16 a[24:27], v[64:67], v[56:59], a[24:27]
 ds_read_b64_tr_b16 v[134:135], v11 offset:17408
 v_mfma_f32_16x16x32_bf16 a[28:31], v[64:67], v[60:63], a[28:31]
 buffer_load_dwordx4 v3, s[4:7], s36 offen offset:1024 lds
 v_mfma_f32_16x16x32_bf16 a[32:35], v[68:71], v[32:35], a[32:35]
 ds_read_b128 v[96:99], v9 offset:32768
 v_mfma_f32_16x16x32_bf16 a[36:39], v[68:71], v[36:39], a[36:39]
 v_mfma_f32_16x16x32_bf16 a[40:43], v[68:71], v[40:43], a[40:43]
 ds_read_b64_tr_b16 v[136:137], v12 offset:16384
 v_mfma_f32_16x16x32_bf16 a[44:47], v[68:71], v[44:47], a[44:47]
 buffer_load_dwordx4 v4, s[4:7], s36 offen offset:2048 lds
 v_mfma_f32_16x16x32_bf16 a[48:51], v[68:71], v[48:51], a[48:51]
 ds_read_b64_tr_b16 v[138:139], v12 offset:17408
 v_mfma_f32_16x16x32_bf16 a[52:55], v[68:71], v[52:55], a[52:55]
 v_mfma_f32_16x16x32_bf16 a[56:59], v[68:71], v[56:59], a[56:59]
 ds_read_b128 v[100:103], v9 offset:34816
 v_mfma_f32_16x16x32_bf16 a[60:63], v[68:71], v[60:63], a[60:63]
 buffer_load_dwordx4 v5, s[4:7], s36 offen offset:3072 lds
 v_mfma_f32_16x16x32_bf16 a[64:67], v[72:75], v[32:35], a[64:67]
 ds_read_b64_tr_b16 v[140:141], v13 offset:16384
 v_mfma_f32_16x16x32_bf16 a[68:71], v[72:75], v[36:39], a[68:71]
 s_add_u32 s37, s58, 3145728
 s_and_b32 s37, s37, 4194303
 s_add_u32 s37, s37, s39
 v_mfma_f32_16x16x32_bf16 a[72:75], v[72:75], v[40:43], a[72:75]
 s_add_u32 m0, s43, 0
 ds_read_b64_tr_b16 v[142:143], v13 offset:17408
 v_mfma_f32_16x16x32_bf16 a[76:79], v[72:75], v[44:47], a[76:79]
 buffer_load_dwordx4 v6, s[8:11], s37 offen offset:0 lds
 v_mfma_f32_16x16x32_bf16 a[80:83], v[72:75], v[48:51], a[80:83]
 ds_read_b128 v[104:107], v9 offset:36864
 v_mfma_f32_16x16x32_bf16 a[84:87], v[72:75], v[52:55], a[84:87]
 v_mfma_f32_16x16x32_bf16 a[88:91], v[72:75], v[56:59], a[88:91]
 ds_read_b64_tr_b16 v[144:145], v10 offset:18432
 v_mfma_f32_16x16x32_bf16 a[92:95], v[72:75], v[60:63], a[92:95]
 buffer_load_dwordx4 v7, s[8:11], s37 offen offset:1024 lds
 v_mfma_f32_16x16x32_bf16 a[96:99], v[76:79], v[32:35], a[96:99]
 ds_read_b64_tr_b16 v[146:147], v10 offset:19456
 v_mfma_f32_16x16x32_bf16 a[100:103], v[76:79], v[36:39], a[100:103]
 v_mfma_f32_16x16x32_bf16 a[104:107], v[76:79], v[40:43], a[104:107]
 s_add_u32 m0, s43, 2048
 ds_read_b128 v[108:111], v9 offset:38912
 v_mfma_f32_16x16x32_bf16 a[108:111], v[76:79], v[44:47], a[108:111]
 buffer_load_dwordx4 v6, s[12:15], s37 offen offset:0 lds
 v_mfma_f32_16x16x32_bf16 a[112:115], v[76:79], v[48:51], a[112:115]
 ds_read_b64_tr_b16 v[148:149], v11 offset:18432
 v_mfma_f32_16x16x32_bf16 a[116:119], v[76:79], v[52:55], a[116:119]
 v_mfma_f32_16x16x32_bf16 a[120:123], v[76:79], v[56:59], a[120:123]
 ds_read_b64_tr_b16 v[150:151], v11 offset:19456
 v_mfma_f32_16x16x32_bf16 a[124:127], v[76:79], v[60:63], a[124:127]
 buffer_load_dwordx4 v7, s[12:15], s37 offen offset:1024 lds
 v_mfma_f32_16x16x32_bf16 a[128:131], v[32:35], v[80:83], a[128:131]
 ds_read_b128 v[112:115], v9 offset:40960
 v_mfma_f32_16x16x32_bf16 a[132:135], v[36:39], v[80:83], a[132:135]
 v_mfma_f32_16x16x32_bf16 a[136:139], v[40:43], v[80:83], a[136:139]
 ds_read_b64_tr_b16 v[152:153], v12 offset:18432
 v_mfma_f32_16x16x32_bf16 a[140:143], v[44:47], v[80:83], a[140:143]
 v_mfma_f32_16x16x32_bf16 a[144:147], v[48:51], v[80:83], a[144:147]
 ds_read_b64_tr_b16 v[154:155], v12 offset:19456
 v_mfma_f32_16x16x32_bf16 a[148:151], v[52:55], v[80:83], a[148:151]
L_pad1:
 s_cbranch_execz L_pad9
 v_mfma_f32_16x16x32_bf16 a[152:155], v[56:59], v[80:83], a[152:155]
 ds_read_b128 v[116:119], v9 offset:43008
 v_mfma_f32_16x16x32_bf16 a[156:159], v[60:63], v[80:83], a[156:159]
 v_mfma_f32_16x16x32_bf16 a[160:163], v[32:35], v[84:87], a[160:163]
 ds_read_b64_tr_b16 v[156:157], v13 offset:18432
 v_mfma_f32_16x16x32_bf16 a[164:167], v[36:39], v[84:87], a[164:167]
 v_mfma_f32_16x16x32_bf16 a[168:171], v[40:43], v[84:87], a[168:171]
 ds_read_b64_tr_b16 v[158:159], v13 offset:19456
 v_mfma_f32_16x16x32_bf16 a[172:175], v[44:47], v[84:87], a[172:175]
 v_mfma_f32_16x16x32_bf16 a[176:179], v[48:51], v[84:87], a[176:179]
 ds_read_b128 v[120:123], v9 offset:45056
 v_mfma_f32_16x16x32_bf16 a[180:183], v[52:55], v[84:87], a[180:183]
 v_mfma_f32_16x16x32_bf16 a[184:187], v[56:59], v[84:87], a[184:187]
 ds_read_b128 v[124:127], v9 offset:47104
 v_mfma_f32_16x16x32_bf16 a[188:191], v[60:63], v[84:87], a[188:191]
 v_mfma_f32_16x16x32_bf16 a[192:195], v[32:35], v[88:91], a[192:195]
 v_mfma_f32_16x16x32_bf16 a[196:199], v[36:39], v[88:91], a[196:199]
 v_mfma_f32_16x16x32_bf16 a[200:203], v[40:43], v[88:91], a[200:203]
 v_mfma_f32_16x16x32_bf16 a[204:207], v[44:47], v[88:91], a[204:207]
 v_mfma_f32_16x16x32_bf16 a[208:211], v[48:51], v[88:91], a[208:211]
 v_mfma_f32_16x16x32_bf16 a[212:215], v[52:55], v[88:91], a[212:215]
 v_mfma_f32_16x16x32_bf16 a[216:219], v[56:59], v[88:91], a[216:219]
 v_mfma_f32_16x16x32_bf16 a[220:223], v[60:63], v[88:91], a[220:223]
 v_mfma_f32_16x16x32_bf16 a[224:227], v[32:35], v[92:95], a[224:227]
 v_mfma_f32_16x16x32_bf16 a[228:231], v[36:39], v[92:95], a[228:231]
 v_mfma_f32_16x16x32_bf16 a[232:235], v[40:43], v[92:95], a[232:235]
 v_mfma_f32_16x16x32_bf16 a[236:239], v[44:47], v[92:95], a[236:239]
 v_mfma_f32_16x16x32_bf16 a[240:243], v[48:51], v[92:95], a[240:243]
 v_mfma_f32_16x16x32_bf16 a[244:247], v[52:55], v[92:95], a[244:247]
 v_mfma_f32_16x16x32_bf16 a[248:251], v[56:59], v[92:95], a[248:251]
 v_mfma_f32_16x16x32_bf16 a[252:255], v[60:63], v[92:95], a[252:255]
 s_waitcnt vmcnt(28) lgkmcnt(0)
 s_barrier
 v_mfma_f32_16x16x32_bf16 a[0:3], v[128:131], v[96:99], a[0:3]
 s_mov_b32 s76, s92
 ds_read_b64_tr_b16 v[64:65], v10 offset:32768
 v_mfma_f32_16x16x32_bf16 a[4:7], v[128:131], v[100:103], a[4:7]
 s_add_u32 s36, s35, 896
 s_and_b32 s36, s36, 1023
 s_add_u32 s36, s36, s38
 v_mfma_f32_16x16x32_bf16 a[8:11], v[128:131], v[104:107], a[8:11]
 s_add_u32 m0, s42, 32768
 ds_read_b64_tr_b16 v[66:67], v10 offset:33792
 v_mfma_f32_16x16x32_bf16 a[12:15], v[128:131], v[108:111], a[12:15]
 buffer_load_dwordx4 v2, s[4:7], s36 offen offset:0 lds
 v_mfma_f32_16x16x32_bf16 a[16:19], v[128:131], v[112:115], a[16:19]
 s_mov_b32 s77, s93
 ds_read_b64_tr_b16 v[68:69], v11 offset:32768
 v_mfma_f32_16x16x32_bf16 a[20:23], v[128:131], v[116:119], a[20:23]
 s_mov_b32 s78, 256
 v_mfma_f32_16x16x32_bf16 a[24:27], v[128:131], v[120:123], a[24:27]
 s_mov_b32 s79, 0x00020000
 ds_read_b64_tr_b16 v[70:71], v11 offset:33792
 v_mfma_f32_16x16x32_bf16 a[28:31], v[128:131], v[124:127], a[28:31]
 buffer_load_dwordx4 v3, s[4:7], s36 offen offset:1024 lds
 v_mfma_f32_16x16x32_bf16 a[32:35], v[132:135], v[96:99], a[32:35]
 s_getreg_b32 s88, hwreg(HW_REG_XCC_ID, 0, 3)
 ds_read_b128 v[32:35], v14 offset:0
 v_mfma_f32_16x16x32_bf16 a[36:39], v[132:135], v[100:103], a[36:39]
 s_lshl_b32 s88, s88, 2
 v_mfma_f32_16x16x32_bf16 a[40:43], v[132:135], v[104:107], a[40:43]
 s_lshl_b32 s88, 1, s88
 ds_read_b64_tr_b16 v[72:73], v12 offset:32768
 v_mfma_f32_16x16x32_bf16 a[44:47], v[132:135], v[108:111], a[44:47]
 buffer_load_dwordx4 v4, s[4:7], s36 offen offset:2048 lds
 v_mfma_f32_16x16x32_bf16 a[48:51], v[132:135], v[112:115], a[48:51]
 ds_read_b64_tr_b16 v[74:75], v12 offset:33792
 v_or_b32 v242, s32, v16
 v_mfma_f32_16x16x32_bf16 a[52:55], v[132:135], v[116:119], a[52:55]
 v_mov_b32 v243, 0x80000000
 v_cmp_eq_u32 vcc, 0, v242
 v_mfma_f32_16x16x32_bf16 a[56:59], v[132:135], v[120:123], a[56:59]
 ds_read_b128 v[36:39], v14 offset:2048
 v_mov_b32 v241, s88
 v_mfma_f32_16x16x32_bf16 a[60:63], v[132:135], v[124:127], a[60:63]
 buffer_load_dwordx4 v5, s[4:7], s36 offen offset:3072 lds
 v_mfma_f32_16x16x32_bf16 a[64:67], v[136:139], v[96:99], a[64:67]
 s_lshl_b32 s88, s33, 3
 ds_read_b64_tr_b16 v[76:77], v13 offset:32768
 v_mfma_f32_16x16x32_bf16 a[68:71], v[136:139], v[100:103], a[68:71]
 s_add_u32 s37, s58, 3407872
 s_and_b32 s37, s37, 4194303
 s_add_u32 s37, s37, s39
 v_mfma_f32_16x16x32_bf16 a[72:75], v[136:139], v[104:107], a[72:75]
 s_add_u32 m0, s43, 16384
 ds_read_b64_tr_b16 v[78:79], v13 offset:33792
 v_cndmask_b32 v242, v243, v242, vcc
 v_mfma_f32_16x16x32_bf16 a[76:79], v[136:139], v[108:111], a[76:79]
 buffer_load_dwordx4 v6, s[8:11], s37 offen offset:0 lds
 v_mfma_f32_16x16x32_bf16 a[80:83], v[136:139], v[112:115], a[80:83]
 ds_read_b128 v[40:43], v14 offset:4096
 v_mfma_f32_16x16x32_bf16 a[84:87], v[136:139], v[116:119], a[84:87]
 v_mfma_f32_16x16x32_bf16 a[88:91], v[136:139], v[120:123], a[88:91]
 ds_read_b64_tr_b16 v[80:81], v10 offset:34816
 v_mfma_f32_16x16x32_bf16 a[92:95], v[136:139], v[124:127], a[92:95]
 buffer_load_dwordx4 v7, s[8:11], s37 offen offset:1024 lds
 v_mfma_f32_16x16x32_bf16 a[96:99], v[140:143], v[96:99], a[96:99]
 ds_read_b64_tr_b16 v[82:83], v10 offset:35840
 v_mfma_f32_16x16x32_bf16 a[100:103], v[140:143], v[100:103], a[100:103]
 v_mfma_f32_16x16x32_bf16 a[104:107], v[140:143], v[104:107], a[104:107]
 s_add_u32 m0, s43, 18432
 ds_read_b128 v[44:47], v14 offset:6144
 v_mfma_f32_16x16x32_bf16 a[108:111], v[140:143], v[108:111], a[108:111]
 buffer_load_dwordx4 v6, s[12:15], s37 offen offset:0 lds
 v_mfma_f32_16x16x32_bf16 a[112:115], v[140:143], v[112:115], a[112:115]
 ds_read_b64_tr_b16 v[84:85], v11 offset:34816
 v_mfma_f32_16x16x32_bf16 a[116:119], v[140:143], v[116:119], a[116:119]
 v_mfma_f32_16x16x32_bf16 a[120:123], v[140:143], v[120:123], a[120:123]
 ds_read_b64_tr_b16 v[86:87], v11 offset:35840
 v_mfma_f32_16x16x32_bf16 a[124:127], v[140:143], v[124:127], a[124:127]
 buffer_load_dwordx4 v7, s[12:15], s37 offen offset:1024 lds
 v_mfma_f32_16x16x32_bf16 a[128:131], v[96:99], v[144:147], a[128:131]
 ds_read_b128 v[48:51], v14 offset:8192
 v_mfma_f32_16x16x32_bf16 a[132:135], v[100:103], v[144:147], a[132:135]
 v_mfma_f32_16x16x32_bf16 a[136:139], v[104:107], v[144:147], a[136:139]
 ds_read_b64_tr_b16 v[88:89], v12 offset:34816
 v_mfma_f32_16x16x32_bf16 a[140:143], v[108:111], v[144:147], a[140:143]
 v_mfma_f32_16x16x32_bf16 a[144:147], v[112:115], v[144:147], a[144:147]
 ds_read_b64_tr_b16 v[90:91], v12 offset:35840
 v_mfma_f32_16x16x32_bf16 a[148:151], v[116:119], v[144:147], a[148:151]
 v_mfma_f32_16x16x32_bf16 a[152:155], v[120:123], v[144:147], a[152:155]
 ds_read_b128 v[52:55], v14 offset:10240
 v_mfma_f32_16x16x32_bf16 a[156:159], v[124:127], v[144:147], a[156:159]
 v_mfma_f32_16x16x32_bf16 a[160:163], v[96:99], v[148:151], a[160:163]
 ds_read_b64_tr_b16 v[92:93], v13 offset:34816
 v_mfma_f32_16x16x32_bf16 a[164:167], v[100:103], v[148:151], a[164:167]
 v_mfma_f32_16x16x32_bf16 a[168:171], v[104:107], v[148:151], a[168:171]
 ds_read_b64_tr_b16 v[94:95], v13 offset:35840
 v_mfma_f32_16x16x32_bf16 a[172:175], v[108:111], v[148:151], a[172:175]
 v_mfma_f32_16x16x32_bf16 a[176:179], v[112:115], v[148:151], a[176:179]
 ds_read_b128 v[56:59], v14 offset:12288
 v_mfma_f32_16x16x32_bf16 a[180:183], v[116:119], v[148:151], a[180:183]
 v_mfma_f32_16x16x32_bf16 a[184:187], v[120:123], v[148:151], a[184:187]
 ds_read_b128 v[60:63], v14 offset:14336
 v_mfma_f32_16x16x32_bf16 a[188:191], v[124:127], v[148:151], a[188:191]
 v_mfma_f32_16x16x32_bf16 a[192:195], v[96:99], v[152:155], a[192:195]
 v_mfma_f32_16x16x32_bf16 a[196:199], v[100:103], v[152:155], a[196:199]
 v_mfma_f32_16x16x32_bf16 a[200:203], v[104:107], v[152:155], a[200:203]
 v_mfma_f32_16x16x32_bf16 a[204:207], v[108:111], v[152:155], a[204:207]
 v_mfma_f32_16x16x32_bf16 a[208:211], v[112:115], v[152:155], a[208:211]
 v_mfma_f32_16x16x32_bf16 a[212:215], v[116:119], v[152:155], a[212:215]
 v_mfma_f32_16x16x32_bf16 a[216:219], v[120:123], v[152:155], a[216:219]
 v_mfma_f32_16x16x32_bf16 a[220:223], v[124:127], v[152:155], a[220:223]
 v_mfma_f32_16x16x32_bf16 a[224:227], v[96:99], v[156:159], a[224:227]
 v_mfma_f32_16x16x32_bf16 a[228:231], v[100:103], v[156:159], a[228:231]
 v_mfma_f32_16x16x32_bf16 a[232:235], v[104:107], v[156:159], a[232:235]
 v_mfma_f32_16x16x32_bf16 a[236:239], v[108:111], v[156:159], a[236:239]
 v_mfma_f32_16x16x32_bf16 a[240:243], v[112:115], v[156:159], a[240:243]
 v_mfma_f32_16x16x32_bf16 a[244:247], v[116:119], v[156:159], a[244:247]
 v_mfma_f32_16x16x32_bf16 a[248:251], v[120:123], v[156:159], a[248:251]
 v_mfma_f32_16x16x32_bf16 a[252:255], v[124:127], v[156:159], a[252:255]
 s_waitcnt vmcnt(16) lgkmcnt(0)
 s_barrier
 v_mfma_f32_16x16x32_bf16 a[0:3], v[64:67], v[32:35], a[0:3]
 ds_read_b64_tr_b16 v[128:129], v10 offset:49152
 v_lshlrev_b32 v240, 16, v222
 v_mfma_f32_16x16x32_bf16 a[4:7], v[64:67], v[36:39], a[4:7]
 s_add_u32 s36, s35, 896
 s_and_b32 s36, s36, 1023
 s_add_u32 s36, s36, s59
 v_lshlrev_b32 v238, 16, v206
 v_lshlrev_b32 v239, 16, v214
 v_mfma_f32_16x16x32_bf16 a[8:11], v[64:67], v[40:43], a[8:11]
 s_add_u32 m0, s42, 36864
 ds_read_b64_tr_b16 v[130:131], v10 offset:50176
 v_mul_f32 v236, v238, v240
 v_mfma_f32_16x16x32_bf16 a[12:15], v[64:67], v[44:47], a[12:15]
 buffer_load_dwordx4 v2, s[4:7], s36 offen offset:0 lds
 v_mfma_f32_16x16x32_bf16 a[16:19], v[64:67], v[48:51], a[16:19]
 ds_read_b64_tr_b16 v[132:133], v11 offset:49152
 v_mul_f32 v237, v239, v240
 v_mfma_f32_16x16x32_bf16 a[20:23], v[64:67], v[52:55], a[20:23]
 v_and_b32 v240, s52, v222
 v_and_b32 v238, s52, v206
 v_mfma_f32_16x16x32_bf16 a[24:27], v[64:67], v[56:59], a[24:27]
 ds_read_b64_tr_b16 v[134:135], v11 offset:50176
 v_and_b32 v239, s52, v214
 v_mfma_f32_16x16x32_bf16 a[28:31], v[64:67], v[60:63], a[28:31]
 buffer_load_dwordx4 v3, s[4:7], s36 offen offset:1024 lds
 v_mfma_f32_16x16x32_bf16 a[32:35], v[68:71], v[32:35], a[32:35]
 ds_read_b128 v[96:99], v15 offset:0
 v_fmac_f32 v236, v238, v240
 v_mfma_f32_16x16x32_bf16 a[36:39], v[68:71], v[36:39], a[36:39]
 v_fmac_f32 v237, v239, v240
 v_lshlrev_b32 v240, 16, v223
 v_mfma_f32_16x16x32_bf16 a[40:43], v[68:71], v[40:43], a[40:43]
 ds_read_b64_tr_b16 v[136:137], v12 offset:49152
 v_lshlrev_b32 v238, 16, v207
 v_mfma_f32_16x16x32_bf16 a[44:47], v[68:71], v[44:47], a[44:47]
 buffer_load_dwordx4 v4, s[4:7], s36 offen offset:2048 lds
 v_mfma_f32_16x16x32_bf16 a[48:51], v[68:71], v[48:51], a[48:51]
 ds_read_b64_tr_b16 v[138:139], v12 offset:50176
 v_lshlrev_b32 v239, 16, v215
 v_mfma_f32_16x16x32_bf16 a[52:55], v[68:71], v[52:55], a[52:55]
 v_fmac_f32 v236, v238, v240
 v_fmac_f32 v237, v239, v240
 v_mfma_f32_16x16x32_bf16 a[56:59], v[68:71], v[56:59], a[56:59]
 ds_read_b128 v[100:103], v15 offset:2048
 v_and_b32 v240, s52, v223
 v_mfma_f32_16x16x32_bf16 a[60:63], v[68:71], v[60:63], a[60:63]
 buffer_load_dwordx4 v5, s[4:7], s36 offen offset:3072 lds
 v_mfma_f32_16x16x32_bf16 a[64:67], v[72:75], v[32:35], a[64:67]
 ds_read_b64_tr_b16 v[140:141], v13 offset:49152
 v_and_b32 v238, s52, v207
 v_mfma_f32_16x16x32_bf16 a[68:71], v[72:75], v[36:39], a[68:71]
 s_add_u32 s37, s58, 3670016
 s_and_b32 s37, s37, 4194303
 s_add_u32 s37, s37, s39
 v_and_b32 v239, s52, v215
 v_fmac_f32 v236, v238, v240
 v_mfma_f32_16x16x32_bf16 a[72:75], v[72:75], v[40:43], a[72:75]
 s_add_u32 m0, s43, 32768
 ds_read_b64_tr_b16 v[142:143], v13 offset:50176
 v_fmac_f32 v237, v239, v240
 v_mfma_f32_16x16x32_bf16 a[76:79], v[72:75], v[44:47], a[76:79]
 buffer_load_dwordx4 v6, s[8:11], s37 offen offset:0 lds
 v_mfma_f32_16x16x32_bf16 a[80:83], v[72:75], v[48:51], a[80:83]
 ds_read_b128 v[104:107], v15 offset:4096
 v_lshlrev_b32 v240, 16, v224
 v_mfma_f32_16x16x32_bf16 a[84:87], v[72:75], v[52:55], a[84:87]
 v_lshlrev_b32 v238, 16, v208
 v_lshlrev_b32 v239, 16, v216
 v_mfma_f32_16x16x32_bf16 a[88:91], v[72:75], v[56:59], a[88:91]
 ds_read_b64_tr_b16 v[144:145], v10 offset:51200
 v_fmac_f32 v236, v238, v240
 v_mfma_f32_16x16x32_bf16 a[92:95], v[72:75], v[60:63], a[92:95]
 buffer_load_dwordx4 v7, s[8:11], s37 offen offset:1024 lds
 v_mfma_f32_16x16x32_bf16 a[96:99], v[76:79], v[32:35], a[96:99]
 ds_read_b64_tr_b16 v[146:147], v10 offset:52224
 v_fmac_f32 v237, v239, v240
 v_mfma_f32_16x16x32_bf16 a[100:103], v[76:79], v[36:39], a[100:103]
 v_and_b32 v240, s52, v224
 v_and_b32 v238, s52, v208
 v_mfma_f32_16x16x32_bf16 a[104:107], v[76:79], v[40:43], a[104:107]
 s_add_u32 m0, s43, 34816
 ds_read_b128 v[108:111], v15 offset:6144
 v_and_b32 v239, s52, v216
 v_mfma_f32_16x16x32_bf16 a[108:111], v[76:79], v[44:47], a[108:111]
 buffer_load_dwordx4 v6, s[12:15], s37 offen offset:0 lds
 v_mfma_f32_16x16x32_bf16 a[112:115], v[76:79], v[48:51], a[112:115]
 ds_read_b64_tr_b16 v[148:149], v11 offset:51200
 v_fmac_f32 v236, v238, v240
 v_mfma_f32_16x16x32_bf16 a[116:119], v[76:79], v[52:55], a[116:119]
 v_fmac_f32 v237, v239, v240
 v_lshlrev_b32 v240, 16, v225
 v_mfma_f32_16x16x32_bf16 a[120:123], v[76:79], v[56:59], a[120:123]
 ds_read_b64_tr_b16 v[150:151], v11 offset:52224
 v_lshlrev_b32 v238, 16, v209
 v_mfma_f32_16x16x32_bf16 a[124:127], v[76:79], v[60:63], a[124:127]
 buffer_load_dwordx4 v7, s[12:15], s37 offen offset:1024 lds
 v_mfma_f32_16x16x32_bf16 a[128:131], v[32:35], v[80:83], a[128:131]
 ds_read_b128 v[112:115], v15 offset:8192
 v_lshlrev_b32 v239, 16, v217
 v_mfma_f32_16x16x32_bf16 a[132:135], v[36:39], v[80:83], a[132:135]
 buffer_load_dword v31, v254, s[20:23], s46 offen
 v_mfma_f32_16x16x32_bf16 a[136:139], v[40:43], v[80:83], a[136:139]
 s_add_u32 s46, s46, 4194304
 ds_read_b64_tr_b16 v[152:153], v12 offset:51200
 v_fmac_f32 v236, v238, v240
 v_mfma_f32_16x16x32_bf16 a[140:143], v[44:47], v[80:83], a[140:143]
 buffer_atomic_add v241, v242, s[76:79], s88 offen sc1
 v_mfma_f32_16x16x32_bf16 a[144:147], v[48:51], v[80:83], a[144:147]
 ds_read_b64_tr_b16 v[154:155], v12 offset:52224
 v_fmac_f32 v237, v239, v240
 v_mfma_f32_16x16x32_bf16 a[148:151], v[52:55], v[80:83], a[148:151]
 buffer_load_dword v31, v254, s[20:23], s46 offen
 v_mfma_f32_16x16x32_bf16 a[152:155], v[56:59], v[80:83], a[152:155]
 ds_read_b128 v[116:119], v15 offset:10240
 v_and_b32 v240, s52, v225
 v_mfma_f32_16x16x32_bf16 a[156:159], v[60:63], v[80:83], a[156:159]
 v_mfma_f32_16x16x32_bf16 a[160:163], v[32:35], v[84:87], a[160:163]
 ds_read_b64_tr_b16 v[156:157], v13 offset:51200
 v_and_b32 v238, s52, v209
 v_mfma_f32_16x16x32_bf16 a[164:167], v[36:39], v[84:87], a[164:167]
 v_and_b32 v239, s52, v217
 v_fmac_f32 v236, v238, v240
 v_mfma_f32_16x16x32_bf16 a[168:171], v[40:43], v[84:87], a[168:171]
 ds_read_b64_tr_b16 v[158:159], v13 offset:52224
 v_fmac_f32 v237, v239, v240
 v_mfma_f32_16x16x32_bf16 a[172:175], v[44:47], v[84:87], a[172:175]
 v_mfma_f32_16x16x32_bf16 a[176:179], v[48:51], v[84:87], a[176:179]
 ds_read_b128 v[120:123], v15 offset:12288
 v_lshlrev_b32 v240, 16, v226
 v_mfma_f32_16x16x32_bf16 a[180:183], v[52:55], v[84:87], a[180:183]
 v_lshlrev_b32 v238, 16, v210
 v_lshlrev_b32 v239, 16, v218
 v_mfma_f32_16x16x32_bf16 a[184:187], v[56:59], v[84:87], a[184:187]
 ds_read_b128 v[124:127], v15 offset:14336
 v_fmac_f32 v236, v238, v240
 v_mfma_f32_16x16x32_bf16 a[188:191], v[60:63], v[84:87], a[188:191]
 v_mfma_f32_16x16x32_bf16 a[192:195], v[32:35], v[88:91], a[192:195]
 v_fmac_f32 v237, v239, v240
 v_and_b32 v240, s52, v226
 v_mfma_f32_16x16x32_bf16 a[196:199], v[36:39], v[88:91], a[196:199]
 v_and_b32 v238, s52, v210
 v_and_b32 v239, s52, v218
 v_mfma_f32_16x16x32_bf16 a[200:203], v[40:43], v[88:91], a[200:203]
 v_fmac_f32 v236, v238, v240
 v_fmac_f32 v237, v239, v240
 v_mfma_f32_16x16x32_bf16 a[204:207], v[44:47], v[88:91], a[204:207]
 v_mfma_f32_16x16x32_bf16 a[208:211], v[48:51], v[88:91], a[208:211]
 v_lshlrev_b32 v240, 16, v227
 v_lshlrev_b32 v238, 16, v211
 v_mfma_f32_16x16x32_bf16 a[212:215], v[52:55], v[88:91], a[212:215]
 v_lshlrev_b32 v239, 16, v219
 v_fmac_f32 v236, v238, v240
 v_mfma_f32_16x16x32_bf16 a[216:219], v[56:59], v[88:91], a[216:219]
 v_fmac_f32 v237, v239, v240
 v_and_b32 v240, s52, v227
 v_mfma_f32_16x16x32_bf16 a[220:223], v[60:63], v[88:91], a[220:223]
 v_mfma_f32_16x16x32_bf16 a[224:227], v[32:35], v[92:95], a[224:227]
 v_and_b32 v238, s52, v211
 v_and_b32 v239, s52, v219
 v_mfma_f32_16x16x32_bf16 a[228:231], v[36:39], v[92:95], a[228:231]
 v_fmac_f32 v236, v238, v240
 v_fmac_f32 v237, v239, v240
 v_mfma_f32_16x16x32_bf16 a[232:235], v[40:43], v[92:95], a[232:235]
 v_lshlrev_b32 v240, 16, v228
 v_lshlrev_b32 v238, 16, v212
 v_mfma_f32_16x16x32_bf16 a[236:239], v[44:47], v[92:95], a[236:239]
 v_mfma_f32_16x16x32_bf16 a[240:243], v[48:51], v[92:95], a[240:243]
 v_lshlrev_b32 v239, 16, v220
 v_fmac_f32 v236, v238, v240
 v_mfma_f32_16x16x32_bf16 a[244:247], v[52:55], v[92:95], a[244:247]
 v_fmac_f32 v237, v239, v240
 v_and_b32 v240, s52, v228
 v_mfma_f32_16x16x32_bf16 a[248:251], v[56:59], v[92:95], a[248:251]
 v_and_b32 v238, s52, v212
 v_and_b32 v239, s52, v220
 v_mfma_f32_16x16x32_bf16 a[252:255], v[60:63], v[92:95], a[252:255]
 s_waitcnt vmcnt(19) lgkmcnt(0)
 s_barrier
 v_fmac_f32 v236, v238, v240
 v_fmac_f32 v237, v239, v240
 v_mfma_f32_16x16x32_bf16 a[0:3], v[128:131], v[96:99], a[0:3]
 s_mov_b32 s4, s86
 ds_read_b64_tr_b16 v[64:65], v10 offset:0
 v_lshlrev_b32 v240, 16, v229
 v_mfma_f32_16x16x32_bf16 a[4:7], v[128:131], v[100:103], a[4:7]
 s_add_u32 s36, s44, 0
 v_lshlrev_b32 v238, 16, v213
 v_lshlrev_b32 v239, 16, v221
 v_mfma_f32_16x16x32_bf16 a[8:11], v[128:131], v[104:107], a[8:11]
 s_add_u32 m0, s42, 65536
 ds_read_b64_tr_b16 v[66:67], v10 offset:1024
 v_fmac_f32 v236, v238, v240
 v_mfma_f32_16x16x32_bf16 a[12:15], v[128:131], v[108:111], a[12:15]
 buffer_load_dwordx4 v17, s[24:27], s36 offen offset:0 lds
 v_mfma_f32_16x16x32_bf16 a[16:19], v[128:131], v[112:115], a[16:19]
 s_mov_b32 s5, s87
 ds_read_b64_tr_b16 v[68:69], v11 offset:0
 v_fmac_f32 v237, v239, v240
 v_mfma_f32_16x16x32_bf16 a[20:23], v[128:131], v[116:119], a[20:23]
 s_mov_b32 s6, 8388608
 v_and_b32 v240, s52, v229
 v_and_b32 v238, s52, v213
 v_mfma_f32_16x16x32_bf16 a[24:27], v[128:131], v[120:123], a[24:27]
 s_lshl_b32 s89, s2, 2
 ds_read_b64_tr_b16 v[70:71], v11 offset:1024
 v_and_b32 v239, s52, v221
 v_mfma_f32_16x16x32_bf16 a[28:31], v[128:131], v[124:127], a[28:31]
 buffer_load_dwordx4 v18, s[24:27], s36 offen offset:1024 lds
 v_mfma_f32_16x16x32_bf16 a[32:35], v[132:135], v[96:99], a[32:35]
 s_add_u32 s89, s89, s32
 ds_read_b128 v[32:35], v8 offset:0
 v_fmac_f32 v236, v238, v240
 v_mfma_f32_16x16x32_bf16 a[36:39], v[132:135], v[100:103], a[36:39]
 s_lshr_b32 s35, s89, 7
 v_fmac_f32 v237, v239, v240
 v_mfma_f32_16x16x32_bf16 a[40:43], v[132:135], v[104:107], a[40:43]
 s_and_b32 s89, s89, 127
 ds_read_b64_tr_b16 v[72:73], v12 offset:0
 v_mfma_f32_16x16x32_bf16 a[44:47], v[132:135], v[108:111], a[44:47]
 buffer_load_dwordx4 v19, s[24:27], s36 offen offset:2048 lds
 v_mfma_f32_16x16x32_bf16 a[48:51], v[132:135], v[112:115], a[48:51]
 s_mul_i32 s89, s89, 2048
 ds_read_b64_tr_b16 v[74:75], v12 offset:1024
 v_add_f32_dpp v236, v236, v236 quad_perm:[1,0,3,2] row_mask:0xf bank_mask:0xf
 v_mfma_f32_16x16x32_bf16 a[52:55], v[132:135], v[116:119], a[52:55]
 s_sub_u32 s35, s35, 4
 s_cselect_b32 s35, 0x400, s35
 v_add_f32_dpp v237, v237, v237 quad_perm:[1,0,3,2] row_mask:0xf bank_mask:0xf
 v_mfma_f32_16x16x32_bf16 a[56:59], v[132:135], v[120:123], a[56:59]
 s_lshl_b32 s35, s35, 21
 ds_read_b128 v[36:39], v8 offset:2048
 v_mfma_f32_16x16x32_bf16 a[60:63], v[132:135], v[124:127], a[60:63]
 buffer_load_dwordx4 v20, s[24:27], s36 offen offset:3072 lds
 v_mfma_f32_16x16x32_bf16 a[64:67], v[136:139], v[96:99], a[64:67]
 s_add_u32 s89, s89, s35
 ds_read_b64_tr_b16 v[76:77], v13 offset:0
 v_add_f32_dpp v236, v236, v236 quad_perm:[2,3,0,1] row_mask:0xf bank_mask:0xf
 v_mfma_f32_16x16x32_bf16 a[68:71], v[136:139], v[100:103], a[68:71]
 s_add_u32 s37, s58, 3932160
 s_and_b32 s37, s37, 4194303
 s_add_u32 s37, s37, s39
 v_add_f32_dpp v237, v237, v237 quad_perm:[2,3,0,1] row_mask:0xf bank_mask:0xf
 v_mfma_f32_16x16x32_bf16 a[72:75], v[136:139], v[104:107], a[72:75]
 s_add_u32 m0, s43, 49152
 ds_read_b64_tr_b16 v[78:79], v13 offset:1024
 v_mfma_f32_16x16x32_bf16 a[76:79], v[136:139], v[108:111], a[76:79]
 buffer_load_dwordx4 v6, s[8:11], s37 offen offset:0 lds
 v_mfma_f32_16x16x32_bf16 a[80:83], v[136:139], v[112:115], a[80:83]
 s_add_u32 s89, s89, 393216
 ds_read_b128 v[40:43], v8 offset:4096
 v_add_f32_dpp v236, v236, v236 row_half_mirror row_mask:0xf bank_mask:0xf
 v_mfma_f32_16x16x32_bf16 a[84:87], v[136:139], v[116:119], a[84:87]
 v_add_f32_dpp v237, v237, v237 row_half_mirror row_mask:0xf bank_mask:0xf
 v_mfma_f32_16x16x32_bf16 a[88:91], v[136:139], v[120:123], a[88:91]
 ds_read_b64_tr_b16 v[80:81], v10 offset:2048
 v_mfma_f32_16x16x32_bf16 a[92:95], v[136:139], v[124:127], a[92:95]
 buffer_load_dwordx4 v7, s[8:11], s37 offen offset:1024 lds
 v_mfma_f32_16x16x32_bf16 a[96:99], v[140:143], v[96:99], a[96:99]
 ds_read_b64_tr_b16 v[82:83], v10 offset:3072
 v_add_f32_dpp v236, v236, v236 row_mirror row_mask:0xf bank_mask:0xf
 v_mfma_f32_16x16x32_bf16 a[100:103], v[140:143], v[100:103], a[100:103]
 v_add_f32_dpp v237, v237, v237 row_mirror row_mask:0xf bank_mask:0xf
 v_mov_b32 v238, v236
 v_mfma_f32_16x16x32_bf16 a[104:107], v[140:143], v[104:107], a[104:107]
 s_add_u32 m0, s43, 51200
 ds_read_b128 v[44:47], v8 offset:6144
 v_mov_b32 v239, v237
 v_mfma_f32_16x16x32_bf16 a[108:111], v[140:143], v[108:111], a[108:111]
 buffer_load_dwordx4 v6, s[12:15], s37 offen offset:0 lds
 v_mfma_f32_16x16x32_bf16 a[112:115], v[140:143], v[112:115], a[112:115]
 ds_read_b64_tr_b16 v[84:85], v11 offset:2048
 v_permlane16_swap_b32 v236, v238
 v_mfma_f32_16x16x32_bf16 a[116:119], v[140:143], v[116:119], a[116:119]
 v_permlane16_swap_b32 v237, v239
 v_mfma_f32_16x16x32_bf16 a[120:123], v[140:143], v[120:123], a[120:123]
 ds_read_b64_tr_b16 v[86:87], v11 offset:3072
 v_add_f32 v236, v236, v238
 v_mfma_f32_16x16x32_bf16 a[124:127], v[140:143], v[124:127], a[124:127]
 buffer_load_dwordx4 v7, s[12:15], s37 offen offset:1024 lds
 v_mfma_f32_16x16x32_bf16 a[128:131], v[96:99], v[144:147], a[128:131]
 ds_read_b128 v[48:51], v8 offset:8192
 v_add_f32 v237, v237, v239
 v_mfma_f32_16x16x32_bf16 a[132:135], v[100:103], v[144:147], a[132:135]
 v_mov_b32 v238, v236
 v_mov_b32 v239, v237
 v_mfma_f32_16x16x32_bf16 a[136:139], v[104:107], v[144:147], a[136:139]
 ds_read_b64_tr_b16 v[88:89], v12 offset:2048
 v_mfma_f32_16x16x32_bf16 a[140:143], v[108:111], v[144:147], a[140:143]
 v_mfma_f32_16x16x32_bf16 a[144:147], v[112:115], v[144:147], a[144:147]
 ds_read_b64_tr_b16 v[90:91], v12 offset:3072
 v_permlane32_swap_b32 v236, v238
 v_mfma_f32_16x16x32_bf16 a[148:151], v[116:119], v[144:147], a[148:151]
 v_permlane32_swap_b32 v237, v239
 v_mfma_f32_16x16x32_bf16 a[152:155], v[120:123], v[144:147], a[152:155]
 ds_read_b128 v[52:55], v8 offset:10240
 v_add_f32 v236, v236, v238
 v_mfma_f32_16x16x32_bf16 a[156:159], v[124:127], v[144:147], a[156:159]
 v_mfma_f32_16x16x32_bf16 a[160:163], v[96:99], v[148:151], a[160:163]
 ds_read_b64_tr_b16 v[92:93], v13 offset:2048
 v_add_f32 v237, v237, v239
 v_mfma_f32_16x16x32_bf16 a[164:167], v[100:103], v[148:151], a[164:167]
 v_mul_f32 v236, 0xbfb8aa3b, v236
 v_mul_f32 v237, 0xbfb8aa3b, v237
 v_mfma_f32_16x16x32_bf16 a[168:171], v[104:107], v[148:151], a[168:171]
 ds_read_b64_tr_b16 v[94:95], v13 offset:3072
 v_exp_f32 v236, v236
 v_mfma_f32_16x16x32_bf16 a[172:175], v[108:111], v[148:151], a[172:175]
 v_mfma_f32_16x16x32_bf16 a[176:179], v[112:115], v[148:151], a[176:179]
 ds_read_b128 v[56:59], v8 offset:12288
 v_exp_f32 v237, v237
 v_mfma_f32_16x16x32_bf16 a[180:183], v[116:119], v[148:151], a[180:183]
 v_mov_b32 v238, 0
 v_add_f32 v236, 1.0, v236
 v_mfma_f32_16x16x32_bf16 a[184:187], v[120:123], v[148:151], a[184:187]
 ds_read_b128 v[60:63], v8 offset:14336
 v_add_f32 v237, 1.0, v237
 v_mfma_f32_16x16x32_bf16 a[188:191], v[124:127], v[148:151], a[188:191]
 v_mfma_f32_16x16x32_bf16 a[192:195], v[96:99], v[152:155], a[192:195]
 v_lshlrev_b32 v254, 3, v16
 v_rcp_f32 v236, v236
 v_mfma_f32_16x16x32_bf16 a[196:199], v[100:103], v[152:155], a[196:199]
 v_rcp_f32 v237, v237
 v_mfma_f32_16x16x32_bf16 a[200:203], v[104:107], v[152:155], a[200:203]
 v_min_u32 v254, 1920, v254
 v_mfma_f32_16x16x32_bf16 a[204:207], v[108:111], v[152:155], a[204:207]
 v_mfma_f32_16x16x32_bf16 a[208:211], v[112:115], v[152:155], a[208:211]
 s_add_u32 s16, s94, 59768832
 s_addc_u32 s17, s95, 0
 v_mfma_f32_16x16x32_bf16 a[212:215], v[116:119], v[152:155], a[212:215]
 s_mov_b32 s18, 8192
 v_mfma_f32_16x16x32_bf16 a[216:219], v[120:123], v[152:155], a[216:219]
 s_lshr_b32 s40, s40, 9
 v_mfma_f32_16x16x32_bf16 a[220:223], v[124:127], v[152:155], a[220:223]
 buffer_load_dword v31, v254, s[4:7], s89 offen
 v_mfma_f32_16x16x32_bf16 a[224:227], v[96:99], v[156:159], a[224:227]
 s_lshr_b32 s41, s41, 9
 v_mfma_f32_16x16x32_bf16 a[228:231], v[100:103], v[156:159], a[228:231]
 v_mfma_f32_16x16x32_bf16 a[232:235], v[104:107], v[156:159], a[232:235]
 v_mfma_f32_16x16x32_bf16 a[236:239], v[108:111], v[156:159], a[236:239]
 buffer_store_dword v236, v238, s[16:19], s40 offen sc1
 v_mfma_f32_16x16x32_bf16 a[240:243], v[112:115], v[156:159], a[240:243]
 v_mfma_f32_16x16x32_bf16 a[244:247], v[116:119], v[156:159], a[244:247]
 v_mfma_f32_16x16x32_bf16 a[248:251], v[120:123], v[156:159], a[248:251]
 v_mfma_f32_16x16x32_bf16 a[252:255], v[124:127], v[156:159], a[252:255]
 s_waitcnt vmcnt(21) lgkmcnt(0)
 s_barrier
 v_mfma_f32_16x16x32_bf16 a[0:3], v[64:67], v[32:35], a[0:3]
 ds_read_b64_tr_b16 v[128:129], v10 offset:16384
 v_lshlrev_b32 v206, 16, v160
 v_mfma_f32_16x16x32_bf16 a[4:7], v[64:67], v[36:39], a[4:7]
 s_add_u32 s36, s45, 0
 v_lshlrev_b32 v207, 16, v162
 v_lshlrev_b32 v208, 16, v164
 v_mfma_f32_16x16x32_bf16 a[8:11], v[64:67], v[40:43], a[8:11]
 s_add_u32 m0, s42, 69632
 ds_read_b64_tr_b16 v[130:131], v10 offset:17408
 v_lshlrev_b32 v209, 16, v166
 v_mfma_f32_16x16x32_bf16 a[12:15], v[64:67], v[44:47], a[12:15]
 buffer_load_dwordx4 v17, s[24:27], s36 offen offset:0 lds
 v_mfma_f32_16x16x32_bf16 a[16:19], v[64:67], v[48:51], a[16:19]
 ds_read_b64_tr_b16 v[132:133], v11 offset:16384
 v_lshlrev_b32 v210, 16, v168
 v_mfma_f32_16x16x32_bf16 a[20:23], v[64:67], v[52:55], a[20:23]
 v_lshlrev_b32 v211, 16, v170
 v_lshlrev_b32 v212, 16, v172
 v_mfma_f32_16x16x32_bf16 a[24:27], v[64:67], v[56:59], a[24:27]
 ds_read_b64_tr_b16 v[134:135], v11 offset:17408
 v_lshlrev_b32 v213, 16, v174
 v_mfma_f32_16x16x32_bf16 a[28:31], v[64:67], v[60:63], a[28:31]
 buffer_load_dwordx4 v18, s[24:27], s36 offen offset:1024 lds
 v_mfma_f32_16x16x32_bf16 a[32:35], v[68:71], v[32:35], a[32:35]
 ds_read_b128 v[96:99], v9 offset:0
 v_lshlrev_b32 v214, 16, v176
 v_mfma_f32_16x16x32_bf16 a[36:39], v[68:71], v[36:39], a[36:39]
 v_lshlrev_b32 v215, 16, v178
 v_lshlrev_b32 v216, 16, v180
 v_mfma_f32_16x16x32_bf16 a[40:43], v[68:71], v[40:43], a[40:43]
 ds_read_b64_tr_b16 v[136:137], v12 offset:16384
 v_lshlrev_b32 v217, 16, v198
 v_mfma_f32_16x16x32_bf16 a[44:47], v[68:71], v[44:47], a[44:47]
 buffer_load_dwordx4 v19, s[24:27], s36 offen offset:2048 lds
 v_mfma_f32_16x16x32_bf16 a[48:51], v[68:71], v[48:51], a[48:51]
 ds_read_b64_tr_b16 v[138:139], v12 offset:17408
 v_and_b32 v218, s52, v198
 v_mfma_f32_16x16x32_bf16 a[52:55], v[68:71], v[52:55], a[52:55]
 v_lshlrev_b32 v219, 16, v199
 v_and_b32 v220, s52, v199
 v_mfma_f32_16x16x32_bf16 a[56:59], v[68:71], v[56:59], a[56:59]
 ds_read_b128 v[100:103], v9 offset:2048
 v_mul_f32 v221, v209, v217
 v_mfma_f32_16x16x32_bf16 a[60:63], v[68:71], v[60:63], a[60:63]
 buffer_load_dwordx4 v20, s[24:27], s36 offen offset:3072 lds
 v_mfma_f32_16x16x32_bf16 a[64:67], v[72:75], v[32:35], a[64:67]
 ds_read_b64_tr_b16 v[140:141], v13 offset:16384
 v_mul_f32 v222, v210, v217
 v_mfma_f32_16x16x32_bf16 a[68:71], v[72:75], v[36:39], a[68:71]
 s_add_u32 s37, s49, 0
 v_mul_f32 v223, v211, v217
 v_mul_f32 v224, v212, v217
 v_mfma_f32_16x16x32_bf16 a[72:75], v[72:75], v[40:43], a[72:75]
 s_add_u32 m0, s50, 0
 ds_read_b64_tr_b16 v[142:143], v13 offset:17408
 v_mul_f32 v225, v213, v217
 v_mfma_f32_16x16x32_bf16 a[76:79], v[72:75], v[44:47], a[76:79]
 buffer_load_dwordx4 v21, s[20:23], s37 offen offset:0 lds
 v_mfma_f32_16x16x32_bf16 a[80:83], v[72:75], v[48:51], a[80:83]
 ds_read_b128 v[104:107], v9 offset:4096
 v_mul_f32 v226, v214, v217
 v_mfma_f32_16x16x32_bf16 a[84:87], v[72:75], v[52:55], a[84:87]
 v_mul_f32 v227, v215, v217
 v_mul_f32 v228, v216, v217
 v_mfma_f32_16x16x32_bf16 a[88:91], v[72:75], v[56:59], a[88:91]
 ds_read_b64_tr_b16 v[144:145], v10 offset:18432
 v_fmac_f32 v221, v208, v218
 v_mfma_f32_16x16x32_bf16 a[92:95], v[72:75], v[60:63], a[92:95]
 buffer_load_dwordx4 v22, s[20:23], s37 offen offset:1024 lds
 v_mfma_f32_16x16x32_bf16 a[96:99], v[76:79], v[32:35], a[96:99]
 ds_read_b64_tr_b16 v[146:147], v10 offset:19456
 v_fmac_f32 v222, v209, v218
 v_mfma_f32_16x16x32_bf16 a[100:103], v[76:79], v[36:39], a[100:103]
 v_fmac_f32 v223, v210, v218
 v_fmac_f32 v224, v211, v218
 v_mfma_f32_16x16x32_bf16 a[104:107], v[76:79], v[40:43], a[104:107]
 ds_read_b128 v[108:111], v9 offset:6144
 v_fmac_f32 v225, v212, v218
 v_mfma_f32_16x16x32_bf16 a[108:111], v[76:79], v[44:47], a[108:111]
 buffer_store_dword v237, v238, s[16:19], s41 offen sc1
 v_mfma_f32_16x16x32_bf16 a[112:115], v[76:79], v[48:51], a[112:115]
 s_add_u32 s16, s94, 50331648
 s_addc_u32 s17, s95, 0
 ds_read_b64_tr_b16 v[148:149], v11 offset:18432
 v_fmac_f32 v226, v213, v218
 v_mfma_f32_16x16x32_bf16 a[116:119], v[76:79], v[52:55], a[116:119]
 s_mov_b32 s18, 4718592
 v_fmac_f32 v227, v214, v218
 v_fmac_f32 v228, v215, v218
 v_mfma_f32_16x16x32_bf16 a[120:123], v[76:79], v[56:59], a[120:123]
 ds_read_b64_tr_b16 v[150:151], v11 offset:19456
 v_fmac_f32 v221, v207, v219
 v_mfma_f32_16x16x32_bf16 a[124:127], v[76:79], v[60:63], a[124:127]
 v_mfma_f32_16x16x32_bf16 a[128:131], v[32:35], v[80:83], a[128:131]
 ds_read_b128 v[112:115], v9 offset:8192
 v_fmac_f32 v222, v208, v219
 v_mfma_f32_16x16x32_bf16 a[132:135], v[36:39], v[80:83], a[132:135]
L_pad2:
 s_cbranch_execz L_pad10
 v_fmac_f32 v223, v209, v219
 v_fmac_f32 v224, v210, v219
 v_mfma_f32_16x16x32_bf16 a[136:139], v[40:43], v[80:83], a[136:139]
 ds_read_b64_tr_b16 v[152:153], v12 offset:18432
 v_fmac_f32 v225, v211, v219
 v_mfma_f32_16x16x32_bf16 a[140:143], v[44:47], v[80:83], a[140:143]
 v_mfma_f32_16x16x32_bf16 a[144:147], v[48:51], v[80:83], a[144:147]
 ds_read_b64_tr_b16 v[154:155], v12 offset:19456
 v_fmac_f32 v226, v212, v219
 v_mfma_f32_16x16x32_bf16 a[148:151], v[52:55], v[80:83], a[148:151]
 v_fmac_f32 v227, v213, v219
 v_fmac_f32 v228, v214, v219
 v_mfma_f32_16x16x32_bf16 a[152:155], v[56:59], v[80:83], a[152:155]
 ds_read_b128 v[116:119], v9 offset:10240
 v_fmac_f32 v221, v206, v220
 v_mfma_f32_16x16x32_bf16 a[156:159], v[60:63], v[80:83], a[156:159]
 v_mfma_f32_16x16x32_bf16 a[160:163], v[32:35], v[84:87], a[160:163]
 ds_read_b64_tr_b16 v[156:157], v13 offset:18432
 v_fmac_f32 v222, v207, v220
 v_mfma_f32_16x16x32_bf16 a[164:167], v[36:39], v[84:87], a[164:167]
 v_fmac_f32 v223, v208, v220
 v_fmac_f32 v224, v209, v220
 v_mfma_f32_16x16x32_bf16 a[168:171], v[40:43], v[84:87], a[168:171]
 ds_read_b64_tr_b16 v[158:159], v13 offset:19456
 v_fmac_f32 v225, v210, v220
 v_mfma_f32_16x16x32_bf16 a[172:175], v[44:47], v[84:87], a[172:175]
 v_mfma_f32_16x16x32_bf16 a[176:179], v[48:51], v[84:87], a[176:179]
 ds_read_b128 v[120:123], v9 offset:12288
 v_fmac_f32 v226, v211, v220
 v_mfma_f32_16x16x32_bf16 a[180:183], v[52:55], v[84:87], a[180:183]
 v_fmac_f32 v227, v212, v220
 v_fmac_f32 v228, v213, v220
 v_mfma_f32_16x16x32_bf16 a[184:187], v[56:59], v[84:87], a[184:187]
 ds_read_b128 v[124:127], v9 offset:14336
 v_lshlrev_b32 v206, 16, v182
 v_mfma_f32_16x16x32_bf16 a[188:191], v[60:63], v[84:87], a[188:191]
 v_mfma_f32_16x16x32_bf16 a[192:195], v[32:35], v[88:91], a[192:195]
 v_lshlrev_b32 v207, 16, v184
 v_lshlrev_b32 v208, 16, v186
 v_mfma_f32_16x16x32_bf16 a[196:199], v[36:39], v[88:91], a[196:199]
 v_lshlrev_b32 v209, 16, v188
 v_lshlrev_b32 v210, 16, v190
 v_mfma_f32_16x16x32_bf16 a[200:203], v[40:43], v[88:91], a[200:203]
 v_lshlrev_b32 v211, 16, v192
 v_lshlrev_b32 v212, 16, v194
 v_mfma_f32_16x16x32_bf16 a[204:207], v[44:47], v[88:91], a[204:207]
 v_mfma_f32_16x16x32_bf16 a[208:211], v[48:51], v[88:91], a[208:211]
 v_lshlrev_b32 v213, 16, v196
 v_mul_f32 v221, v221, v206
 v_mfma_f32_16x16x32_bf16 a[212:215], v[52:55], v[88:91], a[212:215]
 v_mul_f32 v222, v222, v207
 v_mul_f32 v223, v223, v208
 v_mfma_f32_16x16x32_bf16 a[216:219], v[56:59], v[88:91], a[216:219]
 v_mul_f32 v224, v224, v209
 v_mul_f32 v225, v225, v210
 v_mfma_f32_16x16x32_bf16 a[220:223], v[60:63], v[88:91], a[220:223]
 v_mfma_f32_16x16x32_bf16 a[224:227], v[32:35], v[92:95], a[224:227]
 v_mul_f32 v226, v226, v211
 v_mul_f32 v227, v227, v212
 v_mfma_f32_16x16x32_bf16 a[228:231], v[36:39], v[92:95], a[228:231]
 v_mul_f32 v228, v228, v213
 v_cvt_pk_bf16_f32 v244, v228, v227
 v_mfma_f32_16x16x32_bf16 a[232:235], v[40:43], v[92:95], a[232:235]
 v_cvt_pk_bf16_f32 v245, v226, v225
 v_cvt_pk_bf16_f32 v246, v224, v223
 v_mfma_f32_16x16x32_bf16 a[236:239], v[44:47], v[92:95], a[236:239]
 v_mfma_f32_16x16x32_bf16 a[240:243], v[48:51], v[92:95], a[240:243]
 v_cvt_pk_bf16_f32 v247, v222, v221
 v_and_b32 v206, s52, v160
 v_mfma_f32_16x16x32_bf16 a[244:247], v[52:55], v[92:95], a[244:247]
 v_and_b32 v207, s52, v162
 v_and_b32 v208, s52, v164
 v_mfma_f32_16x16x32_bf16 a[248:251], v[56:59], v[92:95], a[248:251]
 v_and_b32 v209, s52, v166
 v_and_b32 v210, s52, v168
 v_mfma_f32_16x16x32_bf16 a[252:255], v[60:63], v[92:95], a[252:255]
 s_waitcnt vmcnt(20) lgkmcnt(0)
 s_barrier
 v_and_b32 v211, s52, v170
 v_and_b32 v212, s52, v172
 v_mfma_f32_16x16x32_bf16 a[0:3], v[128:131], v[96:99], a[0:3]
 ds_read_b64_tr_b16 v[64:65], v10 offset:32768
 v_and_b32 v213, s52, v174
 v_mfma_f32_16x16x32_bf16 a[4:7], v[128:131], v[100:103], a[4:7]
 s_add_u32 s36, s44, 128
 v_and_b32 v214, s52, v176
 v_and_b32 v215, s52, v178
 v_mfma_f32_16x16x32_bf16 a[8:11], v[128:131], v[104:107], a[8:11]
 s_add_u32 m0, s42, 0
 ds_read_b64_tr_b16 v[66:67], v10 offset:33792
 v_and_b32 v216, s52, v180
 v_mfma_f32_16x16x32_bf16 a[12:15], v[128:131], v[108:111], a[12:15]
 buffer_load_dwordx4 v17, s[24:27], s36 offen offset:0 lds
 v_mfma_f32_16x16x32_bf16 a[16:19], v[128:131], v[112:115], a[16:19]
 ds_read_b64_tr_b16 v[68:69], v11 offset:32768
 v_lshlrev_b32 v217, 16, v200
 v_mfma_f32_16x16x32_bf16 a[20:23], v[128:131], v[116:119], a[20:23]
 v_and_b32 v218, s52, v200
 v_lshlrev_b32 v219, 16, v201
 v_mfma_f32_16x16x32_bf16 a[24:27], v[128:131], v[120:123], a[24:27]
 ds_read_b64_tr_b16 v[70:71], v11 offset:33792
 v_and_b32 v220, s52, v201
 v_mfma_f32_16x16x32_bf16 a[28:31], v[128:131], v[124:127], a[28:31]
 buffer_load_dwordx4 v18, s[24:27], s36 offen offset:1024 lds
 v_mfma_f32_16x16x32_bf16 a[32:35], v[132:135], v[96:99], a[32:35]
 ds_read_b128 v[32:35], v8 offset:32768
 v_mul_f32 v221, v209, v217
 v_mfma_f32_16x16x32_bf16 a[36:39], v[132:135], v[100:103], a[36:39]
 v_mul_f32 v222, v210, v217
 v_mul_f32 v223, v211, v217
 v_mfma_f32_16x16x32_bf16 a[40:43], v[132:135], v[104:107], a[40:43]
 ds_read_b64_tr_b16 v[72:73], v12 offset:32768
 v_mul_f32 v224, v212, v217
 v_mfma_f32_16x16x32_bf16 a[44:47], v[132:135], v[108:111], a[44:47]
 buffer_load_dwordx4 v19, s[24:27], s36 offen offset:2048 lds
 v_mfma_f32_16x16x32_bf16 a[48:51], v[132:135], v[112:115], a[48:51]
 ds_read_b64_tr_b16 v[74:75], v12 offset:33792
 v_mul_f32 v225, v213, v217
 v_mfma_f32_16x16x32_bf16 a[52:55], v[132:135], v[116:119], a[52:55]
 v_mul_f32 v226, v214, v217
 v_mul_f32 v227, v215, v217
 v_mfma_f32_16x16x32_bf16 a[56:59], v[132:135], v[120:123], a[56:59]
 ds_read_b128 v[36:39], v8 offset:34816
 v_mul_f32 v228, v216, v217
 v_mfma_f32_16x16x32_bf16 a[60:63], v[132:135], v[124:127], a[60:63]
 buffer_load_dwordx4 v20, s[24:27], s36 offen offset:3072 lds
 v_mfma_f32_16x16x32_bf16 a[64:67], v[136:139], v[96:99], a[64:67]
 ds_read_b64_tr_b16 v[76:77], v13 offset:32768
 v_fmac_f32 v221, v208, v218
 v_mfma_f32_16x16x32_bf16 a[68:71], v[136:139], v[100:103], a[68:71]
 s_add_u32 s37, s49, 262144
 v_fmac_f32 v222, v209, v218
 v_fmac_f32 v223, v210, v218
 v_mfma_f32_16x16x32_bf16 a[72:75], v[136:139], v[104:107], a[72:75]
 s_add_u32 m0, s50, 8704
 ds_read_b64_tr_b16 v[78:79], v13 offset:33792
 v_fmac_f32 v224, v211, v218
 v_mfma_f32_16x16x32_bf16 a[76:79], v[136:139], v[108:111], a[76:79]
 buffer_load_dwordx4 v21, s[20:23], s37 offen offset:0 lds
 v_mfma_f32_16x16x32_bf16 a[80:83], v[136:139], v[112:115], a[80:83]
 ds_read_b128 v[40:43], v8 offset:36864
 v_fmac_f32 v225, v212, v218
 v_mfma_f32_16x16x32_bf16 a[84:87], v[136:139], v[116:119], a[84:87]
 v_fmac_f32 v226, v213, v218
 v_fmac_f32 v227, v214, v218
 v_mfma_f32_16x16x32_bf16 a[88:91], v[136:139], v[120:123], a[88:91]
 ds_read_b64_tr_b16 v[80:81], v10 offset:34816
 v_fmac_f32 v228, v215, v218
 v_mfma_f32_16x16x32_bf16 a[92:95], v[136:139], v[124:127], a[92:95]
 buffer_load_dwordx4 v22, s[20:23], s37 offen offset:1024 lds
 v_mfma_f32_16x16x32_bf16 a[96:99], v[140:143], v[96:99], a[96:99]
 ds_read_b64_tr_b16 v[82:83], v10 offset:35840
 v_fmac_f32 v221, v207, v219
 v_mfma_f32_16x16x32_bf16 a[100:103], v[140:143], v[100:103], a[100:103]
 s_add_u32 s37, s49, 524288
 v_fmac_f32 v222, v208, v219
 v_fmac_f32 v223, v209, v219
 v_mfma_f32_16x16x32_bf16 a[104:107], v[140:143], v[104:107], a[104:107]
 s_add_u32 m0, s50, 17408
 ds_read_b128 v[44:47], v8 offset:38912
 v_fmac_f32 v224, v210, v219
 v_mfma_f32_16x16x32_bf16 a[108:111], v[140:143], v[108:111], a[108:111]
 buffer_load_dwordx4 v21, s[20:23], s37 offen offset:0 lds
 v_mfma_f32_16x16x32_bf16 a[112:115], v[140:143], v[112:115], a[112:115]
 ds_read_b64_tr_b16 v[84:85], v11 offset:34816
 v_fmac_f32 v225, v211, v219
 v_mfma_f32_16x16x32_bf16 a[116:119], v[140:143], v[116:119], a[116:119]
 v_fmac_f32 v226, v212, v219
 v_fmac_f32 v227, v213, v219
 v_mfma_f32_16x16x32_bf16 a[120:123], v[140:143], v[120:123], a[120:123]
 ds_read_b64_tr_b16 v[86:87], v11 offset:35840
 v_fmac_f32 v228, v214, v219
 v_mfma_f32_16x16x32_bf16 a[124:127], v[140:143], v[124:127], a[124:127]
 buffer_load_dwordx4 v22, s[20:23], s37 offen offset:1024 lds
 v_mfma_f32_16x16x32_bf16 a[128:131], v[96:99], v[144:147], a[128:131]
 ds_read_b128 v[48:51], v8 offset:40960
 v_fmac_f32 v221, v206, v220
 v_mfma_f32_16x16x32_bf16 a[132:135], v[100:103], v[144:147], a[132:135]
 v_fmac_f32 v222, v207, v220
 v_fmac_f32 v223, v208, v220
 v_mfma_f32_16x16x32_bf16 a[136:139], v[104:107], v[144:147], a[136:139]
 ds_read_b64_tr_b16 v[88:89], v12 offset:34816
 v_fmac_f32 v224, v209, v220
 v_mfma_f32_16x16x32_bf16 a[140:143], v[108:111], v[144:147], a[140:143]
 buffer_store_dwordx4 v[244:247], v234, s[16:19], 0 offen sc1
 v_mfma_f32_16x16x32_bf16 a[144:147], v[112:115], v[144:147], a[144:147]
 s_movk_i32 s54, 4608
 ds_read_b64_tr_b16 v[90:91], v12 offset:35840
 v_fmac_f32 v225, v210, v220
 v_mfma_f32_16x16x32_bf16 a[148:151], v[116:119], v[144:147], a[148:151]
 v_fmac_f32 v226, v211, v220
 v_fmac_f32 v227, v212, v220
 v_mfma_f32_16x16x32_bf16 a[152:155], v[120:123], v[144:147], a[152:155]
 ds_read_b128 v[52:55], v8 offset:43008
 v_fmac_f32 v228, v213, v220
 v_mfma_f32_16x16x32_bf16 a[156:159], v[124:127], v[144:147], a[156:159]
 v_mfma_f32_16x16x32_bf16 a[160:163], v[96:99], v[148:151], a[160:163]
 ds_read_b64_tr_b16 v[92:93], v13 offset:34816
 v_and_b32 v206, s52, v182
 v_mfma_f32_16x16x32_bf16 a[164:167], v[100:103], v[148:151], a[164:167]
 v_and_b32 v207, s52, v184
 v_and_b32 v208, s52, v186
 v_mfma_f32_16x16x32_bf16 a[168:171], v[104:107], v[148:151], a[168:171]
 ds_read_b64_tr_b16 v[94:95], v13 offset:35840
 v_and_b32 v209, s52, v188
 v_mfma_f32_16x16x32_bf16 a[172:175], v[108:111], v[148:151], a[172:175]
 v_mfma_f32_16x16x32_bf16 a[176:179], v[112:115], v[148:151], a[176:179]
 ds_read_b128 v[56:59], v8 offset:45056
 v_and_b32 v210, s52, v190
 v_mfma_f32_16x16x32_bf16 a[180:183], v[116:119], v[148:151], a[180:183]
 v_and_b32 v211, s52, v192
 v_and_b32 v212, s52, v194
 v_mfma_f32_16x16x32_bf16 a[184:187], v[120:123], v[148:151], a[184:187]
 ds_read_b128 v[60:63], v8 offset:47104
 v_and_b32 v213, s52, v196
 v_mfma_f32_16x16x32_bf16 a[188:191], v[124:127], v[148:151], a[188:191]
 v_mfma_f32_16x16x32_bf16 a[192:195], v[96:99], v[152:155], a[192:195]
 v_mul_f32 v221, v221, v206
 v_mul_f32 v222, v222, v207
 v_mfma_f32_16x16x32_bf16 a[196:199], v[100:103], v[152:155], a[196:199]
 v_mul_f32 v223, v223, v208
 v_mul_f32 v224, v224, v209
 v_mfma_f32_16x16x32_bf16 a[200:203], v[104:107], v[152:155], a[200:203]
 v_mul_f32 v225, v225, v210
 v_mul_f32 v226, v226, v211
 v_mfma_f32_16x16x32_bf16 a[204:207], v[108:111], v[152:155], a[204:207]
 v_mfma_f32_16x16x32_bf16 a[208:211], v[112:115], v[152:155], a[208:211]
 v_mul_f32 v227, v227, v212
 v_mul_f32 v228, v228, v213
 v_mfma_f32_16x16x32_bf16 a[212:215], v[116:119], v[152:155], a[212:215]
 v_cvt_pk_bf16_f32 v248, v228, v227
 v_cvt_pk_bf16_f32 v249, v226, v225
 v_mfma_f32_16x16x32_bf16 a[216:219], v[120:123], v[152:155], a[216:219]
 v_cvt_pk_bf16_f32 v250, v224, v223
 v_cvt_pk_bf16_f32 v251, v222, v221
 v_mfma_f32_16x16x32_bf16 a[220:223], v[124:127], v[152:155], a[220:223]
 buffer_store_dwordx4 v[248:251], v234, s[16:19], s54 offen sc1
 v_mfma_f32_16x16x32_bf16 a[224:227], v[96:99], v[156:159], a[224:227]
 s_movk_i32 s54, 9216
 v_lshlrev_b32 v206, 16, v161
 v_lshlrev_b32 v207, 16, v163
 v_mfma_f32_16x16x32_bf16 a[228:231], v[100:103], v[156:159], a[228:231]
 v_lshlrev_b32 v208, 16, v165
 v_lshlrev_b32 v209, 16, v167
 v_mfma_f32_16x16x32_bf16 a[232:235], v[104:107], v[156:159], a[232:235]
 v_lshlrev_b32 v210, 16, v169
 v_lshlrev_b32 v211, 16, v171
 v_mfma_f32_16x16x32_bf16 a[236:239], v[108:111], v[156:159], a[236:239]
 v_mfma_f32_16x16x32_bf16 a[240:243], v[112:115], v[156:159], a[240:243]
 v_lshlrev_b32 v212, 16, v173
 v_lshlrev_b32 v213, 16, v175
 v_mfma_f32_16x16x32_bf16 a[244:247], v[116:119], v[156:159], a[244:247]
 v_lshlrev_b32 v214, 16, v177
 v_lshlrev_b32 v215, 16, v179
 v_mfma_f32_16x16x32_bf16 a[248:251], v[120:123], v[156:159], a[248:251]
 v_lshlrev_b32 v216, 16, v181
 v_lshlrev_b32 v217, 16, v202
 v_mfma_f32_16x16x32_bf16 a[252:255], v[124:127], v[156:159], a[252:255]
 s_waitcnt vmcnt(19) lgkmcnt(0)
 s_barrier
 v_and_b32 v218, s52, v202
 v_lshlrev_b32 v219, 16, v203
 v_mfma_f32_16x16x32_bf16 a[0:3], v[64:67], v[32:35], a[0:3]
 ds_read_b64_tr_b16 v[128:129], v10 offset:49152
 v_and_b32 v220, s52, v203
 v_mfma_f32_16x16x32_bf16 a[4:7], v[64:67], v[36:39], a[4:7]
 s_add_u32 s36, s45, 128
 v_mul_f32 v221, v209, v217
 v_mul_f32 v222, v210, v217
 v_mfma_f32_16x16x32_bf16 a[8:11], v[64:67], v[40:43], a[8:11]
 s_add_u32 m0, s42, 4096
 ds_read_b64_tr_b16 v[130:131], v10 offset:50176
 v_mul_f32 v223, v211, v217
 v_mfma_f32_16x16x32_bf16 a[12:15], v[64:67], v[44:47], a[12:15]
 buffer_load_dwordx4 v17, s[24:27], s36 offen offset:0 lds
 v_mfma_f32_16x16x32_bf16 a[16:19], v[64:67], v[48:51], a[16:19]
 ds_read_b64_tr_b16 v[132:133], v11 offset:49152
 v_mul_f32 v224, v212, v217
 v_mfma_f32_16x16x32_bf16 a[20:23], v[64:67], v[52:55], a[20:23]
 v_mul_f32 v225, v213, v217
 v_mul_f32 v226, v214, v217
 v_mfma_f32_16x16x32_bf16 a[24:27], v[64:67], v[56:59], a[24:27]
 ds_read_b64_tr_b16 v[134:135], v11 offset:50176
 v_mul_f32 v227, v215, v217
 v_mfma_f32_16x16x32_bf16 a[28:31], v[64:67], v[60:63], a[28:31]
 buffer_load_dwordx4 v18, s[24:27], s36 offen offset:1024 lds
 v_mfma_f32_16x16x32_bf16 a[32:35], v[68:71], v[32:35], a[32:35]
 ds_read_b128 v[96:99], v9 offset:32768
 v_mul_f32 v228, v216, v217
 v_mfma_f32_16x16x32_bf16 a[36:39], v[68:71], v[36:39], a[36:39]
 v_fmac_f32 v221, v208, v218
 v_fmac_f32 v222, v209, v218
 v_mfma_f32_16x16x32_bf16 a[40:43], v[68:71], v[40:43], a[40:43]
 ds_read_b64_tr_b16 v[136:137], v12 offset:49152
 v_fmac_f32 v223, v210, v218
 v_mfma_f32_16x16x32_bf16 a[44:47], v[68:71], v[44:47], a[44:47]
 buffer_load_dwordx4 v19, s[24:27], s36 offen offset:2048 lds
 v_mfma_f32_16x16x32_bf16 a[48:51], v[68:71], v[48:51], a[48:51]
 ds_read_b64_tr_b16 v[138:139], v12 offset:50176
 v_fmac_f32 v224, v211, v218
 v_mfma_f32_16x16x32_bf16 a[52:55], v[68:71], v[52:55], a[52:55]
 v_fmac_f32 v225, v212, v218
 v_fmac_f32 v226, v213, v218
 v_mfma_f32_16x16x32_bf16 a[56:59], v[68:71], v[56:59], a[56:59]
 ds_read_b128 v[100:103], v9 offset:34816
 v_fmac_f32 v227, v214, v218
 v_mfma_f32_16x16x32_bf16 a[60:63], v[68:71], v[60:63], a[60:63]
 buffer_load_dwordx4 v20, s[24:27], s36 offen offset:3072 lds
 v_mfma_f32_16x16x32_bf16 a[64:67], v[72:75], v[32:35], a[64:67]
 ds_read_b64_tr_b16 v[140:141], v13 offset:49152
 v_fmac_f32 v228, v215, v218
 v_mfma_f32_16x16x32_bf16 a[68:71], v[72:75], v[36:39], a[68:71]
 s_add_u32 s37, s49, 786432
 v_fmac_f32 v221, v207, v219
 v_fmac_f32 v222, v208, v219
 v_mfma_f32_16x16x32_bf16 a[72:75], v[72:75], v[40:43], a[72:75]
 s_add_u32 m0, s50, 26112
 ds_read_b64_tr_b16 v[142:143], v13 offset:50176
 v_fmac_f32 v223, v209, v219
 v_mfma_f32_16x16x32_bf16 a[76:79], v[72:75], v[44:47], a[76:79]
 buffer_load_dwordx4 v21, s[20:23], s37 offen offset:0 lds
 v_mfma_f32_16x16x32_bf16 a[80:83], v[72:75], v[48:51], a[80:83]
 ds_read_b128 v[104:107], v9 offset:36864
 v_fmac_f32 v224, v210, v219
 v_mfma_f32_16x16x32_bf16 a[84:87], v[72:75], v[52:55], a[84:87]
 v_fmac_f32 v225, v211, v219
 v_fmac_f32 v226, v212, v219
 v_mfma_f32_16x16x32_bf16 a[88:91], v[72:75], v[56:59], a[88:91]
 ds_read_b64_tr_b16 v[144:145], v10 offset:51200
 v_fmac_f32 v227, v213, v219
 v_mfma_f32_16x16x32_bf16 a[92:95], v[72:75], v[60:63], a[92:95]
 buffer_load_dwordx4 v22, s[20:23], s37 offen offset:1024 lds
 v_mfma_f32_16x16x32_bf16 a[96:99], v[76:79], v[32:35], a[96:99]
 ds_read_b64_tr_b16 v[146:147], v10 offset:52224
 v_fmac_f32 v228, v214, v219
 v_mfma_f32_16x16x32_bf16 a[100:103], v[76:79], v[36:39], a[100:103]
 s_add_u32 s37, s49, 1048576
 v_fmac_f32 v221, v206, v220
 v_fmac_f32 v222, v207, v220
 v_mfma_f32_16x16x32_bf16 a[104:107], v[76:79], v[40:43], a[104:107]
 s_add_u32 m0, s50, 34816
 ds_read_b128 v[108:111], v9 offset:38912
 v_fmac_f32 v223, v208, v220
 v_mfma_f32_16x16x32_bf16 a[108:111], v[76:79], v[44:47], a[108:111]
 buffer_load_dwordx4 v21, s[20:23], s37 offen offset:0 lds
 v_mfma_f32_16x16x32_bf16 a[112:115], v[76:79], v[48:51], a[112:115]
 ds_read_b64_tr_b16 v[148:149], v11 offset:51200
 v_fmac_f32 v224, v209, v220
 v_mfma_f32_16x16x32_bf16 a[116:119], v[76:79], v[52:55], a[116:119]
 v_fmac_f32 v225, v210, v220
 v_fmac_f32 v226, v211, v220
 v_mfma_f32_16x16x32_bf16 a[120:123], v[76:79], v[56:59], a[120:123]
 ds_read_b64_tr_b16 v[150:151], v11 offset:52224
 v_fmac_f32 v227, v212, v220
 v_mfma_f32_16x16x32_bf16 a[124:127], v[76:79], v[60:63], a[124:127]
 buffer_load_dwordx4 v22, s[20:23], s37 offen offset:1024 lds
 v_mfma_f32_16x16x32_bf16 a[128:131], v[32:35], v[80:83], a[128:131]
 ds_read_b128 v[112:115], v9 offset:40960
 v_fmac_f32 v228, v213, v220
 v_mfma_f32_16x16x32_bf16 a[132:135], v[36:39], v[80:83], a[132:135]
 v_lshlrev_b32 v206, 16, v183
 v_lshlrev_b32 v207, 16, v185
 v_mfma_f32_16x16x32_bf16 a[136:139], v[40:43], v[80:83], a[136:139]
 ds_read_b64_tr_b16 v[152:153], v12 offset:51200
 v_lshlrev_b32 v208, 16, v187
 v_mfma_f32_16x16x32_bf16 a[140:143], v[44:47], v[80:83], a[140:143]
 v_mfma_f32_16x16x32_bf16 a[144:147], v[48:51], v[80:83], a[144:147]
 ds_read_b64_tr_b16 v[154:155], v12 offset:52224
 v_lshlrev_b32 v209, 16, v189
 v_mfma_f32_16x16x32_bf16 a[148:151], v[52:55], v[80:83], a[148:151]
 v_lshlrev_b32 v210, 16, v191
 v_lshlrev_b32 v211, 16, v193
 v_mfma_f32_16x16x32_bf16 a[152:155], v[56:59], v[80:83], a[152:155]
 ds_read_b128 v[116:119], v9 offset:43008
 v_lshlrev_b32 v212, 16, v195
 v_mfma_f32_16x16x32_bf16 a[156:159], v[60:63], v[80:83], a[156:159]
 v_mfma_f32_16x16x32_bf16 a[160:163], v[32:35], v[84:87], a[160:163]
 ds_read_b64_tr_b16 v[156:157], v13 offset:51200
 v_lshlrev_b32 v213, 16, v197
 v_mfma_f32_16x16x32_bf16 a[164:167], v[36:39], v[84:87], a[164:167]
 v_mul_f32 v221, v221, v206
 v_mul_f32 v222, v222, v207
 v_mfma_f32_16x16x32_bf16 a[168:171], v[40:43], v[84:87], a[168:171]
 ds_read_b64_tr_b16 v[158:159], v13 offset:52224
 v_mul_f32 v223, v223, v208
 v_mfma_f32_16x16x32_bf16 a[172:175], v[44:47], v[84:87], a[172:175]
 v_mfma_f32_16x16x32_bf16 a[176:179], v[48:51], v[84:87], a[176:179]
 ds_read_b128 v[120:123], v9 offset:45056
 v_mul_f32 v224, v224, v209
 v_mfma_f32_16x16x32_bf16 a[180:183], v[52:55], v[84:87], a[180:183]
 v_mul_f32 v225, v225, v210
 v_mul_f32 v226, v226, v211
 v_mfma_f32_16x16x32_bf16 a[184:187], v[56:59], v[84:87], a[184:187]
 ds_read_b128 v[124:127], v9 offset:47104
 v_mul_f32 v227, v227, v212
 v_mfma_f32_16x16x32_bf16 a[188:191], v[60:63], v[84:87], a[188:191]
 v_mfma_f32_16x16x32_bf16 a[192:195], v[32:35], v[88:91], a[192:195]
 v_mul_f32 v228, v228, v213
 v_cvt_pk_bf16_f32 v244, v228, v227
 v_mfma_f32_16x16x32_bf16 a[196:199], v[36:39], v[88:91], a[196:199]
 v_cvt_pk_bf16_f32 v245, v226, v225
 v_cvt_pk_bf16_f32 v246, v224, v223
 v_mfma_f32_16x16x32_bf16 a[200:203], v[40:43], v[88:91], a[200:203]
 v_cvt_pk_bf16_f32 v247, v222, v221
 v_and_b32 v206, s52, v161
 v_mfma_f32_16x16x32_bf16 a[204:207], v[44:47], v[88:91], a[204:207]
 buffer_store_dwordx4 v[244:247], v234, s[16:19], s54 offen sc1
 v_mfma_f32_16x16x32_bf16 a[208:211], v[48:51], v[88:91], a[208:211]
 s_movk_i32 s54, 13824
 v_and_b32 v207, s52, v163
 v_and_b32 v208, s52, v165
 v_mfma_f32_16x16x32_bf16 a[212:215], v[52:55], v[88:91], a[212:215]
 v_and_b32 v209, s52, v167
 v_and_b32 v210, s52, v169
 v_mfma_f32_16x16x32_bf16 a[216:219], v[56:59], v[88:91], a[216:219]
 v_and_b32 v211, s52, v171
 v_and_b32 v212, s52, v173
 v_mfma_f32_16x16x32_bf16 a[220:223], v[60:63], v[88:91], a[220:223]
 v_mfma_f32_16x16x32_bf16 a[224:227], v[32:35], v[92:95], a[224:227]
 v_and_b32 v213, s52, v175
 v_and_b32 v214, s52, v177
 v_mfma_f32_16x16x32_bf16 a[228:231], v[36:39], v[92:95], a[228:231]
 v_and_b32 v215, s52, v179
 v_and_b32 v216, s52, v181
 v_mfma_f32_16x16x32_bf16 a[232:235], v[40:43], v[92:95], a[232:235]
 v_lshlrev_b32 v217, 16, v204
 v_and_b32 v218, s52, v204
 v_mfma_f32_16x16x32_bf16 a[236:239], v[44:47], v[92:95], a[236:239]
 v_mfma_f32_16x16x32_bf16 a[240:243], v[48:51], v[92:95], a[240:243]
 v_lshlrev_b32 v219, 16, v205
 v_and_b32 v220, s52, v205
 v_mfma_f32_16x16x32_bf16 a[244:247], v[52:55], v[92:95], a[244:247]
 v_mul_f32 v221, v209, v217
 v_mul_f32 v222, v210, v217
 v_mfma_f32_16x16x32_bf16 a[248:251], v[56:59], v[92:95], a[248:251]
 v_mul_f32 v223, v211, v217
 v_mul_f32 v224, v212, v217
 v_mfma_f32_16x16x32_bf16 a[252:255], v[60:63], v[92:95], a[252:255]
 s_waitcnt vmcnt(20) lgkmcnt(0)
 s_barrier
 v_mul_f32 v225, v213, v217
 v_mul_f32 v226, v214, v217
 v_mfma_f32_16x16x32_bf16 a[0:3], v[128:131], v[96:99], a[0:3]
 ds_read_b64_tr_b16 v[48:49], v27 offset:0
 v_mul_f32 v227, v215, v217
 v_mfma_f32_16x16x32_bf16 a[4:7], v[128:131], v[100:103], a[4:7]
 s_add_u32 s36, s44, 256
 v_mul_f32 v228, v216, v217
 v_fmac_f32 v221, v208, v218
 v_mfma_f32_16x16x32_bf16 a[8:11], v[128:131], v[104:107], a[8:11]
 s_add_u32 m0, s42, 32768
 ds_read_b64_tr_b16 v[50:51], v27 offset:1024
 v_fmac_f32 v222, v209, v218
 v_mfma_f32_16x16x32_bf16 a[12:15], v[128:131], v[108:111], a[12:15]
 buffer_load_dwordx4 v17, s[24:27], s36 offen offset:0 lds
 v_mfma_f32_16x16x32_bf16 a[16:19], v[128:131], v[112:115], a[16:19]
 ds_read_b128 v[32:35], v25 offset:0
 v_fmac_f32 v223, v210, v218
 v_mfma_f32_16x16x32_bf16 a[20:23], v[128:131], v[116:119], a[20:23]
 v_fmac_f32 v224, v211, v218
 v_fmac_f32 v225, v212, v218
 v_mfma_f32_16x16x32_bf16 a[24:27], v[128:131], v[120:123], a[24:27]
 ds_read_b128 v[36:39], v25 offset:2048
 v_fmac_f32 v226, v213, v218
 v_mfma_f32_16x16x32_bf16 a[28:31], v[128:131], v[124:127], a[28:31]
 buffer_load_dwordx4 v18, s[24:27], s36 offen offset:1024 lds
 v_mfma_f32_16x16x32_bf16 a[32:35], v[132:135], v[96:99], a[32:35]
 ds_read_b128 v[40:43], v25 offset:4096
 v_fmac_f32 v227, v214, v218
 v_mfma_f32_16x16x32_bf16 a[36:39], v[132:135], v[100:103], a[36:39]
 v_fmac_f32 v228, v215, v218
 v_fmac_f32 v221, v207, v219
 v_mfma_f32_16x16x32_bf16 a[40:43], v[132:135], v[104:107], a[40:43]
 ds_read_b128 v[44:47], v25 offset:6144
 v_fmac_f32 v222, v208, v219
 v_mfma_f32_16x16x32_bf16 a[44:47], v[132:135], v[108:111], a[44:47]
 buffer_load_dwordx4 v19, s[24:27], s36 offen offset:2048 lds
 v_mfma_f32_16x16x32_bf16 a[48:51], v[132:135], v[112:115], a[48:51]
 ds_read_b64_tr_b16 v[52:53], v28 offset:0
 v_fmac_f32 v223, v209, v219
 v_mfma_f32_16x16x32_bf16 a[52:55], v[132:135], v[116:119], a[52:55]
 v_fmac_f32 v224, v210, v219
 v_fmac_f32 v225, v211, v219
 v_mfma_f32_16x16x32_bf16 a[56:59], v[132:135], v[120:123], a[56:59]
 ds_read_b64_tr_b16 v[54:55], v28 offset:1024
 v_fmac_f32 v226, v212, v219
 v_mfma_f32_16x16x32_bf16 a[60:63], v[132:135], v[124:127], a[60:63]
 buffer_load_dwordx4 v20, s[24:27], s36 offen offset:3072 lds
 v_mfma_f32_16x16x32_bf16 a[64:67], v[136:139], v[96:99], a[64:67]
 ds_read_b64_tr_b16 v[56:57], v29 offset:0
 v_fmac_f32 v227, v213, v219
 v_mfma_f32_16x16x32_bf16 a[68:71], v[136:139], v[100:103], a[68:71]
 v_fmac_f32 v228, v214, v219
 v_fmac_f32 v221, v206, v220
 v_mfma_f32_16x16x32_bf16 a[72:75], v[136:139], v[104:107], a[72:75]
 ds_read_b64_tr_b16 v[58:59], v29 offset:1024
 v_fmac_f32 v222, v207, v220
 v_mfma_f32_16x16x32_bf16 a[76:79], v[136:139], v[108:111], a[76:79]
 v_mfma_f32_16x16x32_bf16 a[80:83], v[136:139], v[112:115], a[80:83]
 ds_read_b64_tr_b16 v[60:61], v30 offset:0
 v_fmac_f32 v223, v208, v220
 v_mfma_f32_16x16x32_bf16 a[84:87], v[136:139], v[116:119], a[84:87]
 v_fmac_f32 v224, v209, v220
 v_fmac_f32 v225, v210, v220
 v_mfma_f32_16x16x32_bf16 a[88:91], v[136:139], v[120:123], a[88:91]
 ds_read_b64_tr_b16 v[62:63], v30 offset:1024
 v_fmac_f32 v226, v211, v220
 v_mfma_f32_16x16x32_bf16 a[92:95], v[136:139], v[124:127], a[92:95]
 v_mfma_f32_16x16x32_bf16 a[96:99], v[140:143], v[96:99], a[96:99]
 ds_read_b64_tr_b16 v[64:65], v27 offset:128
 v_fmac_f32 v227, v212, v220
 v_mfma_f32_16x16x32_bf16 a[100:103], v[140:143], v[100:103], a[100:103]
 v_fmac_f32 v228, v213, v220
 v_and_b32 v206, s52, v183
 v_mfma_f32_16x16x32_bf16 a[104:107], v[140:143], v[104:107], a[104:107]
 ds_read_b64_tr_b16 v[66:67], v27 offset:1152
 v_and_b32 v207, s52, v185
 v_mfma_f32_16x16x32_bf16 a[108:111], v[140:143], v[108:111], a[108:111]
 v_mfma_f32_16x16x32_bf16 a[112:115], v[140:143], v[112:115], a[112:115]
 ds_read_b64_tr_b16 v[68:69], v28 offset:128
 v_and_b32 v208, s52, v187
 v_mfma_f32_16x16x32_bf16 a[116:119], v[140:143], v[116:119], a[116:119]
 v_and_b32 v209, s52, v189
 v_and_b32 v210, s52, v191
 v_mfma_f32_16x16x32_bf16 a[120:123], v[140:143], v[120:123], a[120:123]
 ds_read_b64_tr_b16 v[70:71], v28 offset:1152
 v_and_b32 v211, s52, v193
 v_mfma_f32_16x16x32_bf16 a[124:127], v[140:143], v[124:127], a[124:127]
 v_mfma_f32_16x16x32_bf16 a[128:131], v[96:99], v[144:147], a[128:131]
 ds_read_b64_tr_b16 v[72:73], v29 offset:128
 v_and_b32 v212, s52, v195
 v_mfma_f32_16x16x32_bf16 a[132:135], v[100:103], v[144:147], a[132:135]
 v_and_b32 v213, s52, v197
 v_mul_f32 v221, v221, v206
 v_mfma_f32_16x16x32_bf16 a[136:139], v[104:107], v[144:147], a[136:139]
 ds_read_b64_tr_b16 v[74:75], v29 offset:1152
 v_mul_f32 v222, v222, v207
 v_mfma_f32_16x16x32_bf16 a[140:143], v[108:111], v[144:147], a[140:143]
 v_mfma_f32_16x16x32_bf16 a[144:147], v[112:115], v[144:147], a[144:147]
 ds_read_b64_tr_b16 v[76:77], v30 offset:128
 v_mul_f32 v223, v223, v208
 v_mfma_f32_16x16x32_bf16 a[148:151], v[116:119], v[144:147], a[148:151]
 v_mul_f32 v224, v224, v209
 v_mul_f32 v225, v225, v210
 v_mfma_f32_16x16x32_bf16 a[152:155], v[120:123], v[144:147], a[152:155]
 ds_read_b64_tr_b16 v[78:79], v30 offset:1152
 v_mul_f32 v226, v226, v211
 v_mfma_f32_16x16x32_bf16 a[156:159], v[124:127], v[144:147], a[156:159]
 v_mfma_f32_16x16x32_bf16 a[160:163], v[96:99], v[148:151], a[160:163]
 v_mul_f32 v227, v227, v212
 v_mul_f32 v228, v228, v213
 v_mfma_f32_16x16x32_bf16 a[164:167], v[100:103], v[148:151], a[164:167]
 v_cvt_pk_bf16_f32 v248, v228, v227
 v_cvt_pk_bf16_f32 v249, v226, v225
 v_mfma_f32_16x16x32_bf16 a[168:171], v[104:107], v[148:151], a[168:171]
 v_cvt_pk_bf16_f32 v250, v224, v223
 v_cvt_pk_bf16_f32 v251, v222, v221
 v_mfma_f32_16x16x32_bf16 a[172:175], v[108:111], v[148:151], a[172:175]
 buffer_store_dwordx4 v[248:251], v234, s[16:19], s54 offen sc1
 v_mfma_f32_16x16x32_bf16 a[176:179], v[112:115], v[148:151], a[176:179]
 v_mov_b32 v160, 0
 v_mov_b32 v161, 0
 v_mfma_f32_16x16x32_bf16 a[180:183], v[116:119], v[148:151], a[180:183]
 v_mov_b32 v162, 0
 v_mov_b32 v163, 0
 v_mfma_f32_16x16x32_bf16 a[184:187], v[120:123], v[148:151], a[184:187]
 v_mfma_f32_16x16x32_bf16 a[188:191], v[124:127], v[148:151], a[188:191]
 buffer_store_dwordx4 v[160:163], v235, s[16:19], s53 offen sc1
 v_mfma_f32_16x16x32_bf16 a[192:195], v[96:99], v[152:155], a[192:195]
 v_mfma_f32_16x16x32_bf16 a[196:199], v[100:103], v[152:155], a[196:199]
 v_mfma_f32_16x16x32_bf16 a[200:203], v[104:107], v[152:155], a[200:203]
 v_mfma_f32_16x16x32_bf16 a[204:207], v[108:111], v[152:155], a[204:207]
 v_mfma_f32_16x16x32_bf16 a[208:211], v[112:115], v[152:155], a[208:211]
 v_mfma_f32_16x16x32_bf16 a[212:215], v[116:119], v[152:155], a[212:215]
 v_mfma_f32_16x16x32_bf16 a[216:219], v[120:123], v[152:155], a[216:219]
 v_mfma_f32_16x16x32_bf16 a[220:223], v[124:127], v[152:155], a[220:223]
 v_mfma_f32_16x16x32_bf16 a[224:227], v[96:99], v[156:159], a[224:227]
 v_mfma_f32_16x16x32_bf16 a[228:231], v[100:103], v[156:159], a[228:231]
 v_mfma_f32_16x16x32_bf16 a[232:235], v[104:107], v[156:159], a[232:235]
 v_mfma_f32_16x16x32_bf16 a[236:239], v[108:111], v[156:159], a[236:239]
 v_mfma_f32_16x16x32_bf16 a[240:243], v[112:115], v[156:159], a[240:243]
 v_mfma_f32_16x16x32_bf16 a[244:247], v[116:119], v[156:159], a[244:247]
 v_mfma_f32_16x16x32_bf16 a[248:251], v[120:123], v[156:159], a[248:251]
 v_mfma_f32_16x16x32_bf16 a[252:255], v[124:127], v[156:159], a[252:255]
 s_waitcnt vmcnt(19) lgkmcnt(0)
 s_barrier
 v_mfma_f32_16x16x32_bf16 v[128:131], v[48:51], v[32:35], 0
 s_lshl_b32 s38, s33, 6
 ds_read_b64_tr_b16 v[96:97], v27 offset:8704
 ds_read_b64_tr_b16 v[98:99], v27 offset:9728
 v_mfma_f32_16x16x32_bf16 v[160:163], v[48:51], v[36:39], 0
 s_add_u32 s36, s45, 256
 v_mfma_f32_16x16x32_bf16 v[192:195], v[48:51], v[40:43], 0
 s_add_u32 m0, s42, 36864
 ds_read_b128 v[80:83], v26 offset:0
 ds_read_b128 v[84:87], v26 offset:2048
 v_mfma_f32_16x16x32_bf16 v[224:227], v[48:51], v[44:47], 0
 buffer_load_dwordx4 v17, s[24:27], s36 offen offset:0 lds
 v_mfma_f32_16x16x32_bf16 v[132:135], v[52:55], v[32:35], 0
 s_lshl_b32 s54, s34, 3
 ds_read_b128 v[88:91], v26 offset:4096
 ds_read_b128 v[92:95], v26 offset:6144
 v_mfma_f32_16x16x32_bf16 v[164:167], v[52:55], v[36:39], 0
 s_add_u32 s38, s38, s54
 v_accvgpr_read_b32 v4, a132
 v_accvgpr_read_b32 v5, a133
 v_mfma_f32_16x16x32_bf16 v[196:199], v[52:55], v[40:43], 0
 s_lshr_b32 s54, s32, 1
 ds_read_b64_tr_b16 v[100:101], v28 offset:8704
 ds_read_b64_tr_b16 v[102:103], v28 offset:9728
 v_mfma_f32_16x16x32_bf16 v[228:231], v[52:55], v[44:47], 0
 buffer_load_dwordx4 v18, s[24:27], s36 offen offset:1024 lds
 v_mfma_f32_16x16x32_bf16 v[136:139], v[56:59], v[32:35], 0
 s_lshl_b32 s54, s54, 2
 ds_read_b64_tr_b16 v[104:105], v29 offset:8704
 ds_read_b64_tr_b16 v[106:107], v29 offset:9728
 v_mfma_f32_16x16x32_bf16 v[168:171], v[56:59], v[36:39], 0
 s_add_u32 s38, s38, s54
 v_accvgpr_read_b32 v6, a134
 v_accvgpr_read_b32 v7, a135
 v_mfma_f32_16x16x32_bf16 v[200:203], v[56:59], v[40:43], 0
 s_lshl_b32 s38, s38, 14
 ds_read_b64_tr_b16 v[108:109], v30 offset:8704
 ds_read_b64_tr_b16 v[110:111], v30 offset:9728
 v_mfma_f32_16x16x32_bf16 v[232:235], v[56:59], v[44:47], 0
 v_mfma_f32_16x16x32_bf16 v[140:143], v[60:63], v[32:35], 0
 s_and_b32 s54, s32, 1
 ds_read_b64_tr_b16 v[112:113], v27 offset:8832
 ds_read_b64_tr_b16 v[114:115], v27 offset:9856
 v_mfma_f32_16x16x32_bf16 v[172:175], v[60:63], v[36:39], 0
 s_lshl_b32 s54, s54, 11
 v_accvgpr_read_b32 v0, a128
 v_accvgpr_read_b32 v1, a129
 v_mfma_f32_16x16x32_bf16 v[204:207], v[60:63], v[40:43], 0
L_pad3:
 s_cbranch_execz L_pad11
 s_add_u32 s41, s38, s54
 ds_read_b64_tr_b16 v[116:117], v28 offset:8832
 ds_read_b64_tr_b16 v[118:119], v28 offset:9856
 v_mfma_f32_16x16x32_bf16 v[236:239], v[60:63], v[44:47], 0
 buffer_load_dwordx4 v19, s[24:27], s36 offen offset:2048 lds
 v_mfma_f32_16x16x32_bf16 v[144:147], v[64:67], v[32:35], 0
 s_add_u32 s38, s41, s54
 ds_read_b64_tr_b16 v[120:121], v29 offset:8832
 ds_read_b64_tr_b16 v[122:123], v29 offset:9856
 v_mfma_f32_16x16x32_bf16 v[176:179], v[64:67], v[36:39], 0
 s_add_u32 s38, s38, 8192
 v_accvgpr_read_b32 v2, a130
 v_accvgpr_read_b32 v3, a131
 v_mfma_f32_16x16x32_bf16 v[208:211], v[64:67], v[40:43], 0
 s_mov_b32 s40, 0x3e0293ee
 ds_read_b64_tr_b16 v[124:125], v30 offset:8832
 ds_read_b64_tr_b16 v[126:127], v30 offset:9856
 v_mfma_f32_16x16x32_bf16 v[240:243], v[64:67], v[44:47], 0
 s_mov_b32 s16, s94
 v_cvt_pk_bf16_f32 v0, v0, v1
 v_cvt_pk_bf16_f32 v1, v2, v3
 v_mfma_f32_16x16x32_bf16 v[148:151], v[68:71], v[32:35], 0
 s_mov_b32 s17, s95
 v_cvt_pk_bf16_f32 v2, v4, v5
 v_cvt_pk_bf16_f32 v3, v6, v7
 v_mfma_f32_16x16x32_bf16 v[180:183], v[68:71], v[36:39], 0
 buffer_load_dwordx4 v20, s[24:27], s36 offen offset:3072 lds
 v_mfma_f32_16x16x32_bf16 v[212:215], v[68:71], v[40:43], 0
 s_add_u32 s37, s49, 1310720
 v_accvgpr_read_b32 v12, a32
 v_accvgpr_read_b32 v13, a33
 v_mfma_f32_16x16x32_bf16 v[244:247], v[68:71], v[44:47], 0
 s_add_u32 m0, s50, 43520
 v_accvgpr_read_b32 v14, a34
 v_accvgpr_read_b32 v15, a35
 v_mfma_f32_16x16x32_bf16 v[152:155], v[72:75], v[32:35], 0
 buffer_load_dwordx4 v21, s[20:23], s37 offen offset:0 lds
 v_mfma_f32_16x16x32_bf16 v[184:187], v[72:75], v[36:39], 0
 s_mov_b32 s18, 33554432
 v_accvgpr_read_b32 v8, a0
 v_accvgpr_read_b32 v9, a1
 v_mfma_f32_16x16x32_bf16 v[216:219], v[72:75], v[40:43], 0
 v_accvgpr_read_b32 v10, a2
 v_accvgpr_read_b32 v11, a3
 v_mfma_f32_16x16x32_bf16 v[248:251], v[72:75], v[44:47], 0
 buffer_store_dwordx4 v[0:3], v16, s[16:19], s38 offen offset:0
 v_mfma_f32_16x16x32_bf16 v[156:159], v[76:79], v[32:35], 0
 v_mul_f32 v8, s40, v8
 v_mul_f32 v9, s40, v9
 v_mfma_f32_16x16x32_bf16 v[188:191], v[76:79], v[36:39], 0
 v_mul_f32 v10, s40, v10
 v_mul_f32 v11, s40, v11
 v_mfma_f32_16x16x32_bf16 v[220:223], v[76:79], v[40:43], 0
 buffer_load_dwordx4 v22, s[20:23], s37 offen offset:1024 lds
 v_mfma_f32_16x16x32_bf16 v[252:255], v[76:79], v[44:47], 0
 s_waitcnt vmcnt(16) lgkmcnt(0)
 s_barrier
 v_mul_f32 v12, s40, v12
 v_mul_f32 v13, s40, v13
 v_mfma_f32_16x16x32_bf16 v[128:131], v[96:99], v[80:83], v[128:131]
 ds_read_b64_tr_b16 v[48:49], v27 offset:17408
 ds_read_b64_tr_b16 v[50:51], v27 offset:18432
 v_mfma_f32_16x16x32_bf16 v[160:163], v[96:99], v[84:87], v[160:163]
 s_add_u32 s36, s44, 384
 v_mul_f32 v14, s40, v14
 v_mul_f32 v15, s40, v15
 v_mfma_f32_16x16x32_bf16 v[192:195], v[96:99], v[88:91], v[192:195]
 s_add_u32 m0, s42, 65536
 ds_read_b128 v[32:35], v23 offset:0
 ds_read_b128 v[36:39], v23 offset:2048
 v_mfma_f32_16x16x32_bf16 v[224:227], v[96:99], v[92:95], v[224:227]
 buffer_load_dwordx4 v17, s[24:27], s36 offen offset:0 lds
 v_mfma_f32_16x16x32_bf16 v[132:135], v[100:103], v[80:83], v[132:135]
 ds_read_b128 v[40:43], v23 offset:4096
 ds_read_b128 v[44:47], v23 offset:6144
 v_mfma_f32_16x16x32_bf16 v[164:167], v[100:103], v[84:87], v[164:167]
 v_cvt_pk_bf16_f32 v8, v8, v9
 v_cvt_pk_bf16_f32 v9, v10, v11
 v_mfma_f32_16x16x32_bf16 v[196:199], v[100:103], v[88:91], v[196:199]
 ds_read_b64_tr_b16 v[52:53], v28 offset:17408
 ds_read_b64_tr_b16 v[54:55], v28 offset:18432
 v_mfma_f32_16x16x32_bf16 v[228:231], v[100:103], v[92:95], v[228:231]
 buffer_load_dwordx4 v18, s[24:27], s36 offen offset:1024 lds
 v_mfma_f32_16x16x32_bf16 v[136:139], v[104:107], v[80:83], v[136:139]
 ds_read_b64_tr_b16 v[56:57], v29 offset:17408
 ds_read_b64_tr_b16 v[58:59], v29 offset:18432
 v_mfma_f32_16x16x32_bf16 v[168:171], v[104:107], v[84:87], v[168:171]
 v_cvt_pk_bf16_f32 v10, v12, v13
 v_cvt_pk_bf16_f32 v11, v14, v15
 v_mfma_f32_16x16x32_bf16 v[200:203], v[104:107], v[88:91], v[200:203]
 ds_read_b64_tr_b16 v[60:61], v30 offset:17408
 ds_read_b64_tr_b16 v[62:63], v30 offset:18432
 v_mfma_f32_16x16x32_bf16 v[232:235], v[104:107], v[92:95], v[232:235]
 buffer_store_dwordx4 v[8:11], v16, s[16:19], s41 offen offset:0
 v_mfma_f32_16x16x32_bf16 v[140:143], v[108:111], v[80:83], v[140:143]
 ds_read_b64_tr_b16 v[64:65], v27 offset:17536
 ds_read_b64_tr_b16 v[66:67], v27 offset:18560
 v_mfma_f32_16x16x32_bf16 v[172:175], v[108:111], v[84:87], v[172:175]
 v_accvgpr_read_b32 v4, a164
 v_accvgpr_read_b32 v5, a165
 v_mfma_f32_16x16x32_bf16 v[204:207], v[108:111], v[88:91], v[204:207]
 ds_read_b64_tr_b16 v[68:69], v28 offset:17536
 ds_read_b64_tr_b16 v[70:71], v28 offset:18560
 v_mfma_f32_16x16x32_bf16 v[236:239], v[108:111], v[92:95], v[236:239]
 buffer_load_dwordx4 v19, s[24:27], s36 offen offset:2048 lds
 v_mfma_f32_16x16x32_bf16 v[144:147], v[112:115], v[80:83], v[144:147]
 ds_read_b64_tr_b16 v[72:73], v29 offset:17536
 ds_read_b64_tr_b16 v[74:75], v29 offset:18560
 v_mfma_f32_16x16x32_bf16 v[176:179], v[112:115], v[84:87], v[176:179]
 v_accvgpr_read_b32 v6, a166
 v_accvgpr_read_b32 v7, a167
 v_mfma_f32_16x16x32_bf16 v[208:211], v[112:115], v[88:91], v[208:211]
 ds_read_b64_tr_b16 v[76:77], v30 offset:17536
 ds_read_b64_tr_b16 v[78:79], v30 offset:18560
 v_mfma_f32_16x16x32_bf16 v[240:243], v[112:115], v[92:95], v[240:243]
 v_accvgpr_read_b32 v0, a160
 v_accvgpr_read_b32 v1, a161
 v_mfma_f32_16x16x32_bf16 v[148:151], v[116:119], v[80:83], v[148:151]
 v_accvgpr_read_b32 v2, a162
 v_accvgpr_read_b32 v3, a163
 v_mfma_f32_16x16x32_bf16 v[180:183], v[116:119], v[84:87], v[180:183]
 buffer_load_dwordx4 v20, s[24:27], s36 offen offset:3072 lds
 v_mfma_f32_16x16x32_bf16 v[212:215], v[116:119], v[88:91], v[212:215]
 s_add_u32 s37, s49, 1572864
 v_cvt_pk_bf16_f32 v0, v0, v1
 v_cvt_pk_bf16_f32 v1, v2, v3
 v_mfma_f32_16x16x32_bf16 v[244:247], v[116:119], v[92:95], v[244:247]
 s_add_u32 m0, s50, 0
 v_cvt_pk_bf16_f32 v2, v4, v5
 v_cvt_pk_bf16_f32 v3, v6, v7
 v_mfma_f32_16x16x32_bf16 v[152:155], v[120:123], v[80:83], v[152:155]
 buffer_load_dwordx4 v21, s[20:23], s37 offen offset:0 lds
 v_mfma_f32_16x16x32_bf16 v[184:187], v[120:123], v[84:87], v[184:187]
 v_accvgpr_read_b32 v12, a96
 v_accvgpr_read_b32 v13, a97
 v_mfma_f32_16x16x32_bf16 v[216:219], v[120:123], v[88:91], v[216:219]
 v_accvgpr_read_b32 v14, a98
 v_accvgpr_read_b32 v15, a99
 v_mfma_f32_16x16x32_bf16 v[248:251], v[120:123], v[92:95], v[248:251]
 buffer_store_dwordx4 v[0:3], v16, s[16:19], s38 offen offset:1024
 v_mfma_f32_16x16x32_bf16 v[156:159], v[124:127], v[80:83], v[156:159]
 v_accvgpr_read_b32 v8, a64
 v_accvgpr_read_b32 v9, a65
 v_mfma_f32_16x16x32_bf16 v[188:191], v[124:127], v[84:87], v[188:191]
 v_accvgpr_read_b32 v10, a66
 v_accvgpr_read_b32 v11, a67
 v_mfma_f32_16x16x32_bf16 v[220:223], v[124:127], v[88:91], v[220:223]
 buffer_load_dwordx4 v22, s[20:23], s37 offen offset:1024 lds
 v_mfma_f32_16x16x32_bf16 v[252:255], v[124:127], v[92:95], v[252:255]
 s_waitcnt lgkmcnt(0)
 v_mul_f32 v8, s40, v8
 v_mul_f32 v9, s40, v9
 v_mfma_f32_16x16x32_bf16 v[128:131], v[48:51], v[32:35], v[128:131]
 ds_read_b64_tr_b16 v[96:97], v27 offset:26112
 ds_read_b64_tr_b16 v[98:99], v27 offset:27136
 v_mfma_f32_16x16x32_bf16 v[160:163], v[48:51], v[36:39], v[160:163]
 s_add_u32 s36, s45, 384
 v_mul_f32 v10, s40, v10
 v_mul_f32 v11, s40, v11
 v_mfma_f32_16x16x32_bf16 v[192:195], v[48:51], v[40:43], v[192:195]
 s_add_u32 m0, s42, 69632
 ds_read_b128 v[80:83], v24 offset:0
 ds_read_b128 v[84:87], v24 offset:2048
 v_mfma_f32_16x16x32_bf16 v[224:227], v[48:51], v[44:47], v[224:227]
 buffer_load_dwordx4 v17, s[24:27], s36 offen offset:0 lds
 v_mfma_f32_16x16x32_bf16 v[132:135], v[52:55], v[32:35], v[132:135]
 ds_read_b128 v[88:91], v24 offset:4096
 ds_read_b128 v[92:95], v24 offset:6144
 v_mfma_f32_16x16x32_bf16 v[164:167], v[52:55], v[36:39], v[164:167]
 v_mul_f32 v12, s40, v12
 v_mul_f32 v13, s40, v13
 v_mfma_f32_16x16x32_bf16 v[196:199], v[52:55], v[40:43], v[196:199]
 ds_read_b64_tr_b16 v[100:101], v28 offset:26112
 ds_read_b64_tr_b16 v[102:103], v28 offset:27136
 v_mfma_f32_16x16x32_bf16 v[228:231], v[52:55], v[44:47], v[228:231]
 buffer_load_dwordx4 v18, s[24:27], s36 offen offset:1024 lds
 v_mfma_f32_16x16x32_bf16 v[136:139], v[56:59], v[32:35], v[136:139]
 ds_read_b64_tr_b16 v[104:105], v29 offset:26112
 ds_read_b64_tr_b16 v[106:107], v29 offset:27136
 v_mfma_f32_16x16x32_bf16 v[168:171], v[56:59], v[36:39], v[168:171]
 v_mul_f32 v14, s40, v14
 v_mul_f32 v15, s40, v15
 v_mfma_f32_16x16x32_bf16 v[200:203], v[56:59], v[40:43], v[200:203]
 ds_read_b64_tr_b16 v[108:109], v30 offset:26112
 ds_read_b64_tr_b16 v[110:111], v30 offset:27136
 v_mfma_f32_16x16x32_bf16 v[232:235], v[56:59], v[44:47], v[232:235]
 v_mfma_f32_16x16x32_bf16 v[140:143], v[60:63], v[32:35], v[140:143]
 ds_read_b64_tr_b16 v[112:113], v27 offset:26240
 ds_read_b64_tr_b16 v[114:115], v27 offset:27264
 v_mfma_f32_16x16x32_bf16 v[172:175], v[60:63], v[36:39], v[172:175]
 v_cvt_pk_bf16_f32 v8, v8, v9
 v_cvt_pk_bf16_f32 v9, v10, v11
 v_mfma_f32_16x16x32_bf16 v[204:207], v[60:63], v[40:43], v[204:207]
 ds_read_b64_tr_b16 v[116:117], v28 offset:26240
 ds_read_b64_tr_b16 v[118:119], v28 offset:27264
 v_mfma_f32_16x16x32_bf16 v[236:239], v[60:63], v[44:47], v[236:239]
 buffer_load_dwordx4 v19, s[24:27], s36 offen offset:2048 lds
 v_mfma_f32_16x16x32_bf16 v[144:147], v[64:67], v[32:35], v[144:147]
 ds_read_b64_tr_b16 v[120:121], v29 offset:26240
 ds_read_b64_tr_b16 v[122:123], v29 offset:27264
 v_mfma_f32_16x16x32_bf16 v[176:179], v[64:67], v[36:39], v[176:179]
 v_cvt_pk_bf16_f32 v10, v12, v13
 v_cvt_pk_bf16_f32 v11, v14, v15
 v_mfma_f32_16x16x32_bf16 v[208:211], v[64:67], v[40:43], v[208:211]
 ds_read_b64_tr_b16 v[124:125], v30 offset:26240
 ds_read_b64_tr_b16 v[126:127], v30 offset:27264
 v_mfma_f32_16x16x32_bf16 v[240:243], v[64:67], v[44:47], v[240:243]
 v_accvgpr_read_b32 v4, a196
 v_accvgpr_read_b32 v5, a197
 v_mfma_f32_16x16x32_bf16 v[148:151], v[68:71], v[32:35], v[148:151]
 v_accvgpr_read_b32 v6, a198
 v_accvgpr_read_b32 v7, a199
 v_mfma_f32_16x16x32_bf16 v[180:183], v[68:71], v[36:39], v[180:183]
 buffer_load_dwordx4 v20, s[24:27], s36 offen offset:3072 lds
 v_mfma_f32_16x16x32_bf16 v[212:215], v[68:71], v[40:43], v[212:215]
 s_add_u32 s37, s49, 1835008
 v_accvgpr_read_b32 v0, a192
 v_accvgpr_read_b32 v1, a193
 v_mfma_f32_16x16x32_bf16 v[244:247], v[68:71], v[44:47], v[244:247]
 s_add_u32 m0, s50, 8704
 v_accvgpr_read_b32 v2, a194
 v_accvgpr_read_b32 v3, a195
 v_mfma_f32_16x16x32_bf16 v[152:155], v[72:75], v[32:35], v[152:155]
 buffer_load_dwordx4 v21, s[20:23], s37 offen offset:0 lds
 v_mfma_f32_16x16x32_bf16 v[184:187], v[72:75], v[36:39], v[184:187]
 v_cvt_pk_bf16_f32 v0, v0, v1
 v_cvt_pk_bf16_f32 v1, v2, v3
 v_mfma_f32_16x16x32_bf16 v[216:219], v[72:75], v[40:43], v[216:219]
 v_cvt_pk_bf16_f32 v2, v4, v5
 v_cvt_pk_bf16_f32 v3, v6, v7
 v_mfma_f32_16x16x32_bf16 v[248:251], v[72:75], v[44:47], v[248:251]
 buffer_store_dwordx4 v[8:11], v16, s[16:19], s41 offen offset:1024
 v_mfma_f32_16x16x32_bf16 v[156:159], v[76:79], v[32:35], v[156:159]
 s_add_u32 s41, s41, 4096
 v_accvgpr_read_b32 v12, a36
 v_accvgpr_read_b32 v13, a37
 v_mfma_f32_16x16x32_bf16 v[188:191], v[76:79], v[36:39], v[188:191]
 v_accvgpr_read_b32 v14, a38
 v_accvgpr_read_b32 v15, a39
 v_mfma_f32_16x16x32_bf16 v[220:223], v[76:79], v[40:43], v[220:223]
 buffer_load_dwordx4 v22, s[20:23], s37 offen offset:1024 lds
 v_mfma_f32_16x16x32_bf16 v[252:255], v[76:79], v[44:47], v[252:255]
 s_waitcnt vmcnt(15) lgkmcnt(0)
 s_barrier
 v_accvgpr_read_b32 v8, a4
 v_accvgpr_read_b32 v9, a5
 v_mfma_f32_16x16x32_bf16 v[128:131], v[96:99], v[80:83], v[128:131]
 ds_read_b64_tr_b16 v[48:49], v27 offset:34816
 ds_read_b64_tr_b16 v[50:51], v27 offset:35840
 v_mfma_f32_16x16x32_bf16 v[160:163], v[96:99], v[84:87], v[160:163]
 s_add_u32 s36, s44, 512
 v_accvgpr_read_b32 v10, a6
 v_accvgpr_read_b32 v11, a7
 v_mfma_f32_16x16x32_bf16 v[192:195], v[96:99], v[88:91], v[192:195]
 s_add_u32 m0, s42, 0
 ds_read_b128 v[32:35], v23 offset:32768
 ds_read_b128 v[36:39], v23 offset:34816
 v_mfma_f32_16x16x32_bf16 v[224:227], v[96:99], v[92:95], v[224:227]
 buffer_load_dwordx4 v17, s[24:27], s36 offen offset:0 lds
 v_mfma_f32_16x16x32_bf16 v[132:135], v[100:103], v[80:83], v[132:135]
 ds_read_b128 v[40:43], v23 offset:36864
 ds_read_b128 v[44:47], v23 offset:38912
 v_mfma_f32_16x16x32_bf16 v[164:167], v[100:103], v[84:87], v[164:167]
 v_mul_f32 v8, s40, v8
 v_mul_f32 v9, s40, v9
 v_mfma_f32_16x16x32_bf16 v[196:199], v[100:103], v[88:91], v[196:199]
 ds_read_b64_tr_b16 v[52:53], v28 offset:34816
 ds_read_b64_tr_b16 v[54:55], v28 offset:35840
 v_mfma_f32_16x16x32_bf16 v[228:231], v[100:103], v[92:95], v[228:231]
 buffer_load_dwordx4 v18, s[24:27], s36 offen offset:1024 lds
 v_mfma_f32_16x16x32_bf16 v[136:139], v[104:107], v[80:83], v[136:139]
 ds_read_b64_tr_b16 v[56:57], v29 offset:34816
 ds_read_b64_tr_b16 v[58:59], v29 offset:35840
 v_mfma_f32_16x16x32_bf16 v[168:171], v[104:107], v[84:87], v[168:171]
 v_mul_f32 v10, s40, v10
 v_mul_f32 v11, s40, v11
 v_mfma_f32_16x16x32_bf16 v[200:203], v[104:107], v[88:91], v[200:203]
 ds_read_b64_tr_b16 v[60:61], v30 offset:34816
 ds_read_b64_tr_b16 v[62:63], v30 offset:35840
 v_mfma_f32_16x16x32_bf16 v[232:235], v[104:107], v[92:95], v[232:235]
 buffer_store_dwordx4 v[0:3], v16, s[16:19], s38 offen offset:2048
 v_mfma_f32_16x16x32_bf16 v[140:143], v[108:111], v[80:83], v[140:143]
 ds_read_b64_tr_b16 v[64:65], v27 offset:34944
 ds_read_b64_tr_b16 v[66:67], v27 offset:35968
 v_mfma_f32_16x16x32_bf16 v[172:175], v[108:111], v[84:87], v[172:175]
 v_mul_f32 v12, s40, v12
 v_mul_f32 v13, s40, v13
 v_mfma_f32_16x16x32_bf16 v[204:207], v[108:111], v[88:91], v[204:207]
 ds_read_b64_tr_b16 v[68:69], v28 offset:34944
 ds_read_b64_tr_b16 v[70:71], v28 offset:35968
 v_mfma_f32_16x16x32_bf16 v[236:239], v[108:111], v[92:95], v[236:239]
 buffer_load_dwordx4 v19, s[24:27], s36 offen offset:2048 lds
 v_mfma_f32_16x16x32_bf16 v[144:147], v[112:115], v[80:83], v[144:147]
 ds_read_b64_tr_b16 v[72:73], v29 offset:34944
 ds_read_b64_tr_b16 v[74:75], v29 offset:35968
 v_mfma_f32_16x16x32_bf16 v[176:179], v[112:115], v[84:87], v[176:179]
 v_mul_f32 v14, s40, v14
 v_mul_f32 v15, s40, v15
 v_mfma_f32_16x16x32_bf16 v[208:211], v[112:115], v[88:91], v[208:211]
 ds_read_b64_tr_b16 v[76:77], v30 offset:34944
 ds_read_b64_tr_b16 v[78:79], v30 offset:35968
 v_mfma_f32_16x16x32_bf16 v[240:243], v[112:115], v[92:95], v[240:243]
 v_cvt_pk_bf16_f32 v8, v8, v9
 v_cvt_pk_bf16_f32 v9, v10, v11
 v_mfma_f32_16x16x32_bf16 v[148:151], v[116:119], v[80:83], v[148:151]
 v_cvt_pk_bf16_f32 v10, v12, v13
 v_cvt_pk_bf16_f32 v11, v14, v15
 v_mfma_f32_16x16x32_bf16 v[180:183], v[116:119], v[84:87], v[180:183]
 buffer_load_dwordx4 v20, s[24:27], s36 offen offset:3072 lds
 v_mfma_f32_16x16x32_bf16 v[212:215], v[116:119], v[88:91], v[212:215]
 s_add_u32 s37, s49, 2097152
 v_accvgpr_read_b32 v4, a228
 v_accvgpr_read_b32 v5, a229
 v_mfma_f32_16x16x32_bf16 v[244:247], v[116:119], v[92:95], v[244:247]
 s_add_u32 m0, s50, 17408
 v_accvgpr_read_b32 v6, a230
 v_accvgpr_read_b32 v7, a231
 v_mfma_f32_16x16x32_bf16 v[152:155], v[120:123], v[80:83], v[152:155]
 buffer_load_dwordx4 v21, s[20:23], s37 offen offset:0 lds
 v_mfma_f32_16x16x32_bf16 v[184:187], v[120:123], v[84:87], v[184:187]
 v_accvgpr_read_b32 v0, a224
 v_accvgpr_read_b32 v1, a225
 v_mfma_f32_16x16x32_bf16 v[216:219], v[120:123], v[88:91], v[216:219]
 v_accvgpr_read_b32 v2, a226
 v_accvgpr_read_b32 v3, a227
 v_mfma_f32_16x16x32_bf16 v[248:251], v[120:123], v[92:95], v[248:251]
 buffer_store_dwordx4 v[8:11], v16, s[16:19], s41 offen offset:0
 v_mfma_f32_16x16x32_bf16 v[156:159], v[124:127], v[80:83], v[156:159]
 v_cvt_pk_bf16_f32 v0, v0, v1
 v_cvt_pk_bf16_f32 v1, v2, v3
 v_mfma_f32_16x16x32_bf16 v[188:191], v[124:127], v[84:87], v[188:191]
 v_cvt_pk_bf16_f32 v2, v4, v5
 v_cvt_pk_bf16_f32 v3, v6, v7
 v_mfma_f32_16x16x32_bf16 v[220:223], v[124:127], v[88:91], v[220:223]
 buffer_load_dwordx4 v22, s[20:23], s37 offen offset:1024 lds
 v_mfma_f32_16x16x32_bf16 v[252:255], v[124:127], v[92:95], v[252:255]
 s_waitcnt lgkmcnt(0)
 v_accvgpr_read_b32 v12, a100
 v_accvgpr_read_b32 v13, a101
 v_mfma_f32_16x16x32_bf16 v[128:131], v[48:51], v[32:35], v[128:131]
 ds_read_b64_tr_b16 v[96:97], v27 offset:43520
 ds_read_b64_tr_b16 v[98:99], v27 offset:44544
 v_mfma_f32_16x16x32_bf16 v[160:163], v[48:51], v[36:39], v[160:163]
 s_add_u32 s36, s45, 512
 v_accvgpr_read_b32 v14, a102
 v_accvgpr_read_b32 v15, a103
 v_mfma_f32_16x16x32_bf16 v[192:195], v[48:51], v[40:43], v[192:195]
 s_add_u32 m0, s42, 4096
 ds_read_b128 v[80:83], v24 offset:32768
 ds_read_b128 v[84:87], v24 offset:34816
 v_mfma_f32_16x16x32_bf16 v[224:227], v[48:51], v[44:47], v[224:227]
 buffer_load_dwordx4 v17, s[24:27], s36 offen offset:0 lds
 v_mfma_f32_16x16x32_bf16 v[132:135], v[52:55], v[32:35], v[132:135]
 ds_read_b128 v[88:91], v24 offset:36864
 ds_read_b128 v[92:95], v24 offset:38912
 v_mfma_f32_16x16x32_bf16 v[164:167], v[52:55], v[36:39], v[164:167]
 v_accvgpr_read_b32 v8, a68
 v_accvgpr_read_b32 v9, a69
 v_mfma_f32_16x16x32_bf16 v[196:199], v[52:55], v[40:43], v[196:199]
 ds_read_b64_tr_b16 v[100:101], v28 offset:43520
 ds_read_b64_tr_b16 v[102:103], v28 offset:44544
 v_mfma_f32_16x16x32_bf16 v[228:231], v[52:55], v[44:47], v[228:231]
 buffer_load_dwordx4 v18, s[24:27], s36 offen offset:1024 lds
 v_mfma_f32_16x16x32_bf16 v[136:139], v[56:59], v[32:35], v[136:139]
 ds_read_b64_tr_b16 v[104:105], v29 offset:43520
 ds_read_b64_tr_b16 v[106:107], v29 offset:44544
 v_mfma_f32_16x16x32_bf16 v[168:171], v[56:59], v[36:39], v[168:171]
 v_accvgpr_read_b32 v10, a70
 v_accvgpr_read_b32 v11, a71
 v_mfma_f32_16x16x32_bf16 v[200:203], v[56:59], v[40:43], v[200:203]
 ds_read_b64_tr_b16 v[108:109], v30 offset:43520
 ds_read_b64_tr_b16 v[110:111], v30 offset:44544
 v_mfma_f32_16x16x32_bf16 v[232:235], v[56:59], v[44:47], v[232:235]
 buffer_store_dwordx4 v[0:3], v16, s[16:19], s38 offen offset:3072
 v_mfma_f32_16x16x32_bf16 v[140:143], v[60:63], v[32:35], v[140:143]
 s_add_u32 s38, s38, 16384
 ds_read_b64_tr_b16 v[112:113], v27 offset:43648
 ds_read_b64_tr_b16 v[114:115], v27 offset:44672
 v_mfma_f32_16x16x32_bf16 v[172:175], v[60:63], v[36:39], v[172:175]
 v_mul_f32 v8, s40, v8
 v_mul_f32 v9, s40, v9
 v_mfma_f32_16x16x32_bf16 v[204:207], v[60:63], v[40:43], v[204:207]
 ds_read_b64_tr_b16 v[116:117], v28 offset:43648
 ds_read_b64_tr_b16 v[118:119], v28 offset:44672
 v_mfma_f32_16x16x32_bf16 v[236:239], v[60:63], v[44:47], v[236:239]
 buffer_load_dwordx4 v19, s[24:27], s36 offen offset:2048 lds
 v_mfma_f32_16x16x32_bf16 v[144:147], v[64:67], v[32:35], v[144:147]
 ds_read_b64_tr_b16 v[120:121], v29 offset:43648
 ds_read_b64_tr_b16 v[122:123], v29 offset:44672
 v_mfma_f32_16x16x32_bf16 v[176:179], v[64:67], v[36:39], v[176:179]
 v_mul_f32 v10, s40, v10
 v_mul_f32 v11, s40, v11
 v_mfma_f32_16x16x32_bf16 v[208:211], v[64:67], v[40:43], v[208:211]
 ds_read_b64_tr_b16 v[124:125], v30 offset:43648
 ds_read_b64_tr_b16 v[126:127], v30 offset:44672
 v_mfma_f32_16x16x32_bf16 v[240:243], v[64:67], v[44:47], v[240:243]
 v_mul_f32 v12, s40, v12
 v_mul_f32 v13, s40, v13
 v_mfma_f32_16x16x32_bf16 v[148:151], v[68:71], v[32:35], v[148:151]
 v_mul_f32 v14, s40, v14
 v_mul_f32 v15, s40, v15
 v_mfma_f32_16x16x32_bf16 v[180:183], v[68:71], v[36:39], v[180:183]
 buffer_load_dwordx4 v20, s[24:27], s36 offen offset:3072 lds
 v_mfma_f32_16x16x32_bf16 v[212:215], v[68:71], v[40:43], v[212:215]
 s_add_u32 s37, s49, 2359296
 v_cvt_pk_bf16_f32 v8, v8, v9
 v_cvt_pk_bf16_f32 v9, v10, v11
 v_mfma_f32_16x16x32_bf16 v[244:247], v[68:71], v[44:47], v[244:247]
 s_add_u32 m0, s50, 26112
 v_cvt_pk_bf16_f32 v10, v12, v13
 v_cvt_pk_bf16_f32 v11, v14, v15
 v_mfma_f32_16x16x32_bf16 v[152:155], v[72:75], v[32:35], v[152:155]
 buffer_load_dwordx4 v21, s[20:23], s37 offen offset:0 lds
 v_mfma_f32_16x16x32_bf16 v[184:187], v[72:75], v[36:39], v[184:187]
 v_accvgpr_read_b32 v4, a140
 v_accvgpr_read_b32 v5, a141
 v_mfma_f32_16x16x32_bf16 v[216:219], v[72:75], v[40:43], v[216:219]
 v_accvgpr_read_b32 v6, a142
 v_accvgpr_read_b32 v7, a143
 v_mfma_f32_16x16x32_bf16 v[248:251], v[72:75], v[44:47], v[248:251]
 buffer_store_dwordx4 v[8:11], v16, s[16:19], s41 offen offset:1024
 v_mfma_f32_16x16x32_bf16 v[156:159], v[76:79], v[32:35], v[156:159]
 s_add_u32 s41, s41, 12288
 v_accvgpr_read_b32 v0, a136
 v_accvgpr_read_b32 v1, a137
 v_mfma_f32_16x16x32_bf16 v[188:191], v[76:79], v[36:39], v[188:191]
 v_accvgpr_read_b32 v2, a138
 v_accvgpr_read_b32 v3, a139
 v_mfma_f32_16x16x32_bf16 v[220:223], v[76:79], v[40:43], v[220:223]
 buffer_load_dwordx4 v22, s[20:23], s37 offen offset:1024 lds
 v_mfma_f32_16x16x32_bf16 v[252:255], v[76:79], v[44:47], v[252:255]
 s_waitcnt vmcnt(16) lgkmcnt(0)
 s_barrier
 v_cvt_pk_bf16_f32 v0, v0, v1
 v_cvt_pk_bf16_f32 v1, v2, v3
 v_mfma_f32_16x16x32_bf16 v[128:131], v[96:99], v[80:83], v[128:131]
 ds_read_b64_tr_b16 v[48:49], v27 offset:0
 ds_read_b64_tr_b16 v[50:51], v27 offset:1024
 v_mfma_f32_16x16x32_bf16 v[160:163], v[96:99], v[84:87], v[160:163]
 s_add_u32 s36, s44, 640
 v_cvt_pk_bf16_f32 v2, v4, v5
 v_cvt_pk_bf16_f32 v3, v6, v7
 v_mfma_f32_16x16x32_bf16 v[192:195], v[96:99], v[88:91], v[192:195]
 s_add_u32 m0, s42, 32768
 ds_read_b128 v[32:35], v25 offset:0
 ds_read_b128 v[36:39], v25 offset:2048
 v_mfma_f32_16x16x32_bf16 v[224:227], v[96:99], v[92:95], v[224:227]
 buffer_load_dwordx4 v17, s[24:27], s36 offen offset:0 lds
 v_mfma_f32_16x16x32_bf16 v[132:135], v[100:103], v[80:83], v[132:135]
 ds_read_b128 v[40:43], v25 offset:4096
 ds_read_b128 v[44:47], v25 offset:6144
 v_mfma_f32_16x16x32_bf16 v[164:167], v[100:103], v[84:87], v[164:167]
 v_accvgpr_read_b32 v12, a40
 v_accvgpr_read_b32 v13, a41
 v_mfma_f32_16x16x32_bf16 v[196:199], v[100:103], v[88:91], v[196:199]
 ds_read_b64_tr_b16 v[52:53], v28 offset:0
 ds_read_b64_tr_b16 v[54:55], v28 offset:1024
 v_mfma_f32_16x16x32_bf16 v[228:231], v[100:103], v[92:95], v[228:231]
 buffer_load_dwordx4 v18, s[24:27], s36 offen offset:1024 lds
 v_mfma_f32_16x16x32_bf16 v[136:139], v[104:107], v[80:83], v[136:139]
 ds_read_b64_tr_b16 v[56:57], v29 offset:0
 ds_read_b64_tr_b16 v[58:59], v29 offset:1024
 v_mfma_f32_16x16x32_bf16 v[168:171], v[104:107], v[84:87], v[168:171]
 v_accvgpr_read_b32 v14, a42
 v_accvgpr_read_b32 v15, a43
 v_mfma_f32_16x16x32_bf16 v[200:203], v[104:107], v[88:91], v[200:203]
 ds_read_b64_tr_b16 v[60:61], v30 offset:0
 ds_read_b64_tr_b16 v[62:63], v30 offset:1024
 v_mfma_f32_16x16x32_bf16 v[232:235], v[104:107], v[92:95], v[232:235]
 buffer_store_dwordx4 v[0:3], v16, s[16:19], s38 offen offset:0
 v_mfma_f32_16x16x32_bf16 v[140:143], v[108:111], v[80:83], v[140:143]
 ds_read_b64_tr_b16 v[64:65], v27 offset:128
 ds_read_b64_tr_b16 v[66:67], v27 offset:1152
 v_mfma_f32_16x16x32_bf16 v[172:175], v[108:111], v[84:87], v[172:175]
 v_accvgpr_read_b32 v8, a8
 v_accvgpr_read_b32 v9, a9
 v_mfma_f32_16x16x32_bf16 v[204:207], v[108:111], v[88:91], v[204:207]
 ds_read_b64_tr_b16 v[68:69], v28 offset:128
 ds_read_b64_tr_b16 v[70:71], v28 offset:1152
 v_mfma_f32_16x16x32_bf16 v[236:239], v[108:111], v[92:95], v[236:239]
 buffer_load_dwordx4 v19, s[24:27], s36 offen offset:2048 lds
 v_mfma_f32_16x16x32_bf16 v[144:147], v[112:115], v[80:83], v[144:147]
 ds_read_b64_tr_b16 v[72:73], v29 offset:128
 ds_read_b64_tr_b16 v[74:75], v29 offset:1152
 v_mfma_f32_16x16x32_bf16 v[176:179], v[112:115], v[84:87], v[176:179]
 v_accvgpr_read_b32 v10, a10
 v_accvgpr_read_b32 v11, a11
 v_mfma_f32_16x16x32_bf16 v[208:211], v[112:115], v[88:91], v[208:211]
 ds_read_b64_tr_b16 v[76:77], v30 offset:128
 ds_read_b64_tr_b16 v[78:79], v30 offset:1152
 v_mfma_f32_16x16x32_bf16 v[240:243], v[112:115], v[92:95], v[240:243]
 v_mul_f32 v8, s40, v8
 v_mul_f32 v9, s40, v9
 v_mfma_f32_16x16x32_bf16 v[148:151], v[116:119], v[80:83], v[148:151]
 v_mul_f32 v10, s40, v10
 v_mul_f32 v11, s40, v11
 v_mfma_f32_16x16x32_bf16 v[180:183], v[116:119], v[84:87], v[180:183]
 buffer_load_dwordx4 v20, s[24:27], s36 offen offset:3072 lds
 v_mfma_f32_16x16x32_bf16 v[212:215], v[116:119], v[88:91], v[212:215]
 s_add_u32 s37, s49, 2621440
 v_mul_f32 v12, s40, v12
 v_mul_f32 v13, s40, v13
 v_mfma_f32_16x16x32_bf16 v[244:247], v[116:119], v[92:95], v[244:247]
 s_add_u32 m0, s50, 34816
 v_mul_f32 v14, s40, v14
 v_mul_f32 v15, s40, v15
 v_mfma_f32_16x16x32_bf16 v[152:155], v[120:123], v[80:83], v[152:155]
 buffer_load_dwordx4 v21, s[20:23], s37 offen offset:0 lds
 v_mfma_f32_16x16x32_bf16 v[184:187], v[120:123], v[84:87], v[184:187]
 v_cvt_pk_bf16_f32 v8, v8, v9
 v_cvt_pk_bf16_f32 v9, v10, v11
 v_mfma_f32_16x16x32_bf16 v[216:219], v[120:123], v[88:91], v[216:219]
 v_cvt_pk_bf16_f32 v10, v12, v13
 v_cvt_pk_bf16_f32 v11, v14, v15
 v_mfma_f32_16x16x32_bf16 v[248:251], v[120:123], v[92:95], v[248:251]
 buffer_store_dwordx4 v[8:11], v16, s[16:19], s41 offen offset:0
 v_mfma_f32_16x16x32_bf16 v[156:159], v[124:127], v[80:83], v[156:159]
 v_accvgpr_read_b32 v4, a172
 v_accvgpr_read_b32 v5, a173
 v_mfma_f32_16x16x32_bf16 v[188:191], v[124:127], v[84:87], v[188:191]
 v_accvgpr_read_b32 v6, a174
 v_accvgpr_read_b32 v7, a175
 v_mfma_f32_16x16x32_bf16 v[220:223], v[124:127], v[88:91], v[220:223]
 buffer_load_dwordx4 v22, s[20:23], s37 offen offset:1024 lds
 v_mfma_f32_16x16x32_bf16 v[252:255], v[124:127], v[92:95], v[252:255]
 s_waitcnt lgkmcnt(0)
 v_accvgpr_read_b32 v0, a168
 v_accvgpr_read_b32 v1, a169
 v_mfma_f32_16x16x32_bf16 v[128:131], v[48:51], v[32:35], v[128:131]
 ds_read_b64_tr_b16 v[96:97], v27 offset:8704
 ds_read_b64_tr_b16 v[98:99], v27 offset:9728
 v_mfma_f32_16x16x32_bf16 v[160:163], v[48:51], v[36:39], v[160:163]
 s_add_u32 s36, s45, 640
 v_accvgpr_read_b32 v2, a170
 v_accvgpr_read_b32 v3, a171
 v_mfma_f32_16x16x32_bf16 v[192:195], v[48:51], v[40:43], v[192:195]
 s_add_u32 m0, s42, 36864
 ds_read_b128 v[80:83], v26 offset:0
 ds_read_b128 v[84:87], v26 offset:2048
 v_mfma_f32_16x16x32_bf16 v[224:227], v[48:51], v[44:47], v[224:227]
L_pad4:
 s_cbranch_execz L_pad12
 buffer_load_dwordx4 v17, s[24:27], s36 offen offset:0 lds
 v_mfma_f32_16x16x32_bf16 v[132:135], v[52:55], v[32:35], v[132:135]
 ds_read_b128 v[88:91], v26 offset:4096
 ds_read_b128 v[92:95], v26 offset:6144
 v_mfma_f32_16x16x32_bf16 v[164:167], v[52:55], v[36:39], v[164:167]
 v_cvt_pk_bf16_f32 v0, v0, v1
 v_cvt_pk_bf16_f32 v1, v2, v3
 v_mfma_f32_16x16x32_bf16 v[196:199], v[52:55], v[40:43], v[196:199]
 ds_read_b64_tr_b16 v[100:101], v28 offset:8704
 ds_read_b64_tr_b16 v[102:103], v28 offset:9728
 v_mfma_f32_16x16x32_bf16 v[228:231], v[52:55], v[44:47], v[228:231]
 buffer_load_dwordx4 v18, s[24:27], s36 offen offset:1024 lds
 v_mfma_f32_16x16x32_bf16 v[136:139], v[56:59], v[32:35], v[136:139]
 ds_read_b64_tr_b16 v[104:105], v29 offset:8704
 ds_read_b64_tr_b16 v[106:107], v29 offset:9728
 v_mfma_f32_16x16x32_bf16 v[168:171], v[56:59], v[36:39], v[168:171]
 v_cvt_pk_bf16_f32 v2, v4, v5
 v_cvt_pk_bf16_f32 v3, v6, v7
 v_mfma_f32_16x16x32_bf16 v[200:203], v[56:59], v[40:43], v[200:203]
 ds_read_b64_tr_b16 v[108:109], v30 offset:8704
 ds_read_b64_tr_b16 v[110:111], v30 offset:9728
 v_mfma_f32_16x16x32_bf16 v[232:235], v[56:59], v[44:47], v[232:235]
 buffer_store_dwordx4 v[0:3], v16, s[16:19], s38 offen offset:1024
 v_mfma_f32_16x16x32_bf16 v[140:143], v[60:63], v[32:35], v[140:143]
 ds_read_b64_tr_b16 v[112:113], v27 offset:8832
 ds_read_b64_tr_b16 v[114:115], v27 offset:9856
 v_mfma_f32_16x16x32_bf16 v[172:175], v[60:63], v[36:39], v[172:175]
 v_accvgpr_read_b32 v12, a104
 v_accvgpr_read_b32 v13, a105
 v_mfma_f32_16x16x32_bf16 v[204:207], v[60:63], v[40:43], v[204:207]
 ds_read_b64_tr_b16 v[116:117], v28 offset:8832
 ds_read_b64_tr_b16 v[118:119], v28 offset:9856
 v_mfma_f32_16x16x32_bf16 v[236:239], v[60:63], v[44:47], v[236:239]
 buffer_load_dwordx4 v19, s[24:27], s36 offen offset:2048 lds
 v_mfma_f32_16x16x32_bf16 v[144:147], v[64:67], v[32:35], v[144:147]
 ds_read_b64_tr_b16 v[120:121], v29 offset:8832
 ds_read_b64_tr_b16 v[122:123], v29 offset:9856
 v_mfma_f32_16x16x32_bf16 v[176:179], v[64:67], v[36:39], v[176:179]
 v_accvgpr_read_b32 v14, a106
 v_accvgpr_read_b32 v15, a107
 v_mfma_f32_16x16x32_bf16 v[208:211], v[64:67], v[40:43], v[208:211]
 ds_read_b64_tr_b16 v[124:125], v30 offset:8832
 ds_read_b64_tr_b16 v[126:127], v30 offset:9856
 v_mfma_f32_16x16x32_bf16 v[240:243], v[64:67], v[44:47], v[240:243]
 v_accvgpr_read_b32 v8, a72
 v_accvgpr_read_b32 v9, a73
 v_mfma_f32_16x16x32_bf16 v[148:151], v[68:71], v[32:35], v[148:151]
 v_accvgpr_read_b32 v10, a74
 v_accvgpr_read_b32 v11, a75
 v_mfma_f32_16x16x32_bf16 v[180:183], v[68:71], v[36:39], v[180:183]
 buffer_load_dwordx4 v20, s[24:27], s36 offen offset:3072 lds
 v_mfma_f32_16x16x32_bf16 v[212:215], v[68:71], v[40:43], v[212:215]
 s_add_u32 s37, s49, 2883584
 v_mul_f32 v8, s40, v8
 v_mul_f32 v9, s40, v9
 v_mfma_f32_16x16x32_bf16 v[244:247], v[68:71], v[44:47], v[244:247]
 s_add_u32 m0, s50, 43520
 v_mul_f32 v10, s40, v10
 v_mul_f32 v11, s40, v11
 v_mfma_f32_16x16x32_bf16 v[152:155], v[72:75], v[32:35], v[152:155]
 buffer_load_dwordx4 v21, s[20:23], s37 offen offset:0 lds
 v_mfma_f32_16x16x32_bf16 v[184:187], v[72:75], v[36:39], v[184:187]
 v_mul_f32 v12, s40, v12
 v_mul_f32 v13, s40, v13
 v_mfma_f32_16x16x32_bf16 v[216:219], v[72:75], v[40:43], v[216:219]
 v_mul_f32 v14, s40, v14
 v_mul_f32 v15, s40, v15
 v_mfma_f32_16x16x32_bf16 v[248:251], v[72:75], v[44:47], v[248:251]
 v_mfma_f32_16x16x32_bf16 v[156:159], v[76:79], v[32:35], v[156:159]
 v_cvt_pk_bf16_f32 v8, v8, v9
 v_cvt_pk_bf16_f32 v9, v10, v11
 v_mfma_f32_16x16x32_bf16 v[188:191], v[76:79], v[36:39], v[188:191]
 v_cvt_pk_bf16_f32 v10, v12, v13
 v_cvt_pk_bf16_f32 v11, v14, v15
 v_mfma_f32_16x16x32_bf16 v[220:223], v[76:79], v[40:43], v[220:223]
 buffer_load_dwordx4 v22, s[20:23], s37 offen offset:1024 lds
 v_mfma_f32_16x16x32_bf16 v[252:255], v[76:79], v[44:47], v[252:255]
 s_waitcnt vmcnt(15) lgkmcnt(0)
 s_barrier
 v_accvgpr_read_b32 v4, a204
 v_accvgpr_read_b32 v5, a205
 v_mfma_f32_16x16x32_bf16 v[128:131], v[96:99], v[80:83], v[128:131]
 ds_read_b64_tr_b16 v[48:49], v27 offset:17408
 ds_read_b64_tr_b16 v[50:51], v27 offset:18432
 v_mfma_f32_16x16x32_bf16 v[160:163], v[96:99], v[84:87], v[160:163]
 s_add_u32 s36, s44, 768
 v_accvgpr_read_b32 v6, a206
 v_accvgpr_read_b32 v7, a207
 v_mfma_f32_16x16x32_bf16 v[192:195], v[96:99], v[88:91], v[192:195]
 s_add_u32 m0, s42, 65536
 ds_read_b128 v[32:35], v23 offset:0
 ds_read_b128 v[36:39], v23 offset:2048
 v_mfma_f32_16x16x32_bf16 v[224:227], v[96:99], v[92:95], v[224:227]
 buffer_load_dwordx4 v17, s[24:27], s36 offen offset:0 lds
 v_mfma_f32_16x16x32_bf16 v[132:135], v[100:103], v[80:83], v[132:135]
 ds_read_b128 v[40:43], v23 offset:4096
 ds_read_b128 v[44:47], v23 offset:6144
 v_mfma_f32_16x16x32_bf16 v[164:167], v[100:103], v[84:87], v[164:167]
 v_accvgpr_read_b32 v0, a200
 v_accvgpr_read_b32 v1, a201
 v_mfma_f32_16x16x32_bf16 v[196:199], v[100:103], v[88:91], v[196:199]
 ds_read_b64_tr_b16 v[52:53], v28 offset:17408
 ds_read_b64_tr_b16 v[54:55], v28 offset:18432
 v_mfma_f32_16x16x32_bf16 v[228:231], v[100:103], v[92:95], v[228:231]
 buffer_load_dwordx4 v18, s[24:27], s36 offen offset:1024 lds
 v_mfma_f32_16x16x32_bf16 v[136:139], v[104:107], v[80:83], v[136:139]
 ds_read_b64_tr_b16 v[56:57], v29 offset:17408
 ds_read_b64_tr_b16 v[58:59], v29 offset:18432
 v_mfma_f32_16x16x32_bf16 v[168:171], v[104:107], v[84:87], v[168:171]
 v_accvgpr_read_b32 v2, a202
 v_accvgpr_read_b32 v3, a203
 v_mfma_f32_16x16x32_bf16 v[200:203], v[104:107], v[88:91], v[200:203]
 ds_read_b64_tr_b16 v[60:61], v30 offset:17408
 ds_read_b64_tr_b16 v[62:63], v30 offset:18432
 v_mfma_f32_16x16x32_bf16 v[232:235], v[104:107], v[92:95], v[232:235]
 buffer_store_dwordx4 v[8:11], v16, s[16:19], s41 offen offset:1024
 v_mfma_f32_16x16x32_bf16 v[140:143], v[108:111], v[80:83], v[140:143]
 s_add_u32 s41, s41, 4096
 ds_read_b64_tr_b16 v[64:65], v27 offset:17536
 ds_read_b64_tr_b16 v[66:67], v27 offset:18560
 v_mfma_f32_16x16x32_bf16 v[172:175], v[108:111], v[84:87], v[172:175]
 v_cvt_pk_bf16_f32 v0, v0, v1
 v_cvt_pk_bf16_f32 v1, v2, v3
 v_mfma_f32_16x16x32_bf16 v[204:207], v[108:111], v[88:91], v[204:207]
 ds_read_b64_tr_b16 v[68:69], v28 offset:17536
 ds_read_b64_tr_b16 v[70:71], v28 offset:18560
 v_mfma_f32_16x16x32_bf16 v[236:239], v[108:111], v[92:95], v[236:239]
 buffer_load_dwordx4 v19, s[24:27], s36 offen offset:2048 lds
 v_mfma_f32_16x16x32_bf16 v[144:147], v[112:115], v[80:83], v[144:147]
 ds_read_b64_tr_b16 v[72:73], v29 offset:17536
 ds_read_b64_tr_b16 v[74:75], v29 offset:18560
 v_mfma_f32_16x16x32_bf16 v[176:179], v[112:115], v[84:87], v[176:179]
 v_cvt_pk_bf16_f32 v2, v4, v5
 v_cvt_pk_bf16_f32 v3, v6, v7
 v_mfma_f32_16x16x32_bf16 v[208:211], v[112:115], v[88:91], v[208:211]
 ds_read_b64_tr_b16 v[76:77], v30 offset:17536
 ds_read_b64_tr_b16 v[78:79], v30 offset:18560
 v_mfma_f32_16x16x32_bf16 v[240:243], v[112:115], v[92:95], v[240:243]
 v_accvgpr_read_b32 v12, a44
 v_accvgpr_read_b32 v13, a45
 v_mfma_f32_16x16x32_bf16 v[148:151], v[116:119], v[80:83], v[148:151]
 v_accvgpr_read_b32 v14, a46
 v_accvgpr_read_b32 v15, a47
 v_mfma_f32_16x16x32_bf16 v[180:183], v[116:119], v[84:87], v[180:183]
 buffer_load_dwordx4 v20, s[24:27], s36 offen offset:3072 lds
 v_mfma_f32_16x16x32_bf16 v[212:215], v[116:119], v[88:91], v[212:215]
 s_add_u32 s37, s49, 3145728
 v_accvgpr_read_b32 v8, a12
 v_accvgpr_read_b32 v9, a13
 v_mfma_f32_16x16x32_bf16 v[244:247], v[116:119], v[92:95], v[244:247]
 s_add_u32 m0, s50, 0
 v_accvgpr_read_b32 v10, a14
 v_accvgpr_read_b32 v11, a15
 v_mfma_f32_16x16x32_bf16 v[152:155], v[120:123], v[80:83], v[152:155]
 buffer_load_dwordx4 v21, s[20:23], s37 offen offset:0 lds
 v_mfma_f32_16x16x32_bf16 v[184:187], v[120:123], v[84:87], v[184:187]
 v_mul_f32 v8, s40, v8
 v_mul_f32 v9, s40, v9
 v_mfma_f32_16x16x32_bf16 v[216:219], v[120:123], v[88:91], v[216:219]
 v_mul_f32 v10, s40, v10
 v_mul_f32 v11, s40, v11
 v_mfma_f32_16x16x32_bf16 v[248:251], v[120:123], v[92:95], v[248:251]
 buffer_store_dwordx4 v[0:3], v16, s[16:19], s38 offen offset:2048
 v_mfma_f32_16x16x32_bf16 v[156:159], v[124:127], v[80:83], v[156:159]
 v_mul_f32 v12, s40, v12
 v_mul_f32 v13, s40, v13
 v_mfma_f32_16x16x32_bf16 v[188:191], v[124:127], v[84:87], v[188:191]
 v_mul_f32 v14, s40, v14
 v_mul_f32 v15, s40, v15
 v_mfma_f32_16x16x32_bf16 v[220:223], v[124:127], v[88:91], v[220:223]
 buffer_load_dwordx4 v22, s[20:23], s37 offen offset:1024 lds
 v_mfma_f32_16x16x32_bf16 v[252:255], v[124:127], v[92:95], v[252:255]
 s_waitcnt lgkmcnt(0)
 v_cvt_pk_bf16_f32 v8, v8, v9
 v_cvt_pk_bf16_f32 v9, v10, v11
 v_mfma_f32_16x16x32_bf16 v[128:131], v[48:51], v[32:35], v[128:131]
 ds_read_b64_tr_b16 v[96:97], v27 offset:26112
 ds_read_b64_tr_b16 v[98:99], v27 offset:27136
 v_mfma_f32_16x16x32_bf16 v[160:163], v[48:51], v[36:39], v[160:163]
 s_add_u32 s36, s45, 768
 v_cvt_pk_bf16_f32 v10, v12, v13
 v_cvt_pk_bf16_f32 v11, v14, v15
 v_mfma_f32_16x16x32_bf16 v[192:195], v[48:51], v[40:43], v[192:195]
 s_add_u32 m0, s42, 69632
 ds_read_b128 v[80:83], v24 offset:0
 ds_read_b128 v[84:87], v24 offset:2048
 v_mfma_f32_16x16x32_bf16 v[224:227], v[48:51], v[44:47], v[224:227]
 buffer_load_dwordx4 v17, s[24:27], s36 offen offset:0 lds
 v_mfma_f32_16x16x32_bf16 v[132:135], v[52:55], v[32:35], v[132:135]
 ds_read_b128 v[88:91], v24 offset:4096
 ds_read_b128 v[92:95], v24 offset:6144
 v_mfma_f32_16x16x32_bf16 v[164:167], v[52:55], v[36:39], v[164:167]
 v_accvgpr_read_b32 v4, a236
 v_accvgpr_read_b32 v5, a237
 v_mfma_f32_16x16x32_bf16 v[196:199], v[52:55], v[40:43], v[196:199]
 ds_read_b64_tr_b16 v[100:101], v28 offset:26112
 ds_read_b64_tr_b16 v[102:103], v28 offset:27136
 v_mfma_f32_16x16x32_bf16 v[228:231], v[52:55], v[44:47], v[228:231]
 buffer_load_dwordx4 v18, s[24:27], s36 offen offset:1024 lds
 v_mfma_f32_16x16x32_bf16 v[136:139], v[56:59], v[32:35], v[136:139]
 ds_read_b64_tr_b16 v[104:105], v29 offset:26112
 ds_read_b64_tr_b16 v[106:107], v29 offset:27136
 v_mfma_f32_16x16x32_bf16 v[168:171], v[56:59], v[36:39], v[168:171]
 v_accvgpr_read_b32 v6, a238
 v_accvgpr_read_b32 v7, a239
 v_mfma_f32_16x16x32_bf16 v[200:203], v[56:59], v[40:43], v[200:203]
 ds_read_b64_tr_b16 v[108:109], v30 offset:26112
 ds_read_b64_tr_b16 v[110:111], v30 offset:27136
 v_mfma_f32_16x16x32_bf16 v[232:235], v[56:59], v[44:47], v[232:235]
 buffer_store_dwordx4 v[8:11], v16, s[16:19], s41 offen offset:0
 v_mfma_f32_16x16x32_bf16 v[140:143], v[60:63], v[32:35], v[140:143]
 ds_read_b64_tr_b16 v[112:113], v27 offset:26240
 ds_read_b64_tr_b16 v[114:115], v27 offset:27264
 v_mfma_f32_16x16x32_bf16 v[172:175], v[60:63], v[36:39], v[172:175]
 v_accvgpr_read_b32 v0, a232
 v_accvgpr_read_b32 v1, a233
 v_mfma_f32_16x16x32_bf16 v[204:207], v[60:63], v[40:43], v[204:207]
 ds_read_b64_tr_b16 v[116:117], v28 offset:26240
 ds_read_b64_tr_b16 v[118:119], v28 offset:27264
 v_mfma_f32_16x16x32_bf16 v[236:239], v[60:63], v[44:47], v[236:239]
 buffer_load_dwordx4 v19, s[24:27], s36 offen offset:2048 lds
 v_mfma_f32_16x16x32_bf16 v[144:147], v[64:67], v[32:35], v[144:147]
 ds_read_b64_tr_b16 v[120:121], v29 offset:26240
 ds_read_b64_tr_b16 v[122:123], v29 offset:27264
 v_mfma_f32_16x16x32_bf16 v[176:179], v[64:67], v[36:39], v[176:179]
 v_accvgpr_read_b32 v2, a234
 v_accvgpr_read_b32 v3, a235
 v_mfma_f32_16x16x32_bf16 v[208:211], v[64:67], v[40:43], v[208:211]
 ds_read_b64_tr_b16 v[124:125], v30 offset:26240
 ds_read_b64_tr_b16 v[126:127], v30 offset:27264
 v_mfma_f32_16x16x32_bf16 v[240:243], v[64:67], v[44:47], v[240:243]
 v_cvt_pk_bf16_f32 v0, v0, v1
 v_cvt_pk_bf16_f32 v1, v2, v3
 v_mfma_f32_16x16x32_bf16 v[148:151], v[68:71], v[32:35], v[148:151]
 v_cvt_pk_bf16_f32 v2, v4, v5
 v_cvt_pk_bf16_f32 v3, v6, v7
 v_mfma_f32_16x16x32_bf16 v[180:183], v[68:71], v[36:39], v[180:183]
 buffer_load_dwordx4 v20, s[24:27], s36 offen offset:3072 lds
 v_mfma_f32_16x16x32_bf16 v[212:215], v[68:71], v[40:43], v[212:215]
 s_add_u32 s37, s49, 3407872
 v_accvgpr_read_b32 v12, a108
 v_accvgpr_read_b32 v13, a109
 v_mfma_f32_16x16x32_bf16 v[244:247], v[68:71], v[44:47], v[244:247]
 s_add_u32 m0, s50, 8704
 v_accvgpr_read_b32 v14, a110
 v_accvgpr_read_b32 v15, a111
 v_mfma_f32_16x16x32_bf16 v[152:155], v[72:75], v[32:35], v[152:155]
 buffer_load_dwordx4 v21, s[20:23], s37 offen offset:0 lds
 v_mfma_f32_16x16x32_bf16 v[184:187], v[72:75], v[36:39], v[184:187]
 v_accvgpr_read_b32 v8, a76
 v_accvgpr_read_b32 v9, a77
 v_mfma_f32_16x16x32_bf16 v[216:219], v[72:75], v[40:43], v[216:219]
 v_accvgpr_read_b32 v10, a78
 v_accvgpr_read_b32 v11, a79
 v_mfma_f32_16x16x32_bf16 v[248:251], v[72:75], v[44:47], v[248:251]
 buffer_store_dwordx4 v[0:3], v16, s[16:19], s38 offen offset:3072
 v_mfma_f32_16x16x32_bf16 v[156:159], v[76:79], v[32:35], v[156:159]
 s_add_u32 s38, s38, 16384
 v_mul_f32 v8, s40, v8
 v_mul_f32 v9, s40, v9
 v_mfma_f32_16x16x32_bf16 v[188:191], v[76:79], v[36:39], v[188:191]
 v_mul_f32 v10, s40, v10
 v_mul_f32 v11, s40, v11
 v_mfma_f32_16x16x32_bf16 v[220:223], v[76:79], v[40:43], v[220:223]
 buffer_load_dwordx4 v22, s[20:23], s37 offen offset:1024 lds
 v_mfma_f32_16x16x32_bf16 v[252:255], v[76:79], v[44:47], v[252:255]
 s_waitcnt vmcnt(16) lgkmcnt(0)
 s_barrier
 v_mul_f32 v12, s40, v12
 v_mul_f32 v13, s40, v13
 v_mfma_f32_16x16x32_bf16 v[128:131], v[96:99], v[80:83], v[128:131]
 ds_read_b64_tr_b16 v[48:49], v27 offset:34816
 ds_read_b64_tr_b16 v[50:51], v27 offset:35840
 v_mfma_f32_16x16x32_bf16 v[160:163], v[96:99], v[84:87], v[160:163]
 s_add_u32 s36, s44, 896
 v_mul_f32 v14, s40, v14
 v_mul_f32 v15, s40, v15
 v_mfma_f32_16x16x32_bf16 v[192:195], v[96:99], v[88:91], v[192:195]
 s_add_u32 m0, s42, 0
 ds_read_b128 v[32:35], v23 offset:32768
 ds_read_b128 v[36:39], v23 offset:34816
 v_mfma_f32_16x16x32_bf16 v[224:227], v[96:99], v[92:95], v[224:227]
 buffer_load_dwordx4 v17, s[24:27], s36 offen offset:0 lds
 v_mfma_f32_16x16x32_bf16 v[132:135], v[100:103], v[80:83], v[132:135]
 ds_read_b128 v[40:43], v23 offset:36864
 ds_read_b128 v[44:47], v23 offset:38912
 v_mfma_f32_16x16x32_bf16 v[164:167], v[100:103], v[84:87], v[164:167]
 v_cvt_pk_bf16_f32 v8, v8, v9
 v_cvt_pk_bf16_f32 v9, v10, v11
 v_mfma_f32_16x16x32_bf16 v[196:199], v[100:103], v[88:91], v[196:199]
 ds_read_b64_tr_b16 v[52:53], v28 offset:34816
 ds_read_b64_tr_b16 v[54:55], v28 offset:35840
 v_mfma_f32_16x16x32_bf16 v[228:231], v[100:103], v[92:95], v[228:231]
 buffer_load_dwordx4 v18, s[24:27], s36 offen offset:1024 lds
 v_mfma_f32_16x16x32_bf16 v[136:139], v[104:107], v[80:83], v[136:139]
 ds_read_b64_tr_b16 v[56:57], v29 offset:34816
 ds_read_b64_tr_b16 v[58:59], v29 offset:35840
 v_mfma_f32_16x16x32_bf16 v[168:171], v[104:107], v[84:87], v[168:171]
 v_cvt_pk_bf16_f32 v10, v12, v13
 v_cvt_pk_bf16_f32 v11, v14, v15
 v_mfma_f32_16x16x32_bf16 v[200:203], v[104:107], v[88:91], v[200:203]
 ds_read_b64_tr_b16 v[60:61], v30 offset:34816
 ds_read_b64_tr_b16 v[62:63], v30 offset:35840
 v_mfma_f32_16x16x32_bf16 v[232:235], v[104:107], v[92:95], v[232:235]
 buffer_store_dwordx4 v[8:11], v16, s[16:19], s41 offen offset:1024
 v_mfma_f32_16x16x32_bf16 v[140:143], v[108:111], v[80:83], v[140:143]
 s_add_u32 s41, s41, 12288
 ds_read_b64_tr_b16 v[64:65], v27 offset:34944
 ds_read_b64_tr_b16 v[66:67], v27 offset:35968
 v_mfma_f32_16x16x32_bf16 v[172:175], v[108:111], v[84:87], v[172:175]
 v_accvgpr_read_b32 v4, a148
 v_accvgpr_read_b32 v5, a149
 v_mfma_f32_16x16x32_bf16 v[204:207], v[108:111], v[88:91], v[204:207]
 ds_read_b64_tr_b16 v[68:69], v28 offset:34944
 ds_read_b64_tr_b16 v[70:71], v28 offset:35968
 v_mfma_f32_16x16x32_bf16 v[236:239], v[108:111], v[92:95], v[236:239]
 buffer_load_dwordx4 v19, s[24:27], s36 offen offset:2048 lds
 v_mfma_f32_16x16x32_bf16 v[144:147], v[112:115], v[80:83], v[144:147]
 ds_read_b64_tr_b16 v[72:73], v29 offset:34944
 ds_read_b64_tr_b16 v[74:75], v29 offset:35968
 v_mfma_f32_16x16x32_bf16 v[176:179], v[112:115], v[84:87], v[176:179]
 v_accvgpr_read_b32 v6, a150
 v_accvgpr_read_b32 v7, a151
 v_mfma_f32_16x16x32_bf16 v[208:211], v[112:115], v[88:91], v[208:211]
 ds_read_b64_tr_b16 v[76:77], v30 offset:34944
 ds_read_b64_tr_b16 v[78:79], v30 offset:35968
 v_mfma_f32_16x16x32_bf16 v[240:243], v[112:115], v[92:95], v[240:243]
 v_accvgpr_read_b32 v0, a144
 v_accvgpr_read_b32 v1, a145
 v_mfma_f32_16x16x32_bf16 v[148:151], v[116:119], v[80:83], v[148:151]
 v_accvgpr_read_b32 v2, a146
 v_accvgpr_read_b32 v3, a147
 v_mfma_f32_16x16x32_bf16 v[180:183], v[116:119], v[84:87], v[180:183]
 buffer_load_dwordx4 v20, s[24:27], s36 offen offset:3072 lds
 v_mfma_f32_16x16x32_bf16 v[212:215], v[116:119], v[88:91], v[212:215]
 s_add_u32 s37, s49, 3670016
 v_cvt_pk_bf16_f32 v0, v0, v1
 v_cvt_pk_bf16_f32 v1, v2, v3
 v_mfma_f32_16x16x32_bf16 v[244:247], v[116:119], v[92:95], v[244:247]
 s_add_u32 m0, s50, 17408
 v_cvt_pk_bf16_f32 v2, v4, v5
 v_cvt_pk_bf16_f32 v3, v6, v7
 v_mfma_f32_16x16x32_bf16 v[152:155], v[120:123], v[80:83], v[152:155]
 buffer_load_dwordx4 v21, s[20:23], s37 offen offset:0 lds
 v_mfma_f32_16x16x32_bf16 v[184:187], v[120:123], v[84:87], v[184:187]
 v_accvgpr_read_b32 v12, a48
 v_accvgpr_read_b32 v13, a49
 v_mfma_f32_16x16x32_bf16 v[216:219], v[120:123], v[88:91], v[216:219]
 v_accvgpr_read_b32 v14, a50
 v_accvgpr_read_b32 v15, a51
 v_mfma_f32_16x16x32_bf16 v[248:251], v[120:123], v[92:95], v[248:251]
 buffer_store_dwordx4 v[0:3], v16, s[16:19], s38 offen offset:0
 v_mfma_f32_16x16x32_bf16 v[156:159], v[124:127], v[80:83], v[156:159]
 v_accvgpr_read_b32 v8, a16
 v_accvgpr_read_b32 v9, a17
 v_mfma_f32_16x16x32_bf16 v[188:191], v[124:127], v[84:87], v[188:191]
 v_accvgpr_read_b32 v10, a18
 v_accvgpr_read_b32 v11, a19
 v_mfma_f32_16x16x32_bf16 v[220:223], v[124:127], v[88:91], v[220:223]
 buffer_load_dwordx4 v22, s[20:23], s37 offen offset:1024 lds
 v_mfma_f32_16x16x32_bf16 v[252:255], v[124:127], v[92:95], v[252:255]
 s_waitcnt lgkmcnt(0)
 v_mul_f32 v8, s40, v8
 v_mul_f32 v9, s40, v9
 v_mfma_f32_16x16x32_bf16 v[128:131], v[48:51], v[32:35], v[128:131]
 ds_read_b64_tr_b16 v[96:97], v27 offset:43520
 ds_read_b64_tr_b16 v[98:99], v27 offset:44544
 v_mfma_f32_16x16x32_bf16 v[160:163], v[48:51], v[36:39], v[160:163]
 s_add_u32 s36, s45, 896
 v_mul_f32 v10, s40, v10
 v_mul_f32 v11, s40, v11
 v_mfma_f32_16x16x32_bf16 v[192:195], v[48:51], v[40:43], v[192:195]
 s_add_u32 m0, s42, 4096
 ds_read_b128 v[80:83], v24 offset:32768
 ds_read_b128 v[84:87], v24 offset:34816
 v_mfma_f32_16x16x32_bf16 v[224:227], v[48:51], v[44:47], v[224:227]
 buffer_load_dwordx4 v17, s[24:27], s36 offen offset:0 lds
 v_mfma_f32_16x16x32_bf16 v[132:135], v[52:55], v[32:35], v[132:135]
 ds_read_b128 v[88:91], v24 offset:36864
 ds_read_b128 v[92:95], v24 offset:38912
 v_mfma_f32_16x16x32_bf16 v[164:167], v[52:55], v[36:39], v[164:167]
 v_mul_f32 v12, s40, v12
 v_mul_f32 v13, s40, v13
 v_mfma_f32_16x16x32_bf16 v[196:199], v[52:55], v[40:43], v[196:199]
 ds_read_b64_tr_b16 v[100:101], v28 offset:43520
 ds_read_b64_tr_b16 v[102:103], v28 offset:44544
 v_mfma_f32_16x16x32_bf16 v[228:231], v[52:55], v[44:47], v[228:231]
 buffer_load_dwordx4 v18, s[24:27], s36 offen offset:1024 lds
 v_mfma_f32_16x16x32_bf16 v[136:139], v[56:59], v[32:35], v[136:139]
 ds_read_b64_tr_b16 v[104:105], v29 offset:43520
 ds_read_b64_tr_b16 v[106:107], v29 offset:44544
 v_mfma_f32_16x16x32_bf16 v[168:171], v[56:59], v[36:39], v[168:171]
 v_mul_f32 v14, s40, v14
 v_mul_f32 v15, s40, v15
 v_mfma_f32_16x16x32_bf16 v[200:203], v[56:59], v[40:43], v[200:203]
 ds_read_b64_tr_b16 v[108:109], v30 offset:43520
 ds_read_b64_tr_b16 v[110:111], v30 offset:44544
 v_mfma_f32_16x16x32_bf16 v[232:235], v[56:59], v[44:47], v[232:235]
 v_mfma_f32_16x16x32_bf16 v[140:143], v[60:63], v[32:35], v[140:143]
 ds_read_b64_tr_b16 v[112:113], v27 offset:43648
 ds_read_b64_tr_b16 v[114:115], v27 offset:44672
 v_mfma_f32_16x16x32_bf16 v[172:175], v[60:63], v[36:39], v[172:175]
 v_cvt_pk_bf16_f32 v8, v8, v9
 v_cvt_pk_bf16_f32 v9, v10, v11
 v_mfma_f32_16x16x32_bf16 v[204:207], v[60:63], v[40:43], v[204:207]
 ds_read_b64_tr_b16 v[116:117], v28 offset:43648
 ds_read_b64_tr_b16 v[118:119], v28 offset:44672
 v_mfma_f32_16x16x32_bf16 v[236:239], v[60:63], v[44:47], v[236:239]
 buffer_load_dwordx4 v19, s[24:27], s36 offen offset:2048 lds
 v_mfma_f32_16x16x32_bf16 v[144:147], v[64:67], v[32:35], v[144:147]
 ds_read_b64_tr_b16 v[120:121], v29 offset:43648
 ds_read_b64_tr_b16 v[122:123], v29 offset:44672
 v_mfma_f32_16x16x32_bf16 v[176:179], v[64:67], v[36:39], v[176:179]
 v_cvt_pk_bf16_f32 v10, v12, v13
 v_cvt_pk_bf16_f32 v11, v14, v15
 v_mfma_f32_16x16x32_bf16 v[208:211], v[64:67], v[40:43], v[208:211]
 ds_read_b64_tr_b16 v[124:125], v30 offset:43648
 ds_read_b64_tr_b16 v[126:127], v30 offset:44672
 v_mfma_f32_16x16x32_bf16 v[240:243], v[64:67], v[44:47], v[240:243]
 v_accvgpr_read_b32 v4, a180
 v_accvgpr_read_b32 v5, a181
 v_mfma_f32_16x16x32_bf16 v[148:151], v[68:71], v[32:35], v[148:151]
 v_accvgpr_read_b32 v6, a182
 v_accvgpr_read_b32 v7, a183
 v_mfma_f32_16x16x32_bf16 v[180:183], v[68:71], v[36:39], v[180:183]
 buffer_load_dwordx4 v20, s[24:27], s36 offen offset:3072 lds
 v_mfma_f32_16x16x32_bf16 v[212:215], v[68:71], v[40:43], v[212:215]
 s_add_u32 s37, s49, 3932160
 v_accvgpr_read_b32 v0, a176
 v_accvgpr_read_b32 v1, a177
 v_mfma_f32_16x16x32_bf16 v[244:247], v[68:71], v[44:47], v[244:247]
 s_add_u32 m0, s50, 26112
 v_accvgpr_read_b32 v2, a178
 v_accvgpr_read_b32 v3, a179
 v_mfma_f32_16x16x32_bf16 v[152:155], v[72:75], v[32:35], v[152:155]
 buffer_load_dwordx4 v21, s[20:23], s37 offen offset:0 lds
 v_mfma_f32_16x16x32_bf16 v[184:187], v[72:75], v[36:39], v[184:187]
 v_cvt_pk_bf16_f32 v0, v0, v1
 v_cvt_pk_bf16_f32 v1, v2, v3
 v_mfma_f32_16x16x32_bf16 v[216:219], v[72:75], v[40:43], v[216:219]
 v_cvt_pk_bf16_f32 v2, v4, v5
 v_cvt_pk_bf16_f32 v3, v6, v7
 v_mfma_f32_16x16x32_bf16 v[248:251], v[72:75], v[44:47], v[248:251]
 buffer_store_dwordx4 v[8:11], v16, s[16:19], s41 offen offset:0
 v_mfma_f32_16x16x32_bf16 v[156:159], v[76:79], v[32:35], v[156:159]
 v_accvgpr_read_b32 v12, a112
 v_accvgpr_read_b32 v13, a113
 v_mfma_f32_16x16x32_bf16 v[188:191], v[76:79], v[36:39], v[188:191]
 v_accvgpr_read_b32 v14, a114
 v_accvgpr_read_b32 v15, a115
 v_mfma_f32_16x16x32_bf16 v[220:223], v[76:79], v[40:43], v[220:223]
 buffer_load_dwordx4 v22, s[20:23], s37 offen offset:1024 lds
 v_mfma_f32_16x16x32_bf16 v[252:255], v[76:79], v[44:47], v[252:255]
 s_waitcnt vmcnt(15) lgkmcnt(0)
 s_barrier
 v_accvgpr_read_b32 v8, a80
 v_accvgpr_read_b32 v9, a81
 v_mfma_f32_16x16x32_bf16 v[128:131], v[96:99], v[80:83], v[128:131]
 ds_read_b64_tr_b16 v[48:49], v27 offset:0
 ds_read_b64_tr_b16 v[50:51], v27 offset:1024
 v_mfma_f32_16x16x32_bf16 v[160:163], v[96:99], v[84:87], v[160:163]
 s_add_u32 s36, s44, 1024
 v_accvgpr_read_b32 v10, a82
 v_accvgpr_read_b32 v11, a83
 v_mfma_f32_16x16x32_bf16 v[192:195], v[96:99], v[88:91], v[192:195]
 s_add_u32 m0, s42, 32768
 ds_read_b128 v[32:35], v25 offset:0
 ds_read_b128 v[36:39], v25 offset:2048
 v_mfma_f32_16x16x32_bf16 v[224:227], v[96:99], v[92:95], v[224:227]
 buffer_load_dwordx4 v17, s[24:27], s36 offen offset:0 lds
 v_mfma_f32_16x16x32_bf16 v[132:135], v[100:103], v[80:83], v[132:135]
 ds_read_b128 v[40:43], v25 offset:4096
 ds_read_b128 v[44:47], v25 offset:6144
 v_mfma_f32_16x16x32_bf16 v[164:167], v[100:103], v[84:87], v[164:167]
 v_mul_f32 v8, s40, v8
 v_mul_f32 v9, s40, v9
 v_mfma_f32_16x16x32_bf16 v[196:199], v[100:103], v[88:91], v[196:199]
 ds_read_b64_tr_b16 v[52:53], v28 offset:0
 ds_read_b64_tr_b16 v[54:55], v28 offset:1024
 v_mfma_f32_16x16x32_bf16 v[228:231], v[100:103], v[92:95], v[228:231]
 buffer_load_dwordx4 v18, s[24:27], s36 offen offset:1024 lds
 v_mfma_f32_16x16x32_bf16 v[136:139], v[104:107], v[80:83], v[136:139]
 ds_read_b64_tr_b16 v[56:57], v29 offset:0
 ds_read_b64_tr_b16 v[58:59], v29 offset:1024
 v_mfma_f32_16x16x32_bf16 v[168:171], v[104:107], v[84:87], v[168:171]
 v_mul_f32 v10, s40, v10
 v_mul_f32 v11, s40, v11
 v_mfma_f32_16x16x32_bf16 v[200:203], v[104:107], v[88:91], v[200:203]
 ds_read_b64_tr_b16 v[60:61], v30 offset:0
 ds_read_b64_tr_b16 v[62:63], v30 offset:1024
 v_mfma_f32_16x16x32_bf16 v[232:235], v[104:107], v[92:95], v[232:235]
 buffer_store_dwordx4 v[0:3], v16, s[16:19], s38 offen offset:1024
 v_mfma_f32_16x16x32_bf16 v[140:143], v[108:111], v[80:83], v[140:143]
 ds_read_b64_tr_b16 v[64:65], v27 offset:128
 ds_read_b64_tr_b16 v[66:67], v27 offset:1152
 v_mfma_f32_16x16x32_bf16 v[172:175], v[108:111], v[84:87], v[172:175]
 v_mul_f32 v12, s40, v12
 v_mul_f32 v13, s40, v13
 v_mfma_f32_16x16x32_bf16 v[204:207], v[108:111], v[88:91], v[204:207]
 ds_read_b64_tr_b16 v[68:69], v28 offset:128
 ds_read_b64_tr_b16 v[70:71], v28 offset:1152
 v_mfma_f32_16x16x32_bf16 v[236:239], v[108:111], v[92:95], v[236:239]
 buffer_load_dwordx4 v19, s[24:27], s36 offen offset:2048 lds
 v_mfma_f32_16x16x32_bf16 v[144:147], v[112:115], v[80:83], v[144:147]
 ds_read_b64_tr_b16 v[72:73], v29 offset:128
 ds_read_b64_tr_b16 v[74:75], v29 offset:1152
 v_mfma_f32_16x16x32_bf16 v[176:179], v[112:115], v[84:87], v[176:179]
 v_mul_f32 v14, s40, v14
 v_mul_f32 v15, s40, v15
 v_mfma_f32_16x16x32_bf16 v[208:211], v[112:115], v[88:91], v[208:211]
 ds_read_b64_tr_b16 v[76:77], v30 offset:128
 ds_read_b64_tr_b16 v[78:79], v30 offset:1152
 v_mfma_f32_16x16x32_bf16 v[240:243], v[112:115], v[92:95], v[240:243]
 v_cvt_pk_bf16_f32 v8, v8, v9
 v_cvt_pk_bf16_f32 v9, v10, v11
 v_mfma_f32_16x16x32_bf16 v[148:151], v[116:119], v[80:83], v[148:151]
 v_cvt_pk_bf16_f32 v10, v12, v13
 v_cvt_pk_bf16_f32 v11, v14, v15
 v_mfma_f32_16x16x32_bf16 v[180:183], v[116:119], v[84:87], v[180:183]
 buffer_load_dwordx4 v20, s[24:27], s36 offen offset:3072 lds
 v_mfma_f32_16x16x32_bf16 v[212:215], v[116:119], v[88:91], v[212:215]
 s_add_u32 s37, s49, 4194304
 v_accvgpr_read_b32 v4, a212
 v_accvgpr_read_b32 v5, a213
 v_mfma_f32_16x16x32_bf16 v[244:247], v[116:119], v[92:95], v[244:247]
 s_add_u32 m0, s50, 34816
 v_accvgpr_read_b32 v6, a214
 v_accvgpr_read_b32 v7, a215
 v_mfma_f32_16x16x32_bf16 v[152:155], v[120:123], v[80:83], v[152:155]
 buffer_load_dwordx4 v21, s[20:23], s37 offen offset:0 lds
 v_mfma_f32_16x16x32_bf16 v[184:187], v[120:123], v[84:87], v[184:187]
 v_accvgpr_read_b32 v0, a208
 v_accvgpr_read_b32 v1, a209
 v_mfma_f32_16x16x32_bf16 v[216:219], v[120:123], v[88:91], v[216:219]
L_pad5:
 s_cbranch_execz L_pad13
 v_accvgpr_read_b32 v2, a210
 v_accvgpr_read_b32 v3, a211
 v_mfma_f32_16x16x32_bf16 v[248:251], v[120:123], v[92:95], v[248:251]
 buffer_store_dwordx4 v[8:11], v16, s[16:19], s41 offen offset:1024
 v_mfma_f32_16x16x32_bf16 v[156:159], v[124:127], v[80:83], v[156:159]
 s_add_u32 s41, s41, 4096
 v_cvt_pk_bf16_f32 v0, v0, v1
 v_cvt_pk_bf16_f32 v1, v2, v3
 v_mfma_f32_16x16x32_bf16 v[188:191], v[124:127], v[84:87], v[188:191]
 v_cvt_pk_bf16_f32 v2, v4, v5
 v_cvt_pk_bf16_f32 v3, v6, v7
 v_mfma_f32_16x16x32_bf16 v[220:223], v[124:127], v[88:91], v[220:223]
 buffer_load_dwordx4 v22, s[20:23], s37 offen offset:1024 lds
 v_mfma_f32_16x16x32_bf16 v[252:255], v[124:127], v[92:95], v[252:255]
 s_waitcnt lgkmcnt(0)
 v_accvgpr_read_b32 v12, a52
 v_accvgpr_read_b32 v13, a53
 v_mfma_f32_16x16x32_bf16 v[128:131], v[48:51], v[32:35], v[128:131]
 ds_read_b64_tr_b16 v[96:97], v27 offset:8704
 ds_read_b64_tr_b16 v[98:99], v27 offset:9728
 v_mfma_f32_16x16x32_bf16 v[160:163], v[48:51], v[36:39], v[160:163]
 s_add_u32 s36, s45, 1024
 v_accvgpr_read_b32 v14, a54
 v_accvgpr_read_b32 v15, a55
 v_mfma_f32_16x16x32_bf16 v[192:195], v[48:51], v[40:43], v[192:195]
 s_add_u32 m0, s42, 36864
 ds_read_b128 v[80:83], v26 offset:0
 ds_read_b128 v[84:87], v26 offset:2048
 v_mfma_f32_16x16x32_bf16 v[224:227], v[48:51], v[44:47], v[224:227]
 buffer_load_dwordx4 v17, s[24:27], s36 offen offset:0 lds
 v_mfma_f32_16x16x32_bf16 v[132:135], v[52:55], v[32:35], v[132:135]
 ds_read_b128 v[88:91], v26 offset:4096
 ds_read_b128 v[92:95], v26 offset:6144
 v_mfma_f32_16x16x32_bf16 v[164:167], v[52:55], v[36:39], v[164:167]
 v_accvgpr_read_b32 v8, a20
 v_accvgpr_read_b32 v9, a21
 v_mfma_f32_16x16x32_bf16 v[196:199], v[52:55], v[40:43], v[196:199]
 ds_read_b64_tr_b16 v[100:101], v28 offset:8704
 ds_read_b64_tr_b16 v[102:103], v28 offset:9728
 v_mfma_f32_16x16x32_bf16 v[228:231], v[52:55], v[44:47], v[228:231]
 buffer_load_dwordx4 v18, s[24:27], s36 offen offset:1024 lds
 v_mfma_f32_16x16x32_bf16 v[136:139], v[56:59], v[32:35], v[136:139]
 ds_read_b64_tr_b16 v[104:105], v29 offset:8704
 ds_read_b64_tr_b16 v[106:107], v29 offset:9728
 v_mfma_f32_16x16x32_bf16 v[168:171], v[56:59], v[36:39], v[168:171]
 v_accvgpr_read_b32 v10, a22
 v_accvgpr_read_b32 v11, a23
 v_mfma_f32_16x16x32_bf16 v[200:203], v[56:59], v[40:43], v[200:203]
 ds_read_b64_tr_b16 v[108:109], v30 offset:8704
 ds_read_b64_tr_b16 v[110:111], v30 offset:9728
 v_mfma_f32_16x16x32_bf16 v[232:235], v[56:59], v[44:47], v[232:235]
 buffer_store_dwordx4 v[0:3], v16, s[16:19], s38 offen offset:2048
 v_mfma_f32_16x16x32_bf16 v[140:143], v[60:63], v[32:35], v[140:143]
 ds_read_b64_tr_b16 v[112:113], v27 offset:8832
 ds_read_b64_tr_b16 v[114:115], v27 offset:9856
 v_mfma_f32_16x16x32_bf16 v[172:175], v[60:63], v[36:39], v[172:175]
 v_mul_f32 v8, s40, v8
 v_mul_f32 v9, s40, v9
 v_mfma_f32_16x16x32_bf16 v[204:207], v[60:63], v[40:43], v[204:207]
 ds_read_b64_tr_b16 v[116:117], v28 offset:8832
 ds_read_b64_tr_b16 v[118:119], v28 offset:9856
 v_mfma_f32_16x16x32_bf16 v[236:239], v[60:63], v[44:47], v[236:239]
 buffer_load_dwordx4 v19, s[24:27], s36 offen offset:2048 lds
 v_mfma_f32_16x16x32_bf16 v[144:147], v[64:67], v[32:35], v[144:147]
 ds_read_b64_tr_b16 v[120:121], v29 offset:8832
 ds_read_b64_tr_b16 v[122:123], v29 offset:9856
 v_mfma_f32_16x16x32_bf16 v[176:179], v[64:67], v[36:39], v[176:179]
 v_mul_f32 v10, s40, v10
 v_mul_f32 v11, s40, v11
 v_mfma_f32_16x16x32_bf16 v[208:211], v[64:67], v[40:43], v[208:211]
 ds_read_b64_tr_b16 v[124:125], v30 offset:8832
 ds_read_b64_tr_b16 v[126:127], v30 offset:9856
 v_mfma_f32_16x16x32_bf16 v[240:243], v[64:67], v[44:47], v[240:243]
 v_mul_f32 v12, s40, v12
 v_mul_f32 v13, s40, v13
 v_mfma_f32_16x16x32_bf16 v[148:151], v[68:71], v[32:35], v[148:151]
 v_mul_f32 v14, s40, v14
 v_mul_f32 v15, s40, v15
 v_mfma_f32_16x16x32_bf16 v[180:183], v[68:71], v[36:39], v[180:183]
 buffer_load_dwordx4 v20, s[24:27], s36 offen offset:3072 lds
 v_mfma_f32_16x16x32_bf16 v[212:215], v[68:71], v[40:43], v[212:215]
 s_add_u32 s37, s49, 4456448
 v_cvt_pk_bf16_f32 v8, v8, v9
 v_cvt_pk_bf16_f32 v9, v10, v11
 v_mfma_f32_16x16x32_bf16 v[244:247], v[68:71], v[44:47], v[244:247]
 s_add_u32 m0, s50, 43520
 v_cvt_pk_bf16_f32 v10, v12, v13
 v_cvt_pk_bf16_f32 v11, v14, v15
 v_mfma_f32_16x16x32_bf16 v[152:155], v[72:75], v[32:35], v[152:155]
 buffer_load_dwordx4 v21, s[20:23], s37 offen offset:0 lds
 v_mfma_f32_16x16x32_bf16 v[184:187], v[72:75], v[36:39], v[184:187]
 v_accvgpr_read_b32 v4, a244
 v_accvgpr_read_b32 v5, a245
 v_mfma_f32_16x16x32_bf16 v[216:219], v[72:75], v[40:43], v[216:219]
 v_accvgpr_read_b32 v6, a246
 v_accvgpr_read_b32 v7, a247
 v_mfma_f32_16x16x32_bf16 v[248:251], v[72:75], v[44:47], v[248:251]
 buffer_store_dwordx4 v[8:11], v16, s[16:19], s41 offen offset:0
 v_mfma_f32_16x16x32_bf16 v[156:159], v[76:79], v[32:35], v[156:159]
 v_accvgpr_read_b32 v0, a240
 v_accvgpr_read_b32 v1, a241
 v_mfma_f32_16x16x32_bf16 v[188:191], v[76:79], v[36:39], v[188:191]
 v_accvgpr_read_b32 v2, a242
 v_accvgpr_read_b32 v3, a243
 v_mfma_f32_16x16x32_bf16 v[220:223], v[76:79], v[40:43], v[220:223]
 buffer_load_dwordx4 v22, s[20:23], s37 offen offset:1024 lds
 v_mfma_f32_16x16x32_bf16 v[252:255], v[76:79], v[44:47], v[252:255]
 s_waitcnt vmcnt(16) lgkmcnt(0)
 s_barrier
 v_cvt_pk_bf16_f32 v0, v0, v1
 v_cvt_pk_bf16_f32 v1, v2, v3
 v_mfma_f32_16x16x32_bf16 v[128:131], v[96:99], v[80:83], v[128:131]
 ds_read_b64_tr_b16 v[48:49], v27 offset:17408
 ds_read_b64_tr_b16 v[50:51], v27 offset:18432
 v_mfma_f32_16x16x32_bf16 v[160:163], v[96:99], v[84:87], v[160:163]
 s_add_u32 s36, s44, 1152
 v_cvt_pk_bf16_f32 v2, v4, v5
 v_cvt_pk_bf16_f32 v3, v6, v7
 v_mfma_f32_16x16x32_bf16 v[192:195], v[96:99], v[88:91], v[192:195]
 s_add_u32 m0, s42, 65536
 ds_read_b128 v[32:35], v23 offset:0
 ds_read_b128 v[36:39], v23 offset:2048
 v_mfma_f32_16x16x32_bf16 v[224:227], v[96:99], v[92:95], v[224:227]
 buffer_load_dwordx4 v17, s[24:27], s36 offen offset:0 lds
 v_mfma_f32_16x16x32_bf16 v[132:135], v[100:103], v[80:83], v[132:135]
 ds_read_b128 v[40:43], v23 offset:4096
 ds_read_b128 v[44:47], v23 offset:6144
 v_mfma_f32_16x16x32_bf16 v[164:167], v[100:103], v[84:87], v[164:167]
 v_accvgpr_read_b32 v12, a116
 v_accvgpr_read_b32 v13, a117
 v_mfma_f32_16x16x32_bf16 v[196:199], v[100:103], v[88:91], v[196:199]
 ds_read_b64_tr_b16 v[52:53], v28 offset:17408
 ds_read_b64_tr_b16 v[54:55], v28 offset:18432
 v_mfma_f32_16x16x32_bf16 v[228:231], v[100:103], v[92:95], v[228:231]
 buffer_load_dwordx4 v18, s[24:27], s36 offen offset:1024 lds
 v_mfma_f32_16x16x32_bf16 v[136:139], v[104:107], v[80:83], v[136:139]
 ds_read_b64_tr_b16 v[56:57], v29 offset:17408
 ds_read_b64_tr_b16 v[58:59], v29 offset:18432
 v_mfma_f32_16x16x32_bf16 v[168:171], v[104:107], v[84:87], v[168:171]
 v_accvgpr_read_b32 v14, a118
 v_accvgpr_read_b32 v15, a119
 v_mfma_f32_16x16x32_bf16 v[200:203], v[104:107], v[88:91], v[200:203]
 ds_read_b64_tr_b16 v[60:61], v30 offset:17408
 ds_read_b64_tr_b16 v[62:63], v30 offset:18432
 v_mfma_f32_16x16x32_bf16 v[232:235], v[104:107], v[92:95], v[232:235]
 buffer_store_dwordx4 v[0:3], v16, s[16:19], s38 offen offset:3072
 v_mfma_f32_16x16x32_bf16 v[140:143], v[108:111], v[80:83], v[140:143]
 s_add_u32 s38, s38, 16384
 ds_read_b64_tr_b16 v[64:65], v27 offset:17536
 ds_read_b64_tr_b16 v[66:67], v27 offset:18560
 v_mfma_f32_16x16x32_bf16 v[172:175], v[108:111], v[84:87], v[172:175]
 v_accvgpr_read_b32 v8, a84
 v_accvgpr_read_b32 v9, a85
 v_mfma_f32_16x16x32_bf16 v[204:207], v[108:111], v[88:91], v[204:207]
 ds_read_b64_tr_b16 v[68:69], v28 offset:17536
 ds_read_b64_tr_b16 v[70:71], v28 offset:18560
 v_mfma_f32_16x16x32_bf16 v[236:239], v[108:111], v[92:95], v[236:239]
 buffer_load_dwordx4 v19, s[24:27], s36 offen offset:2048 lds
 v_mfma_f32_16x16x32_bf16 v[144:147], v[112:115], v[80:83], v[144:147]
 ds_read_b64_tr_b16 v[72:73], v29 offset:17536
 ds_read_b64_tr_b16 v[74:75], v29 offset:18560
 v_mfma_f32_16x16x32_bf16 v[176:179], v[112:115], v[84:87], v[176:179]
 v_accvgpr_read_b32 v10, a86
 v_accvgpr_read_b32 v11, a87
 v_mfma_f32_16x16x32_bf16 v[208:211], v[112:115], v[88:91], v[208:211]
 ds_read_b64_tr_b16 v[76:77], v30 offset:17536
 ds_read_b64_tr_b16 v[78:79], v30 offset:18560
 v_mfma_f32_16x16x32_bf16 v[240:243], v[112:115], v[92:95], v[240:243]
 v_mul_f32 v8, s40, v8
 v_mul_f32 v9, s40, v9
 v_mfma_f32_16x16x32_bf16 v[148:151], v[116:119], v[80:83], v[148:151]
 v_mul_f32 v10, s40, v10
 v_mul_f32 v11, s40, v11
 v_mfma_f32_16x16x32_bf16 v[180:183], v[116:119], v[84:87], v[180:183]
 buffer_load_dwordx4 v20, s[24:27], s36 offen offset:3072 lds
 v_mfma_f32_16x16x32_bf16 v[212:215], v[116:119], v[88:91], v[212:215]
 s_add_u32 s37, s49, 4718592
 v_mul_f32 v12, s40, v12
 v_mul_f32 v13, s40, v13
 v_mfma_f32_16x16x32_bf16 v[244:247], v[116:119], v[92:95], v[244:247]
 s_add_u32 m0, s50, 0
 v_mul_f32 v14, s40, v14
 v_mul_f32 v15, s40, v15
 v_mfma_f32_16x16x32_bf16 v[152:155], v[120:123], v[80:83], v[152:155]
 buffer_load_dwordx4 v21, s[20:23], s37 offen offset:0 lds
 v_mfma_f32_16x16x32_bf16 v[184:187], v[120:123], v[84:87], v[184:187]
 v_cvt_pk_bf16_f32 v8, v8, v9
 v_cvt_pk_bf16_f32 v9, v10, v11
 v_mfma_f32_16x16x32_bf16 v[216:219], v[120:123], v[88:91], v[216:219]
 v_cvt_pk_bf16_f32 v10, v12, v13
 v_cvt_pk_bf16_f32 v11, v14, v15
 v_mfma_f32_16x16x32_bf16 v[248:251], v[120:123], v[92:95], v[248:251]
 buffer_store_dwordx4 v[8:11], v16, s[16:19], s41 offen offset:1024
 v_mfma_f32_16x16x32_bf16 v[156:159], v[124:127], v[80:83], v[156:159]
 s_add_u32 s41, s41, 12288
 v_accvgpr_read_b32 v4, a156
 v_accvgpr_read_b32 v5, a157
 v_mfma_f32_16x16x32_bf16 v[188:191], v[124:127], v[84:87], v[188:191]
 v_accvgpr_read_b32 v6, a158
 v_accvgpr_read_b32 v7, a159
 v_mfma_f32_16x16x32_bf16 v[220:223], v[124:127], v[88:91], v[220:223]
 buffer_load_dwordx4 v22, s[20:23], s37 offen offset:1024 lds
 v_mfma_f32_16x16x32_bf16 v[252:255], v[124:127], v[92:95], v[252:255]
 s_waitcnt lgkmcnt(0)
 v_accvgpr_read_b32 v0, a152
 v_accvgpr_read_b32 v1, a153
 v_mfma_f32_16x16x32_bf16 v[128:131], v[48:51], v[32:35], v[128:131]
 ds_read_b64_tr_b16 v[96:97], v27 offset:26112
 ds_read_b64_tr_b16 v[98:99], v27 offset:27136
 v_mfma_f32_16x16x32_bf16 v[160:163], v[48:51], v[36:39], v[160:163]
 s_add_u32 s36, s45, 1152
 v_accvgpr_read_b32 v2, a154
 v_accvgpr_read_b32 v3, a155
 v_mfma_f32_16x16x32_bf16 v[192:195], v[48:51], v[40:43], v[192:195]
 s_add_u32 m0, s42, 69632
 ds_read_b128 v[80:83], v24 offset:0
 ds_read_b128 v[84:87], v24 offset:2048
 v_mfma_f32_16x16x32_bf16 v[224:227], v[48:51], v[44:47], v[224:227]
 buffer_load_dwordx4 v17, s[24:27], s36 offen offset:0 lds
 v_mfma_f32_16x16x32_bf16 v[132:135], v[52:55], v[32:35], v[132:135]
 ds_read_b128 v[88:91], v24 offset:4096
 ds_read_b128 v[92:95], v24 offset:6144
 v_mfma_f32_16x16x32_bf16 v[164:167], v[52:55], v[36:39], v[164:167]
 v_cvt_pk_bf16_f32 v0, v0, v1
 v_cvt_pk_bf16_f32 v1, v2, v3
 v_mfma_f32_16x16x32_bf16 v[196:199], v[52:55], v[40:43], v[196:199]
 ds_read_b64_tr_b16 v[100:101], v28 offset:26112
 ds_read_b64_tr_b16 v[102:103], v28 offset:27136
 v_mfma_f32_16x16x32_bf16 v[228:231], v[52:55], v[44:47], v[228:231]
 buffer_load_dwordx4 v18, s[24:27], s36 offen offset:1024 lds
 v_mfma_f32_16x16x32_bf16 v[136:139], v[56:59], v[32:35], v[136:139]
 ds_read_b64_tr_b16 v[104:105], v29 offset:26112
 ds_read_b64_tr_b16 v[106:107], v29 offset:27136
 v_mfma_f32_16x16x32_bf16 v[168:171], v[56:59], v[36:39], v[168:171]
 v_cvt_pk_bf16_f32 v2, v4, v5
 v_cvt_pk_bf16_f32 v3, v6, v7
 v_mfma_f32_16x16x32_bf16 v[200:203], v[56:59], v[40:43], v[200:203]
 ds_read_b64_tr_b16 v[108:109], v30 offset:26112
 ds_read_b64_tr_b16 v[110:111], v30 offset:27136
 v_mfma_f32_16x16x32_bf16 v[232:235], v[56:59], v[44:47], v[232:235]
 buffer_store_dwordx4 v[0:3], v16, s[16:19], s38 offen offset:0
 v_mfma_f32_16x16x32_bf16 v[140:143], v[60:63], v[32:35], v[140:143]
 ds_read_b64_tr_b16 v[112:113], v27 offset:26240
 ds_read_b64_tr_b16 v[114:115], v27 offset:27264
 v_mfma_f32_16x16x32_bf16 v[172:175], v[60:63], v[36:39], v[172:175]
 v_accvgpr_read_b32 v12, a56
 v_accvgpr_read_b32 v13, a57
 v_mfma_f32_16x16x32_bf16 v[204:207], v[60:63], v[40:43], v[204:207]
 ds_read_b64_tr_b16 v[116:117], v28 offset:26240
 ds_read_b64_tr_b16 v[118:119], v28 offset:27264
 v_mfma_f32_16x16x32_bf16 v[236:239], v[60:63], v[44:47], v[236:239]
 buffer_load_dwordx4 v19, s[24:27], s36 offen offset:2048 lds
 v_mfma_f32_16x16x32_bf16 v[144:147], v[64:67], v[32:35], v[144:147]
 ds_read_b64_tr_b16 v[120:121], v29 offset:26240
 ds_read_b64_tr_b16 v[122:123], v29 offset:27264
 v_mfma_f32_16x16x32_bf16 v[176:179], v[64:67], v[36:39], v[176:179]
 v_accvgpr_read_b32 v14, a58
 v_accvgpr_read_b32 v15, a59
 v_mfma_f32_16x16x32_bf16 v[208:211], v[64:67], v[40:43], v[208:211]
 ds_read_b64_tr_b16 v[124:125], v30 offset:26240
 ds_read_b64_tr_b16 v[126:127], v30 offset:27264
 v_mfma_f32_16x16x32_bf16 v[240:243], v[64:67], v[44:47], v[240:243]
 v_accvgpr_read_b32 v8, a24
 v_accvgpr_read_b32 v9, a25
 v_mfma_f32_16x16x32_bf16 v[148:151], v[68:71], v[32:35], v[148:151]
 v_accvgpr_read_b32 v10, a26
 v_accvgpr_read_b32 v11, a27
 v_mfma_f32_16x16x32_bf16 v[180:183], v[68:71], v[36:39], v[180:183]
 buffer_load_dwordx4 v20, s[24:27], s36 offen offset:3072 lds
 v_mfma_f32_16x16x32_bf16 v[212:215], v[68:71], v[40:43], v[212:215]
 s_add_u32 s37, s49, 4980736
 v_mul_f32 v8, s40, v8
 v_mul_f32 v9, s40, v9
 v_mfma_f32_16x16x32_bf16 v[244:247], v[68:71], v[44:47], v[244:247]
 s_add_u32 m0, s50, 8704
 v_mul_f32 v10, s40, v10
 v_mul_f32 v11, s40, v11
 v_mfma_f32_16x16x32_bf16 v[152:155], v[72:75], v[32:35], v[152:155]
 buffer_load_dwordx4 v21, s[20:23], s37 offen offset:0 lds
 v_mfma_f32_16x16x32_bf16 v[184:187], v[72:75], v[36:39], v[184:187]
 v_mul_f32 v12, s40, v12
 v_mul_f32 v13, s40, v13
 v_mfma_f32_16x16x32_bf16 v[216:219], v[72:75], v[40:43], v[216:219]
 v_mul_f32 v14, s40, v14
 v_mul_f32 v15, s40, v15
 v_mfma_f32_16x16x32_bf16 v[248:251], v[72:75], v[44:47], v[248:251]
 v_mfma_f32_16x16x32_bf16 v[156:159], v[76:79], v[32:35], v[156:159]
 v_cvt_pk_bf16_f32 v8, v8, v9
 v_cvt_pk_bf16_f32 v9, v10, v11
 v_mfma_f32_16x16x32_bf16 v[188:191], v[76:79], v[36:39], v[188:191]
 v_cvt_pk_bf16_f32 v10, v12, v13
 v_cvt_pk_bf16_f32 v11, v14, v15
 v_mfma_f32_16x16x32_bf16 v[220:223], v[76:79], v[40:43], v[220:223]
 buffer_load_dwordx4 v22, s[20:23], s37 offen offset:1024 lds
 v_mfma_f32_16x16x32_bf16 v[252:255], v[76:79], v[44:47], v[252:255]
 s_waitcnt vmcnt(15) lgkmcnt(0)
 s_barrier
 v_accvgpr_read_b32 v4, a188
 v_accvgpr_read_b32 v5, a189
 v_mfma_f32_16x16x32_bf16 v[128:131], v[96:99], v[80:83], v[128:131]
 ds_read_b64_tr_b16 v[48:49], v27 offset:34816
 ds_read_b64_tr_b16 v[50:51], v27 offset:35840
 v_mfma_f32_16x16x32_bf16 v[160:163], v[96:99], v[84:87], v[160:163]
 s_add_u32 s36, s44, 1280
 v_accvgpr_read_b32 v6, a190
 v_accvgpr_read_b32 v7, a191
 v_mfma_f32_16x16x32_bf16 v[192:195], v[96:99], v[88:91], v[192:195]
 s_add_u32 m0, s42, 0
 ds_read_b128 v[32:35], v23 offset:32768
 ds_read_b128 v[36:39], v23 offset:34816
 v_mfma_f32_16x16x32_bf16 v[224:227], v[96:99], v[92:95], v[224:227]
 buffer_load_dwordx4 v17, s[24:27], s36 offen offset:0 lds
 v_mfma_f32_16x16x32_bf16 v[132:135], v[100:103], v[80:83], v[132:135]
 ds_read_b128 v[40:43], v23 offset:36864
 ds_read_b128 v[44:47], v23 offset:38912
 v_mfma_f32_16x16x32_bf16 v[164:167], v[100:103], v[84:87], v[164:167]
 v_accvgpr_read_b32 v0, a184
 v_accvgpr_read_b32 v1, a185
 v_mfma_f32_16x16x32_bf16 v[196:199], v[100:103], v[88:91], v[196:199]
 ds_read_b64_tr_b16 v[52:53], v28 offset:34816
 ds_read_b64_tr_b16 v[54:55], v28 offset:35840
 v_mfma_f32_16x16x32_bf16 v[228:231], v[100:103], v[92:95], v[228:231]
 buffer_load_dwordx4 v18, s[24:27], s36 offen offset:1024 lds
 v_mfma_f32_16x16x32_bf16 v[136:139], v[104:107], v[80:83], v[136:139]
 ds_read_b64_tr_b16 v[56:57], v29 offset:34816
 ds_read_b64_tr_b16 v[58:59], v29 offset:35840
 v_mfma_f32_16x16x32_bf16 v[168:171], v[104:107], v[84:87], v[168:171]
 v_accvgpr_read_b32 v2, a186
 v_accvgpr_read_b32 v3, a187
 v_mfma_f32_16x16x32_bf16 v[200:203], v[104:107], v[88:91], v[200:203]
 ds_read_b64_tr_b16 v[60:61], v30 offset:34816
 ds_read_b64_tr_b16 v[62:63], v30 offset:35840
 v_mfma_f32_16x16x32_bf16 v[232:235], v[104:107], v[92:95], v[232:235]
 buffer_store_dwordx4 v[8:11], v16, s[16:19], s41 offen offset:0
 v_mfma_f32_16x16x32_bf16 v[140:143], v[108:111], v[80:83], v[140:143]
 ds_read_b64_tr_b16 v[64:65], v27 offset:34944
 ds_read_b64_tr_b16 v[66:67], v27 offset:35968
 v_mfma_f32_16x16x32_bf16 v[172:175], v[108:111], v[84:87], v[172:175]
 v_cvt_pk_bf16_f32 v0, v0, v1
 v_cvt_pk_bf16_f32 v1, v2, v3
 v_mfma_f32_16x16x32_bf16 v[204:207], v[108:111], v[88:91], v[204:207]
 ds_read_b64_tr_b16 v[68:69], v28 offset:34944
 ds_read_b64_tr_b16 v[70:71], v28 offset:35968
 v_mfma_f32_16x16x32_bf16 v[236:239], v[108:111], v[92:95], v[236:239]
 buffer_load_dwordx4 v19, s[24:27], s36 offen offset:2048 lds
 v_mfma_f32_16x16x32_bf16 v[144:147], v[112:115], v[80:83], v[144:147]
 ds_read_b64_tr_b16 v[72:73], v29 offset:34944
 ds_read_b64_tr_b16 v[74:75], v29 offset:35968
 v_mfma_f32_16x16x32_bf16 v[176:179], v[112:115], v[84:87], v[176:179]
 v_cvt_pk_bf16_f32 v2, v4, v5
 v_cvt_pk_bf16_f32 v3, v6, v7
 v_mfma_f32_16x16x32_bf16 v[208:211], v[112:115], v[88:91], v[208:211]
 ds_read_b64_tr_b16 v[76:77], v30 offset:34944
 ds_read_b64_tr_b16 v[78:79], v30 offset:35968
 v_mfma_f32_16x16x32_bf16 v[240:243], v[112:115], v[92:95], v[240:243]
 v_accvgpr_read_b32 v12, a120
 v_accvgpr_read_b32 v13, a121
 v_mfma_f32_16x16x32_bf16 v[148:151], v[116:119], v[80:83], v[148:151]
 v_accvgpr_read_b32 v14, a122
 v_accvgpr_read_b32 v15, a123
 v_mfma_f32_16x16x32_bf16 v[180:183], v[116:119], v[84:87], v[180:183]
 buffer_load_dwordx4 v20, s[24:27], s36 offen offset:3072 lds
 v_mfma_f32_16x16x32_bf16 v[212:215], v[116:119], v[88:91], v[212:215]
 s_add_u32 s37, s49, 5242880
 v_accvgpr_read_b32 v8, a88
 v_accvgpr_read_b32 v9, a89
 v_mfma_f32_16x16x32_bf16 v[244:247], v[116:119], v[92:95], v[244:247]
 s_add_u32 m0, s50, 17408
 v_accvgpr_read_b32 v10, a90
 v_accvgpr_read_b32 v11, a91
 v_mfma_f32_16x16x32_bf16 v[152:155], v[120:123], v[80:83], v[152:155]
 buffer_load_dwordx4 v21, s[20:23], s37 offen offset:0 lds
 v_mfma_f32_16x16x32_bf16 v[184:187], v[120:123], v[84:87], v[184:187]
 v_mul_f32 v8, s40, v8
 v_mul_f32 v9, s40, v9
 v_mfma_f32_16x16x32_bf16 v[216:219], v[120:123], v[88:91], v[216:219]
 v_mul_f32 v10, s40, v10
 v_mul_f32 v11, s40, v11
 v_mfma_f32_16x16x32_bf16 v[248:251], v[120:123], v[92:95], v[248:251]
 buffer_store_dwordx4 v[0:3], v16, s[16:19], s38 offen offset:1024
 v_mfma_f32_16x16x32_bf16 v[156:159], v[124:127], v[80:83], v[156:159]
 v_mul_f32 v12, s40, v12
 v_mul_f32 v13, s40, v13
 v_mfma_f32_16x16x32_bf16 v[188:191], v[124:127], v[84:87], v[188:191]
 v_mul_f32 v14, s40, v14
 v_mul_f32 v15, s40, v15
 v_mfma_f32_16x16x32_bf16 v[220:223], v[124:127], v[88:91], v[220:223]
 buffer_load_dwordx4 v22, s[20:23], s37 offen offset:1024 lds
 v_mfma_f32_16x16x32_bf16 v[252:255], v[124:127], v[92:95], v[252:255]
 s_waitcnt lgkmcnt(0)
 v_cvt_pk_bf16_f32 v8, v8, v9
 v_cvt_pk_bf16_f32 v9, v10, v11
 v_mfma_f32_16x16x32_bf16 v[128:131], v[48:51], v[32:35], v[128:131]
 ds_read_b64_tr_b16 v[96:97], v27 offset:43520
 ds_read_b64_tr_b16 v[98:99], v27 offset:44544
 v_mfma_f32_16x16x32_bf16 v[160:163], v[48:51], v[36:39], v[160:163]
 s_add_u32 s36, s45, 1280
 v_cvt_pk_bf16_f32 v10, v12, v13
 v_cvt_pk_bf16_f32 v11, v14, v15
 v_mfma_f32_16x16x32_bf16 v[192:195], v[48:51], v[40:43], v[192:195]
 s_add_u32 m0, s42, 4096
 ds_read_b128 v[80:83], v24 offset:32768
 ds_read_b128 v[84:87], v24 offset:34816
 v_mfma_f32_16x16x32_bf16 v[224:227], v[48:51], v[44:47], v[224:227]
 buffer_load_dwordx4 v17, s[24:27], s36 offen offset:0 lds
 v_mfma_f32_16x16x32_bf16 v[132:135], v[52:55], v[32:35], v[132:135]
 ds_read_b128 v[88:91], v24 offset:36864
 ds_read_b128 v[92:95], v24 offset:38912
 v_mfma_f32_16x16x32_bf16 v[164:167], v[52:55], v[36:39], v[164:167]
 v_accvgpr_read_b32 v4, a220
 v_accvgpr_read_b32 v5, a221
 v_mfma_f32_16x16x32_bf16 v[196:199], v[52:55], v[40:43], v[196:199]
 ds_read_b64_tr_b16 v[100:101], v28 offset:43520
 ds_read_b64_tr_b16 v[102:103], v28 offset:44544
 v_mfma_f32_16x16x32_bf16 v[228:231], v[52:55], v[44:47], v[228:231]
 buffer_load_dwordx4 v18, s[24:27], s36 offen offset:1024 lds
 v_mfma_f32_16x16x32_bf16 v[136:139], v[56:59], v[32:35], v[136:139]
 ds_read_b64_tr_b16 v[104:105], v29 offset:43520
 ds_read_b64_tr_b16 v[106:107], v29 offset:44544
 v_mfma_f32_16x16x32_bf16 v[168:171], v[56:59], v[36:39], v[168:171]
 v_accvgpr_read_b32 v6, a222
 v_accvgpr_read_b32 v7, a223
 v_mfma_f32_16x16x32_bf16 v[200:203], v[56:59], v[40:43], v[200:203]
 ds_read_b64_tr_b16 v[108:109], v30 offset:43520
 ds_read_b64_tr_b16 v[110:111], v30 offset:44544
 v_mfma_f32_16x16x32_bf16 v[232:235], v[56:59], v[44:47], v[232:235]
 buffer_store_dwordx4 v[8:11], v16, s[16:19], s41 offen offset:1024
 v_mfma_f32_16x16x32_bf16 v[140:143], v[60:63], v[32:35], v[140:143]
 s_add_u32 s41, s41, 4096
 ds_read_b64_tr_b16 v[112:113], v27 offset:43648
 ds_read_b64_tr_b16 v[114:115], v27 offset:44672
 v_mfma_f32_16x16x32_bf16 v[172:175], v[60:63], v[36:39], v[172:175]
 v_accvgpr_read_b32 v0, a216
 v_accvgpr_read_b32 v1, a217
 v_mfma_f32_16x16x32_bf16 v[204:207], v[60:63], v[40:43], v[204:207]
 ds_read_b64_tr_b16 v[116:117], v28 offset:43648
 ds_read_b64_tr_b16 v[118:119], v28 offset:44672
 v_mfma_f32_16x16x32_bf16 v[236:239], v[60:63], v[44:47], v[236:239]
 buffer_load_dwordx4 v19, s[24:27], s36 offen offset:2048 lds
 v_mfma_f32_16x16x32_bf16 v[144:147], v[64:67], v[32:35], v[144:147]
 ds_read_b64_tr_b16 v[120:121], v29 offset:43648
 ds_read_b64_tr_b16 v[122:123], v29 offset:44672
 v_mfma_f32_16x16x32_bf16 v[176:179], v[64:67], v[36:39], v[176:179]
 v_accvgpr_read_b32 v2, a218
 v_accvgpr_read_b32 v3, a219
 v_mfma_f32_16x16x32_bf16 v[208:211], v[64:67], v[40:43], v[208:211]
 ds_read_b64_tr_b16 v[124:125], v30 offset:43648
 ds_read_b64_tr_b16 v[126:127], v30 offset:44672
 v_mfma_f32_16x16x32_bf16 v[240:243], v[64:67], v[44:47], v[240:243]
 v_cvt_pk_bf16_f32 v0, v0, v1
 v_cvt_pk_bf16_f32 v1, v2, v3
 v_mfma_f32_16x16x32_bf16 v[148:151], v[68:71], v[32:35], v[148:151]
 v_cvt_pk_bf16_f32 v2, v4, v5
 v_cvt_pk_bf16_f32 v3, v6, v7
 v_mfma_f32_16x16x32_bf16 v[180:183], v[68:71], v[36:39], v[180:183]
 buffer_load_dwordx4 v20, s[24:27], s36 offen offset:3072 lds
 v_mfma_f32_16x16x32_bf16 v[212:215], v[68:71], v[40:43], v[212:215]
 s_add_u32 s37, s49, 5505024
 v_accvgpr_read_b32 v12, a60
 v_accvgpr_read_b32 v13, a61
 v_mfma_f32_16x16x32_bf16 v[244:247], v[68:71], v[44:47], v[244:247]
 s_add_u32 m0, s50, 26112
 v_accvgpr_read_b32 v14, a62
 v_accvgpr_read_b32 v15, a63
 v_mfma_f32_16x16x32_bf16 v[152:155], v[72:75], v[32:35], v[152:155]
 buffer_load_dwordx4 v21, s[20:23], s37 offen offset:0 lds
 v_mfma_f32_16x16x32_bf16 v[184:187], v[72:75], v[36:39], v[184:187]
 v_accvgpr_read_b32 v8, a28
 v_accvgpr_read_b32 v9, a29
 v_mfma_f32_16x16x32_bf16 v[216:219], v[72:75], v[40:43], v[216:219]
 v_accvgpr_read_b32 v10, a30
 v_accvgpr_read_b32 v11, a31
 v_mfma_f32_16x16x32_bf16 v[248:251], v[72:75], v[44:47], v[248:251]
 buffer_store_dwordx4 v[0:3], v16, s[16:19], s38 offen offset:2048
 v_mfma_f32_16x16x32_bf16 v[156:159], v[76:79], v[32:35], v[156:159]
 v_mul_f32 v8, s40, v8
 v_mul_f32 v9, s40, v9
 v_mfma_f32_16x16x32_bf16 v[188:191], v[76:79], v[36:39], v[188:191]
 v_mul_f32 v10, s40, v10
 v_mul_f32 v11, s40, v11
 v_mfma_f32_16x16x32_bf16 v[220:223], v[76:79], v[40:43], v[220:223]
 buffer_load_dwordx4 v22, s[20:23], s37 offen offset:1024 lds
 v_mfma_f32_16x16x32_bf16 v[252:255], v[76:79], v[44:47], v[252:255]
 s_waitcnt vmcnt(16) lgkmcnt(0)
 s_barrier
 v_mul_f32 v12, s40, v12
 v_mul_f32 v13, s40, v13
 v_mfma_f32_16x16x32_bf16 v[128:131], v[96:99], v[80:83], v[128:131]
 ds_read_b64_tr_b16 v[48:49], v27 offset:0
 ds_read_b64_tr_b16 v[50:51], v27 offset:1024
 v_mfma_f32_16x16x32_bf16 v[160:163], v[96:99], v[84:87], v[160:163]
 s_add_u32 s36, s44, 1408
 v_mul_f32 v14, s40, v14
 v_mul_f32 v15, s40, v15
 v_mfma_f32_16x16x32_bf16 v[192:195], v[96:99], v[88:91], v[192:195]
 s_add_u32 m0, s42, 32768
 ds_read_b128 v[32:35], v25 offset:0
 ds_read_b128 v[36:39], v25 offset:2048
 v_mfma_f32_16x16x32_bf16 v[224:227], v[96:99], v[92:95], v[224:227]
 buffer_load_dwordx4 v17, s[24:27], s36 offen offset:0 lds
 v_mfma_f32_16x16x32_bf16 v[132:135], v[100:103], v[80:83], v[132:135]
 ds_read_b128 v[40:43], v25 offset:4096
 ds_read_b128 v[44:47], v25 offset:6144
 v_mfma_f32_16x16x32_bf16 v[164:167], v[100:103], v[84:87], v[164:167]
 v_cvt_pk_bf16_f32 v8, v8, v9
 v_cvt_pk_bf16_f32 v9, v10, v11
 v_mfma_f32_16x16x32_bf16 v[196:199], v[100:103], v[88:91], v[196:199]
 ds_read_b64_tr_b16 v[52:53], v28 offset:0
 ds_read_b64_tr_b16 v[54:55], v28 offset:1024
 v_mfma_f32_16x16x32_bf16 v[228:231], v[100:103], v[92:95], v[228:231]
 buffer_load_dwordx4 v18, s[24:27], s36 offen offset:1024 lds
 v_mfma_f32_16x16x32_bf16 v[136:139], v[104:107], v[80:83], v[136:139]
 ds_read_b64_tr_b16 v[56:57], v29 offset:0
 ds_read_b64_tr_b16 v[58:59], v29 offset:1024
 v_mfma_f32_16x16x32_bf16 v[168:171], v[104:107], v[84:87], v[168:171]
 v_cvt_pk_bf16_f32 v10, v12, v13
 v_cvt_pk_bf16_f32 v11, v14, v15
 v_mfma_f32_16x16x32_bf16 v[200:203], v[104:107], v[88:91], v[200:203]
 ds_read_b64_tr_b16 v[60:61], v30 offset:0
 ds_read_b64_tr_b16 v[62:63], v30 offset:1024
 v_mfma_f32_16x16x32_bf16 v[232:235], v[104:107], v[92:95], v[232:235]
 buffer_store_dwordx4 v[8:11], v16, s[16:19], s41 offen offset:0
 v_mfma_f32_16x16x32_bf16 v[140:143], v[108:111], v[80:83], v[140:143]
 ds_read_b64_tr_b16 v[64:65], v27 offset:128
 ds_read_b64_tr_b16 v[66:67], v27 offset:1152
 v_mfma_f32_16x16x32_bf16 v[172:175], v[108:111], v[84:87], v[172:175]
 v_accvgpr_read_b32 v4, a252
 v_accvgpr_read_b32 v5, a253
 v_mfma_f32_16x16x32_bf16 v[204:207], v[108:111], v[88:91], v[204:207]
 ds_read_b64_tr_b16 v[68:69], v28 offset:128
 ds_read_b64_tr_b16 v[70:71], v28 offset:1152
 v_mfma_f32_16x16x32_bf16 v[236:239], v[108:111], v[92:95], v[236:239]
 buffer_load_dwordx4 v19, s[24:27], s36 offen offset:2048 lds
 v_mfma_f32_16x16x32_bf16 v[144:147], v[112:115], v[80:83], v[144:147]
 ds_read_b64_tr_b16 v[72:73], v29 offset:128
 ds_read_b64_tr_b16 v[74:75], v29 offset:1152
 v_mfma_f32_16x16x32_bf16 v[176:179], v[112:115], v[84:87], v[176:179]
L_pad6:
 s_cbranch_execz L_pad14
 v_accvgpr_read_b32 v6, a254
 v_accvgpr_read_b32 v7, a255
 v_mfma_f32_16x16x32_bf16 v[208:211], v[112:115], v[88:91], v[208:211]
 ds_read_b64_tr_b16 v[76:77], v30 offset:128
 ds_read_b64_tr_b16 v[78:79], v30 offset:1152
 v_mfma_f32_16x16x32_bf16 v[240:243], v[112:115], v[92:95], v[240:243]
 v_accvgpr_read_b32 v0, a248
 v_accvgpr_read_b32 v1, a249
 v_mfma_f32_16x16x32_bf16 v[148:151], v[116:119], v[80:83], v[148:151]
 v_accvgpr_read_b32 v2, a250
 v_accvgpr_read_b32 v3, a251
 v_mfma_f32_16x16x32_bf16 v[180:183], v[116:119], v[84:87], v[180:183]
 buffer_load_dwordx4 v20, s[24:27], s36 offen offset:3072 lds
 v_mfma_f32_16x16x32_bf16 v[212:215], v[116:119], v[88:91], v[212:215]
 s_add_u32 s37, s49, 5767168
 v_cvt_pk_bf16_f32 v0, v0, v1
 v_cvt_pk_bf16_f32 v1, v2, v3
 v_mfma_f32_16x16x32_bf16 v[244:247], v[116:119], v[92:95], v[244:247]
 s_add_u32 m0, s50, 34816
 v_cvt_pk_bf16_f32 v2, v4, v5
 v_cvt_pk_bf16_f32 v3, v6, v7
 v_mfma_f32_16x16x32_bf16 v[152:155], v[120:123], v[80:83], v[152:155]
 buffer_load_dwordx4 v21, s[20:23], s37 offen offset:0 lds
 v_mfma_f32_16x16x32_bf16 v[184:187], v[120:123], v[84:87], v[184:187]
 v_accvgpr_read_b32 v12, a124
 v_accvgpr_read_b32 v13, a125
 v_mfma_f32_16x16x32_bf16 v[216:219], v[120:123], v[88:91], v[216:219]
 v_accvgpr_read_b32 v14, a126
 v_accvgpr_read_b32 v15, a127
 v_mfma_f32_16x16x32_bf16 v[248:251], v[120:123], v[92:95], v[248:251]
 buffer_store_dwordx4 v[0:3], v16, s[16:19], s38 offen offset:3072
 v_mfma_f32_16x16x32_bf16 v[156:159], v[124:127], v[80:83], v[156:159]
 s_add_u32 s38, s38, 16384
 v_accvgpr_read_b32 v8, a92
 v_accvgpr_read_b32 v9, a93
 v_mfma_f32_16x16x32_bf16 v[188:191], v[124:127], v[84:87], v[188:191]
 v_accvgpr_read_b32 v10, a94
 v_accvgpr_read_b32 v11, a95
 v_mfma_f32_16x16x32_bf16 v[220:223], v[124:127], v[88:91], v[220:223]
 buffer_load_dwordx4 v22, s[20:23], s37 offen offset:1024 lds
 v_mfma_f32_16x16x32_bf16 v[252:255], v[124:127], v[92:95], v[252:255]
 s_waitcnt lgkmcnt(0)
 v_mul_f32 v8, s40, v8
 v_mul_f32 v9, s40, v9
 v_mfma_f32_16x16x32_bf16 v[128:131], v[48:51], v[32:35], v[128:131]
 ds_read_b64_tr_b16 v[96:97], v27 offset:8704
 ds_read_b64_tr_b16 v[98:99], v27 offset:9728
 v_mfma_f32_16x16x32_bf16 v[160:163], v[48:51], v[36:39], v[160:163]
 s_add_u32 s36, s45, 1408
 v_mul_f32 v10, s40, v10
 v_mul_f32 v11, s40, v11
 v_mfma_f32_16x16x32_bf16 v[192:195], v[48:51], v[40:43], v[192:195]
 s_add_u32 m0, s42, 36864
 ds_read_b128 v[80:83], v26 offset:0
 ds_read_b128 v[84:87], v26 offset:2048
 v_mfma_f32_16x16x32_bf16 v[224:227], v[48:51], v[44:47], v[224:227]
 buffer_load_dwordx4 v17, s[24:27], s36 offen offset:0 lds
 v_mfma_f32_16x16x32_bf16 v[132:135], v[52:55], v[32:35], v[132:135]
 ds_read_b128 v[88:91], v26 offset:4096
 ds_read_b128 v[92:95], v26 offset:6144
 v_mfma_f32_16x16x32_bf16 v[164:167], v[52:55], v[36:39], v[164:167]
 v_mul_f32 v12, s40, v12
 v_mul_f32 v13, s40, v13
 v_mfma_f32_16x16x32_bf16 v[196:199], v[52:55], v[40:43], v[196:199]
 ds_read_b64_tr_b16 v[100:101], v28 offset:8704
 ds_read_b64_tr_b16 v[102:103], v28 offset:9728
 v_mfma_f32_16x16x32_bf16 v[228:231], v[52:55], v[44:47], v[228:231]
 buffer_load_dwordx4 v18, s[24:27], s36 offen offset:1024 lds
 v_mfma_f32_16x16x32_bf16 v[136:139], v[56:59], v[32:35], v[136:139]
 ds_read_b64_tr_b16 v[104:105], v29 offset:8704
 ds_read_b64_tr_b16 v[106:107], v29 offset:9728
 v_mfma_f32_16x16x32_bf16 v[168:171], v[56:59], v[36:39], v[168:171]
 v_mul_f32 v14, s40, v14
 v_mul_f32 v15, s40, v15
 v_mfma_f32_16x16x32_bf16 v[200:203], v[56:59], v[40:43], v[200:203]
 ds_read_b64_tr_b16 v[108:109], v30 offset:8704
 ds_read_b64_tr_b16 v[110:111], v30 offset:9728
 v_mfma_f32_16x16x32_bf16 v[232:235], v[56:59], v[44:47], v[232:235]
 v_mfma_f32_16x16x32_bf16 v[140:143], v[60:63], v[32:35], v[140:143]
 ds_read_b64_tr_b16 v[112:113], v27 offset:8832
 ds_read_b64_tr_b16 v[114:115], v27 offset:9856
 v_mfma_f32_16x16x32_bf16 v[172:175], v[60:63], v[36:39], v[172:175]
 v_cvt_pk_bf16_f32 v8, v8, v9
 v_cvt_pk_bf16_f32 v9, v10, v11
 v_mfma_f32_16x16x32_bf16 v[204:207], v[60:63], v[40:43], v[204:207]
 ds_read_b64_tr_b16 v[116:117], v28 offset:8832
 ds_read_b64_tr_b16 v[118:119], v28 offset:9856
 v_mfma_f32_16x16x32_bf16 v[236:239], v[60:63], v[44:47], v[236:239]
 buffer_load_dwordx4 v19, s[24:27], s36 offen offset:2048 lds
 v_mfma_f32_16x16x32_bf16 v[144:147], v[64:67], v[32:35], v[144:147]
 ds_read_b64_tr_b16 v[120:121], v29 offset:8832
 ds_read_b64_tr_b16 v[122:123], v29 offset:9856
 v_mfma_f32_16x16x32_bf16 v[176:179], v[64:67], v[36:39], v[176:179]
 v_cvt_pk_bf16_f32 v10, v12, v13
 v_cvt_pk_bf16_f32 v11, v14, v15
 v_mfma_f32_16x16x32_bf16 v[208:211], v[64:67], v[40:43], v[208:211]
 ds_read_b64_tr_b16 v[124:125], v30 offset:8832
 ds_read_b64_tr_b16 v[126:127], v30 offset:9856
 v_mfma_f32_16x16x32_bf16 v[240:243], v[64:67], v[44:47], v[240:243]
 v_mfma_f32_16x16x32_bf16 v[148:151], v[68:71], v[32:35], v[148:151]
 v_mfma_f32_16x16x32_bf16 v[180:183], v[68:71], v[36:39], v[180:183]
 buffer_load_dwordx4 v20, s[24:27], s36 offen offset:3072 lds
 v_mfma_f32_16x16x32_bf16 v[212:215], v[68:71], v[40:43], v[212:215]
 s_add_u32 s37, s49, 6029312
 v_mfma_f32_16x16x32_bf16 v[244:247], v[68:71], v[44:47], v[244:247]
 s_add_u32 m0, s50, 43520
 v_mfma_f32_16x16x32_bf16 v[152:155], v[72:75], v[32:35], v[152:155]
 buffer_load_dwordx4 v21, s[20:23], s37 offen offset:0 lds
 v_mfma_f32_16x16x32_bf16 v[184:187], v[72:75], v[36:39], v[184:187]
 v_mfma_f32_16x16x32_bf16 v[216:219], v[72:75], v[40:43], v[216:219]
 v_mfma_f32_16x16x32_bf16 v[248:251], v[72:75], v[44:47], v[248:251]
 buffer_store_dwordx4 v[8:11], v16, s[16:19], s41 offen offset:1024
 v_mfma_f32_16x16x32_bf16 v[156:159], v[76:79], v[32:35], v[156:159]
 s_add_u32 s41, s41, 12288
 v_mfma_f32_16x16x32_bf16 v[188:191], v[76:79], v[36:39], v[188:191]
 v_mov_b32 v1, 1
 v_mov_b32 v0, 0
 v_mfma_f32_16x16x32_bf16 v[220:223], v[76:79], v[40:43], v[220:223]
 buffer_load_dwordx4 v22, s[20:23], s37 offen offset:1024 lds
 v_mfma_f32_16x16x32_bf16 v[252:255], v[76:79], v[44:47], v[252:255]
 s_waitcnt vmcnt(15) lgkmcnt(0)
 s_barrier
 v_bfe_u32 v3, v16, 1, 8
 v_mfma_f32_16x16x32_bf16 v[128:131], v[96:99], v[80:83], v[128:131]
 s_lshl_b32 s40, s33, 7
 ds_read_b64_tr_b16 v[48:49], v27 offset:17408
 ds_read_b64_tr_b16 v[50:51], v27 offset:18432
 v_mfma_f32_16x16x32_bf16 v[160:163], v[96:99], v[84:87], v[160:163]
 s_add_u32 s36, s44, 1536
 v_mfma_f32_16x16x32_bf16 v[192:195], v[96:99], v[88:91], v[192:195]
 s_add_u32 m0, s42, 65536
 ds_read_b128 v[32:35], v23 offset:0
 ds_read_b128 v[36:39], v23 offset:2048
 v_mfma_f32_16x16x32_bf16 v[224:227], v[96:99], v[92:95], v[224:227]
 buffer_load_dwordx4 v17, s[24:27], s36 offen offset:0 lds
 v_mfma_f32_16x16x32_bf16 v[132:135], v[100:103], v[80:83], v[132:135]
 s_add_u32 s40, s40, 393216
 ds_read_b128 v[40:43], v23 offset:4096
 ds_read_b128 v[44:47], v23 offset:6144
 v_mfma_f32_16x16x32_bf16 v[164:167], v[100:103], v[84:87], v[164:167]
 v_mov_b32 v10, 0x0f0f0f0f
 v_mov_b32 v4, 0
 v_mfma_f32_16x16x32_bf16 v[196:199], v[100:103], v[88:91], v[196:199]
 ds_read_b64_tr_b16 v[52:53], v28 offset:17408
 ds_read_b64_tr_b16 v[54:55], v28 offset:18432
 v_mfma_f32_16x16x32_bf16 v[228:231], v[100:103], v[92:95], v[228:231]
 buffer_load_dwordx4 v18, s[24:27], s36 offen offset:1024 lds
 v_mfma_f32_16x16x32_bf16 v[136:139], v[104:107], v[80:83], v[136:139]
 ds_read_b64_tr_b16 v[56:57], v29 offset:17408
 ds_read_b64_tr_b16 v[58:59], v29 offset:18432
 v_mfma_f32_16x16x32_bf16 v[168:171], v[104:107], v[84:87], v[168:171]
 v_mov_b32 v5, 0
 v_mov_b32 v6, 0
 v_mfma_f32_16x16x32_bf16 v[200:203], v[104:107], v[88:91], v[200:203]
 ds_read_b64_tr_b16 v[60:61], v30 offset:17408
 ds_read_b64_tr_b16 v[62:63], v30 offset:18432
 v_mfma_f32_16x16x32_bf16 v[232:235], v[104:107], v[92:95], v[232:235]
 buffer_load_dword v9, v3, s[76:79], 0 offen sc1
 v_mfma_f32_16x16x32_bf16 v[140:143], v[108:111], v[80:83], v[140:143]
 ds_read_b64_tr_b16 v[64:65], v27 offset:17536
 ds_read_b64_tr_b16 v[66:67], v27 offset:18560
 v_mfma_f32_16x16x32_bf16 v[172:175], v[108:111], v[84:87], v[172:175]
 v_mov_b32 v7, 0
 v_mov_b32 v8, 153600
 v_mfma_f32_16x16x32_bf16 v[204:207], v[108:111], v[88:91], v[204:207]
 ds_read_b64_tr_b16 v[68:69], v28 offset:17536
 ds_read_b64_tr_b16 v[70:71], v28 offset:18560
 v_mfma_f32_16x16x32_bf16 v[236:239], v[108:111], v[92:95], v[236:239]
 buffer_load_dwordx4 v19, s[24:27], s36 offen offset:2048 lds
 v_mfma_f32_16x16x32_bf16 v[144:147], v[112:115], v[80:83], v[144:147]
 ds_read_b64_tr_b16 v[72:73], v29 offset:17536
 ds_read_b64_tr_b16 v[74:75], v29 offset:18560
 v_mfma_f32_16x16x32_bf16 v[176:179], v[112:115], v[84:87], v[176:179]
 ds_write_b128 v8, v[4:7]
 ds_read_b128 a[0:3], v8
 v_mfma_f32_16x16x32_bf16 v[208:211], v[112:115], v[88:91], v[208:211]
 ds_read_b64_tr_b16 v[76:77], v30 offset:17536
 ds_read_b64_tr_b16 v[78:79], v30 offset:18560
 v_mfma_f32_16x16x32_bf16 v[240:243], v[112:115], v[92:95], v[240:243]
 ds_read_b128 a[4:7], v8
 ds_read_b128 a[8:11], v8
 v_mfma_f32_16x16x32_bf16 v[148:151], v[116:119], v[80:83], v[148:151]
 ds_read_b128 a[12:15], v8
 ds_read_b128 a[16:19], v8
 v_mfma_f32_16x16x32_bf16 v[180:183], v[116:119], v[84:87], v[180:183]
 buffer_load_dwordx4 v20, s[24:27], s36 offen offset:3072 lds
 v_mfma_f32_16x16x32_bf16 v[212:215], v[116:119], v[88:91], v[212:215]
 s_add_u32 s37, s49, 6291456
 ds_read_b128 a[20:23], v8
 ds_read_b128 a[24:27], v8
 v_mfma_f32_16x16x32_bf16 v[244:247], v[116:119], v[92:95], v[244:247]
 s_add_u32 m0, s50, 0
 ds_read_b128 a[28:31], v8
 ds_read_b128 a[32:35], v8
 v_mfma_f32_16x16x32_bf16 v[152:155], v[120:123], v[80:83], v[152:155]
 buffer_load_dwordx4 v21, s[20:23], s37 offen offset:0 lds
 v_mfma_f32_16x16x32_bf16 v[184:187], v[120:123], v[84:87], v[184:187]
 ds_read_b128 a[36:39], v8
 ds_read_b128 a[40:43], v8
 v_mfma_f32_16x16x32_bf16 v[216:219], v[120:123], v[88:91], v[216:219]
 ds_read_b128 a[44:47], v8
 ds_read_b128 a[48:51], v8
 v_mfma_f32_16x16x32_bf16 v[248:251], v[120:123], v[92:95], v[248:251]
 v_mfma_f32_16x16x32_bf16 v[156:159], v[124:127], v[80:83], v[156:159]
 v_mfma_f32_16x16x32_bf16 v[188:191], v[124:127], v[84:87], v[188:191]
 v_mfma_f32_16x16x32_bf16 v[220:223], v[124:127], v[88:91], v[220:223]
 buffer_load_dwordx4 v22, s[20:23], s37 offen offset:1024 lds
 v_mfma_f32_16x16x32_bf16 v[252:255], v[124:127], v[92:95], v[252:255]
 s_waitcnt lgkmcnt(0)
 v_mfma_f32_16x16x32_bf16 v[128:131], v[48:51], v[32:35], v[128:131]
 s_getreg_b32 s58, hwreg(HW_REG_XCC_ID, 0, 3)
 ds_read_b64_tr_b16 v[96:97], v27 offset:26112
 ds_read_b64_tr_b16 v[98:99], v27 offset:27136
 v_mfma_f32_16x16x32_bf16 v[160:163], v[48:51], v[36:39], v[160:163]
 s_add_u32 s36, s45, 1536
 ds_read_b128 a[52:55], v8
 ds_read_b128 a[56:59], v8
 v_mfma_f32_16x16x32_bf16 v[192:195], v[48:51], v[40:43], v[192:195]
 s_add_u32 m0, s42, 69632
 ds_read_b128 v[80:83], v24 offset:0
 ds_read_b128 v[84:87], v24 offset:2048
 v_mfma_f32_16x16x32_bf16 v[224:227], v[48:51], v[44:47], v[224:227]
 buffer_load_dwordx4 v17, s[24:27], s36 offen offset:0 lds
 v_mfma_f32_16x16x32_bf16 v[132:135], v[52:55], v[32:35], v[132:135]
 s_lshl_b32 s58, s58, 2
 ds_read_b128 v[88:91], v24 offset:4096
 ds_read_b128 v[92:95], v24 offset:6144
 v_mfma_f32_16x16x32_bf16 v[164:167], v[52:55], v[36:39], v[164:167]
 s_lshl_b32 s58, 8, s58
 ds_read_b128 a[60:63], v8
 ds_read_b128 a[64:67], v8
 v_mfma_f32_16x16x32_bf16 v[196:199], v[52:55], v[40:43], v[196:199]
 ds_read_b64_tr_b16 v[100:101], v28 offset:26112
 ds_read_b64_tr_b16 v[102:103], v28 offset:27136
 v_mfma_f32_16x16x32_bf16 v[228:231], v[52:55], v[44:47], v[228:231]
 buffer_load_dwordx4 v18, s[24:27], s36 offen offset:1024 lds
 v_mfma_f32_16x16x32_bf16 v[136:139], v[56:59], v[32:35], v[136:139]
 ds_read_b64_tr_b16 v[104:105], v29 offset:26112
 ds_read_b64_tr_b16 v[106:107], v29 offset:27136
 v_mfma_f32_16x16x32_bf16 v[168:171], v[56:59], v[36:39], v[168:171]
 ds_read_b128 a[68:71], v8
 ds_read_b128 a[72:75], v8
 v_mfma_f32_16x16x32_bf16 v[200:203], v[56:59], v[40:43], v[200:203]
 ds_read_b64_tr_b16 v[108:109], v30 offset:26112
 ds_read_b64_tr_b16 v[110:111], v30 offset:27136
 v_mfma_f32_16x16x32_bf16 v[232:235], v[56:59], v[44:47], v[232:235]
 v_mfma_f32_16x16x32_bf16 v[140:143], v[60:63], v[32:35], v[140:143]
 ds_read_b64_tr_b16 v[112:113], v27 offset:26240
 ds_read_b64_tr_b16 v[114:115], v27 offset:27264
 v_mfma_f32_16x16x32_bf16 v[172:175], v[60:63], v[36:39], v[172:175]
 ds_read_b128 a[76:79], v8
 ds_read_b128 a[80:83], v8
 v_mfma_f32_16x16x32_bf16 v[204:207], v[60:63], v[40:43], v[204:207]
 ds_read_b64_tr_b16 v[116:117], v28 offset:26240
 ds_read_b64_tr_b16 v[118:119], v28 offset:27264
 v_mfma_f32_16x16x32_bf16 v[236:239], v[60:63], v[44:47], v[236:239]
 buffer_load_dwordx4 v19, s[24:27], s36 offen offset:2048 lds
 v_mfma_f32_16x16x32_bf16 v[144:147], v[64:67], v[32:35], v[144:147]
 ds_read_b64_tr_b16 v[120:121], v29 offset:26240
 ds_read_b64_tr_b16 v[122:123], v29 offset:27264
 v_mfma_f32_16x16x32_bf16 v[176:179], v[64:67], v[36:39], v[176:179]
 ds_read_b128 a[84:87], v8
 ds_read_b128 a[88:91], v8
 v_mfma_f32_16x16x32_bf16 v[208:211], v[64:67], v[40:43], v[208:211]
 ds_read_b64_tr_b16 v[124:125], v30 offset:26240
 ds_read_b64_tr_b16 v[126:127], v30 offset:27264
 v_mfma_f32_16x16x32_bf16 v[240:243], v[64:67], v[44:47], v[240:243]
 ds_read_b128 a[92:95], v8
 ds_read_b128 a[96:99], v8
 v_mfma_f32_16x16x32_bf16 v[148:151], v[68:71], v[32:35], v[148:151]
 ds_read_b128 a[100:103], v8
 ds_read_b128 a[104:107], v8
 v_mfma_f32_16x16x32_bf16 v[180:183], v[68:71], v[36:39], v[180:183]
 buffer_load_dwordx4 v20, s[24:27], s36 offen offset:3072 lds
 v_mfma_f32_16x16x32_bf16 v[212:215], v[68:71], v[40:43], v[212:215]
 s_add_u32 s37, s49, 6553600
 ds_read_b128 a[108:111], v8
 ds_read_b128 a[112:115], v8
 v_mfma_f32_16x16x32_bf16 v[244:247], v[68:71], v[44:47], v[244:247]
 s_add_u32 m0, s50, 8704
 ds_read_b128 a[116:119], v8
 ds_read_b128 a[120:123], v8
 v_mfma_f32_16x16x32_bf16 v[152:155], v[72:75], v[32:35], v[152:155]
 buffer_load_dwordx4 v21, s[20:23], s37 offen offset:0 lds
 v_mfma_f32_16x16x32_bf16 v[184:187], v[72:75], v[36:39], v[184:187]
 ds_read_b128 a[124:127], v8
 v_mfma_f32_16x16x32_bf16 v[216:219], v[72:75], v[40:43], v[216:219]
 v_mfma_f32_16x16x32_bf16 v[248:251], v[72:75], v[44:47], v[248:251]
 v_mfma_f32_16x16x32_bf16 v[156:159], v[76:79], v[32:35], v[156:159]
 v_mfma_f32_16x16x32_bf16 v[188:191], v[76:79], v[36:39], v[188:191]
 v_mfma_f32_16x16x32_bf16 v[220:223], v[76:79], v[40:43], v[220:223]
 buffer_load_dwordx4 v22, s[20:23], s37 offen offset:1024 lds
 v_mfma_f32_16x16x32_bf16 v[252:255], v[76:79], v[44:47], v[252:255]
 s_waitcnt vmcnt(10) lgkmcnt(0)
 s_barrier
 v_readlane_b32 s54, v9, s33
 v_and_b32 v11, v10, v9
 v_mfma_f32_16x16x32_bf16 v[128:131], v[96:99], v[80:83], v[128:131]
 ds_read_b64_tr_b16 v[48:49], v27 offset:34816
 ds_read_b64_tr_b16 v[50:51], v27 offset:35840
 v_mfma_f32_16x16x32_bf16 v[160:163], v[96:99], v[84:87], v[160:163]
 s_add_u32 s36, s44, 1664
 v_lshrrev_b32 v12, 4, v9
 v_and_b32 v12, v10, v12
 v_mfma_f32_16x16x32_bf16 v[192:195], v[96:99], v[88:91], v[192:195]
 s_add_u32 m0, s42, 0
 ds_read_b128 v[32:35], v23 offset:32768
 ds_read_b128 v[36:39], v23 offset:34816
 v_mfma_f32_16x16x32_bf16 v[224:227], v[96:99], v[92:95], v[224:227]
 buffer_load_dwordx4 v17, s[24:27], s36 offen offset:0 lds
 v_mfma_f32_16x16x32_bf16 v[132:135], v[100:103], v[80:83], v[132:135]
 ds_read_b128 v[40:43], v23 offset:36864
 ds_read_b128 v[44:47], v23 offset:38912
 v_mfma_f32_16x16x32_bf16 v[164:167], v[100:103], v[84:87], v[164:167]
 v_sad_u8 v11, v11, 0, 0
 v_sad_u8 v11, v12, 0, v11
 v_mfma_f32_16x16x32_bf16 v[196:199], v[100:103], v[88:91], v[196:199]
 ds_read_b64_tr_b16 v[52:53], v28 offset:34816
 ds_read_b64_tr_b16 v[54:55], v28 offset:35840
 v_mfma_f32_16x16x32_bf16 v[228:231], v[100:103], v[92:95], v[228:231]
 buffer_load_dwordx4 v18, s[24:27], s36 offen offset:1024 lds
 v_mfma_f32_16x16x32_bf16 v[136:139], v[104:107], v[80:83], v[136:139]
 ds_read_b64_tr_b16 v[56:57], v29 offset:34816
 ds_read_b64_tr_b16 v[58:59], v29 offset:35840
 v_mfma_f32_16x16x32_bf16 v[168:171], v[104:107], v[84:87], v[168:171]
 v_cmp_ne_u32 vcc, 8, v11
 v_bfe_u32 v3, v16, 2, 5
 v_mfma_f32_16x16x32_bf16 v[200:203], v[104:107], v[88:91], v[200:203]
 ds_read_b64_tr_b16 v[60:61], v30 offset:34816
 ds_read_b64_tr_b16 v[62:63], v30 offset:35840
 v_mfma_f32_16x16x32_bf16 v[232:235], v[104:107], v[92:95], v[232:235]
 v_mfma_f32_16x16x32_bf16 v[140:143], v[108:111], v[80:83], v[140:143]
 s_cbranch_vccnz L_wb
 ds_read_b64_tr_b16 v[64:65], v27 offset:34944
 ds_read_b64_tr_b16 v[66:67], v27 offset:35968
 v_mfma_f32_16x16x32_bf16 v[172:175], v[108:111], v[84:87], v[172:175]
 s_cmp_lg_u32 s54, s58
 s_cbranch_scc1 L_wb
L_wb_ret:
 v_mfma_f32_16x16x32_bf16 v[204:207], v[108:111], v[88:91], v[204:207]
 ds_read_b64_tr_b16 v[68:69], v28 offset:34944
 ds_read_b64_tr_b16 v[70:71], v28 offset:35968
 v_mfma_f32_16x16x32_bf16 v[236:239], v[108:111], v[92:95], v[236:239]
 buffer_load_dwordx4 v19, s[24:27], s36 offen offset:2048 lds
 v_mfma_f32_16x16x32_bf16 v[144:147], v[112:115], v[80:83], v[144:147]
 ds_read_b64_tr_b16 v[72:73], v29 offset:34944
 ds_read_b64_tr_b16 v[74:75], v29 offset:35968
 v_mfma_f32_16x16x32_bf16 v[176:179], v[112:115], v[84:87], v[176:179]
 v_mfma_f32_16x16x32_bf16 v[208:211], v[112:115], v[88:91], v[208:211]
 ds_read_b64_tr_b16 v[76:77], v30 offset:34944
 ds_read_b64_tr_b16 v[78:79], v30 offset:35968
 v_mfma_f32_16x16x32_bf16 v[240:243], v[112:115], v[92:95], v[240:243]
 v_mfma_f32_16x16x32_bf16 v[148:151], v[116:119], v[80:83], v[148:151]
 v_mfma_f32_16x16x32_bf16 v[180:183], v[116:119], v[84:87], v[180:183]
 buffer_load_dwordx4 v20, s[24:27], s36 offen offset:3072 lds
 v_mfma_f32_16x16x32_bf16 v[212:215], v[116:119], v[88:91], v[212:215]
 s_add_u32 s37, s49, 6815744
 v_mfma_f32_16x16x32_bf16 v[244:247], v[116:119], v[92:95], v[244:247]
 s_add_u32 m0, s50, 17408
 v_mfma_f32_16x16x32_bf16 v[152:155], v[120:123], v[80:83], v[152:155]
 buffer_load_dwordx4 v21, s[20:23], s37 offen offset:0 lds
 v_mfma_f32_16x16x32_bf16 v[184:187], v[120:123], v[84:87], v[184:187]
 v_mfma_f32_16x16x32_bf16 v[216:219], v[120:123], v[88:91], v[216:219]
 v_mfma_f32_16x16x32_bf16 v[248:251], v[120:123], v[92:95], v[248:251]
 buffer_store_dword v1, v0, s[28:31], s3 offen sc1
 v_mfma_f32_16x16x32_bf16 v[156:159], v[124:127], v[80:83], v[156:159]
 v_mfma_f32_16x16x32_bf16 v[188:191], v[124:127], v[84:87], v[188:191]
 v_mfma_f32_16x16x32_bf16 v[220:223], v[124:127], v[88:91], v[220:223]
 buffer_load_dwordx4 v22, s[20:23], s37 offen offset:1024 lds
 v_mfma_f32_16x16x32_bf16 v[252:255], v[124:127], v[92:95], v[252:255]
 s_waitcnt lgkmcnt(0)
 v_mfma_f32_16x16x32_bf16 v[128:131], v[48:51], v[32:35], v[128:131]
 ds_read_b64_tr_b16 v[96:97], v27 offset:43520
 ds_read_b64_tr_b16 v[98:99], v27 offset:44544
 v_mfma_f32_16x16x32_bf16 v[160:163], v[48:51], v[36:39], v[160:163]
 s_add_u32 s36, s45, 1664
 v_mfma_f32_16x16x32_bf16 v[192:195], v[48:51], v[40:43], v[192:195]
 s_add_u32 m0, s42, 4096
 ds_read_b128 v[80:83], v24 offset:32768
 ds_read_b128 v[84:87], v24 offset:34816
 v_mfma_f32_16x16x32_bf16 v[224:227], v[48:51], v[44:47], v[224:227]
 buffer_load_dwordx4 v17, s[24:27], s36 offen offset:0 lds
 v_mfma_f32_16x16x32_bf16 v[132:135], v[52:55], v[32:35], v[132:135]
 ds_read_b128 v[88:91], v24 offset:36864
 ds_read_b128 v[92:95], v24 offset:38912
 v_mfma_f32_16x16x32_bf16 v[164:167], v[52:55], v[36:39], v[164:167]
 v_mfma_f32_16x16x32_bf16 v[196:199], v[52:55], v[40:43], v[196:199]
 ds_read_b64_tr_b16 v[100:101], v28 offset:43520
 ds_read_b64_tr_b16 v[102:103], v28 offset:44544
 v_mfma_f32_16x16x32_bf16 v[228:231], v[52:55], v[44:47], v[228:231]
 buffer_load_dwordx4 v18, s[24:27], s36 offen offset:1024 lds
 v_mfma_f32_16x16x32_bf16 v[136:139], v[56:59], v[32:35], v[136:139]
 ds_read_b64_tr_b16 v[104:105], v29 offset:43520
 ds_read_b64_tr_b16 v[106:107], v29 offset:44544
 v_mfma_f32_16x16x32_bf16 v[168:171], v[56:59], v[36:39], v[168:171]
 v_mfma_f32_16x16x32_bf16 v[200:203], v[56:59], v[40:43], v[200:203]
 ds_read_b64_tr_b16 v[108:109], v30 offset:43520
 ds_read_b64_tr_b16 v[110:111], v30 offset:44544
 v_mfma_f32_16x16x32_bf16 v[232:235], v[56:59], v[44:47], v[232:235]
 v_mfma_f32_16x16x32_bf16 v[140:143], v[60:63], v[32:35], v[140:143]
 ds_read_b64_tr_b16 v[112:113], v27 offset:43648
 ds_read_b64_tr_b16 v[114:115], v27 offset:44672
 v_mfma_f32_16x16x32_bf16 v[172:175], v[60:63], v[36:39], v[172:175]
 v_mfma_f32_16x16x32_bf16 v[204:207], v[60:63], v[40:43], v[204:207]
 ds_read_b64_tr_b16 v[116:117], v28 offset:43648
 ds_read_b64_tr_b16 v[118:119], v28 offset:44672
 v_mfma_f32_16x16x32_bf16 v[236:239], v[60:63], v[44:47], v[236:239]
 buffer_load_dwordx4 v19, s[24:27], s36 offen offset:2048 lds
 v_mfma_f32_16x16x32_bf16 v[144:147], v[64:67], v[32:35], v[144:147]
 ds_read_b64_tr_b16 v[120:121], v29 offset:43648
 ds_read_b64_tr_b16 v[122:123], v29 offset:44672
 v_mfma_f32_16x16x32_bf16 v[176:179], v[64:67], v[36:39], v[176:179]
 v_mfma_f32_16x16x32_bf16 v[208:211], v[64:67], v[40:43], v[208:211]
 ds_read_b64_tr_b16 v[124:125], v30 offset:43648
 ds_read_b64_tr_b16 v[126:127], v30 offset:44672
 v_mfma_f32_16x16x32_bf16 v[240:243], v[64:67], v[44:47], v[240:243]
 v_mfma_f32_16x16x32_bf16 v[148:151], v[68:71], v[32:35], v[148:151]
 v_mfma_f32_16x16x32_bf16 v[180:183], v[68:71], v[36:39], v[180:183]
 buffer_load_dwordx4 v20, s[24:27], s36 offen offset:3072 lds
 v_mfma_f32_16x16x32_bf16 v[212:215], v[68:71], v[40:43], v[212:215]
 s_add_u32 s37, s49, 7077888
 v_mfma_f32_16x16x32_bf16 v[244:247], v[68:71], v[44:47], v[244:247]
 s_add_u32 m0, s50, 26112
 v_mfma_f32_16x16x32_bf16 v[152:155], v[72:75], v[32:35], v[152:155]
 buffer_load_dwordx4 v21, s[20:23], s37 offen offset:0 lds
 v_mfma_f32_16x16x32_bf16 v[184:187], v[72:75], v[36:39], v[184:187]
 v_mfma_f32_16x16x32_bf16 v[216:219], v[72:75], v[40:43], v[216:219]
 v_mfma_f32_16x16x32_bf16 v[248:251], v[72:75], v[44:47], v[248:251]
 v_mfma_f32_16x16x32_bf16 v[156:159], v[76:79], v[32:35], v[156:159]
 v_mfma_f32_16x16x32_bf16 v[188:191], v[76:79], v[36:39], v[188:191]
 v_mfma_f32_16x16x32_bf16 v[220:223], v[76:79], v[40:43], v[220:223]
 buffer_load_dwordx4 v22, s[20:23], s37 offen offset:1024 lds
 v_mfma_f32_16x16x32_bf16 v[252:255], v[76:79], v[44:47], v[252:255]
 s_waitcnt vmcnt(13) lgkmcnt(0)
 s_barrier
 v_mfma_f32_16x16x32_bf16 v[128:131], v[96:99], v[80:83], v[128:131]
 ds_read_b64_tr_b16 v[48:49], v27 offset:0
 ds_read_b64_tr_b16 v[50:51], v27 offset:1024
 v_mfma_f32_16x16x32_bf16 v[160:163], v[96:99], v[84:87], v[160:163]
 s_add_u32 s36, s44, 1792
 v_mfma_f32_16x16x32_bf16 v[192:195], v[96:99], v[88:91], v[192:195]
 s_add_u32 m0, s42, 32768
 ds_read_b128 v[32:35], v25 offset:0
 ds_read_b128 v[36:39], v25 offset:2048
 v_mfma_f32_16x16x32_bf16 v[224:227], v[96:99], v[92:95], v[224:227]
 buffer_load_dwordx4 v17, s[24:27], s36 offen offset:0 lds
 v_mfma_f32_16x16x32_bf16 v[132:135], v[100:103], v[80:83], v[132:135]
 ds_read_b128 v[40:43], v25 offset:4096
 ds_read_b128 v[44:47], v25 offset:6144
 v_mfma_f32_16x16x32_bf16 v[164:167], v[100:103], v[84:87], v[164:167]
 v_mfma_f32_16x16x32_bf16 v[196:199], v[100:103], v[88:91], v[196:199]
 ds_read_b64_tr_b16 v[52:53], v28 offset:0
 ds_read_b64_tr_b16 v[54:55], v28 offset:1024
 v_mfma_f32_16x16x32_bf16 v[228:231], v[100:103], v[92:95], v[228:231]
 buffer_load_dwordx4 v18, s[24:27], s36 offen offset:1024 lds
 v_mfma_f32_16x16x32_bf16 v[136:139], v[104:107], v[80:83], v[136:139]
 ds_read_b64_tr_b16 v[56:57], v29 offset:0
 ds_read_b64_tr_b16 v[58:59], v29 offset:1024
 v_mfma_f32_16x16x32_bf16 v[168:171], v[104:107], v[84:87], v[168:171]
 v_mfma_f32_16x16x32_bf16 v[200:203], v[104:107], v[88:91], v[200:203]
 ds_read_b64_tr_b16 v[60:61], v30 offset:0
 ds_read_b64_tr_b16 v[62:63], v30 offset:1024
 v_mfma_f32_16x16x32_bf16 v[232:235], v[104:107], v[92:95], v[232:235]
 v_mfma_f32_16x16x32_bf16 v[140:143], v[108:111], v[80:83], v[140:143]
 ds_read_b64_tr_b16 v[64:65], v27 offset:128
 ds_read_b64_tr_b16 v[66:67], v27 offset:1152
 v_mfma_f32_16x16x32_bf16 v[172:175], v[108:111], v[84:87], v[172:175]
 v_mfma_f32_16x16x32_bf16 v[204:207], v[108:111], v[88:91], v[204:207]
 ds_read_b64_tr_b16 v[68:69], v28 offset:128
 ds_read_b64_tr_b16 v[70:71], v28 offset:1152
 v_mfma_f32_16x16x32_bf16 v[236:239], v[108:111], v[92:95], v[236:239]
 buffer_load_dwordx4 v19, s[24:27], s36 offen offset:2048 lds
 v_mfma_f32_16x16x32_bf16 v[144:147], v[112:115], v[80:83], v[144:147]
 ds_read_b64_tr_b16 v[72:73], v29 offset:128
 ds_read_b64_tr_b16 v[74:75], v29 offset:1152
 v_mfma_f32_16x16x32_bf16 v[176:179], v[112:115], v[84:87], v[176:179]
 v_mfma_f32_16x16x32_bf16 v[208:211], v[112:115], v[88:91], v[208:211]
 ds_read_b64_tr_b16 v[76:77], v30 offset:128
 ds_read_b64_tr_b16 v[78:79], v30 offset:1152
 v_mfma_f32_16x16x32_bf16 v[240:243], v[112:115], v[92:95], v[240:243]
 v_mfma_f32_16x16x32_bf16 v[148:151], v[116:119], v[80:83], v[148:151]
 v_mfma_f32_16x16x32_bf16 v[180:183], v[116:119], v[84:87], v[180:183]
 buffer_load_dwordx4 v20, s[24:27], s36 offen offset:3072 lds
 v_mfma_f32_16x16x32_bf16 v[212:215], v[116:119], v[88:91], v[212:215]
 s_add_u32 s37, s49, 7340032
 v_mfma_f32_16x16x32_bf16 v[244:247], v[116:119], v[92:95], v[244:247]
 s_add_u32 m0, s50, 34816
 v_mfma_f32_16x16x32_bf16 v[152:155], v[120:123], v[80:83], v[152:155]
 buffer_load_dwordx4 v21, s[20:23], s37 offen offset:0 lds
 v_mfma_f32_16x16x32_bf16 v[184:187], v[120:123], v[84:87], v[184:187]
 v_mfma_f32_16x16x32_bf16 v[216:219], v[120:123], v[88:91], v[216:219]
 v_mfma_f32_16x16x32_bf16 v[248:251], v[120:123], v[92:95], v[248:251]
 v_mfma_f32_16x16x32_bf16 v[156:159], v[124:127], v[80:83], v[156:159]
 v_mfma_f32_16x16x32_bf16 v[188:191], v[124:127], v[84:87], v[188:191]
 v_mfma_f32_16x16x32_bf16 v[220:223], v[124:127], v[88:91], v[220:223]
 buffer_load_dwordx4 v22, s[20:23], s37 offen offset:1024 lds
 v_mfma_f32_16x16x32_bf16 v[252:255], v[124:127], v[92:95], v[252:255]
 s_waitcnt lgkmcnt(0)
 v_mfma_f32_16x16x32_bf16 v[128:131], v[48:51], v[32:35], v[128:131]
 ds_read_b64_tr_b16 v[96:97], v27 offset:8704
 ds_read_b64_tr_b16 v[98:99], v27 offset:9728
 v_mfma_f32_16x16x32_bf16 v[160:163], v[48:51], v[36:39], v[160:163]
 s_add_u32 s36, s45, 1792
 v_mfma_f32_16x16x32_bf16 v[192:195], v[48:51], v[40:43], v[192:195]
 s_add_u32 m0, s42, 36864
 ds_read_b128 v[80:83], v26 offset:0
 ds_read_b128 v[84:87], v26 offset:2048
 v_mfma_f32_16x16x32_bf16 v[224:227], v[48:51], v[44:47], v[224:227]
 buffer_load_dwordx4 v17, s[24:27], s36 offen offset:0 lds
 v_mfma_f32_16x16x32_bf16 v[132:135], v[52:55], v[32:35], v[132:135]
 ds_read_b128 v[88:91], v26 offset:4096
 ds_read_b128 v[92:95], v26 offset:6144
 v_mfma_f32_16x16x32_bf16 v[164:167], v[52:55], v[36:39], v[164:167]
 v_mfma_f32_16x16x32_bf16 v[196:199], v[52:55], v[40:43], v[196:199]
 ds_read_b64_tr_b16 v[100:101], v28 offset:8704
 ds_read_b64_tr_b16 v[102:103], v28 offset:9728
 v_mfma_f32_16x16x32_bf16 v[228:231], v[52:55], v[44:47], v[228:231]
 buffer_load_dwordx4 v18, s[24:27], s36 offen offset:1024 lds
 v_mfma_f32_16x16x32_bf16 v[136:139], v[56:59], v[32:35], v[136:139]
 ds_read_b64_tr_b16 v[104:105], v29 offset:8704
 ds_read_b64_tr_b16 v[106:107], v29 offset:9728
 v_mfma_f32_16x16x32_bf16 v[168:171], v[56:59], v[36:39], v[168:171]
 v_mfma_f32_16x16x32_bf16 v[200:203], v[56:59], v[40:43], v[200:203]
 ds_read_b64_tr_b16 v[108:109], v30 offset:8704
 ds_read_b64_tr_b16 v[110:111], v30 offset:9728
 v_mfma_f32_16x16x32_bf16 v[232:235], v[56:59], v[44:47], v[232:235]
 v_mfma_f32_16x16x32_bf16 v[140:143], v[60:63], v[32:35], v[140:143]
 ds_read_b64_tr_b16 v[112:113], v27 offset:8832
 ds_read_b64_tr_b16 v[114:115], v27 offset:9856
 v_mfma_f32_16x16x32_bf16 v[172:175], v[60:63], v[36:39], v[172:175]
L_pad7:
 s_cbranch_execz L_pad15
 v_mfma_f32_16x16x32_bf16 v[204:207], v[60:63], v[40:43], v[204:207]
 ds_read_b64_tr_b16 v[116:117], v28 offset:8832
 ds_read_b64_tr_b16 v[118:119], v28 offset:9856
 v_mfma_f32_16x16x32_bf16 v[236:239], v[60:63], v[44:47], v[236:239]
 buffer_load_dwordx4 v19, s[24:27], s36 offen offset:2048 lds
 v_mfma_f32_16x16x32_bf16 v[144:147], v[64:67], v[32:35], v[144:147]
 ds_read_b64_tr_b16 v[120:121], v29 offset:8832
 ds_read_b64_tr_b16 v[122:123], v29 offset:9856
 v_mfma_f32_16x16x32_bf16 v[176:179], v[64:67], v[36:39], v[176:179]
 v_mfma_f32_16x16x32_bf16 v[208:211], v[64:67], v[40:43], v[208:211]
 ds_read_b64_tr_b16 v[124:125], v30 offset:8832
 ds_read_b64_tr_b16 v[126:127], v30 offset:9856
 v_mfma_f32_16x16x32_bf16 v[240:243], v[64:67], v[44:47], v[240:243]
 v_mfma_f32_16x16x32_bf16 v[148:151], v[68:71], v[32:35], v[148:151]
 v_mfma_f32_16x16x32_bf16 v[180:183], v[68:71], v[36:39], v[180:183]
 buffer_load_dwordx4 v20, s[24:27], s36 offen offset:3072 lds
 v_mfma_f32_16x16x32_bf16 v[212:215], v[68:71], v[40:43], v[212:215]
 s_add_u32 s37, s49, 7602176
 v_mfma_f32_16x16x32_bf16 v[244:247], v[68:71], v[44:47], v[244:247]
 s_add_u32 m0, s50, 43520
 v_mfma_f32_16x16x32_bf16 v[152:155], v[72:75], v[32:35], v[152:155]
 buffer_load_dwordx4 v21, s[20:23], s37 offen offset:0 lds
 v_mfma_f32_16x16x32_bf16 v[184:187], v[72:75], v[36:39], v[184:187]
 v_mfma_f32_16x16x32_bf16 v[216:219], v[72:75], v[40:43], v[216:219]
 v_mfma_f32_16x16x32_bf16 v[248:251], v[72:75], v[44:47], v[248:251]
 v_mfma_f32_16x16x32_bf16 v[156:159], v[76:79], v[32:35], v[156:159]
 v_mfma_f32_16x16x32_bf16 v[188:191], v[76:79], v[36:39], v[188:191]
 v_mfma_f32_16x16x32_bf16 v[220:223], v[76:79], v[40:43], v[220:223]
 buffer_load_dwordx4 v22, s[20:23], s37 offen offset:1024 lds
 v_mfma_f32_16x16x32_bf16 v[252:255], v[76:79], v[44:47], v[252:255]
 s_waitcnt vmcnt(12) lgkmcnt(0)
 s_barrier
 v_mfma_f32_16x16x32_bf16 v[128:131], v[96:99], v[80:83], v[128:131]
 s_add_u32 s8, s94, 67108864
 s_addc_u32 s9, s95, 0
 ds_read_b64_tr_b16 v[48:49], v27 offset:17408
 ds_read_b64_tr_b16 v[50:51], v27 offset:18432
 v_mfma_f32_16x16x32_bf16 v[160:163], v[96:99], v[84:87], v[160:163]
 s_add_u32 s36, s44, 1920
 v_mfma_f32_16x16x32_bf16 v[192:195], v[96:99], v[88:91], v[192:195]
 s_add_u32 m0, s42, 65536
 ds_read_b128 v[32:35], v23 offset:0
 ds_read_b128 v[36:39], v23 offset:2048
 v_mfma_f32_16x16x32_bf16 v[224:227], v[96:99], v[92:95], v[224:227]
 buffer_load_dwordx4 v17, s[24:27], s36 offen offset:0 lds
 v_mfma_f32_16x16x32_bf16 v[132:135], v[100:103], v[80:83], v[132:135]
 s_mov_b32 s10, 16777216
 ds_read_b128 v[40:43], v23 offset:4096
 ds_read_b128 v[44:47], v23 offset:6144
 v_mfma_f32_16x16x32_bf16 v[164:167], v[100:103], v[84:87], v[164:167]
 s_lshl_b32 s41, s2, 2
 v_mfma_f32_16x16x32_bf16 v[196:199], v[100:103], v[88:91], v[196:199]
 s_add_u32 s41, s41, s32
 ds_read_b64_tr_b16 v[52:53], v28 offset:17408
 ds_read_b64_tr_b16 v[54:55], v28 offset:18432
 v_mfma_f32_16x16x32_bf16 v[228:231], v[100:103], v[92:95], v[228:231]
 buffer_load_dwordx4 v18, s[24:27], s36 offen offset:1024 lds
 v_mfma_f32_16x16x32_bf16 v[136:139], v[104:107], v[80:83], v[136:139]
 s_lshl_b32 s41, s41, 14
 ds_read_b64_tr_b16 v[56:57], v29 offset:17408
 ds_read_b64_tr_b16 v[58:59], v29 offset:18432
 v_mfma_f32_16x16x32_bf16 v[168:171], v[104:107], v[84:87], v[168:171]
 s_add_u32 s38, s41, 4096
 v_mfma_f32_16x16x32_bf16 v[200:203], v[104:107], v[88:91], v[200:203]
 ds_read_b64_tr_b16 v[60:61], v30 offset:17408
 ds_read_b64_tr_b16 v[62:63], v30 offset:18432
 v_mfma_f32_16x16x32_bf16 v[232:235], v[104:107], v[92:95], v[232:235]
 v_mfma_f32_16x16x32_bf16 v[140:143], v[108:111], v[80:83], v[140:143]
 ds_read_b64_tr_b16 v[64:65], v27 offset:17536
 ds_read_b64_tr_b16 v[66:67], v27 offset:18560
 v_mfma_f32_16x16x32_bf16 v[172:175], v[108:111], v[84:87], v[172:175]
 v_mfma_f32_16x16x32_bf16 v[204:207], v[108:111], v[88:91], v[204:207]
 ds_read_b64_tr_b16 v[68:69], v28 offset:17536
 ds_read_b64_tr_b16 v[70:71], v28 offset:18560
 v_mfma_f32_16x16x32_bf16 v[236:239], v[108:111], v[92:95], v[236:239]
 buffer_load_dwordx4 v19, s[24:27], s36 offen offset:2048 lds
 v_mfma_f32_16x16x32_bf16 v[144:147], v[112:115], v[80:83], v[144:147]
 ds_read_b64_tr_b16 v[72:73], v29 offset:17536
 ds_read_b64_tr_b16 v[74:75], v29 offset:18560
 v_mfma_f32_16x16x32_bf16 v[176:179], v[112:115], v[84:87], v[176:179]
 v_mfma_f32_16x16x32_bf16 v[208:211], v[112:115], v[88:91], v[208:211]
 ds_read_b64_tr_b16 v[76:77], v30 offset:17536
 ds_read_b64_tr_b16 v[78:79], v30 offset:18560
 v_mfma_f32_16x16x32_bf16 v[240:243], v[112:115], v[92:95], v[240:243]
 v_mfma_f32_16x16x32_bf16 v[148:151], v[116:119], v[80:83], v[148:151]
 v_mfma_f32_16x16x32_bf16 v[180:183], v[116:119], v[84:87], v[180:183]
 buffer_load_dwordx4 v20, s[24:27], s36 offen offset:3072 lds
 v_mfma_f32_16x16x32_bf16 v[212:215], v[116:119], v[88:91], v[212:215]
 s_add_u32 s37, s49, 7864320
 v_mfma_f32_16x16x32_bf16 v[244:247], v[116:119], v[92:95], v[244:247]
 s_add_u32 m0, s50, 0
 v_mfma_f32_16x16x32_bf16 v[152:155], v[120:123], v[80:83], v[152:155]
 buffer_load_dwordx4 v21, s[20:23], s37 offen offset:0 lds
 v_mfma_f32_16x16x32_bf16 v[184:187], v[120:123], v[84:87], v[184:187]
 v_mfma_f32_16x16x32_bf16 v[216:219], v[120:123], v[88:91], v[216:219]
 v_mfma_f32_16x16x32_bf16 v[248:251], v[120:123], v[92:95], v[248:251]
 v_mfma_f32_16x16x32_bf16 v[156:159], v[124:127], v[80:83], v[156:159]
 v_mfma_f32_16x16x32_bf16 v[188:191], v[124:127], v[84:87], v[188:191]
 v_mfma_f32_16x16x32_bf16 v[220:223], v[124:127], v[88:91], v[220:223]
 buffer_load_dwordx4 v22, s[20:23], s37 offen offset:1024 lds
 v_mfma_f32_16x16x32_bf16 v[252:255], v[124:127], v[92:95], v[252:255]
 s_waitcnt lgkmcnt(0)
 v_mfma_f32_16x16x32_bf16 v[128:131], v[48:51], v[32:35], v[128:131]
 ds_read_b64_tr_b16 v[96:97], v27 offset:26112
 ds_read_b64_tr_b16 v[98:99], v27 offset:27136
 v_mfma_f32_16x16x32_bf16 v[160:163], v[48:51], v[36:39], v[160:163]
 s_add_u32 s36, s45, 1920
 v_mfma_f32_16x16x32_bf16 v[192:195], v[48:51], v[40:43], v[192:195]
 s_add_u32 m0, s42, 69632
 ds_read_b128 v[80:83], v24 offset:0
 ds_read_b128 v[84:87], v24 offset:2048
 v_mfma_f32_16x16x32_bf16 v[224:227], v[48:51], v[44:47], v[224:227]
 buffer_load_dwordx4 v17, s[24:27], s36 offen offset:0 lds
 v_mfma_f32_16x16x32_bf16 v[132:135], v[52:55], v[32:35], v[132:135]
 ds_read_b128 v[88:91], v24 offset:4096
 ds_read_b128 v[92:95], v24 offset:6144
 v_mfma_f32_16x16x32_bf16 v[164:167], v[52:55], v[36:39], v[164:167]
 v_mfma_f32_16x16x32_bf16 v[196:199], v[52:55], v[40:43], v[196:199]
 ds_read_b64_tr_b16 v[100:101], v28 offset:26112
 ds_read_b64_tr_b16 v[102:103], v28 offset:27136
 v_mfma_f32_16x16x32_bf16 v[228:231], v[52:55], v[44:47], v[228:231]
 buffer_load_dwordx4 v18, s[24:27], s36 offen offset:1024 lds
 v_mfma_f32_16x16x32_bf16 v[136:139], v[56:59], v[32:35], v[136:139]
 ds_read_b64_tr_b16 v[104:105], v29 offset:26112
 ds_read_b64_tr_b16 v[106:107], v29 offset:27136
 v_mfma_f32_16x16x32_bf16 v[168:171], v[56:59], v[36:39], v[168:171]
 v_mfma_f32_16x16x32_bf16 v[200:203], v[56:59], v[40:43], v[200:203]
 ds_read_b64_tr_b16 v[108:109], v30 offset:26112
 ds_read_b64_tr_b16 v[110:111], v30 offset:27136
 v_mfma_f32_16x16x32_bf16 v[232:235], v[56:59], v[44:47], v[232:235]
 v_mfma_f32_16x16x32_bf16 v[140:143], v[60:63], v[32:35], v[140:143]
 ds_read_b64_tr_b16 v[112:113], v27 offset:26240
 ds_read_b64_tr_b16 v[114:115], v27 offset:27264
 v_mfma_f32_16x16x32_bf16 v[172:175], v[60:63], v[36:39], v[172:175]
 v_mfma_f32_16x16x32_bf16 v[204:207], v[60:63], v[40:43], v[204:207]
 ds_read_b64_tr_b16 v[116:117], v28 offset:26240
 ds_read_b64_tr_b16 v[118:119], v28 offset:27264
 v_mfma_f32_16x16x32_bf16 v[236:239], v[60:63], v[44:47], v[236:239]
 buffer_load_dwordx4 v19, s[24:27], s36 offen offset:2048 lds
 v_mfma_f32_16x16x32_bf16 v[144:147], v[64:67], v[32:35], v[144:147]
 ds_read_b64_tr_b16 v[120:121], v29 offset:26240
 ds_read_b64_tr_b16 v[122:123], v29 offset:27264
 v_mfma_f32_16x16x32_bf16 v[176:179], v[64:67], v[36:39], v[176:179]
 v_mfma_f32_16x16x32_bf16 v[208:211], v[64:67], v[40:43], v[208:211]
 ds_read_b64_tr_b16 v[124:125], v30 offset:26240
 ds_read_b64_tr_b16 v[126:127], v30 offset:27264
 v_mfma_f32_16x16x32_bf16 v[240:243], v[64:67], v[44:47], v[240:243]
 v_mfma_f32_16x16x32_bf16 v[148:151], v[68:71], v[32:35], v[148:151]
 v_mov_b32 v12, -1
 v_mov_b32 v13, -1
 v_mfma_f32_16x16x32_bf16 v[180:183], v[68:71], v[36:39], v[180:183]
 buffer_load_dwordx4 v20, s[24:27], s36 offen offset:3072 lds
 v_mfma_f32_16x16x32_bf16 v[212:215], v[68:71], v[40:43], v[212:215]
 s_add_u32 s37, s49, 8126464
 v_mov_b32 v14, -1
 v_mov_b32 v15, -1
 v_mfma_f32_16x16x32_bf16 v[244:247], v[68:71], v[44:47], v[244:247]
 s_add_u32 m0, s50, 8704
 v_mfma_f32_16x16x32_bf16 v[152:155], v[72:75], v[32:35], v[152:155]
 buffer_load_dwordx4 v21, s[20:23], s37 offen offset:0 lds
 v_mfma_f32_16x16x32_bf16 v[184:187], v[72:75], v[36:39], v[184:187]
 v_mfma_f32_16x16x32_bf16 v[216:219], v[72:75], v[40:43], v[216:219]
 v_mfma_f32_16x16x32_bf16 v[248:251], v[72:75], v[44:47], v[248:251]
 v_mfma_f32_16x16x32_bf16 v[156:159], v[76:79], v[32:35], v[156:159]
 v_mfma_f32_16x16x32_bf16 v[188:191], v[76:79], v[36:39], v[188:191]
 v_mfma_f32_16x16x32_bf16 v[220:223], v[76:79], v[40:43], v[220:223]
 buffer_load_dwordx4 v22, s[20:23], s37 offen offset:1024 lds
 v_mfma_f32_16x16x32_bf16 v[252:255], v[76:79], v[44:47], v[252:255]
 s_waitcnt vmcnt(12) lgkmcnt(0)
 s_barrier
 v_mfma_f32_16x16x32_bf16 v[128:131], v[96:99], v[80:83], v[128:131]
 s_lshl_b32 s36, s33, 20
 ds_read_b64_tr_b16 v[48:49], v27 offset:34816
 ds_read_b64_tr_b16 v[50:51], v27 offset:35840
 v_mfma_f32_16x16x32_bf16 v[160:163], v[96:99], v[84:87], v[160:163]
 s_add_u32 s12, s94, s36
 s_addc_u32 s13, s95, 0
 v_mfma_f32_16x16x32_bf16 v[192:195], v[96:99], v[88:91], v[192:195]
 s_lshl_b32 s36, s34, 16
 ds_read_b128 v[32:35], v23 offset:32768
 ds_read_b128 v[36:39], v23 offset:34816
 v_mfma_f32_16x16x32_bf16 v[224:227], v[96:99], v[92:95], v[224:227]
 buffer_store_dwordx4 v[12:15], v16, s[8:11], s41 offen offset:0 sc1
 v_mfma_f32_16x16x32_bf16 v[132:135], v[100:103], v[80:83], v[132:135]
 s_sub_u32 s14, 1048576, s36
 ds_read_b128 v[40:43], v23 offset:36864
 ds_read_b128 v[44:47], v23 offset:38912
 v_mfma_f32_16x16x32_bf16 v[164:167], v[100:103], v[84:87], v[164:167]
 s_lshl_b32 s59, s32, 12
 v_mfma_f32_16x16x32_bf16 v[196:199], v[100:103], v[88:91], v[196:199]
 s_lshl_b32 s36, s34, 1
 ds_read_b64_tr_b16 v[52:53], v28 offset:34816
 ds_read_b64_tr_b16 v[54:55], v28 offset:35840
 v_mfma_f32_16x16x32_bf16 v[228:231], v[100:103], v[92:95], v[228:231]
 v_mfma_f32_16x16x32_bf16 v[136:139], v[104:107], v[80:83], v[136:139]
 s_add_u32 s36, s36, 3
 ds_read_b64_tr_b16 v[56:57], v29 offset:34816
 ds_read_b64_tr_b16 v[58:59], v29 offset:35840
 v_mfma_f32_16x16x32_bf16 v[168:171], v[104:107], v[84:87], v[168:171]
 s_mul_i32 s37, s36, 52
 v_mfma_f32_16x16x32_bf16 v[200:203], v[104:107], v[88:91], v[200:203]
 s_lshr_b32 s37, s37, 8
 ds_read_b64_tr_b16 v[60:61], v30 offset:34816
 ds_read_b64_tr_b16 v[62:63], v30 offset:35840
 v_mfma_f32_16x16x32_bf16 v[232:235], v[104:107], v[92:95], v[232:235]
 buffer_store_dwordx4 v[12:15], v16, s[8:11], s41 offen offset:1024 sc1
 v_mfma_f32_16x16x32_bf16 v[140:143], v[108:111], v[80:83], v[140:143]
 s_mul_i32 s37, s37, 5
 ds_read_b64_tr_b16 v[64:65], v27 offset:34944
 ds_read_b64_tr_b16 v[66:67], v27 offset:35968
 v_mfma_f32_16x16x32_bf16 v[172:175], v[108:111], v[84:87], v[172:175]
 s_sub_u32 s36, s36, s37
 v_mfma_f32_16x16x32_bf16 v[204:207], v[108:111], v[88:91], v[204:207]
 s_lshl_b32 s47, s36, 15
 ds_read_b64_tr_b16 v[68:69], v28 offset:34944
 ds_read_b64_tr_b16 v[70:71], v28 offset:35968
 v_mfma_f32_16x16x32_bf16 v[236:239], v[108:111], v[92:95], v[236:239]
 v_mfma_f32_16x16x32_bf16 v[144:147], v[112:115], v[80:83], v[144:147]
 s_add_u32 s48, s47, 32768
 ds_read_b64_tr_b16 v[72:73], v29 offset:34944
 ds_read_b64_tr_b16 v[74:75], v29 offset:35968
 v_mfma_f32_16x16x32_bf16 v[176:179], v[112:115], v[84:87], v[176:179]
 s_cmp_eq_u32 s48, 163840
 s_cselect_b32 s48, 0, s48
 v_mfma_f32_16x16x32_bf16 v[208:211], v[112:115], v[88:91], v[208:211]
 s_add_u32 s51, s48, 32768
 ds_read_b64_tr_b16 v[76:77], v30 offset:34944
 ds_read_b64_tr_b16 v[78:79], v30 offset:35968
 v_mfma_f32_16x16x32_bf16 v[240:243], v[112:115], v[92:95], v[240:243]
 s_cmp_eq_u32 s51, 163840
 s_cselect_b32 s51, 0, s51
 v_mfma_f32_16x16x32_bf16 v[148:151], v[116:119], v[80:83], v[148:151]
 s_add_u32 s52, s51, 32768
 v_mfma_f32_16x16x32_bf16 v[180:183], v[116:119], v[84:87], v[180:183]
 buffer_store_dwordx4 v[12:15], v16, s[8:11], s41 offen offset:2048 sc1
 v_mfma_f32_16x16x32_bf16 v[212:215], v[116:119], v[88:91], v[212:215]
 s_cmp_eq_u32 s52, 163840
 s_cselect_b32 s52, 0, s52
 v_mfma_f32_16x16x32_bf16 v[244:247], v[116:119], v[92:95], v[244:247]
 s_add_u32 s53, s52, 32768
 v_mfma_f32_16x16x32_bf16 v[152:155], v[120:123], v[80:83], v[152:155]
 v_mfma_f32_16x16x32_bf16 v[184:187], v[120:123], v[84:87], v[184:187]
 s_cmp_eq_u32 s53, 163840
 s_cselect_b32 s53, 0, s53
 v_mfma_f32_16x16x32_bf16 v[216:219], v[120:123], v[88:91], v[216:219]
 v_mfma_f32_16x16x32_bf16 v[248:251], v[120:123], v[92:95], v[248:251]
 buffer_store_dwordx4 v[12:15], v16, s[8:11], s41 offen offset:3072 sc1
 v_mfma_f32_16x16x32_bf16 v[156:159], v[124:127], v[80:83], v[156:159]
 v_mfma_f32_16x16x32_bf16 v[188:191], v[124:127], v[84:87], v[188:191]
 v_mfma_f32_16x16x32_bf16 v[220:223], v[124:127], v[88:91], v[220:223]
 v_mfma_f32_16x16x32_bf16 v[252:255], v[124:127], v[92:95], v[252:255]
 s_waitcnt lgkmcnt(0)
 v_mfma_f32_16x16x32_bf16 v[128:131], v[48:51], v[32:35], v[128:131]
 ds_read_b64_tr_b16 v[96:97], v27 offset:43520
 ds_read_b64_tr_b16 v[98:99], v27 offset:44544
 v_mfma_f32_16x16x32_bf16 v[160:163], v[48:51], v[36:39], v[160:163]
 s_cmp_lt_u32 s34, 2
 s_cselect_b32 s58, 4, 28
 v_mfma_f32_16x16x32_bf16 v[192:195], v[48:51], v[40:43], v[192:195]
 s_mov_b32 s20, s86
 ds_read_b128 v[80:83], v24 offset:32768
 ds_read_b128 v[84:87], v24 offset:34816
 v_mfma_f32_16x16x32_bf16 v[224:227], v[48:51], v[44:47], v[224:227]
 buffer_store_dwordx4 v[12:15], v16, s[8:11], s38 offen offset:0 sc1
 v_mfma_f32_16x16x32_bf16 v[132:135], v[52:55], v[32:35], v[132:135]
 s_mov_b32 s21, s87
 ds_read_b128 v[88:91], v24 offset:36864
 ds_read_b128 v[92:95], v24 offset:38912
 v_mfma_f32_16x16x32_bf16 v[164:167], v[52:55], v[36:39], v[164:167]
 s_mov_b32 s22, 8388608
 v_min_u32 v3, s58, v3
 v_mfma_f32_16x16x32_bf16 v[196:199], v[52:55], v[40:43], v[196:199]
 s_and_b32 s37, s2, 3
 ds_read_b64_tr_b16 v[100:101], v28 offset:43520
 ds_read_b64_tr_b16 v[102:103], v28 offset:44544
 v_mfma_f32_16x16x32_bf16 v[228:231], v[52:55], v[44:47], v[228:231]
 v_mfma_f32_16x16x32_bf16 v[136:139], v[56:59], v[32:35], v[136:139]
 s_xor_b32 s54, s37, 3
 ds_read_b64_tr_b16 v[104:105], v29 offset:43520
 ds_read_b64_tr_b16 v[106:107], v29 offset:44544
 v_mfma_f32_16x16x32_bf16 v[168:171], v[56:59], v[36:39], v[168:171]
 s_lshl_b32 s54, s54, 2
 v_mfma_f32_16x16x32_bf16 v[200:203], v[56:59], v[40:43], v[200:203]
 s_lshl_b32 s37, s37, 21
 ds_read_b64_tr_b16 v[108:109], v30 offset:43520
 ds_read_b64_tr_b16 v[110:111], v30 offset:44544
 v_mfma_f32_16x16x32_bf16 v[232:235], v[56:59], v[44:47], v[232:235]
 buffer_store_dwordx4 v[12:15], v16, s[8:11], s38 offen offset:1024 sc1
 v_mfma_f32_16x16x32_bf16 v[140:143], v[60:63], v[32:35], v[140:143]
 s_lshl_b32 s88, s32, 14
 ds_read_b64_tr_b16 v[112:113], v27 offset:43648
 ds_read_b64_tr_b16 v[114:115], v27 offset:44672
 v_mfma_f32_16x16x32_bf16 v[172:175], v[60:63], v[36:39], v[172:175]
 s_add_u32 s37, s37, s88
 v_mfma_f32_16x16x32_bf16 v[204:207], v[60:63], v[40:43], v[204:207]
 s_lshr_b32 s88, s2, 5
 ds_read_b64_tr_b16 v[116:117], v28 offset:43648
 ds_read_b64_tr_b16 v[118:119], v28 offset:44672
 v_mfma_f32_16x16x32_bf16 v[236:239], v[60:63], v[44:47], v[236:239]
 buffer_load_dword v2, v3, s[28:31], s40 offen sc1
 v_mfma_f32_16x16x32_bf16 v[144:147], v[64:67], v[32:35], v[144:147]
 s_lshl_b32 s88, s88, 8
 ds_read_b64_tr_b16 v[120:121], v29 offset:43648
 ds_read_b64_tr_b16 v[122:123], v29 offset:44672
 v_mfma_f32_16x16x32_bf16 v[176:179], v[64:67], v[36:39], v[176:179]
 s_add_u32 s88, s88, s37
 v_lshrrev_b32 v4, 8, v16
 v_bfe_u32 v5, v16, 4, 4
 v_mfma_f32_16x16x32_bf16 v[208:211], v[64:67], v[40:43], v[208:211]
 s_add_u32 s88, s88, 393216
 ds_read_b64_tr_b16 v[124:125], v30 offset:43648
 ds_read_b64_tr_b16 v[126:127], v30 offset:44672
 v_mfma_f32_16x16x32_bf16 v[240:243], v[64:67], v[44:47], v[240:243]
 v_lshlrev_b32 v6, 1, v4
 v_xor_b32 v6, v6, v5
 v_mfma_f32_16x16x32_bf16 v[148:151], v[68:71], v[32:35], v[148:151]
 v_xor_b32 v6, s54, v6
 v_lshlrev_b32 v6, 4, v6
 v_mfma_f32_16x16x32_bf16 v[180:183], v[68:71], v[36:39], v[180:183]
 buffer_store_dwordx4 v[12:15], v16, s[8:11], s38 offen offset:2048 sc1
 v_mfma_f32_16x16x32_bf16 v[212:215], v[68:71], v[40:43], v[212:215]
 v_lshl_add_u32 v0, v4, 11, v6
 v_add_u32 v1, 7040, v0
 v_mfma_f32_16x16x32_bf16 v[244:247], v[68:71], v[44:47], v[244:247]
 v_mfma_f32_16x16x32_bf16 v[152:155], v[72:75], v[32:35], v[152:155]
 v_mfma_f32_16x16x32_bf16 v[184:187], v[72:75], v[36:39], v[184:187]
 v_mfma_f32_16x16x32_bf16 v[216:219], v[72:75], v[40:43], v[216:219]
 v_mfma_f32_16x16x32_bf16 v[248:251], v[72:75], v[44:47], v[248:251]
 buffer_store_dwordx4 v[12:15], v16, s[8:11], s38 offen offset:3072 sc1
 v_mfma_f32_16x16x32_bf16 v[156:159], v[76:79], v[32:35], v[156:159]
 v_mfma_f32_16x16x32_bf16 v[188:191], v[76:79], v[36:39], v[188:191]
 v_mfma_f32_16x16x32_bf16 v[220:223], v[76:79], v[40:43], v[220:223]
 v_mfma_f32_16x16x32_bf16 v[252:255], v[76:79], v[44:47], v[252:255]
 s_waitcnt vmcnt(9) lgkmcnt(0)
 s_barrier
 v_mfma_f32_16x16x32_bf16 v[128:131], v[96:99], v[80:83], v[128:131]
 s_add_u32 s38, s59, 131072
 ds_read_b64_tr_b16 v[48:49], v27 offset:0
 ds_read_b64_tr_b16 v[50:51], v27 offset:1024
 v_mfma_f32_16x16x32_bf16 v[160:163], v[96:99], v[84:87], v[160:163]
 s_mov_b32 s42, 0x40004000
 v_mfma_f32_16x16x32_bf16 v[192:195], v[96:99], v[88:91], v[192:195]
 s_mov_b32 s39, s47
 ds_read_b128 v[32:35], v25 offset:0
 ds_read_b128 v[36:39], v25 offset:2048
 v_mfma_f32_16x16x32_bf16 v[224:227], v[96:99], v[92:95], v[224:227]
 buffer_load_dwordx4 a[192:195], v0, s[20:23], s88 offen offset:0
 v_mfma_f32_16x16x32_bf16 v[132:135], v[100:103], v[80:83], v[132:135]
 s_mov_b32 s45, s48
 ds_read_b128 v[40:43], v25 offset:4096
 ds_read_b128 v[44:47], v25 offset:6144
 v_mfma_f32_16x16x32_bf16 v[164:167], v[100:103], v[84:87], v[164:167]
 s_mov_b32 s44, 32768
 v_mfma_f32_16x16x32_bf16 v[196:199], v[100:103], v[88:91], v[196:199]
 s_movk_i32 s49, 16384
 ds_read_b64_tr_b16 v[52:53], v28 offset:0
 ds_read_b64_tr_b16 v[54:55], v28 offset:1024
 v_mfma_f32_16x16x32_bf16 v[228:231], v[100:103], v[92:95], v[228:231]
 buffer_load_dwordx4 a[196:199], v1, s[20:23], s88 offen offset:1152
 v_mfma_f32_16x16x32_bf16 v[136:139], v[104:107], v[80:83], v[136:139]
 s_add_u32 s88, s88, 65536
 ds_read_b64_tr_b16 v[56:57], v29 offset:0
 ds_read_b64_tr_b16 v[58:59], v29 offset:1024
 v_mfma_f32_16x16x32_bf16 v[168:171], v[104:107], v[84:87], v[168:171]
 s_movk_i32 s50, 16384
 v_mfma_f32_16x16x32_bf16 v[200:203], v[104:107], v[88:91], v[200:203]
 s_add_u32 s16, s94, 33554432
 s_addc_u32 s17, s95, 0
 ds_read_b64_tr_b16 v[60:61], v30 offset:0
 ds_read_b64_tr_b16 v[62:63], v30 offset:1024
 v_mfma_f32_16x16x32_bf16 v[232:235], v[104:107], v[92:95], v[232:235]
 buffer_load_dwordx4 a[200:203], v0, s[20:23], s88 offen offset:0
 v_mfma_f32_16x16x32_bf16 v[140:143], v[108:111], v[80:83], v[140:143]
 s_mov_b32 s18, 16777216
 ds_read_b64_tr_b16 v[64:65], v27 offset:128
 ds_read_b64_tr_b16 v[66:67], v27 offset:1152
 v_mfma_f32_16x16x32_bf16 v[172:175], v[108:111], v[84:87], v[172:175]
 s_mov_b32 s8, s86
 v_mfma_f32_16x16x32_bf16 v[204:207], v[108:111], v[88:91], v[204:207]
 s_mov_b32 s9, s87
 ds_read_b64_tr_b16 v[68:69], v28 offset:128
 ds_read_b64_tr_b16 v[70:71], v28 offset:1152
 v_mfma_f32_16x16x32_bf16 v[236:239], v[108:111], v[92:95], v[236:239]
 buffer_load_dwordx4 a[204:207], v1, s[20:23], s88 offen offset:1152
 v_mfma_f32_16x16x32_bf16 v[144:147], v[112:115], v[80:83], v[144:147]
 s_add_u32 s88, s88, 65536
 ds_read_b64_tr_b16 v[72:73], v29 offset:128
 ds_read_b64_tr_b16 v[74:75], v29 offset:1152
 v_mfma_f32_16x16x32_bf16 v[176:179], v[112:115], v[84:87], v[176:179]
 s_mov_b32 s10, 8388608
 v_mfma_f32_16x16x32_bf16 v[208:211], v[112:115], v[88:91], v[208:211]
 s_mov_b32 s4, s72
 ds_read_b64_tr_b16 v[76:77], v30 offset:128
 ds_read_b64_tr_b16 v[78:79], v30 offset:1152
 v_mfma_f32_16x16x32_bf16 v[240:243], v[112:115], v[92:95], v[240:243]
 s_mov_b32 s5, s73
 v_mfma_f32_16x16x32_bf16 v[148:151], v[116:119], v[80:83], v[148:151]
 s_mov_b32 s6, 4194304
 v_mfma_f32_16x16x32_bf16 v[180:183], v[116:119], v[84:87], v[180:183]
 buffer_load_dwordx4 a[208:211], v0, s[20:23], s88 offen offset:0
 v_mfma_f32_16x16x32_bf16 v[212:215], v[116:119], v[88:91], v[212:215]
 s_lshl_b32 s58, s2, 2
 v_mfma_f32_16x16x32_bf16 v[244:247], v[116:119], v[92:95], v[244:247]
 s_add_u32 s58, s58, s32
 v_mfma_f32_16x16x32_bf16 v[152:155], v[120:123], v[80:83], v[152:155]
 buffer_load_dwordx4 a[212:215], v1, s[20:23], s88 offen offset:1152
 v_mfma_f32_16x16x32_bf16 v[184:187], v[120:123], v[84:87], v[184:187]
 s_add_u32 s88, s88, 65536
 v_mfma_f32_16x16x32_bf16 v[216:219], v[120:123], v[88:91], v[216:219]
 s_sub_u32 s46, s58, 512
 v_mfma_f32_16x16x32_bf16 v[248:251], v[120:123], v[92:95], v[248:251]
 buffer_load_dwordx4 a[216:219], v0, s[20:23], s88 offen offset:0
 v_mfma_f32_16x16x32_bf16 v[156:159], v[124:127], v[80:83], v[156:159]
 s_lshl_b32 s46, s46, 11
 v_mfma_f32_16x16x32_bf16 v[188:191], v[124:127], v[84:87], v[188:191]
 s_cmp_lt_u32 s34, 4
 s_cselect_b32 s46, 0x80000000, s46
 v_mfma_f32_16x16x32_bf16 v[220:223], v[124:127], v[88:91], v[220:223]
 buffer_load_dwordx4 a[220:223], v1, s[20:23], s88 offen offset:1152
 v_mfma_f32_16x16x32_bf16 v[252:255], v[124:127], v[92:95], v[252:255]
 s_waitcnt lgkmcnt(0)
 v_mfma_f32_16x16x32_bf16 v[128:131], v[48:51], v[32:35], v[128:131]
 s_add_u32 s88, s88, 65536
 ds_read_b64_tr_b16 v[96:97], v27 offset:8704
 ds_read_b64_tr_b16 v[98:99], v27 offset:9728
 v_mfma_f32_16x16x32_bf16 v[160:163], v[48:51], v[36:39], v[160:163]
 v_mfma_f32_16x16x32_bf16 v[192:195], v[48:51], v[40:43], v[192:195]
 ds_read_b128 v[80:83], v26 offset:0
 ds_read_b128 v[84:87], v26 offset:2048
 v_mfma_f32_16x16x32_bf16 v[224:227], v[48:51], v[44:47], v[224:227]
 v_mfma_f32_16x16x32_bf16 v[132:135], v[52:55], v[32:35], v[132:135]
 ds_read_b128 v[88:91], v26 offset:4096
 ds_read_b128 v[92:95], v26 offset:6144
 v_mfma_f32_16x16x32_bf16 v[164:167], v[52:55], v[36:39], v[164:167]
 v_mfma_f32_16x16x32_bf16 v[196:199], v[52:55], v[40:43], v[196:199]
 ds_read_b64_tr_b16 v[100:101], v28 offset:8704
 ds_read_b64_tr_b16 v[102:103], v28 offset:9728
 v_mfma_f32_16x16x32_bf16 v[228:231], v[52:55], v[44:47], v[228:231]
 v_mfma_f32_16x16x32_bf16 v[136:139], v[56:59], v[32:35], v[136:139]
 ds_read_b64_tr_b16 v[104:105], v29 offset:8704
 ds_read_b64_tr_b16 v[106:107], v29 offset:9728
 v_mfma_f32_16x16x32_bf16 v[168:171], v[56:59], v[36:39], v[168:171]
 v_mfma_f32_16x16x32_bf16 v[200:203], v[56:59], v[40:43], v[200:203]
 ds_read_b64_tr_b16 v[108:109], v30 offset:8704
 ds_read_b64_tr_b16 v[110:111], v30 offset:9728
 v_mfma_f32_16x16x32_bf16 v[232:235], v[56:59], v[44:47], v[232:235]
 v_mfma_f32_16x16x32_bf16 v[140:143], v[60:63], v[32:35], v[140:143]
 ds_read_b64_tr_b16 v[112:113], v27 offset:8832
 ds_read_b64_tr_b16 v[114:115], v27 offset:9856
 v_mfma_f32_16x16x32_bf16 v[172:175], v[60:63], v[36:39], v[172:175]
 v_mfma_f32_16x16x32_bf16 v[204:207], v[60:63], v[40:43], v[204:207]
 ds_read_b64_tr_b16 v[116:117], v28 offset:8832
 ds_read_b64_tr_b16 v[118:119], v28 offset:9856
 v_mfma_f32_16x16x32_bf16 v[236:239], v[60:63], v[44:47], v[236:239]
 v_mfma_f32_16x16x32_bf16 v[144:147], v[64:67], v[32:35], v[144:147]
 ds_read_b64_tr_b16 v[120:121], v29 offset:8832
 ds_read_b64_tr_b16 v[122:123], v29 offset:9856
 v_mfma_f32_16x16x32_bf16 v[176:179], v[64:67], v[36:39], v[176:179]
 v_mfma_f32_16x16x32_bf16 v[208:211], v[64:67], v[40:43], v[208:211]
 ds_read_b64_tr_b16 v[124:125], v30 offset:8832
 ds_read_b64_tr_b16 v[126:127], v30 offset:9856
 v_mfma_f32_16x16x32_bf16 v[240:243], v[64:67], v[44:47], v[240:243]
 v_mfma_f32_16x16x32_bf16 v[148:151], v[68:71], v[32:35], v[148:151]
 v_and_b32 v14, 16, v16
 v_lshrrev_b32 v13, 5, v16
 v_mfma_f32_16x16x32_bf16 v[180:183], v[68:71], v[36:39], v[180:183]
 v_mfma_f32_16x16x32_bf16 v[212:215], v[68:71], v[40:43], v[212:215]
 v_lshl_add_u32 v14, v13, 7, v14
 v_mfma_f32_16x16x32_bf16 v[244:247], v[68:71], v[44:47], v[244:247]
 v_mfma_f32_16x16x32_bf16 v[152:155], v[72:75], v[32:35], v[152:155]
 v_mfma_f32_16x16x32_bf16 v[184:187], v[72:75], v[36:39], v[184:187]
 v_mfma_f32_16x16x32_bf16 v[216:219], v[72:75], v[40:43], v[216:219]
 v_mfma_f32_16x16x32_bf16 v[248:251], v[72:75], v[44:47], v[248:251]
 v_mfma_f32_16x16x32_bf16 v[156:159], v[76:79], v[32:35], v[156:159]
 v_mfma_f32_16x16x32_bf16 v[188:191], v[76:79], v[36:39], v[188:191]
 v_mfma_f32_16x16x32_bf16 v[220:223], v[76:79], v[40:43], v[220:223]
 v_mfma_f32_16x16x32_bf16 v[252:255], v[76:79], v[44:47], v[252:255]
 s_waitcnt vmcnt(10) lgkmcnt(0)
 s_barrier
 v_cmp_ne_u32 vcc, 1, v2
 v_mfma_f32_16x16x32_bf16 v[128:131], v[96:99], v[80:83], v[128:131]
 s_nop 0
 s_cbranch_vccnz L_spin_kv
L_spin_kv_ret:
 v_mfma_f32_16x16x32_bf16 v[160:163], v[96:99], v[84:87], v[160:163]
 s_add_u32 s36, s59, 0
 v_bfe_u32 v40, v16, 4, 4
 v_lshrrev_b32 v41, 8, v16
 v_mfma_f32_16x16x32_bf16 v[192:195], v[96:99], v[88:91], v[192:195]
 s_add_u32 s37, s59, s47
 s_mov_b32 m0, s37
 v_sub_u32 v40, v40, v41
 v_cmp_gt_u32 vcc, 256, v16
 v_mfma_f32_16x16x32_bf16 v[224:227], v[96:99], v[92:95], v[224:227]
 buffer_load_dwordx4 v16, s[12:15], s36 offen offset:0 sc1 lds
 v_mfma_f32_16x16x32_bf16 v[132:135], v[100:103], v[80:83], v[132:135]
 s_add_u32 s40, s59, s53
 v_lshl_add_u32 v40, v40, 2, s32
 v_mov_b32 v41, 0xff000000
 v_mfma_f32_16x16x32_bf16 v[164:167], v[100:103], v[84:87], v[164:167]
 s_add_u32 s41, s40, 16384
 v_lshlrev_b32 v15, 3, v16
 v_cndmask_b32 v19, v41, v15, vcc
 v_mfma_f32_16x16x32_bf16 v[196:199], v[100:103], v[88:91], v[196:199]
 s_lshl_b32 s54, s58, 12
 v_cmp_gt_i32 vcc, 0, v40
 v_cmp_gt_i32 s[66:67], 1, v40
 v_mfma_f32_16x16x32_bf16 v[228:231], v[100:103], v[92:95], v[228:231]
 buffer_load_dwordx4 v16, s[12:15], s36 offen offset:1024 sc1 lds
 v_mfma_f32_16x16x32_bf16 v[136:139], v[104:107], v[80:83], v[136:139]
 v_cndmask_b32 v48, 0, v41, vcc
 v_cndmask_b32 v49, 0, v41, s[66:67]
 v_mfma_f32_16x16x32_bf16 v[168:171], v[104:107], v[84:87], v[168:171]
 v_cmp_gt_i32 vcc, 2, v40
 v_cmp_gt_i32 s[66:67], 3, v40
 v_mfma_f32_16x16x32_bf16 v[200:203], v[104:107], v[88:91], v[200:203]
 v_cndmask_b32 v50, 0, v41, vcc
 v_cndmask_b32 v51, 0, v41, s[66:67]
 v_mfma_f32_16x16x32_bf16 v[232:235], v[104:107], v[92:95], v[232:235]
 buffer_load_dwordx4 v16, s[12:15], s36 offen offset:2048 sc1 lds
 v_mfma_f32_16x16x32_bf16 v[140:143], v[108:111], v[80:83], v[140:143]
 v_cmp_gt_i32 vcc, 16, v40
 v_cmp_gt_i32 s[66:67], 17, v40
 v_mfma_f32_16x16x32_bf16 v[172:175], v[108:111], v[84:87], v[172:175]
 v_cndmask_b32 v52, 0, v41, vcc
 v_cndmask_b32 v53, 0, v41, s[66:67]
 v_mfma_f32_16x16x32_bf16 v[204:207], v[108:111], v[88:91], v[204:207]
 v_cmp_gt_i32 vcc, 18, v40
 v_cmp_gt_i32 s[66:67], 19, v40
 v_mfma_f32_16x16x32_bf16 v[236:239], v[108:111], v[92:95], v[236:239]
 buffer_load_dwordx4 v16, s[12:15], s36 offen offset:3072 sc1 lds
 v_mfma_f32_16x16x32_bf16 v[144:147], v[112:115], v[80:83], v[144:147]
 v_cndmask_b32 v54, 0, v41, vcc
 v_cndmask_b32 v55, 0, v41, s[66:67]
 v_mfma_f32_16x16x32_bf16 v[176:179], v[112:115], v[84:87], v[176:179]
 v_cmp_gt_i32 vcc, 32, v40
 v_cmp_gt_i32 s[66:67], 33, v40
 v_mfma_f32_16x16x32_bf16 v[208:211], v[112:115], v[88:91], v[208:211]
 v_cndmask_b32 v56, 0, v41, vcc
 v_cndmask_b32 v57, 0, v41, s[66:67]
 v_mfma_f32_16x16x32_bf16 v[240:243], v[112:115], v[92:95], v[240:243]
 s_add_u32 s36, s59, 16384
 v_cmp_gt_i32 vcc, 34, v40
 v_cmp_gt_i32 s[66:67], 35, v40
 v_mfma_f32_16x16x32_bf16 v[148:151], v[116:119], v[80:83], v[148:151]
 s_add_u32 s37, s59, s47
 s_add_u32 m0, s37, 16384
 v_cndmask_b32 v58, 0, v41, vcc
 v_cndmask_b32 v59, 0, v41, s[66:67]
 v_mfma_f32_16x16x32_bf16 v[180:183], v[116:119], v[84:87], v[180:183]
 buffer_load_dwordx4 v16, s[12:15], s36 offen offset:0 sc1 lds
 v_mfma_f32_16x16x32_bf16 v[212:215], v[116:119], v[88:91], v[212:215]
 v_cmp_gt_i32 vcc, 48, v40
 v_cmp_gt_i32 s[66:67], 49, v40
 v_mfma_f32_16x16x32_bf16 v[244:247], v[116:119], v[92:95], v[244:247]
 v_cndmask_b32 v60, 0, v41, vcc
 v_cndmask_b32 v61, 0, v41, s[66:67]
 v_mfma_f32_16x16x32_bf16 v[152:155], v[120:123], v[80:83], v[152:155]
 buffer_load_dwordx4 v16, s[12:15], s36 offen offset:1024 sc1 lds
 v_mfma_f32_16x16x32_bf16 v[184:187], v[120:123], v[84:87], v[184:187]
 v_cmp_gt_i32 vcc, 50, v40
 v_cmp_gt_i32 s[66:67], 51, v40
 v_mfma_f32_16x16x32_bf16 v[216:219], v[120:123], v[88:91], v[216:219]
L_pad8:
 s_cbranch_execz L_pad16
 v_cndmask_b32 v62, 0, v41, vcc
 v_cndmask_b32 v63, 0, v41, s[66:67]
 v_mfma_f32_16x16x32_bf16 v[248:251], v[120:123], v[92:95], v[248:251]
 buffer_load_dwordx4 v16, s[12:15], s36 offen offset:2048 sc1 lds
 v_mfma_f32_16x16x32_bf16 v[156:159], v[124:127], v[80:83], v[156:159]
 v_add_u32 v2, s47, v16
 v_add_u32 v3, s47, v16
 v_mfma_f32_16x16x32_bf16 v[188:191], v[124:127], v[84:87], v[188:191]
 v_mov_b32 v24, 0x3f803f80
 v_mov_b32 v25, 0x3f803f80
 v_mfma_f32_16x16x32_bf16 v[220:223], v[124:127], v[88:91], v[220:223]
 buffer_load_dwordx4 v16, s[12:15], s36 offen offset:3072 sc1 lds
 v_mfma_f32_16x16x32_bf16 v[252:255], v[124:127], v[92:95], v[252:255]
 v_mov_b32 v26, 0x3f803f80
 v_mov_b32 v27, 0x3f803f80
 v_cvt_pk_bf16_f32 v80, v128, v129
 v_cvt_pk_bf16_f32 v81, v130, v131
 v_cvt_pk_bf16_f32 v82, v132, v133
 v_cvt_pk_bf16_f32 v83, v134, v135
 v_cvt_pk_bf16_f32 v84, v136, v137
 v_cvt_pk_bf16_f32 v85, v138, v139
 v_cvt_pk_bf16_f32 v86, v140, v141
 v_cvt_pk_bf16_f32 v87, v142, v143
 v_cvt_pk_bf16_f32 v88, v144, v145
 v_cvt_pk_bf16_f32 v89, v146, v147
 v_cvt_pk_bf16_f32 v90, v148, v149
 v_cvt_pk_bf16_f32 v91, v150, v151
 v_cvt_pk_bf16_f32 v92, v152, v153
 v_cvt_pk_bf16_f32 v93, v154, v155
 v_cvt_pk_bf16_f32 v94, v156, v157
 s_add_u32 s36, s59, 32768
 s_add_u32 s37, s59, s48
 s_mov_b32 m0, s37
 s_nop 0
 buffer_load_dwordx4 v16, s[12:15], s36 offen offset:0 sc1 lds
 v_cvt_pk_bf16_f32 v95, v158, v159
 v_cvt_pk_bf16_f32 v96, v160, v161
 v_cvt_pk_bf16_f32 v97, v162, v163
 v_cvt_pk_bf16_f32 v98, v164, v165
 v_cvt_pk_bf16_f32 v99, v166, v167
 v_cvt_pk_bf16_f32 v100, v168, v169
 v_cvt_pk_bf16_f32 v101, v170, v171
 v_cvt_pk_bf16_f32 v102, v172, v173
 v_cvt_pk_bf16_f32 v103, v174, v175
 v_cvt_pk_bf16_f32 v104, v176, v177
 v_cvt_pk_bf16_f32 v105, v178, v179
 v_cvt_pk_bf16_f32 v106, v180, v181
 v_cvt_pk_bf16_f32 v107, v182, v183
 v_cvt_pk_bf16_f32 v108, v184, v185
 v_cvt_pk_bf16_f32 v109, v186, v187
 buffer_load_dwordx4 v16, s[12:15], s36 offen offset:1024 sc1 lds
 v_cvt_pk_bf16_f32 v110, v188, v189
 v_cvt_pk_bf16_f32 v111, v190, v191
 v_cvt_pk_bf16_f32 v112, v192, v193
 v_cvt_pk_bf16_f32 v113, v194, v195
 v_cvt_pk_bf16_f32 v114, v196, v197
 v_cvt_pk_bf16_f32 v115, v198, v199
 v_cvt_pk_bf16_f32 v116, v200, v201
 v_cvt_pk_bf16_f32 v117, v202, v203
 v_cvt_pk_bf16_f32 v118, v204, v205
 v_cvt_pk_bf16_f32 v119, v206, v207
 v_cvt_pk_bf16_f32 v120, v208, v209
 v_cvt_pk_bf16_f32 v121, v210, v211
 v_cvt_pk_bf16_f32 v122, v212, v213
 v_cvt_pk_bf16_f32 v123, v214, v215
 v_cvt_pk_bf16_f32 v124, v216, v217
 buffer_load_dwordx4 v16, s[12:15], s36 offen offset:2048 sc1 lds
 v_cvt_pk_bf16_f32 v125, v218, v219
 v_cvt_pk_bf16_f32 v126, v220, v221
 v_cvt_pk_bf16_f32 v127, v222, v223
 v_cvt_pk_bf16_f32 v128, v224, v225
 v_cvt_pk_bf16_f32 v129, v226, v227
 v_cvt_pk_bf16_f32 v130, v228, v229
 v_cvt_pk_bf16_f32 v131, v230, v231
 v_cvt_pk_bf16_f32 v132, v232, v233
 v_cvt_pk_bf16_f32 v133, v234, v235
 v_cvt_pk_bf16_f32 v134, v236, v237
 v_cvt_pk_bf16_f32 v135, v238, v239
 v_cvt_pk_bf16_f32 v136, v240, v241
 v_cvt_pk_bf16_f32 v137, v242, v243
 v_cvt_pk_bf16_f32 v138, v244, v245
 v_cvt_pk_bf16_f32 v139, v246, v247
 buffer_load_dwordx4 v16, s[12:15], s36 offen offset:3072 sc1 lds
 v_cvt_pk_bf16_f32 v140, v248, v249
 v_cvt_pk_bf16_f32 v141, v250, v251
 v_cvt_pk_bf16_f32 v142, v252, v253
 v_cvt_pk_bf16_f32 v143, v254, v255
 s_waitcnt vmcnt(4)
 s_barrier
 ds_read_b128 a[128:131], v2 offset:0
 ds_read_b128 a[132:135], v2 offset:1024
 ds_read_b128 a[136:139], v2 offset:2048
 ds_read_b128 a[140:143], v2 offset:3072
 ds_read_b128 a[144:147], v2 offset:4096
 ds_read_b128 a[148:151], v2 offset:5120
 ds_read_b128 a[152:155], v2 offset:6144
 ds_read_b128 a[156:159], v2 offset:7168
 v_mov_b32 v240, 0
 v_mov_b32 v241, 0
 v_mov_b32 v242, 0
 s_add_u32 s36, s59, 49152
 s_add_u32 s37, s59, s48
 s_add_u32 m0, s37, 16384
 s_nop 0
 buffer_load_dwordx4 v16, s[12:15], s36 offen offset:0 sc1 lds
 v_mov_b32 v243, 0
 v_mov_b32 v244, 0
 v_mov_b32 v245, 0
 v_mov_b32 v246, 0
 v_mov_b32 v247, 0
 v_mov_b32 v248, 0
 v_mov_b32 v249, 0
 v_mov_b32 v250, 0
 v_mov_b32 v251, 0
 v_mov_b32 v252, 0
 v_mov_b32 v253, 0
 v_mov_b32 v254, 0
 v_mov_b32 v255, 0
 s_waitcnt lgkmcnt(7)
 v_mfma_f32_16x16x32_bf16 v[144:147], a[128:131], v[80:83], 0
 buffer_load_dwordx4 v16, s[12:15], s36 offen offset:1024 sc1 lds
 v_mfma_f32_16x16x32_bf16 v[152:155], a[128:131], v[96:99], 0
 v_mfma_f32_16x16x32_bf16 v[160:163], a[128:131], v[112:115], 0
 v_mfma_f32_16x16x32_bf16 v[168:171], a[128:131], v[128:131], 0
 s_waitcnt lgkmcnt(6)
 v_mfma_f32_16x16x32_bf16 v[144:147], a[132:135], v[84:87], v[144:147]
 buffer_load_dwordx4 v16, s[12:15], s36 offen offset:2048 sc1 lds
 v_mfma_f32_16x16x32_bf16 v[152:155], a[132:135], v[100:103], v[152:155]
 v_mfma_f32_16x16x32_bf16 v[160:163], a[132:135], v[116:119], v[160:163]
 v_mfma_f32_16x16x32_bf16 v[168:171], a[132:135], v[132:135], v[168:171]
 s_waitcnt lgkmcnt(5)
 v_mfma_f32_16x16x32_bf16 v[144:147], a[136:139], v[88:91], v[144:147]
 buffer_load_dwordx4 v16, s[12:15], s36 offen offset:3072 sc1 lds
 v_mfma_f32_16x16x32_bf16 v[152:155], a[136:139], v[104:107], v[152:155]
 v_mfma_f32_16x16x32_bf16 v[160:163], a[136:139], v[120:123], v[160:163]
 v_mfma_f32_16x16x32_bf16 v[168:171], a[136:139], v[136:139], v[168:171]
 s_waitcnt lgkmcnt(4)
 v_mfma_f32_16x16x32_bf16 v[144:147], a[140:143], v[92:95], v[144:147]
 s_add_u32 s36, s59, 65536
 s_add_u32 s37, s59, s51
 s_mov_b32 m0, s37
 s_nop 0
 buffer_load_dwordx4 v16, s[12:15], s36 offen offset:0 sc1 lds
 v_mfma_f32_16x16x32_bf16 v[152:155], a[140:143], v[108:111], v[152:155]
 v_mfma_f32_16x16x32_bf16 v[160:163], a[140:143], v[124:127], v[160:163]
 v_mfma_f32_16x16x32_bf16 v[168:171], a[140:143], v[140:143], v[168:171]
 s_waitcnt lgkmcnt(3)
 v_mfma_f32_16x16x32_bf16 v[148:151], a[144:147], v[80:83], 0
 buffer_load_dwordx4 v16, s[12:15], s36 offen offset:1024 sc1 lds
 v_mfma_f32_16x16x32_bf16 v[156:159], a[144:147], v[96:99], 0
 v_mfma_f32_16x16x32_bf16 v[164:167], a[144:147], v[112:115], 0
 v_mfma_f32_16x16x32_bf16 v[172:175], a[144:147], v[128:131], 0
 s_waitcnt lgkmcnt(2)
 v_mfma_f32_16x16x32_bf16 v[148:151], a[148:151], v[84:87], v[148:151]
 buffer_load_dwordx4 v16, s[12:15], s36 offen offset:2048 sc1 lds
 v_mfma_f32_16x16x32_bf16 v[156:159], a[148:151], v[100:103], v[156:159]
 v_mfma_f32_16x16x32_bf16 v[164:167], a[148:151], v[116:119], v[164:167]
 v_mfma_f32_16x16x32_bf16 v[172:175], a[148:151], v[132:135], v[172:175]
 s_waitcnt lgkmcnt(1)
 v_mfma_f32_16x16x32_bf16 v[148:151], a[152:155], v[88:91], v[148:151]
 buffer_load_dwordx4 v16, s[12:15], s36 offen offset:3072 sc1 lds
 v_mfma_f32_16x16x32_bf16 v[156:159], a[152:155], v[104:107], v[156:159]
 v_mfma_f32_16x16x32_bf16 v[164:167], a[152:155], v[120:123], v[164:167]
 v_mfma_f32_16x16x32_bf16 v[172:175], a[152:155], v[136:139], v[172:175]
 s_waitcnt lgkmcnt(0)
 v_mfma_f32_16x16x32_bf16 v[148:151], a[156:159], v[92:95], v[148:151]
 s_add_u32 s36, s59, 81920
 s_add_u32 s37, s59, s51
 s_add_u32 m0, s37, 16384
 s_nop 0
 buffer_load_dwordx4 v16, s[12:15], s36 offen offset:0 sc1 lds
 v_mfma_f32_16x16x32_bf16 v[156:159], a[156:159], v[108:111], v[156:159]
 v_mfma_f32_16x16x32_bf16 v[164:167], a[156:159], v[124:127], v[164:167]
 v_mfma_f32_16x16x32_bf16 v[172:175], a[156:159], v[140:143], v[172:175]
 ds_read_b128 a[128:131], v2 offset:16384
 ds_read_b128 a[132:135], v2 offset:17408
 ds_read_b128 a[136:139], v2 offset:18432
 ds_read_b128 a[140:143], v2 offset:19456
 ds_read_b128 a[144:147], v2 offset:20480
 ds_read_b128 a[148:151], v2 offset:21504
 ds_read_b128 a[152:155], v2 offset:22528
 ds_read_b128 a[156:159], v2 offset:23552
 ds_read_b128 a[160:163], v2 offset:8192
 ds_read_b128 a[164:167], v2 offset:9216
 ds_read_b128 a[168:171], v2 offset:10240
 ds_read_b128 a[172:175], v2 offset:11264
 s_cmp_lg_u32 s34, 0
 s_cbranch_scc1 L_nomask0
 v_add_f32 v144, v48, v144
 v_add_f32 v145, v49, v145
 v_add_f32 v146, v50, v146
 v_add_f32 v147, v51, v147
 v_add_f32 v148, v52, v148
 v_add_f32 v149, v53, v149
 v_add_f32 v150, v54, v150
 v_add_f32 v151, v55, v151
L_nomask0:
 v_max3_f32 v32, v144, v145, v146
 v_max3_f32 v32, v147, v148, v32
 v_max3_f32 v32, v149, v150, v32
 buffer_load_dwordx4 v16, s[12:15], s36 offen offset:1024 sc1 lds
 v_max_f32 v32, v151, v32
 v_max3_f32 v34, v152, v153, v154
 v_max3_f32 v34, v155, v156, v34
 v_max3_f32 v34, v157, v158, v34
 v_max_f32 v34, v159, v34
 v_max3_f32 v36, v160, v161, v162
 v_max3_f32 v36, v163, v164, v36
 v_max3_f32 v36, v165, v166, v36
 v_max_f32 v36, v167, v36
 v_max3_f32 v38, v168, v169, v170
 v_max3_f32 v38, v171, v172, v38
 v_max3_f32 v38, v173, v174, v38
 v_max_f32 v38, v175, v38
 v_mov_b32 v33, v32
 v_mov_b32 v35, v34
 buffer_load_dwordx4 v16, s[12:15], s36 offen offset:2048 sc1 lds
 v_mov_b32 v37, v36
 v_mov_b32 v39, v38
 v_permlane16_swap_b32 v32, v33
 v_permlane16_swap_b32 v34, v35
 v_permlane16_swap_b32 v36, v37
 v_permlane16_swap_b32 v38, v39
 v_max_f32 v32, v32, v33
 v_max_f32 v34, v34, v35
 v_max_f32 v36, v36, v37
 v_max_f32 v38, v38, v39
 v_mov_b32 v33, v32
 v_mov_b32 v35, v34
 v_mov_b32 v37, v36
 v_mov_b32 v39, v38
 v_permlane32_swap_b32 v32, v33
 buffer_load_dwordx4 v16, s[12:15], s36 offen offset:3072 sc1 lds
 v_permlane32_swap_b32 v34, v35
 v_permlane32_swap_b32 v36, v37
 v_permlane32_swap_b32 v38, v39
 v_max_f32 v32, v32, v33
 v_max_f32 v34, v34, v35
 v_max_f32 v36, v36, v37
 v_max_f32 v38, v38, v39
 v_sub_f32 v64, 0xc1c00000, v32
 v_sub_f32 v65, 0xc1c00000, v32
 v_pk_mov_b32 v[66:67], v[64:65], v[64:65] op_sel:[0,1]
 v_pk_add_f32 v[144:145], v[144:145], v[64:65]
 v_pk_add_f32 v[146:147], v[146:147], v[64:65]
 v_pk_add_f32 v[148:149], v[148:149], v[64:65]
 v_pk_add_f32 v[150:151], v[150:151], v[64:65]
 v_sub_f32 v68, 0xc1c00000, v34
 s_add_u32 s36, s59, 98304
 s_add_u32 s37, s59, s52
 s_mov_b32 m0, s37
 s_nop 0
 buffer_load_dwordx4 v16, s[12:15], s36 offen offset:0 sc1 lds
 v_sub_f32 v69, 0xc1c00000, v34
 v_pk_mov_b32 v[70:71], v[68:69], v[68:69] op_sel:[0,1]
 v_pk_add_f32 v[152:153], v[152:153], v[68:69]
 v_pk_add_f32 v[154:155], v[154:155], v[68:69]
 v_pk_add_f32 v[156:157], v[156:157], v[68:69]
 v_pk_add_f32 v[158:159], v[158:159], v[68:69]
 v_sub_f32 v72, 0xc1c00000, v36
 v_sub_f32 v73, 0xc1c00000, v36
 v_pk_mov_b32 v[74:75], v[72:73], v[72:73] op_sel:[0,1]
 v_pk_add_f32 v[160:161], v[160:161], v[72:73]
 v_pk_add_f32 v[162:163], v[162:163], v[72:73]
 v_pk_add_f32 v[164:165], v[164:165], v[72:73]
 v_pk_add_f32 v[166:167], v[166:167], v[72:73]
 v_sub_f32 v76, 0xc1c00000, v38
 v_sub_f32 v77, 0xc1c00000, v38
 buffer_load_dwordx4 v16, s[12:15], s36 offen offset:1024 sc1 lds
 v_pk_mov_b32 v[78:79], v[76:77], v[76:77] op_sel:[0,1]
 v_pk_add_f32 v[168:169], v[168:169], v[76:77]
 v_pk_add_f32 v[170:171], v[170:171], v[76:77]
 v_pk_add_f32 v[172:173], v[172:173], v[76:77]
 v_pk_add_f32 v[174:175], v[174:175], v[76:77]
 v_exp_f32 v4, v168
 v_exp_f32 v5, v169
 s_nop 0
 v_cvt_pk_bf16_f32 v220, v4, v5
 v_exp_f32 v6, v170
 v_exp_f32 v7, v171
 s_nop 0
 v_cvt_pk_bf16_f32 v221, v6, v7
 buffer_load_dwordx4 v16, s[12:15], s36 offen offset:2048 sc1 lds
 v_exp_f32 v8, v172
 v_exp_f32 v9, v173
 s_nop 0
 v_cvt_pk_bf16_f32 v222, v8, v9
 v_or3_b32 v12, v220, v221, v222
 v_exp_f32 v10, v174
 v_exp_f32 v11, v175
 s_nop 0
 v_cvt_pk_bf16_f32 v223, v10, v11
 v_exp_f32 v4, v160
 v_exp_f32 v5, v161
 s_nop 0
 v_cvt_pk_bf16_f32 v216, v4, v5
 buffer_load_dwordx4 v16, s[12:15], s36 offen offset:3072 sc1 lds
 v_or3_b32 v12, v12, v223, v216
 v_exp_f32 v6, v162
 v_exp_f32 v7, v163
 s_nop 0
 v_cvt_pk_bf16_f32 v217, v6, v7
 v_exp_f32 v8, v164
 v_exp_f32 v9, v165
 s_nop 0
 v_cvt_pk_bf16_f32 v218, v8, v9
 v_or3_b32 v12, v12, v217, v218
 v_exp_f32 v10, v166
 v_exp_f32 v11, v167
 s_nop 0
 v_cvt_pk_bf16_f32 v219, v10, v11
 s_add_u32 s36, s59, 114688
 s_add_u32 s37, s59, s52
 s_add_u32 m0, s37, 16384
 s_nop 0
 buffer_load_dwordx4 v16, s[12:15], s36 offen offset:0 sc1 lds
 buffer_load_dwordx4 v16, s[12:15], s36 offen offset:1024 sc1 lds
 buffer_load_dwordx4 v16, s[12:15], s36 offen offset:2048 sc1 lds
 buffer_load_dwordx4 v16, s[12:15], s36 offen offset:3072 sc1 lds
 s_mov_b32 s47, 393216
 buffer_load_dwordx4 v[28:31], v14, s[28:31], s47 offen sc1
 buffer_load_dword v13, v15, s[4:7], s54 offen
 s_mov_b32 s48, 0
 v_add_u32 v2, s45, v16
 s_waitcnt vmcnt(18) lgkmcnt(0)
 s_barrier
 s_lshl_b32 s58, s34, 1
 s_cbranch_scc0 L_b4e
 s_nop 0
 s_nop 0
 s_nop 0
 s_nop 0
 s_nop 0
 s_nop 0
 s_nop 0
 s_nop 0
 s_nop 0
 s_nop 0
 s_nop 0
 s_nop 0
 s_nop 0
 s_nop 0
L_b4_loop:
 v_mfma_f32_16x16x32_bf16 v[176:179], a[128:131], v[80:83], v[64:67]
 v_exp_f32 v4, v152
 v_mfma_f32_16x16x32_bf16 v[184:187], a[128:131], v[96:99], v[68:71]
 ds_read_b128 a[176:179], v3 offset:12288
 ds_read_b128 a[180:183], v3 offset:13312
 v_mfma_f32_16x16x32_bf16 v[192:195], a[128:131], v[112:115], v[72:75]
 s_waitcnt vmcnt(18)
 ds_read_b128 a[184:187], v3 offset:14336
 v_mfma_f32_16x16x32_bf16 v[200:203], a[128:131], v[128:131], v[76:79]
 s_barrier
 ds_read_b128 a[188:191], v3 offset:15360
 v_mfma_f32_16x16x32_bf16 v[176:179], a[132:135], v[84:87], v[176:179]
 s_mov_b32 m0, s40
 v_exp_f32 v5, v153
 v_mfma_f32_16x16x32_bf16 v[184:187], a[132:135], v[100:103], v[184:187]
 s_add_u32 s43, s38, s49
 v_exp_f32 v6, v154
 v_mfma_f32_16x16x32_bf16 v[192:195], a[132:135], v[116:119], v[192:195]
 ds_read_b128 a[128:131], v2 offset:0
 v_cvt_pk_bf16_f32 v212, v4, v5
 v_mfma_f32_16x16x32_bf16 v[200:203], a[132:135], v[132:135], v[200:203]
 ds_read_b128 a[132:135], v2 offset:1024
 v_or3_b32 v12, v12, v219, v212
 v_mfma_f32_16x16x32_bf16 v[176:179], a[136:139], v[88:91], v[176:179]
 v_exp_f32 v7, v155
 v_mfma_f32_16x16x32_bf16 v[184:187], a[136:139], v[104:107], v[184:187]
 v_exp_f32 v8, v156
 v_mfma_f32_16x16x32_bf16 v[192:195], a[136:139], v[120:123], v[192:195]
 v_exp_f32 v9, v157
 v_mfma_f32_16x16x32_bf16 v[200:203], a[136:139], v[136:139], v[200:203]
 ds_read_b128 a[136:139], v2 offset:2048
 v_cvt_pk_bf16_f32 v213, v6, v7
 v_mfma_f32_16x16x32_bf16 v[176:179], a[140:143], v[92:95], v[176:179]
 v_exp_f32 v10, v158
 v_mfma_f32_16x16x32_bf16 v[184:187], a[140:143], v[108:111], v[184:187]
 v_exp_f32 v11, v159
 v_mfma_f32_16x16x32_bf16 v[192:195], a[140:143], v[124:127], v[192:195]
 v_exp_f32 v4, v144
 v_mfma_f32_16x16x32_bf16 v[200:203], a[140:143], v[140:143], v[200:203]
 s_waitcnt lgkmcnt(11)
 ds_read_b128 a[140:143], v2 offset:3072
 v_cvt_pk_bf16_f32 v214, v8, v9
 v_mfma_f32_16x16x32_bf16 v[180:183], a[144:147], v[80:83], v[64:67]
 v_exp_f32 v5, v145
 v_mfma_f32_16x16x32_bf16 v[188:191], a[144:147], v[96:99], v[68:71]
 v_exp_f32 v6, v146
 v_mfma_f32_16x16x32_bf16 v[196:199], a[144:147], v[112:115], v[72:75]
 v_exp_f32 v7, v147
 v_mfma_f32_16x16x32_bf16 v[204:207], a[144:147], v[128:131], v[76:79]
 ds_read_b128 a[144:147], v2 offset:4096
 v_or3_b32 v12, v12, v213, v214
 v_mfma_f32_16x16x32_bf16 v[180:183], a[148:151], v[84:87], v[180:183]
 buffer_load_dword v13, v19, s[8:11], s46 offen
 v_mfma_f32_16x16x32_bf16 v[188:191], a[148:151], v[100:103], v[188:191]
 v_exp_f32 v8, v148
 v_mfma_f32_16x16x32_bf16 v[196:199], a[148:151], v[116:119], v[196:199]
 v_exp_f32 v9, v149
 v_mfma_f32_16x16x32_bf16 v[204:207], a[148:151], v[132:135], v[204:207]
 ds_read_b128 a[148:151], v2 offset:5120
 v_cvt_pk_bf16_f32 v215, v10, v11
 v_mfma_f32_16x16x32_bf16 v[180:183], a[152:155], v[88:91], v[180:183]
 v_exp_f32 v10, v150
 v_mfma_f32_16x16x32_bf16 v[188:191], a[152:155], v[104:107], v[188:191]
 v_exp_f32 v11, v151
 v_mfma_f32_16x16x32_bf16 v[196:199], a[152:155], v[120:123], v[196:199]
 v_cvt_pk_bf16_f32 v208, v4, v5
 v_or3_b32 v12, v12, v215, v208
 v_mfma_f32_16x16x32_bf16 v[204:207], a[152:155], v[136:139], v[204:207]
 v_cvt_pk_bf16_f32 v209, v6, v7
 v_cvt_pk_bf16_f32 v210, v8, v9
 v_mfma_f32_16x16x32_bf16 v[180:183], a[156:159], v[92:95], v[180:183]
 v_or3_b32 v12, v12, v209, v210
 v_cvt_pk_bf16_f32 v211, v10, v11
 v_mfma_f32_16x16x32_bf16 v[188:191], a[156:159], v[108:111], v[188:191]
 v_bitop3_b32 v12, v12, v211, s42 bitop3:0xa8
 v_cmp_ne_u32 vcc, 0, v12
 v_mfma_f32_16x16x32_bf16 v[196:199], a[156:159], v[124:127], v[196:199]
 s_waitcnt lgkmcnt(10)
 ds_read_b128 a[152:155], v2 offset:6144
 v_mfma_f32_16x16x32_bf16 v[204:207], a[156:159], v[140:143], v[204:207]
 s_cbranch_vccnz L_b4_r0
L_b4_r0_ret:
 ds_read_b128 a[156:159], v2 offset:7168
 v_mfma_f32_16x16x32_bf16 a[0:3], a[160:163], v[208:211], a[0:3]
 v_mfma_f32_16x16x32_bf16 a[32:35], a[160:163], v[212:215], a[32:35]
 v_mfma_f32_16x16x32_bf16 a[64:67], a[160:163], v[216:219], a[64:67]
 buffer_load_dwordx4 v16, s[12:15], s38 offen offset:0 sc1 lds
 v_mfma_f32_16x16x32_bf16 a[96:99], a[160:163], v[220:223], a[96:99]
 ds_read_b128 a[160:163], v3 offset:24576
 v_mfma_f32_16x16x32_bf16 a[4:7], a[164:167], v[208:211], a[4:7]
 v_mfma_f32_16x16x32_bf16 a[36:39], a[164:167], v[212:215], a[36:39]
 v_mfma_f32_16x16x32_bf16 a[68:71], a[164:167], v[216:219], a[68:71]
 v_mfma_f32_16x16x32_bf16 a[100:103], a[164:167], v[220:223], a[100:103]
 ds_read_b128 a[164:167], v3 offset:25600
 v_mfma_f32_16x16x32_bf16 a[8:11], a[168:171], v[208:211], a[8:11]
 v_mfma_f32_16x16x32_bf16 a[40:43], a[168:171], v[212:215], a[40:43]
 v_mfma_f32_16x16x32_bf16 a[72:75], a[168:171], v[216:219], a[72:75]
 v_exp_f32 v4, v200
 v_mfma_f32_16x16x32_bf16 a[104:107], a[168:171], v[220:223], a[104:107]
 ds_read_b128 a[168:171], v3 offset:26624
 v_mfma_f32_16x16x32_bf16 a[12:15], a[172:175], v[208:211], a[12:15]
 v_exp_f32 v5, v201
 v_mfma_f32_16x16x32_bf16 a[44:47], a[172:175], v[212:215], a[44:47]
 v_exp_f32 v6, v202
 v_mfma_f32_16x16x32_bf16 a[76:79], a[172:175], v[216:219], a[76:79]
 v_exp_f32 v7, v203
 v_mfma_f32_16x16x32_bf16 a[108:111], a[172:175], v[220:223], a[108:111]
 s_waitcnt lgkmcnt(11)
 ds_read_b128 a[172:175], v3 offset:27648
 v_mfma_f32_16x16x32_bf16 a[16:19], a[176:179], v[208:211], a[16:19]
 buffer_load_dwordx4 v16, s[12:15], s38 offen offset:1024 sc1 lds
 v_mfma_f32_16x16x32_bf16 a[48:51], a[176:179], v[212:215], a[48:51]
 v_exp_f32 v8, v204
 v_mfma_f32_16x16x32_bf16 a[80:83], a[176:179], v[216:219], a[80:83]
 v_exp_f32 v9, v205
 v_mfma_f32_16x16x32_bf16 a[112:115], a[176:179], v[220:223], a[112:115]
 ds_read_b128 a[176:179], v3 offset:28672
 v_cvt_pk_bf16_f32 v236, v4, v5
 v_mfma_f32_16x16x32_bf16 a[20:23], a[180:183], v[208:211], a[20:23]
 v_exp_f32 v10, v206
 v_mfma_f32_16x16x32_bf16 a[52:55], a[180:183], v[212:215], a[52:55]
 v_exp_f32 v11, v207
 v_mfma_f32_16x16x32_bf16 a[84:87], a[180:183], v[216:219], a[84:87]
 v_exp_f32 v4, v192
 v_mfma_f32_16x16x32_bf16 a[116:119], a[180:183], v[220:223], a[116:119]
 ds_read_b128 a[180:183], v3 offset:29696
 v_cvt_pk_bf16_f32 v237, v6, v7
 v_mfma_f32_16x16x32_bf16 a[24:27], a[184:187], v[208:211], a[24:27]
 v_exp_f32 v5, v193
 v_mfma_f32_16x16x32_bf16 a[56:59], a[184:187], v[212:215], a[56:59]
 v_exp_f32 v6, v194
 v_mfma_f32_16x16x32_bf16 a[88:91], a[184:187], v[216:219], a[88:91]
 v_exp_f32 v7, v195
 v_mfma_f32_16x16x32_bf16 a[120:123], a[184:187], v[220:223], a[120:123]
 ds_read_b128 a[184:187], v3 offset:30720
 v_cvt_pk_bf16_f32 v238, v8, v9
 v_mfma_f32_16x16x32_bf16 a[28:31], a[188:191], v[208:211], a[28:31]
 v_exp_f32 v8, v196
 v_mfma_f32_16x16x32_bf16 a[60:63], a[188:191], v[212:215], a[60:63]
 v_exp_f32 v9, v197
 v_mfma_f32_16x16x32_bf16 a[92:95], a[188:191], v[216:219], a[92:95]
 buffer_load_dwordx4 v16, s[12:15], s38 offen offset:2048 sc1 lds
 v_mfma_f32_16x16x32_bf16 a[124:127], a[188:191], v[220:223], a[124:127]
 ds_read_b128 a[188:191], v3 offset:31744
 v_or3_b32 v12, v236, v237, v238
 v_mfma_f32_16x16x32_bf16 v[240:243], v[24:27], v[208:211], v[240:243]
 v_cvt_pk_bf16_f32 v239, v10, v11
 v_cvt_pk_bf16_f32 v232, v4, v5
 v_mfma_f32_16x16x32_bf16 v[244:247], v[24:27], v[212:215], v[244:247]
 v_exp_f32 v10, v198
 v_mfma_f32_16x16x32_bf16 v[248:251], v[24:27], v[216:219], v[248:251]
 v_exp_f32 v11, v199
 v_mfma_f32_16x16x32_bf16 v[252:255], v[24:27], v[220:223], v[252:255]
 s_waitcnt lgkmcnt(12)
 v_exp_f32 v4, v184
 v_mfma_f32_16x16x32_bf16 v[144:147], a[128:131], v[80:83], v[64:67]
 v_exp_f32 v5, v185
 v_mfma_f32_16x16x32_bf16 v[152:155], a[128:131], v[96:99], v[68:71]
 v_or3_b32 v12, v12, v239, v232
 v_cvt_pk_bf16_f32 v233, v6, v7
 v_mfma_f32_16x16x32_bf16 v[160:163], a[128:131], v[112:115], v[72:75]
 v_exp_f32 v6, v186
 v_mfma_f32_16x16x32_bf16 v[168:171], a[128:131], v[128:131], v[76:79]
 ds_read_b128 a[128:131], v2 offset:16384
 v_cvt_pk_bf16_f32 v234, v8, v9
 v_mfma_f32_16x16x32_bf16 v[144:147], a[132:135], v[84:87], v[144:147]
 v_exp_f32 v7, v187
 v_mfma_f32_16x16x32_bf16 v[152:155], a[132:135], v[100:103], v[152:155]
 v_exp_f32 v8, v188
 v_mfma_f32_16x16x32_bf16 v[160:163], a[132:135], v[116:119], v[160:163]
 v_exp_f32 v9, v189
 v_mfma_f32_16x16x32_bf16 v[168:171], a[132:135], v[132:135], v[168:171]
 ds_read_b128 a[132:135], v2 offset:17408
 v_or3_b32 v12, v12, v233, v234
 v_mfma_f32_16x16x32_bf16 v[144:147], a[136:139], v[88:91], v[144:147]
 v_cvt_pk_bf16_f32 v235, v10, v11
 v_cvt_pk_bf16_f32 v228, v4, v5
 v_mfma_f32_16x16x32_bf16 v[152:155], a[136:139], v[104:107], v[152:155]
 buffer_load_dwordx4 v16, s[12:15], s38 offen offset:3072 sc1 lds
 v_mfma_f32_16x16x32_bf16 v[160:163], a[136:139], v[120:123], v[160:163]
 s_mov_b32 m0, s41
 v_exp_f32 v10, v190
 v_mfma_f32_16x16x32_bf16 v[168:171], a[136:139], v[136:139], v[168:171]
 ds_read_b128 a[136:139], v2 offset:18432
 v_or3_b32 v12, v12, v235, v228
 v_mfma_f32_16x16x32_bf16 v[144:147], a[140:143], v[92:95], v[144:147]
 v_exp_f32 v11, v191
 v_mfma_f32_16x16x32_bf16 v[152:155], a[140:143], v[108:111], v[152:155]
 v_exp_f32 v4, v176
 v_mfma_f32_16x16x32_bf16 v[160:163], a[140:143], v[124:127], v[160:163]
 v_exp_f32 v5, v177
 v_mfma_f32_16x16x32_bf16 v[168:171], a[140:143], v[140:143], v[168:171]
 s_waitcnt lgkmcnt(11)
 ds_read_b128 a[140:143], v2 offset:19456
 v_cvt_pk_bf16_f32 v229, v6, v7
 v_mfma_f32_16x16x32_bf16 v[148:151], a[144:147], v[80:83], v[64:67]
 v_exp_f32 v6, v178
 v_mfma_f32_16x16x32_bf16 v[156:159], a[144:147], v[96:99], v[68:71]
 v_exp_f32 v7, v179
 v_mfma_f32_16x16x32_bf16 v[164:167], a[144:147], v[112:115], v[72:75]
 v_cvt_pk_bf16_f32 v230, v8, v9
 v_or3_b32 v12, v12, v229, v230
 v_mfma_f32_16x16x32_bf16 v[172:175], a[144:147], v[128:131], v[76:79]
 ds_read_b128 a[144:147], v2 offset:20480
 v_cvt_pk_bf16_f32 v231, v10, v11
 v_mfma_f32_16x16x32_bf16 v[148:151], a[148:151], v[84:87], v[148:151]
 v_exp_f32 v8, v180
 v_mfma_f32_16x16x32_bf16 v[156:159], a[148:151], v[100:103], v[156:159]
 v_exp_f32 v9, v181
 v_mfma_f32_16x16x32_bf16 v[164:167], a[148:151], v[116:119], v[164:167]
 buffer_load_dwordx4 v16, s[12:15], s43 offen offset:0 sc1 lds
 v_mfma_f32_16x16x32_bf16 v[172:175], a[148:151], v[132:135], v[172:175]
 ds_read_b128 a[148:151], v2 offset:21504
 v_cvt_pk_bf16_f32 v224, v4, v5
 v_mfma_f32_16x16x32_bf16 v[148:151], a[152:155], v[88:91], v[148:151]
 v_exp_f32 v10, v182
 v_mfma_f32_16x16x32_bf16 v[156:159], a[152:155], v[104:107], v[156:159]
 v_exp_f32 v11, v183
 v_mfma_f32_16x16x32_bf16 v[164:167], a[152:155], v[120:123], v[164:167]
 v_or3_b32 v12, v12, v231, v224
 v_cvt_pk_bf16_f32 v225, v6, v7
 v_mfma_f32_16x16x32_bf16 v[172:175], a[152:155], v[136:139], v[172:175]
 ds_read_b128 a[152:155], v2 offset:22528
 v_cvt_pk_bf16_f32 v226, v8, v9
 v_mfma_f32_16x16x32_bf16 v[148:151], a[156:159], v[92:95], v[148:151]
 v_or3_b32 v12, v12, v225, v226
 v_cvt_pk_bf16_f32 v227, v10, v11
 v_mfma_f32_16x16x32_bf16 v[156:159], a[156:159], v[108:111], v[156:159]
 v_bitop3_b32 v12, v12, v227, s42 bitop3:0xa8
 v_cmp_ne_u32 vcc, 0, v12
 v_mfma_f32_16x16x32_bf16 v[164:167], a[156:159], v[124:127], v[164:167]
 s_waitcnt lgkmcnt(11)
 v_mfma_f32_16x16x32_bf16 v[172:175], a[156:159], v[140:143], v[172:175]
 s_cbranch_vccnz L_b4_r1
L_b4_r1_ret:
 ds_read_b128 a[156:159], v2 offset:23552
 v_mfma_f32_16x16x32_bf16 a[0:3], a[160:163], v[224:227], a[0:3]
 v_mfma_f32_16x16x32_bf16 a[32:35], a[160:163], v[228:231], a[32:35]
 s_add_u32 s38, s38, s44
 v_mfma_f32_16x16x32_bf16 a[64:67], a[160:163], v[232:235], a[64:67]
 s_add_u32 s40, s39, s59
 v_mfma_f32_16x16x32_bf16 a[96:99], a[160:163], v[236:239], a[96:99]
 s_add_u32 s41, s40, s50
 ds_read_b128 a[160:163], v2 offset:8192
 v_mfma_f32_16x16x32_bf16 a[4:7], a[164:167], v[224:227], a[4:7]
 s_mov_b32 s39, s45
 v_mfma_f32_16x16x32_bf16 a[36:39], a[164:167], v[228:231], a[36:39]
 buffer_load_dwordx4 v16, s[12:15], s43 offen offset:1024 sc1 lds
 v_mfma_f32_16x16x32_bf16 a[68:71], a[164:167], v[232:235], a[68:71]
 s_add_u32 s59, s59, s48
 v_mfma_f32_16x16x32_bf16 a[100:103], a[164:167], v[236:239], a[100:103]
 s_add_u32 s45, s45, 32768
 ds_read_b128 a[164:167], v2 offset:9216
 v_mfma_f32_16x16x32_bf16 a[8:11], a[168:171], v[224:227], a[8:11]
 s_cmp_eq_u32 s45, 163840
 v_mfma_f32_16x16x32_bf16 a[40:43], a[168:171], v[228:231], a[40:43]
 s_cselect_b32 s45, 0, s45
 v_mfma_f32_16x16x32_bf16 a[72:75], a[168:171], v[232:235], a[72:75]
 s_add_u32 s46, s46, 1048576
 v_exp_f32 v4, v168
 v_mfma_f32_16x16x32_bf16 a[104:107], a[168:171], v[236:239], a[104:107]
 s_sub_u32 s58, s58, 1
 ds_read_b128 a[168:171], v2 offset:10240
 v_mfma_f32_16x16x32_bf16 a[12:15], a[172:175], v[224:227], a[12:15]
 s_cmp_lg_u32 s58, 0
 v_exp_f32 v5, v169
 v_mfma_f32_16x16x32_bf16 a[44:47], a[172:175], v[228:231], a[44:47]
 v_exp_f32 v6, v170
 v_mfma_f32_16x16x32_bf16 a[76:79], a[172:175], v[232:235], a[76:79]
 v_exp_f32 v7, v171
 v_mfma_f32_16x16x32_bf16 a[108:111], a[172:175], v[236:239], a[108:111]
 s_waitcnt lgkmcnt(11)
 ds_read_b128 a[172:175], v2 offset:11264
 v_cvt_pk_bf16_f32 v220, v4, v5
 v_mfma_f32_16x16x32_bf16 a[16:19], a[176:179], v[224:227], a[16:19]
L_pad9:
 s_cbranch_execz L_pad17
 v_exp_f32 v8, v172
 v_mfma_f32_16x16x32_bf16 a[48:51], a[176:179], v[228:231], a[48:51]
 v_exp_f32 v9, v173
 v_mfma_f32_16x16x32_bf16 a[80:83], a[176:179], v[232:235], a[80:83]
 v_exp_f32 v10, v174
 v_mfma_f32_16x16x32_bf16 a[112:115], a[176:179], v[236:239], a[112:115]
 buffer_load_dwordx4 v16, s[12:15], s43 offen offset:2048 sc1 lds
 v_mfma_f32_16x16x32_bf16 a[20:23], a[180:183], v[224:227], a[20:23]
 v_exp_f32 v11, v175
 v_mfma_f32_16x16x32_bf16 a[52:55], a[180:183], v[228:231], a[52:55]
 v_exp_f32 v4, v160
 v_mfma_f32_16x16x32_bf16 a[84:87], a[180:183], v[232:235], a[84:87]
 v_exp_f32 v5, v161
 v_mfma_f32_16x16x32_bf16 a[116:119], a[180:183], v[236:239], a[116:119]
 v_cvt_pk_bf16_f32 v221, v6, v7
 v_cvt_pk_bf16_f32 v222, v8, v9
 v_mfma_f32_16x16x32_bf16 a[24:27], a[184:187], v[224:227], a[24:27]
 v_exp_f32 v6, v162
 v_mfma_f32_16x16x32_bf16 a[56:59], a[184:187], v[228:231], a[56:59]
 v_exp_f32 v7, v163
 v_mfma_f32_16x16x32_bf16 a[88:91], a[184:187], v[232:235], a[88:91]
 v_exp_f32 v8, v164
 v_mfma_f32_16x16x32_bf16 a[120:123], a[184:187], v[236:239], a[120:123]
 v_exp_f32 v9, v165
 v_mfma_f32_16x16x32_bf16 a[28:31], a[188:191], v[224:227], a[28:31]
 v_or3_b32 v12, v220, v221, v222
 v_cvt_pk_bf16_f32 v223, v10, v11
 v_mfma_f32_16x16x32_bf16 a[60:63], a[188:191], v[228:231], a[60:63]
 v_exp_f32 v10, v166
 v_mfma_f32_16x16x32_bf16 a[92:95], a[188:191], v[232:235], a[92:95]
 v_exp_f32 v11, v167
 v_mfma_f32_16x16x32_bf16 a[124:127], a[188:191], v[236:239], a[124:127]
 v_cvt_pk_bf16_f32 v216, v4, v5
 v_or3_b32 v12, v12, v223, v216
 v_mfma_f32_16x16x32_bf16 v[240:243], v[24:27], v[224:227], v[240:243]
 v_cvt_pk_bf16_f32 v217, v6, v7
 v_cvt_pk_bf16_f32 v218, v8, v9
 v_mfma_f32_16x16x32_bf16 v[244:247], v[24:27], v[228:231], v[244:247]
 v_or3_b32 v12, v12, v217, v218
 v_cvt_pk_bf16_f32 v219, v10, v11
 v_mfma_f32_16x16x32_bf16 v[248:251], v[24:27], v[232:235], v[248:251]
 buffer_load_dwordx4 v16, s[12:15], s43 offen offset:3072 sc1 lds
 v_mfma_f32_16x16x32_bf16 v[252:255], v[24:27], v[236:239], v[252:255]
 s_waitcnt lgkmcnt(8)
 v_mov_b32 v3, v2
 v_add_u32 v2, s45, v16
 s_cbranch_scc1 L_b4_loop
 s_cmp_eq_u32 s34, 7
 s_cbranch_scc1 L_b4_sw
L_b4e:
 v_mfma_f32_16x16x32_bf16 v[176:179], a[128:131], v[80:83], v[64:67]
 v_exp_f32 v4, v152
 v_mfma_f32_16x16x32_bf16 v[184:187], a[128:131], v[96:99], v[68:71]
 v_exp_f32 v5, v153
 v_mfma_f32_16x16x32_bf16 v[192:195], a[128:131], v[112:115], v[72:75]
 s_waitcnt vmcnt(18)
 ds_read_b128 a[176:179], v3 offset:12288
 v_cvt_pk_bf16_f32 v212, v4, v5
 v_mfma_f32_16x16x32_bf16 v[200:203], a[128:131], v[128:131], v[76:79]
 s_barrier
 ds_read_b128 a[180:183], v3 offset:13312
 v_or3_b32 v12, v12, v219, v212
 v_mfma_f32_16x16x32_bf16 v[176:179], a[132:135], v[84:87], v[176:179]
 s_mov_b32 m0, s40
 v_exp_f32 v6, v154
 v_mfma_f32_16x16x32_bf16 v[184:187], a[132:135], v[100:103], v[184:187]
 s_add_u32 s43, s38, s49
 v_exp_f32 v7, v155
 v_mfma_f32_16x16x32_bf16 v[192:195], a[132:135], v[116:119], v[192:195]
 v_exp_f32 v8, v156
 v_mfma_f32_16x16x32_bf16 v[200:203], a[132:135], v[132:135], v[200:203]
 ds_read_b128 a[184:187], v3 offset:14336
 v_cvt_pk_bf16_f32 v213, v6, v7
 v_mfma_f32_16x16x32_bf16 v[176:179], a[136:139], v[88:91], v[176:179]
 v_exp_f32 v9, v157
 v_mfma_f32_16x16x32_bf16 v[184:187], a[136:139], v[104:107], v[184:187]
 v_exp_f32 v10, v158
 v_mfma_f32_16x16x32_bf16 v[192:195], a[136:139], v[120:123], v[192:195]
 v_exp_f32 v11, v159
 v_mfma_f32_16x16x32_bf16 v[200:203], a[136:139], v[136:139], v[200:203]
 ds_read_b128 a[188:191], v3 offset:15360
 v_cvt_pk_bf16_f32 v214, v8, v9
 v_mfma_f32_16x16x32_bf16 v[176:179], a[140:143], v[92:95], v[176:179]
 v_or3_b32 v12, v12, v213, v214
 v_cvt_pk_bf16_f32 v215, v10, v11
 v_mfma_f32_16x16x32_bf16 v[184:187], a[140:143], v[108:111], v[184:187]
 v_add_f32 v144, v48, v144
 v_add_f32 v145, v49, v145
 v_mfma_f32_16x16x32_bf16 v[192:195], a[140:143], v[124:127], v[192:195]
 v_add_f32 v146, v50, v146
 v_add_f32 v147, v51, v147
 v_mfma_f32_16x16x32_bf16 v[200:203], a[140:143], v[140:143], v[200:203]
 s_waitcnt lgkmcnt(8)
 v_add_f32 v148, v52, v148
 v_add_f32 v149, v53, v149
 v_mfma_f32_16x16x32_bf16 v[180:183], a[144:147], v[80:83], v[64:67]
 v_add_f32 v150, v54, v150
 v_add_f32 v151, v55, v151
 v_mfma_f32_16x16x32_bf16 v[188:191], a[144:147], v[96:99], v[68:71]
 v_exp_f32 v4, v144
 v_mfma_f32_16x16x32_bf16 v[196:199], a[144:147], v[112:115], v[72:75]
 v_exp_f32 v5, v145
 v_mfma_f32_16x16x32_bf16 v[204:207], a[144:147], v[128:131], v[76:79]
 v_exp_f32 v6, v146
 v_mfma_f32_16x16x32_bf16 v[180:183], a[148:151], v[84:87], v[180:183]
 buffer_load_dword v13, v19, s[8:11], s46 offen
 v_mfma_f32_16x16x32_bf16 v[188:191], a[148:151], v[100:103], v[188:191]
 v_exp_f32 v7, v147
 v_mfma_f32_16x16x32_bf16 v[196:199], a[148:151], v[116:119], v[196:199]
 v_exp_f32 v8, v148
 v_mfma_f32_16x16x32_bf16 v[204:207], a[148:151], v[132:135], v[204:207]
 v_exp_f32 v9, v149
 v_mfma_f32_16x16x32_bf16 v[180:183], a[152:155], v[88:91], v[180:183]
 v_exp_f32 v10, v150
 v_mfma_f32_16x16x32_bf16 v[188:191], a[152:155], v[104:107], v[188:191]
 v_exp_f32 v11, v151
 v_mfma_f32_16x16x32_bf16 v[196:199], a[152:155], v[120:123], v[196:199]
 v_cvt_pk_bf16_f32 v208, v4, v5
 v_or3_b32 v12, v12, v215, v208
 v_mfma_f32_16x16x32_bf16 v[204:207], a[152:155], v[136:139], v[204:207]
 v_cvt_pk_bf16_f32 v209, v6, v7
 v_cvt_pk_bf16_f32 v210, v8, v9
 v_mfma_f32_16x16x32_bf16 v[180:183], a[156:159], v[92:95], v[180:183]
 v_or3_b32 v12, v12, v209, v210
 v_cvt_pk_bf16_f32 v211, v10, v11
 v_mfma_f32_16x16x32_bf16 v[188:191], a[156:159], v[108:111], v[188:191]
 v_bitop3_b32 v12, v12, v211, s42 bitop3:0xa8
 v_cmp_ne_u32 vcc, 0, v12
 v_mfma_f32_16x16x32_bf16 v[196:199], a[156:159], v[124:127], v[196:199]
 s_waitcnt lgkmcnt(4)
 ds_read_b128 a[128:131], v2 offset:0
 v_mfma_f32_16x16x32_bf16 v[204:207], a[156:159], v[140:143], v[204:207]
 s_cbranch_vccnz L_b4e_r0
L_b4e_r0_ret:
 ds_read_b128 a[132:135], v2 offset:1024
 v_mfma_f32_16x16x32_bf16 a[0:3], a[160:163], v[208:211], a[0:3]
 ds_read_b128 a[136:139], v2 offset:2048
 v_mfma_f32_16x16x32_bf16 a[32:35], a[160:163], v[212:215], a[32:35]
 ds_read_b128 a[140:143], v2 offset:3072
 ds_read_b128 a[144:147], v2 offset:4096
 v_mfma_f32_16x16x32_bf16 a[64:67], a[160:163], v[216:219], a[64:67]
 buffer_load_dwordx4 v16, s[12:15], s38 offen offset:0 sc1 lds
 v_mfma_f32_16x16x32_bf16 a[96:99], a[160:163], v[220:223], a[96:99]
 ds_read_b128 a[148:151], v2 offset:5120
 v_mfma_f32_16x16x32_bf16 a[4:7], a[164:167], v[208:211], a[4:7]
 v_exp_f32 v4, v200
 v_mfma_f32_16x16x32_bf16 a[36:39], a[164:167], v[212:215], a[36:39]
 ds_read_b128 a[152:155], v2 offset:6144
 v_mfma_f32_16x16x32_bf16 a[68:71], a[164:167], v[216:219], a[68:71]
 ds_read_b128 a[156:159], v2 offset:7168
 v_mfma_f32_16x16x32_bf16 a[100:103], a[164:167], v[220:223], a[100:103]
 ds_read_b128 a[160:163], v3 offset:24576
 v_mfma_f32_16x16x32_bf16 a[8:11], a[168:171], v[208:211], a[8:11]
 v_exp_f32 v5, v201
 v_mfma_f32_16x16x32_bf16 a[40:43], a[168:171], v[212:215], a[40:43]
 v_exp_f32 v6, v202
 v_mfma_f32_16x16x32_bf16 a[72:75], a[168:171], v[216:219], a[72:75]
 v_exp_f32 v7, v203
 v_mfma_f32_16x16x32_bf16 a[104:107], a[168:171], v[220:223], a[104:107]
 ds_read_b128 a[164:167], v3 offset:25600
 v_cvt_pk_bf16_f32 v236, v4, v5
 v_mfma_f32_16x16x32_bf16 a[12:15], a[172:175], v[208:211], a[12:15]
 v_exp_f32 v8, v204
 v_mfma_f32_16x16x32_bf16 a[44:47], a[172:175], v[212:215], a[44:47]
 v_exp_f32 v9, v205
 v_mfma_f32_16x16x32_bf16 a[76:79], a[172:175], v[216:219], a[76:79]
 ds_read_b128 a[168:171], v3 offset:26624
 v_cvt_pk_bf16_f32 v237, v6, v7
 v_mfma_f32_16x16x32_bf16 a[108:111], a[172:175], v[220:223], a[108:111]
 s_waitcnt lgkmcnt(11)
 ds_read_b128 a[172:175], v3 offset:27648
 v_cvt_pk_bf16_f32 v238, v8, v9
 v_mfma_f32_16x16x32_bf16 a[16:19], a[176:179], v[208:211], a[16:19]
 buffer_load_dwordx4 v16, s[12:15], s38 offen offset:1024 sc1 lds
 v_mfma_f32_16x16x32_bf16 a[48:51], a[176:179], v[212:215], a[48:51]
 v_exp_f32 v10, v206
 v_mfma_f32_16x16x32_bf16 a[80:83], a[176:179], v[216:219], a[80:83]
 v_exp_f32 v11, v207
 v_mfma_f32_16x16x32_bf16 a[112:115], a[176:179], v[220:223], a[112:115]
 ds_read_b128 a[176:179], v3 offset:28672
 v_or3_b32 v12, v236, v237, v238
 v_mfma_f32_16x16x32_bf16 a[20:23], a[180:183], v[208:211], a[20:23]
 v_exp_f32 v4, v192
 v_mfma_f32_16x16x32_bf16 a[52:55], a[180:183], v[212:215], a[52:55]
 v_exp_f32 v5, v193
 v_mfma_f32_16x16x32_bf16 a[84:87], a[180:183], v[216:219], a[84:87]
 v_exp_f32 v6, v194
 v_mfma_f32_16x16x32_bf16 a[116:119], a[180:183], v[220:223], a[116:119]
 ds_read_b128 a[180:183], v3 offset:29696
 v_cvt_pk_bf16_f32 v239, v10, v11
 v_mfma_f32_16x16x32_bf16 a[24:27], a[184:187], v[208:211], a[24:27]
 v_exp_f32 v7, v195
 v_mfma_f32_16x16x32_bf16 a[56:59], a[184:187], v[212:215], a[56:59]
 v_exp_f32 v8, v196
 v_mfma_f32_16x16x32_bf16 a[88:91], a[184:187], v[216:219], a[88:91]
 v_exp_f32 v9, v197
 v_mfma_f32_16x16x32_bf16 a[120:123], a[184:187], v[220:223], a[120:123]
 ds_read_b128 a[184:187], v3 offset:30720
 v_cvt_pk_bf16_f32 v232, v4, v5
 v_mfma_f32_16x16x32_bf16 a[28:31], a[188:191], v[208:211], a[28:31]
 v_exp_f32 v10, v198
 v_mfma_f32_16x16x32_bf16 a[60:63], a[188:191], v[212:215], a[60:63]
 v_exp_f32 v11, v199
 v_mfma_f32_16x16x32_bf16 a[92:95], a[188:191], v[216:219], a[92:95]
 buffer_load_dwordx4 v16, s[12:15], s38 offen offset:2048 sc1 lds
 v_mfma_f32_16x16x32_bf16 a[124:127], a[188:191], v[220:223], a[124:127]
 ds_read_b128 a[188:191], v3 offset:31744
 v_or3_b32 v12, v12, v239, v232
 v_mfma_f32_16x16x32_bf16 v[240:243], v[24:27], v[208:211], v[240:243]
 v_exp_f32 v4, v184
 v_mfma_f32_16x16x32_bf16 v[244:247], v[24:27], v[212:215], v[244:247]
 v_exp_f32 v5, v185
 v_mfma_f32_16x16x32_bf16 v[248:251], v[24:27], v[216:219], v[248:251]
 v_cvt_pk_bf16_f32 v233, v6, v7
 v_cvt_pk_bf16_f32 v234, v8, v9
 v_mfma_f32_16x16x32_bf16 v[252:255], v[24:27], v[220:223], v[252:255]
 s_waitcnt lgkmcnt(12)
 v_exp_f32 v6, v186
 v_mfma_f32_16x16x32_bf16 v[144:147], a[128:131], v[80:83], v[64:67]
 v_exp_f32 v7, v187
 v_mfma_f32_16x16x32_bf16 v[152:155], a[128:131], v[96:99], v[68:71]
 v_exp_f32 v8, v188
 v_mfma_f32_16x16x32_bf16 v[160:163], a[128:131], v[112:115], v[72:75]
 v_exp_f32 v9, v189
 v_mfma_f32_16x16x32_bf16 v[168:171], a[128:131], v[128:131], v[76:79]
 ds_read_b128 a[128:131], v2 offset:16384
 v_or3_b32 v12, v12, v233, v234
 v_mfma_f32_16x16x32_bf16 v[144:147], a[132:135], v[84:87], v[144:147]
 v_cvt_pk_bf16_f32 v235, v10, v11
 v_cvt_pk_bf16_f32 v228, v4, v5
 v_mfma_f32_16x16x32_bf16 v[152:155], a[132:135], v[100:103], v[152:155]
 v_exp_f32 v10, v190
 v_mfma_f32_16x16x32_bf16 v[160:163], a[132:135], v[116:119], v[160:163]
 v_exp_f32 v11, v191
 v_mfma_f32_16x16x32_bf16 v[168:171], a[132:135], v[132:135], v[168:171]
 ds_read_b128 a[132:135], v2 offset:17408
 v_or3_b32 v12, v12, v235, v228
 v_mfma_f32_16x16x32_bf16 v[144:147], a[136:139], v[88:91], v[144:147]
 v_cvt_pk_bf16_f32 v229, v6, v7
 v_cvt_pk_bf16_f32 v230, v8, v9
 v_mfma_f32_16x16x32_bf16 v[152:155], a[136:139], v[104:107], v[152:155]
 buffer_load_dwordx4 v16, s[12:15], s38 offen offset:3072 sc1 lds
 v_mfma_f32_16x16x32_bf16 v[160:163], a[136:139], v[120:123], v[160:163]
 s_mov_b32 m0, s41
 v_or3_b32 v12, v12, v229, v230
 v_cvt_pk_bf16_f32 v231, v10, v11
 v_mfma_f32_16x16x32_bf16 v[168:171], a[136:139], v[136:139], v[168:171]
 ds_read_b128 a[136:139], v2 offset:18432
 v_add_f32 v176, v56, v176
 v_mfma_f32_16x16x32_bf16 v[144:147], a[140:143], v[92:95], v[144:147]
 v_add_f32 v177, v57, v177
 v_add_f32 v178, v58, v178
 v_mfma_f32_16x16x32_bf16 v[152:155], a[140:143], v[108:111], v[152:155]
 v_add_f32 v179, v59, v179
 v_add_f32 v180, v60, v180
 v_mfma_f32_16x16x32_bf16 v[160:163], a[140:143], v[124:127], v[160:163]
 v_add_f32 v181, v61, v181
 v_add_f32 v182, v62, v182
 v_mfma_f32_16x16x32_bf16 v[168:171], a[140:143], v[140:143], v[168:171]
 s_waitcnt lgkmcnt(11)
 ds_read_b128 a[140:143], v2 offset:19456
 v_add_f32 v183, v63, v183
 v_mfma_f32_16x16x32_bf16 v[148:151], a[144:147], v[80:83], v[64:67]
 v_exp_f32 v4, v176
 v_mfma_f32_16x16x32_bf16 v[156:159], a[144:147], v[96:99], v[68:71]
 v_exp_f32 v5, v177
 v_mfma_f32_16x16x32_bf16 v[164:167], a[144:147], v[112:115], v[72:75]
 v_exp_f32 v6, v178
 v_mfma_f32_16x16x32_bf16 v[172:175], a[144:147], v[128:131], v[76:79]
 ds_read_b128 a[144:147], v2 offset:20480
 v_cvt_pk_bf16_f32 v224, v4, v5
 v_mfma_f32_16x16x32_bf16 v[148:151], a[148:151], v[84:87], v[148:151]
 v_exp_f32 v7, v179
 v_mfma_f32_16x16x32_bf16 v[156:159], a[148:151], v[100:103], v[156:159]
 v_exp_f32 v8, v180
 v_mfma_f32_16x16x32_bf16 v[164:167], a[148:151], v[116:119], v[164:167]
 buffer_load_dwordx4 v16, s[12:15], s43 offen offset:0 sc1 lds
 v_mfma_f32_16x16x32_bf16 v[172:175], a[148:151], v[132:135], v[172:175]
 ds_read_b128 a[148:151], v2 offset:21504
 v_or3_b32 v12, v12, v231, v224
 v_mfma_f32_16x16x32_bf16 v[148:151], a[152:155], v[88:91], v[148:151]
 v_exp_f32 v9, v181
 v_mfma_f32_16x16x32_bf16 v[156:159], a[152:155], v[104:107], v[156:159]
 v_exp_f32 v10, v182
 v_mfma_f32_16x16x32_bf16 v[164:167], a[152:155], v[120:123], v[164:167]
 v_exp_f32 v11, v183
 v_mfma_f32_16x16x32_bf16 v[172:175], a[152:155], v[136:139], v[172:175]
 v_cvt_pk_bf16_f32 v225, v6, v7
 v_cvt_pk_bf16_f32 v226, v8, v9
 v_mfma_f32_16x16x32_bf16 v[148:151], a[156:159], v[92:95], v[148:151]
 v_or3_b32 v12, v12, v225, v226
 v_cvt_pk_bf16_f32 v227, v10, v11
 v_mfma_f32_16x16x32_bf16 v[156:159], a[156:159], v[108:111], v[156:159]
 v_bitop3_b32 v12, v12, v227, s42 bitop3:0xa8
 v_cmp_ne_u32 vcc, 0, v12
 v_mfma_f32_16x16x32_bf16 v[164:167], a[156:159], v[124:127], v[164:167]
 s_waitcnt lgkmcnt(10)
 ds_read_b128 a[152:155], v2 offset:22528
 v_mfma_f32_16x16x32_bf16 v[172:175], a[156:159], v[140:143], v[172:175]
 s_cbranch_vccnz L_b4e_r1
L_b4e_r1_ret:
 ds_read_b128 a[156:159], v2 offset:23552
 v_mfma_f32_16x16x32_bf16 a[0:3], a[160:163], v[224:227], a[0:3]
 v_mfma_f32_16x16x32_bf16 a[32:35], a[160:163], v[228:231], a[32:35]
 s_add_u32 s38, s38, s44
 v_mfma_f32_16x16x32_bf16 a[64:67], a[160:163], v[232:235], a[64:67]
 s_add_u32 s40, s39, s59
 v_mfma_f32_16x16x32_bf16 a[96:99], a[160:163], v[236:239], a[96:99]
 s_add_u32 s41, s40, s50
 ds_read_b128 a[160:163], v2 offset:8192
 v_mfma_f32_16x16x32_bf16 a[4:7], a[164:167], v[224:227], a[4:7]
 s_mov_b32 s39, s45
 v_mfma_f32_16x16x32_bf16 a[36:39], a[164:167], v[228:231], a[36:39]
 buffer_load_dwordx4 v16, s[12:15], s43 offen offset:1024 sc1 lds
 v_mfma_f32_16x16x32_bf16 a[68:71], a[164:167], v[232:235], a[68:71]
 s_add_u32 s59, s59, s48
 v_mfma_f32_16x16x32_bf16 a[100:103], a[164:167], v[236:239], a[100:103]
 s_add_u32 s45, s45, 32768
 ds_read_b128 a[164:167], v2 offset:9216
 v_mfma_f32_16x16x32_bf16 a[8:11], a[168:171], v[224:227], a[8:11]
 s_cmp_eq_u32 s45, 163840
 v_mfma_f32_16x16x32_bf16 a[40:43], a[168:171], v[228:231], a[40:43]
 s_cselect_b32 s45, 0, s45
 v_mfma_f32_16x16x32_bf16 a[72:75], a[168:171], v[232:235], a[72:75]
 s_add_u32 s46, s46, 1048576
 v_exp_f32 v4, v168
 v_mfma_f32_16x16x32_bf16 a[104:107], a[168:171], v[236:239], a[104:107]
 ds_read_b128 a[168:171], v2 offset:10240
 v_mfma_f32_16x16x32_bf16 a[12:15], a[172:175], v[224:227], a[12:15]
 v_exp_f32 v5, v169
 v_mfma_f32_16x16x32_bf16 a[44:47], a[172:175], v[228:231], a[44:47]
 v_exp_f32 v6, v170
 v_mfma_f32_16x16x32_bf16 a[76:79], a[172:175], v[232:235], a[76:79]
 v_exp_f32 v7, v171
 v_mfma_f32_16x16x32_bf16 a[108:111], a[172:175], v[236:239], a[108:111]
 s_waitcnt lgkmcnt(11)
 ds_read_b128 a[172:175], v2 offset:11264
 v_cvt_pk_bf16_f32 v220, v4, v5
 v_mfma_f32_16x16x32_bf16 a[16:19], a[176:179], v[224:227], a[16:19]
 v_exp_f32 v8, v172
 v_mfma_f32_16x16x32_bf16 a[48:51], a[176:179], v[228:231], a[48:51]
 v_exp_f32 v9, v173
 v_mfma_f32_16x16x32_bf16 a[80:83], a[176:179], v[232:235], a[80:83]
 v_exp_f32 v10, v174
 v_mfma_f32_16x16x32_bf16 a[112:115], a[176:179], v[236:239], a[112:115]
 buffer_load_dwordx4 v16, s[12:15], s43 offen offset:2048 sc1 lds
 v_mfma_f32_16x16x32_bf16 a[20:23], a[180:183], v[224:227], a[20:23]
 v_exp_f32 v11, v175
 v_mfma_f32_16x16x32_bf16 a[52:55], a[180:183], v[228:231], a[52:55]
 v_exp_f32 v4, v160
 v_mfma_f32_16x16x32_bf16 a[84:87], a[180:183], v[232:235], a[84:87]
 v_exp_f32 v5, v161
 v_mfma_f32_16x16x32_bf16 a[116:119], a[180:183], v[236:239], a[116:119]
 v_cvt_pk_bf16_f32 v221, v6, v7
 v_cvt_pk_bf16_f32 v222, v8, v9
 v_mfma_f32_16x16x32_bf16 a[24:27], a[184:187], v[224:227], a[24:27]
 v_exp_f32 v6, v162
 v_mfma_f32_16x16x32_bf16 a[56:59], a[184:187], v[228:231], a[56:59]
 v_exp_f32 v7, v163
 v_mfma_f32_16x16x32_bf16 a[88:91], a[184:187], v[232:235], a[88:91]
 v_exp_f32 v8, v164
 v_mfma_f32_16x16x32_bf16 a[120:123], a[184:187], v[236:239], a[120:123]
 v_exp_f32 v9, v165
 v_mfma_f32_16x16x32_bf16 a[28:31], a[188:191], v[224:227], a[28:31]
 v_or3_b32 v12, v220, v221, v222
 v_cvt_pk_bf16_f32 v223, v10, v11
 v_mfma_f32_16x16x32_bf16 a[60:63], a[188:191], v[228:231], a[60:63]
 v_exp_f32 v10, v166
 v_mfma_f32_16x16x32_bf16 a[92:95], a[188:191], v[232:235], a[92:95]
 v_exp_f32 v11, v167
 v_mfma_f32_16x16x32_bf16 a[124:127], a[188:191], v[236:239], a[124:127]
 v_cvt_pk_bf16_f32 v216, v4, v5
 v_or3_b32 v12, v12, v223, v216
 v_mfma_f32_16x16x32_bf16 v[240:243], v[24:27], v[224:227], v[240:243]
 v_cvt_pk_bf16_f32 v217, v6, v7
 v_cvt_pk_bf16_f32 v218, v8, v9
 v_mfma_f32_16x16x32_bf16 v[244:247], v[24:27], v[228:231], v[244:247]
 v_or3_b32 v12, v12, v217, v218
 v_cvt_pk_bf16_f32 v219, v10, v11
 v_mfma_f32_16x16x32_bf16 v[248:251], v[24:27], v[232:235], v[248:251]
 buffer_load_dwordx4 v16, s[12:15], s43 offen offset:3072 sc1 lds
 v_mfma_f32_16x16x32_bf16 v[252:255], v[24:27], v[236:239], v[252:255]
 s_waitcnt lgkmcnt(8)
 v_mov_b32 v3, v2
 v_add_u32 v2, s45, v16
 s_add_u32 s24, s94, 67108864
 s_addc_u32 s25, s95, 0
 s_mov_b32 s26, 16777216
 s_lshl_b32 s46, s2, 2
 s_add_u32 s46, s46, s32
 s_lshl_b32 s46, s46, 14
 s_add_u32 s46, s46, 8192
 s_nop 4
 v_accvgpr_read_b32 v36, a0
 v_accvgpr_read_b32 v37, a1
 v_accvgpr_read_b32 v38, a2
 v_accvgpr_read_b32 v39, a3
 v_accvgpr_read_b32 v40, a4
 v_accvgpr_read_b32 v41, a5
 v_accvgpr_read_b32 v42, a6
 v_accvgpr_read_b32 v43, a7
 v_rcp_f32 v32, v240
 s_nop 0
 v_pk_mul_f32 v[36:37], v[36:37], v[32:33] op_sel_hi:[1,0]
 v_pk_mul_f32 v[38:39], v[38:39], v[32:33] op_sel_hi:[1,0]
 v_pk_mul_f32 v[40:41], v[40:41], v[32:33] op_sel_hi:[1,0]
 v_pk_mul_f32 v[42:43], v[42:43], v[32:33] op_sel_hi:[1,0]
 v_cvt_pk_bf16_f32 v44, v36, v37
 v_cvt_pk_bf16_f32 v45, v38, v39
 v_cvt_pk_bf16_f32 v46, v40, v41
 v_cvt_pk_bf16_f32 v47, v42, v43
 buffer_store_dwordx4 v[44:47], v16, s[16:19], s60 offen offset:0 sc1
 v_accvgpr_read_b32 v36, a8
 v_accvgpr_read_b32 v37, a9
 v_accvgpr_read_b32 v38, a10
 v_accvgpr_read_b32 v39, a11
 v_accvgpr_read_b32 v40, a12
 v_accvgpr_read_b32 v41, a13
 v_accvgpr_read_b32 v42, a14
 v_accvgpr_read_b32 v43, a15
 v_pk_mul_f32 v[36:37], v[36:37], v[32:33] op_sel_hi:[1,0]
 v_pk_mul_f32 v[38:39], v[38:39], v[32:33] op_sel_hi:[1,0]
 v_pk_mul_f32 v[40:41], v[40:41], v[32:33] op_sel_hi:[1,0]
 v_pk_mul_f32 v[42:43], v[42:43], v[32:33] op_sel_hi:[1,0]
 v_cvt_pk_bf16_f32 v20, v36, v37
 v_cvt_pk_bf16_f32 v21, v38, v39
 v_cvt_pk_bf16_f32 v22, v40, v41
 v_cvt_pk_bf16_f32 v23, v42, v43
 buffer_store_dwordx4 v[20:23], v16, s[16:19], s60 offen offset:1024 sc1
 v_accvgpr_read_b32 v36, a16
 v_accvgpr_read_b32 v37, a17
 v_accvgpr_read_b32 v38, a18
 v_accvgpr_read_b32 v39, a19
 v_accvgpr_read_b32 v40, a20
 v_accvgpr_read_b32 v41, a21
 v_accvgpr_read_b32 v42, a22
 v_accvgpr_read_b32 v43, a23
 v_pk_mul_f32 v[36:37], v[36:37], v[32:33] op_sel_hi:[1,0]
 v_pk_mul_f32 v[38:39], v[38:39], v[32:33] op_sel_hi:[1,0]
 v_pk_mul_f32 v[40:41], v[40:41], v[32:33] op_sel_hi:[1,0]
 v_pk_mul_f32 v[42:43], v[42:43], v[32:33] op_sel_hi:[1,0]
 v_cvt_pk_bf16_f32 v44, v36, v37
 v_cvt_pk_bf16_f32 v45, v38, v39
 v_cvt_pk_bf16_f32 v46, v40, v41
 v_cvt_pk_bf16_f32 v47, v42, v43
 buffer_store_dwordx4 v[44:47], v16, s[16:19], s60 offen offset:2048 sc1
 v_accvgpr_read_b32 v36, a24
 v_accvgpr_read_b32 v37, a25
 v_accvgpr_read_b32 v38, a26
 v_accvgpr_read_b32 v39, a27
 v_accvgpr_read_b32 v40, a28
 v_accvgpr_read_b32 v41, a29
 v_accvgpr_read_b32 v42, a30
 v_accvgpr_read_b32 v43, a31
 v_pk_mul_f32 v[36:37], v[36:37], v[32:33] op_sel_hi:[1,0]
 v_pk_mul_f32 v[38:39], v[38:39], v[32:33] op_sel_hi:[1,0]
 v_pk_mul_f32 v[40:41], v[40:41], v[32:33] op_sel_hi:[1,0]
 v_pk_mul_f32 v[42:43], v[42:43], v[32:33] op_sel_hi:[1,0]
 v_cvt_pk_bf16_f32 v20, v36, v37
 v_cvt_pk_bf16_f32 v21, v38, v39
 v_cvt_pk_bf16_f32 v22, v40, v41
 v_cvt_pk_bf16_f32 v23, v42, v43
 buffer_store_dwordx4 v[20:23], v16, s[16:19], s60 offen offset:3072 sc1
 s_waitcnt vmcnt(12)
 v_and_b32 v17, v28, v29
 v_and_b32 v18, v30, v31
 v_and_b32 v17, v17, v18
 v_cmp_ne_u32 vcc, 1, v17
 s_nop 0
 s_cbranch_vccnz L_spin_all
L_spin_all_ret:
 v_mfma_f32_16x16x32_bf16 v[184:187], a[128:131], v[96:99], v[68:71]
 ds_read_b128 a[176:179], v3 offset:12288
 ds_read_b128 a[180:183], v3 offset:13312
 v_mfma_f32_16x16x32_bf16 v[192:195], a[128:131], v[112:115], v[72:75]
 v_mov_b32 v20, -1
 v_mov_b32 v21, -1
 v_mfma_f32_16x16x32_bf16 v[200:203], a[128:131], v[128:131], v[76:79]
 s_waitcnt vmcnt(16)
 ds_read_b128 a[184:187], v3 offset:14336
 v_mov_b32 v22, -1
 v_mfma_f32_16x16x32_bf16 v[184:187], a[132:135], v[100:103], v[184:187]
 s_barrier
 ds_read_b128 a[188:191], v3 offset:15360
 v_mov_b32 v23, -1
 v_mfma_f32_16x16x32_bf16 v[192:195], a[132:135], v[116:119], v[192:195]
 s_mov_b32 m0, s40
 v_add_f32 v152, v48, v152
 v_add_f32 v153, v49, v153
 v_mfma_f32_16x16x32_bf16 v[200:203], a[132:135], v[132:135], v[200:203]
 s_add_u32 s43, s38, s49
 v_add_f32 v154, v50, v154
 v_add_f32 v155, v51, v155
 v_mfma_f32_16x16x32_bf16 v[184:187], a[136:139], v[104:107], v[184:187]
 v_add_f32 v156, v52, v156
 v_add_f32 v157, v53, v157
 v_mfma_f32_16x16x32_bf16 v[192:195], a[136:139], v[120:123], v[192:195]
 v_add_f32 v158, v54, v158
 v_add_f32 v159, v55, v159
 v_mfma_f32_16x16x32_bf16 v[200:203], a[136:139], v[136:139], v[200:203]
 v_exp_f32 v4, v152
 v_mfma_f32_16x16x32_bf16 v[184:187], a[140:143], v[108:111], v[184:187]
 v_exp_f32 v5, v153
 v_mfma_f32_16x16x32_bf16 v[192:195], a[140:143], v[124:127], v[192:195]
 v_exp_f32 v6, v154
 v_mfma_f32_16x16x32_bf16 v[200:203], a[140:143], v[140:143], v[200:203]
 s_waitcnt lgkmcnt(8)
 v_exp_f32 v7, v155
 v_mfma_f32_16x16x32_bf16 v[188:191], a[144:147], v[96:99], v[68:71]
 v_exp_f32 v8, v156
 v_mfma_f32_16x16x32_bf16 v[196:199], a[144:147], v[112:115], v[72:75]
 buffer_store_dwordx4 v[20:23], v16, s[24:27], s46 offen offset:0 sc1
 v_mfma_f32_16x16x32_bf16 v[204:207], a[144:147], v[128:131], v[76:79]
 v_exp_f32 v9, v157
 v_mfma_f32_16x16x32_bf16 v[188:191], a[148:151], v[100:103], v[188:191]
 v_exp_f32 v10, v158
 v_mfma_f32_16x16x32_bf16 v[196:199], a[148:151], v[116:119], v[196:199]
 v_exp_f32 v11, v159
 v_mfma_f32_16x16x32_bf16 v[204:207], a[148:151], v[132:135], v[204:207]
 v_cvt_pk_bf16_f32 v212, v4, v5
 v_or3_b32 v12, v12, v219, v212
 v_mfma_f32_16x16x32_bf16 v[188:191], a[152:155], v[104:107], v[188:191]
 v_cvt_pk_bf16_f32 v213, v6, v7
 v_cvt_pk_bf16_f32 v214, v8, v9
 v_mfma_f32_16x16x32_bf16 v[196:199], a[152:155], v[120:123], v[196:199]
 v_or3_b32 v12, v12, v213, v214
 v_cvt_pk_bf16_f32 v215, v10, v11
 v_mfma_f32_16x16x32_bf16 v[204:207], a[152:155], v[136:139], v[204:207]
 v_bitop3_b32 v12, v12, v215, s42 bitop3:0xa8
 v_cmp_ne_u32 vcc, 0, v12
 v_mfma_f32_16x16x32_bf16 v[188:191], a[156:159], v[108:111], v[188:191]
 buffer_store_dwordx4 v[20:23], v16, s[24:27], s46 offen offset:1024 sc1
 v_mfma_f32_16x16x32_bf16 v[196:199], a[156:159], v[124:127], v[196:199]
 s_waitcnt lgkmcnt(4)
 ds_read_b128 a[128:131], v2 offset:0
 ds_read_b128 a[132:135], v2 offset:1024
 v_mfma_f32_16x16x32_bf16 v[204:207], a[156:159], v[140:143], v[204:207]
 s_cbranch_vccnz L_b3_r0
L_b3_r0_ret:
 ds_read_b128 a[136:139], v2 offset:2048
 ds_read_b128 a[140:143], v2 offset:3072
 v_mfma_f32_16x16x32_bf16 a[32:35], a[160:163], v[212:215], a[32:35]
 ds_read_b128 a[144:147], v2 offset:4096
 ds_read_b128 a[148:151], v2 offset:5120
 v_mfma_f32_16x16x32_bf16 a[64:67], a[160:163], v[216:219], a[64:67]
 ds_read_b128 a[152:155], v2 offset:6144
 ds_read_b128 a[156:159], v2 offset:7168
 v_mfma_f32_16x16x32_bf16 a[96:99], a[160:163], v[220:223], a[96:99]
 v_exp_f32 v4, v200
 v_mfma_f32_16x16x32_bf16 a[36:39], a[164:167], v[212:215], a[36:39]
 v_exp_f32 v5, v201
 v_mfma_f32_16x16x32_bf16 a[68:71], a[164:167], v[216:219], a[68:71]
 v_exp_f32 v6, v202
 v_mfma_f32_16x16x32_bf16 a[100:103], a[164:167], v[220:223], a[100:103]
 buffer_store_dwordx4 v[20:23], v16, s[24:27], s46 offen offset:2048 sc1
 v_mfma_f32_16x16x32_bf16 a[40:43], a[168:171], v[212:215], a[40:43]
 v_exp_f32 v7, v203
 v_mfma_f32_16x16x32_bf16 a[72:75], a[168:171], v[216:219], a[72:75]
 ds_read_b128 a[160:163], v3 offset:24576
 v_cvt_pk_bf16_f32 v236, v4, v5
 v_mfma_f32_16x16x32_bf16 a[104:107], a[168:171], v[220:223], a[104:107]
 v_exp_f32 v8, v204
 v_mfma_f32_16x16x32_bf16 a[44:47], a[172:175], v[212:215], a[44:47]
 v_exp_f32 v9, v205
 v_mfma_f32_16x16x32_bf16 a[76:79], a[172:175], v[216:219], a[76:79]
 ds_read_b128 a[164:167], v3 offset:25600
 v_cvt_pk_bf16_f32 v237, v6, v7
 v_mfma_f32_16x16x32_bf16 a[108:111], a[172:175], v[220:223], a[108:111]
 s_waitcnt lgkmcnt(10)
 ds_read_b128 a[168:171], v3 offset:26624
 v_cvt_pk_bf16_f32 v238, v8, v9
 v_mfma_f32_16x16x32_bf16 a[48:51], a[176:179], v[212:215], a[48:51]
 v_exp_f32 v10, v206
 v_mfma_f32_16x16x32_bf16 a[80:83], a[176:179], v[216:219], a[80:83]
 buffer_store_dwordx4 v[20:23], v16, s[24:27], s46 offen offset:3072 sc1
 v_mfma_f32_16x16x32_bf16 a[112:115], a[176:179], v[220:223], a[112:115]
 v_exp_f32 v11, v207
 v_mfma_f32_16x16x32_bf16 a[52:55], a[180:183], v[212:215], a[52:55]
 ds_read_b128 a[172:175], v3 offset:27648
 v_or3_b32 v12, v236, v237, v238
 v_mfma_f32_16x16x32_bf16 a[84:87], a[180:183], v[216:219], a[84:87]
 v_exp_f32 v4, v192
 v_mfma_f32_16x16x32_bf16 a[116:119], a[180:183], v[220:223], a[116:119]
 v_exp_f32 v5, v193
 v_mfma_f32_16x16x32_bf16 a[56:59], a[184:187], v[212:215], a[56:59]
 ds_read_b128 a[176:179], v3 offset:28672
 v_cvt_pk_bf16_f32 v239, v10, v11
 v_mfma_f32_16x16x32_bf16 a[88:91], a[184:187], v[216:219], a[88:91]
 ds_read_b128 a[180:183], v3 offset:29696
 v_cvt_pk_bf16_f32 v232, v4, v5
 v_mfma_f32_16x16x32_bf16 a[120:123], a[184:187], v[220:223], a[120:123]
 v_exp_f32 v6, v194
 v_mfma_f32_16x16x32_bf16 a[60:63], a[188:191], v[212:215], a[60:63]
 buffer_load_dwordx4 v16, s[12:15], s38 offen offset:0 sc1 lds
 v_mfma_f32_16x16x32_bf16 a[92:95], a[188:191], v[216:219], a[92:95]
 v_exp_f32 v7, v195
 v_mfma_f32_16x16x32_bf16 a[124:127], a[188:191], v[220:223], a[124:127]
 ds_read_b128 a[184:187], v3 offset:30720
 v_or3_b32 v12, v12, v239, v232
 v_mfma_f32_16x16x32_bf16 v[244:247], v[24:27], v[212:215], v[244:247]
 v_exp_f32 v8, v196
 v_mfma_f32_16x16x32_bf16 v[248:251], v[24:27], v[216:219], v[248:251]
 v_exp_f32 v9, v197
 v_mfma_f32_16x16x32_bf16 v[252:255], v[24:27], v[220:223], v[252:255]
L_pad10:
 s_cbranch_execz L_pad18
 s_waitcnt lgkmcnt(11)
 v_exp_f32 v10, v198
 v_mfma_f32_16x16x32_bf16 v[152:155], a[128:131], v[96:99], v[68:71]
 v_exp_f32 v11, v199
 v_mfma_f32_16x16x32_bf16 v[160:163], a[128:131], v[112:115], v[72:75]
 v_cvt_pk_bf16_f32 v233, v6, v7
 v_cvt_pk_bf16_f32 v234, v8, v9
 v_mfma_f32_16x16x32_bf16 v[168:171], a[128:131], v[128:131], v[76:79]
 buffer_load_dwordx4 v16, s[12:15], s38 offen offset:1024 sc1 lds
 v_mfma_f32_16x16x32_bf16 v[152:155], a[132:135], v[100:103], v[152:155]
 v_or3_b32 v12, v12, v233, v234
 v_cvt_pk_bf16_f32 v235, v10, v11
 v_mfma_f32_16x16x32_bf16 v[160:163], a[132:135], v[116:119], v[160:163]
 v_add_f32 v184, v56, v184
 v_add_f32 v185, v57, v185
 v_mfma_f32_16x16x32_bf16 v[168:171], a[132:135], v[132:135], v[168:171]
 v_add_f32 v186, v58, v186
 v_add_f32 v187, v59, v187
 v_mfma_f32_16x16x32_bf16 v[152:155], a[136:139], v[104:107], v[152:155]
 v_add_f32 v188, v60, v188
 v_add_f32 v189, v61, v189
 v_mfma_f32_16x16x32_bf16 v[160:163], a[136:139], v[120:123], v[160:163]
 v_add_f32 v190, v62, v190
 v_add_f32 v191, v63, v191
 v_mfma_f32_16x16x32_bf16 v[168:171], a[136:139], v[136:139], v[168:171]
 v_exp_f32 v4, v184
 v_mfma_f32_16x16x32_bf16 v[152:155], a[140:143], v[108:111], v[152:155]
 buffer_load_dwordx4 v16, s[12:15], s38 offen offset:2048 sc1 lds
 v_mfma_f32_16x16x32_bf16 v[160:163], a[140:143], v[124:127], v[160:163]
 v_exp_f32 v5, v185
 v_mfma_f32_16x16x32_bf16 v[168:171], a[140:143], v[140:143], v[168:171]
 s_waitcnt lgkmcnt(7)
 v_exp_f32 v6, v186
 v_mfma_f32_16x16x32_bf16 v[156:159], a[144:147], v[96:99], v[68:71]
 v_exp_f32 v7, v187
 v_mfma_f32_16x16x32_bf16 v[164:167], a[144:147], v[112:115], v[72:75]
 v_exp_f32 v8, v188
 v_mfma_f32_16x16x32_bf16 v[172:175], a[144:147], v[128:131], v[76:79]
 v_exp_f32 v9, v189
 v_mfma_f32_16x16x32_bf16 v[156:159], a[148:151], v[100:103], v[156:159]
 v_exp_f32 v10, v190
 v_mfma_f32_16x16x32_bf16 v[164:167], a[148:151], v[116:119], v[164:167]
 v_exp_f32 v11, v191
 v_mfma_f32_16x16x32_bf16 v[172:175], a[148:151], v[132:135], v[172:175]
 buffer_load_dwordx4 v16, s[12:15], s38 offen offset:3072 sc1 lds
 v_mfma_f32_16x16x32_bf16 v[156:159], a[152:155], v[104:107], v[156:159]
 s_mov_b32 m0, s41
 v_cvt_pk_bf16_f32 v228, v4, v5
 v_or3_b32 v12, v12, v235, v228
 v_mfma_f32_16x16x32_bf16 v[164:167], a[152:155], v[120:123], v[164:167]
 v_cvt_pk_bf16_f32 v229, v6, v7
 v_cvt_pk_bf16_f32 v230, v8, v9
 v_mfma_f32_16x16x32_bf16 v[172:175], a[152:155], v[136:139], v[172:175]
 v_or3_b32 v12, v12, v229, v230
 v_cvt_pk_bf16_f32 v231, v10, v11
 v_mfma_f32_16x16x32_bf16 v[156:159], a[156:159], v[108:111], v[156:159]
 v_bitop3_b32 v12, v12, v231, s42 bitop3:0xa8
 v_cmp_ne_u32 vcc, 0, v12
 v_mfma_f32_16x16x32_bf16 v[164:167], a[156:159], v[124:127], v[164:167]
 s_waitcnt lgkmcnt(3)
 ds_read_b128 a[188:191], v3 offset:31744
 v_mfma_f32_16x16x32_bf16 v[172:175], a[156:159], v[140:143], v[172:175]
 s_cbranch_vccnz L_b3_r1
L_b3_r1_ret:
 ds_read_b128 a[128:131], v2 offset:16384
 v_mfma_f32_16x16x32_bf16 a[32:35], a[160:163], v[228:231], a[32:35]
 ds_read_b128 a[132:135], v2 offset:17408
 v_mfma_f32_16x16x32_bf16 a[64:67], a[160:163], v[232:235], a[64:67]
 buffer_load_dwordx4 v16, s[12:15], s43 offen offset:0 sc1 lds
 v_mfma_f32_16x16x32_bf16 a[96:99], a[160:163], v[236:239], a[96:99]
 s_add_u32 s38, s38, s44
 ds_read_b128 a[136:139], v2 offset:18432
 v_mfma_f32_16x16x32_bf16 a[36:39], a[164:167], v[228:231], a[36:39]
 s_add_u32 s40, s39, s59
 ds_read_b128 a[140:143], v2 offset:19456
 v_mfma_f32_16x16x32_bf16 a[68:71], a[164:167], v[232:235], a[68:71]
 s_add_u32 s41, s40, s50
 ds_read_b128 a[144:147], v2 offset:20480
 v_mfma_f32_16x16x32_bf16 a[100:103], a[164:167], v[236:239], a[100:103]
 s_mov_b32 s39, s45
 ds_read_b128 a[148:151], v2 offset:21504
 v_mfma_f32_16x16x32_bf16 a[40:43], a[168:171], v[228:231], a[40:43]
 s_add_u32 s59, s59, s48
 ds_read_b128 a[152:155], v2 offset:22528
 v_mfma_f32_16x16x32_bf16 a[72:75], a[168:171], v[232:235], a[72:75]
 s_add_u32 s45, s45, 32768
 ds_read_b128 a[156:159], v2 offset:23552
 v_mfma_f32_16x16x32_bf16 a[104:107], a[168:171], v[236:239], a[104:107]
 s_cmp_eq_u32 s45, 163840
 ds_read_b128 a[160:163], v2 offset:8192
 v_mfma_f32_16x16x32_bf16 a[44:47], a[172:175], v[228:231], a[44:47]
 buffer_load_dwordx4 v16, s[12:15], s43 offen offset:1024 sc1 lds
 v_mfma_f32_16x16x32_bf16 a[76:79], a[172:175], v[232:235], a[76:79]
 s_cselect_b32 s45, 0, s45
 ds_read_b128 a[164:167], v2 offset:9216
 v_mfma_f32_16x16x32_bf16 a[108:111], a[172:175], v[236:239], a[108:111]
 s_waitcnt lgkmcnt(10)
 ds_read_b128 a[168:171], v2 offset:10240
 v_mfma_f32_16x16x32_bf16 a[48:51], a[176:179], v[228:231], a[48:51]
 ds_read_b128 a[172:175], v2 offset:11264
 v_mfma_f32_16x16x32_bf16 a[80:83], a[176:179], v[232:235], a[80:83]
 v_exp_f32 v4, v168
 v_mfma_f32_16x16x32_bf16 a[112:115], a[176:179], v[236:239], a[112:115]
 v_exp_f32 v5, v169
 v_mfma_f32_16x16x32_bf16 a[52:55], a[180:183], v[228:231], a[52:55]
 v_exp_f32 v6, v170
 v_mfma_f32_16x16x32_bf16 a[84:87], a[180:183], v[232:235], a[84:87]
 v_exp_f32 v7, v171
 v_mfma_f32_16x16x32_bf16 a[116:119], a[180:183], v[236:239], a[116:119]
 buffer_load_dwordx4 v16, s[12:15], s43 offen offset:2048 sc1 lds
 v_mfma_f32_16x16x32_bf16 a[56:59], a[184:187], v[228:231], a[56:59]
 v_exp_f32 v8, v172
 v_mfma_f32_16x16x32_bf16 a[88:91], a[184:187], v[232:235], a[88:91]
 v_exp_f32 v9, v173
 v_mfma_f32_16x16x32_bf16 a[120:123], a[184:187], v[236:239], a[120:123]
 v_exp_f32 v10, v174
 v_mfma_f32_16x16x32_bf16 a[60:63], a[188:191], v[228:231], a[60:63]
 v_exp_f32 v11, v175
 v_mfma_f32_16x16x32_bf16 a[92:95], a[188:191], v[232:235], a[92:95]
 v_cvt_pk_bf16_f32 v220, v4, v5
 v_mfma_f32_16x16x32_bf16 a[124:127], a[188:191], v[236:239], a[124:127]
 v_cvt_pk_bf16_f32 v221, v6, v7
 v_cvt_pk_bf16_f32 v222, v8, v9
 v_mfma_f32_16x16x32_bf16 v[244:247], v[24:27], v[228:231], v[244:247]
 v_or3_b32 v12, v220, v221, v222
 v_cvt_pk_bf16_f32 v223, v10, v11
 v_mfma_f32_16x16x32_bf16 v[248:251], v[24:27], v[232:235], v[248:251]
 buffer_load_dwordx4 v16, s[12:15], s43 offen offset:3072 sc1 lds
 v_mfma_f32_16x16x32_bf16 v[252:255], v[24:27], v[236:239], v[252:255]
 s_waitcnt lgkmcnt(8)
 v_mov_b32 v3, v2
 v_add_u32 v2, s45, v16
 s_nop 4
 v_accvgpr_read_b32 v36, a32
 v_accvgpr_read_b32 v37, a33
 v_accvgpr_read_b32 v38, a34
 v_accvgpr_read_b32 v39, a35
 v_accvgpr_read_b32 v40, a36
 v_accvgpr_read_b32 v41, a37
 v_accvgpr_read_b32 v42, a38
 v_accvgpr_read_b32 v43, a39
 v_rcp_f32 v32, v244
 s_nop 0
 v_pk_mul_f32 v[36:37], v[36:37], v[32:33] op_sel_hi:[1,0]
 v_pk_mul_f32 v[38:39], v[38:39], v[32:33] op_sel_hi:[1,0]
 v_pk_mul_f32 v[40:41], v[40:41], v[32:33] op_sel_hi:[1,0]
 v_pk_mul_f32 v[42:43], v[42:43], v[32:33] op_sel_hi:[1,0]
 v_cvt_pk_bf16_f32 v44, v36, v37
 v_cvt_pk_bf16_f32 v45, v38, v39
 v_cvt_pk_bf16_f32 v46, v40, v41
 v_cvt_pk_bf16_f32 v47, v42, v43
 buffer_store_dwordx4 v[44:47], v16, s[16:19], s61 offen offset:0 sc1
 v_accvgpr_read_b32 v36, a40
 v_accvgpr_read_b32 v37, a41
 v_accvgpr_read_b32 v38, a42
 v_accvgpr_read_b32 v39, a43
 v_accvgpr_read_b32 v40, a44
 v_accvgpr_read_b32 v41, a45
 v_accvgpr_read_b32 v42, a46
 v_accvgpr_read_b32 v43, a47
 v_pk_mul_f32 v[36:37], v[36:37], v[32:33] op_sel_hi:[1,0]
 v_pk_mul_f32 v[38:39], v[38:39], v[32:33] op_sel_hi:[1,0]
 v_pk_mul_f32 v[40:41], v[40:41], v[32:33] op_sel_hi:[1,0]
 v_pk_mul_f32 v[42:43], v[42:43], v[32:33] op_sel_hi:[1,0]
 v_cvt_pk_bf16_f32 v20, v36, v37
 v_cvt_pk_bf16_f32 v21, v38, v39
 v_cvt_pk_bf16_f32 v22, v40, v41
 v_cvt_pk_bf16_f32 v23, v42, v43
 buffer_store_dwordx4 v[20:23], v16, s[16:19], s61 offen offset:1024 sc1
 v_accvgpr_read_b32 v36, a48
 v_accvgpr_read_b32 v37, a49
 v_accvgpr_read_b32 v38, a50
 v_accvgpr_read_b32 v39, a51
 v_accvgpr_read_b32 v40, a52
 v_accvgpr_read_b32 v41, a53
 v_accvgpr_read_b32 v42, a54
 v_accvgpr_read_b32 v43, a55
 v_pk_mul_f32 v[36:37], v[36:37], v[32:33] op_sel_hi:[1,0]
 v_pk_mul_f32 v[38:39], v[38:39], v[32:33] op_sel_hi:[1,0]
 v_pk_mul_f32 v[40:41], v[40:41], v[32:33] op_sel_hi:[1,0]
 v_pk_mul_f32 v[42:43], v[42:43], v[32:33] op_sel_hi:[1,0]
 v_cvt_pk_bf16_f32 v44, v36, v37
 v_cvt_pk_bf16_f32 v45, v38, v39
 v_cvt_pk_bf16_f32 v46, v40, v41
 v_cvt_pk_bf16_f32 v47, v42, v43
 buffer_store_dwordx4 v[44:47], v16, s[16:19], s61 offen offset:2048 sc1
 v_accvgpr_read_b32 v36, a56
 v_accvgpr_read_b32 v37, a57
 v_accvgpr_read_b32 v38, a58
 v_accvgpr_read_b32 v39, a59
 v_accvgpr_read_b32 v40, a60
 v_accvgpr_read_b32 v41, a61
 v_accvgpr_read_b32 v42, a62
 v_accvgpr_read_b32 v43, a63
 v_pk_mul_f32 v[36:37], v[36:37], v[32:33] op_sel_hi:[1,0]
 v_pk_mul_f32 v[38:39], v[38:39], v[32:33] op_sel_hi:[1,0]
 v_pk_mul_f32 v[40:41], v[40:41], v[32:33] op_sel_hi:[1,0]
 v_pk_mul_f32 v[42:43], v[42:43], v[32:33] op_sel_hi:[1,0]
 v_cvt_pk_bf16_f32 v20, v36, v37
 v_cvt_pk_bf16_f32 v21, v38, v39
 v_cvt_pk_bf16_f32 v22, v40, v41
 v_cvt_pk_bf16_f32 v23, v42, v43
 buffer_store_dwordx4 v[20:23], v16, s[16:19], s61 offen offset:3072 sc1
 s_lshl_b32 s58, s34, 1
 s_mov_b32 s35, 1
 s_sub_u32 s58, 13, s58
 s_cbranch_scc1 L_b2e
 s_nop 0
 s_nop 0
 s_nop 0
L_b2_loop:
 v_mfma_f32_16x16x32_bf16 v[192:195], a[128:131], v[112:115], v[72:75]
 ds_read_b128 a[176:179], v3 offset:12288
 v_exp_f32 v4, v160
 v_mfma_f32_16x16x32_bf16 v[200:203], a[128:131], v[128:131], v[76:79]
 ds_read_b128 a[180:183], v3 offset:13312
 v_exp_f32 v5, v161
 v_mfma_f32_16x16x32_bf16 v[192:195], a[132:135], v[116:119], v[192:195]
 s_waitcnt vmcnt(16)
 ds_read_b128 a[184:187], v3 offset:14336
 v_exp_f32 v6, v162
 v_mfma_f32_16x16x32_bf16 v[200:203], a[132:135], v[132:135], v[200:203]
 s_barrier
 ds_read_b128 a[188:191], v3 offset:15360
 v_cvt_pk_bf16_f32 v216, v4, v5
 v_mfma_f32_16x16x32_bf16 v[192:195], a[136:139], v[120:123], v[192:195]
 s_mov_b32 m0, s40
 v_exp_f32 v7, v163
 v_mfma_f32_16x16x32_bf16 v[200:203], a[136:139], v[136:139], v[200:203]
 s_add_u32 s43, s38, s49
 v_exp_f32 v8, v164
 v_mfma_f32_16x16x32_bf16 v[192:195], a[140:143], v[124:127], v[192:195]
 v_exp_f32 v9, v165
 v_mfma_f32_16x16x32_bf16 v[200:203], a[140:143], v[140:143], v[200:203]
 s_waitcnt lgkmcnt(8)
 ds_read_b128 a[128:131], v2 offset:0
 v_or3_b32 v12, v12, v223, v216
 v_mfma_f32_16x16x32_bf16 v[196:199], a[144:147], v[112:115], v[72:75]
 v_exp_f32 v10, v166
 v_mfma_f32_16x16x32_bf16 v[204:207], a[144:147], v[128:131], v[76:79]
 v_exp_f32 v11, v167
 v_mfma_f32_16x16x32_bf16 v[196:199], a[148:151], v[116:119], v[196:199]
 v_cvt_pk_bf16_f32 v217, v6, v7
 v_cvt_pk_bf16_f32 v218, v8, v9
 v_mfma_f32_16x16x32_bf16 v[204:207], a[148:151], v[132:135], v[204:207]
 v_or3_b32 v12, v12, v217, v218
 v_cvt_pk_bf16_f32 v219, v10, v11
 v_mfma_f32_16x16x32_bf16 v[196:199], a[152:155], v[120:123], v[196:199]
 v_bitop3_b32 v12, v12, v219, s42 bitop3:0xa8
 v_cmp_ne_u32 vcc, 0, v12
 v_mfma_f32_16x16x32_bf16 v[204:207], a[152:155], v[136:139], v[204:207]
 buffer_load_dwordx4 v16, s[12:15], s38 offen offset:0 sc1 lds
 v_mfma_f32_16x16x32_bf16 v[196:199], a[156:159], v[124:127], v[196:199]
 s_waitcnt lgkmcnt(5)
 ds_read_b128 a[132:135], v2 offset:1024
 ds_read_b128 a[136:139], v2 offset:2048
 v_mfma_f32_16x16x32_bf16 v[204:207], a[156:159], v[140:143], v[204:207]
 s_cbranch_vccnz L_b2_r0
L_b2_r0_ret:
 ds_read_b128 a[140:143], v2 offset:3072
 ds_read_b128 a[144:147], v2 offset:4096
 v_mfma_f32_16x16x32_bf16 a[64:67], a[160:163], v[216:219], a[64:67]
 ds_read_b128 a[148:151], v2 offset:5120
 ds_read_b128 a[152:155], v2 offset:6144
 v_mfma_f32_16x16x32_bf16 a[96:99], a[160:163], v[220:223], a[96:99]
 ds_read_b128 a[156:159], v2 offset:7168
 ds_read_b128 a[160:163], v3 offset:24576
 v_mfma_f32_16x16x32_bf16 a[68:71], a[164:167], v[216:219], a[68:71]
 v_exp_f32 v4, v200
 v_mfma_f32_16x16x32_bf16 a[100:103], a[164:167], v[220:223], a[100:103]
 v_exp_f32 v5, v201
 v_mfma_f32_16x16x32_bf16 a[72:75], a[168:171], v[216:219], a[72:75]
 buffer_load_dwordx4 v16, s[12:15], s38 offen offset:1024 sc1 lds
 v_mfma_f32_16x16x32_bf16 a[104:107], a[168:171], v[220:223], a[104:107]
 ds_read_b128 a[164:167], v3 offset:25600
 ds_read_b128 a[168:171], v3 offset:26624
 v_mfma_f32_16x16x32_bf16 a[76:79], a[172:175], v[216:219], a[76:79]
 v_exp_f32 v6, v202
 v_mfma_f32_16x16x32_bf16 a[108:111], a[172:175], v[220:223], a[108:111]
 s_waitcnt lgkmcnt(11)
 ds_read_b128 a[172:175], v3 offset:27648
 v_cvt_pk_bf16_f32 v236, v4, v5
 v_mfma_f32_16x16x32_bf16 a[80:83], a[176:179], v[216:219], a[80:83]
 v_exp_f32 v7, v203
 v_mfma_f32_16x16x32_bf16 a[112:115], a[176:179], v[220:223], a[112:115]
 v_exp_f32 v8, v204
 v_mfma_f32_16x16x32_bf16 a[84:87], a[180:183], v[216:219], a[84:87]
 v_exp_f32 v9, v205
 v_mfma_f32_16x16x32_bf16 a[116:119], a[180:183], v[220:223], a[116:119]
 ds_read_b128 a[176:179], v3 offset:28672
 v_cvt_pk_bf16_f32 v237, v6, v7
 v_mfma_f32_16x16x32_bf16 a[88:91], a[184:187], v[216:219], a[88:91]
 buffer_load_dwordx4 v16, s[12:15], s38 offen offset:2048 sc1 lds
 v_mfma_f32_16x16x32_bf16 a[120:123], a[184:187], v[220:223], a[120:123]
 v_exp_f32 v10, v206
 v_mfma_f32_16x16x32_bf16 a[92:95], a[188:191], v[216:219], a[92:95]
 ds_read_b128 a[180:183], v3 offset:29696
 v_cvt_pk_bf16_f32 v238, v8, v9
 v_mfma_f32_16x16x32_bf16 a[124:127], a[188:191], v[220:223], a[124:127]
 ds_read_b128 a[184:187], v3 offset:30720
 v_or3_b32 v12, v236, v237, v238
 v_mfma_f32_16x16x32_bf16 v[248:251], v[24:27], v[216:219], v[248:251]
 v_exp_f32 v11, v207
 v_mfma_f32_16x16x32_bf16 v[252:255], v[24:27], v[220:223], v[252:255]
 s_waitcnt lgkmcnt(11)
 v_exp_f32 v4, v192
 v_mfma_f32_16x16x32_bf16 v[160:163], a[128:131], v[112:115], v[72:75]
 v_exp_f32 v5, v193
 v_mfma_f32_16x16x32_bf16 v[168:171], a[128:131], v[128:131], v[76:79]
 ds_read_b128 a[188:191], v3 offset:31744
 v_cvt_pk_bf16_f32 v239, v10, v11
 v_mfma_f32_16x16x32_bf16 v[160:163], a[132:135], v[116:119], v[160:163]
 buffer_load_dwordx4 v16, s[12:15], s38 offen offset:3072 sc1 lds
 v_mfma_f32_16x16x32_bf16 v[168:171], a[132:135], v[132:135], v[168:171]
 s_mov_b32 m0, s41
 v_exp_f32 v6, v194
 v_mfma_f32_16x16x32_bf16 v[160:163], a[136:139], v[120:123], v[160:163]
 v_exp_f32 v7, v195
 v_mfma_f32_16x16x32_bf16 v[168:171], a[136:139], v[136:139], v[168:171]
 v_exp_f32 v8, v196
 v_mfma_f32_16x16x32_bf16 v[160:163], a[140:143], v[124:127], v[160:163]
 v_exp_f32 v9, v197
 v_mfma_f32_16x16x32_bf16 v[168:171], a[140:143], v[140:143], v[168:171]
 s_waitcnt lgkmcnt(8)
 v_exp_f32 v10, v198
 v_mfma_f32_16x16x32_bf16 v[164:167], a[144:147], v[112:115], v[72:75]
 v_exp_f32 v11, v199
 v_mfma_f32_16x16x32_bf16 v[172:175], a[144:147], v[128:131], v[76:79]
 buffer_load_dwordx4 v16, s[12:15], s43 offen offset:0 sc1 lds
 v_mfma_f32_16x16x32_bf16 v[164:167], a[148:151], v[116:119], v[164:167]
 v_cvt_pk_bf16_f32 v232, v4, v5
 v_or3_b32 v12, v12, v239, v232
 v_mfma_f32_16x16x32_bf16 v[172:175], a[148:151], v[132:135], v[172:175]
 v_cvt_pk_bf16_f32 v233, v6, v7
 v_cvt_pk_bf16_f32 v234, v8, v9
 v_mfma_f32_16x16x32_bf16 v[164:167], a[152:155], v[120:123], v[164:167]
 v_or3_b32 v12, v12, v233, v234
 v_cvt_pk_bf16_f32 v235, v10, v11
 v_mfma_f32_16x16x32_bf16 v[172:175], a[152:155], v[136:139], v[172:175]
 v_bitop3_b32 v12, v12, v235, s42 bitop3:0xa8
 v_cmp_ne_u32 vcc, 0, v12
 v_mfma_f32_16x16x32_bf16 v[164:167], a[156:159], v[124:127], v[164:167]
 s_waitcnt lgkmcnt(4)
 ds_read_b128 a[128:131], v2 offset:16384
 ds_read_b128 a[132:135], v2 offset:17408
 v_mfma_f32_16x16x32_bf16 v[172:175], a[156:159], v[140:143], v[172:175]
 s_cbranch_vccnz L_b2_r1
L_b2_r1_ret:
 ds_read_b128 a[136:139], v2 offset:18432
 ds_read_b128 a[140:143], v2 offset:19456
 v_mfma_f32_16x16x32_bf16 a[64:67], a[160:163], v[232:235], a[64:67]
 ds_read_b128 a[144:147], v2 offset:20480
 ds_read_b128 a[148:151], v2 offset:21504
 v_mfma_f32_16x16x32_bf16 a[96:99], a[160:163], v[236:239], a[96:99]
 buffer_load_dwordx4 v16, s[12:15], s43 offen offset:1024 sc1 lds
 v_mfma_f32_16x16x32_bf16 a[68:71], a[164:167], v[232:235], a[68:71]
 s_add_u32 s38, s38, s44
 v_exp_f32 v4, v168
 v_mfma_f32_16x16x32_bf16 a[100:103], a[164:167], v[236:239], a[100:103]
 s_add_u32 s40, s39, s59
 ds_read_b128 a[152:155], v2 offset:22528
 ds_read_b128 a[156:159], v2 offset:23552
 v_mfma_f32_16x16x32_bf16 a[72:75], a[168:171], v[232:235], a[72:75]
 s_add_u32 s41, s40, s50
 v_exp_f32 v5, v169
 v_mfma_f32_16x16x32_bf16 a[104:107], a[168:171], v[236:239], a[104:107]
 s_mov_b32 s39, s45
 ds_read_b128 a[160:163], v2 offset:8192
 v_cvt_pk_bf16_f32 v220, v4, v5
 v_mfma_f32_16x16x32_bf16 a[76:79], a[172:175], v[232:235], a[76:79]
 s_add_u32 s59, s59, s48
 v_exp_f32 v6, v170
 v_mfma_f32_16x16x32_bf16 a[108:111], a[172:175], v[236:239], a[108:111]
 s_waitcnt lgkmcnt(9)
 v_exp_f32 v7, v171
 v_mfma_f32_16x16x32_bf16 a[80:83], a[176:179], v[232:235], a[80:83]
 buffer_load_dwordx4 v16, s[12:15], s43 offen offset:2048 sc1 lds
 v_mfma_f32_16x16x32_bf16 a[112:115], a[176:179], v[236:239], a[112:115]
 s_add_u32 s45, s45, 32768
 ds_read_b128 a[164:167], v2 offset:9216
 v_cvt_pk_bf16_f32 v221, v6, v7
 v_mfma_f32_16x16x32_bf16 a[84:87], a[180:183], v[232:235], a[84:87]
 s_cmp_eq_u32 s45, 163840
 v_exp_f32 v8, v172
 v_mfma_f32_16x16x32_bf16 a[116:119], a[180:183], v[236:239], a[116:119]
 s_cselect_b32 s45, 0, s45
 v_exp_f32 v9, v173
 v_mfma_f32_16x16x32_bf16 a[88:91], a[184:187], v[232:235], a[88:91]
 ds_read_b128 a[168:171], v2 offset:10240
 v_cvt_pk_bf16_f32 v222, v8, v9
 v_mfma_f32_16x16x32_bf16 a[120:123], a[184:187], v[236:239], a[120:123]
 ds_read_b128 a[172:175], v2 offset:11264
 v_or3_b32 v12, v220, v221, v222
 v_mfma_f32_16x16x32_bf16 a[92:95], a[188:191], v[232:235], a[92:95]
 v_exp_f32 v10, v174
 v_mfma_f32_16x16x32_bf16 a[124:127], a[188:191], v[236:239], a[124:127]
 v_exp_f32 v11, v175
 v_mfma_f32_16x16x32_bf16 v[248:251], v[24:27], v[232:235], v[248:251]
 buffer_load_dwordx4 v16, s[12:15], s43 offen offset:3072 sc1 lds
 v_mfma_f32_16x16x32_bf16 v[252:255], v[24:27], v[236:239], v[252:255]
 s_waitcnt lgkmcnt(8)
 v_cvt_pk_bf16_f32 v223, v10, v11
 v_add_u32 v3, s45, v16
 v_mfma_f32_16x16x32_bf16 v[192:195], a[128:131], v[112:115], v[72:75]
 ds_read_b128 a[176:179], v2 offset:12288
 v_exp_f32 v4, v160
 v_mfma_f32_16x16x32_bf16 v[200:203], a[128:131], v[128:131], v[76:79]
 ds_read_b128 a[180:183], v2 offset:13312
 v_exp_f32 v5, v161
 v_mfma_f32_16x16x32_bf16 v[192:195], a[132:135], v[116:119], v[192:195]
 s_waitcnt vmcnt(16)
 ds_read_b128 a[184:187], v2 offset:14336
 v_exp_f32 v6, v162
 v_mfma_f32_16x16x32_bf16 v[200:203], a[132:135], v[132:135], v[200:203]
 s_barrier
 ds_read_b128 a[188:191], v2 offset:15360
 v_cvt_pk_bf16_f32 v216, v4, v5
 v_mfma_f32_16x16x32_bf16 v[192:195], a[136:139], v[120:123], v[192:195]
 s_mov_b32 m0, s40
 v_exp_f32 v7, v163
 v_mfma_f32_16x16x32_bf16 v[200:203], a[136:139], v[136:139], v[200:203]
 s_add_u32 s43, s38, s49
 v_exp_f32 v8, v164
 v_mfma_f32_16x16x32_bf16 v[192:195], a[140:143], v[124:127], v[192:195]
 v_exp_f32 v9, v165
 v_mfma_f32_16x16x32_bf16 v[200:203], a[140:143], v[140:143], v[200:203]
 s_waitcnt lgkmcnt(8)
 ds_read_b128 a[128:131], v3 offset:0
 v_or3_b32 v12, v12, v223, v216
 v_mfma_f32_16x16x32_bf16 v[196:199], a[144:147], v[112:115], v[72:75]
 v_exp_f32 v10, v166
 v_mfma_f32_16x16x32_bf16 v[204:207], a[144:147], v[128:131], v[76:79]
 v_exp_f32 v11, v167
 v_mfma_f32_16x16x32_bf16 v[196:199], a[148:151], v[116:119], v[196:199]
 v_cvt_pk_bf16_f32 v217, v6, v7
 v_cvt_pk_bf16_f32 v218, v8, v9
 v_mfma_f32_16x16x32_bf16 v[204:207], a[148:151], v[132:135], v[204:207]
 v_or3_b32 v12, v12, v217, v218
 v_cvt_pk_bf16_f32 v219, v10, v11
 v_mfma_f32_16x16x32_bf16 v[196:199], a[152:155], v[120:123], v[196:199]
 v_bitop3_b32 v12, v12, v219, s42 bitop3:0xa8
 v_cmp_ne_u32 vcc, 0, v12
 v_mfma_f32_16x16x32_bf16 v[204:207], a[152:155], v[136:139], v[204:207]
 buffer_load_dwordx4 v16, s[12:15], s38 offen offset:0 sc1 lds
 v_mfma_f32_16x16x32_bf16 v[196:199], a[156:159], v[124:127], v[196:199]
 s_waitcnt lgkmcnt(5)
 ds_read_b128 a[132:135], v3 offset:1024
 ds_read_b128 a[136:139], v3 offset:2048
 v_mfma_f32_16x16x32_bf16 v[204:207], a[156:159], v[140:143], v[204:207]
 s_cbranch_vccnz L_b2b_r0
L_b2b_r0_ret:
 ds_read_b128 a[140:143], v3 offset:3072
 ds_read_b128 a[144:147], v3 offset:4096
 v_mfma_f32_16x16x32_bf16 a[64:67], a[160:163], v[216:219], a[64:67]
 ds_read_b128 a[148:151], v3 offset:5120
 ds_read_b128 a[152:155], v3 offset:6144
 v_mfma_f32_16x16x32_bf16 a[96:99], a[160:163], v[220:223], a[96:99]
 ds_read_b128 a[156:159], v3 offset:7168
 ds_read_b128 a[160:163], v2 offset:24576
 v_mfma_f32_16x16x32_bf16 a[68:71], a[164:167], v[216:219], a[68:71]
 v_exp_f32 v4, v200
 v_mfma_f32_16x16x32_bf16 a[100:103], a[164:167], v[220:223], a[100:103]
 v_exp_f32 v5, v201
 v_mfma_f32_16x16x32_bf16 a[72:75], a[168:171], v[216:219], a[72:75]
 buffer_load_dwordx4 v16, s[12:15], s38 offen offset:1024 sc1 lds
 v_mfma_f32_16x16x32_bf16 a[104:107], a[168:171], v[220:223], a[104:107]
 ds_read_b128 a[164:167], v2 offset:25600
 ds_read_b128 a[168:171], v2 offset:26624
 v_mfma_f32_16x16x32_bf16 a[76:79], a[172:175], v[216:219], a[76:79]
 v_exp_f32 v6, v202
 v_mfma_f32_16x16x32_bf16 a[108:111], a[172:175], v[220:223], a[108:111]
 s_waitcnt lgkmcnt(11)
 ds_read_b128 a[172:175], v2 offset:27648
 v_cvt_pk_bf16_f32 v236, v4, v5
 v_mfma_f32_16x16x32_bf16 a[80:83], a[176:179], v[216:219], a[80:83]
 v_exp_f32 v7, v203
 v_mfma_f32_16x16x32_bf16 a[112:115], a[176:179], v[220:223], a[112:115]
 v_exp_f32 v8, v204
 v_mfma_f32_16x16x32_bf16 a[84:87], a[180:183], v[216:219], a[84:87]
 v_exp_f32 v9, v205
 v_mfma_f32_16x16x32_bf16 a[116:119], a[180:183], v[220:223], a[116:119]
 ds_read_b128 a[176:179], v2 offset:28672
 v_cvt_pk_bf16_f32 v237, v6, v7
 v_mfma_f32_16x16x32_bf16 a[88:91], a[184:187], v[216:219], a[88:91]
 buffer_load_dwordx4 v16, s[12:15], s38 offen offset:2048 sc1 lds
 v_mfma_f32_16x16x32_bf16 a[120:123], a[184:187], v[220:223], a[120:123]
 v_exp_f32 v10, v206
 v_mfma_f32_16x16x32_bf16 a[92:95], a[188:191], v[216:219], a[92:95]
 ds_read_b128 a[180:183], v2 offset:29696
 v_cvt_pk_bf16_f32 v238, v8, v9
 v_mfma_f32_16x16x32_bf16 a[124:127], a[188:191], v[220:223], a[124:127]
 ds_read_b128 a[184:187], v2 offset:30720
 v_or3_b32 v12, v236, v237, v238
 v_mfma_f32_16x16x32_bf16 v[248:251], v[24:27], v[216:219], v[248:251]
 v_exp_f32 v11, v207
 v_mfma_f32_16x16x32_bf16 v[252:255], v[24:27], v[220:223], v[252:255]
 s_waitcnt lgkmcnt(11)
 v_exp_f32 v4, v192
 v_mfma_f32_16x16x32_bf16 v[160:163], a[128:131], v[112:115], v[72:75]
 v_exp_f32 v5, v193
 v_mfma_f32_16x16x32_bf16 v[168:171], a[128:131], v[128:131], v[76:79]
 ds_read_b128 a[188:191], v2 offset:31744
 v_cvt_pk_bf16_f32 v239, v10, v11
 v_mfma_f32_16x16x32_bf16 v[160:163], a[132:135], v[116:119], v[160:163]
 buffer_load_dwordx4 v16, s[12:15], s38 offen offset:3072 sc1 lds
 v_mfma_f32_16x16x32_bf16 v[168:171], a[132:135], v[132:135], v[168:171]
 s_mov_b32 m0, s41
 v_exp_f32 v6, v194
 v_mfma_f32_16x16x32_bf16 v[160:163], a[136:139], v[120:123], v[160:163]
 v_exp_f32 v7, v195
 v_mfma_f32_16x16x32_bf16 v[168:171], a[136:139], v[136:139], v[168:171]
 v_exp_f32 v8, v196
 v_mfma_f32_16x16x32_bf16 v[160:163], a[140:143], v[124:127], v[160:163]
 v_exp_f32 v9, v197
 v_mfma_f32_16x16x32_bf16 v[168:171], a[140:143], v[140:143], v[168:171]
 s_waitcnt lgkmcnt(8)
 v_exp_f32 v10, v198
 v_mfma_f32_16x16x32_bf16 v[164:167], a[144:147], v[112:115], v[72:75]
 v_exp_f32 v11, v199
 v_mfma_f32_16x16x32_bf16 v[172:175], a[144:147], v[128:131], v[76:79]
 buffer_load_dwordx4 v16, s[12:15], s43 offen offset:0 sc1 lds
 v_mfma_f32_16x16x32_bf16 v[164:167], a[148:151], v[116:119], v[164:167]
 v_cvt_pk_bf16_f32 v232, v4, v5
 v_or3_b32 v12, v12, v239, v232
 v_mfma_f32_16x16x32_bf16 v[172:175], a[148:151], v[132:135], v[172:175]
 v_cvt_pk_bf16_f32 v233, v6, v7
 v_cvt_pk_bf16_f32 v234, v8, v9
 v_mfma_f32_16x16x32_bf16 v[164:167], a[152:155], v[120:123], v[164:167]
 v_or3_b32 v12, v12, v233, v234
 v_cvt_pk_bf16_f32 v235, v10, v11
 v_mfma_f32_16x16x32_bf16 v[172:175], a[152:155], v[136:139], v[172:175]
 v_bitop3_b32 v12, v12, v235, s42 bitop3:0xa8
 v_cmp_ne_u32 vcc, 0, v12
 v_mfma_f32_16x16x32_bf16 v[164:167], a[156:159], v[124:127], v[164:167]
 s_waitcnt lgkmcnt(4)
 ds_read_b128 a[128:131], v3 offset:16384
 ds_read_b128 a[132:135], v3 offset:17408
 v_mfma_f32_16x16x32_bf16 v[172:175], a[156:159], v[140:143], v[172:175]
 s_cbranch_vccnz L_b2b_r1
L_b2b_r1_ret:
 ds_read_b128 a[136:139], v3 offset:18432
 ds_read_b128 a[140:143], v3 offset:19456
 v_mfma_f32_16x16x32_bf16 a[64:67], a[160:163], v[232:235], a[64:67]
 ds_read_b128 a[144:147], v3 offset:20480
 ds_read_b128 a[148:151], v3 offset:21504
 v_mfma_f32_16x16x32_bf16 a[96:99], a[160:163], v[236:239], a[96:99]
 buffer_load_dwordx4 v16, s[12:15], s43 offen offset:1024 sc1 lds
 v_mfma_f32_16x16x32_bf16 a[68:71], a[164:167], v[232:235], a[68:71]
 s_add_u32 s38, s38, s44
 v_exp_f32 v4, v168
 v_mfma_f32_16x16x32_bf16 a[100:103], a[164:167], v[236:239], a[100:103]
 s_add_u32 s40, s39, s59
 ds_read_b128 a[152:155], v3 offset:22528
 ds_read_b128 a[156:159], v3 offset:23552
 v_mfma_f32_16x16x32_bf16 a[72:75], a[168:171], v[232:235], a[72:75]
 s_add_u32 s41, s40, s50
 v_exp_f32 v5, v169
 v_mfma_f32_16x16x32_bf16 a[104:107], a[168:171], v[236:239], a[104:107]
 s_mov_b32 s39, s45
 ds_read_b128 a[160:163], v3 offset:8192
 v_cvt_pk_bf16_f32 v220, v4, v5
 v_mfma_f32_16x16x32_bf16 a[76:79], a[172:175], v[232:235], a[76:79]
 s_add_u32 s59, s59, s48
 v_exp_f32 v6, v170
 v_mfma_f32_16x16x32_bf16 a[108:111], a[172:175], v[236:239], a[108:111]
 s_waitcnt lgkmcnt(9)
 v_exp_f32 v7, v171
 v_mfma_f32_16x16x32_bf16 a[80:83], a[176:179], v[232:235], a[80:83]
 buffer_load_dwordx4 v16, s[12:15], s43 offen offset:2048 sc1 lds
 v_mfma_f32_16x16x32_bf16 a[112:115], a[176:179], v[236:239], a[112:115]
 s_add_u32 s45, s45, 32768
 ds_read_b128 a[164:167], v3 offset:9216
 v_cvt_pk_bf16_f32 v221, v6, v7
 v_mfma_f32_16x16x32_bf16 a[84:87], a[180:183], v[232:235], a[84:87]
 s_cmp_eq_u32 s45, 163840
 v_exp_f32 v8, v172
 v_mfma_f32_16x16x32_bf16 a[116:119], a[180:183], v[236:239], a[116:119]
 s_cselect_b32 s45, 0, s45
 v_exp_f32 v9, v173
 v_mfma_f32_16x16x32_bf16 a[88:91], a[184:187], v[232:235], a[88:91]
 s_sub_u32 s58, s58, 1
 ds_read_b128 a[168:171], v3 offset:10240
 v_cvt_pk_bf16_f32 v222, v8, v9
 v_mfma_f32_16x16x32_bf16 a[120:123], a[184:187], v[236:239], a[120:123]
 s_cmp_lg_u32 s58, 0
 ds_read_b128 a[172:175], v3 offset:11264
 v_or3_b32 v12, v220, v221, v222
 v_mfma_f32_16x16x32_bf16 a[92:95], a[188:191], v[232:235], a[92:95]
 v_exp_f32 v10, v174
 v_mfma_f32_16x16x32_bf16 a[124:127], a[188:191], v[236:239], a[124:127]
 v_exp_f32 v11, v175
 v_mfma_f32_16x16x32_bf16 v[248:251], v[24:27], v[232:235], v[248:251]
 buffer_load_dwordx4 v16, s[12:15], s43 offen offset:3072 sc1 lds
 v_mfma_f32_16x16x32_bf16 v[252:255], v[24:27], v[236:239], v[252:255]
 s_waitcnt lgkmcnt(8)
 v_cvt_pk_bf16_f32 v223, v10, v11
 v_add_u32 v2, s45, v16
 s_cbranch_scc1 L_b2_loop
 s_cmp_lg_u32 s35, 0
 s_cbranch_scc1 L_b2_sw
L_b2e:
 v_mfma_f32_16x16x32_bf16 v[192:195], a[128:131], v[112:115], v[72:75]
 ds_read_b128 a[176:179], v3 offset:12288
 v_add_f32 v160, v48, v160
 v_mfma_f32_16x16x32_bf16 v[200:203], a[128:131], v[128:131], v[76:79]
L_pad11:
 s_cbranch_execz L_pad19
 ds_read_b128 a[180:183], v3 offset:13312
 v_add_f32 v161, v49, v161
 v_mfma_f32_16x16x32_bf16 v[192:195], a[132:135], v[116:119], v[192:195]
 s_waitcnt vmcnt(16)
 ds_read_b128 a[184:187], v3 offset:14336
 v_add_f32 v162, v50, v162
 v_mfma_f32_16x16x32_bf16 v[200:203], a[132:135], v[132:135], v[200:203]
 s_barrier
 ds_read_b128 a[188:191], v3 offset:15360
 v_add_f32 v163, v51, v163
 v_mfma_f32_16x16x32_bf16 v[192:195], a[136:139], v[120:123], v[192:195]
 s_mov_b32 m0, s40
 ds_read_b128 a[128:131], v2 offset:0
 v_add_f32 v164, v52, v164
 v_add_f32 v165, v53, v165
 v_mfma_f32_16x16x32_bf16 v[200:203], a[136:139], v[136:139], v[200:203]
 s_add_u32 s43, s38, s49
 ds_read_b128 a[132:135], v2 offset:1024
 v_add_f32 v166, v54, v166
 v_add_f32 v167, v55, v167
 v_exp_f32 v4, v160
 v_mfma_f32_16x16x32_bf16 v[192:195], a[140:143], v[124:127], v[192:195]
 ds_read_b128 a[136:139], v2 offset:2048
 v_exp_f32 v5, v161
 v_mfma_f32_16x16x32_bf16 v[200:203], a[140:143], v[140:143], v[200:203]
 s_waitcnt lgkmcnt(11)
 ds_read_b128 a[140:143], v2 offset:3072
 v_exp_f32 v6, v162
 v_mfma_f32_16x16x32_bf16 v[196:199], a[144:147], v[112:115], v[72:75]
 v_exp_f32 v7, v163
 v_mfma_f32_16x16x32_bf16 v[204:207], a[144:147], v[128:131], v[76:79]
 v_exp_f32 v8, v164
 v_mfma_f32_16x16x32_bf16 v[196:199], a[148:151], v[116:119], v[196:199]
 v_exp_f32 v9, v165
 v_mfma_f32_16x16x32_bf16 v[204:207], a[148:151], v[132:135], v[204:207]
 ds_read_b128 a[144:147], v2 offset:4096
 v_cvt_pk_bf16_f32 v216, v4, v5
 v_or3_b32 v12, v12, v223, v216
 v_exp_f32 v10, v166
 v_mfma_f32_16x16x32_bf16 v[196:199], a[152:155], v[120:123], v[196:199]
 v_cvt_pk_bf16_f32 v217, v6, v7
 v_cvt_pk_bf16_f32 v218, v8, v9
 v_or3_b32 v12, v12, v217, v218
 v_exp_f32 v11, v167
 v_mfma_f32_16x16x32_bf16 v[204:207], a[152:155], v[136:139], v[204:207]
 buffer_load_dwordx4 v16, s[12:15], s38 offen offset:0 sc1 lds
 v_cvt_pk_bf16_f32 v219, v10, v11
 v_bitop3_b32 v12, v12, v219, s42 bitop3:0xa8
 v_cmp_ne_u32 vcc, 0, v12
 v_mfma_f32_16x16x32_bf16 v[196:199], a[156:159], v[124:127], v[196:199]
 s_waitcnt lgkmcnt(9)
 ds_read_b128 a[148:151], v2 offset:5120
 ds_read_b128 a[152:155], v2 offset:6144
 v_mfma_f32_16x16x32_bf16 v[204:207], a[156:159], v[140:143], v[204:207]
 s_cbranch_vccnz L_b2e_r0
L_b2e_r0_ret:
 ds_read_b128 a[156:159], v2 offset:7168
 v_exp_f32 v4, v200
 v_mfma_f32_16x16x32_bf16 a[64:67], a[160:163], v[216:219], a[64:67]
 v_exp_f32 v5, v201
 v_mfma_f32_16x16x32_bf16 a[96:99], a[160:163], v[220:223], a[96:99]
 v_exp_f32 v6, v202
 v_mfma_f32_16x16x32_bf16 a[68:71], a[164:167], v[216:219], a[68:71]
 ds_read_b128 a[160:163], v3 offset:24576
 v_exp_f32 v7, v203
 v_mfma_f32_16x16x32_bf16 a[100:103], a[164:167], v[220:223], a[100:103]
 ds_read_b128 a[164:167], v3 offset:25600
 v_exp_f32 v8, v204
 v_mfma_f32_16x16x32_bf16 a[72:75], a[168:171], v[216:219], a[72:75]
 v_exp_f32 v9, v205
 v_mfma_f32_16x16x32_bf16 a[104:107], a[168:171], v[220:223], a[104:107]
 buffer_load_dwordx4 v16, s[12:15], s38 offen offset:1024 sc1 lds
 v_mfma_f32_16x16x32_bf16 a[76:79], a[172:175], v[216:219], a[76:79]
 ds_read_b128 a[168:171], v3 offset:26624
 v_exp_f32 v10, v206
 v_mfma_f32_16x16x32_bf16 a[108:111], a[172:175], v[220:223], a[108:111]
 s_waitcnt lgkmcnt(11)
 ds_read_b128 a[172:175], v3 offset:27648
 v_exp_f32 v11, v207
 v_mfma_f32_16x16x32_bf16 a[80:83], a[176:179], v[216:219], a[80:83]
 v_cvt_pk_bf16_f32 v236, v4, v5
 v_cvt_pk_bf16_f32 v237, v6, v7
 v_mfma_f32_16x16x32_bf16 a[112:115], a[176:179], v[220:223], a[112:115]
 v_cvt_pk_bf16_f32 v238, v8, v9
 v_or3_b32 v12, v236, v237, v238
 v_mfma_f32_16x16x32_bf16 a[84:87], a[180:183], v[216:219], a[84:87]
 ds_read_b128 a[176:179], v3 offset:28672
 v_cvt_pk_bf16_f32 v239, v10, v11
 v_mfma_f32_16x16x32_bf16 a[116:119], a[180:183], v[220:223], a[116:119]
 ds_read_b128 a[180:183], v3 offset:29696
 v_add_f32 v192, v56, v192
 v_mfma_f32_16x16x32_bf16 a[88:91], a[184:187], v[216:219], a[88:91]
 buffer_load_dwordx4 v16, s[12:15], s38 offen offset:2048 sc1 lds
 v_mfma_f32_16x16x32_bf16 a[120:123], a[184:187], v[220:223], a[120:123]
 v_add_f32 v193, v57, v193
 v_add_f32 v194, v58, v194
 v_mfma_f32_16x16x32_bf16 a[92:95], a[188:191], v[216:219], a[92:95]
 ds_read_b128 a[184:187], v3 offset:30720
 v_add_f32 v195, v59, v195
 v_mfma_f32_16x16x32_bf16 a[124:127], a[188:191], v[220:223], a[124:127]
 ds_read_b128 a[188:191], v3 offset:31744
 v_add_f32 v196, v60, v196
 v_mfma_f32_16x16x32_bf16 v[248:251], v[24:27], v[216:219], v[248:251]
 v_add_f32 v197, v61, v197
 v_add_f32 v198, v62, v198
 v_mfma_f32_16x16x32_bf16 v[252:255], v[24:27], v[220:223], v[252:255]
 s_waitcnt lgkmcnt(12)
 v_add_f32 v199, v63, v199
 v_exp_f32 v4, v192
 v_mfma_f32_16x16x32_bf16 v[160:163], a[128:131], v[112:115], v[72:75]
 v_exp_f32 v5, v193
 v_mfma_f32_16x16x32_bf16 v[168:171], a[128:131], v[128:131], v[76:79]
 ds_read_b128 a[128:131], v2 offset:16384
 v_exp_f32 v6, v194
 v_mfma_f32_16x16x32_bf16 v[160:163], a[132:135], v[116:119], v[160:163]
 buffer_load_dwordx4 v16, s[12:15], s38 offen offset:3072 sc1 lds
 v_mfma_f32_16x16x32_bf16 v[168:171], a[132:135], v[132:135], v[168:171]
 s_mov_b32 m0, s41
 v_exp_f32 v7, v195
 v_mfma_f32_16x16x32_bf16 v[160:163], a[136:139], v[120:123], v[160:163]
 ds_read_b128 a[132:135], v2 offset:17408
 v_cvt_pk_bf16_f32 v232, v4, v5
 v_mfma_f32_16x16x32_bf16 v[168:171], a[136:139], v[136:139], v[168:171]
 ds_read_b128 a[136:139], v2 offset:18432
 v_or3_b32 v12, v12, v239, v232
 v_mfma_f32_16x16x32_bf16 v[160:163], a[140:143], v[124:127], v[160:163]
 v_exp_f32 v8, v196
 v_mfma_f32_16x16x32_bf16 v[168:171], a[140:143], v[140:143], v[168:171]
 s_waitcnt lgkmcnt(11)
 v_exp_f32 v9, v197
 v_mfma_f32_16x16x32_bf16 v[164:167], a[144:147], v[112:115], v[72:75]
 v_exp_f32 v10, v198
 v_mfma_f32_16x16x32_bf16 v[172:175], a[144:147], v[128:131], v[76:79]
 buffer_load_dwordx4 v16, s[12:15], s43 offen offset:0 sc1 lds
 v_mfma_f32_16x16x32_bf16 v[164:167], a[148:151], v[116:119], v[164:167]
 v_exp_f32 v11, v199
 v_mfma_f32_16x16x32_bf16 v[172:175], a[148:151], v[132:135], v[172:175]
 v_cvt_pk_bf16_f32 v233, v6, v7
 v_cvt_pk_bf16_f32 v234, v8, v9
 v_mfma_f32_16x16x32_bf16 v[164:167], a[152:155], v[120:123], v[164:167]
 v_or3_b32 v12, v12, v233, v234
 v_cvt_pk_bf16_f32 v235, v10, v11
 v_mfma_f32_16x16x32_bf16 v[172:175], a[152:155], v[136:139], v[172:175]
 v_bitop3_b32 v12, v12, v235, s42 bitop3:0xa8
 v_cmp_ne_u32 vcc, 0, v12
 v_mfma_f32_16x16x32_bf16 v[164:167], a[156:159], v[124:127], v[164:167]
 s_waitcnt lgkmcnt(7)
 ds_read_b128 a[140:143], v2 offset:19456
 ds_read_b128 a[144:147], v2 offset:20480
 v_mfma_f32_16x16x32_bf16 v[172:175], a[156:159], v[140:143], v[172:175]
 s_cbranch_vccnz L_b2e_r1
L_b2e_r1_ret:
 ds_read_b128 a[148:151], v2 offset:21504
 ds_read_b128 a[152:155], v2 offset:22528
 v_mfma_f32_16x16x32_bf16 a[64:67], a[160:163], v[232:235], a[64:67]
 buffer_load_dwordx4 v16, s[12:15], s43 offen offset:1024 sc1 lds
 v_mfma_f32_16x16x32_bf16 a[96:99], a[160:163], v[236:239], a[96:99]
 s_add_u32 s38, s38, s44
 ds_read_b128 a[156:159], v2 offset:23552
 ds_read_b128 a[160:163], v2 offset:8192
 v_mfma_f32_16x16x32_bf16 a[68:71], a[164:167], v[232:235], a[68:71]
 s_add_u32 s40, s39, s59
 v_add_f32 v168, v48, v168
 v_add_f32 v169, v49, v169
 v_mfma_f32_16x16x32_bf16 a[100:103], a[164:167], v[236:239], a[100:103]
 s_add_u32 s41, s40, s50
 v_add_f32 v170, v50, v170
 v_add_f32 v171, v51, v171
 v_mfma_f32_16x16x32_bf16 a[72:75], a[168:171], v[232:235], a[72:75]
 s_mov_b32 s39, s45
 ds_read_b128 a[164:167], v2 offset:9216
 v_add_f32 v172, v52, v172
 v_mfma_f32_16x16x32_bf16 a[104:107], a[168:171], v[236:239], a[104:107]
 s_add_u32 s59, s59, s48
 ds_read_b128 a[168:171], v2 offset:10240
 v_add_f32 v173, v53, v173
 v_mfma_f32_16x16x32_bf16 a[76:79], a[172:175], v[232:235], a[76:79]
 s_add_u32 s45, s45, 32768
 v_add_f32 v174, v54, v174
 v_add_f32 v175, v55, v175
 v_mfma_f32_16x16x32_bf16 a[108:111], a[172:175], v[236:239], a[108:111]
 s_waitcnt lgkmcnt(11)
 v_exp_f32 v4, v168
 v_mfma_f32_16x16x32_bf16 a[80:83], a[176:179], v[232:235], a[80:83]
 buffer_load_dwordx4 v16, s[12:15], s43 offen offset:2048 sc1 lds
 v_mfma_f32_16x16x32_bf16 a[112:115], a[176:179], v[236:239], a[112:115]
 s_cmp_eq_u32 s45, 163840
 ds_read_b128 a[172:175], v2 offset:11264
 v_exp_f32 v5, v169
 v_mfma_f32_16x16x32_bf16 a[84:87], a[180:183], v[232:235], a[84:87]
 s_cselect_b32 s45, 0, s45
 v_exp_f32 v6, v170
 v_mfma_f32_16x16x32_bf16 a[116:119], a[180:183], v[236:239], a[116:119]
 v_exp_f32 v7, v171
 v_mfma_f32_16x16x32_bf16 a[88:91], a[184:187], v[232:235], a[88:91]
 v_exp_f32 v8, v172
 v_mfma_f32_16x16x32_bf16 a[120:123], a[184:187], v[236:239], a[120:123]
 v_exp_f32 v9, v173
 v_mfma_f32_16x16x32_bf16 a[92:95], a[188:191], v[232:235], a[92:95]
 v_exp_f32 v10, v174
 v_mfma_f32_16x16x32_bf16 a[124:127], a[188:191], v[236:239], a[124:127]
 v_exp_f32 v11, v175
 v_mfma_f32_16x16x32_bf16 v[248:251], v[24:27], v[232:235], v[248:251]
 buffer_load_dwordx4 v16, s[12:15], s43 offen offset:3072 sc1 lds
 v_cvt_pk_bf16_f32 v220, v4, v5
 v_cvt_pk_bf16_f32 v221, v6, v7
 v_cvt_pk_bf16_f32 v222, v8, v9
 v_mfma_f32_16x16x32_bf16 v[252:255], v[24:27], v[236:239], v[252:255]
 s_waitcnt lgkmcnt(8)
 v_or3_b32 v12, v220, v221, v222
 v_cvt_pk_bf16_f32 v223, v10, v11
 v_mov_b32 v3, v2
 v_add_u32 v2, s45, v16
 s_waitcnt vmcnt(8)
 v_mov_b32 v17, 0
 v_mov_b32 v18, 1
 buffer_store_dword v18, v17, s[28:31], s55 offen sc1
 s_mov_b32 s20, s74
 s_mov_b32 s21, s75
 s_mov_b32 s22, 2048
 s_lshl_b32 s36, s2, 2
 s_add_u32 s36, s36, s32
 s_lshl_b32 s37, s36, 12
 s_lshl_b32 s36, s36, 1
 buffer_load_dwordx2 v[28:29], v17, s[4:7], s37 offen
 buffer_load_ushort v30, v17, s[20:23], s36 offen
 s_mov_b32 m0, s40
 s_add_u32 s43, s38, s49
 s_barrier
 s_nop 4
 v_accvgpr_read_b32 v36, a64
 buffer_load_dwordx4 v16, s[12:15], s38 offen offset:0 sc1 lds
 v_accvgpr_read_b32 v37, a65
 v_accvgpr_read_b32 v38, a66
 v_accvgpr_read_b32 v39, a67
 v_accvgpr_read_b32 v40, a68
 v_accvgpr_read_b32 v41, a69
 v_accvgpr_read_b32 v42, a70
 v_accvgpr_read_b32 v43, a71
 v_rcp_f32 v32, v248
 s_nop 0
 v_pk_mul_f32 v[36:37], v[36:37], v[32:33] op_sel_hi:[1,0]
 v_pk_mul_f32 v[38:39], v[38:39], v[32:33] op_sel_hi:[1,0]
 v_pk_mul_f32 v[40:41], v[40:41], v[32:33] op_sel_hi:[1,0]
 v_pk_mul_f32 v[42:43], v[42:43], v[32:33] op_sel_hi:[1,0]
 v_cvt_pk_bf16_f32 v144, v36, v37
 v_cvt_pk_bf16_f32 v145, v38, v39
 v_cvt_pk_bf16_f32 v146, v40, v41
 v_cvt_pk_bf16_f32 v147, v42, v43
 v_accvgpr_read_b32 v36, a72
 v_accvgpr_read_b32 v37, a73
 v_accvgpr_read_b32 v38, a74
 v_accvgpr_read_b32 v39, a75
 buffer_load_dwordx4 v16, s[12:15], s38 offen offset:1024 sc1 lds
 v_accvgpr_read_b32 v40, a76
 v_accvgpr_read_b32 v41, a77
 v_accvgpr_read_b32 v42, a78
 v_accvgpr_read_b32 v43, a79
 v_pk_mul_f32 v[36:37], v[36:37], v[32:33] op_sel_hi:[1,0]
 v_pk_mul_f32 v[38:39], v[38:39], v[32:33] op_sel_hi:[1,0]
 v_pk_mul_f32 v[40:41], v[40:41], v[32:33] op_sel_hi:[1,0]
 v_pk_mul_f32 v[42:43], v[42:43], v[32:33] op_sel_hi:[1,0]
 v_cvt_pk_bf16_f32 v148, v36, v37
 v_cvt_pk_bf16_f32 v149, v38, v39
 v_cvt_pk_bf16_f32 v150, v40, v41
 v_cvt_pk_bf16_f32 v151, v42, v43
 v_accvgpr_read_b32 v36, a80
 v_accvgpr_read_b32 v37, a81
 v_accvgpr_read_b32 v38, a82
 v_accvgpr_read_b32 v39, a83
 v_accvgpr_read_b32 v40, a84
 v_accvgpr_read_b32 v41, a85
 v_accvgpr_read_b32 v42, a86
 v_accvgpr_read_b32 v43, a87
 buffer_load_dwordx4 v16, s[12:15], s38 offen offset:2048 sc1 lds
 v_pk_mul_f32 v[36:37], v[36:37], v[32:33] op_sel_hi:[1,0]
 v_pk_mul_f32 v[38:39], v[38:39], v[32:33] op_sel_hi:[1,0]
 v_pk_mul_f32 v[40:41], v[40:41], v[32:33] op_sel_hi:[1,0]
 v_pk_mul_f32 v[42:43], v[42:43], v[32:33] op_sel_hi:[1,0]
 v_cvt_pk_bf16_f32 v152, v36, v37
 v_cvt_pk_bf16_f32 v153, v38, v39
 v_cvt_pk_bf16_f32 v154, v40, v41
 v_cvt_pk_bf16_f32 v155, v42, v43
 v_accvgpr_read_b32 v36, a88
 v_accvgpr_read_b32 v37, a89
 v_accvgpr_read_b32 v38, a90
 v_accvgpr_read_b32 v39, a91
 v_accvgpr_read_b32 v40, a92
 v_accvgpr_read_b32 v41, a93
 v_accvgpr_read_b32 v42, a94
 v_accvgpr_read_b32 v43, a95
 v_pk_mul_f32 v[36:37], v[36:37], v[32:33] op_sel_hi:[1,0]
 v_pk_mul_f32 v[38:39], v[38:39], v[32:33] op_sel_hi:[1,0]
 v_pk_mul_f32 v[40:41], v[40:41], v[32:33] op_sel_hi:[1,0]
 v_pk_mul_f32 v[42:43], v[42:43], v[32:33] op_sel_hi:[1,0]
 buffer_load_dwordx4 v16, s[12:15], s38 offen offset:3072 sc1 lds
 v_cvt_pk_bf16_f32 v156, v36, v37
 v_cvt_pk_bf16_f32 v157, v38, v39
 v_cvt_pk_bf16_f32 v158, v40, v41
 v_cvt_pk_bf16_f32 v159, v42, v43
 v_bitop3_b32 v12, v12, v223, s42 bitop3:0xa8
 v_cmp_ne_u32 vcc, 0, v12
 v_mfma_f32_16x16x32_bf16 v[200:203], a[128:131], v[128:131], v[76:79]
 v_mfma_f32_16x16x32_bf16 v[200:203], a[132:135], v[132:135], v[200:203]
 v_mfma_f32_16x16x32_bf16 v[200:203], a[136:139], v[136:139], v[200:203]
 v_mfma_f32_16x16x32_bf16 v[200:203], a[140:143], v[140:143], v[200:203]
 s_waitcnt lgkmcnt(4)
 s_mov_b32 m0, s41
 s_nop 0
 buffer_load_dwordx4 v16, s[12:15], s43 offen offset:0 sc1 lds
 v_mfma_f32_16x16x32_bf16 v[204:207], a[144:147], v[128:131], v[76:79]
 ds_read_b128 a[176:179], v3 offset:12288
 v_mfma_f32_16x16x32_bf16 v[204:207], a[148:151], v[132:135], v[204:207]
 ds_read_b128 a[180:183], v3 offset:13312
 v_mfma_f32_16x16x32_bf16 v[204:207], a[152:155], v[136:139], v[204:207]
 ds_read_b128 a[184:187], v3 offset:14336
 v_mfma_f32_16x16x32_bf16 v[204:207], a[156:159], v[140:143], v[204:207]
 s_waitcnt lgkmcnt(3)
 ds_read_b128 a[188:191], v3 offset:15360
 buffer_load_dwordx4 v16, s[12:15], s43 offen offset:1024 sc1 lds
 s_cbranch_vccnz L_b1_r0
L_b1_r0_ret:
 ds_read_b128 a[128:131], v3 offset:24576
 ds_read_b128 a[132:135], v3 offset:25600
 ds_read_b128 a[136:139], v3 offset:26624
 ds_read_b128 a[140:143], v3 offset:27648
 ds_read_b128 a[144:147], v3 offset:28672
 ds_read_b128 a[148:151], v3 offset:29696
 ds_read_b128 a[152:155], v3 offset:30720
 ds_read_b128 a[156:159], v3 offset:31744
 v_mfma_f32_16x16x32_bf16 a[96:99], a[160:163], v[220:223], a[96:99]
 v_mfma_f32_16x16x32_bf16 a[100:103], a[164:167], v[220:223], a[100:103]
 v_mfma_f32_16x16x32_bf16 a[104:107], a[168:171], v[220:223], a[104:107]
 buffer_load_dwordx4 v16, s[12:15], s43 offen offset:2048 sc1 lds
 v_mfma_f32_16x16x32_bf16 a[108:111], a[172:175], v[220:223], a[108:111]
 s_waitcnt lgkmcnt(8)
 v_mfma_f32_16x16x32_bf16 a[112:115], a[176:179], v[220:223], a[112:115]
 v_add_f32 v200, v56, v200
 v_add_f32 v201, v57, v201
 v_add_f32 v202, v58, v202
 v_add_f32 v203, v59, v203
 v_add_f32 v204, v60, v204
 v_add_f32 v205, v61, v205
 v_add_f32 v206, v62, v206
 v_add_f32 v207, v63, v207
 v_mfma_f32_16x16x32_bf16 a[116:119], a[180:183], v[220:223], a[116:119]
 buffer_load_dwordx4 v16, s[12:15], s43 offen offset:3072 sc1 lds
 v_exp_f32 v4, v200
 v_exp_f32 v5, v201
 s_nop 0
 v_cvt_pk_bf16_f32 v236, v4, v5
 v_mfma_f32_16x16x32_bf16 a[120:123], a[184:187], v[220:223], a[120:123]
 v_exp_f32 v6, v202
 v_exp_f32 v7, v203
 s_nop 0
 v_cvt_pk_bf16_f32 v237, v6, v7
 buffer_store_dwordx4 v[144:147], v16, s[16:19], s62 offen offset:0 sc1
 v_mfma_f32_16x16x32_bf16 a[124:127], a[188:191], v[220:223], a[124:127]
 v_exp_f32 v8, v204
 v_exp_f32 v9, v205
 s_nop 0
 v_cvt_pk_bf16_f32 v238, v8, v9
 v_mfma_f32_16x16x32_bf16 v[252:255], v[24:27], v[220:223], v[252:255]
 s_waitcnt lgkmcnt(4)
 buffer_store_dwordx4 v[148:151], v16, s[16:19], s62 offen offset:1024 sc1
 v_or3_b32 v12, v236, v237, v238
 v_exp_f32 v10, v206
 v_exp_f32 v11, v207
 s_nop 0
 v_cvt_pk_bf16_f32 v239, v10, v11
 v_bitop3_b32 v12, v12, v239, s42 bitop3:0xa8
 v_cmp_ne_u32 vcc, 0, v12
 s_cbranch_vccnz L_b1_r1
L_b1_r1_ret:
 v_mfma_f32_16x16x32_bf16 a[96:99], a[128:131], v[236:239], a[96:99]
 buffer_store_dwordx4 v[152:155], v16, s[16:19], s62 offen offset:2048 sc1
 v_mfma_f32_16x16x32_bf16 a[100:103], a[132:135], v[236:239], a[100:103]
 v_mfma_f32_16x16x32_bf16 a[104:107], a[136:139], v[236:239], a[104:107]
 v_mfma_f32_16x16x32_bf16 a[108:111], a[140:143], v[236:239], a[108:111]
 s_waitcnt lgkmcnt(0)
 buffer_store_dwordx4 v[156:159], v16, s[16:19], s62 offen offset:3072 sc1
 v_mfma_f32_16x16x32_bf16 a[112:115], a[144:147], v[236:239], a[112:115]
 v_mfma_f32_16x16x32_bf16 a[116:119], a[148:151], v[236:239], a[116:119]
 v_mfma_f32_16x16x32_bf16 a[120:123], a[152:155], v[236:239], a[120:123]
 v_mfma_f32_16x16x32_bf16 a[124:127], a[156:159], v[236:239], a[124:127]
 v_mfma_f32_16x16x32_bf16 v[252:255], v[24:27], v[236:239], v[252:255]
 s_lshl_b32 s36, s2, 2
 s_add_u32 s36, s36, s32
 s_mul_i32 s43, s32, 27040
 s_lshl_b32 s44, s36, 12
 s_mul_i32 s59, s32, 2304
 v_mov_b32 v8, 0
 v_mov_b32 v9, 1
 s_nop 4
 v_accvgpr_read_b32 v36, a96
 v_accvgpr_read_b32 v37, a97
 v_accvgpr_read_b32 v38, a98
 v_accvgpr_read_b32 v39, a99
 v_accvgpr_read_b32 v40, a100
 v_accvgpr_read_b32 v41, a101
 v_accvgpr_read_b32 v42, a102
 v_accvgpr_read_b32 v43, a103
 v_rcp_f32 v32, v252
 s_nop 0
 v_pk_mul_f32 v[36:37], v[36:37], v[32:33] op_sel_hi:[1,0]
 v_pk_mul_f32 v[38:39], v[38:39], v[32:33] op_sel_hi:[1,0]
 v_pk_mul_f32 v[40:41], v[40:41], v[32:33] op_sel_hi:[1,0]
 v_pk_mul_f32 v[42:43], v[42:43], v[32:33] op_sel_hi:[1,0]
 v_cvt_pk_bf16_f32 v44, v36, v37
 v_cvt_pk_bf16_f32 v45, v38, v39
 v_cvt_pk_bf16_f32 v46, v40, v41
 v_cvt_pk_bf16_f32 v47, v42, v43
 buffer_store_dwordx4 v[44:47], v16, s[16:19], s63 offen offset:0 sc1
 v_accvgpr_read_b32 v36, a104
 v_accvgpr_read_b32 v37, a105
 v_accvgpr_read_b32 v38, a106
 v_accvgpr_read_b32 v39, a107
 v_accvgpr_read_b32 v40, a108
 v_accvgpr_read_b32 v41, a109
 v_accvgpr_read_b32 v42, a110
 v_accvgpr_read_b32 v43, a111
 v_pk_mul_f32 v[36:37], v[36:37], v[32:33] op_sel_hi:[1,0]
 v_pk_mul_f32 v[38:39], v[38:39], v[32:33] op_sel_hi:[1,0]
 v_pk_mul_f32 v[40:41], v[40:41], v[32:33] op_sel_hi:[1,0]
 v_pk_mul_f32 v[42:43], v[42:43], v[32:33] op_sel_hi:[1,0]
 v_cvt_pk_bf16_f32 v20, v36, v37
 v_cvt_pk_bf16_f32 v21, v38, v39
 v_cvt_pk_bf16_f32 v22, v40, v41
 v_cvt_pk_bf16_f32 v23, v42, v43
 buffer_store_dwordx4 v[20:23], v16, s[16:19], s63 offen offset:1024 sc1
 v_accvgpr_read_b32 v36, a112
 v_accvgpr_read_b32 v37, a113
 v_accvgpr_read_b32 v38, a114
 v_accvgpr_read_b32 v39, a115
 v_accvgpr_read_b32 v40, a116
 v_accvgpr_read_b32 v41, a117
 v_accvgpr_read_b32 v42, a118
 v_accvgpr_read_b32 v43, a119
 v_pk_mul_f32 v[36:37], v[36:37], v[32:33] op_sel_hi:[1,0]
 v_pk_mul_f32 v[38:39], v[38:39], v[32:33] op_sel_hi:[1,0]
 v_pk_mul_f32 v[40:41], v[40:41], v[32:33] op_sel_hi:[1,0]
 v_pk_mul_f32 v[42:43], v[42:43], v[32:33] op_sel_hi:[1,0]
 v_cvt_pk_bf16_f32 v44, v36, v37
 v_cvt_pk_bf16_f32 v45, v38, v39
 v_cvt_pk_bf16_f32 v46, v40, v41
 v_cvt_pk_bf16_f32 v47, v42, v43
 buffer_store_dwordx4 v[44:47], v16, s[16:19], s63 offen offset:2048 sc1
 v_accvgpr_read_b32 v36, a120
 v_accvgpr_read_b32 v37, a121
 v_accvgpr_read_b32 v38, a122
 v_accvgpr_read_b32 v39, a123
 v_accvgpr_read_b32 v40, a124
 v_accvgpr_read_b32 v41, a125
 v_accvgpr_read_b32 v42, a126
 v_accvgpr_read_b32 v43, a127
 v_pk_mul_f32 v[36:37], v[36:37], v[32:33] op_sel_hi:[1,0]
 v_pk_mul_f32 v[38:39], v[38:39], v[32:33] op_sel_hi:[1,0]
 v_pk_mul_f32 v[40:41], v[40:41], v[32:33] op_sel_hi:[1,0]
 v_pk_mul_f32 v[42:43], v[42:43], v[32:33] op_sel_hi:[1,0]
 v_cvt_pk_bf16_f32 v20, v36, v37
 v_cvt_pk_bf16_f32 v21, v38, v39
 v_cvt_pk_bf16_f32 v22, v40, v41
 v_cvt_pk_bf16_f32 v23, v42, v43
 buffer_store_dwordx4 v[20:23], v16, s[16:19], s63 offen offset:3072 sc1
 v_lshrrev_b32 v232, 4, v16
 v_and_b32 v6, 15, v232
 v_lshrrev_b32 v7, 4, v232
 v_and_b32 v233, 1, v6
 v_cmp_eq_u32 vcc, 1, v233
 v_mov_b32 v234, 4240
 v_lshlrev_b32 v235, 4, v7
 v_cndmask_b32 v234, v234, 8, vcc
 v_lshl_add_u32 v234, v6, 3, v234
 v_add3_u32 v3, v234, v235, s43
 v_and_b32 v236, 3, v6
 v_mul_u32_u24 v236, 4640, v236
 v_lshrrev_b32 v234, 2, v6
 v_lshlrev_b32 v234, 7, v234
 v_sub_u32 v236, v236, v234
 v_add3_u32 v4, v236, v235, s43
 v_add_u32 v4, 8864, v4
 v_mov_b32 v20, 0
 v_mov_b32 v21, 0
 v_mov_b32 v22, 0
 v_mov_b32 v23, 0
 v_and_b32 v234, 7, v232
 v_lshlrev_b32 v234, 4, v234
 v_bfe_u32 v235, v232, 3, 1
 v_mul_u32_u24 v235, 4240, v235
 v_add3_u32 v234, v234, v235, s43
 ds_write_b128 v234, v[20:23]
 v_min_u32 v235, 368, v16
 v_add_u32 v235, s43, v235
 ds_write_b128 v235, v[20:23] offset:12576
 ds_write_b128 v235, v[20:23] offset:17216
 ds_write_b128 v235, v[20:23] offset:21856
 ds_write_b128 v235, v[20:23] offset:26496
 v_lshlrev_b32 v236, 2, v6
 v_sub_u32 v236, 60, v236
 v_lshrrev_b32 v236, 3, v236
 v_sub_u32 v236, v236, v7
 v_lshl_add_u32 v236, v233, 4, v236
 s_waitcnt vmcnt(16)
 v_mov_b32 v234, s43
 ds_write_b64 v234, v[28:29] offset:4360
 v_mov_b32 v12, v30
 v_cmp_eq_u32 vcc, 16, v236
 v_mov_b32 v25, 0
 s_nop 0
 v_cndmask_b32 v24, 0, v12, vcc
 v_cmp_eq_u32 vcc, 0, v236
 v_mov_b32 v27, 0
 s_nop 0
 v_cndmask_b32 v26, 0, v12, vcc
 v_cmp_eq_u32 vcc, 20, v236
 v_mov_b32 v29, 0
 s_nop 0
 v_cndmask_b32 v28, 0, v12, vcc
 v_cmp_eq_u32 vcc, 4, v236
 v_mov_b32 v31, 0
 s_nop 0
 v_cndmask_b32 v30, 0, v12, vcc
 s_waitcnt vmcnt(8) lgkmcnt(0)
 s_barrier
 ds_read_b128 v[96:99], v4 offset:3584
 ds_read_b128 v[64:67], v3 offset:0
 ds_read_b128 v[100:103], v4 offset:3072
 ds_read_b128 v[68:71], v3 offset:512
 ds_read_b128 v[104:107], v4 offset:2560
 ds_read_b128 v[72:75], v3 offset:1024
 ds_read_b128 v[108:111], v4 offset:2048
 ds_read_b128 v[76:79], v3 offset:1536
 ds_read_b128 v[112:115], v4 offset:1536
 ds_read_b128 v[80:83], v3 offset:2048
 ds_read_b128 v[116:119], v4 offset:1024
 ds_read_b128 v[84:87], v3 offset:2560
 ds_read_b128 v[120:123], v4 offset:512
 ds_read_b128 v[88:91], v3 offset:3072
 ds_read_b128 v[124:127], v4 offset:0
 ds_read_b128 v[92:95], v3 offset:3584
 s_waitcnt lgkmcnt(0)
 v_mfma_f32_16x16x32_bf16 v[32:35], v[24:27], v[96:99], 0
 s_and_b32 s45, s2, 3
 s_bfe_u32 s38, s2, 0x20003
 v_mfma_f32_16x16x32_bf16 v[36:39], v[24:27], v[100:103], 0
 s_and_b32 s36, s2, 4
 s_add_u32 s38, s38, s36
 v_mfma_f32_16x16x32_bf16 v[40:43], v[24:27], v[104:107], 0
 ds_read_b128 v[160:163], v4 offset:3648
 s_lshr_b32 s39, s2, 5
 s_lshl_b32 s40, s45, 21
 v_mfma_f32_16x16x32_bf16 v[44:47], v[24:27], v[108:111], 0
 s_lshl_b32 s37, s32, 14
 s_add_u32 s40, s40, s37
 v_mfma_f32_16x16x32_bf16 v[48:51], v[24:27], v[112:115], 0
 ds_read_b128 v[128:131], v3 offset:64
 s_lshl_b32 s37, s39, 8
 s_add_u32 s40, s40, s37
 v_mfma_f32_16x16x32_bf16 v[52:55], v[24:27], v[116:119], 0
 s_lshl_b32 s52, s38, 2
 s_add_u32 s52, s52, s32
 v_mfma_f32_16x16x32_bf16 v[56:59], v[24:27], v[120:123], 0
 ds_read_b128 v[164:167], v4 offset:3136
 s_lshl_b32 s52, s52, 7
 s_lshl_b32 s37, s45, 5
 v_mfma_f32_16x16x32_bf16 v[60:63], v[24:27], v[124:127], 0
 s_add_u32 s52, s52, s37
 v_and_b32 v13, 7, v6
 v_lshlrev_b32 v13, 2, v13
 v_mfma_f32_16x16x32_bf16 v[32:35], v[64:67], v[96:99], v[32:35]
 s_add_u32 m0, s59, 108544
 ds_read_b128 v[132:135], v3 offset:576
 v_add_u32 v2, 524288, v16
 s_lshl_b32 s41, s38, 3
 s_add_u32 s41, s41, s32
 v_mfma_f32_16x16x32_bf16 v[36:39], v[64:67], v[100:103], v[36:39]
 buffer_load_dwordx4 v0, s[8:11], s40 offen offset:0 lds
 v_mfma_f32_16x16x32_bf16 v[40:43], v[64:67], v[104:107], v[40:43]
 ds_read_b128 v[168:171], v4 offset:2624
 s_lshl_b32 s41, s41, 17
 s_lshl_b32 s37, s45, 15
 v_mfma_f32_16x16x32_bf16 v[44:47], v[64:67], v[108:111], v[44:47]
 s_add_u32 s41, s41, s37
 s_add_u32 s42, s41, 8388608
 v_mfma_f32_16x16x32_bf16 v[48:51], v[64:67], v[112:115], v[48:51]
 ds_read_b128 v[136:139], v3 offset:1088
 v_mfma_f32_16x16x32_bf16 v[52:55], v[64:67], v[116:119], v[52:55]
 buffer_load_dwordx4 v1, s[8:11], s40 offen offset:1152 lds
 v_mfma_f32_16x16x32_bf16 v[56:59], v[64:67], v[120:123], v[56:59]
 ds_read_b128 v[172:175], v4 offset:2112
 v_mfma_f32_16x16x32_bf16 v[60:63], v[64:67], v[124:127], v[60:63]
 v_mfma_f32_16x16x32_bf16 v[36:39], v[68:71], v[96:99], v[36:39]
 s_add_u32 s40, s40, 65536
 ds_read_b128 v[140:143], v3 offset:1600
 v_mfma_f32_16x16x32_bf16 v[40:43], v[68:71], v[100:103], v[40:43]
 buffer_load_dword v14, v13, s[28:31], s52 offen sc1
 v_mfma_f32_16x16x32_bf16 v[44:47], v[68:71], v[104:107], v[44:47]
 ds_read_b128 v[176:179], v4 offset:1600
 v_mfma_f32_16x16x32_bf16 v[48:51], v[68:71], v[108:111], v[48:51]
 v_mfma_f32_16x16x32_bf16 v[52:55], v[68:71], v[112:115], v[52:55]
 s_add_u32 m0, s59, 117760
 ds_read_b128 v[144:147], v3 offset:2112
 v_mfma_f32_16x16x32_bf16 v[56:59], v[68:71], v[116:119], v[56:59]
 buffer_load_dwordx4 v0, s[8:11], s40 offen offset:0 lds
 v_mfma_f32_16x16x32_bf16 v[60:63], v[68:71], v[120:123], v[60:63]
 ds_read_b128 v[180:183], v4 offset:1088
 v_mfma_f32_16x16x32_bf16 v[40:43], v[72:75], v[96:99], v[40:43]
 v_mfma_f32_16x16x32_bf16 v[44:47], v[72:75], v[100:103], v[44:47]
 ds_read_b128 v[148:151], v3 offset:2624
 v_mfma_f32_16x16x32_bf16 v[48:51], v[72:75], v[104:107], v[48:51]
 buffer_load_dwordx4 v1, s[8:11], s40 offen offset:1152 lds
 v_mfma_f32_16x16x32_bf16 v[52:55], v[72:75], v[108:111], v[52:55]
 ds_read_b128 v[184:187], v4 offset:576
 v_mfma_f32_16x16x32_bf16 v[56:59], v[72:75], v[112:115], v[56:59]
L_pad12:
 s_cbranch_execz L_back
 v_mfma_f32_16x16x32_bf16 v[60:63], v[72:75], v[116:119], v[60:63]
 s_add_u32 s40, s40, 65536
 s_add_u32 m0, s59, 126976
 ds_read_b128 v[152:155], v3 offset:3136
 v_mfma_f32_16x16x32_bf16 v[44:47], v[76:79], v[96:99], v[44:47]
 buffer_load_dwordx4 v0, s[8:11], s40 offen offset:0 lds
 v_mfma_f32_16x16x32_bf16 v[48:51], v[76:79], v[100:103], v[48:51]
 ds_read_b128 v[188:191], v4 offset:64
 v_mfma_f32_16x16x32_bf16 v[52:55], v[76:79], v[104:107], v[52:55]
 v_mfma_f32_16x16x32_bf16 v[56:59], v[76:79], v[108:111], v[56:59]
 ds_read_b128 v[156:159], v3 offset:3648
 v_mfma_f32_16x16x32_bf16 v[60:63], v[76:79], v[112:115], v[60:63]
 buffer_load_dwordx4 v1, s[8:11], s40 offen offset:1152 lds
 v_mfma_f32_16x16x32_bf16 v[48:51], v[80:83], v[96:99], v[48:51]
 v_mfma_f32_16x16x32_bf16 v[52:55], v[80:83], v[100:103], v[52:55]
 v_mfma_f32_16x16x32_bf16 v[56:59], v[80:83], v[104:107], v[56:59]
 s_add_u32 s40, s40, 65536
 s_add_u32 m0, s59, 136192
 v_mfma_f32_16x16x32_bf16 v[60:63], v[80:83], v[108:111], v[60:63]
 buffer_load_dwordx4 v0, s[8:11], s40 offen offset:0 lds
 v_mfma_f32_16x16x32_bf16 v[52:55], v[84:87], v[96:99], v[52:55]
 v_mfma_f32_16x16x32_bf16 v[56:59], v[84:87], v[100:103], v[56:59]
 v_mfma_f32_16x16x32_bf16 v[60:63], v[84:87], v[104:107], v[60:63]
 v_mfma_f32_16x16x32_bf16 v[56:59], v[88:91], v[96:99], v[56:59]
 buffer_load_dwordx4 v1, s[8:11], s40 offen offset:1152 lds
 v_mfma_f32_16x16x32_bf16 v[60:63], v[88:91], v[100:103], v[60:63]
 v_mfma_f32_16x16x32_bf16 v[60:63], v[92:95], v[96:99], v[60:63]
 s_waitcnt lgkmcnt(0)
 v_mfma_f32_16x16x32_bf16 v[32:35], v[28:31], v[160:163], v[32:35]
 s_add_u32 s40, s40, 65536
 s_add_u32 m0, s59, 145408
 v_mul_u32_u24 v233, 1152, v7
 v_lshrrev_b32 v234, 2, v6
 v_mfma_f32_16x16x32_bf16 v[36:39], v[28:31], v[164:167], v[36:39]
 buffer_load_dwordx4 v0, s[8:11], s40 offen offset:0 lds
 v_mfma_f32_16x16x32_bf16 v[40:43], v[28:31], v[168:171], v[40:43]
 ds_read_b128 v[96:99], v4 offset:3712
 v_lshl_add_u32 v233, v234, 8, v233
 v_mfma_f32_16x16x32_bf16 v[44:47], v[28:31], v[172:175], v[44:47]
 v_and_b32 v235, 3, v6
 v_lshl_add_u32 v233, v235, 3, v233
 v_mfma_f32_16x16x32_bf16 v[48:51], v[28:31], v[176:179], v[48:51]
 ds_read_b128 v[64:67], v3 offset:128
 v_add_u32 v233, 80896, v233
 v_mfma_f32_16x16x32_bf16 v[52:55], v[28:31], v[180:183], v[52:55]
 buffer_load_dwordx4 v1, s[8:11], s40 offen offset:1152 lds
 v_mfma_f32_16x16x32_bf16 v[56:59], v[28:31], v[184:187], v[56:59]
 ds_read_b128 v[100:103], v4 offset:3200
 v_xor_b32 v236, 0, v234
 v_mfma_f32_16x16x32_bf16 v[60:63], v[28:31], v[188:191], v[60:63]
 v_lshl_add_u32 v17, v236, 5, v233
 v_xor_b32 v236, 1, v234
 v_mfma_f32_16x16x32_bf16 v[32:35], v[128:131], v[160:163], v[32:35]
 s_add_u32 s40, s40, 65536
 s_waitcnt vmcnt(11)
 ds_read_b128 v[68:71], v3 offset:640
 v_lshl_add_u32 v18, v236, 5, v233
 v_mfma_f32_16x16x32_bf16 v[36:39], v[128:131], v[164:167], v[36:39]
 buffer_store_dword v9, v8, s[28:31], s56 offen sc1
 v_mfma_f32_16x16x32_bf16 v[40:43], v[128:131], v[168:171], v[40:43]
 ds_read_b128 v[104:107], v4 offset:2688
 v_xor_b32 v236, 2, v234
 v_mfma_f32_16x16x32_bf16 v[44:47], v[128:131], v[172:175], v[44:47]
 v_lshl_add_u32 v19, v236, 5, v233
 v_xor_b32 v236, 3, v234
 v_mfma_f32_16x16x32_bf16 v[48:51], v[128:131], v[176:179], v[48:51]
 s_add_u32 m0, s59, 154624
 ds_read_b128 v[72:75], v3 offset:1152
 v_lshl_add_u32 v20, v236, 5, v233
 v_mfma_f32_16x16x32_bf16 v[52:55], v[128:131], v[180:183], v[52:55]
 buffer_load_dwordx4 v0, s[8:11], s40 offen offset:0 lds
 v_mfma_f32_16x16x32_bf16 v[56:59], v[128:131], v[184:187], v[56:59]
 ds_read_b128 v[108:111], v4 offset:2176
 v_lshlrev_b32 v236, 3, v7
 v_mfma_f32_16x16x32_bf16 v[60:63], v[128:131], v[188:191], v[60:63]
 v_lshl_add_u32 v5, v6, 5, v236
 v_lshl_add_u32 v21, v6, 13, v236
 v_mfma_f32_16x16x32_bf16 v[36:39], v[132:135], v[160:163], v[36:39]
 ds_read_b128 v[76:79], v3 offset:1664
 v_and_b32 v236, 1, v7
 v_mfma_f32_16x16x32_bf16 v[40:43], v[132:135], v[164:167], v[40:43]
 buffer_load_dwordx4 v1, s[8:11], s40 offen offset:1152 lds
 v_mfma_f32_16x16x32_bf16 v[44:47], v[132:135], v[168:171], v[44:47]
 ds_read_b128 v[112:115], v4 offset:1664
 v_mad_u32_u24 v21, v236, 24, v21
 v_mfma_f32_16x16x32_bf16 v[48:51], v[132:135], v[172:175], v[48:51]
 v_mul_u32_u24 v236, 504, v236
 v_add_u32 v5, v5, v236
 v_mfma_f32_16x16x32_bf16 v[52:55], v[132:135], v[176:179], v[52:55]
 s_add_u32 s40, s40, 65536
 ds_read_b128 v[80:83], v3 offset:2176
 v_lshlrev_b32 v10, 11, v7
 v_mfma_f32_16x16x32_bf16 v[56:59], v[132:135], v[180:183], v[56:59]
 v_lshl_add_u32 v10, v6, 4, v10
 v_lshrrev_b32 v236, 2, v232
 v_mfma_f32_16x16x32_bf16 v[60:63], v[132:135], v[184:187], v[60:63]
 ds_read_b128 v[116:119], v4 offset:1152
 v_lshlrev_b32 v236, 9, v236
 v_mfma_f32_16x16x32_bf16 v[40:43], v[136:139], v[160:163], v[40:43]
 v_lshl_add_u32 v236, v235, 3, v236
 s_lshl_b32 s37, s32, 5
 v_add_u32 v22, s37, v236
 v_mfma_f32_16x16x32_bf16 v[44:47], v[136:139], v[164:167], v[44:47]
 ds_read_b128 v[84:87], v3 offset:2688
 v_lshlrev_b32 v23, 4, v6
 s_lshl_b32 s48, s38, 7
 s_add_u32 s48, s48, s32
 v_mfma_f32_16x16x32_bf16 v[48:51], v[136:139], v[168:171], v[48:51]
 s_lshl_b32 s50, s48, 2
 s_lshl_b32 s48, s48, 11
 v_mfma_f32_16x16x32_bf16 v[52:55], v[136:139], v[172:175], v[52:55]
 ds_read_b128 v[120:123], v4 offset:640
 s_lshl_b32 s37, s39, 2
 s_add_u32 s37, s37, s45
 v_mfma_f32_16x16x32_bf16 v[56:59], v[136:139], v[176:179], v[56:59]
 s_lshl_b32 s51, s37, 2
 s_lshl_b32 s37, s37, 6
 v_mfma_f32_16x16x32_bf16 v[60:63], v[136:139], v[180:183], v[60:63]
 ds_read_b128 v[88:91], v3 offset:3200
 s_add_u32 s48, s48, s37
 s_add_u32 s51, s51, s32
 v_mfma_f32_16x16x32_bf16 v[44:47], v[140:143], v[160:163], v[44:47]
 s_lshl_b32 s53, s51, 5
 s_add_u32 s53, s53, 262144
 v_mfma_f32_16x16x32_bf16 v[48:51], v[140:143], v[164:167], v[48:51]
 ds_read_b128 v[124:127], v4 offset:128
 s_lshl_b32 s51, s51, 15
 s_lshl_b32 s37, s38, 8
 v_mfma_f32_16x16x32_bf16 v[52:55], v[140:143], v[168:171], v[52:55]
 s_add_u32 s51, s51, s37
 s_add_u32 s12, s94, 55574528
 s_addc_u32 s13, s95, 0
 v_mfma_f32_16x16x32_bf16 v[56:59], v[140:143], v[172:175], v[56:59]
 ds_read_b128 v[92:95], v3 offset:3712
 s_mov_b32 s14, 4194304
 s_mov_b32 s20, s90
 v_mfma_f32_16x16x32_bf16 v[60:63], v[140:143], v[176:179], v[60:63]
 s_mov_b32 s21, s91
 s_mov_b32 s22, 4194304
 v_mfma_f32_16x16x32_bf16 v[48:51], v[144:147], v[160:163], v[48:51]
 s_add_u32 s4, s94, 59768832
 s_addc_u32 s5, s95, 0
 s_mov_b32 s6, 8192
 v_mfma_f32_16x16x32_bf16 v[52:55], v[144:147], v[164:167], v[52:55]
 s_mov_b32 s24, s64
 s_mov_b32 s25, s65
 v_mfma_f32_16x16x32_bf16 v[56:59], v[144:147], v[168:171], v[56:59]
 s_mov_b32 s26, 4194304
 s_lshl_b32 s46, s44, 2
 v_mfma_f32_16x16x32_bf16 v[60:63], v[144:147], v[172:175], v[60:63]
 v_mfma_f32_16x16x32_bf16 v[52:55], v[148:151], v[160:163], v[52:55]
 v_mfma_f32_16x16x32_bf16 v[56:59], v[148:151], v[164:167], v[56:59]
 v_mfma_f32_16x16x32_bf16 v[60:63], v[148:151], v[168:171], v[60:63]
 s_add_u32 s36, s48, 0
 v_mfma_f32_16x16x32_bf16 v[56:59], v[152:155], v[160:163], v[56:59]
 buffer_load_dwordx4 v[24:27], v21, s[24:27], s36 offen
 v_mfma_f32_16x16x32_bf16 v[60:63], v[152:155], v[164:167], v[60:63]
 v_mfma_f32_16x16x32_bf16 v[60:63], v[156:159], v[160:163], v[60:63]
 s_waitcnt lgkmcnt(0)
 s_waitcnt vmcnt(12)
 v_cmp_ne_u32 vcc, 1, v14
 s_nop 0
 s_cbranch_vccnz L_spin_s
L_spin_s_ret:
 v_mfma_f32_16x16x32_bf16 v[32:35], v[64:67], v[96:99], v[32:35]
 s_add_u32 s36, s48, 131072
 v_mfma_f32_16x16x32_bf16 v[36:39], v[64:67], v[100:103], v[36:39]
 buffer_load_dwordx4 v[28:31], v21, s[24:27], s36 offen
 v_mfma_f32_16x16x32_bf16 v[40:43], v[64:67], v[104:107], v[40:43]
 ds_read_b128 v[160:163], v4 offset:3776
 v_mfma_f32_16x16x32_bf16 v[44:47], v[64:67], v[108:111], v[44:47]
 v_mfma_f32_16x16x32_bf16 v[48:51], v[64:67], v[112:115], v[48:51]
 s_add_u32 s36, s50, 0
 ds_read_b128 v[128:131], v3 offset:192
 v_mfma_f32_16x16x32_bf16 v[52:55], v[64:67], v[116:119], v[52:55]
 buffer_load_dword v6, v23, s[4:7], s36 offen sc1
 v_mfma_f32_16x16x32_bf16 v[56:59], v[64:67], v[120:123], v[56:59]
 ds_read_b128 v[164:167], v4 offset:3264
 v_mfma_f32_16x16x32_bf16 v[60:63], v[64:67], v[124:127], v[60:63]
 v_mfma_f32_16x16x32_bf16 v[36:39], v[68:71], v[96:99], v[36:39]
 s_add_u32 s36, s50, 256
 ds_read_b128 v[132:135], v3 offset:704
 v_mfma_f32_16x16x32_bf16 v[40:43], v[68:71], v[100:103], v[40:43]
 buffer_load_dword v7, v23, s[4:7], s36 offen sc1
 v_mfma_f32_16x16x32_bf16 v[44:47], v[68:71], v[104:107], v[44:47]
 ds_read_b128 v[168:171], v4 offset:2752
 v_mfma_f32_16x16x32_bf16 v[48:51], v[68:71], v[108:111], v[48:51]
 v_mfma_f32_16x16x32_bf16 v[52:55], v[68:71], v[112:115], v[52:55]
 s_add_u32 s36, s50, 4096
 ds_read_b128 v[136:139], v3 offset:1216
 v_mfma_f32_16x16x32_bf16 v[56:59], v[68:71], v[116:119], v[56:59]
 buffer_load_dword v11, v23, s[4:7], s36 offen sc1
 v_mfma_f32_16x16x32_bf16 v[60:63], v[68:71], v[120:123], v[60:63]
 ds_read_b128 v[172:175], v4 offset:2240
 v_mfma_f32_16x16x32_bf16 v[40:43], v[72:75], v[96:99], v[40:43]
 v_mfma_f32_16x16x32_bf16 v[44:47], v[72:75], v[100:103], v[44:47]
 s_add_u32 s36, s50, 4352
 ds_read_b128 v[140:143], v3 offset:1728
 v_mfma_f32_16x16x32_bf16 v[48:51], v[72:75], v[104:107], v[48:51]
 buffer_load_dword v12, v23, s[4:7], s36 offen sc1
 v_mfma_f32_16x16x32_bf16 v[52:55], v[72:75], v[108:111], v[52:55]
 ds_read_b128 v[176:179], v4 offset:1728
 v_mfma_f32_16x16x32_bf16 v[56:59], v[72:75], v[112:115], v[56:59]
 v_mfma_f32_16x16x32_bf16 v[60:63], v[72:75], v[116:119], v[60:63]
 ds_read_b128 v[144:147], v3 offset:2240
 v_mfma_f32_16x16x32_bf16 v[44:47], v[76:79], v[96:99], v[44:47]
 buffer_load_dwordx4 a[0:3], v16, s[16:19], s41 offen offset:0 sc1
 v_mfma_f32_16x16x32_bf16 v[48:51], v[76:79], v[100:103], v[48:51]
 ds_read_b128 v[180:183], v4 offset:1216
 v_mfma_f32_16x16x32_bf16 v[52:55], v[76:79], v[104:107], v[52:55]
 v_mfma_f32_16x16x32_bf16 v[56:59], v[76:79], v[108:111], v[56:59]
 ds_read_b128 v[148:151], v3 offset:2752
 v_mfma_f32_16x16x32_bf16 v[60:63], v[76:79], v[112:115], v[60:63]
 buffer_load_dwordx4 a[4:7], v2, s[16:19], s41 offen offset:0 sc1
 v_mfma_f32_16x16x32_bf16 v[48:51], v[80:83], v[96:99], v[48:51]
 ds_read_b128 v[184:187], v4 offset:704
 v_mfma_f32_16x16x32_bf16 v[52:55], v[80:83], v[100:103], v[52:55]
 v_mfma_f32_16x16x32_bf16 v[56:59], v[80:83], v[104:107], v[56:59]
 ds_read_b128 v[152:155], v3 offset:3264
 v_mfma_f32_16x16x32_bf16 v[60:63], v[80:83], v[108:111], v[60:63]
 buffer_load_dwordx4 a[8:11], v16, s[16:19], s41 offen offset:1024 sc1
 v_mfma_f32_16x16x32_bf16 v[52:55], v[84:87], v[96:99], v[52:55]
 ds_read_b128 v[188:191], v4 offset:192
 v_mfma_f32_16x16x32_bf16 v[56:59], v[84:87], v[100:103], v[56:59]
 v_mfma_f32_16x16x32_bf16 v[60:63], v[84:87], v[104:107], v[60:63]
 ds_read_b128 v[156:159], v3 offset:3776
 v_mfma_f32_16x16x32_bf16 v[56:59], v[88:91], v[96:99], v[56:59]
 buffer_load_dwordx4 a[12:15], v2, s[16:19], s41 offen offset:1024 sc1
 v_mfma_f32_16x16x32_bf16 v[60:63], v[88:91], v[100:103], v[60:63]
 v_mfma_f32_16x16x32_bf16 v[60:63], v[92:95], v[96:99], v[60:63]
 s_waitcnt lgkmcnt(0)
 v_mfma_f32_16x16x32_bf16 v[32:35], v[128:131], v[160:163], v[32:35]
 v_mfma_f32_16x16x32_bf16 v[36:39], v[128:131], v[164:167], v[36:39]
 buffer_load_dwordx4 a[16:19], v16, s[16:19], s41 offen offset:2048 sc1
 v_mfma_f32_16x16x32_bf16 v[40:43], v[128:131], v[168:171], v[40:43]
 ds_read_b128 v[96:99], v4 offset:3840
 v_mfma_f32_16x16x32_bf16 v[44:47], v[128:131], v[172:175], v[44:47]
 v_mfma_f32_16x16x32_bf16 v[48:51], v[128:131], v[176:179], v[48:51]
 ds_read_b128 v[64:67], v3 offset:256
 v_mfma_f32_16x16x32_bf16 v[52:55], v[128:131], v[180:183], v[52:55]
 buffer_load_dwordx4 a[20:23], v2, s[16:19], s41 offen offset:2048 sc1
 v_mfma_f32_16x16x32_bf16 v[56:59], v[128:131], v[184:187], v[56:59]
 ds_read_b128 v[100:103], v4 offset:3328
 v_mfma_f32_16x16x32_bf16 v[60:63], v[128:131], v[188:191], v[60:63]
 v_mfma_f32_16x16x32_bf16 v[36:39], v[132:135], v[160:163], v[36:39]
 ds_read_b128 v[68:71], v3 offset:768
 v_mfma_f32_16x16x32_bf16 v[40:43], v[132:135], v[164:167], v[40:43]
 buffer_load_dwordx4 a[24:27], v16, s[16:19], s41 offen offset:3072 sc1
 v_mfma_f32_16x16x32_bf16 v[44:47], v[132:135], v[168:171], v[44:47]
 ds_read_b128 v[104:107], v4 offset:2816
 v_mfma_f32_16x16x32_bf16 v[48:51], v[132:135], v[172:175], v[48:51]
 v_mfma_f32_16x16x32_bf16 v[52:55], v[132:135], v[176:179], v[52:55]
 ds_read_b128 v[72:75], v3 offset:1280
 v_mfma_f32_16x16x32_bf16 v[56:59], v[132:135], v[180:183], v[56:59]
 buffer_load_dwordx4 a[28:31], v2, s[16:19], s41 offen offset:3072 sc1
 v_mfma_f32_16x16x32_bf16 v[60:63], v[132:135], v[184:187], v[60:63]
 ds_read_b128 v[108:111], v4 offset:2304
 v_mfma_f32_16x16x32_bf16 v[40:43], v[136:139], v[160:163], v[40:43]
 v_mfma_f32_16x16x32_bf16 v[44:47], v[136:139], v[164:167], v[44:47]
 s_add_u32 s41, s41, 4096
 ds_read_b128 v[76:79], v3 offset:1792
 v_mfma_f32_16x16x32_bf16 v[48:51], v[136:139], v[168:171], v[48:51]
 buffer_load_dwordx4 a[32:35], v16, s[16:19], s41 offen offset:0 sc1
 v_mfma_f32_16x16x32_bf16 v[52:55], v[136:139], v[172:175], v[52:55]
 ds_read_b128 v[112:115], v4 offset:1792
 v_mfma_f32_16x16x32_bf16 v[56:59], v[136:139], v[176:179], v[56:59]
 v_mfma_f32_16x16x32_bf16 v[60:63], v[136:139], v[180:183], v[60:63]
 ds_read_b128 v[80:83], v3 offset:2304
 v_mfma_f32_16x16x32_bf16 v[44:47], v[140:143], v[160:163], v[44:47]
 buffer_load_dwordx4 a[36:39], v2, s[16:19], s41 offen offset:0 sc1
 v_mfma_f32_16x16x32_bf16 v[48:51], v[140:143], v[164:167], v[48:51]
 ds_read_b128 v[116:119], v4 offset:1280
 v_mfma_f32_16x16x32_bf16 v[52:55], v[140:143], v[168:171], v[52:55]
 v_mfma_f32_16x16x32_bf16 v[56:59], v[140:143], v[172:175], v[56:59]
 ds_read_b128 v[84:87], v3 offset:2816
 v_mfma_f32_16x16x32_bf16 v[60:63], v[140:143], v[176:179], v[60:63]
 buffer_load_dwordx4 a[40:43], v16, s[16:19], s41 offen offset:1024 sc1
 v_mfma_f32_16x16x32_bf16 v[48:51], v[144:147], v[160:163], v[48:51]
 ds_read_b128 v[120:123], v4 offset:768
 v_mfma_f32_16x16x32_bf16 v[52:55], v[144:147], v[164:167], v[52:55]
 v_mfma_f32_16x16x32_bf16 v[56:59], v[144:147], v[168:171], v[56:59]
 ds_read_b128 v[88:91], v3 offset:3328
 v_mfma_f32_16x16x32_bf16 v[60:63], v[144:147], v[172:175], v[60:63]
 buffer_load_dwordx4 a[44:47], v2, s[16:19], s41 offen offset:1024 sc1
 v_mfma_f32_16x16x32_bf16 v[52:55], v[148:151], v[160:163], v[52:55]
 ds_read_b128 v[124:127], v4 offset:256
 v_mfma_f32_16x16x32_bf16 v[56:59], v[148:151], v[164:167], v[56:59]
 v_mfma_f32_16x16x32_bf16 v[60:63], v[148:151], v[168:171], v[60:63]
 ds_read_b128 v[92:95], v3 offset:3840
 v_mfma_f32_16x16x32_bf16 v[56:59], v[152:155], v[160:163], v[56:59]
 buffer_load_dwordx4 a[48:51], v16, s[16:19], s41 offen offset:2048 sc1
 v_mfma_f32_16x16x32_bf16 v[60:63], v[152:155], v[164:167], v[60:63]
 v_mfma_f32_16x16x32_bf16 v[60:63], v[156:159], v[160:163], v[60:63]
 s_waitcnt lgkmcnt(0)
 v_mfma_f32_16x16x32_bf16 v[32:35], v[64:67], v[96:99], v[32:35]
 v_mfma_f32_16x16x32_bf16 v[36:39], v[64:67], v[100:103], v[36:39]
 buffer_load_dwordx4 a[52:55], v2, s[16:19], s41 offen offset:2048 sc1
 v_mfma_f32_16x16x32_bf16 v[40:43], v[64:67], v[104:107], v[40:43]
 ds_read_b128 v[160:163], v4 offset:3904
 v_mfma_f32_16x16x32_bf16 v[44:47], v[64:67], v[108:111], v[44:47]
 v_mfma_f32_16x16x32_bf16 v[48:51], v[64:67], v[112:115], v[48:51]
 s_add_u32 s52, s52, 4096
 ds_read_b128 v[128:131], v3 offset:320
 v_mfma_f32_16x16x32_bf16 v[52:55], v[64:67], v[116:119], v[52:55]
 buffer_load_dword v14, v13, s[28:31], s52 offen sc1
 v_mfma_f32_16x16x32_bf16 v[56:59], v[64:67], v[120:123], v[56:59]
 ds_read_b128 v[164:167], v4 offset:3392
 v_mfma_f32_16x16x32_bf16 v[60:63], v[64:67], v[124:127], v[60:63]
 v_mfma_f32_16x16x32_bf16 v[36:39], v[68:71], v[96:99], v[36:39]
 ds_read_b128 v[132:135], v3 offset:832
 v_mfma_f32_16x16x32_bf16 v[40:43], v[68:71], v[100:103], v[40:43]
 buffer_load_dwordx4 a[56:59], v16, s[16:19], s41 offen offset:3072 sc1
 v_mfma_f32_16x16x32_bf16 v[44:47], v[68:71], v[104:107], v[44:47]
 ds_read_b128 v[168:171], v4 offset:2880
 v_mfma_f32_16x16x32_bf16 v[48:51], v[68:71], v[108:111], v[48:51]
 v_mfma_f32_16x16x32_bf16 v[52:55], v[68:71], v[112:115], v[52:55]
 ds_read_b128 v[136:139], v3 offset:1344
 v_mfma_f32_16x16x32_bf16 v[56:59], v[68:71], v[116:119], v[56:59]
 buffer_load_dwordx4 a[60:63], v2, s[16:19], s41 offen offset:3072 sc1
 v_mfma_f32_16x16x32_bf16 v[60:63], v[68:71], v[120:123], v[60:63]
 ds_read_b128 v[172:175], v4 offset:2368
 v_mfma_f32_16x16x32_bf16 v[40:43], v[72:75], v[96:99], v[40:43]
 v_mfma_f32_16x16x32_bf16 v[44:47], v[72:75], v[100:103], v[44:47]
 s_add_u32 s41, s41, 4096
 ds_read_b128 v[140:143], v3 offset:1856
 v_mfma_f32_16x16x32_bf16 v[48:51], v[72:75], v[104:107], v[48:51]
 buffer_load_dwordx4 a[64:67], v16, s[16:19], s41 offen offset:0 sc1
 v_mfma_f32_16x16x32_bf16 v[52:55], v[72:75], v[108:111], v[52:55]
 ds_read_b128 v[176:179], v4 offset:1856
 v_mfma_f32_16x16x32_bf16 v[56:59], v[72:75], v[112:115], v[56:59]
 v_mfma_f32_16x16x32_bf16 v[60:63], v[72:75], v[116:119], v[60:63]
 ds_read_b128 v[144:147], v3 offset:2368
 v_mfma_f32_16x16x32_bf16 v[44:47], v[76:79], v[96:99], v[44:47]
 buffer_load_dwordx4 a[68:71], v2, s[16:19], s41 offen offset:0 sc1
 v_mfma_f32_16x16x32_bf16 v[48:51], v[76:79], v[100:103], v[48:51]
 ds_read_b128 v[180:183], v4 offset:1344
 v_mfma_f32_16x16x32_bf16 v[52:55], v[76:79], v[104:107], v[52:55]
 v_mfma_f32_16x16x32_bf16 v[56:59], v[76:79], v[108:111], v[56:59]
 ds_read_b128 v[148:151], v3 offset:2880
 v_mfma_f32_16x16x32_bf16 v[60:63], v[76:79], v[112:115], v[60:63]
 buffer_load_dwordx4 a[72:75], v16, s[16:19], s41 offen offset:1024 sc1
 v_mfma_f32_16x16x32_bf16 v[48:51], v[80:83], v[96:99], v[48:51]
 ds_read_b128 v[184:187], v4 offset:832
 v_mfma_f32_16x16x32_bf16 v[52:55], v[80:83], v[100:103], v[52:55]
 v_mfma_f32_16x16x32_bf16 v[56:59], v[80:83], v[104:107], v[56:59]
 ds_read_b128 v[152:155], v3 offset:3392
 v_mfma_f32_16x16x32_bf16 v[60:63], v[80:83], v[108:111], v[60:63]
 buffer_load_dwordx4 a[76:79], v2, s[16:19], s41 offen offset:1024 sc1
 v_mfma_f32_16x16x32_bf16 v[52:55], v[84:87], v[96:99], v[52:55]
 ds_read_b128 v[188:191], v4 offset:320
 v_mfma_f32_16x16x32_bf16 v[56:59], v[84:87], v[100:103], v[56:59]
 v_mfma_f32_16x16x32_bf16 v[60:63], v[84:87], v[104:107], v[60:63]
 ds_read_b128 v[156:159], v3 offset:3904
 v_mfma_f32_16x16x32_bf16 v[56:59], v[88:91], v[96:99], v[56:59]
 buffer_load_dwordx4 a[80:83], v16, s[16:19], s41 offen offset:2048 sc1
 v_mfma_f32_16x16x32_bf16 v[60:63], v[88:91], v[100:103], v[60:63]
 v_mfma_f32_16x16x32_bf16 v[60:63], v[92:95], v[96:99], v[60:63]
 s_waitcnt lgkmcnt(0)
 s_waitcnt vmcnt(7)
 v_cmp_ne_u32 vcc, 1, v14
 s_nop 0
 s_cbranch_vccnz L_spin_l
L_spin_l_ret:
 v_mfma_f32_16x16x32_bf16 v[32:35], v[128:131], v[160:163], v[32:35]
 v_mfma_f32_16x16x32_bf16 v[36:39], v[128:131], v[164:167], v[36:39]
 buffer_load_dwordx4 a[84:87], v2, s[16:19], s41 offen offset:2048 sc1
 v_mfma_f32_16x16x32_bf16 v[40:43], v[128:131], v[168:171], v[40:43]
 ds_read_b128 v[96:99], v4 offset:3968
 v_mfma_f32_16x16x32_bf16 v[44:47], v[128:131], v[172:175], v[44:47]
 v_mfma_f32_16x16x32_bf16 v[48:51], v[128:131], v[176:179], v[48:51]
 ds_read_b128 v[64:67], v3 offset:384
 v_mfma_f32_16x16x32_bf16 v[52:55], v[128:131], v[180:183], v[52:55]
 buffer_load_dwordx4 a[128:131], v16, s[16:19], s42 offen offset:0 sc1
 v_mfma_f32_16x16x32_bf16 v[56:59], v[128:131], v[184:187], v[56:59]
 ds_read_b128 v[100:103], v4 offset:3456
 v_mfma_f32_16x16x32_bf16 v[60:63], v[128:131], v[188:191], v[60:63]
 v_mfma_f32_16x16x32_bf16 v[36:39], v[132:135], v[160:163], v[36:39]
 ds_read_b128 v[68:71], v3 offset:896
 v_mfma_f32_16x16x32_bf16 v[40:43], v[132:135], v[164:167], v[40:43]
 buffer_load_dwordx4 a[132:135], v2, s[16:19], s42 offen offset:0 sc1
 v_mfma_f32_16x16x32_bf16 v[44:47], v[132:135], v[168:171], v[44:47]
 ds_read_b128 v[104:107], v4 offset:2944
 v_mfma_f32_16x16x32_bf16 v[48:51], v[132:135], v[172:175], v[48:51]
 v_mfma_f32_16x16x32_bf16 v[52:55], v[132:135], v[176:179], v[52:55]
 ds_read_b128 v[72:75], v3 offset:1408
 v_mfma_f32_16x16x32_bf16 v[56:59], v[132:135], v[180:183], v[56:59]
 buffer_load_dwordx4 a[136:139], v16, s[16:19], s42 offen offset:1024 sc1
 v_mfma_f32_16x16x32_bf16 v[60:63], v[132:135], v[184:187], v[60:63]
 ds_read_b128 v[108:111], v4 offset:2432
 v_mfma_f32_16x16x32_bf16 v[40:43], v[136:139], v[160:163], v[40:43]
 v_mfma_f32_16x16x32_bf16 v[44:47], v[136:139], v[164:167], v[44:47]
 ds_read_b128 v[76:79], v3 offset:1920
 v_mfma_f32_16x16x32_bf16 v[48:51], v[136:139], v[168:171], v[48:51]
 buffer_load_dwordx4 a[140:143], v2, s[16:19], s42 offen offset:1024 sc1
 v_mfma_f32_16x16x32_bf16 v[52:55], v[136:139], v[172:175], v[52:55]
 ds_read_b128 v[112:115], v4 offset:1920
 v_mfma_f32_16x16x32_bf16 v[56:59], v[136:139], v[176:179], v[56:59]
 v_mfma_f32_16x16x32_bf16 v[60:63], v[136:139], v[180:183], v[60:63]
 ds_read_b128 v[80:83], v3 offset:2432
 v_mfma_f32_16x16x32_bf16 v[44:47], v[140:143], v[160:163], v[44:47]
 buffer_load_dwordx4 a[144:147], v16, s[16:19], s42 offen offset:2048 sc1
 v_mfma_f32_16x16x32_bf16 v[48:51], v[140:143], v[164:167], v[48:51]
 ds_read_b128 v[116:119], v4 offset:1408
 v_mfma_f32_16x16x32_bf16 v[52:55], v[140:143], v[168:171], v[52:55]
 v_mfma_f32_16x16x32_bf16 v[56:59], v[140:143], v[172:175], v[56:59]
 ds_read_b128 v[84:87], v3 offset:2944
 v_mfma_f32_16x16x32_bf16 v[60:63], v[140:143], v[176:179], v[60:63]
 buffer_load_dwordx4 a[148:151], v2, s[16:19], s42 offen offset:2048 sc1
 v_mfma_f32_16x16x32_bf16 v[48:51], v[144:147], v[160:163], v[48:51]
 ds_read_b128 v[120:123], v4 offset:896
 v_mfma_f32_16x16x32_bf16 v[52:55], v[144:147], v[164:167], v[52:55]
 v_mfma_f32_16x16x32_bf16 v[56:59], v[144:147], v[168:171], v[56:59]
 ds_read_b128 v[88:91], v3 offset:3456
 v_mfma_f32_16x16x32_bf16 v[60:63], v[144:147], v[172:175], v[60:63]
 buffer_load_dwordx4 a[152:155], v16, s[16:19], s42 offen offset:3072 sc1
 v_mfma_f32_16x16x32_bf16 v[52:55], v[148:151], v[160:163], v[52:55]
 ds_read_b128 v[124:127], v4 offset:384
 v_mfma_f32_16x16x32_bf16 v[56:59], v[148:151], v[164:167], v[56:59]
 v_mfma_f32_16x16x32_bf16 v[60:63], v[148:151], v[168:171], v[60:63]
 ds_read_b128 v[92:95], v3 offset:3968
 v_mfma_f32_16x16x32_bf16 v[56:59], v[152:155], v[160:163], v[56:59]
 buffer_load_dwordx4 a[156:159], v2, s[16:19], s42 offen offset:3072 sc1
 v_mfma_f32_16x16x32_bf16 v[60:63], v[152:155], v[164:167], v[60:63]
 v_mfma_f32_16x16x32_bf16 v[60:63], v[156:159], v[160:163], v[60:63]
 s_waitcnt lgkmcnt(0)
 v_mfma_f32_16x16x32_bf16 v[32:35], v[64:67], v[96:99], v[32:35]
 s_add_u32 s42, s42, 4096
 v_mfma_f32_16x16x32_bf16 v[36:39], v[64:67], v[100:103], v[36:39]
 buffer_load_dwordx4 a[160:163], v16, s[16:19], s42 offen offset:0 sc1
 v_mfma_f32_16x16x32_bf16 v[40:43], v[64:67], v[104:107], v[40:43]
 ds_read_b128 v[160:163], v4 offset:4032
 v_mfma_f32_16x16x32_bf16 v[44:47], v[64:67], v[108:111], v[44:47]
 v_mfma_f32_16x16x32_bf16 v[48:51], v[64:67], v[112:115], v[48:51]
 ds_read_b128 v[128:131], v3 offset:448
 v_mfma_f32_16x16x32_bf16 v[52:55], v[64:67], v[116:119], v[52:55]
 buffer_load_dwordx4 a[164:167], v2, s[16:19], s42 offen offset:0 sc1
 v_mfma_f32_16x16x32_bf16 v[56:59], v[64:67], v[120:123], v[56:59]
 ds_read_b128 v[164:167], v4 offset:3520
 v_mfma_f32_16x16x32_bf16 v[60:63], v[64:67], v[124:127], v[60:63]
 v_mfma_f32_16x16x32_bf16 v[36:39], v[68:71], v[96:99], v[36:39]
 ds_read_b128 v[132:135], v3 offset:960
 v_mfma_f32_16x16x32_bf16 v[40:43], v[68:71], v[100:103], v[40:43]
 buffer_load_dwordx4 a[168:171], v16, s[16:19], s42 offen offset:1024 sc1
 v_mfma_f32_16x16x32_bf16 v[44:47], v[68:71], v[104:107], v[44:47]
 ds_read_b128 v[168:171], v4 offset:3008
 v_mfma_f32_16x16x32_bf16 v[48:51], v[68:71], v[108:111], v[48:51]
 v_mfma_f32_16x16x32_bf16 v[52:55], v[68:71], v[112:115], v[52:55]
 ds_read_b128 v[136:139], v3 offset:1472
 v_mfma_f32_16x16x32_bf16 v[56:59], v[68:71], v[116:119], v[56:59]
 buffer_load_dwordx4 a[172:175], v2, s[16:19], s42 offen offset:1024 sc1
 v_mfma_f32_16x16x32_bf16 v[60:63], v[68:71], v[120:123], v[60:63]
 ds_read_b128 v[172:175], v4 offset:2496
 v_mfma_f32_16x16x32_bf16 v[40:43], v[72:75], v[96:99], v[40:43]
 v_mfma_f32_16x16x32_bf16 v[44:47], v[72:75], v[100:103], v[44:47]
 ds_read_b128 v[140:143], v3 offset:1984
 v_mfma_f32_16x16x32_bf16 v[48:51], v[72:75], v[104:107], v[48:51]
 buffer_load_dwordx4 a[176:179], v16, s[16:19], s42 offen offset:2048 sc1
 v_mfma_f32_16x16x32_bf16 v[52:55], v[72:75], v[108:111], v[52:55]
 ds_read_b128 v[176:179], v4 offset:1984
 v_mfma_f32_16x16x32_bf16 v[56:59], v[72:75], v[112:115], v[56:59]
 v_mfma_f32_16x16x32_bf16 v[60:63], v[72:75], v[116:119], v[60:63]
 ds_read_b128 v[144:147], v3 offset:2496
 v_mfma_f32_16x16x32_bf16 v[44:47], v[76:79], v[96:99], v[44:47]
 buffer_load_dwordx4 a[180:183], v2, s[16:19], s42 offen offset:2048 sc1
 v_mfma_f32_16x16x32_bf16 v[48:51], v[76:79], v[100:103], v[48:51]
 ds_read_b128 v[180:183], v4 offset:1472
 v_mfma_f32_16x16x32_bf16 v[52:55], v[76:79], v[104:107], v[52:55]
 v_mfma_f32_16x16x32_bf16 v[56:59], v[76:79], v[108:111], v[56:59]
 ds_read_b128 v[148:151], v3 offset:3008
 v_mfma_f32_16x16x32_bf16 v[60:63], v[76:79], v[112:115], v[60:63]
 buffer_load_dwordx4 a[184:187], v16, s[16:19], s42 offen offset:3072 sc1
 v_mfma_f32_16x16x32_bf16 v[48:51], v[80:83], v[96:99], v[48:51]
 ds_read_b128 v[184:187], v4 offset:960
 v_mfma_f32_16x16x32_bf16 v[52:55], v[80:83], v[100:103], v[52:55]
 v_mfma_f32_16x16x32_bf16 v[56:59], v[80:83], v[104:107], v[56:59]
 ds_read_b128 v[152:155], v3 offset:3520
 v_mfma_f32_16x16x32_bf16 v[60:63], v[80:83], v[108:111], v[60:63]
 buffer_load_dwordx4 a[188:191], v2, s[16:19], s42 offen offset:3072 sc1
 v_mfma_f32_16x16x32_bf16 v[52:55], v[84:87], v[96:99], v[52:55]
 ds_read_b128 v[188:191], v4 offset:448
 v_mfma_f32_16x16x32_bf16 v[56:59], v[84:87], v[100:103], v[56:59]
 v_mfma_f32_16x16x32_bf16 v[60:63], v[84:87], v[104:107], v[60:63]
 s_add_u32 s42, s42, 4096
 ds_read_b128 v[156:159], v3 offset:4032
 v_mfma_f32_16x16x32_bf16 v[56:59], v[88:91], v[96:99], v[56:59]
 buffer_load_dwordx4 a[88:91], v16, s[16:19], s41 offen offset:3072 sc1
 v_mfma_f32_16x16x32_bf16 v[60:63], v[88:91], v[100:103], v[60:63]
 v_mfma_f32_16x16x32_bf16 v[60:63], v[92:95], v[96:99], v[60:63]
 s_waitcnt lgkmcnt(0)
 buffer_load_dwordx4 a[92:95], v2, s[16:19], s41 offen offset:3072 sc1
 s_waitcnt vmcnt(47)
 s_barrier
 s_add_u32 s40, s40, 262144
 v_mfma_f32_16x16x32_bf16 v[32:35], v[128:131], v[160:163], v[32:35]
 s_add_u32 s41, s41, 4096
 s_add_u32 m0, s59, 53248
 ds_read_b64_tr_b16 v[192:193], v17 offset:27648
 ds_read_b64_tr_b16 v[194:195], v17 offset:32256
 v_mfma_f32_16x16x32_bf16 v[36:39], v[128:131], v[164:167], v[36:39]
 buffer_load_dwordx4 v0, s[8:11], s40 offen offset:0 lds
 v_mfma_f32_16x16x32_bf16 v[40:43], v[128:131], v[168:171], v[40:43]
 ds_read_b64_tr_b16 v[196:197], v18 offset:27648
 ds_read_b64_tr_b16 v[198:199], v18 offset:32256
 v_mfma_f32_16x16x32_bf16 v[44:47], v[128:131], v[172:175], v[44:47]
 ds_read_b64_tr_b16 v[200:201], v19 offset:27648
 ds_read_b64_tr_b16 v[202:203], v19 offset:32256
 v_mfma_f32_16x16x32_bf16 v[48:51], v[128:131], v[176:179], v[48:51]
 ds_read_b64_tr_b16 v[204:205], v20 offset:27648
 ds_read_b64_tr_b16 v[206:207], v20 offset:32256
 v_mfma_f32_16x16x32_bf16 v[52:55], v[128:131], v[180:183], v[52:55]
 buffer_load_dwordx4 v1, s[8:11], s40 offen offset:1152 lds
 v_mfma_f32_16x16x32_bf16 v[56:59], v[128:131], v[184:187], v[56:59]
 ds_read_b64_tr_b16 v[208:209], v17 offset:27776
 ds_read_b64_tr_b16 v[210:211], v17 offset:32384
 v_mfma_f32_16x16x32_bf16 v[60:63], v[128:131], v[188:191], v[60:63]
 ds_read_b64_tr_b16 v[212:213], v18 offset:27776
 ds_read_b64_tr_b16 v[214:215], v18 offset:32384
 v_mfma_f32_16x16x32_bf16 v[36:39], v[132:135], v[160:163], v[36:39]
 s_add_u32 s40, s40, 65536
 s_add_u32 m0, s59, 62464
 ds_read_b64_tr_b16 v[216:217], v19 offset:27776
 ds_read_b64_tr_b16 v[218:219], v19 offset:32384
 v_mfma_f32_16x16x32_bf16 v[40:43], v[132:135], v[164:167], v[40:43]
 buffer_load_dwordx4 v0, s[8:11], s40 offen offset:0 lds
 v_mfma_f32_16x16x32_bf16 v[44:47], v[132:135], v[168:171], v[44:47]
 ds_read_b64_tr_b16 v[220:221], v20 offset:27776
 ds_read_b64_tr_b16 v[222:223], v20 offset:32384
 s_add_u32 s37, s59, 16384
 v_mfma_f32_16x16x32_bf16 v[48:51], v[132:135], v[172:175], v[48:51]
 v_add_u32 v233, s37, v16
 v_add_u32 v234, 1152, v233
 v_mfma_f32_16x16x32_bf16 v[52:55], v[132:135], v[176:179], v[52:55]
 ds_write_b128 v233, a[192:195] offset:0
 ds_write_b128 v234, a[196:199] offset:0
 v_mfma_f32_16x16x32_bf16 v[56:59], v[132:135], v[180:183], v[56:59]
 buffer_load_dwordx4 v1, s[8:11], s40 offen offset:1152 lds
 v_mfma_f32_16x16x32_bf16 v[60:63], v[132:135], v[184:187], v[60:63]
 ds_write_b128 v233, a[200:203] offset:9216
 ds_write_b128 v234, a[204:207] offset:9216
 v_mfma_f32_16x16x32_bf16 v[40:43], v[136:139], v[160:163], v[40:43]
 ds_write_b128 v233, a[208:211] offset:18432
 ds_write_b128 v234, a[212:215] offset:18432
 v_mfma_f32_16x16x32_bf16 v[44:47], v[136:139], v[164:167], v[44:47]
L_pad13:
 s_cbranch_execz L_back
 s_add_u32 s40, s40, 65536
 s_add_u32 m0, s59, 71680
 ds_write_b128 v233, a[216:219] offset:27648
 ds_write_b128 v234, a[220:223] offset:27648
 v_mfma_f32_16x16x32_bf16 v[48:51], v[136:139], v[168:171], v[48:51]
 buffer_load_dwordx4 v0, s[8:11], s40 offen offset:0 lds
 v_mfma_f32_16x16x32_bf16 v[52:55], v[136:139], v[172:175], v[52:55]
 v_mfma_f32_16x16x32_bf16 v[56:59], v[136:139], v[176:179], v[56:59]
 v_mfma_f32_16x16x32_bf16 v[60:63], v[136:139], v[180:183], v[60:63]
 v_mfma_f32_16x16x32_bf16 v[44:47], v[140:143], v[160:163], v[44:47]
 buffer_load_dwordx4 v1, s[8:11], s40 offen offset:1152 lds
 v_mfma_f32_16x16x32_bf16 v[48:51], v[140:143], v[164:167], v[48:51]
 v_mfma_f32_16x16x32_bf16 v[52:55], v[140:143], v[168:171], v[52:55]
 v_mfma_f32_16x16x32_bf16 v[56:59], v[140:143], v[172:175], v[56:59]
 s_add_u32 s40, s40, 65536
 v_mfma_f32_16x16x32_bf16 v[60:63], v[140:143], v[176:179], v[60:63]
 buffer_load_dwordx4 a[192:195], v16, s[16:19], s42 offen offset:0 sc1
 v_mfma_f32_16x16x32_bf16 v[48:51], v[144:147], v[160:163], v[48:51]
 v_mfma_f32_16x16x32_bf16 v[52:55], v[144:147], v[164:167], v[52:55]
 v_mfma_f32_16x16x32_bf16 v[56:59], v[144:147], v[168:171], v[56:59]
 v_mfma_f32_16x16x32_bf16 v[60:63], v[144:147], v[172:175], v[60:63]
 buffer_load_dwordx4 a[196:199], v2, s[16:19], s42 offen offset:0 sc1
 v_mfma_f32_16x16x32_bf16 v[52:55], v[148:151], v[160:163], v[52:55]
 v_mfma_f32_16x16x32_bf16 v[56:59], v[148:151], v[164:167], v[56:59]
 v_mfma_f32_16x16x32_bf16 v[60:63], v[148:151], v[168:171], v[60:63]
 v_mfma_f32_16x16x32_bf16 v[56:59], v[152:155], v[160:163], v[56:59]
 buffer_load_dwordx4 a[200:203], v16, s[16:19], s42 offen offset:1024 sc1
 v_mfma_f32_16x16x32_bf16 v[60:63], v[152:155], v[164:167], v[60:63]
 v_mfma_f32_16x16x32_bf16 v[60:63], v[156:159], v[160:163], v[60:63]
 s_nop 4
 v_cvt_pk_bf16_f32 v32, v32, v33
 v_cvt_pk_bf16_f32 v33, v34, v35
 v_cvt_pk_bf16_f32 v34, v36, v37
 v_cvt_pk_bf16_f32 v35, v38, v39
 v_cvt_pk_bf16_f32 v40, v40, v41
 v_cvt_pk_bf16_f32 v41, v42, v43
 v_cvt_pk_bf16_f32 v42, v44, v45
 v_cvt_pk_bf16_f32 v43, v46, v47
 v_cvt_pk_bf16_f32 v48, v48, v49
 v_cvt_pk_bf16_f32 v49, v50, v51
 v_cvt_pk_bf16_f32 v50, v52, v53
 v_cvt_pk_bf16_f32 v51, v54, v55
 v_cvt_pk_bf16_f32 v56, v56, v57
 v_cvt_pk_bf16_f32 v57, v58, v59
 v_cvt_pk_bf16_f32 v58, v60, v61
 v_cvt_pk_bf16_f32 v59, v62, v63
 v_permlane16_swap_b32 v32, v34
 v_permlane16_swap_b32 v33, v35
 v_permlane16_swap_b32 v40, v42
 v_permlane16_swap_b32 v41, v43
 v_permlane16_swap_b32 v48, v50
 v_permlane16_swap_b32 v49, v51
 v_permlane16_swap_b32 v56, v58
 v_permlane16_swap_b32 v57, v59
 buffer_load_dwordx4 a[204:207], v2, s[16:19], s42 offen offset:1024 sc1
 s_waitcnt vmcnt(26) lgkmcnt(0)
 v_mfma_f32_16x16x32_bf16 v[64:67], v[192:195], a[0:3], 0
 v_mfma_f32_16x16x32_bf16 v[68:71], v[192:195], a[4:7], 0
 v_mfma_f32_16x16x32_bf16 v[72:75], v[192:195], a[128:131], 0
 ds_read_b64_tr_b16 v[224:225], v17 offset:36864
 ds_read_b64_tr_b16 v[226:227], v17 offset:41472
 v_mfma_f32_16x16x32_bf16 v[76:79], v[192:195], a[132:135], 0
 ds_read_b64_tr_b16 v[228:229], v18 offset:36864
 ds_read_b64_tr_b16 v[230:231], v18 offset:41472
 v_mfma_f32_16x16x32_bf16 v[80:83], v[196:199], a[0:3], 0
 buffer_store_dwordx4 v[32:35], v5, s[12:15], s44 offen offset:0 sc1
 v_mfma_f32_16x16x32_bf16 v[84:87], v[196:199], a[4:7], 0
 ds_read_b64_tr_b16 v[232:233], v19 offset:36864
 ds_read_b64_tr_b16 v[234:235], v19 offset:41472
 v_mfma_f32_16x16x32_bf16 v[88:91], v[196:199], a[128:131], 0
 ds_read_b64_tr_b16 v[236:237], v20 offset:36864
 ds_read_b64_tr_b16 v[238:239], v20 offset:41472
 v_mfma_f32_16x16x32_bf16 v[92:95], v[196:199], a[132:135], 0
 v_mfma_f32_16x16x32_bf16 v[96:99], v[200:203], a[0:3], 0
 ds_read_b64_tr_b16 v[240:241], v17 offset:36992
 ds_read_b64_tr_b16 v[242:243], v17 offset:41600
 v_mfma_f32_16x16x32_bf16 v[100:103], v[200:203], a[4:7], 0
 buffer_store_dwordx4 v[40:43], v5, s[12:15], s44 offen offset:1024 sc1
 v_mfma_f32_16x16x32_bf16 v[104:107], v[200:203], a[128:131], 0
 ds_read_b64_tr_b16 v[244:245], v18 offset:36992
 ds_read_b64_tr_b16 v[246:247], v18 offset:41600
 v_mfma_f32_16x16x32_bf16 v[108:111], v[200:203], a[132:135], 0
 ds_read_b64_tr_b16 v[248:249], v19 offset:36992
 ds_read_b64_tr_b16 v[250:251], v19 offset:41600
 v_mfma_f32_16x16x32_bf16 v[112:115], v[204:207], a[0:3], 0
 v_mfma_f32_16x16x32_bf16 v[116:119], v[204:207], a[4:7], 0
 ds_read_b64_tr_b16 v[252:253], v20 offset:36992
 ds_read_b64_tr_b16 v[254:255], v20 offset:41600
 v_mfma_f32_16x16x32_bf16 v[120:123], v[204:207], a[128:131], 0
 buffer_store_dwordx4 v[48:51], v5, s[12:15], s44 offen offset:2048 sc1
 v_mfma_f32_16x16x32_bf16 v[124:127], v[204:207], a[132:135], 0
 v_mfma_f32_16x16x32_bf16 v[128:131], v[208:211], a[0:3], 0
 v_mfma_f32_16x16x32_bf16 v[132:135], v[208:211], a[4:7], 0
 v_mfma_f32_16x16x32_bf16 v[136:139], v[208:211], a[128:131], 0
 buffer_store_dwordx4 v[56:59], v5, s[12:15], s44 offen offset:3072 sc1
 v_mfma_f32_16x16x32_bf16 v[140:143], v[208:211], a[132:135], 0
 v_mfma_f32_16x16x32_bf16 v[144:147], v[212:215], a[0:3], 0
 v_mfma_f32_16x16x32_bf16 v[148:151], v[212:215], a[4:7], 0
 v_mfma_f32_16x16x32_bf16 v[152:155], v[212:215], a[128:131], 0
 buffer_load_dwordx4 a[208:211], v16, s[16:19], s42 offen offset:2048 sc1
 v_mfma_f32_16x16x32_bf16 v[156:159], v[212:215], a[132:135], 0
 v_mfma_f32_16x16x32_bf16 v[160:163], v[216:219], a[0:3], 0
 v_mfma_f32_16x16x32_bf16 v[164:167], v[216:219], a[4:7], 0
 v_mfma_f32_16x16x32_bf16 v[168:171], v[216:219], a[128:131], 0
 buffer_load_dwordx4 a[212:215], v2, s[16:19], s42 offen offset:2048 sc1
 v_mfma_f32_16x16x32_bf16 v[172:175], v[216:219], a[132:135], 0
 v_mfma_f32_16x16x32_bf16 v[176:179], v[220:223], a[0:3], 0
 v_mfma_f32_16x16x32_bf16 v[180:183], v[220:223], a[4:7], 0
 v_mfma_f32_16x16x32_bf16 v[184:187], v[220:223], a[128:131], 0
 buffer_load_dwordx4 a[216:219], v16, s[16:19], s42 offen offset:3072 sc1
 v_mfma_f32_16x16x32_bf16 v[188:191], v[220:223], a[132:135], 0
 buffer_load_dwordx4 a[220:223], v2, s[16:19], s42 offen offset:3072 sc1
 s_waitcnt vmcnt(30) lgkmcnt(0)
 s_barrier
 v_mfma_f32_16x16x32_bf16 v[64:67], v[224:227], a[8:11], v[64:67]
 v_mfma_f32_16x16x32_bf16 v[68:71], v[224:227], a[12:15], v[68:71]
 v_mfma_f32_16x16x32_bf16 v[72:75], v[224:227], a[136:139], v[72:75]
 ds_read_b64_tr_b16 v[192:193], v17 offset:46080
 ds_read_b64_tr_b16 v[194:195], v17 offset:50688
 v_mfma_f32_16x16x32_bf16 v[76:79], v[224:227], a[140:143], v[76:79]
 s_add_u32 s42, s42, 4096
 ds_read_b64_tr_b16 v[196:197], v18 offset:46080
 ds_read_b64_tr_b16 v[198:199], v18 offset:50688
 v_mfma_f32_16x16x32_bf16 v[80:83], v[228:231], a[8:11], v[80:83]
 buffer_load_dwordx4 a[224:227], v16, s[16:19], s42 offen offset:0 sc1
 v_mfma_f32_16x16x32_bf16 v[84:87], v[228:231], a[12:15], v[84:87]
 ds_read_b64_tr_b16 v[200:201], v19 offset:46080
 ds_read_b64_tr_b16 v[202:203], v19 offset:50688
 v_mfma_f32_16x16x32_bf16 v[88:91], v[228:231], a[136:139], v[88:91]
 ds_read_b64_tr_b16 v[204:205], v20 offset:46080
 ds_read_b64_tr_b16 v[206:207], v20 offset:50688
 v_mfma_f32_16x16x32_bf16 v[92:95], v[228:231], a[140:143], v[92:95]
 v_mfma_f32_16x16x32_bf16 v[96:99], v[232:235], a[8:11], v[96:99]
 ds_read_b64_tr_b16 v[208:209], v17 offset:46208
 ds_read_b64_tr_b16 v[210:211], v17 offset:50816
 v_mfma_f32_16x16x32_bf16 v[100:103], v[232:235], a[12:15], v[100:103]
 buffer_load_dwordx4 a[228:231], v2, s[16:19], s42 offen offset:0 sc1
 v_mfma_f32_16x16x32_bf16 v[104:107], v[232:235], a[136:139], v[104:107]
 ds_read_b64_tr_b16 v[212:213], v18 offset:46208
 ds_read_b64_tr_b16 v[214:215], v18 offset:50816
 v_mfma_f32_16x16x32_bf16 v[108:111], v[232:235], a[140:143], v[108:111]
 ds_read_b64_tr_b16 v[216:217], v19 offset:46208
 ds_read_b64_tr_b16 v[218:219], v19 offset:50816
 v_mfma_f32_16x16x32_bf16 v[112:115], v[236:239], a[8:11], v[112:115]
 v_mfma_f32_16x16x32_bf16 v[116:119], v[236:239], a[12:15], v[116:119]
 ds_read_b64_tr_b16 v[220:221], v20 offset:46208
 ds_read_b64_tr_b16 v[222:223], v20 offset:50816
 v_mfma_f32_16x16x32_bf16 v[120:123], v[236:239], a[136:139], v[120:123]
 buffer_load_dwordx4 a[96:99], v16, s[16:19], s41 offen offset:0 sc1
 v_mfma_f32_16x16x32_bf16 v[124:127], v[236:239], a[140:143], v[124:127]
 v_mfma_f32_16x16x32_bf16 v[128:131], v[240:243], a[8:11], v[128:131]
 v_mfma_f32_16x16x32_bf16 v[132:135], v[240:243], a[12:15], v[132:135]
 v_mfma_f32_16x16x32_bf16 v[136:139], v[240:243], a[136:139], v[136:139]
 buffer_load_dwordx4 a[100:103], v2, s[16:19], s41 offen offset:0 sc1
 v_mfma_f32_16x16x32_bf16 v[140:143], v[240:243], a[140:143], v[140:143]
 v_mfma_f32_16x16x32_bf16 v[144:147], v[244:247], a[8:11], v[144:147]
 v_mfma_f32_16x16x32_bf16 v[148:151], v[244:247], a[12:15], v[148:151]
 s_add_u32 m0, s59, 80896
 v_mfma_f32_16x16x32_bf16 v[152:155], v[244:247], a[136:139], v[152:155]
 buffer_load_dwordx4 v0, s[8:11], s40 offen offset:0 lds
 v_mfma_f32_16x16x32_bf16 v[156:159], v[244:247], a[140:143], v[156:159]
 v_mfma_f32_16x16x32_bf16 v[160:163], v[248:251], a[8:11], v[160:163]
 v_mfma_f32_16x16x32_bf16 v[164:167], v[248:251], a[12:15], v[164:167]
 v_mfma_f32_16x16x32_bf16 v[168:171], v[248:251], a[136:139], v[168:171]
 buffer_load_dwordx4 v1, s[8:11], s40 offen offset:1152 lds
 v_mfma_f32_16x16x32_bf16 v[172:175], v[248:251], a[140:143], v[172:175]
 v_mfma_f32_16x16x32_bf16 v[176:179], v[252:255], a[8:11], v[176:179]
 v_mfma_f32_16x16x32_bf16 v[180:183], v[252:255], a[12:15], v[180:183]
 s_add_u32 s40, s40, 65536
 v_mfma_f32_16x16x32_bf16 v[184:187], v[252:255], a[136:139], v[184:187]
 buffer_load_dwordx4 a[232:235], v16, s[16:19], s42 offen offset:1024 sc1
 v_mfma_f32_16x16x32_bf16 v[188:191], v[252:255], a[140:143], v[188:191]
 s_waitcnt lgkmcnt(0)
 v_mfma_f32_16x16x32_bf16 v[64:67], v[192:195], a[16:19], v[64:67]
 v_mfma_f32_16x16x32_bf16 v[68:71], v[192:195], a[20:23], v[68:71]
 v_mfma_f32_16x16x32_bf16 v[72:75], v[192:195], a[144:147], v[72:75]
 ds_read_b64_tr_b16 v[224:225], v17 offset:55296
 ds_read_b64_tr_b16 v[226:227], v17 offset:59904
 v_mfma_f32_16x16x32_bf16 v[76:79], v[192:195], a[148:151], v[76:79]
 ds_read_b64_tr_b16 v[228:229], v18 offset:55296
 ds_read_b64_tr_b16 v[230:231], v18 offset:59904
 v_mfma_f32_16x16x32_bf16 v[80:83], v[196:199], a[16:19], v[80:83]
 buffer_load_dwordx4 a[236:239], v2, s[16:19], s42 offen offset:1024 sc1
 v_mfma_f32_16x16x32_bf16 v[84:87], v[196:199], a[20:23], v[84:87]
 ds_read_b64_tr_b16 v[232:233], v19 offset:55296
 ds_read_b64_tr_b16 v[234:235], v19 offset:59904
 v_mfma_f32_16x16x32_bf16 v[88:91], v[196:199], a[144:147], v[88:91]
 ds_read_b64_tr_b16 v[236:237], v20 offset:55296
 ds_read_b64_tr_b16 v[238:239], v20 offset:59904
 v_mfma_f32_16x16x32_bf16 v[92:95], v[196:199], a[148:151], v[92:95]
 v_mfma_f32_16x16x32_bf16 v[96:99], v[200:203], a[16:19], v[96:99]
 s_add_u32 s36, s48, 2097152
 ds_read_b64_tr_b16 v[240:241], v17 offset:55424
 ds_read_b64_tr_b16 v[242:243], v17 offset:60032
 v_mfma_f32_16x16x32_bf16 v[100:103], v[200:203], a[20:23], v[100:103]
 buffer_load_dwordx4 v[32:35], v21, s[24:27], s36 offen
 v_mfma_f32_16x16x32_bf16 v[104:107], v[200:203], a[144:147], v[104:107]
 ds_read_b64_tr_b16 v[244:245], v18 offset:55424
 ds_read_b64_tr_b16 v[246:247], v18 offset:60032
 v_mfma_f32_16x16x32_bf16 v[108:111], v[200:203], a[148:151], v[108:111]
 ds_read_b64_tr_b16 v[248:249], v19 offset:55424
 ds_read_b64_tr_b16 v[250:251], v19 offset:60032
 v_mfma_f32_16x16x32_bf16 v[112:115], v[204:207], a[16:19], v[112:115]
 v_mfma_f32_16x16x32_bf16 v[116:119], v[204:207], a[20:23], v[116:119]
 s_add_u32 s36, s48, 2228224
 ds_read_b64_tr_b16 v[252:253], v20 offset:55424
 ds_read_b64_tr_b16 v[254:255], v20 offset:60032
 v_mfma_f32_16x16x32_bf16 v[120:123], v[204:207], a[144:147], v[120:123]
 buffer_load_dwordx4 v[36:39], v21, s[24:27], s36 offen
 v_mfma_f32_16x16x32_bf16 v[124:127], v[204:207], a[148:151], v[124:127]
 v_mfma_f32_16x16x32_bf16 v[128:131], v[208:211], a[16:19], v[128:131]
 v_mfma_f32_16x16x32_bf16 v[132:135], v[208:211], a[20:23], v[132:135]
 v_mfma_f32_16x16x32_bf16 v[136:139], v[208:211], a[144:147], v[136:139]
 buffer_load_dwordx4 a[104:107], v16, s[16:19], s41 offen offset:1024 sc1
 v_mfma_f32_16x16x32_bf16 v[140:143], v[208:211], a[148:151], v[140:143]
 v_mfma_f32_16x16x32_bf16 v[144:147], v[212:215], a[16:19], v[144:147]
 v_mfma_f32_16x16x32_bf16 v[148:151], v[212:215], a[20:23], v[148:151]
 v_mfma_f32_16x16x32_bf16 v[152:155], v[212:215], a[144:147], v[152:155]
 buffer_load_dwordx4 a[108:111], v2, s[16:19], s41 offen offset:1024 sc1
 v_mfma_f32_16x16x32_bf16 v[156:159], v[212:215], a[148:151], v[156:159]
 v_mfma_f32_16x16x32_bf16 v[160:163], v[216:219], a[16:19], v[160:163]
 v_mfma_f32_16x16x32_bf16 v[164:167], v[216:219], a[20:23], v[164:167]
 s_add_u32 m0, s59, 90112
 v_mfma_f32_16x16x32_bf16 v[168:171], v[216:219], a[144:147], v[168:171]
 buffer_load_dwordx4 v0, s[8:11], s40 offen offset:0 lds
 v_mfma_f32_16x16x32_bf16 v[172:175], v[216:219], a[148:151], v[172:175]
 v_mfma_f32_16x16x32_bf16 v[176:179], v[220:223], a[16:19], v[176:179]
 v_mfma_f32_16x16x32_bf16 v[180:183], v[220:223], a[20:23], v[180:183]
 v_mfma_f32_16x16x32_bf16 v[184:187], v[220:223], a[144:147], v[184:187]
 buffer_load_dwordx4 v1, s[8:11], s40 offen offset:1152 lds
 v_mfma_f32_16x16x32_bf16 v[188:191], v[220:223], a[148:151], v[188:191]
 s_waitcnt vmcnt(40) lgkmcnt(0)
 s_barrier
 v_mfma_f32_16x16x32_bf16 v[64:67], v[224:227], a[24:27], v[64:67]
 v_add_u32 v17, 64512, v17
 v_add_u32 v18, 64512, v18
 v_mfma_f32_16x16x32_bf16 v[68:71], v[224:227], a[28:31], v[68:71]
 v_add_u32 v19, 64512, v19
 v_add_u32 v20, 64512, v20
 v_mfma_f32_16x16x32_bf16 v[72:75], v[224:227], a[152:155], v[72:75]
 ds_read_b64_tr_b16 v[192:193], v17 offset:0
 ds_read_b64_tr_b16 v[194:195], v17 offset:4608
 v_mfma_f32_16x16x32_bf16 v[76:79], v[224:227], a[156:159], v[76:79]
 s_add_u32 s40, s40, 65536
 ds_read_b64_tr_b16 v[196:197], v18 offset:0
 ds_read_b64_tr_b16 v[198:199], v18 offset:4608
 v_mfma_f32_16x16x32_bf16 v[80:83], v[228:231], a[24:27], v[80:83]
 buffer_load_dwordx4 a[240:243], v16, s[16:19], s42 offen offset:2048 sc1
 v_mfma_f32_16x16x32_bf16 v[84:87], v[228:231], a[28:31], v[84:87]
 ds_read_b64_tr_b16 v[200:201], v19 offset:0
 ds_read_b64_tr_b16 v[202:203], v19 offset:4608
 v_mfma_f32_16x16x32_bf16 v[88:91], v[228:231], a[152:155], v[88:91]
 ds_read_b64_tr_b16 v[204:205], v20 offset:0
 ds_read_b64_tr_b16 v[206:207], v20 offset:4608
 v_mfma_f32_16x16x32_bf16 v[92:95], v[228:231], a[156:159], v[92:95]
 v_mfma_f32_16x16x32_bf16 v[96:99], v[232:235], a[24:27], v[96:99]
 ds_read_b64_tr_b16 v[208:209], v17 offset:128
 ds_read_b64_tr_b16 v[210:211], v17 offset:4736
 v_mfma_f32_16x16x32_bf16 v[100:103], v[232:235], a[28:31], v[100:103]
 buffer_load_dwordx4 a[244:247], v2, s[16:19], s42 offen offset:2048 sc1
 v_mfma_f32_16x16x32_bf16 v[104:107], v[232:235], a[152:155], v[104:107]
 ds_read_b64_tr_b16 v[212:213], v18 offset:128
 ds_read_b64_tr_b16 v[214:215], v18 offset:4736
 v_mfma_f32_16x16x32_bf16 v[108:111], v[232:235], a[156:159], v[108:111]
 ds_read_b64_tr_b16 v[216:217], v19 offset:128
 ds_read_b64_tr_b16 v[218:219], v19 offset:4736
 v_mfma_f32_16x16x32_bf16 v[112:115], v[236:239], a[24:27], v[112:115]
 v_mfma_f32_16x16x32_bf16 v[116:119], v[236:239], a[28:31], v[116:119]
 ds_read_b64_tr_b16 v[220:221], v20 offset:128
 ds_read_b64_tr_b16 v[222:223], v20 offset:4736
 v_mfma_f32_16x16x32_bf16 v[120:123], v[236:239], a[152:155], v[120:123]
 buffer_load_dwordx4 a[112:115], v16, s[16:19], s41 offen offset:2048 sc1
 v_mfma_f32_16x16x32_bf16 v[124:127], v[236:239], a[156:159], v[124:127]
 v_mfma_f32_16x16x32_bf16 v[128:131], v[240:243], a[24:27], v[128:131]
 v_mfma_f32_16x16x32_bf16 v[132:135], v[240:243], a[28:31], v[132:135]
 v_mfma_f32_16x16x32_bf16 v[136:139], v[240:243], a[152:155], v[136:139]
 buffer_load_dwordx4 a[116:119], v2, s[16:19], s41 offen offset:2048 sc1
 v_mfma_f32_16x16x32_bf16 v[140:143], v[240:243], a[156:159], v[140:143]
 v_mfma_f32_16x16x32_bf16 v[144:147], v[244:247], a[24:27], v[144:147]
 v_mfma_f32_16x16x32_bf16 v[148:151], v[244:247], a[28:31], v[148:151]
 s_add_u32 m0, s59, 99328
 v_mfma_f32_16x16x32_bf16 v[152:155], v[244:247], a[152:155], v[152:155]
 buffer_load_dwordx4 v0, s[8:11], s40 offen offset:0 lds
 v_mfma_f32_16x16x32_bf16 v[156:159], v[244:247], a[156:159], v[156:159]
 v_mfma_f32_16x16x32_bf16 v[160:163], v[248:251], a[24:27], v[160:163]
 v_mfma_f32_16x16x32_bf16 v[164:167], v[248:251], a[28:31], v[164:167]
 v_mfma_f32_16x16x32_bf16 v[168:171], v[248:251], a[152:155], v[168:171]
 buffer_load_dwordx4 v1, s[8:11], s40 offen offset:1152 lds
 v_mfma_f32_16x16x32_bf16 v[172:175], v[248:251], a[156:159], v[172:175]
 v_mfma_f32_16x16x32_bf16 v[176:179], v[252:255], a[24:27], v[176:179]
 v_mfma_f32_16x16x32_bf16 v[180:183], v[252:255], a[28:31], v[180:183]
 s_add_u32 s40, s40, 65536
 v_mfma_f32_16x16x32_bf16 v[184:187], v[252:255], a[152:155], v[184:187]
 buffer_load_dwordx4 a[248:251], v16, s[16:19], s42 offen offset:3072 sc1
 v_mfma_f32_16x16x32_bf16 v[188:191], v[252:255], a[156:159], v[188:191]
 s_waitcnt lgkmcnt(0)
 v_mfma_f32_16x16x32_bf16 v[64:67], v[192:195], a[32:35], v[64:67]
 v_mfma_f32_16x16x32_bf16 v[68:71], v[192:195], a[36:39], v[68:71]
 v_mfma_f32_16x16x32_bf16 v[72:75], v[192:195], a[160:163], v[72:75]
 ds_read_b64_tr_b16 v[224:225], v17 offset:9216
 ds_read_b64_tr_b16 v[226:227], v17 offset:13824
 v_mfma_f32_16x16x32_bf16 v[76:79], v[192:195], a[164:167], v[76:79]
 ds_read_b64_tr_b16 v[228:229], v18 offset:9216
 ds_read_b64_tr_b16 v[230:231], v18 offset:13824
 v_mfma_f32_16x16x32_bf16 v[80:83], v[196:199], a[32:35], v[80:83]
 buffer_load_dwordx4 a[252:255], v2, s[16:19], s42 offen offset:3072 sc1
 v_mfma_f32_16x16x32_bf16 v[84:87], v[196:199], a[36:39], v[84:87]
 ds_read_b64_tr_b16 v[232:233], v19 offset:9216
 ds_read_b64_tr_b16 v[234:235], v19 offset:13824
 v_mfma_f32_16x16x32_bf16 v[88:91], v[196:199], a[160:163], v[88:91]
 ds_read_b64_tr_b16 v[236:237], v20 offset:9216
 ds_read_b64_tr_b16 v[238:239], v20 offset:13824
 v_mfma_f32_16x16x32_bf16 v[92:95], v[196:199], a[164:167], v[92:95]
 v_mfma_f32_16x16x32_bf16 v[96:99], v[200:203], a[32:35], v[96:99]
 s_add_u32 s42, s42, 4096
 s_waitcnt vmcnt(26)
 ds_read_b64_tr_b16 v[240:241], v17 offset:9344
 ds_read_b64_tr_b16 v[242:243], v17 offset:13952
 v_mfma_f32_16x16x32_bf16 v[100:103], v[200:203], a[36:39], v[100:103]
 buffer_store_dword v9, v8, s[28:31], s57 offen sc1
 v_mfma_f32_16x16x32_bf16 v[104:107], v[200:203], a[160:163], v[104:107]
 ds_read_b64_tr_b16 v[244:245], v18 offset:9344
 ds_read_b64_tr_b16 v[246:247], v18 offset:13952
 v_mfma_f32_16x16x32_bf16 v[108:111], v[200:203], a[164:167], v[108:111]
 ds_read_b64_tr_b16 v[248:249], v19 offset:9344
 ds_read_b64_tr_b16 v[250:251], v19 offset:13952
 v_mfma_f32_16x16x32_bf16 v[112:115], v[204:207], a[32:35], v[112:115]
 v_mfma_f32_16x16x32_bf16 v[116:119], v[204:207], a[36:39], v[116:119]
 ds_read_b64_tr_b16 v[252:253], v20 offset:9344
 ds_read_b64_tr_b16 v[254:255], v20 offset:13952
 v_mfma_f32_16x16x32_bf16 v[120:123], v[204:207], a[160:163], v[120:123]
 buffer_load_dwordx4 a[120:123], v16, s[16:19], s41 offen offset:3072 sc1
 v_mfma_f32_16x16x32_bf16 v[124:127], v[204:207], a[164:167], v[124:127]
 v_mfma_f32_16x16x32_bf16 v[128:131], v[208:211], a[32:35], v[128:131]
 v_mfma_f32_16x16x32_bf16 v[132:135], v[208:211], a[36:39], v[132:135]
 v_mfma_f32_16x16x32_bf16 v[136:139], v[208:211], a[160:163], v[136:139]
 buffer_load_dwordx4 a[124:127], v2, s[16:19], s41 offen offset:3072 sc1
 v_mfma_f32_16x16x32_bf16 v[140:143], v[208:211], a[164:167], v[140:143]
 v_mfma_f32_16x16x32_bf16 v[144:147], v[212:215], a[32:35], v[144:147]
 v_mfma_f32_16x16x32_bf16 v[148:151], v[212:215], a[36:39], v[148:151]
 s_add_u32 s41, s41, 4096
 s_add_u32 m0, s59, 108544
 v_mfma_f32_16x16x32_bf16 v[152:155], v[212:215], a[160:163], v[152:155]
 buffer_load_dwordx4 v0, s[8:11], s40 offen offset:0 lds
 v_mfma_f32_16x16x32_bf16 v[156:159], v[212:215], a[164:167], v[156:159]
 v_mfma_f32_16x16x32_bf16 v[160:163], v[216:219], a[32:35], v[160:163]
 v_mfma_f32_16x16x32_bf16 v[164:167], v[216:219], a[36:39], v[164:167]
 v_mfma_f32_16x16x32_bf16 v[168:171], v[216:219], a[160:163], v[168:171]
 buffer_load_dwordx4 v1, s[8:11], s40 offen offset:1152 lds
 v_mfma_f32_16x16x32_bf16 v[172:175], v[216:219], a[164:167], v[172:175]
 v_mfma_f32_16x16x32_bf16 v[176:179], v[220:223], a[32:35], v[176:179]
 v_mfma_f32_16x16x32_bf16 v[180:183], v[220:223], a[36:39], v[180:183]
 s_add_u32 s40, s40, 65536
 v_mfma_f32_16x16x32_bf16 v[184:187], v[220:223], a[160:163], v[184:187]
 buffer_load_dwordx4 a[128:131], v16, s[16:19], s42 offen offset:0 sc1
 v_mfma_f32_16x16x32_bf16 v[188:191], v[220:223], a[164:167], v[188:191]
 buffer_load_dwordx4 a[132:135], v2, s[16:19], s42 offen offset:0 sc1
 s_waitcnt vmcnt(51) lgkmcnt(0)
 s_barrier
 v_mfma_f32_16x16x32_bf16 v[64:67], v[224:227], a[40:43], v[64:67]
 v_add_u32 v17, 4294838272, v17
 v_add_u32 v18, 4294838272, v18
 v_mfma_f32_16x16x32_bf16 v[68:71], v[224:227], a[44:47], v[68:71]
 v_add_u32 v19, 4294838272, v19
 v_add_u32 v20, 4294838272, v20
 v_mfma_f32_16x16x32_bf16 v[72:75], v[224:227], a[168:171], v[72:75]
 ds_read_b64_tr_b16 v[192:193], v17 offset:0
 ds_read_b64_tr_b16 v[194:195], v17 offset:4608
 v_mfma_f32_16x16x32_bf16 v[76:79], v[224:227], a[172:175], v[76:79]
 ds_read_b64_tr_b16 v[196:197], v18 offset:0
 ds_read_b64_tr_b16 v[198:199], v18 offset:4608
 v_mfma_f32_16x16x32_bf16 v[80:83], v[228:231], a[40:43], v[80:83]
 buffer_load_dwordx4 a[0:3], v16, s[16:19], s41 offen offset:0 sc1
 v_mfma_f32_16x16x32_bf16 v[84:87], v[228:231], a[44:47], v[84:87]
 ds_read_b64_tr_b16 v[200:201], v19 offset:0
 ds_read_b64_tr_b16 v[202:203], v19 offset:4608
 v_mfma_f32_16x16x32_bf16 v[88:91], v[228:231], a[168:171], v[88:91]
 ds_read_b64_tr_b16 v[204:205], v20 offset:0
 ds_read_b64_tr_b16 v[206:207], v20 offset:4608
 v_mfma_f32_16x16x32_bf16 v[92:95], v[228:231], a[172:175], v[92:95]
 v_mfma_f32_16x16x32_bf16 v[96:99], v[232:235], a[40:43], v[96:99]
 ds_read_b64_tr_b16 v[208:209], v17 offset:128
 ds_read_b64_tr_b16 v[210:211], v17 offset:4736
 v_mfma_f32_16x16x32_bf16 v[100:103], v[232:235], a[44:47], v[100:103]
 buffer_load_dwordx4 a[4:7], v2, s[16:19], s41 offen offset:0 sc1
 v_mfma_f32_16x16x32_bf16 v[104:107], v[232:235], a[168:171], v[104:107]
 ds_read_b64_tr_b16 v[212:213], v18 offset:128
 ds_read_b64_tr_b16 v[214:215], v18 offset:4736
 v_mfma_f32_16x16x32_bf16 v[108:111], v[232:235], a[172:175], v[108:111]
 ds_read_b64_tr_b16 v[216:217], v19 offset:128
 ds_read_b64_tr_b16 v[218:219], v19 offset:4736
 v_mfma_f32_16x16x32_bf16 v[112:115], v[236:239], a[40:43], v[112:115]
 v_mfma_f32_16x16x32_bf16 v[116:119], v[236:239], a[44:47], v[116:119]
 s_add_u32 m0, s59, 117760
 ds_read_b64_tr_b16 v[220:221], v20 offset:128
 ds_read_b64_tr_b16 v[222:223], v20 offset:4736
 v_mfma_f32_16x16x32_bf16 v[120:123], v[236:239], a[168:171], v[120:123]
 buffer_load_dwordx4 v0, s[8:11], s40 offen offset:0 lds
 v_mfma_f32_16x16x32_bf16 v[124:127], v[236:239], a[172:175], v[124:127]
 v_mfma_f32_16x16x32_bf16 v[128:131], v[240:243], a[40:43], v[128:131]
 v_mfma_f32_16x16x32_bf16 v[132:135], v[240:243], a[44:47], v[132:135]
 v_mfma_f32_16x16x32_bf16 v[136:139], v[240:243], a[168:171], v[136:139]
 buffer_load_dwordx4 v1, s[8:11], s40 offen offset:1152 lds
 v_mfma_f32_16x16x32_bf16 v[140:143], v[240:243], a[172:175], v[140:143]
 v_mfma_f32_16x16x32_bf16 v[144:147], v[244:247], a[40:43], v[144:147]
 v_mfma_f32_16x16x32_bf16 v[148:151], v[244:247], a[44:47], v[148:151]
 s_add_u32 s40, s40, 65536
 v_mfma_f32_16x16x32_bf16 v[152:155], v[244:247], a[168:171], v[152:155]
 buffer_load_dwordx4 a[136:139], v16, s[16:19], s42 offen offset:1024 sc1
 v_mfma_f32_16x16x32_bf16 v[156:159], v[244:247], a[172:175], v[156:159]
 v_mfma_f32_16x16x32_bf16 v[160:163], v[248:251], a[40:43], v[160:163]
 v_mfma_f32_16x16x32_bf16 v[164:167], v[248:251], a[44:47], v[164:167]
 v_mfma_f32_16x16x32_bf16 v[168:171], v[248:251], a[168:171], v[168:171]
 buffer_load_dwordx4 a[140:143], v2, s[16:19], s42 offen offset:1024 sc1
 v_mfma_f32_16x16x32_bf16 v[172:175], v[248:251], a[172:175], v[172:175]
 v_mfma_f32_16x16x32_bf16 v[176:179], v[252:255], a[40:43], v[176:179]
 v_mfma_f32_16x16x32_bf16 v[180:183], v[252:255], a[44:47], v[180:183]
 v_mfma_f32_16x16x32_bf16 v[184:187], v[252:255], a[168:171], v[184:187]
 buffer_load_dwordx4 a[8:11], v16, s[16:19], s41 offen offset:1024 sc1
 v_mfma_f32_16x16x32_bf16 v[188:191], v[252:255], a[172:175], v[188:191]
 s_waitcnt lgkmcnt(0)
 v_mfma_f32_16x16x32_bf16 v[64:67], v[192:195], a[48:51], v[64:67]
 v_mfma_f32_16x16x32_bf16 v[68:71], v[192:195], a[52:55], v[68:71]
 v_mfma_f32_16x16x32_bf16 v[72:75], v[192:195], a[176:179], v[72:75]
 ds_read_b64_tr_b16 v[224:225], v17 offset:9216
 ds_read_b64_tr_b16 v[226:227], v17 offset:13824
 v_mfma_f32_16x16x32_bf16 v[76:79], v[192:195], a[180:183], v[76:79]
 ds_read_b64_tr_b16 v[228:229], v18 offset:9216
 ds_read_b64_tr_b16 v[230:231], v18 offset:13824
 v_mfma_f32_16x16x32_bf16 v[80:83], v[196:199], a[48:51], v[80:83]
 buffer_load_dwordx4 a[12:15], v2, s[16:19], s41 offen offset:1024 sc1
 v_mfma_f32_16x16x32_bf16 v[84:87], v[196:199], a[52:55], v[84:87]
 ds_read_b64_tr_b16 v[232:233], v19 offset:9216
 ds_read_b64_tr_b16 v[234:235], v19 offset:13824
 v_mfma_f32_16x16x32_bf16 v[88:91], v[196:199], a[176:179], v[88:91]
 ds_read_b64_tr_b16 v[236:237], v20 offset:9216
 ds_read_b64_tr_b16 v[238:239], v20 offset:13824
 v_mfma_f32_16x16x32_bf16 v[92:95], v[196:199], a[180:183], v[92:95]
 v_mfma_f32_16x16x32_bf16 v[96:99], v[200:203], a[48:51], v[96:99]
 s_add_u32 m0, s59, 126976
 ds_read_b64_tr_b16 v[240:241], v17 offset:9344
 ds_read_b64_tr_b16 v[242:243], v17 offset:13952
 v_mfma_f32_16x16x32_bf16 v[100:103], v[200:203], a[52:55], v[100:103]
 buffer_load_dwordx4 v0, s[8:11], s40 offen offset:0 lds
 v_mfma_f32_16x16x32_bf16 v[104:107], v[200:203], a[176:179], v[104:107]
 ds_read_b64_tr_b16 v[244:245], v18 offset:9344
 ds_read_b64_tr_b16 v[246:247], v18 offset:13952
 v_mfma_f32_16x16x32_bf16 v[108:111], v[200:203], a[180:183], v[108:111]
 ds_read_b64_tr_b16 v[248:249], v19 offset:9344
 ds_read_b64_tr_b16 v[250:251], v19 offset:13952
 v_mfma_f32_16x16x32_bf16 v[112:115], v[204:207], a[48:51], v[112:115]
 v_mfma_f32_16x16x32_bf16 v[116:119], v[204:207], a[52:55], v[116:119]
 ds_read_b64_tr_b16 v[252:253], v20 offset:9344
 ds_read_b64_tr_b16 v[254:255], v20 offset:13952
 v_mfma_f32_16x16x32_bf16 v[120:123], v[204:207], a[176:179], v[120:123]
 buffer_load_dwordx4 v1, s[8:11], s40 offen offset:1152 lds
 v_mfma_f32_16x16x32_bf16 v[124:127], v[204:207], a[180:183], v[124:127]
 v_mfma_f32_16x16x32_bf16 v[128:131], v[208:211], a[48:51], v[128:131]
 v_mfma_f32_16x16x32_bf16 v[132:135], v[208:211], a[52:55], v[132:135]
 s_add_u32 s40, s40, 65536
 v_mfma_f32_16x16x32_bf16 v[136:139], v[208:211], a[176:179], v[136:139]
 buffer_load_dwordx4 a[144:147], v16, s[16:19], s42 offen offset:2048 sc1
 v_mfma_f32_16x16x32_bf16 v[140:143], v[208:211], a[180:183], v[140:143]
 v_mfma_f32_16x16x32_bf16 v[144:147], v[212:215], a[48:51], v[144:147]
 v_mfma_f32_16x16x32_bf16 v[148:151], v[212:215], a[52:55], v[148:151]
 v_mfma_f32_16x16x32_bf16 v[152:155], v[212:215], a[176:179], v[152:155]
 buffer_load_dwordx4 a[148:151], v2, s[16:19], s42 offen offset:2048 sc1
 v_mfma_f32_16x16x32_bf16 v[156:159], v[212:215], a[180:183], v[156:159]
 v_mfma_f32_16x16x32_bf16 v[160:163], v[216:219], a[48:51], v[160:163]
 v_mfma_f32_16x16x32_bf16 v[164:167], v[216:219], a[52:55], v[164:167]
 v_mfma_f32_16x16x32_bf16 v[168:171], v[216:219], a[176:179], v[168:171]
 buffer_load_dwordx4 a[16:19], v16, s[16:19], s41 offen offset:2048 sc1
 v_mfma_f32_16x16x32_bf16 v[172:175], v[216:219], a[180:183], v[172:175]
 v_mfma_f32_16x16x32_bf16 v[176:179], v[220:223], a[48:51], v[176:179]
 v_mfma_f32_16x16x32_bf16 v[180:183], v[220:223], a[52:55], v[180:183]
 v_mfma_f32_16x16x32_bf16 v[184:187], v[220:223], a[176:179], v[184:187]
 buffer_load_dwordx4 a[20:23], v2, s[16:19], s41 offen offset:2048 sc1
 v_mfma_f32_16x16x32_bf16 v[188:191], v[220:223], a[180:183], v[188:191]
 s_waitcnt vmcnt(53) lgkmcnt(0)
 s_barrier
 v_mfma_f32_16x16x32_bf16 v[64:67], v[224:227], a[56:59], v[64:67]
 v_mfma_f32_16x16x32_bf16 v[68:71], v[224:227], a[60:63], v[68:71]
 v_mfma_f32_16x16x32_bf16 v[72:75], v[224:227], a[184:187], v[72:75]
 ds_read_b64_tr_b16 v[192:193], v17 offset:18432
 ds_read_b64_tr_b16 v[194:195], v17 offset:23040
 v_mfma_f32_16x16x32_bf16 v[76:79], v[224:227], a[188:191], v[76:79]
 s_add_u32 m0, s59, 136192
 ds_read_b64_tr_b16 v[196:197], v18 offset:18432
 ds_read_b64_tr_b16 v[198:199], v18 offset:23040
 v_mfma_f32_16x16x32_bf16 v[80:83], v[228:231], a[56:59], v[80:83]
 buffer_load_dwordx4 v0, s[8:11], s40 offen offset:0 lds
 v_mfma_f32_16x16x32_bf16 v[84:87], v[228:231], a[60:63], v[84:87]
 ds_read_b64_tr_b16 v[200:201], v19 offset:18432
 ds_read_b64_tr_b16 v[202:203], v19 offset:23040
 v_mfma_f32_16x16x32_bf16 v[88:91], v[228:231], a[184:187], v[88:91]
 ds_read_b64_tr_b16 v[204:205], v20 offset:18432
 ds_read_b64_tr_b16 v[206:207], v20 offset:23040
 v_mfma_f32_16x16x32_bf16 v[92:95], v[228:231], a[188:191], v[92:95]
 v_mfma_f32_16x16x32_bf16 v[96:99], v[232:235], a[56:59], v[96:99]
 ds_read_b64_tr_b16 v[208:209], v17 offset:18560
 ds_read_b64_tr_b16 v[210:211], v17 offset:23168
 v_mfma_f32_16x16x32_bf16 v[100:103], v[232:235], a[60:63], v[100:103]
 buffer_load_dwordx4 v1, s[8:11], s40 offen offset:1152 lds
 v_mfma_f32_16x16x32_bf16 v[104:107], v[232:235], a[184:187], v[104:107]
 ds_read_b64_tr_b16 v[212:213], v18 offset:18560
 ds_read_b64_tr_b16 v[214:215], v18 offset:23168
 v_mfma_f32_16x16x32_bf16 v[108:111], v[232:235], a[188:191], v[108:111]
 ds_read_b64_tr_b16 v[216:217], v19 offset:18560
 ds_read_b64_tr_b16 v[218:219], v19 offset:23168
 v_mfma_f32_16x16x32_bf16 v[112:115], v[236:239], a[56:59], v[112:115]
 v_mfma_f32_16x16x32_bf16 v[116:119], v[236:239], a[60:63], v[116:119]
 s_add_u32 s40, s40, 65536
 ds_read_b64_tr_b16 v[220:221], v20 offset:18560
 ds_read_b64_tr_b16 v[222:223], v20 offset:23168
 v_mfma_f32_16x16x32_bf16 v[120:123], v[236:239], a[184:187], v[120:123]
 buffer_load_dwordx4 a[152:155], v16, s[16:19], s42 offen offset:3072 sc1
 v_mfma_f32_16x16x32_bf16 v[124:127], v[236:239], a[188:191], v[124:127]
 v_mfma_f32_16x16x32_bf16 v[128:131], v[240:243], a[56:59], v[128:131]
 v_mfma_f32_16x16x32_bf16 v[132:135], v[240:243], a[60:63], v[132:135]
 v_mfma_f32_16x16x32_bf16 v[136:139], v[240:243], a[184:187], v[136:139]
L_pad14:
 s_cbranch_execz L_back
 buffer_load_dwordx4 a[156:159], v2, s[16:19], s42 offen offset:3072 sc1
 v_mfma_f32_16x16x32_bf16 v[140:143], v[240:243], a[188:191], v[140:143]
 v_mfma_f32_16x16x32_bf16 v[144:147], v[244:247], a[56:59], v[144:147]
 v_mfma_f32_16x16x32_bf16 v[148:151], v[244:247], a[60:63], v[148:151]
 s_add_u32 s42, s42, 4096
 v_mfma_f32_16x16x32_bf16 v[152:155], v[244:247], a[184:187], v[152:155]
 buffer_load_dwordx4 a[24:27], v16, s[16:19], s41 offen offset:3072 sc1
 v_mfma_f32_16x16x32_bf16 v[156:159], v[244:247], a[188:191], v[156:159]
 v_mfma_f32_16x16x32_bf16 v[160:163], v[248:251], a[56:59], v[160:163]
 v_mfma_f32_16x16x32_bf16 v[164:167], v[248:251], a[60:63], v[164:167]
 v_mfma_f32_16x16x32_bf16 v[168:171], v[248:251], a[184:187], v[168:171]
 buffer_load_dwordx4 a[28:31], v2, s[16:19], s41 offen offset:3072 sc1
 v_mfma_f32_16x16x32_bf16 v[172:175], v[248:251], a[188:191], v[172:175]
 v_mfma_f32_16x16x32_bf16 v[176:179], v[252:255], a[56:59], v[176:179]
 v_mfma_f32_16x16x32_bf16 v[180:183], v[252:255], a[60:63], v[180:183]
 s_add_u32 s41, s41, 4096
 s_add_u32 m0, s59, 145408
 v_mfma_f32_16x16x32_bf16 v[184:187], v[252:255], a[184:187], v[184:187]
 buffer_load_dwordx4 v0, s[8:11], s40 offen offset:0 lds
 v_mfma_f32_16x16x32_bf16 v[188:191], v[252:255], a[188:191], v[188:191]
 s_waitcnt lgkmcnt(0)
 v_mfma_f32_16x16x32_bf16 v[64:67], v[192:195], a[64:67], v[64:67]
 v_mfma_f32_16x16x32_bf16 v[68:71], v[192:195], a[68:71], v[68:71]
 v_mfma_f32_16x16x32_bf16 v[72:75], v[192:195], a[192:195], v[72:75]
 ds_read_b64_tr_b16 v[224:225], v17 offset:27648
 ds_read_b64_tr_b16 v[226:227], v17 offset:32256
 v_mfma_f32_16x16x32_bf16 v[76:79], v[192:195], a[196:199], v[76:79]
 ds_read_b64_tr_b16 v[228:229], v18 offset:27648
 ds_read_b64_tr_b16 v[230:231], v18 offset:32256
 v_mfma_f32_16x16x32_bf16 v[80:83], v[196:199], a[64:67], v[80:83]
 buffer_load_dwordx4 v1, s[8:11], s40 offen offset:1152 lds
 v_mfma_f32_16x16x32_bf16 v[84:87], v[196:199], a[68:71], v[84:87]
 ds_read_b64_tr_b16 v[232:233], v19 offset:27648
 ds_read_b64_tr_b16 v[234:235], v19 offset:32256
 v_mfma_f32_16x16x32_bf16 v[88:91], v[196:199], a[192:195], v[88:91]
 ds_read_b64_tr_b16 v[236:237], v20 offset:27648
 ds_read_b64_tr_b16 v[238:239], v20 offset:32256
 v_mfma_f32_16x16x32_bf16 v[92:95], v[196:199], a[196:199], v[92:95]
 v_mfma_f32_16x16x32_bf16 v[96:99], v[200:203], a[64:67], v[96:99]
 s_add_u32 s40, s40, 65536
 ds_read_b64_tr_b16 v[240:241], v17 offset:27776
 ds_read_b64_tr_b16 v[242:243], v17 offset:32384
 v_mfma_f32_16x16x32_bf16 v[100:103], v[200:203], a[68:71], v[100:103]
 buffer_load_dwordx4 a[160:163], v16, s[16:19], s42 offen offset:0 sc1
 v_mfma_f32_16x16x32_bf16 v[104:107], v[200:203], a[192:195], v[104:107]
 ds_read_b64_tr_b16 v[244:245], v18 offset:27776
 ds_read_b64_tr_b16 v[246:247], v18 offset:32384
 v_mfma_f32_16x16x32_bf16 v[108:111], v[200:203], a[196:199], v[108:111]
 ds_read_b64_tr_b16 v[248:249], v19 offset:27776
 ds_read_b64_tr_b16 v[250:251], v19 offset:32384
 v_mfma_f32_16x16x32_bf16 v[112:115], v[204:207], a[64:67], v[112:115]
 v_mfma_f32_16x16x32_bf16 v[116:119], v[204:207], a[68:71], v[116:119]
 ds_read_b64_tr_b16 v[252:253], v20 offset:27776
 ds_read_b64_tr_b16 v[254:255], v20 offset:32384
 v_mfma_f32_16x16x32_bf16 v[120:123], v[204:207], a[192:195], v[120:123]
 buffer_load_dwordx4 a[164:167], v2, s[16:19], s42 offen offset:0 sc1
 v_mfma_f32_16x16x32_bf16 v[124:127], v[204:207], a[196:199], v[124:127]
 v_mfma_f32_16x16x32_bf16 v[128:131], v[208:211], a[64:67], v[128:131]
 v_mfma_f32_16x16x32_bf16 v[132:135], v[208:211], a[68:71], v[132:135]
 v_mfma_f32_16x16x32_bf16 v[136:139], v[208:211], a[192:195], v[136:139]
 buffer_load_dwordx4 a[32:35], v16, s[16:19], s41 offen offset:0 sc1
 v_mfma_f32_16x16x32_bf16 v[140:143], v[208:211], a[196:199], v[140:143]
 v_mfma_f32_16x16x32_bf16 v[144:147], v[212:215], a[64:67], v[144:147]
 v_mfma_f32_16x16x32_bf16 v[148:151], v[212:215], a[68:71], v[148:151]
 v_mfma_f32_16x16x32_bf16 v[152:155], v[212:215], a[192:195], v[152:155]
 buffer_load_dwordx4 a[36:39], v2, s[16:19], s41 offen offset:0 sc1
 v_mfma_f32_16x16x32_bf16 v[156:159], v[212:215], a[196:199], v[156:159]
 v_mfma_f32_16x16x32_bf16 v[160:163], v[216:219], a[64:67], v[160:163]
 v_mfma_f32_16x16x32_bf16 v[164:167], v[216:219], a[68:71], v[164:167]
 s_add_u32 m0, s59, 154624
 v_mfma_f32_16x16x32_bf16 v[168:171], v[216:219], a[192:195], v[168:171]
 buffer_load_dwordx4 v0, s[8:11], s40 offen offset:0 lds
 v_mfma_f32_16x16x32_bf16 v[172:175], v[216:219], a[196:199], v[172:175]
 v_mfma_f32_16x16x32_bf16 v[176:179], v[220:223], a[64:67], v[176:179]
 v_mfma_f32_16x16x32_bf16 v[180:183], v[220:223], a[68:71], v[180:183]
 v_mfma_f32_16x16x32_bf16 v[184:187], v[220:223], a[192:195], v[184:187]
 buffer_load_dwordx4 v1, s[8:11], s40 offen offset:1152 lds
 v_mfma_f32_16x16x32_bf16 v[188:191], v[220:223], a[196:199], v[188:191]
 s_waitcnt vmcnt(59) lgkmcnt(0)
 s_barrier
 v_mfma_f32_16x16x32_bf16 v[64:67], v[224:227], a[72:75], v[64:67]
 v_mfma_f32_16x16x32_bf16 v[68:71], v[224:227], a[76:79], v[68:71]
 v_mfma_f32_16x16x32_bf16 v[72:75], v[224:227], a[200:203], v[72:75]
 ds_read_b64_tr_b16 v[192:193], v17 offset:36864
 ds_read_b64_tr_b16 v[194:195], v17 offset:41472
 v_mfma_f32_16x16x32_bf16 v[76:79], v[224:227], a[204:207], v[76:79]
 s_add_u32 s40, s40, 65536
 ds_read_b64_tr_b16 v[196:197], v18 offset:36864
 ds_read_b64_tr_b16 v[198:199], v18 offset:41472
 v_mfma_f32_16x16x32_bf16 v[80:83], v[228:231], a[72:75], v[80:83]
 buffer_load_dwordx4 a[168:171], v16, s[16:19], s42 offen offset:1024 sc1
 v_mfma_f32_16x16x32_bf16 v[84:87], v[228:231], a[76:79], v[84:87]
 ds_read_b64_tr_b16 v[200:201], v19 offset:36864
 ds_read_b64_tr_b16 v[202:203], v19 offset:41472
 v_mfma_f32_16x16x32_bf16 v[88:91], v[228:231], a[200:203], v[88:91]
 ds_read_b64_tr_b16 v[204:205], v20 offset:36864
 ds_read_b64_tr_b16 v[206:207], v20 offset:41472
 v_mfma_f32_16x16x32_bf16 v[92:95], v[228:231], a[204:207], v[92:95]
 v_mfma_f32_16x16x32_bf16 v[96:99], v[232:235], a[72:75], v[96:99]
 ds_read_b64_tr_b16 v[208:209], v17 offset:36992
 ds_read_b64_tr_b16 v[210:211], v17 offset:41600
 v_mfma_f32_16x16x32_bf16 v[100:103], v[232:235], a[76:79], v[100:103]
 buffer_load_dwordx4 a[172:175], v2, s[16:19], s42 offen offset:1024 sc1
 v_mfma_f32_16x16x32_bf16 v[104:107], v[232:235], a[200:203], v[104:107]
 ds_read_b64_tr_b16 v[212:213], v18 offset:36992
 ds_read_b64_tr_b16 v[214:215], v18 offset:41600
 v_mfma_f32_16x16x32_bf16 v[108:111], v[232:235], a[204:207], v[108:111]
 ds_read_b64_tr_b16 v[216:217], v19 offset:36992
 ds_read_b64_tr_b16 v[218:219], v19 offset:41600
 v_mfma_f32_16x16x32_bf16 v[112:115], v[236:239], a[72:75], v[112:115]
 v_mfma_f32_16x16x32_bf16 v[116:119], v[236:239], a[76:79], v[116:119]
 ds_read_b64_tr_b16 v[220:221], v20 offset:36992
 ds_read_b64_tr_b16 v[222:223], v20 offset:41600
 v_mfma_f32_16x16x32_bf16 v[120:123], v[236:239], a[200:203], v[120:123]
 buffer_load_dwordx4 a[40:43], v16, s[16:19], s41 offen offset:1024 sc1
 v_mfma_f32_16x16x32_bf16 v[124:127], v[236:239], a[204:207], v[124:127]
 v_mfma_f32_16x16x32_bf16 v[128:131], v[240:243], a[72:75], v[128:131]
 v_mfma_f32_16x16x32_bf16 v[132:135], v[240:243], a[76:79], v[132:135]
 v_mfma_f32_16x16x32_bf16 v[136:139], v[240:243], a[200:203], v[136:139]
 buffer_load_dwordx4 a[44:47], v2, s[16:19], s41 offen offset:1024 sc1
 v_mfma_f32_16x16x32_bf16 v[140:143], v[240:243], a[204:207], v[140:143]
 v_mfma_f32_16x16x32_bf16 v[144:147], v[244:247], a[72:75], v[144:147]
 v_mfma_f32_16x16x32_bf16 v[148:151], v[244:247], a[76:79], v[148:151]
 s_add_u32 m0, s59, 16384
 v_mfma_f32_16x16x32_bf16 v[152:155], v[244:247], a[200:203], v[152:155]
 buffer_load_dwordx4 v0, s[8:11], s40 offen offset:0 lds
 v_mfma_f32_16x16x32_bf16 v[156:159], v[244:247], a[204:207], v[156:159]
 v_mfma_f32_16x16x32_bf16 v[160:163], v[248:251], a[72:75], v[160:163]
 v_mfma_f32_16x16x32_bf16 v[164:167], v[248:251], a[76:79], v[164:167]
 v_mfma_f32_16x16x32_bf16 v[168:171], v[248:251], a[200:203], v[168:171]
 buffer_load_dwordx4 v1, s[8:11], s40 offen offset:1152 lds
 v_mfma_f32_16x16x32_bf16 v[172:175], v[248:251], a[204:207], v[172:175]
 v_mfma_f32_16x16x32_bf16 v[176:179], v[252:255], a[72:75], v[176:179]
 v_mfma_f32_16x16x32_bf16 v[180:183], v[252:255], a[76:79], v[180:183]
 s_add_u32 s40, s40, 65536
 v_mfma_f32_16x16x32_bf16 v[184:187], v[252:255], a[200:203], v[184:187]
 buffer_load_dwordx4 a[176:179], v16, s[16:19], s42 offen offset:2048 sc1
 v_mfma_f32_16x16x32_bf16 v[188:191], v[252:255], a[204:207], v[188:191]
 s_waitcnt lgkmcnt(0)
 v_mfma_f32_16x16x32_bf16 v[64:67], v[192:195], a[80:83], v[64:67]
 v_mfma_f32_16x16x32_bf16 v[68:71], v[192:195], a[84:87], v[68:71]
 v_mfma_f32_16x16x32_bf16 v[72:75], v[192:195], a[208:211], v[72:75]
 ds_read_b64_tr_b16 v[224:225], v17 offset:46080
 ds_read_b64_tr_b16 v[226:227], v17 offset:50688
 v_mfma_f32_16x16x32_bf16 v[76:79], v[192:195], a[212:215], v[76:79]
 ds_read_b64_tr_b16 v[228:229], v18 offset:46080
 ds_read_b64_tr_b16 v[230:231], v18 offset:50688
 v_mfma_f32_16x16x32_bf16 v[80:83], v[196:199], a[80:83], v[80:83]
 buffer_load_dwordx4 a[180:183], v2, s[16:19], s42 offen offset:2048 sc1
 v_mfma_f32_16x16x32_bf16 v[84:87], v[196:199], a[84:87], v[84:87]
 ds_read_b64_tr_b16 v[232:233], v19 offset:46080
 ds_read_b64_tr_b16 v[234:235], v19 offset:50688
 v_mfma_f32_16x16x32_bf16 v[88:91], v[196:199], a[208:211], v[88:91]
 ds_read_b64_tr_b16 v[236:237], v20 offset:46080
 ds_read_b64_tr_b16 v[238:239], v20 offset:50688
 v_mfma_f32_16x16x32_bf16 v[92:95], v[196:199], a[212:215], v[92:95]
 v_mfma_f32_16x16x32_bf16 v[96:99], v[200:203], a[80:83], v[96:99]
 ds_read_b64_tr_b16 v[240:241], v17 offset:46208
 ds_read_b64_tr_b16 v[242:243], v17 offset:50816
 v_mfma_f32_16x16x32_bf16 v[100:103], v[200:203], a[84:87], v[100:103]
 buffer_load_dwordx4 a[48:51], v16, s[16:19], s41 offen offset:2048 sc1
 v_mfma_f32_16x16x32_bf16 v[104:107], v[200:203], a[208:211], v[104:107]
 ds_read_b64_tr_b16 v[244:245], v18 offset:46208
 ds_read_b64_tr_b16 v[246:247], v18 offset:50816
 v_mfma_f32_16x16x32_bf16 v[108:111], v[200:203], a[212:215], v[108:111]
 ds_read_b64_tr_b16 v[248:249], v19 offset:46208
 ds_read_b64_tr_b16 v[250:251], v19 offset:50816
 v_mfma_f32_16x16x32_bf16 v[112:115], v[204:207], a[80:83], v[112:115]
 v_add_u32 v13, s53, v13
 v_lshrrev_b32 v15, 8, v16
 v_mfma_f32_16x16x32_bf16 v[116:119], v[204:207], a[84:87], v[116:119]
 ds_read_b64_tr_b16 v[252:253], v20 offset:46208
 ds_read_b64_tr_b16 v[254:255], v20 offset:50816
 v_mfma_f32_16x16x32_bf16 v[120:123], v[204:207], a[208:211], v[120:123]
 buffer_load_dwordx4 a[52:55], v2, s[16:19], s41 offen offset:2048 sc1
 v_mfma_f32_16x16x32_bf16 v[124:127], v[204:207], a[212:215], v[124:127]
 v_lshlrev_b32 v15, 4, v15
 v_cmp_gt_u32 vcc, 256, v16
 v_mfma_f32_16x16x32_bf16 v[128:131], v[208:211], a[80:83], v[128:131]
 v_xor_b32 v15, s57, v15
 v_mfma_f32_16x16x32_bf16 v[132:135], v[208:211], a[84:87], v[132:135]
 s_add_u32 m0, s59, 25600
 v_cndmask_b32 v13, v15, v13, vcc
 v_mfma_f32_16x16x32_bf16 v[136:139], v[208:211], a[208:211], v[136:139]
 buffer_load_dwordx4 v0, s[8:11], s40 offen offset:0 lds
 v_mfma_f32_16x16x32_bf16 v[140:143], v[208:211], a[212:215], v[140:143]
 v_mfma_f32_16x16x32_bf16 v[144:147], v[212:215], a[80:83], v[144:147]
 v_mfma_f32_16x16x32_bf16 v[148:151], v[212:215], a[84:87], v[148:151]
 v_mfma_f32_16x16x32_bf16 v[152:155], v[212:215], a[208:211], v[152:155]
 buffer_load_dwordx4 v1, s[8:11], s40 offen offset:1152 lds
 v_mfma_f32_16x16x32_bf16 v[156:159], v[212:215], a[212:215], v[156:159]
 v_mfma_f32_16x16x32_bf16 v[160:163], v[216:219], a[80:83], v[160:163]
 v_mfma_f32_16x16x32_bf16 v[164:167], v[216:219], a[84:87], v[164:167]
 s_add_u32 s40, s40, 65536
 v_mfma_f32_16x16x32_bf16 v[168:171], v[216:219], a[208:211], v[168:171]
 buffer_load_dwordx4 a[184:187], v16, s[16:19], s42 offen offset:3072 sc1
 v_mfma_f32_16x16x32_bf16 v[172:175], v[216:219], a[212:215], v[172:175]
 v_mfma_f32_16x16x32_bf16 v[176:179], v[220:223], a[80:83], v[176:179]
 v_mfma_f32_16x16x32_bf16 v[180:183], v[220:223], a[84:87], v[180:183]
 v_mfma_f32_16x16x32_bf16 v[184:187], v[220:223], a[208:211], v[184:187]
 buffer_load_dwordx4 a[188:191], v2, s[16:19], s42 offen offset:3072 sc1
 v_mfma_f32_16x16x32_bf16 v[188:191], v[220:223], a[212:215], v[188:191]
 s_waitcnt vmcnt(62) lgkmcnt(0)
 s_barrier
 v_mfma_f32_16x16x32_bf16 v[64:67], v[224:227], a[88:91], v[64:67]
 v_mfma_f32_16x16x32_bf16 v[68:71], v[224:227], a[92:95], v[68:71]
 v_mfma_f32_16x16x32_bf16 v[72:75], v[224:227], a[216:219], v[72:75]
 ds_read_b64_tr_b16 v[192:193], v17 offset:55296
 ds_read_b64_tr_b16 v[194:195], v17 offset:59904
 v_mfma_f32_16x16x32_bf16 v[76:79], v[224:227], a[220:223], v[76:79]
 s_add_u32 s42, s42, 4096
 ds_read_b64_tr_b16 v[196:197], v18 offset:55296
 ds_read_b64_tr_b16 v[198:199], v18 offset:59904
 v_mfma_f32_16x16x32_bf16 v[80:83], v[228:231], a[88:91], v[80:83]
 buffer_load_dword v14, v13, s[28:31], 0 offen sc1
 v_mfma_f32_16x16x32_bf16 v[84:87], v[228:231], a[92:95], v[84:87]
 ds_read_b64_tr_b16 v[200:201], v19 offset:55296
 ds_read_b64_tr_b16 v[202:203], v19 offset:59904
 v_mfma_f32_16x16x32_bf16 v[88:91], v[228:231], a[216:219], v[88:91]
 ds_read_b64_tr_b16 v[204:205], v20 offset:55296
 ds_read_b64_tr_b16 v[206:207], v20 offset:59904
 v_mfma_f32_16x16x32_bf16 v[92:95], v[228:231], a[220:223], v[92:95]
 v_mfma_f32_16x16x32_bf16 v[96:99], v[232:235], a[88:91], v[96:99]
 ds_read_b64_tr_b16 v[208:209], v17 offset:55424
 ds_read_b64_tr_b16 v[210:211], v17 offset:60032
 v_mfma_f32_16x16x32_bf16 v[100:103], v[232:235], a[92:95], v[100:103]
 buffer_load_dwordx4 a[56:59], v16, s[16:19], s41 offen offset:3072 sc1
 v_mfma_f32_16x16x32_bf16 v[104:107], v[232:235], a[216:219], v[104:107]
 ds_read_b64_tr_b16 v[212:213], v18 offset:55424
 ds_read_b64_tr_b16 v[214:215], v18 offset:60032
 v_mfma_f32_16x16x32_bf16 v[108:111], v[232:235], a[220:223], v[108:111]
 ds_read_b64_tr_b16 v[216:217], v19 offset:55424
 ds_read_b64_tr_b16 v[218:219], v19 offset:60032
 v_mfma_f32_16x16x32_bf16 v[112:115], v[236:239], a[88:91], v[112:115]
 v_mfma_f32_16x16x32_bf16 v[116:119], v[236:239], a[92:95], v[116:119]
 ds_read_b64_tr_b16 v[220:221], v20 offset:55424
 ds_read_b64_tr_b16 v[222:223], v20 offset:60032
 v_mfma_f32_16x16x32_bf16 v[120:123], v[236:239], a[216:219], v[120:123]
 buffer_load_dwordx4 a[60:63], v2, s[16:19], s41 offen offset:3072 sc1
 v_mfma_f32_16x16x32_bf16 v[124:127], v[236:239], a[220:223], v[124:127]
 v_mfma_f32_16x16x32_bf16 v[128:131], v[240:243], a[88:91], v[128:131]
 v_mfma_f32_16x16x32_bf16 v[132:135], v[240:243], a[92:95], v[132:135]
 s_add_u32 s41, s41, 4096
 s_add_u32 m0, s59, 34816
 v_mfma_f32_16x16x32_bf16 v[136:139], v[240:243], a[216:219], v[136:139]
 buffer_load_dwordx4 v0, s[8:11], s40 offen offset:0 lds
 v_mfma_f32_16x16x32_bf16 v[140:143], v[240:243], a[220:223], v[140:143]
 v_mfma_f32_16x16x32_bf16 v[144:147], v[244:247], a[88:91], v[144:147]
 v_mfma_f32_16x16x32_bf16 v[148:151], v[244:247], a[92:95], v[148:151]
 v_mfma_f32_16x16x32_bf16 v[152:155], v[244:247], a[216:219], v[152:155]
 buffer_load_dwordx4 v1, s[8:11], s40 offen offset:1152 lds
 v_mfma_f32_16x16x32_bf16 v[156:159], v[244:247], a[220:223], v[156:159]
 v_mfma_f32_16x16x32_bf16 v[160:163], v[248:251], a[88:91], v[160:163]
 v_mfma_f32_16x16x32_bf16 v[164:167], v[248:251], a[92:95], v[164:167]
 s_add_u32 s40, s40, 65536
 v_mfma_f32_16x16x32_bf16 v[168:171], v[248:251], a[216:219], v[168:171]
 buffer_load_dwordx4 a[192:195], v16, s[16:19], s42 offen offset:0 sc1
 v_mfma_f32_16x16x32_bf16 v[172:175], v[248:251], a[220:223], v[172:175]
 v_mfma_f32_16x16x32_bf16 v[176:179], v[252:255], a[88:91], v[176:179]
 v_mfma_f32_16x16x32_bf16 v[180:183], v[252:255], a[92:95], v[180:183]
 v_mfma_f32_16x16x32_bf16 v[184:187], v[252:255], a[216:219], v[184:187]
 buffer_load_dwordx4 a[196:199], v2, s[16:19], s42 offen offset:0 sc1
 v_mfma_f32_16x16x32_bf16 v[188:191], v[252:255], a[220:223], v[188:191]
 s_waitcnt lgkmcnt(0)
 v_mfma_f32_16x16x32_bf16 v[64:67], v[192:195], a[96:99], v[64:67]
 v_add_u32 v17, 64512, v17
 v_add_u32 v18, 64512, v18
 v_mfma_f32_16x16x32_bf16 v[68:71], v[192:195], a[100:103], v[68:71]
 v_add_u32 v19, 64512, v19
 v_add_u32 v20, 64512, v20
 v_mfma_f32_16x16x32_bf16 v[72:75], v[192:195], a[224:227], v[72:75]
 ds_read_b64_tr_b16 v[224:225], v17 offset:0
 ds_read_b64_tr_b16 v[226:227], v17 offset:4608
 v_mfma_f32_16x16x32_bf16 v[76:79], v[192:195], a[228:231], v[76:79]
 ds_read_b64_tr_b16 v[228:229], v18 offset:0
 ds_read_b64_tr_b16 v[230:231], v18 offset:4608
 v_mfma_f32_16x16x32_bf16 v[80:83], v[196:199], a[96:99], v[80:83]
 buffer_load_dwordx4 a[64:67], v16, s[16:19], s41 offen offset:0 sc1
 v_mfma_f32_16x16x32_bf16 v[84:87], v[196:199], a[100:103], v[84:87]
 ds_read_b64_tr_b16 v[232:233], v19 offset:0
 ds_read_b64_tr_b16 v[234:235], v19 offset:4608
 v_mfma_f32_16x16x32_bf16 v[88:91], v[196:199], a[224:227], v[88:91]
 ds_read_b64_tr_b16 v[236:237], v20 offset:0
 ds_read_b64_tr_b16 v[238:239], v20 offset:4608
 v_mfma_f32_16x16x32_bf16 v[92:95], v[196:199], a[228:231], v[92:95]
 v_mfma_f32_16x16x32_bf16 v[96:99], v[200:203], a[96:99], v[96:99]
 ds_read_b64_tr_b16 v[240:241], v17 offset:128
 ds_read_b64_tr_b16 v[242:243], v17 offset:4736
 v_mfma_f32_16x16x32_bf16 v[100:103], v[200:203], a[100:103], v[100:103]
 buffer_load_dwordx4 a[68:71], v2, s[16:19], s41 offen offset:0 sc1
 v_mfma_f32_16x16x32_bf16 v[104:107], v[200:203], a[224:227], v[104:107]
 ds_read_b64_tr_b16 v[244:245], v18 offset:128
 ds_read_b64_tr_b16 v[246:247], v18 offset:4736
 v_mfma_f32_16x16x32_bf16 v[108:111], v[200:203], a[228:231], v[108:111]
 ds_read_b64_tr_b16 v[248:249], v19 offset:128
 ds_read_b64_tr_b16 v[250:251], v19 offset:4736
 v_mfma_f32_16x16x32_bf16 v[112:115], v[204:207], a[96:99], v[112:115]
 v_mfma_f32_16x16x32_bf16 v[116:119], v[204:207], a[100:103], v[116:119]
 s_add_u32 m0, s59, 44032
 ds_read_b64_tr_b16 v[252:253], v20 offset:128
 ds_read_b64_tr_b16 v[254:255], v20 offset:4736
 v_mfma_f32_16x16x32_bf16 v[120:123], v[204:207], a[224:227], v[120:123]
 buffer_load_dwordx4 v0, s[8:11], s40 offen offset:0 lds
 v_mfma_f32_16x16x32_bf16 v[124:127], v[204:207], a[228:231], v[124:127]
 v_mfma_f32_16x16x32_bf16 v[128:131], v[208:211], a[96:99], v[128:131]
 v_mfma_f32_16x16x32_bf16 v[132:135], v[208:211], a[100:103], v[132:135]
 v_mfma_f32_16x16x32_bf16 v[136:139], v[208:211], a[224:227], v[136:139]
 buffer_load_dwordx4 v1, s[8:11], s40 offen offset:1152 lds
 v_mfma_f32_16x16x32_bf16 v[140:143], v[208:211], a[228:231], v[140:143]
 v_mfma_f32_16x16x32_bf16 v[144:147], v[212:215], a[96:99], v[144:147]
 v_mfma_f32_16x16x32_bf16 v[148:151], v[212:215], a[100:103], v[148:151]
 s_add_u32 s40, s40, 65536
 v_mfma_f32_16x16x32_bf16 v[152:155], v[212:215], a[224:227], v[152:155]
 buffer_load_dwordx4 a[200:203], v16, s[16:19], s42 offen offset:1024 sc1
 v_mfma_f32_16x16x32_bf16 v[156:159], v[212:215], a[228:231], v[156:159]
 v_mfma_f32_16x16x32_bf16 v[160:163], v[216:219], a[96:99], v[160:163]
 v_mfma_f32_16x16x32_bf16 v[164:167], v[216:219], a[100:103], v[164:167]
 v_mfma_f32_16x16x32_bf16 v[168:171], v[216:219], a[224:227], v[168:171]
 buffer_load_dwordx4 a[204:207], v2, s[16:19], s42 offen offset:1024 sc1
 v_mfma_f32_16x16x32_bf16 v[172:175], v[216:219], a[228:231], v[172:175]
 v_mfma_f32_16x16x32_bf16 v[176:179], v[220:223], a[96:99], v[176:179]
 v_mfma_f32_16x16x32_bf16 v[180:183], v[220:223], a[100:103], v[180:183]
 v_mfma_f32_16x16x32_bf16 v[184:187], v[220:223], a[224:227], v[184:187]
 buffer_load_dwordx4 a[72:75], v16, s[16:19], s41 offen offset:1024 sc1
 v_mfma_f32_16x16x32_bf16 v[188:191], v[220:223], a[228:231], v[188:191]
 buffer_load_dwordx4 a[76:79], v2, s[16:19], s41 offen offset:1024 sc1
 s_waitcnt vmcnt(62) lgkmcnt(0)
 s_barrier
 v_mfma_f32_16x16x32_bf16 v[64:67], v[224:227], a[104:107], v[64:67]
 v_mfma_f32_16x16x32_bf16 v[68:71], v[224:227], a[108:111], v[68:71]
 v_mfma_f32_16x16x32_bf16 v[72:75], v[224:227], a[232:235], v[72:75]
 ds_read_b64_tr_b16 v[192:193], v17 offset:9216
 ds_read_b64_tr_b16 v[194:195], v17 offset:13824
 v_mfma_f32_16x16x32_bf16 v[76:79], v[224:227], a[236:239], v[76:79]
 s_add_u32 m0, s59, 53248
 ds_read_b64_tr_b16 v[196:197], v18 offset:9216
 ds_read_b64_tr_b16 v[198:199], v18 offset:13824
 v_mfma_f32_16x16x32_bf16 v[80:83], v[228:231], a[104:107], v[80:83]
 buffer_load_dwordx4 v0, s[8:11], s40 offen offset:0 lds
 v_mfma_f32_16x16x32_bf16 v[84:87], v[228:231], a[108:111], v[84:87]
 ds_read_b64_tr_b16 v[200:201], v19 offset:9216
 ds_read_b64_tr_b16 v[202:203], v19 offset:13824
 v_mfma_f32_16x16x32_bf16 v[88:91], v[228:231], a[232:235], v[88:91]
 ds_read_b64_tr_b16 v[204:205], v20 offset:9216
 ds_read_b64_tr_b16 v[206:207], v20 offset:13824
 v_mfma_f32_16x16x32_bf16 v[92:95], v[228:231], a[236:239], v[92:95]
 v_mfma_f32_16x16x32_bf16 v[96:99], v[232:235], a[104:107], v[96:99]
 ds_read_b64_tr_b16 v[208:209], v17 offset:9344
 ds_read_b64_tr_b16 v[210:211], v17 offset:13952
 v_mfma_f32_16x16x32_bf16 v[100:103], v[232:235], a[108:111], v[100:103]
 buffer_load_dwordx4 v1, s[8:11], s40 offen offset:1152 lds
 v_mfma_f32_16x16x32_bf16 v[104:107], v[232:235], a[232:235], v[104:107]
 ds_read_b64_tr_b16 v[212:213], v18 offset:9344
 ds_read_b64_tr_b16 v[214:215], v18 offset:13952
 v_mfma_f32_16x16x32_bf16 v[108:111], v[232:235], a[236:239], v[108:111]
 ds_read_b64_tr_b16 v[216:217], v19 offset:9344
 ds_read_b64_tr_b16 v[218:219], v19 offset:13952
 v_mfma_f32_16x16x32_bf16 v[112:115], v[236:239], a[104:107], v[112:115]
 s_waitcnt vmcnt(16)
 v_cmp_ne_u32 vcc, 1, v14
 s_nop 0
 v_mfma_f32_16x16x32_bf16 v[116:119], v[236:239], a[108:111], v[116:119]
 s_add_u32 s40, s40, 65536
 ds_read_b64_tr_b16 v[220:221], v20 offset:9344
 ds_read_b64_tr_b16 v[222:223], v20 offset:13952
 v_mfma_f32_16x16x32_bf16 v[120:123], v[236:239], a[232:235], v[120:123]
 buffer_load_dwordx4 a[208:211], v16, s[16:19], s42 offen offset:2048 sc1
 v_mfma_f32_16x16x32_bf16 v[124:127], v[236:239], a[236:239], v[124:127]
 s_cbranch_vccnz L_spin_y
L_spin_y_ret:
 v_mfma_f32_16x16x32_bf16 v[128:131], v[240:243], a[104:107], v[128:131]
 s_lshl_b32 s53, s32, 12
 v_mfma_f32_16x16x32_bf16 v[132:135], v[240:243], a[108:111], v[132:135]
 v_mfma_f32_16x16x32_bf16 v[136:139], v[240:243], a[232:235], v[136:139]
 buffer_load_dwordx4 a[212:215], v2, s[16:19], s42 offen offset:2048 sc1
 v_mfma_f32_16x16x32_bf16 v[140:143], v[240:243], a[236:239], v[140:143]
 v_mfma_f32_16x16x32_bf16 v[144:147], v[244:247], a[104:107], v[144:147]
 v_mfma_f32_16x16x32_bf16 v[148:151], v[244:247], a[108:111], v[148:151]
 v_mfma_f32_16x16x32_bf16 v[152:155], v[244:247], a[232:235], v[152:155]
 buffer_load_dwordx4 a[80:83], v16, s[16:19], s41 offen offset:2048 sc1
 v_mfma_f32_16x16x32_bf16 v[156:159], v[244:247], a[236:239], v[156:159]
 v_mfma_f32_16x16x32_bf16 v[160:163], v[248:251], a[104:107], v[160:163]
 v_mfma_f32_16x16x32_bf16 v[164:167], v[248:251], a[108:111], v[164:167]
 v_mfma_f32_16x16x32_bf16 v[168:171], v[248:251], a[232:235], v[168:171]
 buffer_load_dwordx4 a[84:87], v2, s[16:19], s41 offen offset:2048 sc1
 v_mfma_f32_16x16x32_bf16 v[172:175], v[248:251], a[236:239], v[172:175]
 v_mfma_f32_16x16x32_bf16 v[176:179], v[252:255], a[104:107], v[176:179]
 v_mfma_f32_16x16x32_bf16 v[180:183], v[252:255], a[108:111], v[180:183]
 s_add_u32 m0, s59, 62464
 v_mfma_f32_16x16x32_bf16 v[184:187], v[252:255], a[232:235], v[184:187]
 buffer_load_dwordx4 v0, s[8:11], s40 offen offset:0 lds
 v_mfma_f32_16x16x32_bf16 v[188:191], v[252:255], a[236:239], v[188:191]
 s_waitcnt lgkmcnt(0)
 v_mfma_f32_16x16x32_bf16 v[64:67], v[192:195], a[112:115], v[64:67]
 v_mfma_f32_16x16x32_bf16 v[68:71], v[192:195], a[116:119], v[68:71]
 v_mfma_f32_16x16x32_bf16 v[72:75], v[192:195], a[240:243], v[72:75]
 ds_read_b64_tr_b16 v[224:225], v17 offset:18432
 ds_read_b64_tr_b16 v[226:227], v17 offset:23040
 v_mfma_f32_16x16x32_bf16 v[76:79], v[192:195], a[244:247], v[76:79]
 ds_read_b64_tr_b16 v[228:229], v18 offset:18432
 ds_read_b64_tr_b16 v[230:231], v18 offset:23040
 v_mfma_f32_16x16x32_bf16 v[80:83], v[196:199], a[112:115], v[80:83]
 buffer_load_dwordx4 v1, s[8:11], s40 offen offset:1152 lds
 v_mfma_f32_16x16x32_bf16 v[84:87], v[196:199], a[116:119], v[84:87]
 ds_read_b64_tr_b16 v[232:233], v19 offset:18432
 ds_read_b64_tr_b16 v[234:235], v19 offset:23040
 v_mfma_f32_16x16x32_bf16 v[88:91], v[196:199], a[240:243], v[88:91]
 ds_read_b64_tr_b16 v[236:237], v20 offset:18432
 ds_read_b64_tr_b16 v[238:239], v20 offset:23040
 v_mfma_f32_16x16x32_bf16 v[92:95], v[196:199], a[244:247], v[92:95]
 v_mfma_f32_16x16x32_bf16 v[96:99], v[200:203], a[112:115], v[96:99]
 s_add_u32 s40, s40, 65536
 s_add_u32 m0, s53, 0
 s_add_u32 s36, s51, 0
 ds_read_b64_tr_b16 v[240:241], v17 offset:18560
 ds_read_b64_tr_b16 v[242:243], v17 offset:23168
 v_mfma_f32_16x16x32_bf16 v[100:103], v[200:203], a[116:119], v[100:103]
 buffer_load_dwordx4 v10, s[12:15], s36 offen sc1 lds
 v_mfma_f32_16x16x32_bf16 v[104:107], v[200:203], a[240:243], v[104:107]
 ds_read_b64_tr_b16 v[244:245], v18 offset:18560
 ds_read_b64_tr_b16 v[246:247], v18 offset:23168
 v_mfma_f32_16x16x32_bf16 v[108:111], v[200:203], a[244:247], v[108:111]
 ds_read_b64_tr_b16 v[248:249], v19 offset:18560
 ds_read_b64_tr_b16 v[250:251], v19 offset:23168
 v_mfma_f32_16x16x32_bf16 v[112:115], v[204:207], a[112:115], v[112:115]
 s_mov_b32 s37, 0xffff0000
 s_waitcnt vmcnt(62)
 v_permlane16_swap_b32 v24, v26
 v_mfma_f32_16x16x32_bf16 v[116:119], v[204:207], a[116:119], v[116:119]
 s_add_u32 m0, s53, 1024
 s_add_u32 s36, s51, 8192
 ds_read_b64_tr_b16 v[252:253], v20 offset:18560
 ds_read_b64_tr_b16 v[254:255], v20 offset:23168
 v_mfma_f32_16x16x32_bf16 v[120:123], v[204:207], a[240:243], v[120:123]
 buffer_load_dwordx4 v10, s[12:15], s36 offen sc1 lds
 v_mfma_f32_16x16x32_bf16 v[124:127], v[204:207], a[244:247], v[124:127]
 v_permlane16_swap_b32 v25, v27
 v_mfma_f32_16x16x32_bf16 v[128:131], v[208:211], a[112:115], v[128:131]
 v_permlane16_swap_b32 v28, v30
 v_mfma_f32_16x16x32_bf16 v[132:135], v[208:211], a[116:119], v[132:135]
 s_add_u32 m0, s53, 2048
 s_add_u32 s36, s51, 16384
 v_permlane16_swap_b32 v29, v31
 v_mfma_f32_16x16x32_bf16 v[136:139], v[208:211], a[240:243], v[136:139]
 buffer_load_dwordx4 v10, s[12:15], s36 offen sc1 lds
 v_mfma_f32_16x16x32_bf16 v[140:143], v[208:211], a[244:247], v[140:143]
 v_permlane16_swap_b32 v32, v34
 v_mfma_f32_16x16x32_bf16 v[144:147], v[212:215], a[112:115], v[144:147]
 v_permlane16_swap_b32 v33, v35
 v_mfma_f32_16x16x32_bf16 v[148:151], v[212:215], a[116:119], v[148:151]
 s_add_u32 m0, s53, 3072
 s_add_u32 s36, s51, 24576
 v_permlane16_swap_b32 v36, v38
 v_mfma_f32_16x16x32_bf16 v[152:155], v[212:215], a[240:243], v[152:155]
 buffer_load_dwordx4 v10, s[12:15], s36 offen sc1 lds
 v_mfma_f32_16x16x32_bf16 v[156:159], v[212:215], a[244:247], v[156:159]
 v_permlane16_swap_b32 v37, v39
 v_mfma_f32_16x16x32_bf16 v[160:163], v[216:219], a[112:115], v[160:163]
 v_mfma_f32_16x16x32_bf16 v[164:167], v[216:219], a[116:119], v[164:167]
 v_mfma_f32_16x16x32_bf16 v[168:171], v[216:219], a[240:243], v[168:171]
 buffer_load_dwordx4 a[216:219], v16, s[16:19], s42 offen offset:3072 sc1
 v_mfma_f32_16x16x32_bf16 v[172:175], v[216:219], a[244:247], v[172:175]
 v_mfma_f32_16x16x32_bf16 v[176:179], v[220:223], a[112:115], v[176:179]
 v_mfma_f32_16x16x32_bf16 v[180:183], v[220:223], a[116:119], v[180:183]
 v_mfma_f32_16x16x32_bf16 v[184:187], v[220:223], a[240:243], v[184:187]
 buffer_load_dwordx4 a[220:223], v2, s[16:19], s42 offen offset:3072 sc1
 v_mfma_f32_16x16x32_bf16 v[188:191], v[220:223], a[244:247], v[188:191]
 s_waitcnt vmcnt(62) lgkmcnt(0)
 s_barrier
 v_mfma_f32_16x16x32_bf16 v[64:67], v[224:227], a[120:123], v[64:67]
 v_mfma_f32_16x16x32_bf16 v[68:71], v[224:227], a[124:127], v[68:71]
 v_mfma_f32_16x16x32_bf16 v[72:75], v[224:227], a[248:251], v[72:75]
 ds_read_b64_tr_b16 v[192:193], v17 offset:27648
 ds_read_b64_tr_b16 v[194:195], v17 offset:32256
 v_mfma_f32_16x16x32_bf16 v[76:79], v[224:227], a[252:255], v[76:79]
 s_add_u32 s42, s42, 4096
 ds_read_b64_tr_b16 v[196:197], v18 offset:27648
 ds_read_b64_tr_b16 v[198:199], v18 offset:32256
 v_mfma_f32_16x16x32_bf16 v[80:83], v[228:231], a[120:123], v[80:83]
 buffer_load_dwordx4 a[88:91], v16, s[16:19], s41 offen offset:3072 sc1
 v_mfma_f32_16x16x32_bf16 v[84:87], v[228:231], a[124:127], v[84:87]
 ds_read_b64_tr_b16 v[200:201], v19 offset:27648
 ds_read_b64_tr_b16 v[202:203], v19 offset:32256
 v_mfma_f32_16x16x32_bf16 v[88:91], v[228:231], a[248:251], v[88:91]
 ds_read_b64_tr_b16 v[204:205], v20 offset:27648
 ds_read_b64_tr_b16 v[206:207], v20 offset:32256
 v_mfma_f32_16x16x32_bf16 v[92:95], v[228:231], a[252:255], v[92:95]
 v_mfma_f32_16x16x32_bf16 v[96:99], v[232:235], a[120:123], v[96:99]
 ds_read_b64_tr_b16 v[208:209], v17 offset:27776
 ds_read_b64_tr_b16 v[210:211], v17 offset:32384
 v_mfma_f32_16x16x32_bf16 v[100:103], v[232:235], a[124:127], v[100:103]
 buffer_load_dwordx4 a[92:95], v2, s[16:19], s41 offen offset:3072 sc1
 v_mfma_f32_16x16x32_bf16 v[104:107], v[232:235], a[248:251], v[104:107]
 ds_read_b64_tr_b16 v[212:213], v18 offset:27776
 ds_read_b64_tr_b16 v[214:215], v18 offset:32384
 v_mfma_f32_16x16x32_bf16 v[108:111], v[232:235], a[252:255], v[108:111]
 ds_read_b64_tr_b16 v[216:217], v19 offset:27776
 ds_read_b64_tr_b16 v[218:219], v19 offset:32384
 v_mfma_f32_16x16x32_bf16 v[112:115], v[236:239], a[120:123], v[112:115]
 v_mfma_f32_16x16x32_bf16 v[116:119], v[236:239], a[124:127], v[116:119]
 s_add_u32 s41, s41, 4096
 s_add_u32 m0, s59, 71680
 ds_read_b64_tr_b16 v[220:221], v20 offset:27776
 ds_read_b64_tr_b16 v[222:223], v20 offset:32384
 v_mfma_f32_16x16x32_bf16 v[120:123], v[236:239], a[248:251], v[120:123]
 buffer_load_dwordx4 v0, s[8:11], s40 offen offset:0 lds
 v_mfma_f32_16x16x32_bf16 v[124:127], v[236:239], a[252:255], v[124:127]
 v_mfma_f32_16x16x32_bf16 v[128:131], v[240:243], a[120:123], v[128:131]
 v_mfma_f32_16x16x32_bf16 v[132:135], v[240:243], a[124:127], v[132:135]
 v_mfma_f32_16x16x32_bf16 v[136:139], v[240:243], a[248:251], v[136:139]
 buffer_load_dwordx4 v1, s[8:11], s40 offen offset:1152 lds
 v_mfma_f32_16x16x32_bf16 v[140:143], v[240:243], a[252:255], v[140:143]
 v_mfma_f32_16x16x32_bf16 v[144:147], v[244:247], a[120:123], v[144:147]
 v_mfma_f32_16x16x32_bf16 v[148:151], v[244:247], a[124:127], v[148:151]
 s_add_u32 s40, s40, 65536
 v_mfma_f32_16x16x32_bf16 v[152:155], v[244:247], a[248:251], v[152:155]
 buffer_load_dwordx4 a[224:227], v16, s[16:19], s42 offen offset:0 sc1
 v_mfma_f32_16x16x32_bf16 v[156:159], v[244:247], a[252:255], v[156:159]
 v_mfma_f32_16x16x32_bf16 v[160:163], v[248:251], a[120:123], v[160:163]
 v_mfma_f32_16x16x32_bf16 v[164:167], v[248:251], a[124:127], v[164:167]
 v_mfma_f32_16x16x32_bf16 v[168:171], v[248:251], a[248:251], v[168:171]
 buffer_load_dwordx4 a[228:231], v2, s[16:19], s42 offen offset:0 sc1
 v_mfma_f32_16x16x32_bf16 v[172:175], v[248:251], a[252:255], v[172:175]
 v_mfma_f32_16x16x32_bf16 v[176:179], v[252:255], a[120:123], v[176:179]
 v_mfma_f32_16x16x32_bf16 v[180:183], v[252:255], a[124:127], v[180:183]
 v_mfma_f32_16x16x32_bf16 v[184:187], v[252:255], a[248:251], v[184:187]
 buffer_load_dwordx4 a[96:99], v16, s[16:19], s41 offen offset:0 sc1
 v_mfma_f32_16x16x32_bf16 v[188:191], v[252:255], a[252:255], v[188:191]
 s_waitcnt lgkmcnt(0)
 v_mfma_f32_16x16x32_bf16 v[64:67], v[192:195], a[0:3], v[64:67]
L_pad15:
 s_cbranch_execz L_back
 ds_read_b64_tr_b16 v[224:225], v17 offset:36864
 ds_read_b64_tr_b16 v[226:227], v17 offset:41472
 v_mfma_f32_16x16x32_bf16 v[68:71], v[192:195], a[4:7], v[68:71]
 buffer_load_dwordx4 a[100:103], v2, s[16:19], s41 offen offset:0 sc1
 v_mfma_f32_16x16x32_bf16 v[72:75], v[192:195], a[128:131], v[72:75]
 ds_read_b64_tr_b16 v[228:229], v18 offset:36864
 ds_read_b64_tr_b16 v[230:231], v18 offset:41472
 v_mfma_f32_16x16x32_bf16 v[76:79], v[192:195], a[132:135], v[76:79]
 v_mfma_f32_16x16x32_bf16 v[80:83], v[196:199], a[0:3], v[80:83]
 v_mfma_f32_16x16x32_bf16 v[84:87], v[196:199], a[4:7], v[84:87]
 s_add_u32 m0, s59, 80896
 s_nop 0
 buffer_load_dwordx4 v0, s[8:11], s40 offen offset:0 lds
 v_mfma_f32_16x16x32_bf16 v[88:91], v[196:199], a[128:131], v[88:91]
 v_mfma_f32_16x16x32_bf16 v[92:95], v[196:199], a[132:135], v[92:95]
 buffer_load_dwordx4 v1, s[8:11], s40 offen offset:1152 lds
 s_waitcnt vmcnt(12) lgkmcnt(0)
 s_barrier
 v_mfma_f32_16x16x32_bf16 v[64:67], v[224:227], a[8:11], v[64:67]
 ds_read_b64_tr_b16 v[192:193], v17 offset:46080
 ds_read_b64_tr_b16 v[194:195], v17 offset:50688
 v_mfma_f32_16x16x32_bf16 v[68:71], v[224:227], a[12:15], v[68:71]
 s_add_u32 s40, s40, 65536
 buffer_load_dwordx4 a[232:235], v16, s[16:19], s42 offen offset:1024 sc1
 v_mfma_f32_16x16x32_bf16 v[72:75], v[224:227], a[136:139], v[72:75]
 ds_read_b64_tr_b16 v[196:197], v18 offset:46080
 ds_read_b64_tr_b16 v[198:199], v18 offset:50688
 v_mfma_f32_16x16x32_bf16 v[76:79], v[224:227], a[140:143], v[76:79]
 ds_read_b64_tr_b16 v[48:49], v22 offset:0
 ds_read_b64_tr_b16 v[50:51], v22 offset:128
 v_mfma_f32_16x16x32_bf16 v[80:83], v[228:231], a[8:11], v[80:83]
 ds_read_b64_tr_b16 v[52:53], v22 offset:256
 ds_read_b64_tr_b16 v[54:55], v22 offset:384
 v_mfma_f32_16x16x32_bf16 v[84:87], v[228:231], a[12:15], v[84:87]
 buffer_load_dwordx4 a[236:239], v2, s[16:19], s42 offen offset:1024 sc1
 v_mfma_f32_16x16x32_bf16 v[88:91], v[228:231], a[136:139], v[88:91]
 ds_read_b64_tr_b16 v[56:57], v22 offset:8192
 ds_read_b64_tr_b16 v[58:59], v22 offset:8320
 v_mfma_f32_16x16x32_bf16 v[92:95], v[228:231], a[140:143], v[92:95]
 s_waitcnt lgkmcnt(0)
 ds_read_b64_tr_b16 v[60:61], v22 offset:8448
 ds_read_b64_tr_b16 v[62:63], v22 offset:8576
 v_mfma_f32_16x16x32_bf16 v[64:67], v[192:195], a[16:19], v[64:67]
 ds_read_b64_tr_b16 v[224:225], v17 offset:55296
 ds_read_b64_tr_b16 v[226:227], v17 offset:59904
 v_mfma_f32_16x16x32_bf16 v[68:71], v[192:195], a[20:23], v[68:71]
 buffer_load_dwordx4 a[104:107], v16, s[16:19], s41 offen offset:1024 sc1
 v_mfma_f32_16x16x32_bf16 v[72:75], v[192:195], a[144:147], v[72:75]
 ds_read_b64_tr_b16 v[228:229], v18 offset:55296
 ds_read_b64_tr_b16 v[230:231], v18 offset:59904
 v_mfma_f32_16x16x32_bf16 v[76:79], v[192:195], a[148:151], v[76:79]
 v_mfma_f32_16x16x32_bf16 v[80:83], v[196:199], a[16:19], v[80:83]
 v_mfma_f32_16x16x32_bf16 v[84:87], v[196:199], a[20:23], v[84:87]
 buffer_load_dwordx4 a[108:111], v2, s[16:19], s41 offen offset:1024 sc1
 v_mfma_f32_16x16x32_bf16 v[88:91], v[196:199], a[144:147], v[88:91]
 v_mfma_f32_16x16x32_bf16 v[92:95], v[196:199], a[148:151], v[92:95]
 s_waitcnt lgkmcnt(0)
 v_lshlrev_b32 v3, 16, v24
 v_lshlrev_b32 v4, 16, v48
 s_waitcnt vmcnt(57) lgkmcnt(0)
 s_barrier
 v_mfma_f32_16x16x32_bf16 v[64:67], v[224:227], a[24:27], v[64:67]
 v_add_u32 v17, 64512, v17
 v_add_u32 v18, 64512, v18
 v_mfma_f32_16x16x32_bf16 v[68:71], v[224:227], a[28:31], v[68:71]
 v_add_u32 v19, 64512, v19
 v_add_u32 v20, 64512, v20
 v_mfma_f32_16x16x32_bf16 v[72:75], v[224:227], a[152:155], v[72:75]
 ds_read_b64_tr_b16 v[192:193], v17 offset:0
 ds_read_b64_tr_b16 v[194:195], v17 offset:4608
 v_mfma_f32_16x16x32_bf16 v[76:79], v[224:227], a[156:159], v[76:79]
 ds_read_b64_tr_b16 v[196:197], v18 offset:0
 ds_read_b64_tr_b16 v[198:199], v18 offset:4608
 v_mfma_f32_16x16x32_bf16 v[80:83], v[228:231], a[24:27], v[80:83]
 s_add_u32 m0, s59, 90112
 s_nop 0
 buffer_load_dwordx4 v0, s[8:11], s40 offen offset:0 lds
 v_mfma_f32_16x16x32_bf16 v[84:87], v[228:231], a[28:31], v[84:87]
 buffer_load_dwordx4 v1, s[8:11], s40 offen offset:1152 lds
 v_mfma_f32_16x16x32_bf16 v[88:91], v[228:231], a[152:155], v[88:91]
 v_mul_f32 v3, v3, v4
 v_mul_f32 v40, v6, v3
 v_mfma_f32_16x16x32_bf16 v[92:95], v[228:231], a[156:159], v[92:95]
 s_waitcnt lgkmcnt(0)
 v_and_b32 v3, s37, v24
 v_and_b32 v4, s37, v48
 v_mfma_f32_16x16x32_bf16 v[64:67], v[192:195], a[32:35], v[64:67]
 ds_read_b64_tr_b16 v[224:225], v17 offset:9216
 ds_read_b64_tr_b16 v[226:227], v17 offset:13824
 v_mfma_f32_16x16x32_bf16 v[68:71], v[192:195], a[36:39], v[68:71]
 s_add_u32 s40, s40, 65536
 buffer_load_dwordx4 a[240:243], v16, s[16:19], s42 offen offset:2048 sc1
 v_mfma_f32_16x16x32_bf16 v[72:75], v[192:195], a[160:163], v[72:75]
 ds_read_b64_tr_b16 v[228:229], v18 offset:9216
 ds_read_b64_tr_b16 v[230:231], v18 offset:13824
 v_mfma_f32_16x16x32_bf16 v[76:79], v[192:195], a[164:167], v[76:79]
 v_mul_f32 v3, v3, v4
 v_mul_f32 v41, v6, v3
 v_mfma_f32_16x16x32_bf16 v[80:83], v[196:199], a[32:35], v[80:83]
 v_lshlrev_b32 v3, 16, v25
 v_lshlrev_b32 v4, 16, v49
 v_mfma_f32_16x16x32_bf16 v[84:87], v[196:199], a[36:39], v[84:87]
 buffer_load_dwordx4 a[244:247], v2, s[16:19], s42 offen offset:2048 sc1
 v_mfma_f32_16x16x32_bf16 v[88:91], v[196:199], a[160:163], v[88:91]
 v_mul_f32 v3, v3, v4
 v_mul_f32 v42, v6, v3
 v_mfma_f32_16x16x32_bf16 v[92:95], v[196:199], a[164:167], v[92:95]
 v_and_b32 v3, s37, v25
 v_and_b32 v4, s37, v49
 s_waitcnt vmcnt(49) lgkmcnt(0)
 s_barrier
 v_mfma_f32_16x16x32_bf16 v[64:67], v[224:227], a[40:43], v[64:67]
 v_add_u32 v17, 4294838272, v17
 v_add_u32 v18, 4294838272, v18
 v_mfma_f32_16x16x32_bf16 v[68:71], v[224:227], a[44:47], v[68:71]
 v_add_u32 v19, 4294838272, v19
 v_add_u32 v20, 4294838272, v20
 v_mfma_f32_16x16x32_bf16 v[72:75], v[224:227], a[168:171], v[72:75]
 ds_read_b64_tr_b16 v[192:193], v17 offset:0
 ds_read_b64_tr_b16 v[194:195], v17 offset:4608
 v_mfma_f32_16x16x32_bf16 v[76:79], v[224:227], a[172:175], v[76:79]
 ds_read_b64_tr_b16 v[196:197], v18 offset:0
 ds_read_b64_tr_b16 v[198:199], v18 offset:4608
 v_mfma_f32_16x16x32_bf16 v[80:83], v[228:231], a[40:43], v[80:83]
 buffer_load_dwordx4 a[112:115], v16, s[16:19], s41 offen offset:2048 sc1
 v_mfma_f32_16x16x32_bf16 v[84:87], v[228:231], a[44:47], v[84:87]
 buffer_load_dwordx4 a[116:119], v2, s[16:19], s41 offen offset:2048 sc1
 v_mfma_f32_16x16x32_bf16 v[88:91], v[228:231], a[168:171], v[88:91]
 v_mul_f32 v3, v3, v4
 v_mul_f32 v43, v6, v3
 v_mfma_f32_16x16x32_bf16 v[92:95], v[228:231], a[172:175], v[92:95]
 s_waitcnt lgkmcnt(0)
 v_lshlrev_b32 v3, 16, v28
 v_lshlrev_b32 v4, 16, v50
 v_mfma_f32_16x16x32_bf16 v[64:67], v[192:195], a[48:51], v[64:67]
 ds_read_b64_tr_b16 v[224:225], v17 offset:9216
 ds_read_b64_tr_b16 v[226:227], v17 offset:13824
 v_mfma_f32_16x16x32_bf16 v[68:71], v[192:195], a[52:55], v[68:71]
 s_add_u32 m0, s59, 99328
 s_nop 0
 buffer_load_dwordx4 v0, s[8:11], s40 offen offset:0 lds
 v_mfma_f32_16x16x32_bf16 v[72:75], v[192:195], a[176:179], v[72:75]
 ds_read_b64_tr_b16 v[228:229], v18 offset:9216
 ds_read_b64_tr_b16 v[230:231], v18 offset:13824
 v_mfma_f32_16x16x32_bf16 v[76:79], v[192:195], a[180:183], v[76:79]
 v_mul_f32 v3, v3, v4
 v_mul_f32 v44, v7, v3
 v_mfma_f32_16x16x32_bf16 v[80:83], v[196:199], a[48:51], v[80:83]
 v_and_b32 v3, s37, v28
 v_and_b32 v4, s37, v50
 v_mfma_f32_16x16x32_bf16 v[84:87], v[196:199], a[52:55], v[84:87]
 buffer_load_dwordx4 v1, s[8:11], s40 offen offset:1152 lds
 v_mfma_f32_16x16x32_bf16 v[88:91], v[196:199], a[176:179], v[88:91]
 v_mul_f32 v3, v3, v4
 v_mul_f32 v45, v7, v3
 v_mfma_f32_16x16x32_bf16 v[92:95], v[196:199], a[180:183], v[92:95]
 v_lshlrev_b32 v3, 16, v29
 v_lshlrev_b32 v4, 16, v51
 s_waitcnt vmcnt(40) lgkmcnt(0)
 s_barrier
 v_mfma_f32_16x16x32_bf16 v[64:67], v[224:227], a[56:59], v[64:67]
 ds_read_b64_tr_b16 v[192:193], v17 offset:18432
 ds_read_b64_tr_b16 v[194:195], v17 offset:23040
 v_mfma_f32_16x16x32_bf16 v[68:71], v[224:227], a[60:63], v[68:71]
 s_add_u32 s40, s40, 65536
 buffer_load_dwordx4 a[248:251], v16, s[16:19], s42 offen offset:3072 sc1
 v_mfma_f32_16x16x32_bf16 v[72:75], v[224:227], a[184:187], v[72:75]
 ds_read_b64_tr_b16 v[196:197], v18 offset:18432
 ds_read_b64_tr_b16 v[198:199], v18 offset:23040
 v_mfma_f32_16x16x32_bf16 v[76:79], v[224:227], a[188:191], v[76:79]
 v_mul_f32 v3, v3, v4
 v_mul_f32 v46, v7, v3
 v_mfma_f32_16x16x32_bf16 v[80:83], v[228:231], a[56:59], v[80:83]
 v_and_b32 v3, s37, v29
 v_and_b32 v4, s37, v51
 v_mfma_f32_16x16x32_bf16 v[84:87], v[228:231], a[60:63], v[84:87]
 buffer_load_dwordx4 a[252:255], v2, s[16:19], s42 offen offset:3072 sc1
 v_mfma_f32_16x16x32_bf16 v[88:91], v[228:231], a[184:187], v[88:91]
 v_mul_f32 v3, v3, v4
 v_mul_f32 v47, v7, v3
 v_mfma_f32_16x16x32_bf16 v[92:95], v[228:231], a[188:191], v[92:95]
 s_waitcnt lgkmcnt(0)
 v_lshlrev_b32 v3, 16, v32
 v_lshlrev_b32 v4, 16, v52
 v_mfma_f32_16x16x32_bf16 v[64:67], v[192:195], a[64:67], v[64:67]
 ds_read_b64_tr_b16 v[224:225], v17 offset:27648
 ds_read_b64_tr_b16 v[226:227], v17 offset:32256
 v_mfma_f32_16x16x32_bf16 v[68:71], v[192:195], a[68:71], v[68:71]
 s_add_u32 s42, s42, 4096
 buffer_load_dwordx4 a[120:123], v16, s[16:19], s41 offen offset:3072 sc1
 v_mfma_f32_16x16x32_bf16 v[72:75], v[192:195], a[192:195], v[72:75]
 ds_read_b64_tr_b16 v[228:229], v18 offset:27648
 ds_read_b64_tr_b16 v[230:231], v18 offset:32256
 v_mfma_f32_16x16x32_bf16 v[76:79], v[192:195], a[196:199], v[76:79]
 v_mul_f32 v3, v3, v4
 v_mul_f32 v48, v11, v3
 v_mfma_f32_16x16x32_bf16 v[80:83], v[196:199], a[64:67], v[80:83]
 v_and_b32 v3, s37, v32
 v_and_b32 v4, s37, v52
 v_mfma_f32_16x16x32_bf16 v[84:87], v[196:199], a[68:71], v[84:87]
 buffer_load_dwordx4 a[124:127], v2, s[16:19], s41 offen offset:3072 sc1
 v_mfma_f32_16x16x32_bf16 v[88:91], v[196:199], a[192:195], v[88:91]
 v_mul_f32 v3, v3, v4
 v_mul_f32 v49, v11, v3
 v_mfma_f32_16x16x32_bf16 v[92:95], v[196:199], a[196:199], v[92:95]
 v_lshlrev_b32 v3, 16, v33
 v_lshlrev_b32 v4, 16, v53
 s_waitcnt vmcnt(32) lgkmcnt(0)
 s_barrier
 v_mfma_f32_16x16x32_bf16 v[64:67], v[224:227], a[72:75], v[64:67]
 ds_read_b64_tr_b16 v[192:193], v17 offset:36864
 ds_read_b64_tr_b16 v[194:195], v17 offset:41472
 v_mfma_f32_16x16x32_bf16 v[68:71], v[224:227], a[76:79], v[68:71]
 s_add_u32 s41, s41, 4096
 s_add_u32 s16, s94, 67108864
 s_addc_u32 s17, s95, 0
 s_mov_b32 s18, 16777216
 v_mul_f32 v3, v3, v4
 v_mul_f32 v50, v11, v3
 v_mfma_f32_16x16x32_bf16 v[72:75], v[224:227], a[200:203], v[72:75]
 ds_read_b64_tr_b16 v[196:197], v18 offset:36864
 ds_read_b64_tr_b16 v[198:199], v18 offset:41472
 v_mfma_f32_16x16x32_bf16 v[76:79], v[224:227], a[204:207], v[76:79]
 v_and_b32 v3, s37, v33
 v_and_b32 v4, s37, v53
 v_mfma_f32_16x16x32_bf16 v[80:83], v[228:231], a[72:75], v[80:83]
 v_mul_f32 v3, v3, v4
 v_mul_f32 v51, v11, v3
 v_mfma_f32_16x16x32_bf16 v[84:87], v[228:231], a[76:79], v[84:87]
 v_lshlrev_b32 v3, 16, v36
 v_lshlrev_b32 v4, 16, v54
 v_mfma_f32_16x16x32_bf16 v[88:91], v[228:231], a[200:203], v[88:91]
 v_mul_f32 v3, v3, v4
 v_mul_f32 v52, v12, v3
 v_mfma_f32_16x16x32_bf16 v[92:95], v[228:231], a[204:207], v[92:95]
 s_waitcnt lgkmcnt(0)
 v_and_b32 v3, s37, v36
 v_and_b32 v4, s37, v54
 v_mfma_f32_16x16x32_bf16 v[64:67], v[192:195], a[80:83], v[64:67]
 ds_read_b64_tr_b16 v[224:225], v17 offset:46080
 ds_read_b64_tr_b16 v[226:227], v17 offset:50688
 v_mfma_f32_16x16x32_bf16 v[68:71], v[192:195], a[84:87], v[68:71]
 v_mul_f32 v3, v3, v4
 v_mul_f32 v53, v12, v3
 v_mfma_f32_16x16x32_bf16 v[72:75], v[192:195], a[208:211], v[72:75]
 ds_read_b64_tr_b16 v[228:229], v18 offset:46080
 ds_read_b64_tr_b16 v[230:231], v18 offset:50688
 v_mfma_f32_16x16x32_bf16 v[76:79], v[192:195], a[212:215], v[76:79]
 v_lshlrev_b32 v3, 16, v37
 v_lshlrev_b32 v4, 16, v55
 v_mfma_f32_16x16x32_bf16 v[80:83], v[196:199], a[80:83], v[80:83]
 v_mul_f32 v3, v3, v4
 v_mul_f32 v54, v12, v3
 v_mfma_f32_16x16x32_bf16 v[84:87], v[196:199], a[84:87], v[84:87]
 v_and_b32 v3, s37, v37
 v_and_b32 v4, s37, v55
 v_mfma_f32_16x16x32_bf16 v[88:91], v[196:199], a[208:211], v[88:91]
 v_mul_f32 v3, v3, v4
 v_mul_f32 v55, v12, v3
 v_mfma_f32_16x16x32_bf16 v[92:95], v[196:199], a[212:215], v[92:95]
 v_lshlrev_b32 v3, 16, v26
 v_lshlrev_b32 v4, 16, v56
 s_waitcnt vmcnt(16) lgkmcnt(0)
 s_barrier
 v_mfma_f32_16x16x32_bf16 v[64:67], v[224:227], a[88:91], v[64:67]
 ds_read_b64_tr_b16 v[192:193], v17 offset:55296
 ds_read_b64_tr_b16 v[194:195], v17 offset:59904
 v_mfma_f32_16x16x32_bf16 v[68:71], v[224:227], a[92:95], v[68:71]
 v_mul_f32 v3, v3, v4
 v_mul_f32 v24, v6, v3
 v_mfma_f32_16x16x32_bf16 v[72:75], v[224:227], a[216:219], v[72:75]
 ds_read_b64_tr_b16 v[196:197], v18 offset:55296
 ds_read_b64_tr_b16 v[198:199], v18 offset:59904
 v_mfma_f32_16x16x32_bf16 v[76:79], v[224:227], a[220:223], v[76:79]
 v_and_b32 v3, s37, v26
 v_and_b32 v4, s37, v56
 v_mfma_f32_16x16x32_bf16 v[80:83], v[228:231], a[88:91], v[80:83]
 v_mul_f32 v3, v3, v4
 v_mul_f32 v25, v6, v3
 v_mfma_f32_16x16x32_bf16 v[84:87], v[228:231], a[92:95], v[84:87]
 v_lshlrev_b32 v3, 16, v27
 v_lshlrev_b32 v4, 16, v57
 v_mfma_f32_16x16x32_bf16 v[88:91], v[228:231], a[216:219], v[88:91]
 v_mul_f32 v3, v3, v4
 v_mul_f32 v28, v6, v3
 v_mfma_f32_16x16x32_bf16 v[92:95], v[228:231], a[220:223], v[92:95]
 s_waitcnt lgkmcnt(0)
 v_and_b32 v3, s37, v27
 v_and_b32 v4, s37, v57
 v_mfma_f32_16x16x32_bf16 v[64:67], v[192:195], a[96:99], v[64:67]
 v_add_u32 v17, 64512, v17
 v_add_u32 v18, 64512, v18
 v_mfma_f32_16x16x32_bf16 v[68:71], v[192:195], a[100:103], v[68:71]
 v_add_u32 v19, 64512, v19
 v_add_u32 v20, 64512, v20
 v_mfma_f32_16x16x32_bf16 v[72:75], v[192:195], a[224:227], v[72:75]
 ds_read_b64_tr_b16 v[224:225], v17 offset:0
 ds_read_b64_tr_b16 v[226:227], v17 offset:4608
 v_mfma_f32_16x16x32_bf16 v[76:79], v[192:195], a[228:231], v[76:79]
 ds_read_b64_tr_b16 v[228:229], v18 offset:0
 ds_read_b64_tr_b16 v[230:231], v18 offset:4608
 v_mfma_f32_16x16x32_bf16 v[80:83], v[196:199], a[96:99], v[80:83]
 v_mul_f32 v3, v3, v4
 v_mul_f32 v29, v6, v3
 v_mfma_f32_16x16x32_bf16 v[84:87], v[196:199], a[100:103], v[84:87]
 v_lshlrev_b32 v3, 16, v30
 v_lshlrev_b32 v4, 16, v58
 v_mfma_f32_16x16x32_bf16 v[88:91], v[196:199], a[224:227], v[88:91]
 v_mul_f32 v3, v3, v4
 v_mul_f32 v32, v7, v3
 v_mfma_f32_16x16x32_bf16 v[92:95], v[196:199], a[228:231], v[92:95]
 v_and_b32 v3, s37, v30
 v_and_b32 v4, s37, v58
 s_waitcnt vmcnt(4) lgkmcnt(0)
 s_barrier
 v_mfma_f32_16x16x32_bf16 v[64:67], v[224:227], a[104:107], v[64:67]
 ds_read_b64_tr_b16 v[192:193], v17 offset:9216
 ds_read_b64_tr_b16 v[194:195], v17 offset:13824
 v_mfma_f32_16x16x32_bf16 v[68:71], v[224:227], a[108:111], v[68:71]
 v_mul_f32 v3, v3, v4
 v_mul_f32 v33, v7, v3
 v_mfma_f32_16x16x32_bf16 v[72:75], v[224:227], a[232:235], v[72:75]
 ds_read_b64_tr_b16 v[196:197], v18 offset:9216
 ds_read_b64_tr_b16 v[198:199], v18 offset:13824
 v_mfma_f32_16x16x32_bf16 v[76:79], v[224:227], a[236:239], v[76:79]
 v_lshlrev_b32 v3, 16, v31
 v_lshlrev_b32 v4, 16, v59
 v_mfma_f32_16x16x32_bf16 v[80:83], v[228:231], a[104:107], v[80:83]
 v_mul_f32 v3, v3, v4
 v_mul_f32 v36, v7, v3
 v_mfma_f32_16x16x32_bf16 v[84:87], v[228:231], a[108:111], v[84:87]
 v_and_b32 v3, s37, v31
 v_and_b32 v4, s37, v59
 v_mfma_f32_16x16x32_bf16 v[88:91], v[228:231], a[232:235], v[88:91]
 v_mul_f32 v3, v3, v4
 v_mul_f32 v37, v7, v3
 v_mfma_f32_16x16x32_bf16 v[92:95], v[228:231], a[236:239], v[92:95]
 s_waitcnt lgkmcnt(0)
 v_lshlrev_b32 v3, 16, v34
 v_lshlrev_b32 v4, 16, v60
 v_mfma_f32_16x16x32_bf16 v[64:67], v[192:195], a[112:115], v[64:67]
 ds_read_b64_tr_b16 v[224:225], v17 offset:18432
 ds_read_b64_tr_b16 v[226:227], v17 offset:23040
 v_mfma_f32_16x16x32_bf16 v[68:71], v[192:195], a[116:119], v[68:71]
 v_mul_f32 v3, v3, v4
 v_mul_f32 v56, v11, v3
 v_mfma_f32_16x16x32_bf16 v[72:75], v[192:195], a[240:243], v[72:75]
 ds_read_b64_tr_b16 v[228:229], v18 offset:18432
 ds_read_b64_tr_b16 v[230:231], v18 offset:23040
 v_mfma_f32_16x16x32_bf16 v[76:79], v[192:195], a[244:247], v[76:79]
 v_and_b32 v3, s37, v34
 v_and_b32 v4, s37, v60
 v_mfma_f32_16x16x32_bf16 v[80:83], v[196:199], a[112:115], v[80:83]
 v_mul_f32 v3, v3, v4
 v_mul_f32 v57, v11, v3
 v_mfma_f32_16x16x32_bf16 v[84:87], v[196:199], a[116:119], v[84:87]
 v_lshlrev_b32 v3, 16, v35
 v_lshlrev_b32 v4, 16, v61
 v_mfma_f32_16x16x32_bf16 v[88:91], v[196:199], a[240:243], v[88:91]
 v_mul_f32 v3, v3, v4
 v_mul_f32 v58, v11, v3
 v_mfma_f32_16x16x32_bf16 v[92:95], v[196:199], a[244:247], v[92:95]
 v_and_b32 v3, s37, v35
 v_and_b32 v4, s37, v61
 s_waitcnt vmcnt(0) lgkmcnt(0)
 s_barrier
 v_mfma_f32_16x16x32_bf16 v[64:67], v[224:227], a[120:123], v[64:67]
 v_mfma_f32_16x16x32_bf16 v[68:71], v[224:227], a[124:127], v[68:71]
 v_mul_f32 v3, v3, v4
 v_mul_f32 v59, v11, v3
 v_mfma_f32_16x16x32_bf16 v[72:75], v[224:227], a[248:251], v[72:75]
 v_mfma_f32_16x16x32_bf16 v[76:79], v[224:227], a[252:255], v[76:79]
 v_lshlrev_b32 v3, 16, v38
 v_lshlrev_b32 v4, 16, v62
 v_mfma_f32_16x16x32_bf16 v[80:83], v[228:231], a[120:123], v[80:83]
 v_mul_f32 v3, v3, v4
 v_mul_f32 v26, v12, v3
 v_mfma_f32_16x16x32_bf16 v[84:87], v[228:231], a[124:127], v[84:87]
 v_and_b32 v3, s37, v38
 v_and_b32 v4, s37, v62
 v_mfma_f32_16x16x32_bf16 v[88:91], v[228:231], a[248:251], v[88:91]
 v_mul_f32 v3, v3, v4
 v_mul_f32 v27, v12, v3
 v_mfma_f32_16x16x32_bf16 v[92:95], v[228:231], a[252:255], v[92:95]
 s_waitcnt lgkmcnt(0)
 v_lshlrev_b32 v3, 16, v39
 v_lshlrev_b32 v4, 16, v63
 v_mfma_f32_16x16x32_bf16 v[96:99], v[200:203], a[0:3], v[96:99]
 ds_read_b64_tr_b16 v[232:233], v19 offset:36864
 ds_read_b64_tr_b16 v[234:235], v19 offset:41472
 v_mfma_f32_16x16x32_bf16 v[100:103], v[200:203], a[4:7], v[100:103]
 v_mfma_f32_16x16x32_bf16 v[104:107], v[200:203], a[128:131], v[104:107]
 ds_read_b64_tr_b16 v[236:237], v20 offset:36864
 ds_read_b64_tr_b16 v[238:239], v20 offset:41472
 v_mfma_f32_16x16x32_bf16 v[108:111], v[200:203], a[132:135], v[108:111]
 v_mfma_f32_16x16x32_bf16 v[112:115], v[204:207], a[0:3], v[112:115]
 v_mfma_f32_16x16x32_bf16 v[116:119], v[204:207], a[4:7], v[116:119]
 v_cvt_pk_bf16_f32 v64, v64, v65
 v_cvt_pk_bf16_f32 v65, v66, v67
 v_mfma_f32_16x16x32_bf16 v[120:123], v[204:207], a[128:131], v[120:123]
 v_cvt_pk_bf16_f32 v66, v68, v69
 v_cvt_pk_bf16_f32 v67, v70, v71
 v_mfma_f32_16x16x32_bf16 v[124:127], v[204:207], a[132:135], v[124:127]
 s_waitcnt lgkmcnt(0)
 v_mfma_f32_16x16x32_bf16 v[96:99], v[232:235], a[8:11], v[96:99]
 ds_read_b64_tr_b16 v[200:201], v19 offset:46080
 ds_read_b64_tr_b16 v[202:203], v19 offset:50688
 v_mfma_f32_16x16x32_bf16 v[100:103], v[232:235], a[12:15], v[100:103]
 buffer_store_dwordx4 v[64:67], v16, s[16:19], s46 offen offset:0 sc1
 v_mfma_f32_16x16x32_bf16 v[104:107], v[232:235], a[136:139], v[104:107]
 ds_read_b64_tr_b16 v[204:205], v20 offset:46080
 ds_read_b64_tr_b16 v[206:207], v20 offset:50688
 v_mfma_f32_16x16x32_bf16 v[108:111], v[232:235], a[140:143], v[108:111]
 v_cvt_pk_bf16_f32 v68, v72, v73
 v_cvt_pk_bf16_f32 v69, v74, v75
 v_mfma_f32_16x16x32_bf16 v[112:115], v[236:239], a[8:11], v[112:115]
 v_cvt_pk_bf16_f32 v70, v76, v77
 v_cvt_pk_bf16_f32 v71, v78, v79
 v_mfma_f32_16x16x32_bf16 v[116:119], v[236:239], a[12:15], v[116:119]
 buffer_store_dwordx4 v[68:71], v16, s[16:19], s46 offen offset:1024 sc1
 v_mfma_f32_16x16x32_bf16 v[120:123], v[236:239], a[136:139], v[120:123]
 v_cvt_pk_bf16_f32 v72, v80, v81
 v_cvt_pk_bf16_f32 v73, v82, v83
 v_mfma_f32_16x16x32_bf16 v[124:127], v[236:239], a[140:143], v[124:127]
 s_waitcnt lgkmcnt(0)
 v_cvt_pk_bf16_f32 v74, v84, v85
 v_cvt_pk_bf16_f32 v75, v86, v87
 v_mfma_f32_16x16x32_bf16 v[96:99], v[200:203], a[16:19], v[96:99]
 ds_read_b64_tr_b16 v[232:233], v19 offset:55296
 ds_read_b64_tr_b16 v[234:235], v19 offset:59904
 v_mfma_f32_16x16x32_bf16 v[100:103], v[200:203], a[20:23], v[100:103]
 buffer_store_dwordx4 v[72:75], v16, s[16:19], s46 offen offset:2048 sc1
 v_mfma_f32_16x16x32_bf16 v[104:107], v[200:203], a[144:147], v[104:107]
 ds_read_b64_tr_b16 v[236:237], v20 offset:55296
 ds_read_b64_tr_b16 v[238:239], v20 offset:59904
 v_mfma_f32_16x16x32_bf16 v[108:111], v[200:203], a[148:151], v[108:111]
 v_cvt_pk_bf16_f32 v76, v88, v89
 v_cvt_pk_bf16_f32 v77, v90, v91
 v_mfma_f32_16x16x32_bf16 v[112:115], v[204:207], a[16:19], v[112:115]
 v_cvt_pk_bf16_f32 v78, v92, v93
 v_cvt_pk_bf16_f32 v79, v94, v95
 v_mfma_f32_16x16x32_bf16 v[116:119], v[204:207], a[20:23], v[116:119]
 buffer_store_dwordx4 v[76:79], v16, s[16:19], s46 offen offset:3072 sc1
 v_mfma_f32_16x16x32_bf16 v[120:123], v[204:207], a[144:147], v[120:123]
 s_add_u32 s46, s46, 4096
 v_mul_f32 v3, v3, v4
 v_mul_f32 v30, v12, v3
 v_mfma_f32_16x16x32_bf16 v[124:127], v[204:207], a[148:151], v[124:127]
 s_waitcnt lgkmcnt(0)
 v_and_b32 v3, s37, v39
 v_and_b32 v4, s37, v63
 v_mfma_f32_16x16x32_bf16 v[96:99], v[232:235], a[24:27], v[96:99]
 v_add_u32 v17, 64512, v17
 v_add_u32 v18, 64512, v18
 v_mfma_f32_16x16x32_bf16 v[100:103], v[232:235], a[28:31], v[100:103]
 v_add_u32 v19, 64512, v19
 v_add_u32 v20, 64512, v20
 v_mfma_f32_16x16x32_bf16 v[104:107], v[232:235], a[152:155], v[104:107]
 ds_read_b64_tr_b16 v[200:201], v19 offset:0
 ds_read_b64_tr_b16 v[202:203], v19 offset:4608
 v_mfma_f32_16x16x32_bf16 v[108:111], v[232:235], a[156:159], v[108:111]
 ds_read_b64_tr_b16 v[204:205], v20 offset:0
 ds_read_b64_tr_b16 v[206:207], v20 offset:4608
 v_mfma_f32_16x16x32_bf16 v[112:115], v[236:239], a[24:27], v[112:115]
 v_mul_f32 v3, v3, v4
 v_mul_f32 v31, v12, v3
 v_mfma_f32_16x16x32_bf16 v[116:119], v[236:239], a[28:31], v[116:119]
 v_sub_f32 v6, 1.0, v6
 v_sub_f32 v7, 1.0, v7
 v_mfma_f32_16x16x32_bf16 v[120:123], v[236:239], a[152:155], v[120:123]
 v_sub_f32 v11, 1.0, v11
 v_sub_f32 v12, 1.0, v12
 v_mfma_f32_16x16x32_bf16 v[124:127], v[236:239], a[156:159], v[124:127]
 s_waitcnt lgkmcnt(0)
 v_mfma_f32_16x16x32_bf16 v[96:99], v[200:203], a[32:35], v[96:99]
 ds_read_b64_tr_b16 v[232:233], v19 offset:9216
 ds_read_b64_tr_b16 v[234:235], v19 offset:13824
 v_mfma_f32_16x16x32_bf16 v[100:103], v[200:203], a[36:39], v[100:103]
 v_mfma_f32_16x16x32_bf16 v[104:107], v[200:203], a[160:163], v[104:107]
 ds_read_b64_tr_b16 v[236:237], v20 offset:9216
 ds_read_b64_tr_b16 v[238:239], v20 offset:13824
 v_mfma_f32_16x16x32_bf16 v[108:111], v[200:203], a[164:167], v[108:111]
 v_mfma_f32_16x16x32_bf16 v[112:115], v[204:207], a[32:35], v[112:115]
 v_mfma_f32_16x16x32_bf16 v[116:119], v[204:207], a[36:39], v[116:119]
 v_mfma_f32_16x16x32_bf16 v[120:123], v[204:207], a[160:163], v[120:123]
 v_mfma_f32_16x16x32_bf16 v[124:127], v[204:207], a[164:167], v[124:127]
 s_waitcnt lgkmcnt(0)
 v_mfma_f32_16x16x32_bf16 v[96:99], v[232:235], a[40:43], v[96:99]
 v_add_u32 v17, 4294838272, v17
 v_add_u32 v18, 4294838272, v18
 v_mfma_f32_16x16x32_bf16 v[100:103], v[232:235], a[44:47], v[100:103]
 v_add_u32 v19, 4294838272, v19
 v_add_u32 v20, 4294838272, v20
 v_mfma_f32_16x16x32_bf16 v[104:107], v[232:235], a[168:171], v[104:107]
 ds_read_b64_tr_b16 v[200:201], v19 offset:0
 ds_read_b64_tr_b16 v[202:203], v19 offset:4608
 v_mfma_f32_16x16x32_bf16 v[108:111], v[232:235], a[172:175], v[108:111]
 ds_read_b64_tr_b16 v[204:205], v20 offset:0
 ds_read_b64_tr_b16 v[206:207], v20 offset:4608
 v_mfma_f32_16x16x32_bf16 v[112:115], v[236:239], a[40:43], v[112:115]
 v_mfma_f32_16x16x32_bf16 v[116:119], v[236:239], a[44:47], v[116:119]
 v_mfma_f32_16x16x32_bf16 v[120:123], v[236:239], a[168:171], v[120:123]
 v_mfma_f32_16x16x32_bf16 v[124:127], v[236:239], a[172:175], v[124:127]
 s_waitcnt lgkmcnt(0)
 v_mfma_f32_16x16x32_bf16 v[96:99], v[200:203], a[48:51], v[96:99]
 ds_read_b64_tr_b16 v[232:233], v19 offset:9216
 ds_read_b64_tr_b16 v[234:235], v19 offset:13824
 v_mfma_f32_16x16x32_bf16 v[100:103], v[200:203], a[52:55], v[100:103]
 v_mfma_f32_16x16x32_bf16 v[104:107], v[200:203], a[176:179], v[104:107]
 ds_read_b64_tr_b16 v[236:237], v20 offset:9216
 ds_read_b64_tr_b16 v[238:239], v20 offset:13824
 v_mfma_f32_16x16x32_bf16 v[108:111], v[200:203], a[180:183], v[108:111]
 v_mfma_f32_16x16x32_bf16 v[112:115], v[204:207], a[48:51], v[112:115]
 v_mfma_f32_16x16x32_bf16 v[116:119], v[204:207], a[52:55], v[116:119]
 v_mfma_f32_16x16x32_bf16 v[120:123], v[204:207], a[176:179], v[120:123]
 v_mfma_f32_16x16x32_bf16 v[124:127], v[204:207], a[180:183], v[124:127]
 s_waitcnt lgkmcnt(0)
 v_mfma_f32_16x16x32_bf16 v[96:99], v[232:235], a[56:59], v[96:99]
 ds_read_b64_tr_b16 v[200:201], v19 offset:18432
 ds_read_b64_tr_b16 v[202:203], v19 offset:23040
 v_mfma_f32_16x16x32_bf16 v[100:103], v[232:235], a[60:63], v[100:103]
 v_mfma_f32_16x16x32_bf16 v[104:107], v[232:235], a[184:187], v[104:107]
 ds_read_b64_tr_b16 v[204:205], v20 offset:18432
 ds_read_b64_tr_b16 v[206:207], v20 offset:23040
 v_mfma_f32_16x16x32_bf16 v[108:111], v[232:235], a[188:191], v[108:111]
 v_mfma_f32_16x16x32_bf16 v[112:115], v[236:239], a[56:59], v[112:115]
 v_mfma_f32_16x16x32_bf16 v[116:119], v[236:239], a[60:63], v[116:119]
 v_mfma_f32_16x16x32_bf16 v[120:123], v[236:239], a[184:187], v[120:123]
 v_mfma_f32_16x16x32_bf16 v[124:127], v[236:239], a[188:191], v[124:127]
 s_waitcnt lgkmcnt(0)
 v_mfma_f32_16x16x32_bf16 v[96:99], v[200:203], a[64:67], v[96:99]
 ds_read_b64_tr_b16 v[232:233], v19 offset:27648
 ds_read_b64_tr_b16 v[234:235], v19 offset:32256
 v_mfma_f32_16x16x32_bf16 v[100:103], v[200:203], a[68:71], v[100:103]
 v_mfma_f32_16x16x32_bf16 v[104:107], v[200:203], a[192:195], v[104:107]
 ds_read_b64_tr_b16 v[236:237], v20 offset:27648
 ds_read_b64_tr_b16 v[238:239], v20 offset:32256
 v_mfma_f32_16x16x32_bf16 v[108:111], v[200:203], a[196:199], v[108:111]
 v_mfma_f32_16x16x32_bf16 v[112:115], v[204:207], a[64:67], v[112:115]
 v_mfma_f32_16x16x32_bf16 v[116:119], v[204:207], a[68:71], v[116:119]
 v_mfma_f32_16x16x32_bf16 v[120:123], v[204:207], a[192:195], v[120:123]
 v_mfma_f32_16x16x32_bf16 v[124:127], v[204:207], a[196:199], v[124:127]
 s_waitcnt lgkmcnt(0)
 v_mfma_f32_16x16x32_bf16 v[96:99], v[232:235], a[72:75], v[96:99]
 ds_read_b64_tr_b16 v[200:201], v19 offset:36864
 ds_read_b64_tr_b16 v[202:203], v19 offset:41472
 v_mfma_f32_16x16x32_bf16 v[100:103], v[232:235], a[76:79], v[100:103]
 v_mfma_f32_16x16x32_bf16 v[104:107], v[232:235], a[200:203], v[104:107]
 ds_read_b64_tr_b16 v[204:205], v20 offset:36864
 ds_read_b64_tr_b16 v[206:207], v20 offset:41472
 v_mfma_f32_16x16x32_bf16 v[108:111], v[232:235], a[204:207], v[108:111]
 v_mfma_f32_16x16x32_bf16 v[112:115], v[236:239], a[72:75], v[112:115]
 v_mfma_f32_16x16x32_bf16 v[116:119], v[236:239], a[76:79], v[116:119]
 v_mfma_f32_16x16x32_bf16 v[120:123], v[236:239], a[200:203], v[120:123]
 v_mfma_f32_16x16x32_bf16 v[124:127], v[236:239], a[204:207], v[124:127]
 s_waitcnt lgkmcnt(0)
 v_mfma_f32_16x16x32_bf16 v[96:99], v[200:203], a[80:83], v[96:99]
 ds_read_b64_tr_b16 v[232:233], v19 offset:46080
 ds_read_b64_tr_b16 v[234:235], v19 offset:50688
 v_mfma_f32_16x16x32_bf16 v[100:103], v[200:203], a[84:87], v[100:103]
 v_mfma_f32_16x16x32_bf16 v[104:107], v[200:203], a[208:211], v[104:107]
 ds_read_b64_tr_b16 v[236:237], v20 offset:46080
 ds_read_b64_tr_b16 v[238:239], v20 offset:50688
 v_mfma_f32_16x16x32_bf16 v[108:111], v[200:203], a[212:215], v[108:111]
 v_mfma_f32_16x16x32_bf16 v[112:115], v[204:207], a[80:83], v[112:115]
 v_mfma_f32_16x16x32_bf16 v[116:119], v[204:207], a[84:87], v[116:119]
 v_mfma_f32_16x16x32_bf16 v[120:123], v[204:207], a[208:211], v[120:123]
 v_mfma_f32_16x16x32_bf16 v[124:127], v[204:207], a[212:215], v[124:127]
 s_waitcnt lgkmcnt(0)
 v_mfma_f32_16x16x32_bf16 v[96:99], v[232:235], a[88:91], v[96:99]
 ds_read_b64_tr_b16 v[200:201], v19 offset:55296
 ds_read_b64_tr_b16 v[202:203], v19 offset:59904
 v_mfma_f32_16x16x32_bf16 v[100:103], v[232:235], a[92:95], v[100:103]
 v_mfma_f32_16x16x32_bf16 v[104:107], v[232:235], a[216:219], v[104:107]
 ds_read_b64_tr_b16 v[204:205], v20 offset:55296
 ds_read_b64_tr_b16 v[206:207], v20 offset:59904
 v_mfma_f32_16x16x32_bf16 v[108:111], v[232:235], a[220:223], v[108:111]
 v_mfma_f32_16x16x32_bf16 v[112:115], v[236:239], a[88:91], v[112:115]
 v_mfma_f32_16x16x32_bf16 v[116:119], v[236:239], a[92:95], v[116:119]
 v_mfma_f32_16x16x32_bf16 v[120:123], v[236:239], a[216:219], v[120:123]
 v_mfma_f32_16x16x32_bf16 v[124:127], v[236:239], a[220:223], v[124:127]
 s_waitcnt lgkmcnt(0)
 v_mfma_f32_16x16x32_bf16 v[96:99], v[200:203], a[96:99], v[96:99]
 v_add_u32 v17, 64512, v17
 v_add_u32 v18, 64512, v18
 v_mfma_f32_16x16x32_bf16 v[100:103], v[200:203], a[100:103], v[100:103]
 v_add_u32 v19, 64512, v19
 v_add_u32 v20, 64512, v20
 v_mfma_f32_16x16x32_bf16 v[104:107], v[200:203], a[224:227], v[104:107]
 ds_read_b64_tr_b16 v[232:233], v19 offset:0
 ds_read_b64_tr_b16 v[234:235], v19 offset:4608
 v_mfma_f32_16x16x32_bf16 v[108:111], v[200:203], a[228:231], v[108:111]
 ds_read_b64_tr_b16 v[236:237], v20 offset:0
 ds_read_b64_tr_b16 v[238:239], v20 offset:4608
 v_mfma_f32_16x16x32_bf16 v[112:115], v[204:207], a[96:99], v[112:115]
 v_mfma_f32_16x16x32_bf16 v[116:119], v[204:207], a[100:103], v[116:119]
 v_mfma_f32_16x16x32_bf16 v[120:123], v[204:207], a[224:227], v[120:123]
 v_mfma_f32_16x16x32_bf16 v[124:127], v[204:207], a[228:231], v[124:127]
L_pad16:
 s_cbranch_execz L_back
 s_waitcnt lgkmcnt(0)
 v_mfma_f32_16x16x32_bf16 v[96:99], v[232:235], a[104:107], v[96:99]
 ds_read_b64_tr_b16 v[200:201], v19 offset:9216
 ds_read_b64_tr_b16 v[202:203], v19 offset:13824
 v_mfma_f32_16x16x32_bf16 v[100:103], v[232:235], a[108:111], v[100:103]
 v_mfma_f32_16x16x32_bf16 v[104:107], v[232:235], a[232:235], v[104:107]
 ds_read_b64_tr_b16 v[204:205], v20 offset:9216
 ds_read_b64_tr_b16 v[206:207], v20 offset:13824
 v_mfma_f32_16x16x32_bf16 v[108:111], v[232:235], a[236:239], v[108:111]
 v_mfma_f32_16x16x32_bf16 v[112:115], v[236:239], a[104:107], v[112:115]
 v_mfma_f32_16x16x32_bf16 v[116:119], v[236:239], a[108:111], v[116:119]
 v_mfma_f32_16x16x32_bf16 v[120:123], v[236:239], a[232:235], v[120:123]
 v_mfma_f32_16x16x32_bf16 v[124:127], v[236:239], a[236:239], v[124:127]
 s_waitcnt lgkmcnt(0)
 v_mfma_f32_16x16x32_bf16 v[96:99], v[200:203], a[112:115], v[96:99]
 ds_read_b64_tr_b16 v[232:233], v19 offset:18432
 ds_read_b64_tr_b16 v[234:235], v19 offset:23040
 v_mfma_f32_16x16x32_bf16 v[100:103], v[200:203], a[116:119], v[100:103]
 v_mfma_f32_16x16x32_bf16 v[104:107], v[200:203], a[240:243], v[104:107]
 ds_read_b64_tr_b16 v[236:237], v20 offset:18432
 ds_read_b64_tr_b16 v[238:239], v20 offset:23040
 v_mfma_f32_16x16x32_bf16 v[108:111], v[200:203], a[244:247], v[108:111]
 v_mfma_f32_16x16x32_bf16 v[112:115], v[204:207], a[112:115], v[112:115]
 v_mfma_f32_16x16x32_bf16 v[116:119], v[204:207], a[116:119], v[116:119]
 v_mfma_f32_16x16x32_bf16 v[120:123], v[204:207], a[240:243], v[120:123]
 v_mfma_f32_16x16x32_bf16 v[124:127], v[204:207], a[244:247], v[124:127]
 s_waitcnt lgkmcnt(0)
 v_mfma_f32_16x16x32_bf16 v[96:99], v[232:235], a[120:123], v[96:99]
 v_mfma_f32_16x16x32_bf16 v[100:103], v[232:235], a[124:127], v[100:103]
 s_lshl_b32 s52, s44, 2
 s_xor_b32 s52, s52, 196608
 v_mfma_f32_16x16x32_bf16 v[104:107], v[232:235], a[248:251], v[104:107]
 v_mfma_f32_16x16x32_bf16 v[108:111], v[232:235], a[252:255], v[108:111]
 s_add_u32 s52, s52, 0
 buffer_load_dwordx4 v[80:83], v16, s[16:19], s52 offen offset:0 sc1
 v_mfma_f32_16x16x32_bf16 v[112:115], v[236:239], a[120:123], v[112:115]
 buffer_load_dwordx4 v[84:87], v16, s[16:19], s52 offen offset:1024 sc1
 v_mfma_f32_16x16x32_bf16 v[116:119], v[236:239], a[124:127], v[116:119]
 buffer_load_dwordx4 v[88:91], v16, s[16:19], s52 offen offset:2048 sc1
 v_mfma_f32_16x16x32_bf16 v[120:123], v[236:239], a[248:251], v[120:123]
 buffer_load_dwordx4 v[92:95], v16, s[16:19], s52 offen offset:3072 sc1
 v_mfma_f32_16x16x32_bf16 v[124:127], v[236:239], a[252:255], v[124:127]
 s_waitcnt lgkmcnt(0)
 v_mfma_f32_16x16x32_bf16 v[128:131], v[208:211], a[0:3], v[128:131]
 ds_read_b64_tr_b16 v[240:241], v17 offset:36992
 ds_read_b64_tr_b16 v[242:243], v17 offset:41600
 v_mfma_f32_16x16x32_bf16 v[132:135], v[208:211], a[4:7], v[132:135]
 v_mfma_f32_16x16x32_bf16 v[136:139], v[208:211], a[128:131], v[136:139]
 ds_read_b64_tr_b16 v[244:245], v18 offset:36992
 ds_read_b64_tr_b16 v[246:247], v18 offset:41600
 v_mfma_f32_16x16x32_bf16 v[140:143], v[208:211], a[132:135], v[140:143]
 v_mfma_f32_16x16x32_bf16 v[144:147], v[212:215], a[0:3], v[144:147]
 v_mfma_f32_16x16x32_bf16 v[148:151], v[212:215], a[4:7], v[148:151]
 v_cvt_pk_bf16_f32 v96, v96, v97
 v_cvt_pk_bf16_f32 v97, v98, v99
 v_mfma_f32_16x16x32_bf16 v[152:155], v[212:215], a[128:131], v[152:155]
 v_cvt_pk_bf16_f32 v98, v100, v101
 v_cvt_pk_bf16_f32 v99, v102, v103
 v_mfma_f32_16x16x32_bf16 v[156:159], v[212:215], a[132:135], v[156:159]
 s_waitcnt lgkmcnt(0)
 v_mfma_f32_16x16x32_bf16 v[128:131], v[240:243], a[8:11], v[128:131]
 ds_read_b64_tr_b16 v[208:209], v17 offset:46208
 ds_read_b64_tr_b16 v[210:211], v17 offset:50816
 v_mfma_f32_16x16x32_bf16 v[132:135], v[240:243], a[12:15], v[132:135]
 buffer_store_dwordx4 v[96:99], v16, s[16:19], s46 offen offset:0 sc1
 v_mfma_f32_16x16x32_bf16 v[136:139], v[240:243], a[136:139], v[136:139]
 ds_read_b64_tr_b16 v[212:213], v18 offset:46208
 ds_read_b64_tr_b16 v[214:215], v18 offset:50816
 v_mfma_f32_16x16x32_bf16 v[140:143], v[240:243], a[140:143], v[140:143]
 v_cvt_pk_bf16_f32 v100, v104, v105
 v_cvt_pk_bf16_f32 v101, v106, v107
 v_mfma_f32_16x16x32_bf16 v[144:147], v[244:247], a[8:11], v[144:147]
 v_cvt_pk_bf16_f32 v102, v108, v109
 v_cvt_pk_bf16_f32 v103, v110, v111
 v_mfma_f32_16x16x32_bf16 v[148:151], v[244:247], a[12:15], v[148:151]
 buffer_store_dwordx4 v[100:103], v16, s[16:19], s46 offen offset:1024 sc1
 v_mfma_f32_16x16x32_bf16 v[152:155], v[244:247], a[136:139], v[152:155]
 v_cvt_pk_bf16_f32 v104, v112, v113
 v_cvt_pk_bf16_f32 v105, v114, v115
 v_mfma_f32_16x16x32_bf16 v[156:159], v[244:247], a[140:143], v[156:159]
 s_waitcnt lgkmcnt(0)
 v_cvt_pk_bf16_f32 v106, v116, v117
 v_cvt_pk_bf16_f32 v107, v118, v119
 v_mfma_f32_16x16x32_bf16 v[128:131], v[208:211], a[16:19], v[128:131]
 ds_read_b64_tr_b16 v[240:241], v17 offset:55424
 ds_read_b64_tr_b16 v[242:243], v17 offset:60032
 v_mfma_f32_16x16x32_bf16 v[132:135], v[208:211], a[20:23], v[132:135]
 buffer_store_dwordx4 v[104:107], v16, s[16:19], s46 offen offset:2048 sc1
 v_mfma_f32_16x16x32_bf16 v[136:139], v[208:211], a[144:147], v[136:139]
 ds_read_b64_tr_b16 v[244:245], v18 offset:55424
 ds_read_b64_tr_b16 v[246:247], v18 offset:60032
 v_mfma_f32_16x16x32_bf16 v[140:143], v[208:211], a[148:151], v[140:143]
 v_cvt_pk_bf16_f32 v108, v120, v121
 v_cvt_pk_bf16_f32 v109, v122, v123
 v_mfma_f32_16x16x32_bf16 v[144:147], v[212:215], a[16:19], v[144:147]
 v_cvt_pk_bf16_f32 v110, v124, v125
 v_cvt_pk_bf16_f32 v111, v126, v127
 v_mfma_f32_16x16x32_bf16 v[148:151], v[212:215], a[20:23], v[148:151]
 buffer_store_dwordx4 v[108:111], v16, s[16:19], s46 offen offset:3072 sc1
 v_mfma_f32_16x16x32_bf16 v[152:155], v[212:215], a[144:147], v[152:155]
 s_add_u32 s46, s46, 4096
 v_mfma_f32_16x16x32_bf16 v[156:159], v[212:215], a[148:151], v[156:159]
 s_waitcnt lgkmcnt(0)
 v_mfma_f32_16x16x32_bf16 v[128:131], v[240:243], a[24:27], v[128:131]
 v_add_u32 v17, 64512, v17
 v_add_u32 v18, 64512, v18
 v_mfma_f32_16x16x32_bf16 v[132:135], v[240:243], a[28:31], v[132:135]
 v_add_u32 v19, 64512, v19
 v_add_u32 v20, 64512, v20
 v_mfma_f32_16x16x32_bf16 v[136:139], v[240:243], a[152:155], v[136:139]
 ds_read_b64_tr_b16 v[208:209], v17 offset:128
 ds_read_b64_tr_b16 v[210:211], v17 offset:4736
 v_mfma_f32_16x16x32_bf16 v[140:143], v[240:243], a[156:159], v[140:143]
 ds_read_b64_tr_b16 v[212:213], v18 offset:128
 ds_read_b64_tr_b16 v[214:215], v18 offset:4736
 v_mfma_f32_16x16x32_bf16 v[144:147], v[244:247], a[24:27], v[144:147]
 v_mfma_f32_16x16x32_bf16 v[148:151], v[244:247], a[28:31], v[148:151]
 v_mfma_f32_16x16x32_bf16 v[152:155], v[244:247], a[152:155], v[152:155]
 v_mfma_f32_16x16x32_bf16 v[156:159], v[244:247], a[156:159], v[156:159]
 s_waitcnt lgkmcnt(0)
 v_mfma_f32_16x16x32_bf16 v[128:131], v[208:211], a[32:35], v[128:131]
 ds_read_b64_tr_b16 v[240:241], v17 offset:9344
 ds_read_b64_tr_b16 v[242:243], v17 offset:13952
 v_mfma_f32_16x16x32_bf16 v[132:135], v[208:211], a[36:39], v[132:135]
 v_mfma_f32_16x16x32_bf16 v[136:139], v[208:211], a[160:163], v[136:139]
 ds_read_b64_tr_b16 v[244:245], v18 offset:9344
 ds_read_b64_tr_b16 v[246:247], v18 offset:13952
 v_mfma_f32_16x16x32_bf16 v[140:143], v[208:211], a[164:167], v[140:143]
 v_mfma_f32_16x16x32_bf16 v[144:147], v[212:215], a[32:35], v[144:147]
 v_mfma_f32_16x16x32_bf16 v[148:151], v[212:215], a[36:39], v[148:151]
 v_mfma_f32_16x16x32_bf16 v[152:155], v[212:215], a[160:163], v[152:155]
 v_mfma_f32_16x16x32_bf16 v[156:159], v[212:215], a[164:167], v[156:159]
 s_waitcnt lgkmcnt(0)
 v_mfma_f32_16x16x32_bf16 v[128:131], v[240:243], a[40:43], v[128:131]
 v_add_u32 v17, 4294838272, v17
 v_add_u32 v18, 4294838272, v18
 v_mfma_f32_16x16x32_bf16 v[132:135], v[240:243], a[44:47], v[132:135]
 v_add_u32 v19, 4294838272, v19
 v_add_u32 v20, 4294838272, v20
 v_mfma_f32_16x16x32_bf16 v[136:139], v[240:243], a[168:171], v[136:139]
 ds_read_b64_tr_b16 v[208:209], v17 offset:128
 ds_read_b64_tr_b16 v[210:211], v17 offset:4736
 v_mfma_f32_16x16x32_bf16 v[140:143], v[240:243], a[172:175], v[140:143]
 ds_read_b64_tr_b16 v[212:213], v18 offset:128
 ds_read_b64_tr_b16 v[214:215], v18 offset:4736
 v_mfma_f32_16x16x32_bf16 v[144:147], v[244:247], a[40:43], v[144:147]
 s_waitcnt vmcnt(4)
 v_max3_u32 v15, v80, v81, v82
 v_max3_u32 v15, v15, v83, v84
 v_mfma_f32_16x16x32_bf16 v[148:151], v[244:247], a[44:47], v[148:151]
 v_max3_u32 v15, v15, v85, v86
 v_max3_u32 v15, v15, v87, v88
 v_mfma_f32_16x16x32_bf16 v[152:155], v[244:247], a[168:171], v[152:155]
 v_max3_u32 v15, v15, v89, v90
 v_max3_u32 v15, v15, v91, v92
 v_mfma_f32_16x16x32_bf16 v[156:159], v[244:247], a[172:175], v[156:159]
 s_waitcnt lgkmcnt(0)
 v_max3_u32 v15, v15, v93, v94
 v_max_u32 v15, v15, v95
 v_mfma_f32_16x16x32_bf16 v[128:131], v[208:211], a[48:51], v[128:131]
 ds_read_b64_tr_b16 v[240:241], v17 offset:9344
 ds_read_b64_tr_b16 v[242:243], v17 offset:13952
 v_mfma_f32_16x16x32_bf16 v[132:135], v[208:211], a[52:55], v[132:135]
 v_cmp_eq_u32 vcc, -1, v15
 v_mfma_f32_16x16x32_bf16 v[136:139], v[208:211], a[176:179], v[136:139]
 ds_read_b64_tr_b16 v[244:245], v18 offset:9344
 ds_read_b64_tr_b16 v[246:247], v18 offset:13952
 v_mfma_f32_16x16x32_bf16 v[140:143], v[208:211], a[180:183], v[140:143]
 v_mfma_f32_16x16x32_bf16 v[144:147], v[212:215], a[48:51], v[144:147]
 s_cbranch_vccnz L_spin_x3
L_spin_x3_ret:
 v_lshlrev_b32 v3, 16, v80
 v_fmac_f32 v40, v6, v3
 v_mfma_f32_16x16x32_bf16 v[148:151], v[212:215], a[52:55], v[148:151]
 v_and_b32 v4, s37, v80
 v_fmac_f32 v41, v6, v4
 v_mfma_f32_16x16x32_bf16 v[152:155], v[212:215], a[176:179], v[152:155]
 v_lshlrev_b32 v3, 16, v81
 v_fmac_f32 v42, v6, v3
 v_mfma_f32_16x16x32_bf16 v[156:159], v[212:215], a[180:183], v[156:159]
 s_waitcnt lgkmcnt(0)
 v_and_b32 v4, s37, v81
 v_fmac_f32 v43, v6, v4
 v_mfma_f32_16x16x32_bf16 v[128:131], v[240:243], a[56:59], v[128:131]
 ds_read_b64_tr_b16 v[208:209], v17 offset:18560
 ds_read_b64_tr_b16 v[210:211], v17 offset:23168
 v_mfma_f32_16x16x32_bf16 v[132:135], v[240:243], a[60:63], v[132:135]
 v_lshlrev_b32 v3, 16, v82
 v_fmac_f32 v44, v7, v3
 v_mfma_f32_16x16x32_bf16 v[136:139], v[240:243], a[184:187], v[136:139]
 ds_read_b64_tr_b16 v[212:213], v18 offset:18560
 ds_read_b64_tr_b16 v[214:215], v18 offset:23168
 v_mfma_f32_16x16x32_bf16 v[140:143], v[240:243], a[188:191], v[140:143]
 v_and_b32 v4, s37, v82
 v_fmac_f32 v45, v7, v4
 v_mfma_f32_16x16x32_bf16 v[144:147], v[244:247], a[56:59], v[144:147]
 v_lshlrev_b32 v3, 16, v83
 v_fmac_f32 v46, v7, v3
 v_mfma_f32_16x16x32_bf16 v[148:151], v[244:247], a[60:63], v[148:151]
 v_and_b32 v4, s37, v83
 v_fmac_f32 v47, v7, v4
 v_mfma_f32_16x16x32_bf16 v[152:155], v[244:247], a[184:187], v[152:155]
 v_lshlrev_b32 v3, 16, v84
 v_fmac_f32 v48, v11, v3
 v_mfma_f32_16x16x32_bf16 v[156:159], v[244:247], a[188:191], v[156:159]
 s_waitcnt lgkmcnt(0)
 v_and_b32 v4, s37, v84
 v_fmac_f32 v49, v11, v4
 v_mfma_f32_16x16x32_bf16 v[128:131], v[208:211], a[64:67], v[128:131]
 ds_read_b64_tr_b16 v[240:241], v17 offset:27776
 ds_read_b64_tr_b16 v[242:243], v17 offset:32384
 v_mfma_f32_16x16x32_bf16 v[132:135], v[208:211], a[68:71], v[132:135]
 v_lshlrev_b32 v3, 16, v85
 v_fmac_f32 v50, v11, v3
 v_mfma_f32_16x16x32_bf16 v[136:139], v[208:211], a[192:195], v[136:139]
 ds_read_b64_tr_b16 v[244:245], v18 offset:27776
 ds_read_b64_tr_b16 v[246:247], v18 offset:32384
 v_mfma_f32_16x16x32_bf16 v[140:143], v[208:211], a[196:199], v[140:143]
 v_and_b32 v4, s37, v85
 v_fmac_f32 v51, v11, v4
 v_mfma_f32_16x16x32_bf16 v[144:147], v[212:215], a[64:67], v[144:147]
 v_lshlrev_b32 v3, 16, v86
 v_fmac_f32 v52, v12, v3
 v_mfma_f32_16x16x32_bf16 v[148:151], v[212:215], a[68:71], v[148:151]
 v_and_b32 v4, s37, v86
 v_fmac_f32 v53, v12, v4
 v_mfma_f32_16x16x32_bf16 v[152:155], v[212:215], a[192:195], v[152:155]
 v_lshlrev_b32 v3, 16, v87
 v_fmac_f32 v54, v12, v3
 v_mfma_f32_16x16x32_bf16 v[156:159], v[212:215], a[196:199], v[156:159]
 s_waitcnt lgkmcnt(0)
 v_and_b32 v4, s37, v87
 v_fmac_f32 v55, v12, v4
 v_mfma_f32_16x16x32_bf16 v[128:131], v[240:243], a[72:75], v[128:131]
 ds_read_b64_tr_b16 v[208:209], v17 offset:36992
 ds_read_b64_tr_b16 v[210:211], v17 offset:41600
 v_mfma_f32_16x16x32_bf16 v[132:135], v[240:243], a[76:79], v[132:135]
 v_lshlrev_b32 v3, 16, v88
 v_fmac_f32 v24, v6, v3
 v_mfma_f32_16x16x32_bf16 v[136:139], v[240:243], a[200:203], v[136:139]
 ds_read_b64_tr_b16 v[212:213], v18 offset:36992
 ds_read_b64_tr_b16 v[214:215], v18 offset:41600
 v_mfma_f32_16x16x32_bf16 v[140:143], v[240:243], a[204:207], v[140:143]
 v_and_b32 v4, s37, v88
 v_fmac_f32 v25, v6, v4
 v_mfma_f32_16x16x32_bf16 v[144:147], v[244:247], a[72:75], v[144:147]
 v_lshlrev_b32 v3, 16, v89
 v_fmac_f32 v28, v6, v3
 v_mfma_f32_16x16x32_bf16 v[148:151], v[244:247], a[76:79], v[148:151]
 v_and_b32 v4, s37, v89
 v_fmac_f32 v29, v6, v4
 v_mfma_f32_16x16x32_bf16 v[152:155], v[244:247], a[200:203], v[152:155]
 v_lshlrev_b32 v3, 16, v90
 v_fmac_f32 v32, v7, v3
 v_mfma_f32_16x16x32_bf16 v[156:159], v[244:247], a[204:207], v[156:159]
 s_waitcnt lgkmcnt(0)
 v_and_b32 v4, s37, v90
 v_fmac_f32 v33, v7, v4
 v_mfma_f32_16x16x32_bf16 v[128:131], v[208:211], a[80:83], v[128:131]
 ds_read_b64_tr_b16 v[240:241], v17 offset:46208
 ds_read_b64_tr_b16 v[242:243], v17 offset:50816
 v_mfma_f32_16x16x32_bf16 v[132:135], v[208:211], a[84:87], v[132:135]
 v_lshlrev_b32 v3, 16, v91
 v_fmac_f32 v36, v7, v3
 v_mfma_f32_16x16x32_bf16 v[136:139], v[208:211], a[208:211], v[136:139]
 ds_read_b64_tr_b16 v[244:245], v18 offset:46208
 ds_read_b64_tr_b16 v[246:247], v18 offset:50816
 v_mfma_f32_16x16x32_bf16 v[140:143], v[208:211], a[212:215], v[140:143]
 v_and_b32 v4, s37, v91
 v_fmac_f32 v37, v7, v4
 v_mfma_f32_16x16x32_bf16 v[144:147], v[212:215], a[80:83], v[144:147]
 v_lshlrev_b32 v3, 16, v92
 v_fmac_f32 v56, v11, v3
 v_mfma_f32_16x16x32_bf16 v[148:151], v[212:215], a[84:87], v[148:151]
 v_and_b32 v4, s37, v92
 v_fmac_f32 v57, v11, v4
 v_mfma_f32_16x16x32_bf16 v[152:155], v[212:215], a[208:211], v[152:155]
 v_lshlrev_b32 v3, 16, v93
 v_fmac_f32 v58, v11, v3
 v_mfma_f32_16x16x32_bf16 v[156:159], v[212:215], a[212:215], v[156:159]
 s_waitcnt lgkmcnt(0)
 v_and_b32 v4, s37, v93
 v_fmac_f32 v59, v11, v4
 v_mfma_f32_16x16x32_bf16 v[128:131], v[240:243], a[88:91], v[128:131]
 ds_read_b64_tr_b16 v[208:209], v17 offset:55424
 ds_read_b64_tr_b16 v[210:211], v17 offset:60032
 v_mfma_f32_16x16x32_bf16 v[132:135], v[240:243], a[92:95], v[132:135]
 v_lshlrev_b32 v3, 16, v94
 v_fmac_f32 v26, v12, v3
 v_mfma_f32_16x16x32_bf16 v[136:139], v[240:243], a[216:219], v[136:139]
 ds_read_b64_tr_b16 v[212:213], v18 offset:55424
 ds_read_b64_tr_b16 v[214:215], v18 offset:60032
 v_mfma_f32_16x16x32_bf16 v[140:143], v[240:243], a[220:223], v[140:143]
 v_and_b32 v4, s37, v94
 v_fmac_f32 v27, v12, v4
 v_mfma_f32_16x16x32_bf16 v[144:147], v[244:247], a[88:91], v[144:147]
 v_lshlrev_b32 v3, 16, v95
 v_fmac_f32 v30, v12, v3
 v_mfma_f32_16x16x32_bf16 v[148:151], v[244:247], a[92:95], v[148:151]
 v_and_b32 v4, s37, v95
 v_fmac_f32 v31, v12, v4
 v_mfma_f32_16x16x32_bf16 v[152:155], v[244:247], a[216:219], v[152:155]
 v_mfma_f32_16x16x32_bf16 v[156:159], v[244:247], a[220:223], v[156:159]
 s_waitcnt lgkmcnt(0)
 v_mfma_f32_16x16x32_bf16 v[128:131], v[208:211], a[96:99], v[128:131]
 v_add_u32 v17, 64512, v17
 v_add_u32 v18, 64512, v18
 v_mfma_f32_16x16x32_bf16 v[132:135], v[208:211], a[100:103], v[132:135]
 v_add_u32 v19, 64512, v19
 v_add_u32 v20, 64512, v20
 v_mfma_f32_16x16x32_bf16 v[136:139], v[208:211], a[224:227], v[136:139]
 ds_read_b64_tr_b16 v[240:241], v17 offset:128
 ds_read_b64_tr_b16 v[242:243], v17 offset:4736
 v_mfma_f32_16x16x32_bf16 v[140:143], v[208:211], a[228:231], v[140:143]
 ds_read_b64_tr_b16 v[244:245], v18 offset:128
 ds_read_b64_tr_b16 v[246:247], v18 offset:4736
 v_mfma_f32_16x16x32_bf16 v[144:147], v[212:215], a[96:99], v[144:147]
 v_mfma_f32_16x16x32_bf16 v[148:151], v[212:215], a[100:103], v[148:151]
 v_mfma_f32_16x16x32_bf16 v[152:155], v[212:215], a[224:227], v[152:155]
 v_mfma_f32_16x16x32_bf16 v[156:159], v[212:215], a[228:231], v[156:159]
 s_waitcnt lgkmcnt(0)
 v_mfma_f32_16x16x32_bf16 v[128:131], v[240:243], a[104:107], v[128:131]
 ds_read_b64_tr_b16 v[208:209], v17 offset:9344
 ds_read_b64_tr_b16 v[210:211], v17 offset:13952
 v_mfma_f32_16x16x32_bf16 v[132:135], v[240:243], a[108:111], v[132:135]
 v_mfma_f32_16x16x32_bf16 v[136:139], v[240:243], a[232:235], v[136:139]
 ds_read_b64_tr_b16 v[212:213], v18 offset:9344
 ds_read_b64_tr_b16 v[214:215], v18 offset:13952
 v_mfma_f32_16x16x32_bf16 v[140:143], v[240:243], a[236:239], v[140:143]
 v_mfma_f32_16x16x32_bf16 v[144:147], v[244:247], a[104:107], v[144:147]
 v_mfma_f32_16x16x32_bf16 v[148:151], v[244:247], a[108:111], v[148:151]
 v_mfma_f32_16x16x32_bf16 v[152:155], v[244:247], a[232:235], v[152:155]
 v_mfma_f32_16x16x32_bf16 v[156:159], v[244:247], a[236:239], v[156:159]
 s_waitcnt lgkmcnt(0)
 v_mfma_f32_16x16x32_bf16 v[128:131], v[208:211], a[112:115], v[128:131]
 ds_read_b64_tr_b16 v[240:241], v17 offset:18560
 ds_read_b64_tr_b16 v[242:243], v17 offset:23168
 v_mfma_f32_16x16x32_bf16 v[132:135], v[208:211], a[116:119], v[132:135]
 v_mfma_f32_16x16x32_bf16 v[136:139], v[208:211], a[240:243], v[136:139]
 ds_read_b64_tr_b16 v[244:245], v18 offset:18560
 ds_read_b64_tr_b16 v[246:247], v18 offset:23168
 v_mfma_f32_16x16x32_bf16 v[140:143], v[208:211], a[244:247], v[140:143]
 v_mfma_f32_16x16x32_bf16 v[144:147], v[212:215], a[112:115], v[144:147]
 v_mfma_f32_16x16x32_bf16 v[148:151], v[212:215], a[116:119], v[148:151]
 v_mfma_f32_16x16x32_bf16 v[152:155], v[212:215], a[240:243], v[152:155]
 v_mfma_f32_16x16x32_bf16 v[156:159], v[212:215], a[244:247], v[156:159]
 s_waitcnt lgkmcnt(0)
 v_mfma_f32_16x16x32_bf16 v[128:131], v[240:243], a[120:123], v[128:131]
 v_mfma_f32_16x16x32_bf16 v[132:135], v[240:243], a[124:127], v[132:135]
 s_lshl_b32 s42, s44, 2
 s_xor_b32 s42, s42, 131072
 v_mfma_f32_16x16x32_bf16 v[136:139], v[240:243], a[248:251], v[136:139]
 v_mfma_f32_16x16x32_bf16 v[140:143], v[240:243], a[252:255], v[140:143]
 s_add_u32 s42, s42, 4096
 buffer_load_dwordx4 v[64:67], v16, s[16:19], s42 offen offset:0 sc1
 v_mfma_f32_16x16x32_bf16 v[144:147], v[244:247], a[120:123], v[144:147]
 buffer_load_dwordx4 v[68:71], v16, s[16:19], s42 offen offset:1024 sc1
 v_mfma_f32_16x16x32_bf16 v[148:151], v[244:247], a[124:127], v[148:151]
 buffer_load_dwordx4 v[72:75], v16, s[16:19], s42 offen offset:2048 sc1
 v_mfma_f32_16x16x32_bf16 v[152:155], v[244:247], a[248:251], v[152:155]
 buffer_load_dwordx4 v[76:79], v16, s[16:19], s42 offen offset:3072 sc1
 v_mfma_f32_16x16x32_bf16 v[156:159], v[244:247], a[252:255], v[156:159]
 s_waitcnt lgkmcnt(0)
 v_mfma_f32_16x16x32_bf16 v[160:163], v[216:219], a[0:3], v[160:163]
 ds_read_b64_tr_b16 v[248:249], v19 offset:36992
 ds_read_b64_tr_b16 v[250:251], v19 offset:41600
 v_mfma_f32_16x16x32_bf16 v[164:167], v[216:219], a[4:7], v[164:167]
 v_mfma_f32_16x16x32_bf16 v[168:171], v[216:219], a[128:131], v[168:171]
 ds_read_b64_tr_b16 v[252:253], v20 offset:36992
 ds_read_b64_tr_b16 v[254:255], v20 offset:41600
 v_mfma_f32_16x16x32_bf16 v[172:175], v[216:219], a[132:135], v[172:175]
 v_mfma_f32_16x16x32_bf16 v[176:179], v[220:223], a[0:3], v[176:179]
 v_mfma_f32_16x16x32_bf16 v[180:183], v[220:223], a[4:7], v[180:183]
 v_cvt_pk_bf16_f32 v128, v128, v129
 v_cvt_pk_bf16_f32 v129, v130, v131
 v_mfma_f32_16x16x32_bf16 v[184:187], v[220:223], a[128:131], v[184:187]
 v_cvt_pk_bf16_f32 v130, v132, v133
 v_cvt_pk_bf16_f32 v131, v134, v135
 v_mfma_f32_16x16x32_bf16 v[188:191], v[220:223], a[132:135], v[188:191]
 s_waitcnt lgkmcnt(0)
 v_mfma_f32_16x16x32_bf16 v[160:163], v[248:251], a[8:11], v[160:163]
 ds_read_b64_tr_b16 v[216:217], v19 offset:46208
 ds_read_b64_tr_b16 v[218:219], v19 offset:50816
 v_mfma_f32_16x16x32_bf16 v[164:167], v[248:251], a[12:15], v[164:167]
 buffer_store_dwordx4 v[128:131], v16, s[16:19], s46 offen offset:0 sc1
 v_mfma_f32_16x16x32_bf16 v[168:171], v[248:251], a[136:139], v[168:171]
 ds_read_b64_tr_b16 v[220:221], v20 offset:46208
 ds_read_b64_tr_b16 v[222:223], v20 offset:50816
 v_mfma_f32_16x16x32_bf16 v[172:175], v[248:251], a[140:143], v[172:175]
 v_cvt_pk_bf16_f32 v132, v136, v137
 v_cvt_pk_bf16_f32 v133, v138, v139
 v_mfma_f32_16x16x32_bf16 v[176:179], v[252:255], a[8:11], v[176:179]
 v_cvt_pk_bf16_f32 v134, v140, v141
 v_cvt_pk_bf16_f32 v135, v142, v143
 v_mfma_f32_16x16x32_bf16 v[180:183], v[252:255], a[12:15], v[180:183]
 buffer_store_dwordx4 v[132:135], v16, s[16:19], s46 offen offset:1024 sc1
 v_mfma_f32_16x16x32_bf16 v[184:187], v[252:255], a[136:139], v[184:187]
 v_cvt_pk_bf16_f32 v136, v144, v145
 v_cvt_pk_bf16_f32 v137, v146, v147
 v_mfma_f32_16x16x32_bf16 v[188:191], v[252:255], a[140:143], v[188:191]
 s_waitcnt lgkmcnt(0)
 v_cvt_pk_bf16_f32 v138, v148, v149
 v_cvt_pk_bf16_f32 v139, v150, v151
 v_mfma_f32_16x16x32_bf16 v[160:163], v[216:219], a[16:19], v[160:163]
 ds_read_b64_tr_b16 v[248:249], v19 offset:55424
 ds_read_b64_tr_b16 v[250:251], v19 offset:60032
 v_mfma_f32_16x16x32_bf16 v[164:167], v[216:219], a[20:23], v[164:167]
 buffer_store_dwordx4 v[136:139], v16, s[16:19], s46 offen offset:2048 sc1
 v_mfma_f32_16x16x32_bf16 v[168:171], v[216:219], a[144:147], v[168:171]
 ds_read_b64_tr_b16 v[252:253], v20 offset:55424
 ds_read_b64_tr_b16 v[254:255], v20 offset:60032
 v_mfma_f32_16x16x32_bf16 v[172:175], v[216:219], a[148:151], v[172:175]
 v_cvt_pk_bf16_f32 v140, v152, v153
 v_cvt_pk_bf16_f32 v141, v154, v155
 v_mfma_f32_16x16x32_bf16 v[176:179], v[220:223], a[16:19], v[176:179]
 v_cvt_pk_bf16_f32 v142, v156, v157
 v_cvt_pk_bf16_f32 v143, v158, v159
 v_mfma_f32_16x16x32_bf16 v[180:183], v[220:223], a[20:23], v[180:183]
 buffer_store_dwordx4 v[140:143], v16, s[16:19], s46 offen offset:3072 sc1
 v_mfma_f32_16x16x32_bf16 v[184:187], v[220:223], a[144:147], v[184:187]
 s_add_u32 s46, s46, 4096
 v_mfma_f32_16x16x32_bf16 v[188:191], v[220:223], a[148:151], v[188:191]
 s_waitcnt lgkmcnt(0)
 v_mfma_f32_16x16x32_bf16 v[160:163], v[248:251], a[24:27], v[160:163]
 v_add_u32 v17, 64512, v17
 v_add_u32 v18, 64512, v18
 v_mfma_f32_16x16x32_bf16 v[164:167], v[248:251], a[28:31], v[164:167]
 v_add_u32 v19, 64512, v19
 v_add_u32 v20, 64512, v20
 v_mfma_f32_16x16x32_bf16 v[168:171], v[248:251], a[152:155], v[168:171]
 ds_read_b64_tr_b16 v[216:217], v19 offset:128
 ds_read_b64_tr_b16 v[218:219], v19 offset:4736
 v_mfma_f32_16x16x32_bf16 v[172:175], v[248:251], a[156:159], v[172:175]
 ds_read_b64_tr_b16 v[220:221], v20 offset:128
 ds_read_b64_tr_b16 v[222:223], v20 offset:4736
 v_mfma_f32_16x16x32_bf16 v[176:179], v[252:255], a[24:27], v[176:179]
 v_mfma_f32_16x16x32_bf16 v[180:183], v[252:255], a[28:31], v[180:183]
 v_mfma_f32_16x16x32_bf16 v[184:187], v[252:255], a[152:155], v[184:187]
 v_mfma_f32_16x16x32_bf16 v[188:191], v[252:255], a[156:159], v[188:191]
 s_waitcnt lgkmcnt(0)
 v_mfma_f32_16x16x32_bf16 v[160:163], v[216:219], a[32:35], v[160:163]
 ds_read_b64_tr_b16 v[248:249], v19 offset:9344
 ds_read_b64_tr_b16 v[250:251], v19 offset:13952
 v_mfma_f32_16x16x32_bf16 v[164:167], v[216:219], a[36:39], v[164:167]
 v_mfma_f32_16x16x32_bf16 v[168:171], v[216:219], a[160:163], v[168:171]
 ds_read_b64_tr_b16 v[252:253], v20 offset:9344
 ds_read_b64_tr_b16 v[254:255], v20 offset:13952
 v_mfma_f32_16x16x32_bf16 v[172:175], v[216:219], a[164:167], v[172:175]
 v_mfma_f32_16x16x32_bf16 v[176:179], v[220:223], a[32:35], v[176:179]
 v_mfma_f32_16x16x32_bf16 v[180:183], v[220:223], a[36:39], v[180:183]
 v_mfma_f32_16x16x32_bf16 v[184:187], v[220:223], a[160:163], v[184:187]
 v_mfma_f32_16x16x32_bf16 v[188:191], v[220:223], a[164:167], v[188:191]
 s_waitcnt lgkmcnt(0)
 v_mfma_f32_16x16x32_bf16 v[160:163], v[248:251], a[40:43], v[160:163]
 v_add_u32 v17, 4294838272, v17
 v_add_u32 v18, 4294838272, v18
 v_mfma_f32_16x16x32_bf16 v[164:167], v[248:251], a[44:47], v[164:167]
 v_add_u32 v19, 4294838272, v19
 v_add_u32 v20, 4294838272, v20
 v_mfma_f32_16x16x32_bf16 v[168:171], v[248:251], a[168:171], v[168:171]
 ds_read_b64_tr_b16 v[216:217], v19 offset:128
 ds_read_b64_tr_b16 v[218:219], v19 offset:4736
 v_mfma_f32_16x16x32_bf16 v[172:175], v[248:251], a[172:175], v[172:175]
 ds_read_b64_tr_b16 v[220:221], v20 offset:128
 ds_read_b64_tr_b16 v[222:223], v20 offset:4736
 v_mfma_f32_16x16x32_bf16 v[176:179], v[252:255], a[40:43], v[176:179]
 s_waitcnt vmcnt(4)
 v_max3_u32 v15, v64, v65, v66
 v_max3_u32 v15, v15, v67, v68
 v_mfma_f32_16x16x32_bf16 v[180:183], v[252:255], a[44:47], v[180:183]
 v_max3_u32 v15, v15, v69, v70
 v_max3_u32 v15, v15, v71, v72
 v_mfma_f32_16x16x32_bf16 v[184:187], v[252:255], a[168:171], v[184:187]
 v_max3_u32 v15, v15, v73, v74
 v_max3_u32 v15, v15, v75, v76
 v_mfma_f32_16x16x32_bf16 v[188:191], v[252:255], a[172:175], v[188:191]
 s_waitcnt lgkmcnt(0)
 v_max3_u32 v15, v15, v77, v78
 v_max_u32 v15, v15, v79
 v_mfma_f32_16x16x32_bf16 v[160:163], v[216:219], a[48:51], v[160:163]
 ds_read_b64_tr_b16 v[248:249], v19 offset:9344
 ds_read_b64_tr_b16 v[250:251], v19 offset:13952
 v_mfma_f32_16x16x32_bf16 v[164:167], v[216:219], a[52:55], v[164:167]
 v_cmp_eq_u32 vcc, -1, v15
 v_mfma_f32_16x16x32_bf16 v[168:171], v[216:219], a[176:179], v[168:171]
 ds_read_b64_tr_b16 v[252:253], v20 offset:9344
 ds_read_b64_tr_b16 v[254:255], v20 offset:13952
 v_mfma_f32_16x16x32_bf16 v[172:175], v[216:219], a[180:183], v[172:175]
 v_mfma_f32_16x16x32_bf16 v[176:179], v[220:223], a[48:51], v[176:179]
 s_cbranch_vccnz L_spin_x2
L_spin_x2_ret:
 v_lshlrev_b32 v3, 16, v64
 v_fmac_f32 v40, v6, v3
 v_mfma_f32_16x16x32_bf16 v[180:183], v[220:223], a[52:55], v[180:183]
 v_and_b32 v4, s37, v64
 v_fmac_f32 v41, v6, v4
 v_mfma_f32_16x16x32_bf16 v[184:187], v[220:223], a[176:179], v[184:187]
 v_lshlrev_b32 v3, 16, v65
 v_fmac_f32 v42, v6, v3
 v_mfma_f32_16x16x32_bf16 v[188:191], v[220:223], a[180:183], v[188:191]
 s_waitcnt lgkmcnt(0)
 v_and_b32 v4, s37, v65
 v_fmac_f32 v43, v6, v4
 v_mfma_f32_16x16x32_bf16 v[160:163], v[248:251], a[56:59], v[160:163]
 ds_read_b64_tr_b16 v[216:217], v19 offset:18560
 ds_read_b64_tr_b16 v[218:219], v19 offset:23168
 v_mfma_f32_16x16x32_bf16 v[164:167], v[248:251], a[60:63], v[164:167]
 v_lshlrev_b32 v3, 16, v66
 v_fmac_f32 v44, v7, v3
 v_mfma_f32_16x16x32_bf16 v[168:171], v[248:251], a[184:187], v[168:171]
 ds_read_b64_tr_b16 v[220:221], v20 offset:18560
 ds_read_b64_tr_b16 v[222:223], v20 offset:23168
 v_mfma_f32_16x16x32_bf16 v[172:175], v[248:251], a[188:191], v[172:175]
 v_and_b32 v4, s37, v66
 v_fmac_f32 v45, v7, v4
 v_mfma_f32_16x16x32_bf16 v[176:179], v[252:255], a[56:59], v[176:179]
 v_lshlrev_b32 v3, 16, v67
 v_fmac_f32 v46, v7, v3
 v_mfma_f32_16x16x32_bf16 v[180:183], v[252:255], a[60:63], v[180:183]
 v_and_b32 v4, s37, v67
 v_fmac_f32 v47, v7, v4
 v_mfma_f32_16x16x32_bf16 v[184:187], v[252:255], a[184:187], v[184:187]
 v_lshlrev_b32 v3, 16, v68
 v_fmac_f32 v48, v11, v3
 v_mfma_f32_16x16x32_bf16 v[188:191], v[252:255], a[188:191], v[188:191]
 s_waitcnt lgkmcnt(0)
 v_and_b32 v4, s37, v68
 v_fmac_f32 v49, v11, v4
 v_mfma_f32_16x16x32_bf16 v[160:163], v[216:219], a[64:67], v[160:163]
 ds_read_b64_tr_b16 v[248:249], v19 offset:27776
 ds_read_b64_tr_b16 v[250:251], v19 offset:32384
 v_mfma_f32_16x16x32_bf16 v[164:167], v[216:219], a[68:71], v[164:167]
 v_lshlrev_b32 v3, 16, v69
 v_fmac_f32 v50, v11, v3
 v_mfma_f32_16x16x32_bf16 v[168:171], v[216:219], a[192:195], v[168:171]
 ds_read_b64_tr_b16 v[252:253], v20 offset:27776
 ds_read_b64_tr_b16 v[254:255], v20 offset:32384
 v_mfma_f32_16x16x32_bf16 v[172:175], v[216:219], a[196:199], v[172:175]
 v_and_b32 v4, s37, v69
 v_fmac_f32 v51, v11, v4
 v_mfma_f32_16x16x32_bf16 v[176:179], v[220:223], a[64:67], v[176:179]
 v_lshlrev_b32 v3, 16, v70
 v_fmac_f32 v52, v12, v3
 v_mfma_f32_16x16x32_bf16 v[180:183], v[220:223], a[68:71], v[180:183]
 v_and_b32 v4, s37, v70
 v_fmac_f32 v53, v12, v4
 v_mfma_f32_16x16x32_bf16 v[184:187], v[220:223], a[192:195], v[184:187]
 v_lshlrev_b32 v3, 16, v71
 v_fmac_f32 v54, v12, v3
 v_mfma_f32_16x16x32_bf16 v[188:191], v[220:223], a[196:199], v[188:191]
 s_waitcnt lgkmcnt(0)
 v_and_b32 v4, s37, v71
 v_fmac_f32 v55, v12, v4
 v_mfma_f32_16x16x32_bf16 v[160:163], v[248:251], a[72:75], v[160:163]
 ds_read_b64_tr_b16 v[216:217], v19 offset:36992
 ds_read_b64_tr_b16 v[218:219], v19 offset:41600
 v_mfma_f32_16x16x32_bf16 v[164:167], v[248:251], a[76:79], v[164:167]
 v_lshlrev_b32 v3, 16, v72
 v_fmac_f32 v24, v6, v3
 v_mfma_f32_16x16x32_bf16 v[168:171], v[248:251], a[200:203], v[168:171]
 ds_read_b64_tr_b16 v[220:221], v20 offset:36992
 ds_read_b64_tr_b16 v[222:223], v20 offset:41600
 v_mfma_f32_16x16x32_bf16 v[172:175], v[248:251], a[204:207], v[172:175]
 v_and_b32 v4, s37, v72
 v_fmac_f32 v25, v6, v4
 v_mfma_f32_16x16x32_bf16 v[176:179], v[252:255], a[72:75], v[176:179]
 v_lshlrev_b32 v3, 16, v73
 v_fmac_f32 v28, v6, v3
 v_mfma_f32_16x16x32_bf16 v[180:183], v[252:255], a[76:79], v[180:183]
 v_and_b32 v4, s37, v73
 v_fmac_f32 v29, v6, v4
 v_mfma_f32_16x16x32_bf16 v[184:187], v[252:255], a[200:203], v[184:187]
 v_lshlrev_b32 v3, 16, v74
 v_fmac_f32 v32, v7, v3
 v_mfma_f32_16x16x32_bf16 v[188:191], v[252:255], a[204:207], v[188:191]
 s_waitcnt lgkmcnt(0)
 v_and_b32 v4, s37, v74
 v_fmac_f32 v33, v7, v4
 v_mfma_f32_16x16x32_bf16 v[160:163], v[216:219], a[80:83], v[160:163]
 ds_read_b64_tr_b16 v[248:249], v19 offset:46208
 ds_read_b64_tr_b16 v[250:251], v19 offset:50816
 v_mfma_f32_16x16x32_bf16 v[164:167], v[216:219], a[84:87], v[164:167]
 s_lshl_b32 s41, s44, 2
 s_xor_b32 s41, s41, 65536
 v_mfma_f32_16x16x32_bf16 v[168:171], v[216:219], a[208:211], v[168:171]
 ds_read_b64_tr_b16 v[252:253], v20 offset:46208
 ds_read_b64_tr_b16 v[254:255], v20 offset:50816
 v_mfma_f32_16x16x32_bf16 v[172:175], v[216:219], a[212:215], v[172:175]
L_pad17:
 s_cbranch_execz L_back
 s_add_u32 s41, s41, 8192
 buffer_load_dwordx4 v[96:99], v16, s[16:19], s41 offen offset:0 sc1
 v_mfma_f32_16x16x32_bf16 v[176:179], v[220:223], a[80:83], v[176:179]
 buffer_load_dwordx4 v[100:103], v16, s[16:19], s41 offen offset:1024 sc1
 v_mfma_f32_16x16x32_bf16 v[180:183], v[220:223], a[84:87], v[180:183]
 buffer_load_dwordx4 v[104:107], v16, s[16:19], s41 offen offset:2048 sc1
 v_mfma_f32_16x16x32_bf16 v[184:187], v[220:223], a[208:211], v[184:187]
 buffer_load_dwordx4 v[108:111], v16, s[16:19], s41 offen offset:3072 sc1
 v_mfma_f32_16x16x32_bf16 v[188:191], v[220:223], a[212:215], v[188:191]
 s_waitcnt lgkmcnt(0)
 v_lshlrev_b32 v3, 16, v75
 v_fmac_f32 v36, v7, v3
 v_mfma_f32_16x16x32_bf16 v[160:163], v[248:251], a[88:91], v[160:163]
 ds_read_b64_tr_b16 v[216:217], v19 offset:55424
 ds_read_b64_tr_b16 v[218:219], v19 offset:60032
 v_mfma_f32_16x16x32_bf16 v[164:167], v[248:251], a[92:95], v[164:167]
 v_and_b32 v4, s37, v75
 v_fmac_f32 v37, v7, v4
 v_mfma_f32_16x16x32_bf16 v[168:171], v[248:251], a[216:219], v[168:171]
 ds_read_b64_tr_b16 v[220:221], v20 offset:55424
 ds_read_b64_tr_b16 v[222:223], v20 offset:60032
 v_mfma_f32_16x16x32_bf16 v[172:175], v[248:251], a[220:223], v[172:175]
 v_lshlrev_b32 v3, 16, v76
 v_fmac_f32 v56, v11, v3
 v_mfma_f32_16x16x32_bf16 v[176:179], v[252:255], a[88:91], v[176:179]
 v_and_b32 v4, s37, v76
 v_fmac_f32 v57, v11, v4
 v_mfma_f32_16x16x32_bf16 v[180:183], v[252:255], a[92:95], v[180:183]
 v_lshlrev_b32 v3, 16, v77
 v_fmac_f32 v58, v11, v3
 v_mfma_f32_16x16x32_bf16 v[184:187], v[252:255], a[216:219], v[184:187]
 v_and_b32 v4, s37, v77
 v_fmac_f32 v59, v11, v4
 v_mfma_f32_16x16x32_bf16 v[188:191], v[252:255], a[220:223], v[188:191]
 s_waitcnt lgkmcnt(0)
 v_lshlrev_b32 v3, 16, v78
 v_fmac_f32 v26, v12, v3
 v_mfma_f32_16x16x32_bf16 v[160:163], v[216:219], a[96:99], v[160:163]
 v_add_u32 v17, 64512, v17
 v_add_u32 v18, 64512, v18
 v_mfma_f32_16x16x32_bf16 v[164:167], v[216:219], a[100:103], v[164:167]
 v_add_u32 v19, 64512, v19
 v_add_u32 v20, 64512, v20
 v_mfma_f32_16x16x32_bf16 v[168:171], v[216:219], a[224:227], v[168:171]
 ds_read_b64_tr_b16 v[248:249], v19 offset:128
 ds_read_b64_tr_b16 v[250:251], v19 offset:4736
 v_mfma_f32_16x16x32_bf16 v[172:175], v[216:219], a[228:231], v[172:175]
 ds_read_b64_tr_b16 v[252:253], v20 offset:128
 ds_read_b64_tr_b16 v[254:255], v20 offset:4736
 v_mfma_f32_16x16x32_bf16 v[176:179], v[220:223], a[96:99], v[176:179]
 v_and_b32 v4, s37, v78
 v_fmac_f32 v27, v12, v4
 v_mfma_f32_16x16x32_bf16 v[180:183], v[220:223], a[100:103], v[180:183]
 v_lshlrev_b32 v3, 16, v79
 v_fmac_f32 v30, v12, v3
 v_mfma_f32_16x16x32_bf16 v[184:187], v[220:223], a[224:227], v[184:187]
 v_and_b32 v4, s37, v79
 v_fmac_f32 v31, v12, v4
 v_mfma_f32_16x16x32_bf16 v[188:191], v[220:223], a[228:231], v[188:191]
 s_waitcnt lgkmcnt(0)
 v_mfma_f32_16x16x32_bf16 v[160:163], v[248:251], a[104:107], v[160:163]
 ds_read_b64_tr_b16 v[216:217], v19 offset:9344
 ds_read_b64_tr_b16 v[218:219], v19 offset:13952
 v_mfma_f32_16x16x32_bf16 v[164:167], v[248:251], a[108:111], v[164:167]
 v_mfma_f32_16x16x32_bf16 v[168:171], v[248:251], a[232:235], v[168:171]
 ds_read_b64_tr_b16 v[220:221], v20 offset:9344
 ds_read_b64_tr_b16 v[222:223], v20 offset:13952
 v_mfma_f32_16x16x32_bf16 v[172:175], v[248:251], a[236:239], v[172:175]
 v_mfma_f32_16x16x32_bf16 v[176:179], v[252:255], a[104:107], v[176:179]
 v_mfma_f32_16x16x32_bf16 v[180:183], v[252:255], a[108:111], v[180:183]
 v_mfma_f32_16x16x32_bf16 v[184:187], v[252:255], a[232:235], v[184:187]
 v_mfma_f32_16x16x32_bf16 v[188:191], v[252:255], a[236:239], v[188:191]
 s_waitcnt lgkmcnt(0)
 v_mfma_f32_16x16x32_bf16 v[160:163], v[216:219], a[112:115], v[160:163]
 ds_read_b64_tr_b16 v[248:249], v19 offset:18560
 ds_read_b64_tr_b16 v[250:251], v19 offset:23168
 v_mfma_f32_16x16x32_bf16 v[164:167], v[216:219], a[116:119], v[164:167]
 v_mfma_f32_16x16x32_bf16 v[168:171], v[216:219], a[240:243], v[168:171]
 ds_read_b64_tr_b16 v[252:253], v20 offset:18560
 ds_read_b64_tr_b16 v[254:255], v20 offset:23168
 v_mfma_f32_16x16x32_bf16 v[172:175], v[216:219], a[244:247], v[172:175]
 v_mfma_f32_16x16x32_bf16 v[176:179], v[220:223], a[112:115], v[176:179]
 v_mfma_f32_16x16x32_bf16 v[180:183], v[220:223], a[116:119], v[180:183]
 v_mfma_f32_16x16x32_bf16 v[184:187], v[220:223], a[240:243], v[184:187]
 v_mfma_f32_16x16x32_bf16 v[188:191], v[220:223], a[244:247], v[188:191]
 s_waitcnt lgkmcnt(0)
 v_mfma_f32_16x16x32_bf16 v[160:163], v[248:251], a[120:123], v[160:163]
 v_mfma_f32_16x16x32_bf16 v[164:167], v[248:251], a[124:127], v[164:167]
 v_mfma_f32_16x16x32_bf16 v[168:171], v[248:251], a[248:251], v[168:171]
 v_mfma_f32_16x16x32_bf16 v[172:175], v[248:251], a[252:255], v[172:175]
 v_mfma_f32_16x16x32_bf16 v[176:179], v[252:255], a[120:123], v[176:179]
 v_mfma_f32_16x16x32_bf16 v[180:183], v[252:255], a[124:127], v[180:183]
 v_mfma_f32_16x16x32_bf16 v[184:187], v[252:255], a[248:251], v[184:187]
 v_mfma_f32_16x16x32_bf16 v[188:191], v[252:255], a[252:255], v[188:191]
 s_waitcnt lgkmcnt(0)
 s_waitcnt vmcnt(0)
 v_max3_u32 v15, v96, v97, v98
 v_max3_u32 v15, v15, v99, v100
 v_max3_u32 v15, v15, v101, v102
 v_max3_u32 v15, v15, v103, v104
 v_max3_u32 v15, v15, v105, v106
 v_max3_u32 v15, v15, v107, v108
 v_max3_u32 v15, v15, v109, v110
 v_max_u32 v15, v15, v111
 v_cmp_eq_u32 vcc, -1, v15
 s_nop 0
 s_nop 0
 s_cbranch_vccnz L_spin_x1
L_spin_x1_ret:
 v_lshlrev_b32 v132, 16, v96
 v_and_b32 v133, s37, v96
 v_lshlrev_b32 v134, 16, v97
 v_and_b32 v135, s37, v97
 v_pk_add_f32 v[160:161], v[160:161], v[132:133]
 v_pk_add_f32 v[162:163], v[162:163], v[134:135]
 v_fma_f32 v160, v160, v6, v40
 v_fma_f32 v161, v161, v6, v41
 v_fma_f32 v162, v162, v6, v42
 v_fma_f32 v163, v163, v6, v43
 v_cvt_pk_bf16_f32 v112, v160, v161
 v_cvt_pk_bf16_f32 v113, v162, v163
 v_lshlrev_b32 v132, 16, v104
 v_and_b32 v133, s37, v104
 v_lshlrev_b32 v134, 16, v105
 v_and_b32 v135, s37, v105
 v_pk_add_f32 v[176:177], v[176:177], v[132:133]
 v_pk_add_f32 v[178:179], v[178:179], v[134:135]
 v_fma_f32 v176, v176, v6, v24
 v_fma_f32 v177, v177, v6, v25
 v_fma_f32 v178, v178, v6, v28
 v_fma_f32 v179, v179, v6, v29
 v_cvt_pk_bf16_f32 v114, v176, v177
 v_cvt_pk_bf16_f32 v115, v178, v179
 s_add_u32 s36, s48, 0
 v_permlane16_swap_b32 v112, v114
 v_permlane16_swap_b32 v113, v115
 buffer_store_dwordx4 v[112:115], v21, s[20:23], s36 offen
 v_lshlrev_b32 v132, 16, v98
 v_and_b32 v133, s37, v98
 v_lshlrev_b32 v134, 16, v99
 v_and_b32 v135, s37, v99
 v_pk_add_f32 v[164:165], v[164:165], v[132:133]
 v_pk_add_f32 v[166:167], v[166:167], v[134:135]
 v_fma_f32 v164, v164, v7, v44
 v_fma_f32 v165, v165, v7, v45
 v_fma_f32 v166, v166, v7, v46
 v_fma_f32 v167, v167, v7, v47
 v_cvt_pk_bf16_f32 v116, v164, v165
 v_cvt_pk_bf16_f32 v117, v166, v167
 v_lshlrev_b32 v132, 16, v106
 v_and_b32 v133, s37, v106
 v_lshlrev_b32 v134, 16, v107
 v_and_b32 v135, s37, v107
 v_pk_add_f32 v[180:181], v[180:181], v[132:133]
 v_pk_add_f32 v[182:183], v[182:183], v[134:135]
 v_fma_f32 v180, v180, v7, v32
 v_fma_f32 v181, v181, v7, v33
 v_fma_f32 v182, v182, v7, v36
 v_fma_f32 v183, v183, v7, v37
 v_cvt_pk_bf16_f32 v118, v180, v181
 v_cvt_pk_bf16_f32 v119, v182, v183
 s_add_u32 s36, s48, 131072
 v_permlane16_swap_b32 v116, v118
 v_permlane16_swap_b32 v117, v119
 buffer_store_dwordx4 v[116:119], v21, s[20:23], s36 offen
 v_lshlrev_b32 v132, 16, v100
 v_and_b32 v133, s37, v100
 v_lshlrev_b32 v134, 16, v101
 v_and_b32 v135, s37, v101
 v_pk_add_f32 v[168:169], v[168:169], v[132:133]
 v_pk_add_f32 v[170:171], v[170:171], v[134:135]
 v_fma_f32 v168, v168, v11, v48
 v_fma_f32 v169, v169, v11, v49
 v_fma_f32 v170, v170, v11, v50
 v_fma_f32 v171, v171, v11, v51
 v_cvt_pk_bf16_f32 v112, v168, v169
 v_cvt_pk_bf16_f32 v113, v170, v171
 v_lshlrev_b32 v132, 16, v108
 v_and_b32 v133, s37, v108
 v_lshlrev_b32 v134, 16, v109
 v_and_b32 v135, s37, v109
 v_pk_add_f32 v[184:185], v[184:185], v[132:133]
 v_pk_add_f32 v[186:187], v[186:187], v[134:135]
 v_fma_f32 v184, v184, v11, v56
 v_fma_f32 v185, v185, v11, v57
 v_fma_f32 v186, v186, v11, v58
 v_fma_f32 v187, v187, v11, v59
 v_cvt_pk_bf16_f32 v114, v184, v185
 v_cvt_pk_bf16_f32 v115, v186, v187
 s_add_u32 s36, s48, 2097152
 v_permlane16_swap_b32 v112, v114
 v_permlane16_swap_b32 v113, v115
 buffer_store_dwordx4 v[112:115], v21, s[20:23], s36 offen
 v_lshlrev_b32 v132, 16, v102
 v_and_b32 v133, s37, v102
 v_lshlrev_b32 v134, 16, v103
 v_and_b32 v135, s37, v103
 v_pk_add_f32 v[172:173], v[172:173], v[132:133]
 v_pk_add_f32 v[174:175], v[174:175], v[134:135]
 v_fma_f32 v172, v172, v12, v52
 v_fma_f32 v173, v173, v12, v53
 v_fma_f32 v174, v174, v12, v54
 v_fma_f32 v175, v175, v12, v55
 v_cvt_pk_bf16_f32 v116, v172, v173
 v_cvt_pk_bf16_f32 v117, v174, v175
 v_lshlrev_b32 v132, 16, v110
 v_and_b32 v133, s37, v110
 v_lshlrev_b32 v134, 16, v111
 v_and_b32 v135, s37, v111
 v_pk_add_f32 v[188:189], v[188:189], v[132:133]
 v_pk_add_f32 v[190:191], v[190:191], v[134:135]
 v_fma_f32 v188, v188, v12, v26
 v_fma_f32 v189, v189, v12, v27
 v_fma_f32 v190, v190, v12, v30
 v_fma_f32 v191, v191, v12, v31
 v_cvt_pk_bf16_f32 v118, v188, v189
 v_cvt_pk_bf16_f32 v119, v190, v191
 s_add_u32 s36, s48, 2228224
 v_permlane16_swap_b32 v116, v118
 v_permlane16_swap_b32 v117, v119
 buffer_store_dwordx4 v[116:119], v21, s[20:23], s36 offen
L_end:
 s_endpgm
L_wb:
 v_bfe_u32 v3, v16, 1, 8
 s_branch L_wbs
L_wbs_ret:
 v_bfe_u32 v3, v16, 2, 5
 buffer_wbl2 sc1
 s_waitcnt vmcnt(0)
 s_branch L_wb_ret
L_wbs:
 s_mov_b32 s54, 0
L_wbs_again:
 s_sleep 2
 buffer_load_dword v9, v3, s[76:79], 0 offen sc1
 s_waitcnt vmcnt(0)
 v_and_b32 v11, v10, v9
 v_lshrrev_b32 v12, 4, v9
 v_and_b32 v12, v10, v12
 v_sad_u8 v11, v11, 0, 0
 v_sad_u8 v11, v12, 0, v11
 v_cmp_ne_u32 vcc, 8, v11
 s_add_u32 s54, s54, 1
 s_cmp_gt_u32 s54, 0x40000
 s_cbranch_scc1 L_wbs_ret
 s_cbranch_vccnz L_wbs_again
 s_branch L_wbs_ret
L_spin_kv:
 s_mov_b32 s54, 0
L_spin_kv_again:
 s_sleep 2
 buffer_load_dword v2, v3, s[28:31], s40 offen sc1
 s_waitcnt vmcnt(0)
 v_cmp_ne_u32 vcc, 1, v2
 s_add_u32 s54, s54, 1
 s_cmp_gt_u32 s54, 0x40000
 s_cbranch_scc1 L_spin_kv_ret
 s_cbranch_vccnz L_spin_kv_again
 s_branch L_spin_kv_ret
L_b4_sw:
 s_waitcnt vmcnt(8)
 v_and_b32 v17, v28, v29
 v_and_b32 v18, v30, v31
 v_and_b32 v17, v17, v18
 v_cmp_ne_u32 vcc, 1, v17
 s_mov_b32 s58, 1
 s_mov_b32 s35, 0
 s_cbranch_vccnz L_b4_sw_spin
L_b4_sw_spin_ret:
 s_lshl_b32 s36, s2, 2
 s_cmp_eq_u32 s32, 0
 s_cbranch_scc1 L_b4_sw_h
 s_add_u32 s12, s94, 50331648
 s_addc_u32 s13, s95, 0
 s_mov_b32 s14, 4718592
 s_mov_b32 s15, 0x00020000
 s_mul_i32 s38, s36, 4608
 s_movk_i32 s44, 4608
 s_mov_b32 s49, -2
 s_movk_i32 s50, 4640
 s_lshl_b32 s37, s32, 2
 s_sub_u32 s37, 10, s37
 s_add_u32 s38, s38, s37
 s_mul_i32 s59, s32, 9280
 s_add_u32 s59, s59, 4294966496
 s_cmp_eq_u32 s32, 3
 s_cbranch_scc0 L_b4_sw_go
 s_mov_b32 s14, 0
 s_mov_b32 s38, 2
 s_mov_b32 s59, 163840
 s_mov_b32 s50, 0
 s_branch L_b4_sw_go
L_b4_sw_h:
 s_mov_b32 s12, s72
 s_mov_b32 s13, s73
 s_mov_b32 s14, 4194304
 s_mov_b32 s15, 0x00020000
 s_lshl_b32 s38, s36, 12
 s_movk_i32 s44, 4096
 s_mov_b32 s49, 8
 s_movk_i32 s50, 4240
 s_movk_i32 s59, 128
L_b4_sw_go:
 s_mov_b32 s40, s59
 s_add_u32 s41, s59, s50
 s_movk_i32 s48, -5728
 s_add_u32 s59, s59, s48
 s_branch L_b4e
L_b4_sw_spin:
 s_mov_b32 s54, 0
L_b4_sw_spin_again:
 s_sleep 2
 buffer_load_dwordx4 v[28:31], v14, s[28:31], s47 offen sc1
 s_waitcnt vmcnt(0)
 v_and_b32 v17, v28, v29
 v_and_b32 v18, v30, v31
 v_and_b32 v17, v17, v18
 v_cmp_ne_u32 vcc, 1, v17
 s_add_u32 s54, s54, 1
 s_cmp_gt_u32 s54, 0x40000
 s_cbranch_scc1 L_b4_sw_spin_ret
 s_cbranch_vccnz L_b4_sw_spin_again
 s_branch L_b4_sw_spin_ret
L_spin_all:
 s_mov_b32 s54, 0
L_spin_all_again:
 s_sleep 2
 buffer_load_dwordx4 v[28:31], v14, s[28:31], s47 offen sc1
 s_waitcnt vmcnt(0)
 v_and_b32 v17, v28, v29
 v_and_b32 v18, v30, v31
 v_and_b32 v17, v17, v18
 v_cmp_ne_u32 vcc, 1, v17
 s_add_u32 s54, s54, 1
 s_cmp_gt_u32 s54, 0x40000
 s_cbranch_scc1 L_spin_all_ret
 s_cbranch_vccnz L_spin_all_again
 s_branch L_spin_all_ret
L_b2_sw:
L_pad18:
 s_cbranch_execz L_back
 s_waitcnt vmcnt(8)
 v_and_b32 v17, v28, v29
 v_and_b32 v18, v30, v31
 v_and_b32 v17, v17, v18
 v_cmp_ne_u32 vcc, 1, v17
 s_mov_b32 s58, 1
 s_mov_b32 s35, 0
 s_cbranch_vccnz L_b2_sw_spin
L_b2_sw_spin_ret:
 v_mov_b32 v17, 0
 v_mov_b32 v18, 1
 buffer_store_dword v18, v17, s[28:31], s55 offen sc1
 s_lshl_b32 s36, s2, 2
 s_cmp_eq_u32 s32, 0
 s_cbranch_scc1 L_b2_sw_h
 s_add_u32 s12, s94, 50331648
 s_addc_u32 s13, s95, 0
 s_mov_b32 s14, 4718592
 s_mov_b32 s15, 0x00020000
 s_mul_i32 s38, s36, 4608
 s_movk_i32 s44, 4608
 s_mov_b32 s49, -2
 s_movk_i32 s50, 4640
 s_lshl_b32 s37, s32, 2
 s_sub_u32 s37, 10, s37
 s_add_u32 s38, s38, s37
 s_mul_i32 s59, s32, 9280
 s_add_u32 s59, s59, 4294966496
 s_cmp_eq_u32 s32, 3
 s_cbranch_scc0 L_b2_sw_go
 s_mov_b32 s14, 0
 s_mov_b32 s38, 2
 s_mov_b32 s59, 163840
 s_mov_b32 s50, 0
 s_branch L_b2_sw_go
L_b2_sw_h:
L_pad19:
 s_cbranch_execz L_back
 s_mov_b32 s12, s72
 s_mov_b32 s13, s73
 s_mov_b32 s14, 4194304
 s_mov_b32 s15, 0x00020000
 s_lshl_b32 s38, s36, 12
 s_movk_i32 s44, 4096
 s_mov_b32 s49, 8
 s_movk_i32 s50, 4240
 s_movk_i32 s59, 128
L_b2_sw_go:
 s_mov_b32 s40, s59
 s_add_u32 s41, s59, s50
 s_movk_i32 s48, -5728
 s_add_u32 s59, s59, s48
 s_branch L_b2_loop
L_b2_sw_spin:
 s_mov_b32 s54, 0
L_b2_sw_spin_again:
 s_sleep 2
 buffer_load_dwordx4 v[28:31], v14, s[28:31], s47 offen sc1
 s_waitcnt vmcnt(0)
 v_and_b32 v17, v28, v29
 v_and_b32 v18, v30, v31
 v_and_b32 v17, v17, v18
 v_cmp_ne_u32 vcc, 1, v17
 s_add_u32 s54, s54, 1
 s_cmp_gt_u32 s54, 0x40000
 s_cbranch_scc1 L_b2_sw_spin_ret
 s_cbranch_vccnz L_b2_sw_spin_again
 s_branch L_b2_sw_spin_ret
L_spin_s:
 s_mov_b32 s54, 0
L_spin_s_again:
 s_sleep 2
 buffer_load_dword v14, v13, s[28:31], s52 offen sc1
 s_waitcnt vmcnt(0)
 v_cmp_ne_u32 vcc, 1, v14
 s_add_u32 s54, s54, 1
 s_cmp_gt_u32 s54, 0x40000
 s_cbranch_scc1 L_spin_s_ret
 s_cbranch_vccnz L_spin_s_again
 s_branch L_spin_s_ret
L_spin_l:
 s_mov_b32 s54, 0
L_spin_l_again:
 s_sleep 2
 buffer_load_dword v14, v13, s[28:31], s52 offen sc1
 s_waitcnt vmcnt(0)
 v_cmp_ne_u32 vcc, 1, v14
 s_add_u32 s54, s54, 1
 s_cmp_gt_u32 s54, 0x40000
 s_cbranch_scc1 L_spin_l_ret
 s_cbranch_vccnz L_spin_l_again
 s_branch L_spin_l_ret
L_spin_y:
 s_mov_b32 s54, 0
L_spin_y_again:
 s_sleep 2
 buffer_load_dword v14, v13, s[28:31], 0 offen sc1
 s_waitcnt vmcnt(0)
 v_cmp_ne_u32 vcc, 1, v14
 s_add_u32 s54, s54, 1
 s_cmp_gt_u32 s54, 0x40000
 s_cbranch_scc1 L_spin_y_ret
 s_cbranch_vccnz L_spin_y_again
 s_branch L_spin_y_ret
L_spin_x3:
 s_mov_b32 s54, 0
L_spin_x3_again:
 s_sleep 2
 buffer_load_dwordx4 v[80:83], v16, s[16:19], s52 offen offset:0 sc1
 buffer_load_dwordx4 v[84:87], v16, s[16:19], s52 offen offset:1024 sc1
 buffer_load_dwordx4 v[88:91], v16, s[16:19], s52 offen offset:2048 sc1
 buffer_load_dwordx4 v[92:95], v16, s[16:19], s52 offen offset:3072 sc1
 s_waitcnt vmcnt(0)
 v_max3_u32 v15, v80, v81, v82
 v_max3_u32 v15, v15, v83, v84
 v_max3_u32 v15, v15, v85, v86
 v_max3_u32 v15, v15, v87, v88
 v_max3_u32 v15, v15, v89, v90
 v_max3_u32 v15, v15, v91, v92
 v_max3_u32 v15, v15, v93, v94
 v_max_u32 v15, v15, v95
 v_cmp_eq_u32 vcc, -1, v15
 s_add_u32 s54, s54, 1
 s_cmp_gt_u32 s54, 0x40000
 s_cbranch_scc1 L_spin_x3_ret
 s_cbranch_vccnz L_spin_x3_again
 s_branch L_spin_x3_ret
L_spin_x2:
 s_mov_b32 s54, 0
L_spin_x2_again:
 s_sleep 2
 buffer_load_dwordx4 v[64:67], v16, s[16:19], s42 offen offset:0 sc1
 buffer_load_dwordx4 v[68:71], v16, s[16:19], s42 offen offset:1024 sc1
 buffer_load_dwordx4 v[72:75], v16, s[16:19], s42 offen offset:2048 sc1
 buffer_load_dwordx4 v[76:79], v16, s[16:19], s42 offen offset:3072 sc1
 s_waitcnt vmcnt(0)
 v_max3_u32 v15, v64, v65, v66
 v_max3_u32 v15, v15, v67, v68
 v_max3_u32 v15, v15, v69, v70
 v_max3_u32 v15, v15, v71, v72
 v_max3_u32 v15, v15, v73, v74
 v_max3_u32 v15, v15, v75, v76
 v_max3_u32 v15, v15, v77, v78
 v_max_u32 v15, v15, v79
 v_cmp_eq_u32 vcc, -1, v15
 s_add_u32 s54, s54, 1
 s_cmp_gt_u32 s54, 0x40000
 s_cbranch_scc1 L_spin_x2_ret
 s_cbranch_vccnz L_spin_x2_again
 s_branch L_spin_x2_ret
L_spin_x1:
 s_mov_b32 s54, 0
L_spin_x1_again:
 s_sleep 2
 buffer_load_dwordx4 v[96:99], v16, s[16:19], s41 offen offset:0 sc1
 buffer_load_dwordx4 v[100:103], v16, s[16:19], s41 offen offset:1024 sc1
 buffer_load_dwordx4 v[104:107], v16, s[16:19], s41 offen offset:2048 sc1
 buffer_load_dwordx4 v[108:111], v16, s[16:19], s41 offen offset:3072 sc1
 s_waitcnt vmcnt(0)
 v_max3_u32 v15, v96, v97, v98
 v_max3_u32 v15, v15, v99, v100
 v_max3_u32 v15, v15, v101, v102
 v_max3_u32 v15, v15, v103, v104
 v_max3_u32 v15, v15, v105, v106
 v_max3_u32 v15, v15, v107, v108
 v_max3_u32 v15, v15, v109, v110
 v_max_u32 v15, v15, v111
 v_cmp_eq_u32 vcc, -1, v15
 s_add_u32 s54, s54, 1
 s_cmp_gt_u32 s54, 0x40000
 s_cbranch_scc1 L_spin_x1_ret
 s_cbranch_vccnz L_spin_x1_again
 s_branch L_spin_x1_ret
L_hotend:
L_b4_r0:
 s_nop 7
 v_max3_f32 v32, v144, v145, v146
 v_max3_f32 v32, v147, v148, v32
 v_max3_f32 v32, v149, v150, v32
 v_max_f32 v32, v151, v32
 v_mov_b32 v33, v32
 s_nop 1
 v_permlane16_swap_b32 v32, v33
 s_nop 1
 v_max_f32 v32, v32, v33
 v_mov_b32 v33, v32
 s_nop 1
 v_permlane32_swap_b32 v32, v33
 s_nop 1
 v_max_f32 v32, v32, v33
 v_add_f32 v32, 0x41c00000, v32
 v_max_f32 v32, 0, v32
 v_exp_f32 v34, -v32
 v_sub_f32 v64, v64, v32
 v_sub_f32 v65, v65, v32
 v_sub_f32 v66, v66, v32
 v_sub_f32 v67, v67, v32
 v_sub_f32 v144, v144, v32
 v_sub_f32 v145, v145, v32
 v_sub_f32 v146, v146, v32
 v_sub_f32 v147, v147, v32
 v_sub_f32 v148, v148, v32
 v_sub_f32 v149, v149, v32
 v_sub_f32 v150, v150, v32
 v_sub_f32 v151, v151, v32
 v_sub_f32 v176, v176, v32
 v_sub_f32 v177, v177, v32
 v_sub_f32 v178, v178, v32
 v_sub_f32 v179, v179, v32
 v_sub_f32 v180, v180, v32
 v_sub_f32 v181, v181, v32
 v_sub_f32 v182, v182, v32
 v_sub_f32 v183, v183, v32
 v_mul_f32 v240, v240, v34
 v_mul_f32 v241, v241, v34
 v_mul_f32 v242, v242, v34
 v_mul_f32 v243, v243, v34
 v_accvgpr_read_b32 v33, a0
 v_mul_f32 v33, v33, v34
 v_accvgpr_write_b32 a0, v33
 v_accvgpr_read_b32 v33, a1
 v_mul_f32 v33, v33, v34
 v_accvgpr_write_b32 a1, v33
 v_accvgpr_read_b32 v33, a2
 v_mul_f32 v33, v33, v34
 v_accvgpr_write_b32 a2, v33
 v_accvgpr_read_b32 v33, a3
 v_mul_f32 v33, v33, v34
 v_accvgpr_write_b32 a3, v33
 v_accvgpr_read_b32 v33, a4
 v_mul_f32 v33, v33, v34
 v_accvgpr_write_b32 a4, v33
 v_accvgpr_read_b32 v33, a5
 v_mul_f32 v33, v33, v34
 v_accvgpr_write_b32 a5, v33
 v_accvgpr_read_b32 v33, a6
 v_mul_f32 v33, v33, v34
 v_accvgpr_write_b32 a6, v33
 v_accvgpr_read_b32 v33, a7
 v_mul_f32 v33, v33, v34
 v_accvgpr_write_b32 a7, v33
 v_accvgpr_read_b32 v33, a8
 v_mul_f32 v33, v33, v34
 v_accvgpr_write_b32 a8, v33
 v_accvgpr_read_b32 v33, a9
 v_mul_f32 v33, v33, v34
 v_accvgpr_write_b32 a9, v33
 v_accvgpr_read_b32 v33, a10
 v_mul_f32 v33, v33, v34
 v_accvgpr_write_b32 a10, v33
 v_accvgpr_read_b32 v33, a11
 v_mul_f32 v33, v33, v34
 v_accvgpr_write_b32 a11, v33
 v_accvgpr_read_b32 v33, a12
 v_mul_f32 v33, v33, v34
 v_accvgpr_write_b32 a12, v33
 v_accvgpr_read_b32 v33, a13
 v_mul_f32 v33, v33, v34
 v_accvgpr_write_b32 a13, v33
 v_accvgpr_read_b32 v33, a14
 v_mul_f32 v33, v33, v34
 v_accvgpr_write_b32 a14, v33
 v_accvgpr_read_b32 v33, a15
 v_mul_f32 v33, v33, v34
 v_accvgpr_write_b32 a15, v33
 v_accvgpr_read_b32 v33, a16
 v_mul_f32 v33, v33, v34
 v_accvgpr_write_b32 a16, v33
 v_accvgpr_read_b32 v33, a17
 v_mul_f32 v33, v33, v34
 v_accvgpr_write_b32 a17, v33
 v_accvgpr_read_b32 v33, a18
 v_mul_f32 v33, v33, v34
 v_accvgpr_write_b32 a18, v33
 v_accvgpr_read_b32 v33, a19
 v_mul_f32 v33, v33, v34
 v_accvgpr_write_b32 a19, v33
 v_accvgpr_read_b32 v33, a20
 v_mul_f32 v33, v33, v34
 v_accvgpr_write_b32 a20, v33
 v_accvgpr_read_b32 v33, a21
 v_mul_f32 v33, v33, v34
 v_accvgpr_write_b32 a21, v33
 v_accvgpr_read_b32 v33, a22
 v_mul_f32 v33, v33, v34
 v_accvgpr_write_b32 a22, v33
 v_accvgpr_read_b32 v33, a23
 v_mul_f32 v33, v33, v34
 v_accvgpr_write_b32 a23, v33
 v_accvgpr_read_b32 v33, a24
 v_mul_f32 v33, v33, v34
 v_accvgpr_write_b32 a24, v33
 v_accvgpr_read_b32 v33, a25
 v_mul_f32 v33, v33, v34
 v_accvgpr_write_b32 a25, v33
 v_accvgpr_read_b32 v33, a26
 v_mul_f32 v33, v33, v34
 v_accvgpr_write_b32 a26, v33
 v_accvgpr_read_b32 v33, a27
 v_mul_f32 v33, v33, v34
 v_accvgpr_write_b32 a27, v33
 v_accvgpr_read_b32 v33, a28
 v_mul_f32 v33, v33, v34
 v_accvgpr_write_b32 a28, v33
 v_accvgpr_read_b32 v33, a29
 v_mul_f32 v33, v33, v34
 v_accvgpr_write_b32 a29, v33
 v_accvgpr_read_b32 v33, a30
 v_mul_f32 v33, v33, v34
 v_accvgpr_write_b32 a30, v33
 v_accvgpr_read_b32 v33, a31
 v_mul_f32 v33, v33, v34
 v_accvgpr_write_b32 a31, v33
 v_exp_f32 v36, v144
 v_exp_f32 v37, v145
 s_nop 0
 v_cvt_pk_bf16_f32 v208, v36, v37
 v_exp_f32 v36, v146
 v_exp_f32 v37, v147
 s_nop 0
 v_cvt_pk_bf16_f32 v209, v36, v37
 v_exp_f32 v36, v148
 v_exp_f32 v37, v149
 s_nop 0
 v_cvt_pk_bf16_f32 v210, v36, v37
 v_exp_f32 v36, v150
 v_exp_f32 v37, v151
 s_nop 0
 v_cvt_pk_bf16_f32 v211, v36, v37
 v_max3_f32 v32, v152, v153, v154
 v_max3_f32 v32, v155, v156, v32
 v_max3_f32 v32, v157, v158, v32
 v_max_f32 v32, v159, v32
 v_mov_b32 v33, v32
 s_nop 1
 v_permlane16_swap_b32 v32, v33
 s_nop 1
 v_max_f32 v32, v32, v33
 v_mov_b32 v33, v32
 s_nop 1
 v_permlane32_swap_b32 v32, v33
 s_nop 1
 v_max_f32 v32, v32, v33
 v_add_f32 v32, 0x41c00000, v32
 v_max_f32 v32, 0, v32
 v_exp_f32 v34, -v32
 v_sub_f32 v68, v68, v32
 v_sub_f32 v69, v69, v32
 v_sub_f32 v70, v70, v32
 v_sub_f32 v71, v71, v32
 v_sub_f32 v152, v152, v32
 v_sub_f32 v153, v153, v32
 v_sub_f32 v154, v154, v32
 v_sub_f32 v155, v155, v32
 v_sub_f32 v156, v156, v32
 v_sub_f32 v157, v157, v32
 v_sub_f32 v158, v158, v32
 v_sub_f32 v159, v159, v32
 v_sub_f32 v184, v184, v32
 v_sub_f32 v185, v185, v32
 v_sub_f32 v186, v186, v32
 v_sub_f32 v187, v187, v32
 v_sub_f32 v188, v188, v32
 v_sub_f32 v189, v189, v32
 v_sub_f32 v190, v190, v32
 v_sub_f32 v191, v191, v32
 v_mul_f32 v244, v244, v34
 v_mul_f32 v245, v245, v34
 v_mul_f32 v246, v246, v34
 v_mul_f32 v247, v247, v34
 v_accvgpr_read_b32 v33, a32
 v_mul_f32 v33, v33, v34
 v_accvgpr_write_b32 a32, v33
 v_accvgpr_read_b32 v33, a33
 v_mul_f32 v33, v33, v34
 v_accvgpr_write_b32 a33, v33
 v_accvgpr_read_b32 v33, a34
 v_mul_f32 v33, v33, v34
 v_accvgpr_write_b32 a34, v33
 v_accvgpr_read_b32 v33, a35
 v_mul_f32 v33, v33, v34
 v_accvgpr_write_b32 a35, v33
 v_accvgpr_read_b32 v33, a36
 v_mul_f32 v33, v33, v34
 v_accvgpr_write_b32 a36, v33
 v_accvgpr_read_b32 v33, a37
 v_mul_f32 v33, v33, v34
 v_accvgpr_write_b32 a37, v33
 v_accvgpr_read_b32 v33, a38
 v_mul_f32 v33, v33, v34
 v_accvgpr_write_b32 a38, v33
 v_accvgpr_read_b32 v33, a39
 v_mul_f32 v33, v33, v34
 v_accvgpr_write_b32 a39, v33
 v_accvgpr_read_b32 v33, a40
 v_mul_f32 v33, v33, v34
 v_accvgpr_write_b32 a40, v33
 v_accvgpr_read_b32 v33, a41
 v_mul_f32 v33, v33, v34
 v_accvgpr_write_b32 a41, v33
 v_accvgpr_read_b32 v33, a42
 v_mul_f32 v33, v33, v34
 v_accvgpr_write_b32 a42, v33
 v_accvgpr_read_b32 v33, a43
 v_mul_f32 v33, v33, v34
 v_accvgpr_write_b32 a43, v33
 v_accvgpr_read_b32 v33, a44
 v_mul_f32 v33, v33, v34
 v_accvgpr_write_b32 a44, v33
 v_accvgpr_read_b32 v33, a45
 v_mul_f32 v33, v33, v34
 v_accvgpr_write_b32 a45, v33
 v_accvgpr_read_b32 v33, a46
 v_mul_f32 v33, v33, v34
 v_accvgpr_write_b32 a46, v33
 v_accvgpr_read_b32 v33, a47
 v_mul_f32 v33, v33, v34
 v_accvgpr_write_b32 a47, v33
 v_accvgpr_read_b32 v33, a48
 v_mul_f32 v33, v33, v34
 v_accvgpr_write_b32 a48, v33
 v_accvgpr_read_b32 v33, a49
 v_mul_f32 v33, v33, v34
 v_accvgpr_write_b32 a49, v33
 v_accvgpr_read_b32 v33, a50
 v_mul_f32 v33, v33, v34
 v_accvgpr_write_b32 a50, v33
 v_accvgpr_read_b32 v33, a51
 v_mul_f32 v33, v33, v34
 v_accvgpr_write_b32 a51, v33
 v_accvgpr_read_b32 v33, a52
 v_mul_f32 v33, v33, v34
 v_accvgpr_write_b32 a52, v33
 v_accvgpr_read_b32 v33, a53
 v_mul_f32 v33, v33, v34
 v_accvgpr_write_b32 a53, v33
 v_accvgpr_read_b32 v33, a54
 v_mul_f32 v33, v33, v34
 v_accvgpr_write_b32 a54, v33
 v_accvgpr_read_b32 v33, a55
 v_mul_f32 v33, v33, v34
 v_accvgpr_write_b32 a55, v33
 v_accvgpr_read_b32 v33, a56
 v_mul_f32 v33, v33, v34
 v_accvgpr_write_b32 a56, v33
 v_accvgpr_read_b32 v33, a57
 v_mul_f32 v33, v33, v34
 v_accvgpr_write_b32 a57, v33
 v_accvgpr_read_b32 v33, a58
 v_mul_f32 v33, v33, v34
 v_accvgpr_write_b32 a58, v33
 v_accvgpr_read_b32 v33, a59
 v_mul_f32 v33, v33, v34
 v_accvgpr_write_b32 a59, v33
 v_accvgpr_read_b32 v33, a60
 v_mul_f32 v33, v33, v34
 v_accvgpr_write_b32 a60, v33
 v_accvgpr_read_b32 v33, a61
 v_mul_f32 v33, v33, v34
 v_accvgpr_write_b32 a61, v33
 v_accvgpr_read_b32 v33, a62
 v_mul_f32 v33, v33, v34
 v_accvgpr_write_b32 a62, v33
 v_accvgpr_read_b32 v33, a63
 v_mul_f32 v33, v33, v34
 v_accvgpr_write_b32 a63, v33
 v_exp_f32 v36, v152
 v_exp_f32 v37, v153
 s_nop 0
 v_cvt_pk_bf16_f32 v212, v36, v37
 v_exp_f32 v36, v154
 v_exp_f32 v37, v155
 s_nop 0
 v_cvt_pk_bf16_f32 v213, v36, v37
 v_exp_f32 v36, v156
 v_exp_f32 v37, v157
 s_nop 0
 v_cvt_pk_bf16_f32 v214, v36, v37
 v_exp_f32 v36, v158
 v_exp_f32 v37, v159
 s_nop 0
 v_cvt_pk_bf16_f32 v215, v36, v37
 v_max3_f32 v32, v160, v161, v162
 v_max3_f32 v32, v163, v164, v32
 v_max3_f32 v32, v165, v166, v32
 v_max_f32 v32, v167, v32
 v_mov_b32 v33, v32
 s_nop 1
 v_permlane16_swap_b32 v32, v33
 s_nop 1
 v_max_f32 v32, v32, v33
 v_mov_b32 v33, v32
 s_nop 1
 v_permlane32_swap_b32 v32, v33
 s_nop 1
 v_max_f32 v32, v32, v33
 v_add_f32 v32, 0x41c00000, v32
 v_max_f32 v32, 0, v32
 v_exp_f32 v34, -v32
 v_sub_f32 v72, v72, v32
 v_sub_f32 v73, v73, v32
 v_sub_f32 v74, v74, v32
 v_sub_f32 v75, v75, v32
 v_sub_f32 v160, v160, v32
 v_sub_f32 v161, v161, v32
 v_sub_f32 v162, v162, v32
 v_sub_f32 v163, v163, v32
 v_sub_f32 v164, v164, v32
 v_sub_f32 v165, v165, v32
 v_sub_f32 v166, v166, v32
 v_sub_f32 v167, v167, v32
 v_sub_f32 v192, v192, v32
 v_sub_f32 v193, v193, v32
 v_sub_f32 v194, v194, v32
 v_sub_f32 v195, v195, v32
 v_sub_f32 v196, v196, v32
 v_sub_f32 v197, v197, v32
 v_sub_f32 v198, v198, v32
 v_sub_f32 v199, v199, v32
 v_mul_f32 v248, v248, v34
 v_mul_f32 v249, v249, v34
 v_mul_f32 v250, v250, v34
 v_mul_f32 v251, v251, v34
 v_accvgpr_read_b32 v33, a64
 v_mul_f32 v33, v33, v34
 v_accvgpr_write_b32 a64, v33
 v_accvgpr_read_b32 v33, a65
 v_mul_f32 v33, v33, v34
 v_accvgpr_write_b32 a65, v33
 v_accvgpr_read_b32 v33, a66
 v_mul_f32 v33, v33, v34
 v_accvgpr_write_b32 a66, v33
 v_accvgpr_read_b32 v33, a67
 v_mul_f32 v33, v33, v34
 v_accvgpr_write_b32 a67, v33
 v_accvgpr_read_b32 v33, a68
 v_mul_f32 v33, v33, v34
 v_accvgpr_write_b32 a68, v33
 v_accvgpr_read_b32 v33, a69
 v_mul_f32 v33, v33, v34
 v_accvgpr_write_b32 a69, v33
 v_accvgpr_read_b32 v33, a70
 v_mul_f32 v33, v33, v34
 v_accvgpr_write_b32 a70, v33
 v_accvgpr_read_b32 v33, a71
 v_mul_f32 v33, v33, v34
 v_accvgpr_write_b32 a71, v33
 v_accvgpr_read_b32 v33, a72
 v_mul_f32 v33, v33, v34
 v_accvgpr_write_b32 a72, v33
 v_accvgpr_read_b32 v33, a73
 v_mul_f32 v33, v33, v34
 v_accvgpr_write_b32 a73, v33
 v_accvgpr_read_b32 v33, a74
 v_mul_f32 v33, v33, v34
 v_accvgpr_write_b32 a74, v33
 v_accvgpr_read_b32 v33, a75
 v_mul_f32 v33, v33, v34
 v_accvgpr_write_b32 a75, v33
 v_accvgpr_read_b32 v33, a76
 v_mul_f32 v33, v33, v34
 v_accvgpr_write_b32 a76, v33
 v_accvgpr_read_b32 v33, a77
 v_mul_f32 v33, v33, v34
 v_accvgpr_write_b32 a77, v33
 v_accvgpr_read_b32 v33, a78
 v_mul_f32 v33, v33, v34
 v_accvgpr_write_b32 a78, v33
 v_accvgpr_read_b32 v33, a79
 v_mul_f32 v33, v33, v34
 v_accvgpr_write_b32 a79, v33
 v_accvgpr_read_b32 v33, a80
 v_mul_f32 v33, v33, v34
 v_accvgpr_write_b32 a80, v33
 v_accvgpr_read_b32 v33, a81
 v_mul_f32 v33, v33, v34
 v_accvgpr_write_b32 a81, v33
 v_accvgpr_read_b32 v33, a82
 v_mul_f32 v33, v33, v34
 v_accvgpr_write_b32 a82, v33
 v_accvgpr_read_b32 v33, a83
 v_mul_f32 v33, v33, v34
 v_accvgpr_write_b32 a83, v33
 v_accvgpr_read_b32 v33, a84
 v_mul_f32 v33, v33, v34
 v_accvgpr_write_b32 a84, v33
 v_accvgpr_read_b32 v33, a85
 v_mul_f32 v33, v33, v34
 v_accvgpr_write_b32 a85, v33
 v_accvgpr_read_b32 v33, a86
 v_mul_f32 v33, v33, v34
 v_accvgpr_write_b32 a86, v33
 v_accvgpr_read_b32 v33, a87
 v_mul_f32 v33, v33, v34
 v_accvgpr_write_b32 a87, v33
 v_accvgpr_read_b32 v33, a88
 v_mul_f32 v33, v33, v34
 v_accvgpr_write_b32 a88, v33
 v_accvgpr_read_b32 v33, a89
 v_mul_f32 v33, v33, v34
 v_accvgpr_write_b32 a89, v33
 v_accvgpr_read_b32 v33, a90
 v_mul_f32 v33, v33, v34
 v_accvgpr_write_b32 a90, v33
 v_accvgpr_read_b32 v33, a91
 v_mul_f32 v33, v33, v34
 v_accvgpr_write_b32 a91, v33
 v_accvgpr_read_b32 v33, a92
 v_mul_f32 v33, v33, v34
 v_accvgpr_write_b32 a92, v33
 v_accvgpr_read_b32 v33, a93
 v_mul_f32 v33, v33, v34
 v_accvgpr_write_b32 a93, v33
 v_accvgpr_read_b32 v33, a94
 v_mul_f32 v33, v33, v34
 v_accvgpr_write_b32 a94, v33
 v_accvgpr_read_b32 v33, a95
 v_mul_f32 v33, v33, v34
 v_accvgpr_write_b32 a95, v33
 v_exp_f32 v36, v160
 v_exp_f32 v37, v161
 s_nop 0
 v_cvt_pk_bf16_f32 v216, v36, v37
 v_exp_f32 v36, v162
 v_exp_f32 v37, v163
 s_nop 0
 v_cvt_pk_bf16_f32 v217, v36, v37
 v_exp_f32 v36, v164
 v_exp_f32 v37, v165
 s_nop 0
 v_cvt_pk_bf16_f32 v218, v36, v37
 v_exp_f32 v36, v166
 v_exp_f32 v37, v167
 s_nop 0
 v_cvt_pk_bf16_f32 v219, v36, v37
 v_max3_f32 v32, v168, v169, v170
 v_max3_f32 v32, v171, v172, v32
 v_max3_f32 v32, v173, v174, v32
 v_max_f32 v32, v175, v32
 v_mov_b32 v33, v32
 s_nop 1
 v_permlane16_swap_b32 v32, v33
 s_nop 1
 v_max_f32 v32, v32, v33
 v_mov_b32 v33, v32
 s_nop 1
 v_permlane32_swap_b32 v32, v33
 s_nop 1
 v_max_f32 v32, v32, v33
 v_add_f32 v32, 0x41c00000, v32
 v_max_f32 v32, 0, v32
 v_exp_f32 v34, -v32
 v_sub_f32 v76, v76, v32
 v_sub_f32 v77, v77, v32
 v_sub_f32 v78, v78, v32
 v_sub_f32 v79, v79, v32
 v_sub_f32 v168, v168, v32
 v_sub_f32 v169, v169, v32
 v_sub_f32 v170, v170, v32
 v_sub_f32 v171, v171, v32
 v_sub_f32 v172, v172, v32
 v_sub_f32 v173, v173, v32
 v_sub_f32 v174, v174, v32
 v_sub_f32 v175, v175, v32
 v_sub_f32 v200, v200, v32
 v_sub_f32 v201, v201, v32
 v_sub_f32 v202, v202, v32
 v_sub_f32 v203, v203, v32
 v_sub_f32 v204, v204, v32
 v_sub_f32 v205, v205, v32
 v_sub_f32 v206, v206, v32
 v_sub_f32 v207, v207, v32
 v_mul_f32 v252, v252, v34
 v_mul_f32 v253, v253, v34
 v_mul_f32 v254, v254, v34
 v_mul_f32 v255, v255, v34
 v_accvgpr_read_b32 v33, a96
 v_mul_f32 v33, v33, v34
 v_accvgpr_write_b32 a96, v33
 v_accvgpr_read_b32 v33, a97
 v_mul_f32 v33, v33, v34
 v_accvgpr_write_b32 a97, v33
 v_accvgpr_read_b32 v33, a98
 v_mul_f32 v33, v33, v34
 v_accvgpr_write_b32 a98, v33
 v_accvgpr_read_b32 v33, a99
 v_mul_f32 v33, v33, v34
 v_accvgpr_write_b32 a99, v33
 v_accvgpr_read_b32 v33, a100
 v_mul_f32 v33, v33, v34
 v_accvgpr_write_b32 a100, v33
 v_accvgpr_read_b32 v33, a101
 v_mul_f32 v33, v33, v34
 v_accvgpr_write_b32 a101, v33
 v_accvgpr_read_b32 v33, a102
 v_mul_f32 v33, v33, v34
 v_accvgpr_write_b32 a102, v33
 v_accvgpr_read_b32 v33, a103
 v_mul_f32 v33, v33, v34
 v_accvgpr_write_b32 a103, v33
 v_accvgpr_read_b32 v33, a104
 v_mul_f32 v33, v33, v34
 v_accvgpr_write_b32 a104, v33
 v_accvgpr_read_b32 v33, a105
 v_mul_f32 v33, v33, v34
 v_accvgpr_write_b32 a105, v33
 v_accvgpr_read_b32 v33, a106
 v_mul_f32 v33, v33, v34
 v_accvgpr_write_b32 a106, v33
 v_accvgpr_read_b32 v33, a107
 v_mul_f32 v33, v33, v34
 v_accvgpr_write_b32 a107, v33
 v_accvgpr_read_b32 v33, a108
 v_mul_f32 v33, v33, v34
 v_accvgpr_write_b32 a108, v33
 v_accvgpr_read_b32 v33, a109
 v_mul_f32 v33, v33, v34
 v_accvgpr_write_b32 a109, v33
 v_accvgpr_read_b32 v33, a110
 v_mul_f32 v33, v33, v34
 v_accvgpr_write_b32 a110, v33
 v_accvgpr_read_b32 v33, a111
 v_mul_f32 v33, v33, v34
 v_accvgpr_write_b32 a111, v33
 v_accvgpr_read_b32 v33, a112
 v_mul_f32 v33, v33, v34
 v_accvgpr_write_b32 a112, v33
 v_accvgpr_read_b32 v33, a113
 v_mul_f32 v33, v33, v34
 v_accvgpr_write_b32 a113, v33
 v_accvgpr_read_b32 v33, a114
 v_mul_f32 v33, v33, v34
 v_accvgpr_write_b32 a114, v33
 v_accvgpr_read_b32 v33, a115
 v_mul_f32 v33, v33, v34
 v_accvgpr_write_b32 a115, v33
 v_accvgpr_read_b32 v33, a116
 v_mul_f32 v33, v33, v34
 v_accvgpr_write_b32 a116, v33
 v_accvgpr_read_b32 v33, a117
 v_mul_f32 v33, v33, v34
 v_accvgpr_write_b32 a117, v33
 v_accvgpr_read_b32 v33, a118
 v_mul_f32 v33, v33, v34
 v_accvgpr_write_b32 a118, v33
 v_accvgpr_read_b32 v33, a119
 v_mul_f32 v33, v33, v34
 v_accvgpr_write_b32 a119, v33
 v_accvgpr_read_b32 v33, a120
 v_mul_f32 v33, v33, v34
 v_accvgpr_write_b32 a120, v33
 v_accvgpr_read_b32 v33, a121
 v_mul_f32 v33, v33, v34
 v_accvgpr_write_b32 a121, v33
 v_accvgpr_read_b32 v33, a122
 v_mul_f32 v33, v33, v34
 v_accvgpr_write_b32 a122, v33
 v_accvgpr_read_b32 v33, a123
 v_mul_f32 v33, v33, v34
 v_accvgpr_write_b32 a123, v33
 v_accvgpr_read_b32 v33, a124
 v_mul_f32 v33, v33, v34
 v_accvgpr_write_b32 a124, v33
 v_accvgpr_read_b32 v33, a125
 v_mul_f32 v33, v33, v34
 v_accvgpr_write_b32 a125, v33
 v_accvgpr_read_b32 v33, a126
 v_mul_f32 v33, v33, v34
 v_accvgpr_write_b32 a126, v33
 v_accvgpr_read_b32 v33, a127
 v_mul_f32 v33, v33, v34
 v_accvgpr_write_b32 a127, v33
 v_exp_f32 v36, v168
 v_exp_f32 v37, v169
 s_nop 0
 v_cvt_pk_bf16_f32 v220, v36, v37
 v_exp_f32 v36, v170
 v_exp_f32 v37, v171
 s_nop 0
 v_cvt_pk_bf16_f32 v221, v36, v37
 v_exp_f32 v36, v172
 v_exp_f32 v37, v173
 s_nop 0
 v_cvt_pk_bf16_f32 v222, v36, v37
 v_exp_f32 v36, v174
 v_exp_f32 v37, v175
 s_nop 0
 v_cvt_pk_bf16_f32 v223, v36, v37
 s_nop 1
 s_branch L_b4_r0_ret
L_b4_r1:
 s_nop 7
 v_max3_f32 v32, v176, v177, v178
 v_max3_f32 v32, v179, v180, v32
 v_max3_f32 v32, v181, v182, v32
 v_max_f32 v32, v183, v32
 v_mov_b32 v33, v32
 s_nop 1
 v_permlane16_swap_b32 v32, v33
 s_nop 1
 v_max_f32 v32, v32, v33
 v_mov_b32 v33, v32
 s_nop 1
 v_permlane32_swap_b32 v32, v33
 s_nop 1
 v_max_f32 v32, v32, v33
 v_add_f32 v32, 0x41c00000, v32
 v_max_f32 v32, 0, v32
 v_exp_f32 v34, -v32
 v_sub_f32 v64, v64, v32
 v_sub_f32 v65, v65, v32
 v_sub_f32 v66, v66, v32
 v_sub_f32 v67, v67, v32
 v_sub_f32 v176, v176, v32
 v_sub_f32 v177, v177, v32
 v_sub_f32 v178, v178, v32
 v_sub_f32 v179, v179, v32
 v_sub_f32 v180, v180, v32
 v_sub_f32 v181, v181, v32
 v_sub_f32 v182, v182, v32
 v_sub_f32 v183, v183, v32
 v_sub_f32 v144, v144, v32
 v_sub_f32 v145, v145, v32
 v_sub_f32 v146, v146, v32
 v_sub_f32 v147, v147, v32
 v_sub_f32 v148, v148, v32
 v_sub_f32 v149, v149, v32
 v_sub_f32 v150, v150, v32
 v_sub_f32 v151, v151, v32
 v_mul_f32 v240, v240, v34
 v_mul_f32 v241, v241, v34
 v_mul_f32 v242, v242, v34
 v_mul_f32 v243, v243, v34
 v_accvgpr_read_b32 v33, a0
 v_mul_f32 v33, v33, v34
 v_accvgpr_write_b32 a0, v33
 v_accvgpr_read_b32 v33, a1
 v_mul_f32 v33, v33, v34
 v_accvgpr_write_b32 a1, v33
 v_accvgpr_read_b32 v33, a2
 v_mul_f32 v33, v33, v34
 v_accvgpr_write_b32 a2, v33
 v_accvgpr_read_b32 v33, a3
 v_mul_f32 v33, v33, v34
 v_accvgpr_write_b32 a3, v33
 v_accvgpr_read_b32 v33, a4
 v_mul_f32 v33, v33, v34
 v_accvgpr_write_b32 a4, v33
 v_accvgpr_read_b32 v33, a5
 v_mul_f32 v33, v33, v34
 v_accvgpr_write_b32 a5, v33
 v_accvgpr_read_b32 v33, a6
 v_mul_f32 v33, v33, v34
 v_accvgpr_write_b32 a6, v33
 v_accvgpr_read_b32 v33, a7
 v_mul_f32 v33, v33, v34
 v_accvgpr_write_b32 a7, v33
 v_accvgpr_read_b32 v33, a8
 v_mul_f32 v33, v33, v34
 v_accvgpr_write_b32 a8, v33
 v_accvgpr_read_b32 v33, a9
 v_mul_f32 v33, v33, v34
 v_accvgpr_write_b32 a9, v33
 v_accvgpr_read_b32 v33, a10
 v_mul_f32 v33, v33, v34
 v_accvgpr_write_b32 a10, v33
 v_accvgpr_read_b32 v33, a11
 v_mul_f32 v33, v33, v34
 v_accvgpr_write_b32 a11, v33
 v_accvgpr_read_b32 v33, a12
 v_mul_f32 v33, v33, v34
 v_accvgpr_write_b32 a12, v33
 v_accvgpr_read_b32 v33, a13
 v_mul_f32 v33, v33, v34
 v_accvgpr_write_b32 a13, v33
 v_accvgpr_read_b32 v33, a14
 v_mul_f32 v33, v33, v34
 v_accvgpr_write_b32 a14, v33
 v_accvgpr_read_b32 v33, a15
 v_mul_f32 v33, v33, v34
 v_accvgpr_write_b32 a15, v33
 v_accvgpr_read_b32 v33, a16
 v_mul_f32 v33, v33, v34
 v_accvgpr_write_b32 a16, v33
 v_accvgpr_read_b32 v33, a17
 v_mul_f32 v33, v33, v34
 v_accvgpr_write_b32 a17, v33
 v_accvgpr_read_b32 v33, a18
 v_mul_f32 v33, v33, v34
 v_accvgpr_write_b32 a18, v33
 v_accvgpr_read_b32 v33, a19
 v_mul_f32 v33, v33, v34
 v_accvgpr_write_b32 a19, v33
 v_accvgpr_read_b32 v33, a20
 v_mul_f32 v33, v33, v34
 v_accvgpr_write_b32 a20, v33
 v_accvgpr_read_b32 v33, a21
 v_mul_f32 v33, v33, v34
 v_accvgpr_write_b32 a21, v33
 v_accvgpr_read_b32 v33, a22
 v_mul_f32 v33, v33, v34
 v_accvgpr_write_b32 a22, v33
 v_accvgpr_read_b32 v33, a23
 v_mul_f32 v33, v33, v34
 v_accvgpr_write_b32 a23, v33
 v_accvgpr_read_b32 v33, a24
 v_mul_f32 v33, v33, v34
 v_accvgpr_write_b32 a24, v33
 v_accvgpr_read_b32 v33, a25
 v_mul_f32 v33, v33, v34
 v_accvgpr_write_b32 a25, v33
 v_accvgpr_read_b32 v33, a26
 v_mul_f32 v33, v33, v34
 v_accvgpr_write_b32 a26, v33
 v_accvgpr_read_b32 v33, a27
 v_mul_f32 v33, v33, v34
 v_accvgpr_write_b32 a27, v33
 v_accvgpr_read_b32 v33, a28
 v_mul_f32 v33, v33, v34
 v_accvgpr_write_b32 a28, v33
 v_accvgpr_read_b32 v33, a29
 v_mul_f32 v33, v33, v34
 v_accvgpr_write_b32 a29, v33
 v_accvgpr_read_b32 v33, a30
 v_mul_f32 v33, v33, v34
 v_accvgpr_write_b32 a30, v33
 v_accvgpr_read_b32 v33, a31
 v_mul_f32 v33, v33, v34
 v_accvgpr_write_b32 a31, v33
 v_exp_f32 v36, v176
 v_exp_f32 v37, v177
 s_nop 0
 v_cvt_pk_bf16_f32 v224, v36, v37
 v_exp_f32 v36, v178
 v_exp_f32 v37, v179
 s_nop 0
 v_cvt_pk_bf16_f32 v225, v36, v37
 v_exp_f32 v36, v180
 v_exp_f32 v37, v181
 s_nop 0
 v_cvt_pk_bf16_f32 v226, v36, v37
 v_exp_f32 v36, v182
 v_exp_f32 v37, v183
 s_nop 0
 v_cvt_pk_bf16_f32 v227, v36, v37
 v_max3_f32 v32, v184, v185, v186
 v_max3_f32 v32, v187, v188, v32
 v_max3_f32 v32, v189, v190, v32
 v_max_f32 v32, v191, v32
 v_mov_b32 v33, v32
 s_nop 1
 v_permlane16_swap_b32 v32, v33
 s_nop 1
 v_max_f32 v32, v32, v33
 v_mov_b32 v33, v32
 s_nop 1
 v_permlane32_swap_b32 v32, v33
 s_nop 1
 v_max_f32 v32, v32, v33
 v_add_f32 v32, 0x41c00000, v32
 v_max_f32 v32, 0, v32
 v_exp_f32 v34, -v32
 v_sub_f32 v68, v68, v32
 v_sub_f32 v69, v69, v32
 v_sub_f32 v70, v70, v32
 v_sub_f32 v71, v71, v32
 v_sub_f32 v184, v184, v32
 v_sub_f32 v185, v185, v32
 v_sub_f32 v186, v186, v32
 v_sub_f32 v187, v187, v32
 v_sub_f32 v188, v188, v32
 v_sub_f32 v189, v189, v32
 v_sub_f32 v190, v190, v32
 v_sub_f32 v191, v191, v32
 v_sub_f32 v152, v152, v32
 v_sub_f32 v153, v153, v32
 v_sub_f32 v154, v154, v32
 v_sub_f32 v155, v155, v32
 v_sub_f32 v156, v156, v32
 v_sub_f32 v157, v157, v32
 v_sub_f32 v158, v158, v32
 v_sub_f32 v159, v159, v32
 v_mul_f32 v244, v244, v34
 v_mul_f32 v245, v245, v34
 v_mul_f32 v246, v246, v34
 v_mul_f32 v247, v247, v34
 v_accvgpr_read_b32 v33, a32
 v_mul_f32 v33, v33, v34
 v_accvgpr_write_b32 a32, v33
 v_accvgpr_read_b32 v33, a33
 v_mul_f32 v33, v33, v34
 v_accvgpr_write_b32 a33, v33
 v_accvgpr_read_b32 v33, a34
 v_mul_f32 v33, v33, v34
 v_accvgpr_write_b32 a34, v33
 v_accvgpr_read_b32 v33, a35
 v_mul_f32 v33, v33, v34
 v_accvgpr_write_b32 a35, v33
 v_accvgpr_read_b32 v33, a36
 v_mul_f32 v33, v33, v34
 v_accvgpr_write_b32 a36, v33
 v_accvgpr_read_b32 v33, a37
 v_mul_f32 v33, v33, v34
 v_accvgpr_write_b32 a37, v33
 v_accvgpr_read_b32 v33, a38
 v_mul_f32 v33, v33, v34
 v_accvgpr_write_b32 a38, v33
 v_accvgpr_read_b32 v33, a39
 v_mul_f32 v33, v33, v34
 v_accvgpr_write_b32 a39, v33
 v_accvgpr_read_b32 v33, a40
 v_mul_f32 v33, v33, v34
 v_accvgpr_write_b32 a40, v33
 v_accvgpr_read_b32 v33, a41
 v_mul_f32 v33, v33, v34
 v_accvgpr_write_b32 a41, v33
 v_accvgpr_read_b32 v33, a42
 v_mul_f32 v33, v33, v34
 v_accvgpr_write_b32 a42, v33
 v_accvgpr_read_b32 v33, a43
 v_mul_f32 v33, v33, v34
 v_accvgpr_write_b32 a43, v33
 v_accvgpr_read_b32 v33, a44
 v_mul_f32 v33, v33, v34
 v_accvgpr_write_b32 a44, v33
 v_accvgpr_read_b32 v33, a45
 v_mul_f32 v33, v33, v34
 v_accvgpr_write_b32 a45, v33
 v_accvgpr_read_b32 v33, a46
 v_mul_f32 v33, v33, v34
 v_accvgpr_write_b32 a46, v33
 v_accvgpr_read_b32 v33, a47
 v_mul_f32 v33, v33, v34
 v_accvgpr_write_b32 a47, v33
 v_accvgpr_read_b32 v33, a48
 v_mul_f32 v33, v33, v34
 v_accvgpr_write_b32 a48, v33
 v_accvgpr_read_b32 v33, a49
 v_mul_f32 v33, v33, v34
 v_accvgpr_write_b32 a49, v33
 v_accvgpr_read_b32 v33, a50
 v_mul_f32 v33, v33, v34
 v_accvgpr_write_b32 a50, v33
 v_accvgpr_read_b32 v33, a51
 v_mul_f32 v33, v33, v34
 v_accvgpr_write_b32 a51, v33
 v_accvgpr_read_b32 v33, a52
 v_mul_f32 v33, v33, v34
 v_accvgpr_write_b32 a52, v33
 v_accvgpr_read_b32 v33, a53
 v_mul_f32 v33, v33, v34
 v_accvgpr_write_b32 a53, v33
 v_accvgpr_read_b32 v33, a54
 v_mul_f32 v33, v33, v34
 v_accvgpr_write_b32 a54, v33
 v_accvgpr_read_b32 v33, a55
 v_mul_f32 v33, v33, v34
 v_accvgpr_write_b32 a55, v33
 v_accvgpr_read_b32 v33, a56
 v_mul_f32 v33, v33, v34
 v_accvgpr_write_b32 a56, v33
 v_accvgpr_read_b32 v33, a57
 v_mul_f32 v33, v33, v34
 v_accvgpr_write_b32 a57, v33
 v_accvgpr_read_b32 v33, a58
 v_mul_f32 v33, v33, v34
 v_accvgpr_write_b32 a58, v33
 v_accvgpr_read_b32 v33, a59
 v_mul_f32 v33, v33, v34
 v_accvgpr_write_b32 a59, v33
 v_accvgpr_read_b32 v33, a60
 v_mul_f32 v33, v33, v34
 v_accvgpr_write_b32 a60, v33
 v_accvgpr_read_b32 v33, a61
 v_mul_f32 v33, v33, v34
 v_accvgpr_write_b32 a61, v33
 v_accvgpr_read_b32 v33, a62
 v_mul_f32 v33, v33, v34
 v_accvgpr_write_b32 a62, v33
 v_accvgpr_read_b32 v33, a63
 v_mul_f32 v33, v33, v34
 v_accvgpr_write_b32 a63, v33
 v_exp_f32 v36, v184
 v_exp_f32 v37, v185
 s_nop 0
 v_cvt_pk_bf16_f32 v228, v36, v37
 v_exp_f32 v36, v186
 v_exp_f32 v37, v187
 s_nop 0
 v_cvt_pk_bf16_f32 v229, v36, v37
 v_exp_f32 v36, v188
 v_exp_f32 v37, v189
 s_nop 0
 v_cvt_pk_bf16_f32 v230, v36, v37
 v_exp_f32 v36, v190
 v_exp_f32 v37, v191
 s_nop 0
 v_cvt_pk_bf16_f32 v231, v36, v37
 v_max3_f32 v32, v192, v193, v194
 v_max3_f32 v32, v195, v196, v32
 v_max3_f32 v32, v197, v198, v32
 v_max_f32 v32, v199, v32
 v_mov_b32 v33, v32
 s_nop 1
 v_permlane16_swap_b32 v32, v33
 s_nop 1
 v_max_f32 v32, v32, v33
 v_mov_b32 v33, v32
 s_nop 1
 v_permlane32_swap_b32 v32, v33
 s_nop 1
 v_max_f32 v32, v32, v33
 v_add_f32 v32, 0x41c00000, v32
 v_max_f32 v32, 0, v32
 v_exp_f32 v34, -v32
 v_sub_f32 v72, v72, v32
 v_sub_f32 v73, v73, v32
 v_sub_f32 v74, v74, v32
 v_sub_f32 v75, v75, v32
 v_sub_f32 v192, v192, v32
 v_sub_f32 v193, v193, v32
 v_sub_f32 v194, v194, v32
 v_sub_f32 v195, v195, v32
 v_sub_f32 v196, v196, v32
 v_sub_f32 v197, v197, v32
 v_sub_f32 v198, v198, v32
 v_sub_f32 v199, v199, v32
 v_sub_f32 v160, v160, v32
 v_sub_f32 v161, v161, v32
 v_sub_f32 v162, v162, v32
 v_sub_f32 v163, v163, v32
 v_sub_f32 v164, v164, v32
 v_sub_f32 v165, v165, v32
 v_sub_f32 v166, v166, v32
 v_sub_f32 v167, v167, v32
 v_mul_f32 v248, v248, v34
 v_mul_f32 v249, v249, v34
 v_mul_f32 v250, v250, v34
 v_mul_f32 v251, v251, v34
 v_accvgpr_read_b32 v33, a64
 v_mul_f32 v33, v33, v34
 v_accvgpr_write_b32 a64, v33
 v_accvgpr_read_b32 v33, a65
 v_mul_f32 v33, v33, v34
 v_accvgpr_write_b32 a65, v33
 v_accvgpr_read_b32 v33, a66
 v_mul_f32 v33, v33, v34
 v_accvgpr_write_b32 a66, v33
 v_accvgpr_read_b32 v33, a67
 v_mul_f32 v33, v33, v34
 v_accvgpr_write_b32 a67, v33
 v_accvgpr_read_b32 v33, a68
 v_mul_f32 v33, v33, v34
 v_accvgpr_write_b32 a68, v33
 v_accvgpr_read_b32 v33, a69
 v_mul_f32 v33, v33, v34
 v_accvgpr_write_b32 a69, v33
 v_accvgpr_read_b32 v33, a70
 v_mul_f32 v33, v33, v34
 v_accvgpr_write_b32 a70, v33
 v_accvgpr_read_b32 v33, a71
 v_mul_f32 v33, v33, v34
 v_accvgpr_write_b32 a71, v33
 v_accvgpr_read_b32 v33, a72
 v_mul_f32 v33, v33, v34
 v_accvgpr_write_b32 a72, v33
 v_accvgpr_read_b32 v33, a73
 v_mul_f32 v33, v33, v34
 v_accvgpr_write_b32 a73, v33
 v_accvgpr_read_b32 v33, a74
 v_mul_f32 v33, v33, v34
 v_accvgpr_write_b32 a74, v33
 v_accvgpr_read_b32 v33, a75
 v_mul_f32 v33, v33, v34
 v_accvgpr_write_b32 a75, v33
 v_accvgpr_read_b32 v33, a76
 v_mul_f32 v33, v33, v34
 v_accvgpr_write_b32 a76, v33
 v_accvgpr_read_b32 v33, a77
 v_mul_f32 v33, v33, v34
 v_accvgpr_write_b32 a77, v33
 v_accvgpr_read_b32 v33, a78
 v_mul_f32 v33, v33, v34
 v_accvgpr_write_b32 a78, v33
 v_accvgpr_read_b32 v33, a79
 v_mul_f32 v33, v33, v34
 v_accvgpr_write_b32 a79, v33
 v_accvgpr_read_b32 v33, a80
 v_mul_f32 v33, v33, v34
 v_accvgpr_write_b32 a80, v33
 v_accvgpr_read_b32 v33, a81
 v_mul_f32 v33, v33, v34
 v_accvgpr_write_b32 a81, v33
 v_accvgpr_read_b32 v33, a82
 v_mul_f32 v33, v33, v34
 v_accvgpr_write_b32 a82, v33
 v_accvgpr_read_b32 v33, a83
 v_mul_f32 v33, v33, v34
 v_accvgpr_write_b32 a83, v33
 v_accvgpr_read_b32 v33, a84
 v_mul_f32 v33, v33, v34
 v_accvgpr_write_b32 a84, v33
 v_accvgpr_read_b32 v33, a85
 v_mul_f32 v33, v33, v34
 v_accvgpr_write_b32 a85, v33
 v_accvgpr_read_b32 v33, a86
 v_mul_f32 v33, v33, v34
 v_accvgpr_write_b32 a86, v33
 v_accvgpr_read_b32 v33, a87
 v_mul_f32 v33, v33, v34
 v_accvgpr_write_b32 a87, v33
 v_accvgpr_read_b32 v33, a88
 v_mul_f32 v33, v33, v34
 v_accvgpr_write_b32 a88, v33
 v_accvgpr_read_b32 v33, a89
 v_mul_f32 v33, v33, v34
 v_accvgpr_write_b32 a89, v33
 v_accvgpr_read_b32 v33, a90
 v_mul_f32 v33, v33, v34
 v_accvgpr_write_b32 a90, v33
 v_accvgpr_read_b32 v33, a91
 v_mul_f32 v33, v33, v34
 v_accvgpr_write_b32 a91, v33
 v_accvgpr_read_b32 v33, a92
 v_mul_f32 v33, v33, v34
 v_accvgpr_write_b32 a92, v33
 v_accvgpr_read_b32 v33, a93
 v_mul_f32 v33, v33, v34
 v_accvgpr_write_b32 a93, v33
 v_accvgpr_read_b32 v33, a94
 v_mul_f32 v33, v33, v34
 v_accvgpr_write_b32 a94, v33
 v_accvgpr_read_b32 v33, a95
 v_mul_f32 v33, v33, v34
 v_accvgpr_write_b32 a95, v33
 v_exp_f32 v36, v192
 v_exp_f32 v37, v193
 s_nop 0
 v_cvt_pk_bf16_f32 v232, v36, v37
 v_exp_f32 v36, v194
 v_exp_f32 v37, v195
 s_nop 0
 v_cvt_pk_bf16_f32 v233, v36, v37
 v_exp_f32 v36, v196
 v_exp_f32 v37, v197
 s_nop 0
 v_cvt_pk_bf16_f32 v234, v36, v37
 v_exp_f32 v36, v198
 v_exp_f32 v37, v199
 s_nop 0
 v_cvt_pk_bf16_f32 v235, v36, v37
 v_max3_f32 v32, v200, v201, v202
 v_max3_f32 v32, v203, v204, v32
 v_max3_f32 v32, v205, v206, v32
 v_max_f32 v32, v207, v32
 v_mov_b32 v33, v32
 s_nop 1
 v_permlane16_swap_b32 v32, v33
 s_nop 1
 v_max_f32 v32, v32, v33
 v_mov_b32 v33, v32
 s_nop 1
 v_permlane32_swap_b32 v32, v33
 s_nop 1
 v_max_f32 v32, v32, v33
 v_add_f32 v32, 0x41c00000, v32
 v_max_f32 v32, 0, v32
 v_exp_f32 v34, -v32
 v_sub_f32 v76, v76, v32
 v_sub_f32 v77, v77, v32
 v_sub_f32 v78, v78, v32
 v_sub_f32 v79, v79, v32
 v_sub_f32 v200, v200, v32
 v_sub_f32 v201, v201, v32
 v_sub_f32 v202, v202, v32
 v_sub_f32 v203, v203, v32
 v_sub_f32 v204, v204, v32
 v_sub_f32 v205, v205, v32
 v_sub_f32 v206, v206, v32
 v_sub_f32 v207, v207, v32
 v_sub_f32 v168, v168, v32
 v_sub_f32 v169, v169, v32
 v_sub_f32 v170, v170, v32
 v_sub_f32 v171, v171, v32
 v_sub_f32 v172, v172, v32
 v_sub_f32 v173, v173, v32
 v_sub_f32 v174, v174, v32
 v_sub_f32 v175, v175, v32
 v_mul_f32 v252, v252, v34
 v_mul_f32 v253, v253, v34
 v_mul_f32 v254, v254, v34
 v_mul_f32 v255, v255, v34
 v_accvgpr_read_b32 v33, a96
 v_mul_f32 v33, v33, v34
 v_accvgpr_write_b32 a96, v33
 v_accvgpr_read_b32 v33, a97
 v_mul_f32 v33, v33, v34
 v_accvgpr_write_b32 a97, v33
 v_accvgpr_read_b32 v33, a98
 v_mul_f32 v33, v33, v34
 v_accvgpr_write_b32 a98, v33
 v_accvgpr_read_b32 v33, a99
 v_mul_f32 v33, v33, v34
 v_accvgpr_write_b32 a99, v33
 v_accvgpr_read_b32 v33, a100
 v_mul_f32 v33, v33, v34
 v_accvgpr_write_b32 a100, v33
 v_accvgpr_read_b32 v33, a101
 v_mul_f32 v33, v33, v34
 v_accvgpr_write_b32 a101, v33
 v_accvgpr_read_b32 v33, a102
 v_mul_f32 v33, v33, v34
 v_accvgpr_write_b32 a102, v33
 v_accvgpr_read_b32 v33, a103
 v_mul_f32 v33, v33, v34
 v_accvgpr_write_b32 a103, v33
 v_accvgpr_read_b32 v33, a104
 v_mul_f32 v33, v33, v34
 v_accvgpr_write_b32 a104, v33
 v_accvgpr_read_b32 v33, a105
 v_mul_f32 v33, v33, v34
 v_accvgpr_write_b32 a105, v33
 v_accvgpr_read_b32 v33, a106
 v_mul_f32 v33, v33, v34
 v_accvgpr_write_b32 a106, v33
 v_accvgpr_read_b32 v33, a107
 v_mul_f32 v33, v33, v34
 v_accvgpr_write_b32 a107, v33
 v_accvgpr_read_b32 v33, a108
 v_mul_f32 v33, v33, v34
 v_accvgpr_write_b32 a108, v33
 v_accvgpr_read_b32 v33, a109
 v_mul_f32 v33, v33, v34
 v_accvgpr_write_b32 a109, v33
 v_accvgpr_read_b32 v33, a110
 v_mul_f32 v33, v33, v34
 v_accvgpr_write_b32 a110, v33
 v_accvgpr_read_b32 v33, a111
 v_mul_f32 v33, v33, v34
 v_accvgpr_write_b32 a111, v33
 v_accvgpr_read_b32 v33, a112
 v_mul_f32 v33, v33, v34
 v_accvgpr_write_b32 a112, v33
 v_accvgpr_read_b32 v33, a113
 v_mul_f32 v33, v33, v34
 v_accvgpr_write_b32 a113, v33
 v_accvgpr_read_b32 v33, a114
 v_mul_f32 v33, v33, v34
 v_accvgpr_write_b32 a114, v33
 v_accvgpr_read_b32 v33, a115
 v_mul_f32 v33, v33, v34
 v_accvgpr_write_b32 a115, v33
 v_accvgpr_read_b32 v33, a116
 v_mul_f32 v33, v33, v34
 v_accvgpr_write_b32 a116, v33
 v_accvgpr_read_b32 v33, a117
 v_mul_f32 v33, v33, v34
 v_accvgpr_write_b32 a117, v33
 v_accvgpr_read_b32 v33, a118
 v_mul_f32 v33, v33, v34
 v_accvgpr_write_b32 a118, v33
 v_accvgpr_read_b32 v33, a119
 v_mul_f32 v33, v33, v34
 v_accvgpr_write_b32 a119, v33
 v_accvgpr_read_b32 v33, a120
 v_mul_f32 v33, v33, v34
 v_accvgpr_write_b32 a120, v33
 v_accvgpr_read_b32 v33, a121
 v_mul_f32 v33, v33, v34
 v_accvgpr_write_b32 a121, v33
 v_accvgpr_read_b32 v33, a122
 v_mul_f32 v33, v33, v34
 v_accvgpr_write_b32 a122, v33
 v_accvgpr_read_b32 v33, a123
 v_mul_f32 v33, v33, v34
 v_accvgpr_write_b32 a123, v33
 v_accvgpr_read_b32 v33, a124
 v_mul_f32 v33, v33, v34
 v_accvgpr_write_b32 a124, v33
 v_accvgpr_read_b32 v33, a125
 v_mul_f32 v33, v33, v34
 v_accvgpr_write_b32 a125, v33
 v_accvgpr_read_b32 v33, a126
 v_mul_f32 v33, v33, v34
 v_accvgpr_write_b32 a126, v33
 v_accvgpr_read_b32 v33, a127
 v_mul_f32 v33, v33, v34
 v_accvgpr_write_b32 a127, v33
 v_exp_f32 v36, v200
 v_exp_f32 v37, v201
 s_nop 0
 v_cvt_pk_bf16_f32 v236, v36, v37
 v_exp_f32 v36, v202
 v_exp_f32 v37, v203
 s_nop 0
 v_cvt_pk_bf16_f32 v237, v36, v37
 v_exp_f32 v36, v204
 v_exp_f32 v37, v205
 s_nop 0
 v_cvt_pk_bf16_f32 v238, v36, v37
 v_exp_f32 v36, v206
 v_exp_f32 v37, v207
 s_nop 0
 v_cvt_pk_bf16_f32 v239, v36, v37
 s_nop 1
 s_branch L_b4_r1_ret
L_b4e_r0:
 s_nop 7
 v_max3_f32 v32, v144, v145, v146
 v_max3_f32 v32, v147, v148, v32
 v_max3_f32 v32, v149, v150, v32
 v_max_f32 v32, v151, v32
 v_mov_b32 v33, v32
 s_nop 1
 v_permlane16_swap_b32 v32, v33
 s_nop 1
 v_max_f32 v32, v32, v33
 v_mov_b32 v33, v32
 s_nop 1
 v_permlane32_swap_b32 v32, v33
 s_nop 1
 v_max_f32 v32, v32, v33
 v_add_f32 v32, 0x41c00000, v32
 v_max_f32 v32, 0, v32
 v_exp_f32 v34, -v32
 v_sub_f32 v64, v64, v32
 v_sub_f32 v65, v65, v32
 v_sub_f32 v66, v66, v32
 v_sub_f32 v67, v67, v32
 v_sub_f32 v144, v144, v32
 v_sub_f32 v145, v145, v32
 v_sub_f32 v146, v146, v32
 v_sub_f32 v147, v147, v32
 v_sub_f32 v148, v148, v32
 v_sub_f32 v149, v149, v32
 v_sub_f32 v150, v150, v32
 v_sub_f32 v151, v151, v32
 v_sub_f32 v176, v176, v32
 v_sub_f32 v177, v177, v32
 v_sub_f32 v178, v178, v32
 v_sub_f32 v179, v179, v32
 v_sub_f32 v180, v180, v32
 v_sub_f32 v181, v181, v32
 v_sub_f32 v182, v182, v32
 v_sub_f32 v183, v183, v32
 v_mul_f32 v240, v240, v34
 v_mul_f32 v241, v241, v34
 v_mul_f32 v242, v242, v34
 v_mul_f32 v243, v243, v34
 v_accvgpr_read_b32 v33, a0
 v_mul_f32 v33, v33, v34
 v_accvgpr_write_b32 a0, v33
 v_accvgpr_read_b32 v33, a1
 v_mul_f32 v33, v33, v34
 v_accvgpr_write_b32 a1, v33
 v_accvgpr_read_b32 v33, a2
 v_mul_f32 v33, v33, v34
 v_accvgpr_write_b32 a2, v33
 v_accvgpr_read_b32 v33, a3
 v_mul_f32 v33, v33, v34
 v_accvgpr_write_b32 a3, v33
 v_accvgpr_read_b32 v33, a4
 v_mul_f32 v33, v33, v34
 v_accvgpr_write_b32 a4, v33
 v_accvgpr_read_b32 v33, a5
 v_mul_f32 v33, v33, v34
 v_accvgpr_write_b32 a5, v33
 v_accvgpr_read_b32 v33, a6
 v_mul_f32 v33, v33, v34
 v_accvgpr_write_b32 a6, v33
 v_accvgpr_read_b32 v33, a7
 v_mul_f32 v33, v33, v34
 v_accvgpr_write_b32 a7, v33
 v_accvgpr_read_b32 v33, a8
 v_mul_f32 v33, v33, v34
 v_accvgpr_write_b32 a8, v33
 v_accvgpr_read_b32 v33, a9
 v_mul_f32 v33, v33, v34
 v_accvgpr_write_b32 a9, v33
 v_accvgpr_read_b32 v33, a10
 v_mul_f32 v33, v33, v34
 v_accvgpr_write_b32 a10, v33
 v_accvgpr_read_b32 v33, a11
 v_mul_f32 v33, v33, v34
 v_accvgpr_write_b32 a11, v33
 v_accvgpr_read_b32 v33, a12
 v_mul_f32 v33, v33, v34
 v_accvgpr_write_b32 a12, v33
 v_accvgpr_read_b32 v33, a13
 v_mul_f32 v33, v33, v34
 v_accvgpr_write_b32 a13, v33
 v_accvgpr_read_b32 v33, a14
 v_mul_f32 v33, v33, v34
 v_accvgpr_write_b32 a14, v33
 v_accvgpr_read_b32 v33, a15
 v_mul_f32 v33, v33, v34
 v_accvgpr_write_b32 a15, v33
 v_accvgpr_read_b32 v33, a16
 v_mul_f32 v33, v33, v34
 v_accvgpr_write_b32 a16, v33
 v_accvgpr_read_b32 v33, a17
 v_mul_f32 v33, v33, v34
 v_accvgpr_write_b32 a17, v33
 v_accvgpr_read_b32 v33, a18
 v_mul_f32 v33, v33, v34
 v_accvgpr_write_b32 a18, v33
 v_accvgpr_read_b32 v33, a19
 v_mul_f32 v33, v33, v34
 v_accvgpr_write_b32 a19, v33
 v_accvgpr_read_b32 v33, a20
 v_mul_f32 v33, v33, v34
 v_accvgpr_write_b32 a20, v33
 v_accvgpr_read_b32 v33, a21
 v_mul_f32 v33, v33, v34
 v_accvgpr_write_b32 a21, v33
 v_accvgpr_read_b32 v33, a22
 v_mul_f32 v33, v33, v34
 v_accvgpr_write_b32 a22, v33
 v_accvgpr_read_b32 v33, a23
 v_mul_f32 v33, v33, v34
 v_accvgpr_write_b32 a23, v33
 v_accvgpr_read_b32 v33, a24
 v_mul_f32 v33, v33, v34
 v_accvgpr_write_b32 a24, v33
 v_accvgpr_read_b32 v33, a25
 v_mul_f32 v33, v33, v34
 v_accvgpr_write_b32 a25, v33
 v_accvgpr_read_b32 v33, a26
 v_mul_f32 v33, v33, v34
 v_accvgpr_write_b32 a26, v33
 v_accvgpr_read_b32 v33, a27
 v_mul_f32 v33, v33, v34
 v_accvgpr_write_b32 a27, v33
 v_accvgpr_read_b32 v33, a28
 v_mul_f32 v33, v33, v34
 v_accvgpr_write_b32 a28, v33
 v_accvgpr_read_b32 v33, a29
 v_mul_f32 v33, v33, v34
 v_accvgpr_write_b32 a29, v33
 v_accvgpr_read_b32 v33, a30
 v_mul_f32 v33, v33, v34
 v_accvgpr_write_b32 a30, v33
 v_accvgpr_read_b32 v33, a31
 v_mul_f32 v33, v33, v34
 v_accvgpr_write_b32 a31, v33
 v_exp_f32 v36, v144
 v_exp_f32 v37, v145
 s_nop 0
 v_cvt_pk_bf16_f32 v208, v36, v37
 v_exp_f32 v36, v146
 v_exp_f32 v37, v147
 s_nop 0
 v_cvt_pk_bf16_f32 v209, v36, v37
 v_exp_f32 v36, v148
 v_exp_f32 v37, v149
 s_nop 0
 v_cvt_pk_bf16_f32 v210, v36, v37
 v_exp_f32 v36, v150
 v_exp_f32 v37, v151
 s_nop 0
 v_cvt_pk_bf16_f32 v211, v36, v37
 v_max3_f32 v32, v152, v153, v154
 v_max3_f32 v32, v155, v156, v32
 v_max3_f32 v32, v157, v158, v32
 v_max_f32 v32, v159, v32
 v_mov_b32 v33, v32
 s_nop 1
 v_permlane16_swap_b32 v32, v33
 s_nop 1
 v_max_f32 v32, v32, v33
 v_mov_b32 v33, v32
 s_nop 1
 v_permlane32_swap_b32 v32, v33
 s_nop 1
 v_max_f32 v32, v32, v33
 v_add_f32 v32, 0x41c00000, v32
 v_max_f32 v32, 0, v32
 v_exp_f32 v34, -v32
 v_sub_f32 v68, v68, v32
 v_sub_f32 v69, v69, v32
 v_sub_f32 v70, v70, v32
 v_sub_f32 v71, v71, v32
 v_sub_f32 v152, v152, v32
 v_sub_f32 v153, v153, v32
 v_sub_f32 v154, v154, v32
 v_sub_f32 v155, v155, v32
 v_sub_f32 v156, v156, v32
 v_sub_f32 v157, v157, v32
 v_sub_f32 v158, v158, v32
 v_sub_f32 v159, v159, v32
 v_sub_f32 v184, v184, v32
 v_sub_f32 v185, v185, v32
 v_sub_f32 v186, v186, v32
 v_sub_f32 v187, v187, v32
 v_sub_f32 v188, v188, v32
 v_sub_f32 v189, v189, v32
 v_sub_f32 v190, v190, v32
 v_sub_f32 v191, v191, v32
 v_mul_f32 v244, v244, v34
 v_mul_f32 v245, v245, v34
 v_mul_f32 v246, v246, v34
 v_mul_f32 v247, v247, v34
 v_accvgpr_read_b32 v33, a32
 v_mul_f32 v33, v33, v34
 v_accvgpr_write_b32 a32, v33
 v_accvgpr_read_b32 v33, a33
 v_mul_f32 v33, v33, v34
 v_accvgpr_write_b32 a33, v33
 v_accvgpr_read_b32 v33, a34
 v_mul_f32 v33, v33, v34
 v_accvgpr_write_b32 a34, v33
 v_accvgpr_read_b32 v33, a35
 v_mul_f32 v33, v33, v34
 v_accvgpr_write_b32 a35, v33
 v_accvgpr_read_b32 v33, a36
 v_mul_f32 v33, v33, v34
 v_accvgpr_write_b32 a36, v33
 v_accvgpr_read_b32 v33, a37
 v_mul_f32 v33, v33, v34
 v_accvgpr_write_b32 a37, v33
 v_accvgpr_read_b32 v33, a38
 v_mul_f32 v33, v33, v34
 v_accvgpr_write_b32 a38, v33
 v_accvgpr_read_b32 v33, a39
 v_mul_f32 v33, v33, v34
 v_accvgpr_write_b32 a39, v33
 v_accvgpr_read_b32 v33, a40
 v_mul_f32 v33, v33, v34
 v_accvgpr_write_b32 a40, v33
 v_accvgpr_read_b32 v33, a41
 v_mul_f32 v33, v33, v34
 v_accvgpr_write_b32 a41, v33
 v_accvgpr_read_b32 v33, a42
 v_mul_f32 v33, v33, v34
 v_accvgpr_write_b32 a42, v33
 v_accvgpr_read_b32 v33, a43
 v_mul_f32 v33, v33, v34
 v_accvgpr_write_b32 a43, v33
 v_accvgpr_read_b32 v33, a44
 v_mul_f32 v33, v33, v34
 v_accvgpr_write_b32 a44, v33
 v_accvgpr_read_b32 v33, a45
 v_mul_f32 v33, v33, v34
 v_accvgpr_write_b32 a45, v33
 v_accvgpr_read_b32 v33, a46
 v_mul_f32 v33, v33, v34
 v_accvgpr_write_b32 a46, v33
 v_accvgpr_read_b32 v33, a47
 v_mul_f32 v33, v33, v34
 v_accvgpr_write_b32 a47, v33
 v_accvgpr_read_b32 v33, a48
 v_mul_f32 v33, v33, v34
 v_accvgpr_write_b32 a48, v33
 v_accvgpr_read_b32 v33, a49
 v_mul_f32 v33, v33, v34
 v_accvgpr_write_b32 a49, v33
 v_accvgpr_read_b32 v33, a50
 v_mul_f32 v33, v33, v34
 v_accvgpr_write_b32 a50, v33
 v_accvgpr_read_b32 v33, a51
 v_mul_f32 v33, v33, v34
 v_accvgpr_write_b32 a51, v33
 v_accvgpr_read_b32 v33, a52
 v_mul_f32 v33, v33, v34
 v_accvgpr_write_b32 a52, v33
 v_accvgpr_read_b32 v33, a53
 v_mul_f32 v33, v33, v34
 v_accvgpr_write_b32 a53, v33
 v_accvgpr_read_b32 v33, a54
 v_mul_f32 v33, v33, v34
 v_accvgpr_write_b32 a54, v33
 v_accvgpr_read_b32 v33, a55
 v_mul_f32 v33, v33, v34
 v_accvgpr_write_b32 a55, v33
 v_accvgpr_read_b32 v33, a56
 v_mul_f32 v33, v33, v34
 v_accvgpr_write_b32 a56, v33
 v_accvgpr_read_b32 v33, a57
 v_mul_f32 v33, v33, v34
 v_accvgpr_write_b32 a57, v33
 v_accvgpr_read_b32 v33, a58
 v_mul_f32 v33, v33, v34
 v_accvgpr_write_b32 a58, v33
 v_accvgpr_read_b32 v33, a59
 v_mul_f32 v33, v33, v34
 v_accvgpr_write_b32 a59, v33
 v_accvgpr_read_b32 v33, a60
 v_mul_f32 v33, v33, v34
 v_accvgpr_write_b32 a60, v33
 v_accvgpr_read_b32 v33, a61
 v_mul_f32 v33, v33, v34
 v_accvgpr_write_b32 a61, v33
 v_accvgpr_read_b32 v33, a62
 v_mul_f32 v33, v33, v34
 v_accvgpr_write_b32 a62, v33
 v_accvgpr_read_b32 v33, a63
 v_mul_f32 v33, v33, v34
 v_accvgpr_write_b32 a63, v33
 v_exp_f32 v36, v152
 v_exp_f32 v37, v153
 s_nop 0
 v_cvt_pk_bf16_f32 v212, v36, v37
 v_exp_f32 v36, v154
 v_exp_f32 v37, v155
 s_nop 0
 v_cvt_pk_bf16_f32 v213, v36, v37
 v_exp_f32 v36, v156
 v_exp_f32 v37, v157
 s_nop 0
 v_cvt_pk_bf16_f32 v214, v36, v37
 v_exp_f32 v36, v158
 v_exp_f32 v37, v159
 s_nop 0
 v_cvt_pk_bf16_f32 v215, v36, v37
 v_max3_f32 v32, v160, v161, v162
 v_max3_f32 v32, v163, v164, v32
 v_max3_f32 v32, v165, v166, v32
 v_max_f32 v32, v167, v32
 v_mov_b32 v33, v32
 s_nop 1
 v_permlane16_swap_b32 v32, v33
 s_nop 1
 v_max_f32 v32, v32, v33
 v_mov_b32 v33, v32
 s_nop 1
 v_permlane32_swap_b32 v32, v33
 s_nop 1
 v_max_f32 v32, v32, v33
 v_add_f32 v32, 0x41c00000, v32
 v_max_f32 v32, 0, v32
 v_exp_f32 v34, -v32
 v_sub_f32 v72, v72, v32
 v_sub_f32 v73, v73, v32
 v_sub_f32 v74, v74, v32
 v_sub_f32 v75, v75, v32
 v_sub_f32 v160, v160, v32
 v_sub_f32 v161, v161, v32
 v_sub_f32 v162, v162, v32
 v_sub_f32 v163, v163, v32
 v_sub_f32 v164, v164, v32
 v_sub_f32 v165, v165, v32
 v_sub_f32 v166, v166, v32
 v_sub_f32 v167, v167, v32
 v_sub_f32 v192, v192, v32
 v_sub_f32 v193, v193, v32
 v_sub_f32 v194, v194, v32
 v_sub_f32 v195, v195, v32
 v_sub_f32 v196, v196, v32
 v_sub_f32 v197, v197, v32
 v_sub_f32 v198, v198, v32
 v_sub_f32 v199, v199, v32
 v_mul_f32 v248, v248, v34
 v_mul_f32 v249, v249, v34
 v_mul_f32 v250, v250, v34
 v_mul_f32 v251, v251, v34
 v_accvgpr_read_b32 v33, a64
 v_mul_f32 v33, v33, v34
 v_accvgpr_write_b32 a64, v33
 v_accvgpr_read_b32 v33, a65
 v_mul_f32 v33, v33, v34
 v_accvgpr_write_b32 a65, v33
 v_accvgpr_read_b32 v33, a66
 v_mul_f32 v33, v33, v34
 v_accvgpr_write_b32 a66, v33
 v_accvgpr_read_b32 v33, a67
 v_mul_f32 v33, v33, v34
 v_accvgpr_write_b32 a67, v33
 v_accvgpr_read_b32 v33, a68
 v_mul_f32 v33, v33, v34
 v_accvgpr_write_b32 a68, v33
 v_accvgpr_read_b32 v33, a69
 v_mul_f32 v33, v33, v34
 v_accvgpr_write_b32 a69, v33
 v_accvgpr_read_b32 v33, a70
 v_mul_f32 v33, v33, v34
 v_accvgpr_write_b32 a70, v33
 v_accvgpr_read_b32 v33, a71
 v_mul_f32 v33, v33, v34
 v_accvgpr_write_b32 a71, v33
 v_accvgpr_read_b32 v33, a72
 v_mul_f32 v33, v33, v34
 v_accvgpr_write_b32 a72, v33
 v_accvgpr_read_b32 v33, a73
 v_mul_f32 v33, v33, v34
 v_accvgpr_write_b32 a73, v33
 v_accvgpr_read_b32 v33, a74
 v_mul_f32 v33, v33, v34
 v_accvgpr_write_b32 a74, v33
 v_accvgpr_read_b32 v33, a75
 v_mul_f32 v33, v33, v34
 v_accvgpr_write_b32 a75, v33
 v_accvgpr_read_b32 v33, a76
 v_mul_f32 v33, v33, v34
 v_accvgpr_write_b32 a76, v33
 v_accvgpr_read_b32 v33, a77
 v_mul_f32 v33, v33, v34
 v_accvgpr_write_b32 a77, v33
 v_accvgpr_read_b32 v33, a78
 v_mul_f32 v33, v33, v34
 v_accvgpr_write_b32 a78, v33
 v_accvgpr_read_b32 v33, a79
 v_mul_f32 v33, v33, v34
 v_accvgpr_write_b32 a79, v33
 v_accvgpr_read_b32 v33, a80
 v_mul_f32 v33, v33, v34
 v_accvgpr_write_b32 a80, v33
 v_accvgpr_read_b32 v33, a81
 v_mul_f32 v33, v33, v34
 v_accvgpr_write_b32 a81, v33
 v_accvgpr_read_b32 v33, a82
 v_mul_f32 v33, v33, v34
 v_accvgpr_write_b32 a82, v33
 v_accvgpr_read_b32 v33, a83
 v_mul_f32 v33, v33, v34
 v_accvgpr_write_b32 a83, v33
 v_accvgpr_read_b32 v33, a84
 v_mul_f32 v33, v33, v34
 v_accvgpr_write_b32 a84, v33
 v_accvgpr_read_b32 v33, a85
 v_mul_f32 v33, v33, v34
 v_accvgpr_write_b32 a85, v33
 v_accvgpr_read_b32 v33, a86
 v_mul_f32 v33, v33, v34
 v_accvgpr_write_b32 a86, v33
 v_accvgpr_read_b32 v33, a87
 v_mul_f32 v33, v33, v34
 v_accvgpr_write_b32 a87, v33
 v_accvgpr_read_b32 v33, a88
 v_mul_f32 v33, v33, v34
 v_accvgpr_write_b32 a88, v33
 v_accvgpr_read_b32 v33, a89
 v_mul_f32 v33, v33, v34
 v_accvgpr_write_b32 a89, v33
 v_accvgpr_read_b32 v33, a90
 v_mul_f32 v33, v33, v34
 v_accvgpr_write_b32 a90, v33
 v_accvgpr_read_b32 v33, a91
 v_mul_f32 v33, v33, v34
 v_accvgpr_write_b32 a91, v33
 v_accvgpr_read_b32 v33, a92
 v_mul_f32 v33, v33, v34
 v_accvgpr_write_b32 a92, v33
 v_accvgpr_read_b32 v33, a93
 v_mul_f32 v33, v33, v34
 v_accvgpr_write_b32 a93, v33
 v_accvgpr_read_b32 v33, a94
 v_mul_f32 v33, v33, v34
 v_accvgpr_write_b32 a94, v33
 v_accvgpr_read_b32 v33, a95
 v_mul_f32 v33, v33, v34
 v_accvgpr_write_b32 a95, v33
 v_exp_f32 v36, v160
 v_exp_f32 v37, v161
 s_nop 0
 v_cvt_pk_bf16_f32 v216, v36, v37
 v_exp_f32 v36, v162
 v_exp_f32 v37, v163
 s_nop 0
 v_cvt_pk_bf16_f32 v217, v36, v37
 v_exp_f32 v36, v164
 v_exp_f32 v37, v165
 s_nop 0
 v_cvt_pk_bf16_f32 v218, v36, v37
 v_exp_f32 v36, v166
 v_exp_f32 v37, v167
 s_nop 0
 v_cvt_pk_bf16_f32 v219, v36, v37
 v_max3_f32 v32, v168, v169, v170
 v_max3_f32 v32, v171, v172, v32
 v_max3_f32 v32, v173, v174, v32
 v_max_f32 v32, v175, v32
 v_mov_b32 v33, v32
 s_nop 1
 v_permlane16_swap_b32 v32, v33
 s_nop 1
 v_max_f32 v32, v32, v33
 v_mov_b32 v33, v32
 s_nop 1
 v_permlane32_swap_b32 v32, v33
 s_nop 1
 v_max_f32 v32, v32, v33
 v_add_f32 v32, 0x41c00000, v32
 v_max_f32 v32, 0, v32
 v_exp_f32 v34, -v32
 v_sub_f32 v76, v76, v32
 v_sub_f32 v77, v77, v32
 v_sub_f32 v78, v78, v32
 v_sub_f32 v79, v79, v32
 v_sub_f32 v168, v168, v32
 v_sub_f32 v169, v169, v32
 v_sub_f32 v170, v170, v32
 v_sub_f32 v171, v171, v32
 v_sub_f32 v172, v172, v32
 v_sub_f32 v173, v173, v32
 v_sub_f32 v174, v174, v32
 v_sub_f32 v175, v175, v32
 v_sub_f32 v200, v200, v32
 v_sub_f32 v201, v201, v32
 v_sub_f32 v202, v202, v32
 v_sub_f32 v203, v203, v32
 v_sub_f32 v204, v204, v32
 v_sub_f32 v205, v205, v32
 v_sub_f32 v206, v206, v32
 v_sub_f32 v207, v207, v32
 v_mul_f32 v252, v252, v34
 v_mul_f32 v253, v253, v34
 v_mul_f32 v254, v254, v34
 v_mul_f32 v255, v255, v34
 v_accvgpr_read_b32 v33, a96
 v_mul_f32 v33, v33, v34
 v_accvgpr_write_b32 a96, v33
 v_accvgpr_read_b32 v33, a97
 v_mul_f32 v33, v33, v34
 v_accvgpr_write_b32 a97, v33
 v_accvgpr_read_b32 v33, a98
 v_mul_f32 v33, v33, v34
 v_accvgpr_write_b32 a98, v33
 v_accvgpr_read_b32 v33, a99
 v_mul_f32 v33, v33, v34
 v_accvgpr_write_b32 a99, v33
 v_accvgpr_read_b32 v33, a100
 v_mul_f32 v33, v33, v34
 v_accvgpr_write_b32 a100, v33
 v_accvgpr_read_b32 v33, a101
 v_mul_f32 v33, v33, v34
 v_accvgpr_write_b32 a101, v33
 v_accvgpr_read_b32 v33, a102
 v_mul_f32 v33, v33, v34
 v_accvgpr_write_b32 a102, v33
 v_accvgpr_read_b32 v33, a103
 v_mul_f32 v33, v33, v34
 v_accvgpr_write_b32 a103, v33
 v_accvgpr_read_b32 v33, a104
 v_mul_f32 v33, v33, v34
 v_accvgpr_write_b32 a104, v33
 v_accvgpr_read_b32 v33, a105
 v_mul_f32 v33, v33, v34
 v_accvgpr_write_b32 a105, v33
 v_accvgpr_read_b32 v33, a106
 v_mul_f32 v33, v33, v34
 v_accvgpr_write_b32 a106, v33
 v_accvgpr_read_b32 v33, a107
 v_mul_f32 v33, v33, v34
 v_accvgpr_write_b32 a107, v33
 v_accvgpr_read_b32 v33, a108
 v_mul_f32 v33, v33, v34
 v_accvgpr_write_b32 a108, v33
 v_accvgpr_read_b32 v33, a109
 v_mul_f32 v33, v33, v34
 v_accvgpr_write_b32 a109, v33
 v_accvgpr_read_b32 v33, a110
 v_mul_f32 v33, v33, v34
 v_accvgpr_write_b32 a110, v33
 v_accvgpr_read_b32 v33, a111
 v_mul_f32 v33, v33, v34
 v_accvgpr_write_b32 a111, v33
 v_accvgpr_read_b32 v33, a112
 v_mul_f32 v33, v33, v34
 v_accvgpr_write_b32 a112, v33
 v_accvgpr_read_b32 v33, a113
 v_mul_f32 v33, v33, v34
 v_accvgpr_write_b32 a113, v33
 v_accvgpr_read_b32 v33, a114
 v_mul_f32 v33, v33, v34
 v_accvgpr_write_b32 a114, v33
 v_accvgpr_read_b32 v33, a115
 v_mul_f32 v33, v33, v34
 v_accvgpr_write_b32 a115, v33
 v_accvgpr_read_b32 v33, a116
 v_mul_f32 v33, v33, v34
 v_accvgpr_write_b32 a116, v33
 v_accvgpr_read_b32 v33, a117
 v_mul_f32 v33, v33, v34
 v_accvgpr_write_b32 a117, v33
 v_accvgpr_read_b32 v33, a118
 v_mul_f32 v33, v33, v34
 v_accvgpr_write_b32 a118, v33
 v_accvgpr_read_b32 v33, a119
 v_mul_f32 v33, v33, v34
 v_accvgpr_write_b32 a119, v33
 v_accvgpr_read_b32 v33, a120
 v_mul_f32 v33, v33, v34
 v_accvgpr_write_b32 a120, v33
 v_accvgpr_read_b32 v33, a121
 v_mul_f32 v33, v33, v34
 v_accvgpr_write_b32 a121, v33
 v_accvgpr_read_b32 v33, a122
 v_mul_f32 v33, v33, v34
 v_accvgpr_write_b32 a122, v33
 v_accvgpr_read_b32 v33, a123
 v_mul_f32 v33, v33, v34
 v_accvgpr_write_b32 a123, v33
 v_accvgpr_read_b32 v33, a124
 v_mul_f32 v33, v33, v34
 v_accvgpr_write_b32 a124, v33
 v_accvgpr_read_b32 v33, a125
 v_mul_f32 v33, v33, v34
 v_accvgpr_write_b32 a125, v33
 v_accvgpr_read_b32 v33, a126
 v_mul_f32 v33, v33, v34
 v_accvgpr_write_b32 a126, v33
 v_accvgpr_read_b32 v33, a127
 v_mul_f32 v33, v33, v34
 v_accvgpr_write_b32 a127, v33
 v_exp_f32 v36, v168
 v_exp_f32 v37, v169
 s_nop 0
 v_cvt_pk_bf16_f32 v220, v36, v37
 v_exp_f32 v36, v170
 v_exp_f32 v37, v171
 s_nop 0
 v_cvt_pk_bf16_f32 v221, v36, v37
 v_exp_f32 v36, v172
 v_exp_f32 v37, v173
 s_nop 0
 v_cvt_pk_bf16_f32 v222, v36, v37
 v_exp_f32 v36, v174
 v_exp_f32 v37, v175
 s_nop 0
 v_cvt_pk_bf16_f32 v223, v36, v37
 s_nop 1
 s_branch L_b4e_r0_ret
L_b4e_r1:
 s_nop 7
 v_max3_f32 v32, v176, v177, v178
 v_max3_f32 v32, v179, v180, v32
 v_max3_f32 v32, v181, v182, v32
 v_max_f32 v32, v183, v32
 v_mov_b32 v33, v32
 s_nop 1
 v_permlane16_swap_b32 v32, v33
 s_nop 1
 v_max_f32 v32, v32, v33
 v_mov_b32 v33, v32
 s_nop 1
 v_permlane32_swap_b32 v32, v33
 s_nop 1
 v_max_f32 v32, v32, v33
 v_add_f32 v32, 0x41c00000, v32
 v_max_f32 v32, 0, v32
 v_exp_f32 v34, -v32
 v_sub_f32 v64, v64, v32
 v_sub_f32 v65, v65, v32
 v_sub_f32 v66, v66, v32
 v_sub_f32 v67, v67, v32
 v_sub_f32 v176, v176, v32
 v_sub_f32 v177, v177, v32
 v_sub_f32 v178, v178, v32
 v_sub_f32 v179, v179, v32
 v_sub_f32 v180, v180, v32
 v_sub_f32 v181, v181, v32
 v_sub_f32 v182, v182, v32
 v_sub_f32 v183, v183, v32
 v_sub_f32 v144, v144, v32
 v_sub_f32 v145, v145, v32
 v_sub_f32 v146, v146, v32
 v_sub_f32 v147, v147, v32
 v_sub_f32 v148, v148, v32
 v_sub_f32 v149, v149, v32
 v_sub_f32 v150, v150, v32
 v_sub_f32 v151, v151, v32
 v_mul_f32 v240, v240, v34
 v_mul_f32 v241, v241, v34
 v_mul_f32 v242, v242, v34
 v_mul_f32 v243, v243, v34
 v_accvgpr_read_b32 v33, a0
 v_mul_f32 v33, v33, v34
 v_accvgpr_write_b32 a0, v33
 v_accvgpr_read_b32 v33, a1
 v_mul_f32 v33, v33, v34
 v_accvgpr_write_b32 a1, v33
 v_accvgpr_read_b32 v33, a2
 v_mul_f32 v33, v33, v34
 v_accvgpr_write_b32 a2, v33
 v_accvgpr_read_b32 v33, a3
 v_mul_f32 v33, v33, v34
 v_accvgpr_write_b32 a3, v33
 v_accvgpr_read_b32 v33, a4
 v_mul_f32 v33, v33, v34
 v_accvgpr_write_b32 a4, v33
 v_accvgpr_read_b32 v33, a5
 v_mul_f32 v33, v33, v34
 v_accvgpr_write_b32 a5, v33
 v_accvgpr_read_b32 v33, a6
 v_mul_f32 v33, v33, v34
 v_accvgpr_write_b32 a6, v33
 v_accvgpr_read_b32 v33, a7
 v_mul_f32 v33, v33, v34
 v_accvgpr_write_b32 a7, v33
 v_accvgpr_read_b32 v33, a8
 v_mul_f32 v33, v33, v34
 v_accvgpr_write_b32 a8, v33
 v_accvgpr_read_b32 v33, a9
 v_mul_f32 v33, v33, v34
 v_accvgpr_write_b32 a9, v33
 v_accvgpr_read_b32 v33, a10
 v_mul_f32 v33, v33, v34
 v_accvgpr_write_b32 a10, v33
 v_accvgpr_read_b32 v33, a11
 v_mul_f32 v33, v33, v34
 v_accvgpr_write_b32 a11, v33
 v_accvgpr_read_b32 v33, a12
 v_mul_f32 v33, v33, v34
 v_accvgpr_write_b32 a12, v33
 v_accvgpr_read_b32 v33, a13
 v_mul_f32 v33, v33, v34
 v_accvgpr_write_b32 a13, v33
 v_accvgpr_read_b32 v33, a14
 v_mul_f32 v33, v33, v34
 v_accvgpr_write_b32 a14, v33
 v_accvgpr_read_b32 v33, a15
 v_mul_f32 v33, v33, v34
 v_accvgpr_write_b32 a15, v33
 v_accvgpr_read_b32 v33, a16
 v_mul_f32 v33, v33, v34
 v_accvgpr_write_b32 a16, v33
 v_accvgpr_read_b32 v33, a17
 v_mul_f32 v33, v33, v34
 v_accvgpr_write_b32 a17, v33
 v_accvgpr_read_b32 v33, a18
 v_mul_f32 v33, v33, v34
 v_accvgpr_write_b32 a18, v33
 v_accvgpr_read_b32 v33, a19
 v_mul_f32 v33, v33, v34
 v_accvgpr_write_b32 a19, v33
 v_accvgpr_read_b32 v33, a20
 v_mul_f32 v33, v33, v34
 v_accvgpr_write_b32 a20, v33
 v_accvgpr_read_b32 v33, a21
 v_mul_f32 v33, v33, v34
 v_accvgpr_write_b32 a21, v33
 v_accvgpr_read_b32 v33, a22
 v_mul_f32 v33, v33, v34
 v_accvgpr_write_b32 a22, v33
 v_accvgpr_read_b32 v33, a23
 v_mul_f32 v33, v33, v34
 v_accvgpr_write_b32 a23, v33
 v_accvgpr_read_b32 v33, a24
 v_mul_f32 v33, v33, v34
 v_accvgpr_write_b32 a24, v33
 v_accvgpr_read_b32 v33, a25
 v_mul_f32 v33, v33, v34
 v_accvgpr_write_b32 a25, v33
 v_accvgpr_read_b32 v33, a26
 v_mul_f32 v33, v33, v34
 v_accvgpr_write_b32 a26, v33
 v_accvgpr_read_b32 v33, a27
 v_mul_f32 v33, v33, v34
 v_accvgpr_write_b32 a27, v33
 v_accvgpr_read_b32 v33, a28
 v_mul_f32 v33, v33, v34
 v_accvgpr_write_b32 a28, v33
 v_accvgpr_read_b32 v33, a29
 v_mul_f32 v33, v33, v34
 v_accvgpr_write_b32 a29, v33
 v_accvgpr_read_b32 v33, a30
 v_mul_f32 v33, v33, v34
 v_accvgpr_write_b32 a30, v33
 v_accvgpr_read_b32 v33, a31
 v_mul_f32 v33, v33, v34
 v_accvgpr_write_b32 a31, v33
 v_exp_f32 v36, v176
 v_exp_f32 v37, v177
 s_nop 0
 v_cvt_pk_bf16_f32 v224, v36, v37
 v_exp_f32 v36, v178
 v_exp_f32 v37, v179
 s_nop 0
 v_cvt_pk_bf16_f32 v225, v36, v37
 v_exp_f32 v36, v180
 v_exp_f32 v37, v181
 s_nop 0
 v_cvt_pk_bf16_f32 v226, v36, v37
 v_exp_f32 v36, v182
 v_exp_f32 v37, v183
 s_nop 0
 v_cvt_pk_bf16_f32 v227, v36, v37
 v_max3_f32 v32, v184, v185, v186
 v_max3_f32 v32, v187, v188, v32
 v_max3_f32 v32, v189, v190, v32
 v_max_f32 v32, v191, v32
 v_mov_b32 v33, v32
 s_nop 1
 v_permlane16_swap_b32 v32, v33
 s_nop 1
 v_max_f32 v32, v32, v33
 v_mov_b32 v33, v32
 s_nop 1
 v_permlane32_swap_b32 v32, v33
 s_nop 1
 v_max_f32 v32, v32, v33
 v_add_f32 v32, 0x41c00000, v32
 v_max_f32 v32, 0, v32
 v_exp_f32 v34, -v32
 v_sub_f32 v68, v68, v32
 v_sub_f32 v69, v69, v32
 v_sub_f32 v70, v70, v32
 v_sub_f32 v71, v71, v32
 v_sub_f32 v184, v184, v32
 v_sub_f32 v185, v185, v32
 v_sub_f32 v186, v186, v32
 v_sub_f32 v187, v187, v32
 v_sub_f32 v188, v188, v32
 v_sub_f32 v189, v189, v32
 v_sub_f32 v190, v190, v32
 v_sub_f32 v191, v191, v32
 v_sub_f32 v152, v152, v32
 v_sub_f32 v153, v153, v32
 v_sub_f32 v154, v154, v32
 v_sub_f32 v155, v155, v32
 v_sub_f32 v156, v156, v32
 v_sub_f32 v157, v157, v32
 v_sub_f32 v158, v158, v32
 v_sub_f32 v159, v159, v32
 v_mul_f32 v244, v244, v34
 v_mul_f32 v245, v245, v34
 v_mul_f32 v246, v246, v34
 v_mul_f32 v247, v247, v34
 v_accvgpr_read_b32 v33, a32
 v_mul_f32 v33, v33, v34
 v_accvgpr_write_b32 a32, v33
 v_accvgpr_read_b32 v33, a33
 v_mul_f32 v33, v33, v34
 v_accvgpr_write_b32 a33, v33
 v_accvgpr_read_b32 v33, a34
 v_mul_f32 v33, v33, v34
 v_accvgpr_write_b32 a34, v33
 v_accvgpr_read_b32 v33, a35
 v_mul_f32 v33, v33, v34
 v_accvgpr_write_b32 a35, v33
 v_accvgpr_read_b32 v33, a36
 v_mul_f32 v33, v33, v34
 v_accvgpr_write_b32 a36, v33
 v_accvgpr_read_b32 v33, a37
 v_mul_f32 v33, v33, v34
 v_accvgpr_write_b32 a37, v33
 v_accvgpr_read_b32 v33, a38
 v_mul_f32 v33, v33, v34
 v_accvgpr_write_b32 a38, v33
 v_accvgpr_read_b32 v33, a39
 v_mul_f32 v33, v33, v34
 v_accvgpr_write_b32 a39, v33
 v_accvgpr_read_b32 v33, a40
 v_mul_f32 v33, v33, v34
 v_accvgpr_write_b32 a40, v33
 v_accvgpr_read_b32 v33, a41
 v_mul_f32 v33, v33, v34
 v_accvgpr_write_b32 a41, v33
 v_accvgpr_read_b32 v33, a42
 v_mul_f32 v33, v33, v34
 v_accvgpr_write_b32 a42, v33
 v_accvgpr_read_b32 v33, a43
 v_mul_f32 v33, v33, v34
 v_accvgpr_write_b32 a43, v33
 v_accvgpr_read_b32 v33, a44
 v_mul_f32 v33, v33, v34
 v_accvgpr_write_b32 a44, v33
 v_accvgpr_read_b32 v33, a45
 v_mul_f32 v33, v33, v34
 v_accvgpr_write_b32 a45, v33
 v_accvgpr_read_b32 v33, a46
 v_mul_f32 v33, v33, v34
 v_accvgpr_write_b32 a46, v33
 v_accvgpr_read_b32 v33, a47
 v_mul_f32 v33, v33, v34
 v_accvgpr_write_b32 a47, v33
 v_accvgpr_read_b32 v33, a48
 v_mul_f32 v33, v33, v34
 v_accvgpr_write_b32 a48, v33
 v_accvgpr_read_b32 v33, a49
 v_mul_f32 v33, v33, v34
 v_accvgpr_write_b32 a49, v33
 v_accvgpr_read_b32 v33, a50
 v_mul_f32 v33, v33, v34
 v_accvgpr_write_b32 a50, v33
 v_accvgpr_read_b32 v33, a51
 v_mul_f32 v33, v33, v34
 v_accvgpr_write_b32 a51, v33
 v_accvgpr_read_b32 v33, a52
 v_mul_f32 v33, v33, v34
 v_accvgpr_write_b32 a52, v33
 v_accvgpr_read_b32 v33, a53
 v_mul_f32 v33, v33, v34
 v_accvgpr_write_b32 a53, v33
 v_accvgpr_read_b32 v33, a54
 v_mul_f32 v33, v33, v34
 v_accvgpr_write_b32 a54, v33
 v_accvgpr_read_b32 v33, a55
 v_mul_f32 v33, v33, v34
 v_accvgpr_write_b32 a55, v33
 v_accvgpr_read_b32 v33, a56
 v_mul_f32 v33, v33, v34
 v_accvgpr_write_b32 a56, v33
 v_accvgpr_read_b32 v33, a57
 v_mul_f32 v33, v33, v34
 v_accvgpr_write_b32 a57, v33
 v_accvgpr_read_b32 v33, a58
 v_mul_f32 v33, v33, v34
 v_accvgpr_write_b32 a58, v33
 v_accvgpr_read_b32 v33, a59
 v_mul_f32 v33, v33, v34
 v_accvgpr_write_b32 a59, v33
 v_accvgpr_read_b32 v33, a60
 v_mul_f32 v33, v33, v34
 v_accvgpr_write_b32 a60, v33
 v_accvgpr_read_b32 v33, a61
 v_mul_f32 v33, v33, v34
 v_accvgpr_write_b32 a61, v33
 v_accvgpr_read_b32 v33, a62
 v_mul_f32 v33, v33, v34
 v_accvgpr_write_b32 a62, v33
 v_accvgpr_read_b32 v33, a63
 v_mul_f32 v33, v33, v34
 v_accvgpr_write_b32 a63, v33
 v_exp_f32 v36, v184
 v_exp_f32 v37, v185
 s_nop 0
 v_cvt_pk_bf16_f32 v228, v36, v37
 v_exp_f32 v36, v186
 v_exp_f32 v37, v187
 s_nop 0
 v_cvt_pk_bf16_f32 v229, v36, v37
 v_exp_f32 v36, v188
 v_exp_f32 v37, v189
 s_nop 0
 v_cvt_pk_bf16_f32 v230, v36, v37
 v_exp_f32 v36, v190
 v_exp_f32 v37, v191
 s_nop 0
 v_cvt_pk_bf16_f32 v231, v36, v37
 v_max3_f32 v32, v192, v193, v194
 v_max3_f32 v32, v195, v196, v32
 v_max3_f32 v32, v197, v198, v32
 v_max_f32 v32, v199, v32
 v_mov_b32 v33, v32
 s_nop 1
 v_permlane16_swap_b32 v32, v33
 s_nop 1
 v_max_f32 v32, v32, v33
 v_mov_b32 v33, v32
 s_nop 1
 v_permlane32_swap_b32 v32, v33
 s_nop 1
 v_max_f32 v32, v32, v33
 v_add_f32 v32, 0x41c00000, v32
 v_max_f32 v32, 0, v32
 v_exp_f32 v34, -v32
 v_sub_f32 v72, v72, v32
 v_sub_f32 v73, v73, v32
 v_sub_f32 v74, v74, v32
 v_sub_f32 v75, v75, v32
 v_sub_f32 v192, v192, v32
 v_sub_f32 v193, v193, v32
 v_sub_f32 v194, v194, v32
 v_sub_f32 v195, v195, v32
 v_sub_f32 v196, v196, v32
 v_sub_f32 v197, v197, v32
 v_sub_f32 v198, v198, v32
 v_sub_f32 v199, v199, v32
 v_sub_f32 v160, v160, v32
 v_sub_f32 v161, v161, v32
 v_sub_f32 v162, v162, v32
 v_sub_f32 v163, v163, v32
 v_sub_f32 v164, v164, v32
 v_sub_f32 v165, v165, v32
 v_sub_f32 v166, v166, v32
 v_sub_f32 v167, v167, v32
 v_mul_f32 v248, v248, v34
 v_mul_f32 v249, v249, v34
 v_mul_f32 v250, v250, v34
 v_mul_f32 v251, v251, v34
 v_accvgpr_read_b32 v33, a64
 v_mul_f32 v33, v33, v34
 v_accvgpr_write_b32 a64, v33
 v_accvgpr_read_b32 v33, a65
 v_mul_f32 v33, v33, v34
 v_accvgpr_write_b32 a65, v33
 v_accvgpr_read_b32 v33, a66
 v_mul_f32 v33, v33, v34
 v_accvgpr_write_b32 a66, v33
 v_accvgpr_read_b32 v33, a67
 v_mul_f32 v33, v33, v34
 v_accvgpr_write_b32 a67, v33
 v_accvgpr_read_b32 v33, a68
 v_mul_f32 v33, v33, v34
 v_accvgpr_write_b32 a68, v33
 v_accvgpr_read_b32 v33, a69
 v_mul_f32 v33, v33, v34
 v_accvgpr_write_b32 a69, v33
 v_accvgpr_read_b32 v33, a70
 v_mul_f32 v33, v33, v34
 v_accvgpr_write_b32 a70, v33
 v_accvgpr_read_b32 v33, a71
 v_mul_f32 v33, v33, v34
 v_accvgpr_write_b32 a71, v33
 v_accvgpr_read_b32 v33, a72
 v_mul_f32 v33, v33, v34
 v_accvgpr_write_b32 a72, v33
 v_accvgpr_read_b32 v33, a73
 v_mul_f32 v33, v33, v34
 v_accvgpr_write_b32 a73, v33
 v_accvgpr_read_b32 v33, a74
 v_mul_f32 v33, v33, v34
 v_accvgpr_write_b32 a74, v33
 v_accvgpr_read_b32 v33, a75
 v_mul_f32 v33, v33, v34
 v_accvgpr_write_b32 a75, v33
 v_accvgpr_read_b32 v33, a76
 v_mul_f32 v33, v33, v34
 v_accvgpr_write_b32 a76, v33
 v_accvgpr_read_b32 v33, a77
 v_mul_f32 v33, v33, v34
 v_accvgpr_write_b32 a77, v33
 v_accvgpr_read_b32 v33, a78
 v_mul_f32 v33, v33, v34
 v_accvgpr_write_b32 a78, v33
 v_accvgpr_read_b32 v33, a79
 v_mul_f32 v33, v33, v34
 v_accvgpr_write_b32 a79, v33
 v_accvgpr_read_b32 v33, a80
 v_mul_f32 v33, v33, v34
 v_accvgpr_write_b32 a80, v33
 v_accvgpr_read_b32 v33, a81
 v_mul_f32 v33, v33, v34
 v_accvgpr_write_b32 a81, v33
 v_accvgpr_read_b32 v33, a82
 v_mul_f32 v33, v33, v34
 v_accvgpr_write_b32 a82, v33
 v_accvgpr_read_b32 v33, a83
 v_mul_f32 v33, v33, v34
 v_accvgpr_write_b32 a83, v33
 v_accvgpr_read_b32 v33, a84
 v_mul_f32 v33, v33, v34
 v_accvgpr_write_b32 a84, v33
 v_accvgpr_read_b32 v33, a85
 v_mul_f32 v33, v33, v34
 v_accvgpr_write_b32 a85, v33
 v_accvgpr_read_b32 v33, a86
 v_mul_f32 v33, v33, v34
 v_accvgpr_write_b32 a86, v33
 v_accvgpr_read_b32 v33, a87
 v_mul_f32 v33, v33, v34
 v_accvgpr_write_b32 a87, v33
 v_accvgpr_read_b32 v33, a88
 v_mul_f32 v33, v33, v34
 v_accvgpr_write_b32 a88, v33
 v_accvgpr_read_b32 v33, a89
 v_mul_f32 v33, v33, v34
 v_accvgpr_write_b32 a89, v33
 v_accvgpr_read_b32 v33, a90
 v_mul_f32 v33, v33, v34
 v_accvgpr_write_b32 a90, v33
 v_accvgpr_read_b32 v33, a91
 v_mul_f32 v33, v33, v34
 v_accvgpr_write_b32 a91, v33
 v_accvgpr_read_b32 v33, a92
 v_mul_f32 v33, v33, v34
 v_accvgpr_write_b32 a92, v33
 v_accvgpr_read_b32 v33, a93
 v_mul_f32 v33, v33, v34
 v_accvgpr_write_b32 a93, v33
 v_accvgpr_read_b32 v33, a94
 v_mul_f32 v33, v33, v34
 v_accvgpr_write_b32 a94, v33
 v_accvgpr_read_b32 v33, a95
 v_mul_f32 v33, v33, v34
 v_accvgpr_write_b32 a95, v33
 v_exp_f32 v36, v192
 v_exp_f32 v37, v193
 s_nop 0
 v_cvt_pk_bf16_f32 v232, v36, v37
 v_exp_f32 v36, v194
 v_exp_f32 v37, v195
 s_nop 0
 v_cvt_pk_bf16_f32 v233, v36, v37
 v_exp_f32 v36, v196
 v_exp_f32 v37, v197
 s_nop 0
 v_cvt_pk_bf16_f32 v234, v36, v37
 v_exp_f32 v36, v198
 v_exp_f32 v37, v199
 s_nop 0
 v_cvt_pk_bf16_f32 v235, v36, v37
 v_max3_f32 v32, v200, v201, v202
 v_max3_f32 v32, v203, v204, v32
 v_max3_f32 v32, v205, v206, v32
 v_max_f32 v32, v207, v32
 v_mov_b32 v33, v32
 s_nop 1
 v_permlane16_swap_b32 v32, v33
 s_nop 1
 v_max_f32 v32, v32, v33
 v_mov_b32 v33, v32
 s_nop 1
 v_permlane32_swap_b32 v32, v33
 s_nop 1
 v_max_f32 v32, v32, v33
 v_add_f32 v32, 0x41c00000, v32
 v_max_f32 v32, 0, v32
 v_exp_f32 v34, -v32
 v_sub_f32 v76, v76, v32
 v_sub_f32 v77, v77, v32
 v_sub_f32 v78, v78, v32
 v_sub_f32 v79, v79, v32
 v_sub_f32 v200, v200, v32
 v_sub_f32 v201, v201, v32
 v_sub_f32 v202, v202, v32
 v_sub_f32 v203, v203, v32
 v_sub_f32 v204, v204, v32
 v_sub_f32 v205, v205, v32
 v_sub_f32 v206, v206, v32
 v_sub_f32 v207, v207, v32
 v_sub_f32 v168, v168, v32
 v_sub_f32 v169, v169, v32
 v_sub_f32 v170, v170, v32
 v_sub_f32 v171, v171, v32
 v_sub_f32 v172, v172, v32
 v_sub_f32 v173, v173, v32
 v_sub_f32 v174, v174, v32
 v_sub_f32 v175, v175, v32
 v_mul_f32 v252, v252, v34
 v_mul_f32 v253, v253, v34
 v_mul_f32 v254, v254, v34
 v_mul_f32 v255, v255, v34
 v_accvgpr_read_b32 v33, a96
 v_mul_f32 v33, v33, v34
 v_accvgpr_write_b32 a96, v33
 v_accvgpr_read_b32 v33, a97
 v_mul_f32 v33, v33, v34
 v_accvgpr_write_b32 a97, v33
 v_accvgpr_read_b32 v33, a98
 v_mul_f32 v33, v33, v34
 v_accvgpr_write_b32 a98, v33
 v_accvgpr_read_b32 v33, a99
 v_mul_f32 v33, v33, v34
 v_accvgpr_write_b32 a99, v33
 v_accvgpr_read_b32 v33, a100
 v_mul_f32 v33, v33, v34
 v_accvgpr_write_b32 a100, v33
 v_accvgpr_read_b32 v33, a101
 v_mul_f32 v33, v33, v34
 v_accvgpr_write_b32 a101, v33
 v_accvgpr_read_b32 v33, a102
 v_mul_f32 v33, v33, v34
 v_accvgpr_write_b32 a102, v33
 v_accvgpr_read_b32 v33, a103
 v_mul_f32 v33, v33, v34
 v_accvgpr_write_b32 a103, v33
 v_accvgpr_read_b32 v33, a104
 v_mul_f32 v33, v33, v34
 v_accvgpr_write_b32 a104, v33
 v_accvgpr_read_b32 v33, a105
 v_mul_f32 v33, v33, v34
 v_accvgpr_write_b32 a105, v33
 v_accvgpr_read_b32 v33, a106
 v_mul_f32 v33, v33, v34
 v_accvgpr_write_b32 a106, v33
 v_accvgpr_read_b32 v33, a107
 v_mul_f32 v33, v33, v34
 v_accvgpr_write_b32 a107, v33
 v_accvgpr_read_b32 v33, a108
 v_mul_f32 v33, v33, v34
 v_accvgpr_write_b32 a108, v33
 v_accvgpr_read_b32 v33, a109
 v_mul_f32 v33, v33, v34
 v_accvgpr_write_b32 a109, v33
 v_accvgpr_read_b32 v33, a110
 v_mul_f32 v33, v33, v34
 v_accvgpr_write_b32 a110, v33
 v_accvgpr_read_b32 v33, a111
 v_mul_f32 v33, v33, v34
 v_accvgpr_write_b32 a111, v33
 v_accvgpr_read_b32 v33, a112
 v_mul_f32 v33, v33, v34
 v_accvgpr_write_b32 a112, v33
 v_accvgpr_read_b32 v33, a113
 v_mul_f32 v33, v33, v34
 v_accvgpr_write_b32 a113, v33
 v_accvgpr_read_b32 v33, a114
 v_mul_f32 v33, v33, v34
 v_accvgpr_write_b32 a114, v33
 v_accvgpr_read_b32 v33, a115
 v_mul_f32 v33, v33, v34
 v_accvgpr_write_b32 a115, v33
 v_accvgpr_read_b32 v33, a116
 v_mul_f32 v33, v33, v34
 v_accvgpr_write_b32 a116, v33
 v_accvgpr_read_b32 v33, a117
 v_mul_f32 v33, v33, v34
 v_accvgpr_write_b32 a117, v33
 v_accvgpr_read_b32 v33, a118
 v_mul_f32 v33, v33, v34
 v_accvgpr_write_b32 a118, v33
 v_accvgpr_read_b32 v33, a119
 v_mul_f32 v33, v33, v34
 v_accvgpr_write_b32 a119, v33
 v_accvgpr_read_b32 v33, a120
 v_mul_f32 v33, v33, v34
 v_accvgpr_write_b32 a120, v33
 v_accvgpr_read_b32 v33, a121
 v_mul_f32 v33, v33, v34
 v_accvgpr_write_b32 a121, v33
 v_accvgpr_read_b32 v33, a122
 v_mul_f32 v33, v33, v34
 v_accvgpr_write_b32 a122, v33
 v_accvgpr_read_b32 v33, a123
 v_mul_f32 v33, v33, v34
 v_accvgpr_write_b32 a123, v33
 v_accvgpr_read_b32 v33, a124
 v_mul_f32 v33, v33, v34
 v_accvgpr_write_b32 a124, v33
 v_accvgpr_read_b32 v33, a125
 v_mul_f32 v33, v33, v34
 v_accvgpr_write_b32 a125, v33
 v_accvgpr_read_b32 v33, a126
 v_mul_f32 v33, v33, v34
 v_accvgpr_write_b32 a126, v33
 v_accvgpr_read_b32 v33, a127
 v_mul_f32 v33, v33, v34
 v_accvgpr_write_b32 a127, v33
 v_exp_f32 v36, v200
 v_exp_f32 v37, v201
 s_nop 0
 v_cvt_pk_bf16_f32 v236, v36, v37
 v_exp_f32 v36, v202
 v_exp_f32 v37, v203
 s_nop 0
 v_cvt_pk_bf16_f32 v237, v36, v37
 v_exp_f32 v36, v204
 v_exp_f32 v37, v205
 s_nop 0
 v_cvt_pk_bf16_f32 v238, v36, v37
 v_exp_f32 v36, v206
 v_exp_f32 v37, v207
 s_nop 0
 v_cvt_pk_bf16_f32 v239, v36, v37
 s_nop 1
 s_branch L_b4e_r1_ret
L_b3_r0:
 s_nop 7
 v_max3_f32 v32, v152, v153, v154
 v_max3_f32 v32, v155, v156, v32
 v_max3_f32 v32, v157, v158, v32
 v_max_f32 v32, v159, v32
 v_mov_b32 v33, v32
 s_nop 1
 v_permlane16_swap_b32 v32, v33
 s_nop 1
 v_max_f32 v32, v32, v33
 v_mov_b32 v33, v32
 s_nop 1
 v_permlane32_swap_b32 v32, v33
 s_nop 1
 v_max_f32 v32, v32, v33
 v_add_f32 v32, 0x41c00000, v32
 v_max_f32 v32, 0, v32
 v_exp_f32 v34, -v32
 v_sub_f32 v68, v68, v32
 v_sub_f32 v69, v69, v32
 v_sub_f32 v70, v70, v32
 v_sub_f32 v71, v71, v32
 v_sub_f32 v152, v152, v32
 v_sub_f32 v153, v153, v32
 v_sub_f32 v154, v154, v32
 v_sub_f32 v155, v155, v32
 v_sub_f32 v156, v156, v32
 v_sub_f32 v157, v157, v32
 v_sub_f32 v158, v158, v32
 v_sub_f32 v159, v159, v32
 v_sub_f32 v184, v184, v32
 v_sub_f32 v185, v185, v32
 v_sub_f32 v186, v186, v32
 v_sub_f32 v187, v187, v32
 v_sub_f32 v188, v188, v32
 v_sub_f32 v189, v189, v32
 v_sub_f32 v190, v190, v32
 v_sub_f32 v191, v191, v32
 v_mul_f32 v244, v244, v34
 v_mul_f32 v245, v245, v34
 v_mul_f32 v246, v246, v34
 v_mul_f32 v247, v247, v34
 v_accvgpr_read_b32 v33, a32
 v_mul_f32 v33, v33, v34
 v_accvgpr_write_b32 a32, v33
 v_accvgpr_read_b32 v33, a33
 v_mul_f32 v33, v33, v34
 v_accvgpr_write_b32 a33, v33
 v_accvgpr_read_b32 v33, a34
 v_mul_f32 v33, v33, v34
 v_accvgpr_write_b32 a34, v33
 v_accvgpr_read_b32 v33, a35
 v_mul_f32 v33, v33, v34
 v_accvgpr_write_b32 a35, v33
 v_accvgpr_read_b32 v33, a36
 v_mul_f32 v33, v33, v34
 v_accvgpr_write_b32 a36, v33
 v_accvgpr_read_b32 v33, a37
 v_mul_f32 v33, v33, v34
 v_accvgpr_write_b32 a37, v33
 v_accvgpr_read_b32 v33, a38
 v_mul_f32 v33, v33, v34
 v_accvgpr_write_b32 a38, v33
 v_accvgpr_read_b32 v33, a39
 v_mul_f32 v33, v33, v34
 v_accvgpr_write_b32 a39, v33
 v_accvgpr_read_b32 v33, a40
 v_mul_f32 v33, v33, v34
 v_accvgpr_write_b32 a40, v33
 v_accvgpr_read_b32 v33, a41
 v_mul_f32 v33, v33, v34
 v_accvgpr_write_b32 a41, v33
 v_accvgpr_read_b32 v33, a42
 v_mul_f32 v33, v33, v34
 v_accvgpr_write_b32 a42, v33
 v_accvgpr_read_b32 v33, a43
 v_mul_f32 v33, v33, v34
 v_accvgpr_write_b32 a43, v33
 v_accvgpr_read_b32 v33, a44
 v_mul_f32 v33, v33, v34
 v_accvgpr_write_b32 a44, v33
 v_accvgpr_read_b32 v33, a45
 v_mul_f32 v33, v33, v34
 v_accvgpr_write_b32 a45, v33
 v_accvgpr_read_b32 v33, a46
 v_mul_f32 v33, v33, v34
 v_accvgpr_write_b32 a46, v33
 v_accvgpr_read_b32 v33, a47
 v_mul_f32 v33, v33, v34
 v_accvgpr_write_b32 a47, v33
 v_accvgpr_read_b32 v33, a48
 v_mul_f32 v33, v33, v34
 v_accvgpr_write_b32 a48, v33
 v_accvgpr_read_b32 v33, a49
 v_mul_f32 v33, v33, v34
 v_accvgpr_write_b32 a49, v33
 v_accvgpr_read_b32 v33, a50
 v_mul_f32 v33, v33, v34
 v_accvgpr_write_b32 a50, v33
 v_accvgpr_read_b32 v33, a51
 v_mul_f32 v33, v33, v34
 v_accvgpr_write_b32 a51, v33
 v_accvgpr_read_b32 v33, a52
 v_mul_f32 v33, v33, v34
 v_accvgpr_write_b32 a52, v33
 v_accvgpr_read_b32 v33, a53
 v_mul_f32 v33, v33, v34
 v_accvgpr_write_b32 a53, v33
 v_accvgpr_read_b32 v33, a54
 v_mul_f32 v33, v33, v34
 v_accvgpr_write_b32 a54, v33
 v_accvgpr_read_b32 v33, a55
 v_mul_f32 v33, v33, v34
 v_accvgpr_write_b32 a55, v33
 v_accvgpr_read_b32 v33, a56
 v_mul_f32 v33, v33, v34
 v_accvgpr_write_b32 a56, v33
 v_accvgpr_read_b32 v33, a57
 v_mul_f32 v33, v33, v34
 v_accvgpr_write_b32 a57, v33
 v_accvgpr_read_b32 v33, a58
 v_mul_f32 v33, v33, v34
 v_accvgpr_write_b32 a58, v33
 v_accvgpr_read_b32 v33, a59
 v_mul_f32 v33, v33, v34
 v_accvgpr_write_b32 a59, v33
 v_accvgpr_read_b32 v33, a60
 v_mul_f32 v33, v33, v34
 v_accvgpr_write_b32 a60, v33
 v_accvgpr_read_b32 v33, a61
 v_mul_f32 v33, v33, v34
 v_accvgpr_write_b32 a61, v33
 v_accvgpr_read_b32 v33, a62
 v_mul_f32 v33, v33, v34
 v_accvgpr_write_b32 a62, v33
 v_accvgpr_read_b32 v33, a63
 v_mul_f32 v33, v33, v34
 v_accvgpr_write_b32 a63, v33
 v_exp_f32 v36, v152
 v_exp_f32 v37, v153
 s_nop 0
 v_cvt_pk_bf16_f32 v212, v36, v37
 v_exp_f32 v36, v154
 v_exp_f32 v37, v155
 s_nop 0
 v_cvt_pk_bf16_f32 v213, v36, v37
 v_exp_f32 v36, v156
 v_exp_f32 v37, v157
 s_nop 0
 v_cvt_pk_bf16_f32 v214, v36, v37
 v_exp_f32 v36, v158
 v_exp_f32 v37, v159
 s_nop 0
 v_cvt_pk_bf16_f32 v215, v36, v37
 v_max3_f32 v32, v160, v161, v162
 v_max3_f32 v32, v163, v164, v32
 v_max3_f32 v32, v165, v166, v32
 v_max_f32 v32, v167, v32
 v_mov_b32 v33, v32
 s_nop 1
 v_permlane16_swap_b32 v32, v33
 s_nop 1
 v_max_f32 v32, v32, v33
 v_mov_b32 v33, v32
 s_nop 1
 v_permlane32_swap_b32 v32, v33
 s_nop 1
 v_max_f32 v32, v32, v33
 v_add_f32 v32, 0x41c00000, v32
 v_max_f32 v32, 0, v32
 v_exp_f32 v34, -v32
 v_sub_f32 v72, v72, v32
 v_sub_f32 v73, v73, v32
 v_sub_f32 v74, v74, v32
 v_sub_f32 v75, v75, v32
 v_sub_f32 v160, v160, v32
 v_sub_f32 v161, v161, v32
 v_sub_f32 v162, v162, v32
 v_sub_f32 v163, v163, v32
 v_sub_f32 v164, v164, v32
 v_sub_f32 v165, v165, v32
 v_sub_f32 v166, v166, v32
 v_sub_f32 v167, v167, v32
 v_sub_f32 v192, v192, v32
 v_sub_f32 v193, v193, v32
 v_sub_f32 v194, v194, v32
 v_sub_f32 v195, v195, v32
 v_sub_f32 v196, v196, v32
 v_sub_f32 v197, v197, v32
 v_sub_f32 v198, v198, v32
 v_sub_f32 v199, v199, v32
 v_mul_f32 v248, v248, v34
 v_mul_f32 v249, v249, v34
 v_mul_f32 v250, v250, v34
 v_mul_f32 v251, v251, v34
 v_accvgpr_read_b32 v33, a64
 v_mul_f32 v33, v33, v34
 v_accvgpr_write_b32 a64, v33
 v_accvgpr_read_b32 v33, a65
 v_mul_f32 v33, v33, v34
 v_accvgpr_write_b32 a65, v33
 v_accvgpr_read_b32 v33, a66
 v_mul_f32 v33, v33, v34
 v_accvgpr_write_b32 a66, v33
 v_accvgpr_read_b32 v33, a67
 v_mul_f32 v33, v33, v34
 v_accvgpr_write_b32 a67, v33
 v_accvgpr_read_b32 v33, a68
 v_mul_f32 v33, v33, v34
 v_accvgpr_write_b32 a68, v33
 v_accvgpr_read_b32 v33, a69
 v_mul_f32 v33, v33, v34
 v_accvgpr_write_b32 a69, v33
 v_accvgpr_read_b32 v33, a70
 v_mul_f32 v33, v33, v34
 v_accvgpr_write_b32 a70, v33
 v_accvgpr_read_b32 v33, a71
 v_mul_f32 v33, v33, v34
 v_accvgpr_write_b32 a71, v33
 v_accvgpr_read_b32 v33, a72
 v_mul_f32 v33, v33, v34
 v_accvgpr_write_b32 a72, v33
 v_accvgpr_read_b32 v33, a73
 v_mul_f32 v33, v33, v34
 v_accvgpr_write_b32 a73, v33
 v_accvgpr_read_b32 v33, a74
 v_mul_f32 v33, v33, v34
 v_accvgpr_write_b32 a74, v33
 v_accvgpr_read_b32 v33, a75
 v_mul_f32 v33, v33, v34
 v_accvgpr_write_b32 a75, v33
 v_accvgpr_read_b32 v33, a76
 v_mul_f32 v33, v33, v34
 v_accvgpr_write_b32 a76, v33
 v_accvgpr_read_b32 v33, a77
 v_mul_f32 v33, v33, v34
 v_accvgpr_write_b32 a77, v33
 v_accvgpr_read_b32 v33, a78
 v_mul_f32 v33, v33, v34
 v_accvgpr_write_b32 a78, v33
 v_accvgpr_read_b32 v33, a79
 v_mul_f32 v33, v33, v34
 v_accvgpr_write_b32 a79, v33
 v_accvgpr_read_b32 v33, a80
 v_mul_f32 v33, v33, v34
 v_accvgpr_write_b32 a80, v33
 v_accvgpr_read_b32 v33, a81
 v_mul_f32 v33, v33, v34
 v_accvgpr_write_b32 a81, v33
 v_accvgpr_read_b32 v33, a82
 v_mul_f32 v33, v33, v34
 v_accvgpr_write_b32 a82, v33
 v_accvgpr_read_b32 v33, a83
 v_mul_f32 v33, v33, v34
 v_accvgpr_write_b32 a83, v33
 v_accvgpr_read_b32 v33, a84
 v_mul_f32 v33, v33, v34
 v_accvgpr_write_b32 a84, v33
 v_accvgpr_read_b32 v33, a85
 v_mul_f32 v33, v33, v34
 v_accvgpr_write_b32 a85, v33
 v_accvgpr_read_b32 v33, a86
 v_mul_f32 v33, v33, v34
 v_accvgpr_write_b32 a86, v33
 v_accvgpr_read_b32 v33, a87
 v_mul_f32 v33, v33, v34
 v_accvgpr_write_b32 a87, v33
 v_accvgpr_read_b32 v33, a88
 v_mul_f32 v33, v33, v34
 v_accvgpr_write_b32 a88, v33
 v_accvgpr_read_b32 v33, a89
 v_mul_f32 v33, v33, v34
 v_accvgpr_write_b32 a89, v33
 v_accvgpr_read_b32 v33, a90
 v_mul_f32 v33, v33, v34
 v_accvgpr_write_b32 a90, v33
 v_accvgpr_read_b32 v33, a91
 v_mul_f32 v33, v33, v34
 v_accvgpr_write_b32 a91, v33
 v_accvgpr_read_b32 v33, a92
 v_mul_f32 v33, v33, v34
 v_accvgpr_write_b32 a92, v33
 v_accvgpr_read_b32 v33, a93
 v_mul_f32 v33, v33, v34
 v_accvgpr_write_b32 a93, v33
 v_accvgpr_read_b32 v33, a94
 v_mul_f32 v33, v33, v34
 v_accvgpr_write_b32 a94, v33
 v_accvgpr_read_b32 v33, a95
 v_mul_f32 v33, v33, v34
 v_accvgpr_write_b32 a95, v33
 v_exp_f32 v36, v160
 v_exp_f32 v37, v161
 s_nop 0
 v_cvt_pk_bf16_f32 v216, v36, v37
 v_exp_f32 v36, v162
 v_exp_f32 v37, v163
 s_nop 0
 v_cvt_pk_bf16_f32 v217, v36, v37
 v_exp_f32 v36, v164
 v_exp_f32 v37, v165
 s_nop 0
 v_cvt_pk_bf16_f32 v218, v36, v37
 v_exp_f32 v36, v166
 v_exp_f32 v37, v167
 s_nop 0
 v_cvt_pk_bf16_f32 v219, v36, v37
 v_max3_f32 v32, v168, v169, v170
 v_max3_f32 v32, v171, v172, v32
 v_max3_f32 v32, v173, v174, v32
 v_max_f32 v32, v175, v32
 v_mov_b32 v33, v32
 s_nop 1
 v_permlane16_swap_b32 v32, v33
 s_nop 1
 v_max_f32 v32, v32, v33
 v_mov_b32 v33, v32
 s_nop 1
 v_permlane32_swap_b32 v32, v33
 s_nop 1
 v_max_f32 v32, v32, v33
 v_add_f32 v32, 0x41c00000, v32
 v_max_f32 v32, 0, v32
 v_exp_f32 v34, -v32
 v_sub_f32 v76, v76, v32
 v_sub_f32 v77, v77, v32
 v_sub_f32 v78, v78, v32
 v_sub_f32 v79, v79, v32
 v_sub_f32 v168, v168, v32
 v_sub_f32 v169, v169, v32
 v_sub_f32 v170, v170, v32
 v_sub_f32 v171, v171, v32
 v_sub_f32 v172, v172, v32
 v_sub_f32 v173, v173, v32
 v_sub_f32 v174, v174, v32
 v_sub_f32 v175, v175, v32
 v_sub_f32 v200, v200, v32
 v_sub_f32 v201, v201, v32
 v_sub_f32 v202, v202, v32
 v_sub_f32 v203, v203, v32
 v_sub_f32 v204, v204, v32
 v_sub_f32 v205, v205, v32
 v_sub_f32 v206, v206, v32
 v_sub_f32 v207, v207, v32
 v_mul_f32 v252, v252, v34
 v_mul_f32 v253, v253, v34
 v_mul_f32 v254, v254, v34
 v_mul_f32 v255, v255, v34
 v_accvgpr_read_b32 v33, a96
 v_mul_f32 v33, v33, v34
 v_accvgpr_write_b32 a96, v33
 v_accvgpr_read_b32 v33, a97
 v_mul_f32 v33, v33, v34
 v_accvgpr_write_b32 a97, v33
 v_accvgpr_read_b32 v33, a98
 v_mul_f32 v33, v33, v34
 v_accvgpr_write_b32 a98, v33
 v_accvgpr_read_b32 v33, a99
 v_mul_f32 v33, v33, v34
 v_accvgpr_write_b32 a99, v33
 v_accvgpr_read_b32 v33, a100
 v_mul_f32 v33, v33, v34
 v_accvgpr_write_b32 a100, v33
 v_accvgpr_read_b32 v33, a101
 v_mul_f32 v33, v33, v34
 v_accvgpr_write_b32 a101, v33
 v_accvgpr_read_b32 v33, a102
 v_mul_f32 v33, v33, v34
 v_accvgpr_write_b32 a102, v33
 v_accvgpr_read_b32 v33, a103
 v_mul_f32 v33, v33, v34
 v_accvgpr_write_b32 a103, v33
 v_accvgpr_read_b32 v33, a104
 v_mul_f32 v33, v33, v34
 v_accvgpr_write_b32 a104, v33
 v_accvgpr_read_b32 v33, a105
 v_mul_f32 v33, v33, v34
 v_accvgpr_write_b32 a105, v33
 v_accvgpr_read_b32 v33, a106
 v_mul_f32 v33, v33, v34
 v_accvgpr_write_b32 a106, v33
 v_accvgpr_read_b32 v33, a107
 v_mul_f32 v33, v33, v34
 v_accvgpr_write_b32 a107, v33
 v_accvgpr_read_b32 v33, a108
 v_mul_f32 v33, v33, v34
 v_accvgpr_write_b32 a108, v33
 v_accvgpr_read_b32 v33, a109
 v_mul_f32 v33, v33, v34
 v_accvgpr_write_b32 a109, v33
 v_accvgpr_read_b32 v33, a110
 v_mul_f32 v33, v33, v34
 v_accvgpr_write_b32 a110, v33
 v_accvgpr_read_b32 v33, a111
 v_mul_f32 v33, v33, v34
 v_accvgpr_write_b32 a111, v33
 v_accvgpr_read_b32 v33, a112
 v_mul_f32 v33, v33, v34
 v_accvgpr_write_b32 a112, v33
 v_accvgpr_read_b32 v33, a113
 v_mul_f32 v33, v33, v34
 v_accvgpr_write_b32 a113, v33
 v_accvgpr_read_b32 v33, a114
 v_mul_f32 v33, v33, v34
 v_accvgpr_write_b32 a114, v33
 v_accvgpr_read_b32 v33, a115
 v_mul_f32 v33, v33, v34
 v_accvgpr_write_b32 a115, v33
 v_accvgpr_read_b32 v33, a116
 v_mul_f32 v33, v33, v34
 v_accvgpr_write_b32 a116, v33
 v_accvgpr_read_b32 v33, a117
 v_mul_f32 v33, v33, v34
 v_accvgpr_write_b32 a117, v33
 v_accvgpr_read_b32 v33, a118
 v_mul_f32 v33, v33, v34
 v_accvgpr_write_b32 a118, v33
 v_accvgpr_read_b32 v33, a119
 v_mul_f32 v33, v33, v34
 v_accvgpr_write_b32 a119, v33
 v_accvgpr_read_b32 v33, a120
 v_mul_f32 v33, v33, v34
 v_accvgpr_write_b32 a120, v33
 v_accvgpr_read_b32 v33, a121
 v_mul_f32 v33, v33, v34
 v_accvgpr_write_b32 a121, v33
 v_accvgpr_read_b32 v33, a122
 v_mul_f32 v33, v33, v34
 v_accvgpr_write_b32 a122, v33
 v_accvgpr_read_b32 v33, a123
 v_mul_f32 v33, v33, v34
 v_accvgpr_write_b32 a123, v33
 v_accvgpr_read_b32 v33, a124
 v_mul_f32 v33, v33, v34
 v_accvgpr_write_b32 a124, v33
 v_accvgpr_read_b32 v33, a125
 v_mul_f32 v33, v33, v34
 v_accvgpr_write_b32 a125, v33
 v_accvgpr_read_b32 v33, a126
 v_mul_f32 v33, v33, v34
 v_accvgpr_write_b32 a126, v33
 v_accvgpr_read_b32 v33, a127
 v_mul_f32 v33, v33, v34
 v_accvgpr_write_b32 a127, v33
 v_exp_f32 v36, v168
 v_exp_f32 v37, v169
 s_nop 0
 v_cvt_pk_bf16_f32 v220, v36, v37
 v_exp_f32 v36, v170
 v_exp_f32 v37, v171
 s_nop 0
 v_cvt_pk_bf16_f32 v221, v36, v37
 v_exp_f32 v36, v172
 v_exp_f32 v37, v173
 s_nop 0
 v_cvt_pk_bf16_f32 v222, v36, v37
 v_exp_f32 v36, v174
 v_exp_f32 v37, v175
 s_nop 0
 v_cvt_pk_bf16_f32 v223, v36, v37
 s_nop 1
 s_branch L_b3_r0_ret
L_b3_r1:
 s_nop 7
 v_max3_f32 v32, v184, v185, v186
 v_max3_f32 v32, v187, v188, v32
 v_max3_f32 v32, v189, v190, v32
 v_max_f32 v32, v191, v32
 v_mov_b32 v33, v32
 s_nop 1
 v_permlane16_swap_b32 v32, v33
 s_nop 1
 v_max_f32 v32, v32, v33
 v_mov_b32 v33, v32
 s_nop 1
 v_permlane32_swap_b32 v32, v33
 s_nop 1
 v_max_f32 v32, v32, v33
 v_add_f32 v32, 0x41c00000, v32
 v_max_f32 v32, 0, v32
 v_exp_f32 v34, -v32
 v_sub_f32 v68, v68, v32
 v_sub_f32 v69, v69, v32
 v_sub_f32 v70, v70, v32
 v_sub_f32 v71, v71, v32
 v_sub_f32 v184, v184, v32
 v_sub_f32 v185, v185, v32
 v_sub_f32 v186, v186, v32
 v_sub_f32 v187, v187, v32
 v_sub_f32 v188, v188, v32
 v_sub_f32 v189, v189, v32
 v_sub_f32 v190, v190, v32
 v_sub_f32 v191, v191, v32
 v_sub_f32 v152, v152, v32
 v_sub_f32 v153, v153, v32
 v_sub_f32 v154, v154, v32
 v_sub_f32 v155, v155, v32
 v_sub_f32 v156, v156, v32
 v_sub_f32 v157, v157, v32
 v_sub_f32 v158, v158, v32
 v_sub_f32 v159, v159, v32
 v_mul_f32 v244, v244, v34
 v_mul_f32 v245, v245, v34
 v_mul_f32 v246, v246, v34
 v_mul_f32 v247, v247, v34
 v_accvgpr_read_b32 v33, a32
 v_mul_f32 v33, v33, v34
 v_accvgpr_write_b32 a32, v33
 v_accvgpr_read_b32 v33, a33
 v_mul_f32 v33, v33, v34
 v_accvgpr_write_b32 a33, v33
 v_accvgpr_read_b32 v33, a34
 v_mul_f32 v33, v33, v34
 v_accvgpr_write_b32 a34, v33
 v_accvgpr_read_b32 v33, a35
 v_mul_f32 v33, v33, v34
 v_accvgpr_write_b32 a35, v33
 v_accvgpr_read_b32 v33, a36
 v_mul_f32 v33, v33, v34
 v_accvgpr_write_b32 a36, v33
 v_accvgpr_read_b32 v33, a37
 v_mul_f32 v33, v33, v34
 v_accvgpr_write_b32 a37, v33
 v_accvgpr_read_b32 v33, a38
 v_mul_f32 v33, v33, v34
 v_accvgpr_write_b32 a38, v33
 v_accvgpr_read_b32 v33, a39
 v_mul_f32 v33, v33, v34
 v_accvgpr_write_b32 a39, v33
 v_accvgpr_read_b32 v33, a40
 v_mul_f32 v33, v33, v34
 v_accvgpr_write_b32 a40, v33
 v_accvgpr_read_b32 v33, a41
 v_mul_f32 v33, v33, v34
 v_accvgpr_write_b32 a41, v33
 v_accvgpr_read_b32 v33, a42
 v_mul_f32 v33, v33, v34
 v_accvgpr_write_b32 a42, v33
 v_accvgpr_read_b32 v33, a43
 v_mul_f32 v33, v33, v34
 v_accvgpr_write_b32 a43, v33
 v_accvgpr_read_b32 v33, a44
 v_mul_f32 v33, v33, v34
 v_accvgpr_write_b32 a44, v33
 v_accvgpr_read_b32 v33, a45
 v_mul_f32 v33, v33, v34
 v_accvgpr_write_b32 a45, v33
 v_accvgpr_read_b32 v33, a46
 v_mul_f32 v33, v33, v34
 v_accvgpr_write_b32 a46, v33
 v_accvgpr_read_b32 v33, a47
 v_mul_f32 v33, v33, v34
 v_accvgpr_write_b32 a47, v33
 v_accvgpr_read_b32 v33, a48
 v_mul_f32 v33, v33, v34
 v_accvgpr_write_b32 a48, v33
 v_accvgpr_read_b32 v33, a49
 v_mul_f32 v33, v33, v34
 v_accvgpr_write_b32 a49, v33
 v_accvgpr_read_b32 v33, a50
 v_mul_f32 v33, v33, v34
 v_accvgpr_write_b32 a50, v33
 v_accvgpr_read_b32 v33, a51
 v_mul_f32 v33, v33, v34
 v_accvgpr_write_b32 a51, v33
 v_accvgpr_read_b32 v33, a52
 v_mul_f32 v33, v33, v34
 v_accvgpr_write_b32 a52, v33
 v_accvgpr_read_b32 v33, a53
 v_mul_f32 v33, v33, v34
 v_accvgpr_write_b32 a53, v33
 v_accvgpr_read_b32 v33, a54
 v_mul_f32 v33, v33, v34
 v_accvgpr_write_b32 a54, v33
 v_accvgpr_read_b32 v33, a55
 v_mul_f32 v33, v33, v34
 v_accvgpr_write_b32 a55, v33
 v_accvgpr_read_b32 v33, a56
 v_mul_f32 v33, v33, v34
 v_accvgpr_write_b32 a56, v33
 v_accvgpr_read_b32 v33, a57
 v_mul_f32 v33, v33, v34
 v_accvgpr_write_b32 a57, v33
 v_accvgpr_read_b32 v33, a58
 v_mul_f32 v33, v33, v34
 v_accvgpr_write_b32 a58, v33
 v_accvgpr_read_b32 v33, a59
 v_mul_f32 v33, v33, v34
 v_accvgpr_write_b32 a59, v33
 v_accvgpr_read_b32 v33, a60
 v_mul_f32 v33, v33, v34
 v_accvgpr_write_b32 a60, v33
 v_accvgpr_read_b32 v33, a61
 v_mul_f32 v33, v33, v34
 v_accvgpr_write_b32 a61, v33
 v_accvgpr_read_b32 v33, a62
 v_mul_f32 v33, v33, v34
 v_accvgpr_write_b32 a62, v33
 v_accvgpr_read_b32 v33, a63
 v_mul_f32 v33, v33, v34
 v_accvgpr_write_b32 a63, v33
 v_exp_f32 v36, v184
 v_exp_f32 v37, v185
 s_nop 0
 v_cvt_pk_bf16_f32 v228, v36, v37
 v_exp_f32 v36, v186
 v_exp_f32 v37, v187
 s_nop 0
 v_cvt_pk_bf16_f32 v229, v36, v37
 v_exp_f32 v36, v188
 v_exp_f32 v37, v189
 s_nop 0
 v_cvt_pk_bf16_f32 v230, v36, v37
 v_exp_f32 v36, v190
 v_exp_f32 v37, v191
 s_nop 0
 v_cvt_pk_bf16_f32 v231, v36, v37
 v_max3_f32 v32, v192, v193, v194
 v_max3_f32 v32, v195, v196, v32
 v_max3_f32 v32, v197, v198, v32
 v_max_f32 v32, v199, v32
 v_mov_b32 v33, v32
 s_nop 1
 v_permlane16_swap_b32 v32, v33
 s_nop 1
 v_max_f32 v32, v32, v33
 v_mov_b32 v33, v32
 s_nop 1
 v_permlane32_swap_b32 v32, v33
 s_nop 1
 v_max_f32 v32, v32, v33
 v_add_f32 v32, 0x41c00000, v32
 v_max_f32 v32, 0, v32
 v_exp_f32 v34, -v32
 v_sub_f32 v72, v72, v32
 v_sub_f32 v73, v73, v32
 v_sub_f32 v74, v74, v32
 v_sub_f32 v75, v75, v32
 v_sub_f32 v192, v192, v32
 v_sub_f32 v193, v193, v32
 v_sub_f32 v194, v194, v32
 v_sub_f32 v195, v195, v32
 v_sub_f32 v196, v196, v32
 v_sub_f32 v197, v197, v32
 v_sub_f32 v198, v198, v32
 v_sub_f32 v199, v199, v32
 v_sub_f32 v160, v160, v32
 v_sub_f32 v161, v161, v32
 v_sub_f32 v162, v162, v32
 v_sub_f32 v163, v163, v32
 v_sub_f32 v164, v164, v32
 v_sub_f32 v165, v165, v32
 v_sub_f32 v166, v166, v32
 v_sub_f32 v167, v167, v32
 v_mul_f32 v248, v248, v34
 v_mul_f32 v249, v249, v34
 v_mul_f32 v250, v250, v34
 v_mul_f32 v251, v251, v34
 v_accvgpr_read_b32 v33, a64
 v_mul_f32 v33, v33, v34
 v_accvgpr_write_b32 a64, v33
 v_accvgpr_read_b32 v33, a65
 v_mul_f32 v33, v33, v34
 v_accvgpr_write_b32 a65, v33
 v_accvgpr_read_b32 v33, a66
 v_mul_f32 v33, v33, v34
 v_accvgpr_write_b32 a66, v33
 v_accvgpr_read_b32 v33, a67
 v_mul_f32 v33, v33, v34
 v_accvgpr_write_b32 a67, v33
 v_accvgpr_read_b32 v33, a68
 v_mul_f32 v33, v33, v34
 v_accvgpr_write_b32 a68, v33
 v_accvgpr_read_b32 v33, a69
 v_mul_f32 v33, v33, v34
 v_accvgpr_write_b32 a69, v33
 v_accvgpr_read_b32 v33, a70
 v_mul_f32 v33, v33, v34
 v_accvgpr_write_b32 a70, v33
 v_accvgpr_read_b32 v33, a71
 v_mul_f32 v33, v33, v34
 v_accvgpr_write_b32 a71, v33
 v_accvgpr_read_b32 v33, a72
 v_mul_f32 v33, v33, v34
 v_accvgpr_write_b32 a72, v33
 v_accvgpr_read_b32 v33, a73
 v_mul_f32 v33, v33, v34
 v_accvgpr_write_b32 a73, v33
 v_accvgpr_read_b32 v33, a74
 v_mul_f32 v33, v33, v34
 v_accvgpr_write_b32 a74, v33
 v_accvgpr_read_b32 v33, a75
 v_mul_f32 v33, v33, v34
 v_accvgpr_write_b32 a75, v33
 v_accvgpr_read_b32 v33, a76
 v_mul_f32 v33, v33, v34
 v_accvgpr_write_b32 a76, v33
 v_accvgpr_read_b32 v33, a77
 v_mul_f32 v33, v33, v34
 v_accvgpr_write_b32 a77, v33
 v_accvgpr_read_b32 v33, a78
 v_mul_f32 v33, v33, v34
 v_accvgpr_write_b32 a78, v33
 v_accvgpr_read_b32 v33, a79
 v_mul_f32 v33, v33, v34
 v_accvgpr_write_b32 a79, v33
 v_accvgpr_read_b32 v33, a80
 v_mul_f32 v33, v33, v34
 v_accvgpr_write_b32 a80, v33
 v_accvgpr_read_b32 v33, a81
 v_mul_f32 v33, v33, v34
 v_accvgpr_write_b32 a81, v33
 v_accvgpr_read_b32 v33, a82
 v_mul_f32 v33, v33, v34
 v_accvgpr_write_b32 a82, v33
 v_accvgpr_read_b32 v33, a83
 v_mul_f32 v33, v33, v34
 v_accvgpr_write_b32 a83, v33
 v_accvgpr_read_b32 v33, a84
 v_mul_f32 v33, v33, v34
 v_accvgpr_write_b32 a84, v33
 v_accvgpr_read_b32 v33, a85
 v_mul_f32 v33, v33, v34
 v_accvgpr_write_b32 a85, v33
 v_accvgpr_read_b32 v33, a86
 v_mul_f32 v33, v33, v34
 v_accvgpr_write_b32 a86, v33
 v_accvgpr_read_b32 v33, a87
 v_mul_f32 v33, v33, v34
 v_accvgpr_write_b32 a87, v33
 v_accvgpr_read_b32 v33, a88
 v_mul_f32 v33, v33, v34
 v_accvgpr_write_b32 a88, v33
 v_accvgpr_read_b32 v33, a89
 v_mul_f32 v33, v33, v34
 v_accvgpr_write_b32 a89, v33
 v_accvgpr_read_b32 v33, a90
 v_mul_f32 v33, v33, v34
 v_accvgpr_write_b32 a90, v33
 v_accvgpr_read_b32 v33, a91
 v_mul_f32 v33, v33, v34
 v_accvgpr_write_b32 a91, v33
 v_accvgpr_read_b32 v33, a92
 v_mul_f32 v33, v33, v34
 v_accvgpr_write_b32 a92, v33
 v_accvgpr_read_b32 v33, a93
 v_mul_f32 v33, v33, v34
 v_accvgpr_write_b32 a93, v33
 v_accvgpr_read_b32 v33, a94
 v_mul_f32 v33, v33, v34
 v_accvgpr_write_b32 a94, v33
 v_accvgpr_read_b32 v33, a95
 v_mul_f32 v33, v33, v34
 v_accvgpr_write_b32 a95, v33
 v_exp_f32 v36, v192
 v_exp_f32 v37, v193
 s_nop 0
 v_cvt_pk_bf16_f32 v232, v36, v37
 v_exp_f32 v36, v194
 v_exp_f32 v37, v195
 s_nop 0
 v_cvt_pk_bf16_f32 v233, v36, v37
 v_exp_f32 v36, v196
 v_exp_f32 v37, v197
 s_nop 0
 v_cvt_pk_bf16_f32 v234, v36, v37
 v_exp_f32 v36, v198
 v_exp_f32 v37, v199
 s_nop 0
 v_cvt_pk_bf16_f32 v235, v36, v37
 v_max3_f32 v32, v200, v201, v202
 v_max3_f32 v32, v203, v204, v32
 v_max3_f32 v32, v205, v206, v32
 v_max_f32 v32, v207, v32
 v_mov_b32 v33, v32
 s_nop 1
 v_permlane16_swap_b32 v32, v33
 s_nop 1
 v_max_f32 v32, v32, v33
 v_mov_b32 v33, v32
 s_nop 1
 v_permlane32_swap_b32 v32, v33
 s_nop 1
 v_max_f32 v32, v32, v33
 v_add_f32 v32, 0x41c00000, v32
 v_max_f32 v32, 0, v32
 v_exp_f32 v34, -v32
 v_sub_f32 v76, v76, v32
 v_sub_f32 v77, v77, v32
 v_sub_f32 v78, v78, v32
 v_sub_f32 v79, v79, v32
 v_sub_f32 v200, v200, v32
 v_sub_f32 v201, v201, v32
 v_sub_f32 v202, v202, v32
 v_sub_f32 v203, v203, v32
 v_sub_f32 v204, v204, v32
 v_sub_f32 v205, v205, v32
 v_sub_f32 v206, v206, v32
 v_sub_f32 v207, v207, v32
 v_sub_f32 v168, v168, v32
 v_sub_f32 v169, v169, v32
 v_sub_f32 v170, v170, v32
 v_sub_f32 v171, v171, v32
 v_sub_f32 v172, v172, v32
 v_sub_f32 v173, v173, v32
 v_sub_f32 v174, v174, v32
 v_sub_f32 v175, v175, v32
 v_mul_f32 v252, v252, v34
 v_mul_f32 v253, v253, v34
 v_mul_f32 v254, v254, v34
 v_mul_f32 v255, v255, v34
 v_accvgpr_read_b32 v33, a96
 v_mul_f32 v33, v33, v34
 v_accvgpr_write_b32 a96, v33
 v_accvgpr_read_b32 v33, a97
 v_mul_f32 v33, v33, v34
 v_accvgpr_write_b32 a97, v33
 v_accvgpr_read_b32 v33, a98
 v_mul_f32 v33, v33, v34
 v_accvgpr_write_b32 a98, v33
 v_accvgpr_read_b32 v33, a99
 v_mul_f32 v33, v33, v34
 v_accvgpr_write_b32 a99, v33
 v_accvgpr_read_b32 v33, a100
 v_mul_f32 v33, v33, v34
 v_accvgpr_write_b32 a100, v33
 v_accvgpr_read_b32 v33, a101
 v_mul_f32 v33, v33, v34
 v_accvgpr_write_b32 a101, v33
 v_accvgpr_read_b32 v33, a102
 v_mul_f32 v33, v33, v34
 v_accvgpr_write_b32 a102, v33
 v_accvgpr_read_b32 v33, a103
 v_mul_f32 v33, v33, v34
 v_accvgpr_write_b32 a103, v33
 v_accvgpr_read_b32 v33, a104
 v_mul_f32 v33, v33, v34
 v_accvgpr_write_b32 a104, v33
 v_accvgpr_read_b32 v33, a105
 v_mul_f32 v33, v33, v34
 v_accvgpr_write_b32 a105, v33
 v_accvgpr_read_b32 v33, a106
 v_mul_f32 v33, v33, v34
 v_accvgpr_write_b32 a106, v33
 v_accvgpr_read_b32 v33, a107
 v_mul_f32 v33, v33, v34
 v_accvgpr_write_b32 a107, v33
 v_accvgpr_read_b32 v33, a108
 v_mul_f32 v33, v33, v34
 v_accvgpr_write_b32 a108, v33
 v_accvgpr_read_b32 v33, a109
 v_mul_f32 v33, v33, v34
 v_accvgpr_write_b32 a109, v33
 v_accvgpr_read_b32 v33, a110
 v_mul_f32 v33, v33, v34
 v_accvgpr_write_b32 a110, v33
 v_accvgpr_read_b32 v33, a111
 v_mul_f32 v33, v33, v34
 v_accvgpr_write_b32 a111, v33
 v_accvgpr_read_b32 v33, a112
 v_mul_f32 v33, v33, v34
 v_accvgpr_write_b32 a112, v33
 v_accvgpr_read_b32 v33, a113
 v_mul_f32 v33, v33, v34
 v_accvgpr_write_b32 a113, v33
 v_accvgpr_read_b32 v33, a114
 v_mul_f32 v33, v33, v34
 v_accvgpr_write_b32 a114, v33
 v_accvgpr_read_b32 v33, a115
 v_mul_f32 v33, v33, v34
 v_accvgpr_write_b32 a115, v33
 v_accvgpr_read_b32 v33, a116
 v_mul_f32 v33, v33, v34
 v_accvgpr_write_b32 a116, v33
 v_accvgpr_read_b32 v33, a117
 v_mul_f32 v33, v33, v34
 v_accvgpr_write_b32 a117, v33
 v_accvgpr_read_b32 v33, a118
 v_mul_f32 v33, v33, v34
 v_accvgpr_write_b32 a118, v33
 v_accvgpr_read_b32 v33, a119
 v_mul_f32 v33, v33, v34
 v_accvgpr_write_b32 a119, v33
 v_accvgpr_read_b32 v33, a120
 v_mul_f32 v33, v33, v34
 v_accvgpr_write_b32 a120, v33
 v_accvgpr_read_b32 v33, a121
 v_mul_f32 v33, v33, v34
 v_accvgpr_write_b32 a121, v33
 v_accvgpr_read_b32 v33, a122
 v_mul_f32 v33, v33, v34
 v_accvgpr_write_b32 a122, v33
 v_accvgpr_read_b32 v33, a123
 v_mul_f32 v33, v33, v34
 v_accvgpr_write_b32 a123, v33
 v_accvgpr_read_b32 v33, a124
 v_mul_f32 v33, v33, v34
 v_accvgpr_write_b32 a124, v33
 v_accvgpr_read_b32 v33, a125
 v_mul_f32 v33, v33, v34
 v_accvgpr_write_b32 a125, v33
 v_accvgpr_read_b32 v33, a126
 v_mul_f32 v33, v33, v34
 v_accvgpr_write_b32 a126, v33
 v_accvgpr_read_b32 v33, a127
 v_mul_f32 v33, v33, v34
 v_accvgpr_write_b32 a127, v33
 v_exp_f32 v36, v200
 v_exp_f32 v37, v201
 s_nop 0
 v_cvt_pk_bf16_f32 v236, v36, v37
 v_exp_f32 v36, v202
 v_exp_f32 v37, v203
 s_nop 0
 v_cvt_pk_bf16_f32 v237, v36, v37
 v_exp_f32 v36, v204
 v_exp_f32 v37, v205
 s_nop 0
 v_cvt_pk_bf16_f32 v238, v36, v37
 v_exp_f32 v36, v206
 v_exp_f32 v37, v207
 s_nop 0
 v_cvt_pk_bf16_f32 v239, v36, v37
 s_nop 1
 s_branch L_b3_r1_ret
L_b2_r0:
 s_nop 7
 v_max3_f32 v32, v160, v161, v162
 v_max3_f32 v32, v163, v164, v32
 v_max3_f32 v32, v165, v166, v32
 v_max_f32 v32, v167, v32
 v_mov_b32 v33, v32
 s_nop 1
 v_permlane16_swap_b32 v32, v33
 s_nop 1
 v_max_f32 v32, v32, v33
 v_mov_b32 v33, v32
 s_nop 1
 v_permlane32_swap_b32 v32, v33
 s_nop 1
 v_max_f32 v32, v32, v33
 v_add_f32 v32, 0x41c00000, v32
 v_max_f32 v32, 0, v32
 v_exp_f32 v34, -v32
 v_sub_f32 v72, v72, v32
 v_sub_f32 v73, v73, v32
 v_sub_f32 v74, v74, v32
 v_sub_f32 v75, v75, v32
 v_sub_f32 v160, v160, v32
 v_sub_f32 v161, v161, v32
 v_sub_f32 v162, v162, v32
 v_sub_f32 v163, v163, v32
 v_sub_f32 v164, v164, v32
 v_sub_f32 v165, v165, v32
 v_sub_f32 v166, v166, v32
 v_sub_f32 v167, v167, v32
 v_sub_f32 v192, v192, v32
 v_sub_f32 v193, v193, v32
 v_sub_f32 v194, v194, v32
 v_sub_f32 v195, v195, v32
 v_sub_f32 v196, v196, v32
 v_sub_f32 v197, v197, v32
 v_sub_f32 v198, v198, v32
 v_sub_f32 v199, v199, v32
 v_mul_f32 v248, v248, v34
 v_mul_f32 v249, v249, v34
 v_mul_f32 v250, v250, v34
 v_mul_f32 v251, v251, v34
 v_accvgpr_read_b32 v33, a64
 v_mul_f32 v33, v33, v34
 v_accvgpr_write_b32 a64, v33
 v_accvgpr_read_b32 v33, a65
 v_mul_f32 v33, v33, v34
 v_accvgpr_write_b32 a65, v33
 v_accvgpr_read_b32 v33, a66
 v_mul_f32 v33, v33, v34
 v_accvgpr_write_b32 a66, v33
 v_accvgpr_read_b32 v33, a67
 v_mul_f32 v33, v33, v34
 v_accvgpr_write_b32 a67, v33
 v_accvgpr_read_b32 v33, a68
 v_mul_f32 v33, v33, v34
 v_accvgpr_write_b32 a68, v33
 v_accvgpr_read_b32 v33, a69
 v_mul_f32 v33, v33, v34
 v_accvgpr_write_b32 a69, v33
 v_accvgpr_read_b32 v33, a70
 v_mul_f32 v33, v33, v34
 v_accvgpr_write_b32 a70, v33
 v_accvgpr_read_b32 v33, a71
 v_mul_f32 v33, v33, v34
 v_accvgpr_write_b32 a71, v33
 v_accvgpr_read_b32 v33, a72
 v_mul_f32 v33, v33, v34
 v_accvgpr_write_b32 a72, v33
 v_accvgpr_read_b32 v33, a73
 v_mul_f32 v33, v33, v34
 v_accvgpr_write_b32 a73, v33
 v_accvgpr_read_b32 v33, a74
 v_mul_f32 v33, v33, v34
 v_accvgpr_write_b32 a74, v33
 v_accvgpr_read_b32 v33, a75
 v_mul_f32 v33, v33, v34
 v_accvgpr_write_b32 a75, v33
 v_accvgpr_read_b32 v33, a76
 v_mul_f32 v33, v33, v34
 v_accvgpr_write_b32 a76, v33
 v_accvgpr_read_b32 v33, a77
 v_mul_f32 v33, v33, v34
 v_accvgpr_write_b32 a77, v33
 v_accvgpr_read_b32 v33, a78
 v_mul_f32 v33, v33, v34
 v_accvgpr_write_b32 a78, v33
 v_accvgpr_read_b32 v33, a79
 v_mul_f32 v33, v33, v34
 v_accvgpr_write_b32 a79, v33
 v_accvgpr_read_b32 v33, a80
 v_mul_f32 v33, v33, v34
 v_accvgpr_write_b32 a80, v33
 v_accvgpr_read_b32 v33, a81
 v_mul_f32 v33, v33, v34
 v_accvgpr_write_b32 a81, v33
 v_accvgpr_read_b32 v33, a82
 v_mul_f32 v33, v33, v34
 v_accvgpr_write_b32 a82, v33
 v_accvgpr_read_b32 v33, a83
 v_mul_f32 v33, v33, v34
 v_accvgpr_write_b32 a83, v33
 v_accvgpr_read_b32 v33, a84
 v_mul_f32 v33, v33, v34
 v_accvgpr_write_b32 a84, v33
 v_accvgpr_read_b32 v33, a85
 v_mul_f32 v33, v33, v34
 v_accvgpr_write_b32 a85, v33
 v_accvgpr_read_b32 v33, a86
 v_mul_f32 v33, v33, v34
 v_accvgpr_write_b32 a86, v33
 v_accvgpr_read_b32 v33, a87
 v_mul_f32 v33, v33, v34
 v_accvgpr_write_b32 a87, v33
 v_accvgpr_read_b32 v33, a88
 v_mul_f32 v33, v33, v34
 v_accvgpr_write_b32 a88, v33
 v_accvgpr_read_b32 v33, a89
 v_mul_f32 v33, v33, v34
 v_accvgpr_write_b32 a89, v33
 v_accvgpr_read_b32 v33, a90
 v_mul_f32 v33, v33, v34
 v_accvgpr_write_b32 a90, v33
 v_accvgpr_read_b32 v33, a91
 v_mul_f32 v33, v33, v34
 v_accvgpr_write_b32 a91, v33
 v_accvgpr_read_b32 v33, a92
 v_mul_f32 v33, v33, v34
 v_accvgpr_write_b32 a92, v33
 v_accvgpr_read_b32 v33, a93
 v_mul_f32 v33, v33, v34
 v_accvgpr_write_b32 a93, v33
 v_accvgpr_read_b32 v33, a94
 v_mul_f32 v33, v33, v34
 v_accvgpr_write_b32 a94, v33
 v_accvgpr_read_b32 v33, a95
 v_mul_f32 v33, v33, v34
 v_accvgpr_write_b32 a95, v33
 v_exp_f32 v36, v160
 v_exp_f32 v37, v161
 s_nop 0
 v_cvt_pk_bf16_f32 v216, v36, v37
 v_exp_f32 v36, v162
 v_exp_f32 v37, v163
 s_nop 0
 v_cvt_pk_bf16_f32 v217, v36, v37
 v_exp_f32 v36, v164
 v_exp_f32 v37, v165
 s_nop 0
 v_cvt_pk_bf16_f32 v218, v36, v37
 v_exp_f32 v36, v166
 v_exp_f32 v37, v167
 s_nop 0
 v_cvt_pk_bf16_f32 v219, v36, v37
 v_max3_f32 v32, v168, v169, v170
 v_max3_f32 v32, v171, v172, v32
 v_max3_f32 v32, v173, v174, v32
 v_max_f32 v32, v175, v32
 v_mov_b32 v33, v32
 s_nop 1
 v_permlane16_swap_b32 v32, v33
 s_nop 1
 v_max_f32 v32, v32, v33
 v_mov_b32 v33, v32
 s_nop 1
 v_permlane32_swap_b32 v32, v33
 s_nop 1
 v_max_f32 v32, v32, v33
 v_add_f32 v32, 0x41c00000, v32
 v_max_f32 v32, 0, v32
 v_exp_f32 v34, -v32
 v_sub_f32 v76, v76, v32
 v_sub_f32 v77, v77, v32
 v_sub_f32 v78, v78, v32
 v_sub_f32 v79, v79, v32
 v_sub_f32 v168, v168, v32
 v_sub_f32 v169, v169, v32
 v_sub_f32 v170, v170, v32
 v_sub_f32 v171, v171, v32
 v_sub_f32 v172, v172, v32
 v_sub_f32 v173, v173, v32
 v_sub_f32 v174, v174, v32
 v_sub_f32 v175, v175, v32
 v_sub_f32 v200, v200, v32
 v_sub_f32 v201, v201, v32
 v_sub_f32 v202, v202, v32
 v_sub_f32 v203, v203, v32
 v_sub_f32 v204, v204, v32
 v_sub_f32 v205, v205, v32
 v_sub_f32 v206, v206, v32
 v_sub_f32 v207, v207, v32
 v_mul_f32 v252, v252, v34
 v_mul_f32 v253, v253, v34
 v_mul_f32 v254, v254, v34
 v_mul_f32 v255, v255, v34
 v_accvgpr_read_b32 v33, a96
 v_mul_f32 v33, v33, v34
 v_accvgpr_write_b32 a96, v33
 v_accvgpr_read_b32 v33, a97
 v_mul_f32 v33, v33, v34
 v_accvgpr_write_b32 a97, v33
 v_accvgpr_read_b32 v33, a98
 v_mul_f32 v33, v33, v34
 v_accvgpr_write_b32 a98, v33
 v_accvgpr_read_b32 v33, a99
 v_mul_f32 v33, v33, v34
 v_accvgpr_write_b32 a99, v33
 v_accvgpr_read_b32 v33, a100
 v_mul_f32 v33, v33, v34
 v_accvgpr_write_b32 a100, v33
 v_accvgpr_read_b32 v33, a101
 v_mul_f32 v33, v33, v34
 v_accvgpr_write_b32 a101, v33
 v_accvgpr_read_b32 v33, a102
 v_mul_f32 v33, v33, v34
 v_accvgpr_write_b32 a102, v33
 v_accvgpr_read_b32 v33, a103
 v_mul_f32 v33, v33, v34
 v_accvgpr_write_b32 a103, v33
 v_accvgpr_read_b32 v33, a104
 v_mul_f32 v33, v33, v34
 v_accvgpr_write_b32 a104, v33
 v_accvgpr_read_b32 v33, a105
 v_mul_f32 v33, v33, v34
 v_accvgpr_write_b32 a105, v33
 v_accvgpr_read_b32 v33, a106
 v_mul_f32 v33, v33, v34
 v_accvgpr_write_b32 a106, v33
 v_accvgpr_read_b32 v33, a107
 v_mul_f32 v33, v33, v34
 v_accvgpr_write_b32 a107, v33
 v_accvgpr_read_b32 v33, a108
 v_mul_f32 v33, v33, v34
 v_accvgpr_write_b32 a108, v33
 v_accvgpr_read_b32 v33, a109
 v_mul_f32 v33, v33, v34
 v_accvgpr_write_b32 a109, v33
 v_accvgpr_read_b32 v33, a110
 v_mul_f32 v33, v33, v34
 v_accvgpr_write_b32 a110, v33
 v_accvgpr_read_b32 v33, a111
 v_mul_f32 v33, v33, v34
 v_accvgpr_write_b32 a111, v33
 v_accvgpr_read_b32 v33, a112
 v_mul_f32 v33, v33, v34
 v_accvgpr_write_b32 a112, v33
 v_accvgpr_read_b32 v33, a113
 v_mul_f32 v33, v33, v34
 v_accvgpr_write_b32 a113, v33
 v_accvgpr_read_b32 v33, a114
 v_mul_f32 v33, v33, v34
 v_accvgpr_write_b32 a114, v33
 v_accvgpr_read_b32 v33, a115
 v_mul_f32 v33, v33, v34
 v_accvgpr_write_b32 a115, v33
 v_accvgpr_read_b32 v33, a116
 v_mul_f32 v33, v33, v34
 v_accvgpr_write_b32 a116, v33
 v_accvgpr_read_b32 v33, a117
 v_mul_f32 v33, v33, v34
 v_accvgpr_write_b32 a117, v33
 v_accvgpr_read_b32 v33, a118
 v_mul_f32 v33, v33, v34
 v_accvgpr_write_b32 a118, v33
 v_accvgpr_read_b32 v33, a119
 v_mul_f32 v33, v33, v34
 v_accvgpr_write_b32 a119, v33
 v_accvgpr_read_b32 v33, a120
 v_mul_f32 v33, v33, v34
 v_accvgpr_write_b32 a120, v33
 v_accvgpr_read_b32 v33, a121
 v_mul_f32 v33, v33, v34
 v_accvgpr_write_b32 a121, v33
 v_accvgpr_read_b32 v33, a122
 v_mul_f32 v33, v33, v34
 v_accvgpr_write_b32 a122, v33
 v_accvgpr_read_b32 v33, a123
 v_mul_f32 v33, v33, v34
 v_accvgpr_write_b32 a123, v33
 v_accvgpr_read_b32 v33, a124
 v_mul_f32 v33, v33, v34
 v_accvgpr_write_b32 a124, v33
 v_accvgpr_read_b32 v33, a125
 v_mul_f32 v33, v33, v34
 v_accvgpr_write_b32 a125, v33
 v_accvgpr_read_b32 v33, a126
 v_mul_f32 v33, v33, v34
 v_accvgpr_write_b32 a126, v33
 v_accvgpr_read_b32 v33, a127
 v_mul_f32 v33, v33, v34
 v_accvgpr_write_b32 a127, v33
 v_exp_f32 v36, v168
 v_exp_f32 v37, v169
 s_nop 0
 v_cvt_pk_bf16_f32 v220, v36, v37
 v_exp_f32 v36, v170
 v_exp_f32 v37, v171
 s_nop 0
 v_cvt_pk_bf16_f32 v221, v36, v37
 v_exp_f32 v36, v172
 v_exp_f32 v37, v173
 s_nop 0
 v_cvt_pk_bf16_f32 v222, v36, v37
 v_exp_f32 v36, v174
 v_exp_f32 v37, v175
 s_nop 0
 v_cvt_pk_bf16_f32 v223, v36, v37
 s_nop 1
 s_branch L_b2_r0_ret
L_b2_r1:
 s_nop 7
 v_max3_f32 v32, v192, v193, v194
 v_max3_f32 v32, v195, v196, v32
 v_max3_f32 v32, v197, v198, v32
 v_max_f32 v32, v199, v32
 v_mov_b32 v33, v32
 s_nop 1
 v_permlane16_swap_b32 v32, v33
 s_nop 1
 v_max_f32 v32, v32, v33
 v_mov_b32 v33, v32
 s_nop 1
 v_permlane32_swap_b32 v32, v33
 s_nop 1
 v_max_f32 v32, v32, v33
 v_add_f32 v32, 0x41c00000, v32
 v_max_f32 v32, 0, v32
 v_exp_f32 v34, -v32
 v_sub_f32 v72, v72, v32
 v_sub_f32 v73, v73, v32
 v_sub_f32 v74, v74, v32
 v_sub_f32 v75, v75, v32
 v_sub_f32 v192, v192, v32
 v_sub_f32 v193, v193, v32
 v_sub_f32 v194, v194, v32
 v_sub_f32 v195, v195, v32
 v_sub_f32 v196, v196, v32
 v_sub_f32 v197, v197, v32
 v_sub_f32 v198, v198, v32
 v_sub_f32 v199, v199, v32
 v_sub_f32 v160, v160, v32
 v_sub_f32 v161, v161, v32
 v_sub_f32 v162, v162, v32
 v_sub_f32 v163, v163, v32
 v_sub_f32 v164, v164, v32
 v_sub_f32 v165, v165, v32
 v_sub_f32 v166, v166, v32
 v_sub_f32 v167, v167, v32
 v_mul_f32 v248, v248, v34
 v_mul_f32 v249, v249, v34
 v_mul_f32 v250, v250, v34
 v_mul_f32 v251, v251, v34
 v_accvgpr_read_b32 v33, a64
 v_mul_f32 v33, v33, v34
 v_accvgpr_write_b32 a64, v33
 v_accvgpr_read_b32 v33, a65
 v_mul_f32 v33, v33, v34
 v_accvgpr_write_b32 a65, v33
 v_accvgpr_read_b32 v33, a66
 v_mul_f32 v33, v33, v34
 v_accvgpr_write_b32 a66, v33
 v_accvgpr_read_b32 v33, a67
 v_mul_f32 v33, v33, v34
 v_accvgpr_write_b32 a67, v33
 v_accvgpr_read_b32 v33, a68
 v_mul_f32 v33, v33, v34
 v_accvgpr_write_b32 a68, v33
 v_accvgpr_read_b32 v33, a69
 v_mul_f32 v33, v33, v34
 v_accvgpr_write_b32 a69, v33
 v_accvgpr_read_b32 v33, a70
 v_mul_f32 v33, v33, v34
 v_accvgpr_write_b32 a70, v33
 v_accvgpr_read_b32 v33, a71
 v_mul_f32 v33, v33, v34
 v_accvgpr_write_b32 a71, v33
 v_accvgpr_read_b32 v33, a72
 v_mul_f32 v33, v33, v34
 v_accvgpr_write_b32 a72, v33
 v_accvgpr_read_b32 v33, a73
 v_mul_f32 v33, v33, v34
 v_accvgpr_write_b32 a73, v33
 v_accvgpr_read_b32 v33, a74
 v_mul_f32 v33, v33, v34
 v_accvgpr_write_b32 a74, v33
 v_accvgpr_read_b32 v33, a75
 v_mul_f32 v33, v33, v34
 v_accvgpr_write_b32 a75, v33
 v_accvgpr_read_b32 v33, a76
 v_mul_f32 v33, v33, v34
 v_accvgpr_write_b32 a76, v33
 v_accvgpr_read_b32 v33, a77
 v_mul_f32 v33, v33, v34
 v_accvgpr_write_b32 a77, v33
 v_accvgpr_read_b32 v33, a78
 v_mul_f32 v33, v33, v34
 v_accvgpr_write_b32 a78, v33
 v_accvgpr_read_b32 v33, a79
 v_mul_f32 v33, v33, v34
 v_accvgpr_write_b32 a79, v33
 v_accvgpr_read_b32 v33, a80
 v_mul_f32 v33, v33, v34
 v_accvgpr_write_b32 a80, v33
 v_accvgpr_read_b32 v33, a81
 v_mul_f32 v33, v33, v34
 v_accvgpr_write_b32 a81, v33
 v_accvgpr_read_b32 v33, a82
 v_mul_f32 v33, v33, v34
 v_accvgpr_write_b32 a82, v33
 v_accvgpr_read_b32 v33, a83
 v_mul_f32 v33, v33, v34
 v_accvgpr_write_b32 a83, v33
 v_accvgpr_read_b32 v33, a84
 v_mul_f32 v33, v33, v34
 v_accvgpr_write_b32 a84, v33
 v_accvgpr_read_b32 v33, a85
 v_mul_f32 v33, v33, v34
 v_accvgpr_write_b32 a85, v33
 v_accvgpr_read_b32 v33, a86
 v_mul_f32 v33, v33, v34
 v_accvgpr_write_b32 a86, v33
 v_accvgpr_read_b32 v33, a87
 v_mul_f32 v33, v33, v34
 v_accvgpr_write_b32 a87, v33
 v_accvgpr_read_b32 v33, a88
 v_mul_f32 v33, v33, v34
 v_accvgpr_write_b32 a88, v33
 v_accvgpr_read_b32 v33, a89
 v_mul_f32 v33, v33, v34
 v_accvgpr_write_b32 a89, v33
 v_accvgpr_read_b32 v33, a90
 v_mul_f32 v33, v33, v34
 v_accvgpr_write_b32 a90, v33
 v_accvgpr_read_b32 v33, a91
 v_mul_f32 v33, v33, v34
 v_accvgpr_write_b32 a91, v33
 v_accvgpr_read_b32 v33, a92
 v_mul_f32 v33, v33, v34
 v_accvgpr_write_b32 a92, v33
 v_accvgpr_read_b32 v33, a93
 v_mul_f32 v33, v33, v34
 v_accvgpr_write_b32 a93, v33
 v_accvgpr_read_b32 v33, a94
 v_mul_f32 v33, v33, v34
 v_accvgpr_write_b32 a94, v33
 v_accvgpr_read_b32 v33, a95
 v_mul_f32 v33, v33, v34
 v_accvgpr_write_b32 a95, v33
 v_exp_f32 v36, v192
 v_exp_f32 v37, v193
 s_nop 0
 v_cvt_pk_bf16_f32 v232, v36, v37
 v_exp_f32 v36, v194
 v_exp_f32 v37, v195
 s_nop 0
 v_cvt_pk_bf16_f32 v233, v36, v37
 v_exp_f32 v36, v196
 v_exp_f32 v37, v197
 s_nop 0
 v_cvt_pk_bf16_f32 v234, v36, v37
 v_exp_f32 v36, v198
 v_exp_f32 v37, v199
 s_nop 0
 v_cvt_pk_bf16_f32 v235, v36, v37
 v_max3_f32 v32, v200, v201, v202
 v_max3_f32 v32, v203, v204, v32
 v_max3_f32 v32, v205, v206, v32
 v_max_f32 v32, v207, v32
 v_mov_b32 v33, v32
 s_nop 1
 v_permlane16_swap_b32 v32, v33
 s_nop 1
 v_max_f32 v32, v32, v33
 v_mov_b32 v33, v32
 s_nop 1
 v_permlane32_swap_b32 v32, v33
 s_nop 1
 v_max_f32 v32, v32, v33
 v_add_f32 v32, 0x41c00000, v32
 v_max_f32 v32, 0, v32
 v_exp_f32 v34, -v32
 v_sub_f32 v76, v76, v32
 v_sub_f32 v77, v77, v32
 v_sub_f32 v78, v78, v32
 v_sub_f32 v79, v79, v32
 v_sub_f32 v200, v200, v32
 v_sub_f32 v201, v201, v32
 v_sub_f32 v202, v202, v32
 v_sub_f32 v203, v203, v32
 v_sub_f32 v204, v204, v32
 v_sub_f32 v205, v205, v32
 v_sub_f32 v206, v206, v32
 v_sub_f32 v207, v207, v32
 v_sub_f32 v168, v168, v32
 v_sub_f32 v169, v169, v32
 v_sub_f32 v170, v170, v32
 v_sub_f32 v171, v171, v32
 v_sub_f32 v172, v172, v32
 v_sub_f32 v173, v173, v32
 v_sub_f32 v174, v174, v32
 v_sub_f32 v175, v175, v32
 v_mul_f32 v252, v252, v34
 v_mul_f32 v253, v253, v34
 v_mul_f32 v254, v254, v34
 v_mul_f32 v255, v255, v34
 v_accvgpr_read_b32 v33, a96
 v_mul_f32 v33, v33, v34
 v_accvgpr_write_b32 a96, v33
 v_accvgpr_read_b32 v33, a97
 v_mul_f32 v33, v33, v34
 v_accvgpr_write_b32 a97, v33
 v_accvgpr_read_b32 v33, a98
 v_mul_f32 v33, v33, v34
 v_accvgpr_write_b32 a98, v33
 v_accvgpr_read_b32 v33, a99
 v_mul_f32 v33, v33, v34
 v_accvgpr_write_b32 a99, v33
 v_accvgpr_read_b32 v33, a100
 v_mul_f32 v33, v33, v34
 v_accvgpr_write_b32 a100, v33
 v_accvgpr_read_b32 v33, a101
 v_mul_f32 v33, v33, v34
 v_accvgpr_write_b32 a101, v33
 v_accvgpr_read_b32 v33, a102
 v_mul_f32 v33, v33, v34
 v_accvgpr_write_b32 a102, v33
 v_accvgpr_read_b32 v33, a103
 v_mul_f32 v33, v33, v34
 v_accvgpr_write_b32 a103, v33
 v_accvgpr_read_b32 v33, a104
 v_mul_f32 v33, v33, v34
 v_accvgpr_write_b32 a104, v33
 v_accvgpr_read_b32 v33, a105
 v_mul_f32 v33, v33, v34
 v_accvgpr_write_b32 a105, v33
 v_accvgpr_read_b32 v33, a106
 v_mul_f32 v33, v33, v34
 v_accvgpr_write_b32 a106, v33
 v_accvgpr_read_b32 v33, a107
 v_mul_f32 v33, v33, v34
 v_accvgpr_write_b32 a107, v33
 v_accvgpr_read_b32 v33, a108
 v_mul_f32 v33, v33, v34
 v_accvgpr_write_b32 a108, v33
 v_accvgpr_read_b32 v33, a109
 v_mul_f32 v33, v33, v34
 v_accvgpr_write_b32 a109, v33
 v_accvgpr_read_b32 v33, a110
 v_mul_f32 v33, v33, v34
 v_accvgpr_write_b32 a110, v33
 v_accvgpr_read_b32 v33, a111
 v_mul_f32 v33, v33, v34
 v_accvgpr_write_b32 a111, v33
 v_accvgpr_read_b32 v33, a112
 v_mul_f32 v33, v33, v34
 v_accvgpr_write_b32 a112, v33
 v_accvgpr_read_b32 v33, a113
 v_mul_f32 v33, v33, v34
 v_accvgpr_write_b32 a113, v33
 v_accvgpr_read_b32 v33, a114
 v_mul_f32 v33, v33, v34
 v_accvgpr_write_b32 a114, v33
 v_accvgpr_read_b32 v33, a115
 v_mul_f32 v33, v33, v34
 v_accvgpr_write_b32 a115, v33
 v_accvgpr_read_b32 v33, a116
 v_mul_f32 v33, v33, v34
 v_accvgpr_write_b32 a116, v33
 v_accvgpr_read_b32 v33, a117
 v_mul_f32 v33, v33, v34
 v_accvgpr_write_b32 a117, v33
 v_accvgpr_read_b32 v33, a118
 v_mul_f32 v33, v33, v34
 v_accvgpr_write_b32 a118, v33
 v_accvgpr_read_b32 v33, a119
 v_mul_f32 v33, v33, v34
 v_accvgpr_write_b32 a119, v33
 v_accvgpr_read_b32 v33, a120
 v_mul_f32 v33, v33, v34
 v_accvgpr_write_b32 a120, v33
 v_accvgpr_read_b32 v33, a121
 v_mul_f32 v33, v33, v34
 v_accvgpr_write_b32 a121, v33
 v_accvgpr_read_b32 v33, a122
 v_mul_f32 v33, v33, v34
 v_accvgpr_write_b32 a122, v33
 v_accvgpr_read_b32 v33, a123
 v_mul_f32 v33, v33, v34
 v_accvgpr_write_b32 a123, v33
 v_accvgpr_read_b32 v33, a124
 v_mul_f32 v33, v33, v34
 v_accvgpr_write_b32 a124, v33
 v_accvgpr_read_b32 v33, a125
 v_mul_f32 v33, v33, v34
 v_accvgpr_write_b32 a125, v33
 v_accvgpr_read_b32 v33, a126
 v_mul_f32 v33, v33, v34
 v_accvgpr_write_b32 a126, v33
 v_accvgpr_read_b32 v33, a127
 v_mul_f32 v33, v33, v34
 v_accvgpr_write_b32 a127, v33
 v_exp_f32 v36, v200
 v_exp_f32 v37, v201
 s_nop 0
 v_cvt_pk_bf16_f32 v236, v36, v37
 v_exp_f32 v36, v202
 v_exp_f32 v37, v203
 s_nop 0
 v_cvt_pk_bf16_f32 v237, v36, v37
 v_exp_f32 v36, v204
 v_exp_f32 v37, v205
 s_nop 0
 v_cvt_pk_bf16_f32 v238, v36, v37
 v_exp_f32 v36, v206
 v_exp_f32 v37, v207
 s_nop 0
 v_cvt_pk_bf16_f32 v239, v36, v37
 s_nop 1
 s_branch L_b2_r1_ret
L_b2b_r0:
 s_nop 7
 v_max3_f32 v32, v160, v161, v162
 v_max3_f32 v32, v163, v164, v32
 v_max3_f32 v32, v165, v166, v32
 v_max_f32 v32, v167, v32
 v_mov_b32 v33, v32
 s_nop 1
 v_permlane16_swap_b32 v32, v33
 s_nop 1
 v_max_f32 v32, v32, v33
 v_mov_b32 v33, v32
 s_nop 1
 v_permlane32_swap_b32 v32, v33
 s_nop 1
 v_max_f32 v32, v32, v33
 v_add_f32 v32, 0x41c00000, v32
 v_max_f32 v32, 0, v32
 v_exp_f32 v34, -v32
 v_sub_f32 v72, v72, v32
 v_sub_f32 v73, v73, v32
 v_sub_f32 v74, v74, v32
 v_sub_f32 v75, v75, v32
 v_sub_f32 v160, v160, v32
 v_sub_f32 v161, v161, v32
 v_sub_f32 v162, v162, v32
 v_sub_f32 v163, v163, v32
 v_sub_f32 v164, v164, v32
 v_sub_f32 v165, v165, v32
 v_sub_f32 v166, v166, v32
 v_sub_f32 v167, v167, v32
 v_sub_f32 v192, v192, v32
 v_sub_f32 v193, v193, v32
 v_sub_f32 v194, v194, v32
 v_sub_f32 v195, v195, v32
 v_sub_f32 v196, v196, v32
 v_sub_f32 v197, v197, v32
 v_sub_f32 v198, v198, v32
 v_sub_f32 v199, v199, v32
 v_mul_f32 v248, v248, v34
 v_mul_f32 v249, v249, v34
 v_mul_f32 v250, v250, v34
 v_mul_f32 v251, v251, v34
 v_accvgpr_read_b32 v33, a64
 v_mul_f32 v33, v33, v34
 v_accvgpr_write_b32 a64, v33
 v_accvgpr_read_b32 v33, a65
 v_mul_f32 v33, v33, v34
 v_accvgpr_write_b32 a65, v33
 v_accvgpr_read_b32 v33, a66
 v_mul_f32 v33, v33, v34
 v_accvgpr_write_b32 a66, v33
 v_accvgpr_read_b32 v33, a67
 v_mul_f32 v33, v33, v34
 v_accvgpr_write_b32 a67, v33
 v_accvgpr_read_b32 v33, a68
 v_mul_f32 v33, v33, v34
 v_accvgpr_write_b32 a68, v33
 v_accvgpr_read_b32 v33, a69
 v_mul_f32 v33, v33, v34
 v_accvgpr_write_b32 a69, v33
 v_accvgpr_read_b32 v33, a70
 v_mul_f32 v33, v33, v34
 v_accvgpr_write_b32 a70, v33
 v_accvgpr_read_b32 v33, a71
 v_mul_f32 v33, v33, v34
 v_accvgpr_write_b32 a71, v33
 v_accvgpr_read_b32 v33, a72
 v_mul_f32 v33, v33, v34
 v_accvgpr_write_b32 a72, v33
 v_accvgpr_read_b32 v33, a73
 v_mul_f32 v33, v33, v34
 v_accvgpr_write_b32 a73, v33
 v_accvgpr_read_b32 v33, a74
 v_mul_f32 v33, v33, v34
 v_accvgpr_write_b32 a74, v33
 v_accvgpr_read_b32 v33, a75
 v_mul_f32 v33, v33, v34
 v_accvgpr_write_b32 a75, v33
 v_accvgpr_read_b32 v33, a76
 v_mul_f32 v33, v33, v34
 v_accvgpr_write_b32 a76, v33
 v_accvgpr_read_b32 v33, a77
 v_mul_f32 v33, v33, v34
 v_accvgpr_write_b32 a77, v33
 v_accvgpr_read_b32 v33, a78
 v_mul_f32 v33, v33, v34
 v_accvgpr_write_b32 a78, v33
 v_accvgpr_read_b32 v33, a79
 v_mul_f32 v33, v33, v34
 v_accvgpr_write_b32 a79, v33
 v_accvgpr_read_b32 v33, a80
 v_mul_f32 v33, v33, v34
 v_accvgpr_write_b32 a80, v33
 v_accvgpr_read_b32 v33, a81
 v_mul_f32 v33, v33, v34
 v_accvgpr_write_b32 a81, v33
 v_accvgpr_read_b32 v33, a82
 v_mul_f32 v33, v33, v34
 v_accvgpr_write_b32 a82, v33
 v_accvgpr_read_b32 v33, a83
 v_mul_f32 v33, v33, v34
 v_accvgpr_write_b32 a83, v33
 v_accvgpr_read_b32 v33, a84
 v_mul_f32 v33, v33, v34
 v_accvgpr_write_b32 a84, v33
 v_accvgpr_read_b32 v33, a85
 v_mul_f32 v33, v33, v34
 v_accvgpr_write_b32 a85, v33
 v_accvgpr_read_b32 v33, a86
 v_mul_f32 v33, v33, v34
 v_accvgpr_write_b32 a86, v33
 v_accvgpr_read_b32 v33, a87
 v_mul_f32 v33, v33, v34
 v_accvgpr_write_b32 a87, v33
 v_accvgpr_read_b32 v33, a88
 v_mul_f32 v33, v33, v34
 v_accvgpr_write_b32 a88, v33
 v_accvgpr_read_b32 v33, a89
 v_mul_f32 v33, v33, v34
 v_accvgpr_write_b32 a89, v33
 v_accvgpr_read_b32 v33, a90
 v_mul_f32 v33, v33, v34
 v_accvgpr_write_b32 a90, v33
 v_accvgpr_read_b32 v33, a91
 v_mul_f32 v33, v33, v34
 v_accvgpr_write_b32 a91, v33
 v_accvgpr_read_b32 v33, a92
 v_mul_f32 v33, v33, v34
 v_accvgpr_write_b32 a92, v33
 v_accvgpr_read_b32 v33, a93
 v_mul_f32 v33, v33, v34
 v_accvgpr_write_b32 a93, v33
 v_accvgpr_read_b32 v33, a94
 v_mul_f32 v33, v33, v34
 v_accvgpr_write_b32 a94, v33
 v_accvgpr_read_b32 v33, a95
 v_mul_f32 v33, v33, v34
 v_accvgpr_write_b32 a95, v33
 v_exp_f32 v36, v160
 v_exp_f32 v37, v161
 s_nop 0
 v_cvt_pk_bf16_f32 v216, v36, v37
 v_exp_f32 v36, v162
 v_exp_f32 v37, v163
 s_nop 0
 v_cvt_pk_bf16_f32 v217, v36, v37
 v_exp_f32 v36, v164
 v_exp_f32 v37, v165
 s_nop 0
 v_cvt_pk_bf16_f32 v218, v36, v37
 v_exp_f32 v36, v166
 v_exp_f32 v37, v167
 s_nop 0
 v_cvt_pk_bf16_f32 v219, v36, v37
 v_max3_f32 v32, v168, v169, v170
 v_max3_f32 v32, v171, v172, v32
 v_max3_f32 v32, v173, v174, v32
 v_max_f32 v32, v175, v32
 v_mov_b32 v33, v32
 s_nop 1
 v_permlane16_swap_b32 v32, v33
 s_nop 1
 v_max_f32 v32, v32, v33
 v_mov_b32 v33, v32
 s_nop 1
 v_permlane32_swap_b32 v32, v33
 s_nop 1
 v_max_f32 v32, v32, v33
 v_add_f32 v32, 0x41c00000, v32
 v_max_f32 v32, 0, v32
 v_exp_f32 v34, -v32
 v_sub_f32 v76, v76, v32
 v_sub_f32 v77, v77, v32
 v_sub_f32 v78, v78, v32
 v_sub_f32 v79, v79, v32
 v_sub_f32 v168, v168, v32
 v_sub_f32 v169, v169, v32
 v_sub_f32 v170, v170, v32
 v_sub_f32 v171, v171, v32
 v_sub_f32 v172, v172, v32
 v_sub_f32 v173, v173, v32
 v_sub_f32 v174, v174, v32
 v_sub_f32 v175, v175, v32
 v_sub_f32 v200, v200, v32
 v_sub_f32 v201, v201, v32
 v_sub_f32 v202, v202, v32
 v_sub_f32 v203, v203, v32
 v_sub_f32 v204, v204, v32
 v_sub_f32 v205, v205, v32
 v_sub_f32 v206, v206, v32
 v_sub_f32 v207, v207, v32
 v_mul_f32 v252, v252, v34
 v_mul_f32 v253, v253, v34
 v_mul_f32 v254, v254, v34
 v_mul_f32 v255, v255, v34
 v_accvgpr_read_b32 v33, a96
 v_mul_f32 v33, v33, v34
 v_accvgpr_write_b32 a96, v33
 v_accvgpr_read_b32 v33, a97
 v_mul_f32 v33, v33, v34
 v_accvgpr_write_b32 a97, v33
 v_accvgpr_read_b32 v33, a98
 v_mul_f32 v33, v33, v34
 v_accvgpr_write_b32 a98, v33
 v_accvgpr_read_b32 v33, a99
 v_mul_f32 v33, v33, v34
 v_accvgpr_write_b32 a99, v33
 v_accvgpr_read_b32 v33, a100
 v_mul_f32 v33, v33, v34
 v_accvgpr_write_b32 a100, v33
 v_accvgpr_read_b32 v33, a101
 v_mul_f32 v33, v33, v34
 v_accvgpr_write_b32 a101, v33
 v_accvgpr_read_b32 v33, a102
 v_mul_f32 v33, v33, v34
 v_accvgpr_write_b32 a102, v33
 v_accvgpr_read_b32 v33, a103
 v_mul_f32 v33, v33, v34
 v_accvgpr_write_b32 a103, v33
 v_accvgpr_read_b32 v33, a104
 v_mul_f32 v33, v33, v34
 v_accvgpr_write_b32 a104, v33
 v_accvgpr_read_b32 v33, a105
 v_mul_f32 v33, v33, v34
 v_accvgpr_write_b32 a105, v33
 v_accvgpr_read_b32 v33, a106
 v_mul_f32 v33, v33, v34
 v_accvgpr_write_b32 a106, v33
 v_accvgpr_read_b32 v33, a107
 v_mul_f32 v33, v33, v34
 v_accvgpr_write_b32 a107, v33
 v_accvgpr_read_b32 v33, a108
 v_mul_f32 v33, v33, v34
 v_accvgpr_write_b32 a108, v33
 v_accvgpr_read_b32 v33, a109
 v_mul_f32 v33, v33, v34
 v_accvgpr_write_b32 a109, v33
 v_accvgpr_read_b32 v33, a110
 v_mul_f32 v33, v33, v34
 v_accvgpr_write_b32 a110, v33
 v_accvgpr_read_b32 v33, a111
 v_mul_f32 v33, v33, v34
 v_accvgpr_write_b32 a111, v33
 v_accvgpr_read_b32 v33, a112
 v_mul_f32 v33, v33, v34
 v_accvgpr_write_b32 a112, v33
 v_accvgpr_read_b32 v33, a113
 v_mul_f32 v33, v33, v34
 v_accvgpr_write_b32 a113, v33
 v_accvgpr_read_b32 v33, a114
 v_mul_f32 v33, v33, v34
 v_accvgpr_write_b32 a114, v33
 v_accvgpr_read_b32 v33, a115
 v_mul_f32 v33, v33, v34
 v_accvgpr_write_b32 a115, v33
 v_accvgpr_read_b32 v33, a116
 v_mul_f32 v33, v33, v34
 v_accvgpr_write_b32 a116, v33
 v_accvgpr_read_b32 v33, a117
 v_mul_f32 v33, v33, v34
 v_accvgpr_write_b32 a117, v33
 v_accvgpr_read_b32 v33, a118
 v_mul_f32 v33, v33, v34
 v_accvgpr_write_b32 a118, v33
 v_accvgpr_read_b32 v33, a119
 v_mul_f32 v33, v33, v34
 v_accvgpr_write_b32 a119, v33
 v_accvgpr_read_b32 v33, a120
 v_mul_f32 v33, v33, v34
 v_accvgpr_write_b32 a120, v33
 v_accvgpr_read_b32 v33, a121
 v_mul_f32 v33, v33, v34
 v_accvgpr_write_b32 a121, v33
 v_accvgpr_read_b32 v33, a122
 v_mul_f32 v33, v33, v34
 v_accvgpr_write_b32 a122, v33
 v_accvgpr_read_b32 v33, a123
 v_mul_f32 v33, v33, v34
 v_accvgpr_write_b32 a123, v33
 v_accvgpr_read_b32 v33, a124
 v_mul_f32 v33, v33, v34
 v_accvgpr_write_b32 a124, v33
 v_accvgpr_read_b32 v33, a125
 v_mul_f32 v33, v33, v34
 v_accvgpr_write_b32 a125, v33
 v_accvgpr_read_b32 v33, a126
 v_mul_f32 v33, v33, v34
 v_accvgpr_write_b32 a126, v33
 v_accvgpr_read_b32 v33, a127
 v_mul_f32 v33, v33, v34
 v_accvgpr_write_b32 a127, v33
 v_exp_f32 v36, v168
 v_exp_f32 v37, v169
 s_nop 0
 v_cvt_pk_bf16_f32 v220, v36, v37
 v_exp_f32 v36, v170
 v_exp_f32 v37, v171
 s_nop 0
 v_cvt_pk_bf16_f32 v221, v36, v37
 v_exp_f32 v36, v172
 v_exp_f32 v37, v173
 s_nop 0
 v_cvt_pk_bf16_f32 v222, v36, v37
 v_exp_f32 v36, v174
 v_exp_f32 v37, v175
 s_nop 0
 v_cvt_pk_bf16_f32 v223, v36, v37
 s_nop 1
 s_branch L_b2b_r0_ret
L_b2b_r1:
 s_nop 7
 v_max3_f32 v32, v192, v193, v194
 v_max3_f32 v32, v195, v196, v32
 v_max3_f32 v32, v197, v198, v32
 v_max_f32 v32, v199, v32
 v_mov_b32 v33, v32
 s_nop 1
 v_permlane16_swap_b32 v32, v33
 s_nop 1
 v_max_f32 v32, v32, v33
 v_mov_b32 v33, v32
 s_nop 1
 v_permlane32_swap_b32 v32, v33
 s_nop 1
 v_max_f32 v32, v32, v33
 v_add_f32 v32, 0x41c00000, v32
 v_max_f32 v32, 0, v32
 v_exp_f32 v34, -v32
 v_sub_f32 v72, v72, v32
 v_sub_f32 v73, v73, v32
 v_sub_f32 v74, v74, v32
 v_sub_f32 v75, v75, v32
 v_sub_f32 v192, v192, v32
 v_sub_f32 v193, v193, v32
 v_sub_f32 v194, v194, v32
 v_sub_f32 v195, v195, v32
 v_sub_f32 v196, v196, v32
 v_sub_f32 v197, v197, v32
 v_sub_f32 v198, v198, v32
 v_sub_f32 v199, v199, v32
 v_sub_f32 v160, v160, v32
 v_sub_f32 v161, v161, v32
 v_sub_f32 v162, v162, v32
 v_sub_f32 v163, v163, v32
 v_sub_f32 v164, v164, v32
 v_sub_f32 v165, v165, v32
 v_sub_f32 v166, v166, v32
 v_sub_f32 v167, v167, v32
 v_mul_f32 v248, v248, v34
 v_mul_f32 v249, v249, v34
 v_mul_f32 v250, v250, v34
 v_mul_f32 v251, v251, v34
 v_accvgpr_read_b32 v33, a64
 v_mul_f32 v33, v33, v34
 v_accvgpr_write_b32 a64, v33
 v_accvgpr_read_b32 v33, a65
 v_mul_f32 v33, v33, v34
 v_accvgpr_write_b32 a65, v33
 v_accvgpr_read_b32 v33, a66
 v_mul_f32 v33, v33, v34
 v_accvgpr_write_b32 a66, v33
 v_accvgpr_read_b32 v33, a67
 v_mul_f32 v33, v33, v34
 v_accvgpr_write_b32 a67, v33
 v_accvgpr_read_b32 v33, a68
 v_mul_f32 v33, v33, v34
 v_accvgpr_write_b32 a68, v33
 v_accvgpr_read_b32 v33, a69
 v_mul_f32 v33, v33, v34
 v_accvgpr_write_b32 a69, v33
 v_accvgpr_read_b32 v33, a70
 v_mul_f32 v33, v33, v34
 v_accvgpr_write_b32 a70, v33
 v_accvgpr_read_b32 v33, a71
 v_mul_f32 v33, v33, v34
 v_accvgpr_write_b32 a71, v33
 v_accvgpr_read_b32 v33, a72
 v_mul_f32 v33, v33, v34
 v_accvgpr_write_b32 a72, v33
 v_accvgpr_read_b32 v33, a73
 v_mul_f32 v33, v33, v34
 v_accvgpr_write_b32 a73, v33
 v_accvgpr_read_b32 v33, a74
 v_mul_f32 v33, v33, v34
 v_accvgpr_write_b32 a74, v33
 v_accvgpr_read_b32 v33, a75
 v_mul_f32 v33, v33, v34
 v_accvgpr_write_b32 a75, v33
 v_accvgpr_read_b32 v33, a76
 v_mul_f32 v33, v33, v34
 v_accvgpr_write_b32 a76, v33
 v_accvgpr_read_b32 v33, a77
 v_mul_f32 v33, v33, v34
 v_accvgpr_write_b32 a77, v33
 v_accvgpr_read_b32 v33, a78
 v_mul_f32 v33, v33, v34
 v_accvgpr_write_b32 a78, v33
 v_accvgpr_read_b32 v33, a79
 v_mul_f32 v33, v33, v34
 v_accvgpr_write_b32 a79, v33
 v_accvgpr_read_b32 v33, a80
 v_mul_f32 v33, v33, v34
 v_accvgpr_write_b32 a80, v33
 v_accvgpr_read_b32 v33, a81
 v_mul_f32 v33, v33, v34
 v_accvgpr_write_b32 a81, v33
 v_accvgpr_read_b32 v33, a82
 v_mul_f32 v33, v33, v34
 v_accvgpr_write_b32 a82, v33
 v_accvgpr_read_b32 v33, a83
 v_mul_f32 v33, v33, v34
 v_accvgpr_write_b32 a83, v33
 v_accvgpr_read_b32 v33, a84
 v_mul_f32 v33, v33, v34
 v_accvgpr_write_b32 a84, v33
 v_accvgpr_read_b32 v33, a85
 v_mul_f32 v33, v33, v34
 v_accvgpr_write_b32 a85, v33
 v_accvgpr_read_b32 v33, a86
 v_mul_f32 v33, v33, v34
 v_accvgpr_write_b32 a86, v33
 v_accvgpr_read_b32 v33, a87
 v_mul_f32 v33, v33, v34
 v_accvgpr_write_b32 a87, v33
 v_accvgpr_read_b32 v33, a88
 v_mul_f32 v33, v33, v34
 v_accvgpr_write_b32 a88, v33
 v_accvgpr_read_b32 v33, a89
 v_mul_f32 v33, v33, v34
 v_accvgpr_write_b32 a89, v33
 v_accvgpr_read_b32 v33, a90
 v_mul_f32 v33, v33, v34
 v_accvgpr_write_b32 a90, v33
 v_accvgpr_read_b32 v33, a91
 v_mul_f32 v33, v33, v34
 v_accvgpr_write_b32 a91, v33
 v_accvgpr_read_b32 v33, a92
 v_mul_f32 v33, v33, v34
 v_accvgpr_write_b32 a92, v33
 v_accvgpr_read_b32 v33, a93
 v_mul_f32 v33, v33, v34
 v_accvgpr_write_b32 a93, v33
 v_accvgpr_read_b32 v33, a94
 v_mul_f32 v33, v33, v34
 v_accvgpr_write_b32 a94, v33
 v_accvgpr_read_b32 v33, a95
 v_mul_f32 v33, v33, v34
 v_accvgpr_write_b32 a95, v33
 v_exp_f32 v36, v192
 v_exp_f32 v37, v193
 s_nop 0
 v_cvt_pk_bf16_f32 v232, v36, v37
 v_exp_f32 v36, v194
 v_exp_f32 v37, v195
 s_nop 0
 v_cvt_pk_bf16_f32 v233, v36, v37
 v_exp_f32 v36, v196
 v_exp_f32 v37, v197
 s_nop 0
 v_cvt_pk_bf16_f32 v234, v36, v37
 v_exp_f32 v36, v198
 v_exp_f32 v37, v199
 s_nop 0
 v_cvt_pk_bf16_f32 v235, v36, v37
 v_max3_f32 v32, v200, v201, v202
 v_max3_f32 v32, v203, v204, v32
 v_max3_f32 v32, v205, v206, v32
 v_max_f32 v32, v207, v32
 v_mov_b32 v33, v32
 s_nop 1
 v_permlane16_swap_b32 v32, v33
 s_nop 1
 v_max_f32 v32, v32, v33
 v_mov_b32 v33, v32
 s_nop 1
 v_permlane32_swap_b32 v32, v33
 s_nop 1
 v_max_f32 v32, v32, v33
 v_add_f32 v32, 0x41c00000, v32
 v_max_f32 v32, 0, v32
 v_exp_f32 v34, -v32
 v_sub_f32 v76, v76, v32
 v_sub_f32 v77, v77, v32
 v_sub_f32 v78, v78, v32
 v_sub_f32 v79, v79, v32
 v_sub_f32 v200, v200, v32
 v_sub_f32 v201, v201, v32
 v_sub_f32 v202, v202, v32
 v_sub_f32 v203, v203, v32
 v_sub_f32 v204, v204, v32
 v_sub_f32 v205, v205, v32
 v_sub_f32 v206, v206, v32
 v_sub_f32 v207, v207, v32
 v_sub_f32 v168, v168, v32
 v_sub_f32 v169, v169, v32
 v_sub_f32 v170, v170, v32
 v_sub_f32 v171, v171, v32
 v_sub_f32 v172, v172, v32
 v_sub_f32 v173, v173, v32
 v_sub_f32 v174, v174, v32
 v_sub_f32 v175, v175, v32
 v_mul_f32 v252, v252, v34
 v_mul_f32 v253, v253, v34
 v_mul_f32 v254, v254, v34
 v_mul_f32 v255, v255, v34
 v_accvgpr_read_b32 v33, a96
 v_mul_f32 v33, v33, v34
 v_accvgpr_write_b32 a96, v33
 v_accvgpr_read_b32 v33, a97
 v_mul_f32 v33, v33, v34
 v_accvgpr_write_b32 a97, v33
 v_accvgpr_read_b32 v33, a98
 v_mul_f32 v33, v33, v34
 v_accvgpr_write_b32 a98, v33
 v_accvgpr_read_b32 v33, a99
 v_mul_f32 v33, v33, v34
 v_accvgpr_write_b32 a99, v33
 v_accvgpr_read_b32 v33, a100
 v_mul_f32 v33, v33, v34
 v_accvgpr_write_b32 a100, v33
 v_accvgpr_read_b32 v33, a101
 v_mul_f32 v33, v33, v34
 v_accvgpr_write_b32 a101, v33
 v_accvgpr_read_b32 v33, a102
 v_mul_f32 v33, v33, v34
 v_accvgpr_write_b32 a102, v33
 v_accvgpr_read_b32 v33, a103
 v_mul_f32 v33, v33, v34
 v_accvgpr_write_b32 a103, v33
 v_accvgpr_read_b32 v33, a104
 v_mul_f32 v33, v33, v34
 v_accvgpr_write_b32 a104, v33
 v_accvgpr_read_b32 v33, a105
 v_mul_f32 v33, v33, v34
 v_accvgpr_write_b32 a105, v33
 v_accvgpr_read_b32 v33, a106
 v_mul_f32 v33, v33, v34
 v_accvgpr_write_b32 a106, v33
 v_accvgpr_read_b32 v33, a107
 v_mul_f32 v33, v33, v34
 v_accvgpr_write_b32 a107, v33
 v_accvgpr_read_b32 v33, a108
 v_mul_f32 v33, v33, v34
 v_accvgpr_write_b32 a108, v33
 v_accvgpr_read_b32 v33, a109
 v_mul_f32 v33, v33, v34
 v_accvgpr_write_b32 a109, v33
 v_accvgpr_read_b32 v33, a110
 v_mul_f32 v33, v33, v34
 v_accvgpr_write_b32 a110, v33
 v_accvgpr_read_b32 v33, a111
 v_mul_f32 v33, v33, v34
 v_accvgpr_write_b32 a111, v33
 v_accvgpr_read_b32 v33, a112
 v_mul_f32 v33, v33, v34
 v_accvgpr_write_b32 a112, v33
 v_accvgpr_read_b32 v33, a113
 v_mul_f32 v33, v33, v34
 v_accvgpr_write_b32 a113, v33
 v_accvgpr_read_b32 v33, a114
 v_mul_f32 v33, v33, v34
 v_accvgpr_write_b32 a114, v33
 v_accvgpr_read_b32 v33, a115
 v_mul_f32 v33, v33, v34
 v_accvgpr_write_b32 a115, v33
 v_accvgpr_read_b32 v33, a116
 v_mul_f32 v33, v33, v34
 v_accvgpr_write_b32 a116, v33
 v_accvgpr_read_b32 v33, a117
 v_mul_f32 v33, v33, v34
 v_accvgpr_write_b32 a117, v33
 v_accvgpr_read_b32 v33, a118
 v_mul_f32 v33, v33, v34
 v_accvgpr_write_b32 a118, v33
 v_accvgpr_read_b32 v33, a119
 v_mul_f32 v33, v33, v34
 v_accvgpr_write_b32 a119, v33
 v_accvgpr_read_b32 v33, a120
 v_mul_f32 v33, v33, v34
 v_accvgpr_write_b32 a120, v33
 v_accvgpr_read_b32 v33, a121
 v_mul_f32 v33, v33, v34
 v_accvgpr_write_b32 a121, v33
 v_accvgpr_read_b32 v33, a122
 v_mul_f32 v33, v33, v34
 v_accvgpr_write_b32 a122, v33
 v_accvgpr_read_b32 v33, a123
 v_mul_f32 v33, v33, v34
 v_accvgpr_write_b32 a123, v33
 v_accvgpr_read_b32 v33, a124
 v_mul_f32 v33, v33, v34
 v_accvgpr_write_b32 a124, v33
 v_accvgpr_read_b32 v33, a125
 v_mul_f32 v33, v33, v34
 v_accvgpr_write_b32 a125, v33
 v_accvgpr_read_b32 v33, a126
 v_mul_f32 v33, v33, v34
 v_accvgpr_write_b32 a126, v33
 v_accvgpr_read_b32 v33, a127
 v_mul_f32 v33, v33, v34
 v_accvgpr_write_b32 a127, v33
 v_exp_f32 v36, v200
 v_exp_f32 v37, v201
 s_nop 0
 v_cvt_pk_bf16_f32 v236, v36, v37
 v_exp_f32 v36, v202
 v_exp_f32 v37, v203
 s_nop 0
 v_cvt_pk_bf16_f32 v237, v36, v37
 v_exp_f32 v36, v204
 v_exp_f32 v37, v205
 s_nop 0
 v_cvt_pk_bf16_f32 v238, v36, v37
 v_exp_f32 v36, v206
 v_exp_f32 v37, v207
 s_nop 0
 v_cvt_pk_bf16_f32 v239, v36, v37
 s_nop 1
 s_branch L_b2b_r1_ret
L_b2e_r0:
 s_nop 7
 v_max3_f32 v32, v160, v161, v162
 v_max3_f32 v32, v163, v164, v32
 v_max3_f32 v32, v165, v166, v32
 v_max_f32 v32, v167, v32
 v_mov_b32 v33, v32
 s_nop 1
 v_permlane16_swap_b32 v32, v33
 s_nop 1
 v_max_f32 v32, v32, v33
 v_mov_b32 v33, v32
 s_nop 1
 v_permlane32_swap_b32 v32, v33
 s_nop 1
 v_max_f32 v32, v32, v33
 v_add_f32 v32, 0x41c00000, v32
 v_max_f32 v32, 0, v32
 v_exp_f32 v34, -v32
 v_sub_f32 v72, v72, v32
 v_sub_f32 v73, v73, v32
 v_sub_f32 v74, v74, v32
 v_sub_f32 v75, v75, v32
 v_sub_f32 v160, v160, v32
 v_sub_f32 v161, v161, v32
 v_sub_f32 v162, v162, v32
 v_sub_f32 v163, v163, v32
 v_sub_f32 v164, v164, v32
 v_sub_f32 v165, v165, v32
 v_sub_f32 v166, v166, v32
 v_sub_f32 v167, v167, v32
 v_sub_f32 v192, v192, v32
 v_sub_f32 v193, v193, v32
 v_sub_f32 v194, v194, v32
 v_sub_f32 v195, v195, v32
 v_sub_f32 v196, v196, v32
 v_sub_f32 v197, v197, v32
 v_sub_f32 v198, v198, v32
 v_sub_f32 v199, v199, v32
 v_mul_f32 v248, v248, v34
 v_mul_f32 v249, v249, v34
 v_mul_f32 v250, v250, v34
 v_mul_f32 v251, v251, v34
 v_accvgpr_read_b32 v33, a64
 v_mul_f32 v33, v33, v34
 v_accvgpr_write_b32 a64, v33
 v_accvgpr_read_b32 v33, a65
 v_mul_f32 v33, v33, v34
 v_accvgpr_write_b32 a65, v33
 v_accvgpr_read_b32 v33, a66
 v_mul_f32 v33, v33, v34
 v_accvgpr_write_b32 a66, v33
 v_accvgpr_read_b32 v33, a67
 v_mul_f32 v33, v33, v34
 v_accvgpr_write_b32 a67, v33
 v_accvgpr_read_b32 v33, a68
 v_mul_f32 v33, v33, v34
 v_accvgpr_write_b32 a68, v33
 v_accvgpr_read_b32 v33, a69
 v_mul_f32 v33, v33, v34
 v_accvgpr_write_b32 a69, v33
 v_accvgpr_read_b32 v33, a70
 v_mul_f32 v33, v33, v34
 v_accvgpr_write_b32 a70, v33
 v_accvgpr_read_b32 v33, a71
 v_mul_f32 v33, v33, v34
 v_accvgpr_write_b32 a71, v33
 v_accvgpr_read_b32 v33, a72
 v_mul_f32 v33, v33, v34
 v_accvgpr_write_b32 a72, v33
 v_accvgpr_read_b32 v33, a73
 v_mul_f32 v33, v33, v34
 v_accvgpr_write_b32 a73, v33
 v_accvgpr_read_b32 v33, a74
 v_mul_f32 v33, v33, v34
 v_accvgpr_write_b32 a74, v33
 v_accvgpr_read_b32 v33, a75
 v_mul_f32 v33, v33, v34
 v_accvgpr_write_b32 a75, v33
 v_accvgpr_read_b32 v33, a76
 v_mul_f32 v33, v33, v34
 v_accvgpr_write_b32 a76, v33
 v_accvgpr_read_b32 v33, a77
 v_mul_f32 v33, v33, v34
 v_accvgpr_write_b32 a77, v33
 v_accvgpr_read_b32 v33, a78
 v_mul_f32 v33, v33, v34
 v_accvgpr_write_b32 a78, v33
 v_accvgpr_read_b32 v33, a79
 v_mul_f32 v33, v33, v34
 v_accvgpr_write_b32 a79, v33
 v_accvgpr_read_b32 v33, a80
 v_mul_f32 v33, v33, v34
 v_accvgpr_write_b32 a80, v33
 v_accvgpr_read_b32 v33, a81
 v_mul_f32 v33, v33, v34
 v_accvgpr_write_b32 a81, v33
 v_accvgpr_read_b32 v33, a82
 v_mul_f32 v33, v33, v34
 v_accvgpr_write_b32 a82, v33
 v_accvgpr_read_b32 v33, a83
 v_mul_f32 v33, v33, v34
 v_accvgpr_write_b32 a83, v33
 v_accvgpr_read_b32 v33, a84
 v_mul_f32 v33, v33, v34
 v_accvgpr_write_b32 a84, v33
 v_accvgpr_read_b32 v33, a85
 v_mul_f32 v33, v33, v34
 v_accvgpr_write_b32 a85, v33
 v_accvgpr_read_b32 v33, a86
 v_mul_f32 v33, v33, v34
 v_accvgpr_write_b32 a86, v33
 v_accvgpr_read_b32 v33, a87
 v_mul_f32 v33, v33, v34
 v_accvgpr_write_b32 a87, v33
 v_accvgpr_read_b32 v33, a88
 v_mul_f32 v33, v33, v34
 v_accvgpr_write_b32 a88, v33
 v_accvgpr_read_b32 v33, a89
 v_mul_f32 v33, v33, v34
 v_accvgpr_write_b32 a89, v33
 v_accvgpr_read_b32 v33, a90
 v_mul_f32 v33, v33, v34
 v_accvgpr_write_b32 a90, v33
 v_accvgpr_read_b32 v33, a91
 v_mul_f32 v33, v33, v34
 v_accvgpr_write_b32 a91, v33
 v_accvgpr_read_b32 v33, a92
 v_mul_f32 v33, v33, v34
 v_accvgpr_write_b32 a92, v33
 v_accvgpr_read_b32 v33, a93
 v_mul_f32 v33, v33, v34
 v_accvgpr_write_b32 a93, v33
 v_accvgpr_read_b32 v33, a94
 v_mul_f32 v33, v33, v34
 v_accvgpr_write_b32 a94, v33
 v_accvgpr_read_b32 v33, a95
 v_mul_f32 v33, v33, v34
 v_accvgpr_write_b32 a95, v33
 v_exp_f32 v36, v160
 v_exp_f32 v37, v161
 s_nop 0
 v_cvt_pk_bf16_f32 v216, v36, v37
 v_exp_f32 v36, v162
 v_exp_f32 v37, v163
 s_nop 0
 v_cvt_pk_bf16_f32 v217, v36, v37
 v_exp_f32 v36, v164
 v_exp_f32 v37, v165
 s_nop 0
 v_cvt_pk_bf16_f32 v218, v36, v37
 v_exp_f32 v36, v166
 v_exp_f32 v37, v167
 s_nop 0
 v_cvt_pk_bf16_f32 v219, v36, v37
 v_max3_f32 v32, v168, v169, v170
 v_max3_f32 v32, v171, v172, v32
 v_max3_f32 v32, v173, v174, v32
 v_max_f32 v32, v175, v32
 v_mov_b32 v33, v32
 s_nop 1
 v_permlane16_swap_b32 v32, v33
 s_nop 1
 v_max_f32 v32, v32, v33
 v_mov_b32 v33, v32
 s_nop 1
 v_permlane32_swap_b32 v32, v33
 s_nop 1
 v_max_f32 v32, v32, v33
 v_add_f32 v32, 0x41c00000, v32
 v_max_f32 v32, 0, v32
 v_exp_f32 v34, -v32
 v_sub_f32 v76, v76, v32
 v_sub_f32 v77, v77, v32
 v_sub_f32 v78, v78, v32
 v_sub_f32 v79, v79, v32
 v_sub_f32 v168, v168, v32
 v_sub_f32 v169, v169, v32
 v_sub_f32 v170, v170, v32
 v_sub_f32 v171, v171, v32
 v_sub_f32 v172, v172, v32
 v_sub_f32 v173, v173, v32
 v_sub_f32 v174, v174, v32
 v_sub_f32 v175, v175, v32
 v_sub_f32 v200, v200, v32
 v_sub_f32 v201, v201, v32
 v_sub_f32 v202, v202, v32
 v_sub_f32 v203, v203, v32
 v_sub_f32 v204, v204, v32
 v_sub_f32 v205, v205, v32
 v_sub_f32 v206, v206, v32
 v_sub_f32 v207, v207, v32
 v_mul_f32 v252, v252, v34
 v_mul_f32 v253, v253, v34
 v_mul_f32 v254, v254, v34
 v_mul_f32 v255, v255, v34
 v_accvgpr_read_b32 v33, a96
 v_mul_f32 v33, v33, v34
 v_accvgpr_write_b32 a96, v33
 v_accvgpr_read_b32 v33, a97
 v_mul_f32 v33, v33, v34
 v_accvgpr_write_b32 a97, v33
 v_accvgpr_read_b32 v33, a98
 v_mul_f32 v33, v33, v34
 v_accvgpr_write_b32 a98, v33
 v_accvgpr_read_b32 v33, a99
 v_mul_f32 v33, v33, v34
 v_accvgpr_write_b32 a99, v33
 v_accvgpr_read_b32 v33, a100
 v_mul_f32 v33, v33, v34
 v_accvgpr_write_b32 a100, v33
 v_accvgpr_read_b32 v33, a101
 v_mul_f32 v33, v33, v34
 v_accvgpr_write_b32 a101, v33
 v_accvgpr_read_b32 v33, a102
 v_mul_f32 v33, v33, v34
 v_accvgpr_write_b32 a102, v33
 v_accvgpr_read_b32 v33, a103
 v_mul_f32 v33, v33, v34
 v_accvgpr_write_b32 a103, v33
 v_accvgpr_read_b32 v33, a104
 v_mul_f32 v33, v33, v34
 v_accvgpr_write_b32 a104, v33
 v_accvgpr_read_b32 v33, a105
 v_mul_f32 v33, v33, v34
 v_accvgpr_write_b32 a105, v33
 v_accvgpr_read_b32 v33, a106
 v_mul_f32 v33, v33, v34
 v_accvgpr_write_b32 a106, v33
 v_accvgpr_read_b32 v33, a107
 v_mul_f32 v33, v33, v34
 v_accvgpr_write_b32 a107, v33
 v_accvgpr_read_b32 v33, a108
 v_mul_f32 v33, v33, v34
 v_accvgpr_write_b32 a108, v33
 v_accvgpr_read_b32 v33, a109
 v_mul_f32 v33, v33, v34
 v_accvgpr_write_b32 a109, v33
 v_accvgpr_read_b32 v33, a110
 v_mul_f32 v33, v33, v34
 v_accvgpr_write_b32 a110, v33
 v_accvgpr_read_b32 v33, a111
 v_mul_f32 v33, v33, v34
 v_accvgpr_write_b32 a111, v33
 v_accvgpr_read_b32 v33, a112
 v_mul_f32 v33, v33, v34
 v_accvgpr_write_b32 a112, v33
 v_accvgpr_read_b32 v33, a113
 v_mul_f32 v33, v33, v34
 v_accvgpr_write_b32 a113, v33
 v_accvgpr_read_b32 v33, a114
 v_mul_f32 v33, v33, v34
 v_accvgpr_write_b32 a114, v33
 v_accvgpr_read_b32 v33, a115
 v_mul_f32 v33, v33, v34
 v_accvgpr_write_b32 a115, v33
 v_accvgpr_read_b32 v33, a116
 v_mul_f32 v33, v33, v34
 v_accvgpr_write_b32 a116, v33
 v_accvgpr_read_b32 v33, a117
 v_mul_f32 v33, v33, v34
 v_accvgpr_write_b32 a117, v33
 v_accvgpr_read_b32 v33, a118
 v_mul_f32 v33, v33, v34
 v_accvgpr_write_b32 a118, v33
 v_accvgpr_read_b32 v33, a119
 v_mul_f32 v33, v33, v34
 v_accvgpr_write_b32 a119, v33
 v_accvgpr_read_b32 v33, a120
 v_mul_f32 v33, v33, v34
 v_accvgpr_write_b32 a120, v33
 v_accvgpr_read_b32 v33, a121
 v_mul_f32 v33, v33, v34
 v_accvgpr_write_b32 a121, v33
 v_accvgpr_read_b32 v33, a122
 v_mul_f32 v33, v33, v34
 v_accvgpr_write_b32 a122, v33
 v_accvgpr_read_b32 v33, a123
 v_mul_f32 v33, v33, v34
 v_accvgpr_write_b32 a123, v33
 v_accvgpr_read_b32 v33, a124
 v_mul_f32 v33, v33, v34
 v_accvgpr_write_b32 a124, v33
 v_accvgpr_read_b32 v33, a125
 v_mul_f32 v33, v33, v34
 v_accvgpr_write_b32 a125, v33
 v_accvgpr_read_b32 v33, a126
 v_mul_f32 v33, v33, v34
 v_accvgpr_write_b32 a126, v33
 v_accvgpr_read_b32 v33, a127
 v_mul_f32 v33, v33, v34
 v_accvgpr_write_b32 a127, v33
 v_exp_f32 v36, v168
 v_exp_f32 v37, v169
 s_nop 0
 v_cvt_pk_bf16_f32 v220, v36, v37
 v_exp_f32 v36, v170
 v_exp_f32 v37, v171
 s_nop 0
 v_cvt_pk_bf16_f32 v221, v36, v37
 v_exp_f32 v36, v172
 v_exp_f32 v37, v173
 s_nop 0
 v_cvt_pk_bf16_f32 v222, v36, v37
 v_exp_f32 v36, v174
 v_exp_f32 v37, v175
 s_nop 0
 v_cvt_pk_bf16_f32 v223, v36, v37
 s_nop 1
 s_branch L_b2e_r0_ret
L_b2e_r1:
 s_nop 7
 v_max3_f32 v32, v192, v193, v194
 v_max3_f32 v32, v195, v196, v32
 v_max3_f32 v32, v197, v198, v32
 v_max_f32 v32, v199, v32
 v_mov_b32 v33, v32
 s_nop 1
 v_permlane16_swap_b32 v32, v33
 s_nop 1
 v_max_f32 v32, v32, v33
 v_mov_b32 v33, v32
 s_nop 1
 v_permlane32_swap_b32 v32, v33
 s_nop 1
 v_max_f32 v32, v32, v33
 v_add_f32 v32, 0x41c00000, v32
 v_max_f32 v32, 0, v32
 v_exp_f32 v34, -v32
 v_sub_f32 v72, v72, v32
 v_sub_f32 v73, v73, v32
 v_sub_f32 v74, v74, v32
 v_sub_f32 v75, v75, v32
 v_sub_f32 v192, v192, v32
 v_sub_f32 v193, v193, v32
 v_sub_f32 v194, v194, v32
 v_sub_f32 v195, v195, v32
 v_sub_f32 v196, v196, v32
 v_sub_f32 v197, v197, v32
 v_sub_f32 v198, v198, v32
 v_sub_f32 v199, v199, v32
 v_sub_f32 v160, v160, v32
 v_sub_f32 v161, v161, v32
 v_sub_f32 v162, v162, v32
 v_sub_f32 v163, v163, v32
 v_sub_f32 v164, v164, v32
 v_sub_f32 v165, v165, v32
 v_sub_f32 v166, v166, v32
 v_sub_f32 v167, v167, v32
 v_mul_f32 v248, v248, v34
 v_mul_f32 v249, v249, v34
 v_mul_f32 v250, v250, v34
 v_mul_f32 v251, v251, v34
 v_accvgpr_read_b32 v33, a64
 v_mul_f32 v33, v33, v34
 v_accvgpr_write_b32 a64, v33
 v_accvgpr_read_b32 v33, a65
 v_mul_f32 v33, v33, v34
 v_accvgpr_write_b32 a65, v33
 v_accvgpr_read_b32 v33, a66
 v_mul_f32 v33, v33, v34
 v_accvgpr_write_b32 a66, v33
 v_accvgpr_read_b32 v33, a67
 v_mul_f32 v33, v33, v34
 v_accvgpr_write_b32 a67, v33
 v_accvgpr_read_b32 v33, a68
 v_mul_f32 v33, v33, v34
 v_accvgpr_write_b32 a68, v33
 v_accvgpr_read_b32 v33, a69
 v_mul_f32 v33, v33, v34
 v_accvgpr_write_b32 a69, v33
 v_accvgpr_read_b32 v33, a70
 v_mul_f32 v33, v33, v34
 v_accvgpr_write_b32 a70, v33
 v_accvgpr_read_b32 v33, a71
 v_mul_f32 v33, v33, v34
 v_accvgpr_write_b32 a71, v33
 v_accvgpr_read_b32 v33, a72
 v_mul_f32 v33, v33, v34
 v_accvgpr_write_b32 a72, v33
 v_accvgpr_read_b32 v33, a73
 v_mul_f32 v33, v33, v34
 v_accvgpr_write_b32 a73, v33
 v_accvgpr_read_b32 v33, a74
 v_mul_f32 v33, v33, v34
 v_accvgpr_write_b32 a74, v33
 v_accvgpr_read_b32 v33, a75
 v_mul_f32 v33, v33, v34
 v_accvgpr_write_b32 a75, v33
 v_accvgpr_read_b32 v33, a76
 v_mul_f32 v33, v33, v34
 v_accvgpr_write_b32 a76, v33
 v_accvgpr_read_b32 v33, a77
 v_mul_f32 v33, v33, v34
 v_accvgpr_write_b32 a77, v33
 v_accvgpr_read_b32 v33, a78
 v_mul_f32 v33, v33, v34
 v_accvgpr_write_b32 a78, v33
 v_accvgpr_read_b32 v33, a79
 v_mul_f32 v33, v33, v34
 v_accvgpr_write_b32 a79, v33
 v_accvgpr_read_b32 v33, a80
 v_mul_f32 v33, v33, v34
 v_accvgpr_write_b32 a80, v33
 v_accvgpr_read_b32 v33, a81
 v_mul_f32 v33, v33, v34
 v_accvgpr_write_b32 a81, v33
 v_accvgpr_read_b32 v33, a82
 v_mul_f32 v33, v33, v34
 v_accvgpr_write_b32 a82, v33
 v_accvgpr_read_b32 v33, a83
 v_mul_f32 v33, v33, v34
 v_accvgpr_write_b32 a83, v33
 v_accvgpr_read_b32 v33, a84
 v_mul_f32 v33, v33, v34
 v_accvgpr_write_b32 a84, v33
 v_accvgpr_read_b32 v33, a85
 v_mul_f32 v33, v33, v34
 v_accvgpr_write_b32 a85, v33
 v_accvgpr_read_b32 v33, a86
 v_mul_f32 v33, v33, v34
 v_accvgpr_write_b32 a86, v33
 v_accvgpr_read_b32 v33, a87
 v_mul_f32 v33, v33, v34
 v_accvgpr_write_b32 a87, v33
 v_accvgpr_read_b32 v33, a88
 v_mul_f32 v33, v33, v34
 v_accvgpr_write_b32 a88, v33
 v_accvgpr_read_b32 v33, a89
 v_mul_f32 v33, v33, v34
 v_accvgpr_write_b32 a89, v33
 v_accvgpr_read_b32 v33, a90
 v_mul_f32 v33, v33, v34
 v_accvgpr_write_b32 a90, v33
 v_accvgpr_read_b32 v33, a91
 v_mul_f32 v33, v33, v34
 v_accvgpr_write_b32 a91, v33
 v_accvgpr_read_b32 v33, a92
 v_mul_f32 v33, v33, v34
 v_accvgpr_write_b32 a92, v33
 v_accvgpr_read_b32 v33, a93
 v_mul_f32 v33, v33, v34
 v_accvgpr_write_b32 a93, v33
 v_accvgpr_read_b32 v33, a94
 v_mul_f32 v33, v33, v34
 v_accvgpr_write_b32 a94, v33
 v_accvgpr_read_b32 v33, a95
 v_mul_f32 v33, v33, v34
 v_accvgpr_write_b32 a95, v33
 v_exp_f32 v36, v192
 v_exp_f32 v37, v193
 s_nop 0
 v_cvt_pk_bf16_f32 v232, v36, v37
 v_exp_f32 v36, v194
 v_exp_f32 v37, v195
 s_nop 0
 v_cvt_pk_bf16_f32 v233, v36, v37
 v_exp_f32 v36, v196
 v_exp_f32 v37, v197
 s_nop 0
 v_cvt_pk_bf16_f32 v234, v36, v37
 v_exp_f32 v36, v198
 v_exp_f32 v37, v199
 s_nop 0
 v_cvt_pk_bf16_f32 v235, v36, v37
 v_max3_f32 v32, v200, v201, v202
 v_max3_f32 v32, v203, v204, v32
 v_max3_f32 v32, v205, v206, v32
 v_max_f32 v32, v207, v32
 v_mov_b32 v33, v32
 s_nop 1
 v_permlane16_swap_b32 v32, v33
 s_nop 1
 v_max_f32 v32, v32, v33
 v_mov_b32 v33, v32
 s_nop 1
 v_permlane32_swap_b32 v32, v33
 s_nop 1
 v_max_f32 v32, v32, v33
 v_add_f32 v32, 0x41c00000, v32
 v_max_f32 v32, 0, v32
 v_exp_f32 v34, -v32
 v_sub_f32 v76, v76, v32
 v_sub_f32 v77, v77, v32
 v_sub_f32 v78, v78, v32
 v_sub_f32 v79, v79, v32
 v_sub_f32 v200, v200, v32
 v_sub_f32 v201, v201, v32
 v_sub_f32 v202, v202, v32
 v_sub_f32 v203, v203, v32
 v_sub_f32 v204, v204, v32
 v_sub_f32 v205, v205, v32
 v_sub_f32 v206, v206, v32
 v_sub_f32 v207, v207, v32
 v_sub_f32 v168, v168, v32
 v_sub_f32 v169, v169, v32
 v_sub_f32 v170, v170, v32
 v_sub_f32 v171, v171, v32
 v_sub_f32 v172, v172, v32
 v_sub_f32 v173, v173, v32
 v_sub_f32 v174, v174, v32
 v_sub_f32 v175, v175, v32
 v_mul_f32 v252, v252, v34
 v_mul_f32 v253, v253, v34
 v_mul_f32 v254, v254, v34
 v_mul_f32 v255, v255, v34
 v_accvgpr_read_b32 v33, a96
 v_mul_f32 v33, v33, v34
 v_accvgpr_write_b32 a96, v33
 v_accvgpr_read_b32 v33, a97
 v_mul_f32 v33, v33, v34
 v_accvgpr_write_b32 a97, v33
 v_accvgpr_read_b32 v33, a98
 v_mul_f32 v33, v33, v34
 v_accvgpr_write_b32 a98, v33
 v_accvgpr_read_b32 v33, a99
 v_mul_f32 v33, v33, v34
 v_accvgpr_write_b32 a99, v33
 v_accvgpr_read_b32 v33, a100
 v_mul_f32 v33, v33, v34
 v_accvgpr_write_b32 a100, v33
 v_accvgpr_read_b32 v33, a101
 v_mul_f32 v33, v33, v34
 v_accvgpr_write_b32 a101, v33
 v_accvgpr_read_b32 v33, a102
 v_mul_f32 v33, v33, v34
 v_accvgpr_write_b32 a102, v33
 v_accvgpr_read_b32 v33, a103
 v_mul_f32 v33, v33, v34
 v_accvgpr_write_b32 a103, v33
 v_accvgpr_read_b32 v33, a104
 v_mul_f32 v33, v33, v34
 v_accvgpr_write_b32 a104, v33
 v_accvgpr_read_b32 v33, a105
 v_mul_f32 v33, v33, v34
 v_accvgpr_write_b32 a105, v33
 v_accvgpr_read_b32 v33, a106
 v_mul_f32 v33, v33, v34
 v_accvgpr_write_b32 a106, v33
 v_accvgpr_read_b32 v33, a107
 v_mul_f32 v33, v33, v34
 v_accvgpr_write_b32 a107, v33
 v_accvgpr_read_b32 v33, a108
 v_mul_f32 v33, v33, v34
 v_accvgpr_write_b32 a108, v33
 v_accvgpr_read_b32 v33, a109
 v_mul_f32 v33, v33, v34
 v_accvgpr_write_b32 a109, v33
 v_accvgpr_read_b32 v33, a110
 v_mul_f32 v33, v33, v34
 v_accvgpr_write_b32 a110, v33
 v_accvgpr_read_b32 v33, a111
 v_mul_f32 v33, v33, v34
 v_accvgpr_write_b32 a111, v33
 v_accvgpr_read_b32 v33, a112
 v_mul_f32 v33, v33, v34
 v_accvgpr_write_b32 a112, v33
 v_accvgpr_read_b32 v33, a113
 v_mul_f32 v33, v33, v34
 v_accvgpr_write_b32 a113, v33
 v_accvgpr_read_b32 v33, a114
 v_mul_f32 v33, v33, v34
 v_accvgpr_write_b32 a114, v33
 v_accvgpr_read_b32 v33, a115
 v_mul_f32 v33, v33, v34
 v_accvgpr_write_b32 a115, v33
 v_accvgpr_read_b32 v33, a116
 v_mul_f32 v33, v33, v34
 v_accvgpr_write_b32 a116, v33
 v_accvgpr_read_b32 v33, a117
 v_mul_f32 v33, v33, v34
 v_accvgpr_write_b32 a117, v33
 v_accvgpr_read_b32 v33, a118
 v_mul_f32 v33, v33, v34
 v_accvgpr_write_b32 a118, v33
 v_accvgpr_read_b32 v33, a119
 v_mul_f32 v33, v33, v34
 v_accvgpr_write_b32 a119, v33
 v_accvgpr_read_b32 v33, a120
 v_mul_f32 v33, v33, v34
 v_accvgpr_write_b32 a120, v33
 v_accvgpr_read_b32 v33, a121
 v_mul_f32 v33, v33, v34
 v_accvgpr_write_b32 a121, v33
 v_accvgpr_read_b32 v33, a122
 v_mul_f32 v33, v33, v34
 v_accvgpr_write_b32 a122, v33
 v_accvgpr_read_b32 v33, a123
 v_mul_f32 v33, v33, v34
 v_accvgpr_write_b32 a123, v33
 v_accvgpr_read_b32 v33, a124
 v_mul_f32 v33, v33, v34
 v_accvgpr_write_b32 a124, v33
 v_accvgpr_read_b32 v33, a125
 v_mul_f32 v33, v33, v34
 v_accvgpr_write_b32 a125, v33
 v_accvgpr_read_b32 v33, a126
 v_mul_f32 v33, v33, v34
 v_accvgpr_write_b32 a126, v33
 v_accvgpr_read_b32 v33, a127
 v_mul_f32 v33, v33, v34
 v_accvgpr_write_b32 a127, v33
 v_exp_f32 v36, v200
 v_exp_f32 v37, v201
 s_nop 0
 v_cvt_pk_bf16_f32 v236, v36, v37
 v_exp_f32 v36, v202
 v_exp_f32 v37, v203
 s_nop 0
 v_cvt_pk_bf16_f32 v237, v36, v37
 v_exp_f32 v36, v204
 v_exp_f32 v37, v205
 s_nop 0
 v_cvt_pk_bf16_f32 v238, v36, v37
 v_exp_f32 v36, v206
 v_exp_f32 v37, v207
 s_nop 0
 v_cvt_pk_bf16_f32 v239, v36, v37
 s_nop 1
 s_branch L_b2e_r1_ret
L_b1_r0:
 s_nop 7
 v_max3_f32 v32, v168, v169, v170
 v_max3_f32 v32, v171, v172, v32
 v_max3_f32 v32, v173, v174, v32
 v_max_f32 v32, v175, v32
 v_mov_b32 v33, v32
 s_nop 1
 v_permlane16_swap_b32 v32, v33
 s_nop 1
 v_max_f32 v32, v32, v33
 v_mov_b32 v33, v32
 s_nop 1
 v_permlane32_swap_b32 v32, v33
 s_nop 1
 v_max_f32 v32, v32, v33
 v_add_f32 v32, 0x41c00000, v32
 v_max_f32 v32, 0, v32
 v_exp_f32 v34, -v32
 v_sub_f32 v76, v76, v32
 v_sub_f32 v77, v77, v32
 v_sub_f32 v78, v78, v32
 v_sub_f32 v79, v79, v32
 v_sub_f32 v168, v168, v32
 v_sub_f32 v169, v169, v32
 v_sub_f32 v170, v170, v32
 v_sub_f32 v171, v171, v32
 v_sub_f32 v172, v172, v32
 v_sub_f32 v173, v173, v32
 v_sub_f32 v174, v174, v32
 v_sub_f32 v175, v175, v32
 v_sub_f32 v200, v200, v32
 v_sub_f32 v201, v201, v32
 v_sub_f32 v202, v202, v32
 v_sub_f32 v203, v203, v32
 v_sub_f32 v204, v204, v32
 v_sub_f32 v205, v205, v32
 v_sub_f32 v206, v206, v32
 v_sub_f32 v207, v207, v32
 v_mul_f32 v252, v252, v34
 v_mul_f32 v253, v253, v34
 v_mul_f32 v254, v254, v34
 v_mul_f32 v255, v255, v34
 v_accvgpr_read_b32 v33, a96
 v_mul_f32 v33, v33, v34
 v_accvgpr_write_b32 a96, v33
 v_accvgpr_read_b32 v33, a97
 v_mul_f32 v33, v33, v34
 v_accvgpr_write_b32 a97, v33
 v_accvgpr_read_b32 v33, a98
 v_mul_f32 v33, v33, v34
 v_accvgpr_write_b32 a98, v33
 v_accvgpr_read_b32 v33, a99
 v_mul_f32 v33, v33, v34
 v_accvgpr_write_b32 a99, v33
 v_accvgpr_read_b32 v33, a100
 v_mul_f32 v33, v33, v34
 v_accvgpr_write_b32 a100, v33
 v_accvgpr_read_b32 v33, a101
 v_mul_f32 v33, v33, v34
 v_accvgpr_write_b32 a101, v33
 v_accvgpr_read_b32 v33, a102
 v_mul_f32 v33, v33, v34
 v_accvgpr_write_b32 a102, v33
 v_accvgpr_read_b32 v33, a103
 v_mul_f32 v33, v33, v34
 v_accvgpr_write_b32 a103, v33
 v_accvgpr_read_b32 v33, a104
 v_mul_f32 v33, v33, v34
 v_accvgpr_write_b32 a104, v33
 v_accvgpr_read_b32 v33, a105
 v_mul_f32 v33, v33, v34
 v_accvgpr_write_b32 a105, v33
 v_accvgpr_read_b32 v33, a106
 v_mul_f32 v33, v33, v34
 v_accvgpr_write_b32 a106, v33
 v_accvgpr_read_b32 v33, a107
 v_mul_f32 v33, v33, v34
 v_accvgpr_write_b32 a107, v33
 v_accvgpr_read_b32 v33, a108
 v_mul_f32 v33, v33, v34
 v_accvgpr_write_b32 a108, v33
 v_accvgpr_read_b32 v33, a109
 v_mul_f32 v33, v33, v34
 v_accvgpr_write_b32 a109, v33
 v_accvgpr_read_b32 v33, a110
 v_mul_f32 v33, v33, v34
 v_accvgpr_write_b32 a110, v33
 v_accvgpr_read_b32 v33, a111
 v_mul_f32 v33, v33, v34
 v_accvgpr_write_b32 a111, v33
 v_accvgpr_read_b32 v33, a112
 v_mul_f32 v33, v33, v34
 v_accvgpr_write_b32 a112, v33
 v_accvgpr_read_b32 v33, a113
 v_mul_f32 v33, v33, v34
 v_accvgpr_write_b32 a113, v33
 v_accvgpr_read_b32 v33, a114
 v_mul_f32 v33, v33, v34
 v_accvgpr_write_b32 a114, v33
 v_accvgpr_read_b32 v33, a115
 v_mul_f32 v33, v33, v34
 v_accvgpr_write_b32 a115, v33
 v_accvgpr_read_b32 v33, a116
 v_mul_f32 v33, v33, v34
 v_accvgpr_write_b32 a116, v33
 v_accvgpr_read_b32 v33, a117
 v_mul_f32 v33, v33, v34
 v_accvgpr_write_b32 a117, v33
 v_accvgpr_read_b32 v33, a118
 v_mul_f32 v33, v33, v34
 v_accvgpr_write_b32 a118, v33
 v_accvgpr_read_b32 v33, a119
 v_mul_f32 v33, v33, v34
 v_accvgpr_write_b32 a119, v33
 v_accvgpr_read_b32 v33, a120
 v_mul_f32 v33, v33, v34
 v_accvgpr_write_b32 a120, v33
 v_accvgpr_read_b32 v33, a121
 v_mul_f32 v33, v33, v34
 v_accvgpr_write_b32 a121, v33
 v_accvgpr_read_b32 v33, a122
 v_mul_f32 v33, v33, v34
 v_accvgpr_write_b32 a122, v33
 v_accvgpr_read_b32 v33, a123
 v_mul_f32 v33, v33, v34
 v_accvgpr_write_b32 a123, v33
 v_accvgpr_read_b32 v33, a124
 v_mul_f32 v33, v33, v34
 v_accvgpr_write_b32 a124, v33
 v_accvgpr_read_b32 v33, a125
 v_mul_f32 v33, v33, v34
 v_accvgpr_write_b32 a125, v33
 v_accvgpr_read_b32 v33, a126
 v_mul_f32 v33, v33, v34
 v_accvgpr_write_b32 a126, v33
 v_accvgpr_read_b32 v33, a127
 v_mul_f32 v33, v33, v34
 v_accvgpr_write_b32 a127, v33
 v_exp_f32 v36, v168
 v_exp_f32 v37, v169
 s_nop 0
 v_cvt_pk_bf16_f32 v220, v36, v37
 v_exp_f32 v36, v170
 v_exp_f32 v37, v171
 s_nop 0
 v_cvt_pk_bf16_f32 v221, v36, v37
 v_exp_f32 v36, v172
 v_exp_f32 v37, v173
 s_nop 0
 v_cvt_pk_bf16_f32 v222, v36, v37
 v_exp_f32 v36, v174
 v_exp_f32 v37, v175
 s_nop 0
 v_cvt_pk_bf16_f32 v223, v36, v37
 s_nop 1
 s_branch L_b1_r0_ret
L_b1_r1:
 s_nop 7
 v_max3_f32 v32, v200, v201, v202
 v_max3_f32 v32, v203, v204, v32
 v_max3_f32 v32, v205, v206, v32
 v_max_f32 v32, v207, v32
 v_mov_b32 v33, v32
 s_nop 1
 v_permlane16_swap_b32 v32, v33
 s_nop 1
 v_max_f32 v32, v32, v33
 v_mov_b32 v33, v32
 s_nop 1
 v_permlane32_swap_b32 v32, v33
 s_nop 1
 v_max_f32 v32, v32, v33
 v_add_f32 v32, 0x41c00000, v32
 v_max_f32 v32, 0, v32
 v_exp_f32 v34, -v32
 v_sub_f32 v76, v76, v32
 v_sub_f32 v77, v77, v32
 v_sub_f32 v78, v78, v32
 v_sub_f32 v79, v79, v32
 v_sub_f32 v200, v200, v32
 v_sub_f32 v201, v201, v32
 v_sub_f32 v202, v202, v32
 v_sub_f32 v203, v203, v32
 v_sub_f32 v204, v204, v32
 v_sub_f32 v205, v205, v32
 v_sub_f32 v206, v206, v32
 v_sub_f32 v207, v207, v32
 v_mul_f32 v252, v252, v34
 v_mul_f32 v253, v253, v34
 v_mul_f32 v254, v254, v34
 v_mul_f32 v255, v255, v34
 v_accvgpr_read_b32 v33, a96
 v_mul_f32 v33, v33, v34
 v_accvgpr_write_b32 a96, v33
 v_accvgpr_read_b32 v33, a97
 v_mul_f32 v33, v33, v34
 v_accvgpr_write_b32 a97, v33
 v_accvgpr_read_b32 v33, a98
 v_mul_f32 v33, v33, v34
 v_accvgpr_write_b32 a98, v33
 v_accvgpr_read_b32 v33, a99
 v_mul_f32 v33, v33, v34
 v_accvgpr_write_b32 a99, v33
 v_accvgpr_read_b32 v33, a100
 v_mul_f32 v33, v33, v34
 v_accvgpr_write_b32 a100, v33
 v_accvgpr_read_b32 v33, a101
 v_mul_f32 v33, v33, v34
 v_accvgpr_write_b32 a101, v33
 v_accvgpr_read_b32 v33, a102
 v_mul_f32 v33, v33, v34
 v_accvgpr_write_b32 a102, v33
 v_accvgpr_read_b32 v33, a103
 v_mul_f32 v33, v33, v34
 v_accvgpr_write_b32 a103, v33
 v_accvgpr_read_b32 v33, a104
 v_mul_f32 v33, v33, v34
 v_accvgpr_write_b32 a104, v33
 v_accvgpr_read_b32 v33, a105
 v_mul_f32 v33, v33, v34
 v_accvgpr_write_b32 a105, v33
 v_accvgpr_read_b32 v33, a106
 v_mul_f32 v33, v33, v34
 v_accvgpr_write_b32 a106, v33
 v_accvgpr_read_b32 v33, a107
 v_mul_f32 v33, v33, v34
 v_accvgpr_write_b32 a107, v33
 v_accvgpr_read_b32 v33, a108
 v_mul_f32 v33, v33, v34
 v_accvgpr_write_b32 a108, v33
 v_accvgpr_read_b32 v33, a109
 v_mul_f32 v33, v33, v34
 v_accvgpr_write_b32 a109, v33
 v_accvgpr_read_b32 v33, a110
 v_mul_f32 v33, v33, v34
 v_accvgpr_write_b32 a110, v33
 v_accvgpr_read_b32 v33, a111
 v_mul_f32 v33, v33, v34
 v_accvgpr_write_b32 a111, v33
 v_accvgpr_read_b32 v33, a112
 v_mul_f32 v33, v33, v34
 v_accvgpr_write_b32 a112, v33
 v_accvgpr_read_b32 v33, a113
 v_mul_f32 v33, v33, v34
 v_accvgpr_write_b32 a113, v33
 v_accvgpr_read_b32 v33, a114
 v_mul_f32 v33, v33, v34
 v_accvgpr_write_b32 a114, v33
 v_accvgpr_read_b32 v33, a115
 v_mul_f32 v33, v33, v34
 v_accvgpr_write_b32 a115, v33
 v_accvgpr_read_b32 v33, a116
 v_mul_f32 v33, v33, v34
 v_accvgpr_write_b32 a116, v33
 v_accvgpr_read_b32 v33, a117
 v_mul_f32 v33, v33, v34
 v_accvgpr_write_b32 a117, v33
 v_accvgpr_read_b32 v33, a118
 v_mul_f32 v33, v33, v34
 v_accvgpr_write_b32 a118, v33
 v_accvgpr_read_b32 v33, a119
 v_mul_f32 v33, v33, v34
 v_accvgpr_write_b32 a119, v33
 v_accvgpr_read_b32 v33, a120
 v_mul_f32 v33, v33, v34
 v_accvgpr_write_b32 a120, v33
 v_accvgpr_read_b32 v33, a121
 v_mul_f32 v33, v33, v34
 v_accvgpr_write_b32 a121, v33
 v_accvgpr_read_b32 v33, a122
 v_mul_f32 v33, v33, v34
 v_accvgpr_write_b32 a122, v33
 v_accvgpr_read_b32 v33, a123
 v_mul_f32 v33, v33, v34
 v_accvgpr_write_b32 a123, v33
 v_accvgpr_read_b32 v33, a124
 v_mul_f32 v33, v33, v34
 v_accvgpr_write_b32 a124, v33
 v_accvgpr_read_b32 v33, a125
 v_mul_f32 v33, v33, v34
 v_accvgpr_write_b32 a125, v33
 v_accvgpr_read_b32 v33, a126
 v_mul_f32 v33, v33, v34
 v_accvgpr_write_b32 a126, v33
 v_accvgpr_read_b32 v33, a127
 v_mul_f32 v33, v33, v34
 v_accvgpr_write_b32 a127, v33
 v_exp_f32 v36, v200
 v_exp_f32 v37, v201
 s_nop 0
 v_cvt_pk_bf16_f32 v236, v36, v37
 v_exp_f32 v36, v202
 v_exp_f32 v37, v203
 s_nop 0
 v_cvt_pk_bf16_f32 v237, v36, v37
 v_exp_f32 v36, v204
 v_exp_f32 v37, v205
 s_nop 0
 v_cvt_pk_bf16_f32 v238, v36, v37
 v_exp_f32 v36, v206
 v_exp_f32 v37, v207
 s_nop 0
 v_cvt_pk_bf16_f32 v239, v36, v37
 s_nop 1
 s_branch L_b1_r1_ret

.section .rodata,"a"
.p2align 6
.amdhsa_kernel gated_mix__ssm_conv_h3__compressed_kv_cla__prompt_kernel
  .amdhsa_next_free_vgpr 512
  .amdhsa_next_free_sgpr 102
  .amdhsa_accum_offset 256
  .amdhsa_group_segment_fixed_size 0
  .amdhsa_kernarg_size 128
  .amdhsa_user_sgpr_count 2
  .amdhsa_user_sgpr_kernarg_segment_ptr 1
  .amdhsa_system_sgpr_workgroup_id_x 1
  .amdhsa_float_denorm_mode_32 3
.end_amdhsa_kernel
```
